```python
import torch

def _softmax(x, axis=-1):
    return torch.softmax(x, dim=axis)

def _gelu(x):
    return torch.nn.functional.gelu(x, approximate='tanh')

def _silu(x):
    return torch.nn.functional.silu(x)

def _sigmoid(x):
    return torch.sigmoid(x)

def _layernorm(x, axis=-1, eps=1e-05):
    m = x.mean(dim=axis, keepdim=True)
    v = x.var(dim=axis, keepdim=True, unbiased=False)
    return (x - m) / torch.sqrt(v + eps)

def _scatter_add(tgt, idx, src, axis=0):
    return tgt.clone().index_add_(axis, idx, src)

def _segment_sum(src, seg, n):
    out = torch.zeros((n,) + src.shape[1:], dtype=src.dtype)
    return out.index_add_(0, seg, src)

def _pad(x, pw):
    flat = tuple((v for pair in reversed(pw) for v in pair))
    return torch.nn.functional.pad(x, flat)
kernel_name = 'adaLN_cond__memory_aug_recurrent_mem_tr__moe_arch_mod__prompt'

def setup_inputs():

    _w = lambda a: (lambda t: t.to(torch.bfloat16) if t.is_floating_point() else t)(torch.as_tensor(a))

    def _A_setup():
        B, S, Dm = (1, 2048, 640)
        H, Dh = (32, 192)
        M, seg = (8, 32)
        seg = min(seg, S)
        S = S // seg * seg
        return {'x': _w((lambda *s: torch.randn(*s, dtype=torch.bfloat16) * 0.05)(B, S, Dm)), 'mem0': _w((lambda *s: torch.randn(*s, dtype=torch.bfloat16) * 0.4)(B, M, Dm)), 'Wq': _w((lambda *s: torch.randn(*s, dtype=torch.bfloat16) * 3.2)(Dm, H, Dh) * Dm ** (-0.5)), 'Wk': _w((lambda *s: torch.randn(*s, dtype=torch.bfloat16) * 3.2)(Dm, H, Dh) * Dm ** (-0.5)), 'Wv': _w((lambda *s: torch.randn(*s, dtype=torch.bfloat16) * 0.4)(Dm, H, Dh) * Dm ** (-0.5)), 'Wo': _w((lambda *s: torch.randn(*s, dtype=torch.bfloat16) * 0.4)(H, Dh, Dm) * (H * Dh) ** (-0.5)), 'seg_len': seg}
    _A_in = _A_setup()

    def _B_setup():
        B, S, D, F, C = (1, 2048, 640, 1536, 8)
        return {'x': _w((lambda *s: torch.randn(*s, dtype=torch.bfloat16) * 0.05)(B, S, D)), 'w_r': _w((lambda *s: torch.randn(*s, dtype=torch.bfloat16) * 0.05)(D)), 'w_gate': _w((lambda *s: torch.randn(*s, dtype=torch.bfloat16) * 0.05)(D, F)), 'w_up': _w((lambda *s: torch.randn(*s, dtype=torch.bfloat16) * 0.05)(D, F)), 'w_down': _w((lambda *s: torch.randn(*s, dtype=torch.bfloat16) * 0.05)(F, D))}
    _B_in = _B_setup()
    return {'A_x': _A_in['x'], 'A_mem0': _A_in['mem0'], 'A_Wq': _A_in['Wq'], 'A_Wk': _A_in['Wk'], 'A_Wv': _A_in['Wv'], 'A_Wo': _A_in['Wo'], 'A_seg_len': _A_in['seg_len'], 'B_x': _B_in['x'], 'B_w_r': _B_in['w_r'], 'B_w_gate': _B_in['w_gate'], 'B_w_up': _B_in['w_up'], 'B_w_down': _B_in['w_down'], 'c': _w((lambda *s: torch.randn(*s, dtype=torch.bfloat16) * 0.05)(1, 640) * 8.0), 'w_mod': _w((lambda *s: torch.randn(*s, dtype=torch.bfloat16) * 0.05)(640, 6 * 640) * 640 ** (-0.5) * 8.0)}

def reference(A_x, A_mem0, A_Wq, A_Wk, A_Wv, A_Wo, A_seg_len, B_x, B_w_r, B_w_gate, B_w_up, B_w_down, c, w_mod):

    def _A_ref(x, mem0, Wq, Wk, Wv, Wo, seg_len):
        B, S, Dm = x.shape
        H, Dh = (Wq.shape[1], Wq.shape[2])
        M = mem0.shape[1]
        scale = Dh ** (-0.5)
        n_seg = S // seg_len
        L = M + seg_len
        idx = torch.arange(L)
        mask = (idx[:, None] < M) | (idx[:, None] >= idx[None, :])
        mem = mem0
        outs = []
        for s in range(n_seg):
            xs = x[:, s * seg_len:(s + 1) * seg_len, :].clone()
            h = torch.concatenate([mem, xs], axis=1)
            q = torch.einsum('btd,dhe->bhte', h, Wq)
            k = torch.einsum('btd,dhe->bhte', h, Wk)
            v = torch.einsum('btd,dhe->bhte', h, Wv)
            scores = torch.einsum('bhqe,bhke->bhqk', q, k) * scale
            scores = torch.where(mask[None, None], scores, -1000000000.0)
            p = _softmax(scores, axis=-1)
            o = torch.einsum('bhqk,bhke->bhqe', p, v)
            o = torch.einsum('bhte,hed->btd', o, Wo)
            mem = o[:, :M, :].clone()
            outs.append(o[:, M:, :])
        return torch.concatenate(outs, axis=1)

    def _B_ref(x, w_r, w_gate, w_up, w_down):
        B, S, D = x.shape
        C = 8
        r = x @ w_r
        idx = torch.argsort(-r, axis=-1)[:, :C]
        idx_e = (lambda x, n, axis: torch.repeat_interleave(x, n, dim=axis))(idx.reshape(B, C, 1), D, axis=2)
        x_sel = (lambda x, i, axis: torch.take_along_dim(x, i, dim=axis))(x, idx_e, axis=1)
        g = _silu(x_sel @ w_gate)
        u = x_sel @ w_up
        y = g * u @ w_down
        r_sel = _sigmoid((lambda x, i, axis: torch.take_along_dim(x, i, dim=axis))(r, idx, axis=1))
        y = y * r_sel.reshape(B, C, 1)
        b_off = (torch.arange(B) * S).reshape(B, 1)
        flat_idx = (idx + b_off).reshape(B * C)
        zero = (x * 0.0).reshape(B * S, D)
        upd = _scatter_add(zero, flat_idx, y.reshape(B * C, D), axis=0)
        return x + upd.reshape(B, S, D)
    x = A_x
    mod = (_silu(c) @ w_mod).reshape(c.shape[0], 6, 1, -1)
    sa, ca, ga, sb, cb, gb = (mod[:, 0].clone(), mod[:, 1].clone(), mod[:, 2].clone(), mod[:, 3].clone(), mod[:, 4].clone(), mod[:, 5].clone())
    h = _layernorm(x, axis=-1) * (1 + ca) + sa
    x = x + ga * _A_ref(h, A_mem0, A_Wq, A_Wk, A_Wv, A_Wo, A_seg_len)
    h = _layernorm(x, axis=-1) * (1 + cb) + sb
    x = x + gb * _B_ref(h, B_w_r, B_w_gate, B_w_up, B_w_down)
    return x
```

```asm
; @launch kernel=rec_kernel grid=(256,1,1) block=(256,1,1) lds=163840
.amdgcn_target "amdgcn-amd-amdhsa--gfx950"
.text
.globl rec_kernel
.p2align 8
.type rec_kernel,@function
rec_kernel:
    s_cmp_ge_u32 s2, 256
    s_cbranch_scc1 R_exit
    s_load_dwordx2 s[8:9], s[0:1], 128
    s_load_dwordx2 s[12:13], s[0:1], 120
    s_mov_b32 s10, 268435456
    s_mov_b32 s11, 0x20000
    s_mov_b32 s14, 256
    s_mov_b32 s15, 0x20000
    s_waitcnt lgkmcnt(0)
    s_getreg_b32 s4, hwreg(HW_REG_XCC_ID)
    s_getreg_b32 s5, hwreg(HW_REG_HW_ID)
    s_and_b32 s4, s4, 7
    s_bfe_u32 s20, s5, 0x30008
    s_bfe_u32 s6, s5, 0x1000b
    s_bfe_u32 s5, s5, 131085
    s_lshl_b32 s7, s5, 3
    s_add_u32 s20, s20, s7
    v_and_b32 v1, 63, v0
    v_lshrrev_b32 v2, 6, v0
    s_nop 0
    v_readfirstlane_b32 s3, v2
    s_mov_b32 s30, 65536
    s_lshl_b32 s5, s4, 5
    v_mov_b32 v134, 0
    s_cmp_lg_u32 s6, 0
    s_cbranch_scc1 R_c8
R_clm:
    s_lshl_b32 s33, 1, s20
    s_cmp_lg_u32 s3, 0
    s_cbranch_scc1 R_disp
    v_mov_b32 v135, s33
    s_mov_b64 exec, 1
    buffer_atomic_or v135, v134, s[12:15], s5 offen sc0 sc1
    s_mov_b64 exec, -1
R_disp:
    s_mov_b32 s99, s4
    s_lshl_b32 s51, s4, 5
    s_add_u32 s51, s51, s20
    s_mov_b32 s82, 0
    s_cmp_ge_u32 s20, 28
    s_cbranch_scc1 R_x
    s_cmp_ge_u32 s20, 18
    s_cbranch_scc1 R_c
    s_cmp_ge_u32 s20, 12
    s_cbranch_scc1 R_v
    v_lshlrev_b32 v2, 4, v1
    s_load_dwordx2 s[12:13], s[0:1], 16
    s_load_dwordx2 s[16:17], s[0:1], 24
    s_mov_b32 s14, 7864320
    s_mov_b32 s15, 0x20000
    s_mov_b32 s18, 7864320
    s_mov_b32 s19, 0x20000
    s_waitcnt lgkmcnt(0)
    s_mul_i32 s42, s99, 12
    s_add_u32 s42, s42, s20
    s_lshl_b32 s42, s42, 7
    s_mov_b32 s47, s42
    s_lshl_b32 s37, s3, 11
    s_lshl_b32 s4, s3, 4
    s_and_b32 s5, s3, 1
    s_lshl_b32 s5, s5, 1
    v_lshrrev_b32 v60, 3, v1
    v_and_b32 v61, 1, v60
    v_or_b32 v61, s5, v61
    v_add_u32 v60, s4, v60
    v_mul_u32_u24 v13, 12288, v60
    v_bfe_u32 v60, v1, 1, 2
    v_xor_b32 v60, v60, v61
    v_lshlrev_b32 v60, 5, v60
    v_and_b32 v61, 1, v1
    v_lshlrev_b32 v61, 4, v61
    v_add3_u32 v13, v13, v60, v61
    v_lshrrev_b32 v60, 4, v1
    v_lshlrev_b32 v60, 2, v60
    v_bfe_u32 v61, v1, 2, 1
    v_add_u32 v60, v60, v61
    v_bfe_u32 v61, v1, 3, 1
    v_lshlrev_b32 v61, 4, v61
    v_add_u32 v60, v60, v61
    v_lshlrev_b32 v0, 7, v60
    v_bfe_u32 v60, v1, 2, 2
    v_lshlrev_b32 v60, 5, v60
    v_and_b32 v61, 3, v1
    v_lshlrev_b32 v61, 3, v61
    v_add3_u32 v0, v0, v60, v61
    v_mov_b32 v134, 163776
    s_cmp_lg_u32 s3, 0
    s_cbranch_scc1 SC_c
    s_waitcnt vmcnt(0)
    v_readfirstlane_b32 s4, v135
    s_and_b32 s4, s4, s33
    s_nop 0
    v_mov_b32 v135, s4
    ds_write_b32 v134, v135
    s_waitcnt lgkmcnt(0)
SC_c:
    s_barrier
    ds_read_b32 v135, v134
    s_waitcnt lgkmcnt(0)
    v_readfirstlane_b32 s4, v135
    s_cmp_lg_u32 s4, 0
    s_cbranch_scc1 R_ovf
    s_load_dwordx2 s[84:85], s[0:1], 120
    s_mov_b32 s86, 256
    s_mov_b32 s87, 0x20000
    s_waitcnt lgkmcnt(0)
    s_mul_i32 s22, s99, 1048576
    s_add_u32 s22, s22, 8388608
    s_lshl_b32 s33, s20, 4
    s_lshl_b32 s4, s3, 2
    s_add_u32 s33, s33, s4
    s_add_u32 s33, s33, s22
    s_add_u32 s33, s33, 155648
    s_mov_b32 s48, 0xfffffffe
    v_mov_b32 v9, 0
    v_mov_b32 v240, -1
    v_mov_b32 v241, -1
    v_mov_b32 v242, -1
    v_mov_b32 v243, -1
    v_and_b32 v16, 8, v1
    v_mov_b32 v5, 0x4444
    v_mov_b32 v17, 0xeeee
    v_cmp_ne_u32 vcc, 0, v16
    s_nop 1
    v_cndmask_b32 v5, v5, v17, vcc
    s_mul_i32 s4, s20, 43
    s_lshr_b32 s4, s4, 7
    s_mul_i32 s5, s4, 3
    s_sub_u32 s5, s20, s5
    s_lshl_b32 s4, s4, 12
    s_lshl_b32 s6, s5, 10
    s_add_u32 s6, s6, s4
    s_lshl_b32 s7, s3, 6
    s_add_u32 s6, s6, s7
    s_lshl_b32 s5, s5, 2
    s_add_u32 s5, s5, s4
    s_add_u32 s5, s5, 3072
    v_and_b32 v16, 7, v1
    v_lshrrev_b32 v17, 4, v1
    v_bfe_u32 v18, v1, 3, 1
    v_lshlrev_b32 v19, 7, v16
    v_mov_b32 v64, 0x80000000
    v_mov_b32 v65, 0x80000000
    v_mov_b32 v14, 0x80000000
    s_cmp_lt_u32 s3, 2
    s_cselect_b32 exec_lo, 0x00ff00ff, 0
    s_mov_b32 exec_hi, exec_lo
    v_lshl_add_u32 v64, v17, 4, v19
    v_add_u32 v64, s6, v64
    s_cmp_eq_u32 s3, 2
    s_cselect_b64 exec, -1, 0
    v_lshl_add_u32 v65, v17, 5, v19
    v_lshl_add_u32 v65, v18, 4, v65
    v_add_u32 v65, s5, v65
    s_cmp_eq_u32 s3, 3
    s_cselect_b64 exec, 1, 0
    v_mov_b32 v14, 0
    s_mov_b64 exec, -1
    s_add_u32 s24, s22, 40960
    s_add_u32 s5, s24, 16384
    s_mul_i32 s4, s20, 43
    s_lshr_b32 s4, s4, 7
    s_mul_i32 s4, s4, 61
    s_add_u32 s4, s4, s20
    s_lshl_b32 s4, s4, 2
    s_add_u32 s44, s4, s22
    s_add_u32 s44, s44, 156800
    buffer_store_dwordx4 v[240:243], v64, s[8:11], s24 offen offset:0 sc1
    buffer_store_dword v240, v65, s[8:11], s24 offen offset:0 sc1
    buffer_store_dwordx4 v[240:243], v64, s[8:11], s5 offen offset:0 sc1
    buffer_store_dword v240, v65, s[8:11], s5 offen offset:0 sc1
    buffer_store_dword v9, v14, s[8:11], s44 offen offset:0 sc1
    v_mov_b32 v10, 0
    s_mov_b64 exec, 1
    buffer_store_dword v10, v9, s[8:11], s33 offen sc1
    s_mov_b64 exec, -1
    v_and_b32 v16, 15, v1
    v_lshrrev_b32 v17, 4, v1
    v_and_b32 v18, 1, v17
    v_lshlrev_b32 v18, 2, v18
    v_sub_u32 v18, v16, v18
    v_mov_b32 v19, 0x3f80
    v_mov_b32 v20, 0x3f800000
    v_cmp_eq_u32 vcc, 0, v18
    s_nop 1
    v_cndmask_b32 v84, 0, v19, vcc
    v_cmp_eq_u32 vcc, 1, v18
    s_nop 1
    v_cndmask_b32 v84, v84, v20, vcc
    v_cmp_eq_u32 vcc, 2, v18
    s_nop 1
    v_cndmask_b32 v85, 0, v19, vcc
    v_cmp_eq_u32 vcc, 3, v18
    s_nop 1
    v_cndmask_b32 v85, v85, v20, vcc
    v_cmp_eq_u32 vcc, 8, v18
    s_nop 1
    v_cndmask_b32 v86, 0, v19, vcc
    v_cmp_eq_u32 vcc, 9, v18
    s_nop 1
    v_cndmask_b32 v86, v86, v20, vcc
    v_cmp_eq_u32 vcc, 10, v18
    s_nop 1
    v_cndmask_b32 v87, 0, v19, vcc
    v_cmp_eq_u32 vcc, 11, v18
    s_nop 1
    v_cndmask_b32 v87, v87, v20, vcc
    s_lshl_b32 s4, s3, 11
    s_add_u32 s4, s4, 73728
    v_add_u32 v3, s4, v2
    s_lshl_b32 s4, s3, 9
    s_add_u32 s4, s4, 90112
    v_lshl_add_u32 v4, v1, 3, s4
    s_mul_i32 s4, s3, 640
    s_add_u32 s4, s4, 92160
    v_mul_u32_u24 v7, 40, v16
    v_lshl_add_u32 v7, v17, 3, v7
    v_add_u32 v7, s4, v7
    v_lshrrev_b32 v18, 2, v1
    v_mul_u32_u24 v18, 40, v18
    v_add_u32 v18, 92160, v18
    v_and_b32 v19, 1, v1
    v_lshl_add_u32 v8, v19, 3, v18
    s_cmp_eq_u32 s3, 2
    s_cselect_b32 s4, 1, 0
    v_bfe_u32 v19, v1, s4, 1
    v_lshl_add_u32 v6, v19, 3, v18
    s_lshr_b32 s4, s3, 1
    s_lshl_b32 s4, s4, 10
    s_and_b32 s5, s3, 1
    s_lshl_b32 s5, s5, 3
    s_add_u32 s4, s4, s5
    s_add_u32 s4, s4, 96256
    v_add_u32 v12, s4, v2
    s_lshl_b32 s4, s3, 2
    s_lshr_b32 s5, 0x0232, s4
    s_and_b32 s5, s5, 3
    s_lshl_b32 s5, s5, 11
    s_add_u32 s5, s5, 96256
    v_add_u32 v15, s5, v2
    s_min_u32 s5, s3, 1
    s_lshl_b32 s5, s5, 11
    s_add_u32 s5, s5, 96256
    v_add_u32 v62, s5, v2
    s_lshr_b32 s5, 0x3120, s4
    s_and_b32 s5, s5, 3
    s_lshl_b32 s5, s5, 10
    s_lshl_b32 s36, s20, 12
    s_add_u32 s36, s36, s5
    s_add_u32 s36, s36, s22
    s_add_u32 s36, s36, 356352
    s_cmp_eq_u32 s3, 3
    s_cselect_b32 s5, 0x80000000, 0
    v_add_u32 v63, s5, v2
    s_lshl_b32 s4, s20, 2
    s_add_u32 s4, s4, s3
    s_lshr_b32 s5, s4, 3
    s_lshl_b32 s5, s5, 14
    s_and_b32 s6, s4, 7
    s_lshl_b32 s6, s6, 10
    s_add_u32 s5, s5, s6
    s_and_b32 s6, s99, 3
    s_mul_i32 s6, s6, 81920
    s_add_u32 s5, s5, s6
    s_and_b32 s6, s99, 4
    s_lshl_b32 s6, s6, 11
    s_add_u32 s5, s5, s6
    s_add_u32 s46, s5, 48758784
    s_cmp_lt_u32 s4, 40
    s_cselect_b32 s45, 7, 0
    s_cselect_b32 s88, 20, 99
    s_mul_i32 s5, s99, 40
    s_add_u32 s5, s5, s4
    s_lshl_b32 s5, s5, 10
    s_cmp_lt_u32 s5, 163840
    s_cselect_b32 s6, 0, 2457600
    s_add_u32 s5, s5, s6
    s_add_u32 s89, s5, 59080704
    s_mov_b32 s40, 0xff00ff00
    s_mov_b32 s41, 0xff00ff00
    s_mov_b32 s90, 0xffff0000
    s_mov_b32 s91, 0xffff0000
    s_waitcnt vmcnt(0)
    s_barrier
    s_cmp_lg_u32 s3, 0
    s_cbranch_scc1 SA_n
    s_lshl_b32 s4, s99, 5
    s_add_u32 s4, s4, 4
    v_mov_b32 v16, 0
    v_mov_b32 v17, 1
    s_mov_b64 exec, 1
    buffer_atomic_add v17, v16, s[84:87], s4 offen sc1
    s_mov_b64 exec, -1
SA_n:
    s_add_u32 s4, s42, 0
    s_add_u32 m0, s37, 0
    s_nop 0
    buffer_load_dwordx4 v13, s[12:15], s4 offen nt lds
    s_add_u32 s4, s42, 98304
    s_add_u32 m0, s37, 1024
    s_nop 0
    buffer_load_dwordx4 v13, s[12:15], s4 offen nt lds
    s_waitcnt vmcnt(2)
    s_add_u32 s4, s47, 0
    s_add_u32 m0, s37, 81920
    s_nop 0
    buffer_load_dwordx4 v13, s[16:19], s4 offen nt lds
    s_add_u32 s4, s47, 98304
    s_add_u32 m0, s37, 82944
    s_nop 0
    buffer_load_dwordx4 v13, s[16:19], s4 offen nt lds
    s_waitcnt vmcnt(2)
    s_add_u32 s4, s42, 786432
    s_add_u32 m0, s37, 8192
    s_nop 0
    buffer_load_dwordx4 v13, s[12:15], s4 offen nt lds
    s_add_u32 s4, s42, 884736
    s_add_u32 m0, s37, 9216
    s_nop 0
    buffer_load_dwordx4 v13, s[12:15], s4 offen nt lds
    s_waitcnt vmcnt(2)
    s_add_u32 s4, s47, 786432
    s_add_u32 m0, s37, 90112
    s_nop 0
    buffer_load_dwordx4 v13, s[16:19], s4 offen nt lds
    s_add_u32 s4, s47, 884736
    s_add_u32 m0, s37, 91136
    s_nop 0
    buffer_load_dwordx4 v13, s[16:19], s4 offen nt lds
    s_waitcnt vmcnt(2)
    s_add_u32 s4, s42, 1572864
    s_add_u32 m0, s37, 16384
    s_nop 0
    buffer_load_dwordx4 v13, s[12:15], s4 offen nt lds
    s_add_u32 s4, s42, 1671168
    s_add_u32 m0, s37, 17408
    s_nop 0
    buffer_load_dwordx4 v13, s[12:15], s4 offen nt lds
    s_waitcnt vmcnt(2)
    s_add_u32 s4, s47, 1572864
    s_add_u32 m0, s37, 98304
    s_nop 0
    buffer_load_dwordx4 v13, s[16:19], s4 offen nt lds
    s_add_u32 s4, s47, 1671168
    s_add_u32 m0, s37, 99328
    s_nop 0
    buffer_load_dwordx4 v13, s[16:19], s4 offen nt lds
    s_waitcnt vmcnt(2)
    s_add_u32 s4, s42, 2359296
    s_add_u32 m0, s37, 24576
    s_nop 0
    buffer_load_dwordx4 v13, s[12:15], s4 offen nt lds
    s_add_u32 s4, s42, 2457600
    s_add_u32 m0, s37, 25600
    s_nop 0
    buffer_load_dwordx4 v13, s[12:15], s4 offen nt lds
    s_waitcnt vmcnt(2)
    s_add_u32 s4, s47, 2359296
    s_add_u32 m0, s37, 106496
    s_nop 0
    buffer_load_dwordx4 v13, s[16:19], s4 offen nt lds
    s_add_u32 s4, s47, 2457600
    s_add_u32 m0, s37, 107520
    s_nop 0
    buffer_load_dwordx4 v13, s[16:19], s4 offen nt lds
    s_waitcnt vmcnt(2)
    s_add_u32 s4, s42, 3145728
    s_add_u32 m0, s37, 32768
    s_nop 0
    buffer_load_dwordx4 v13, s[12:15], s4 offen nt lds
    s_add_u32 s4, s42, 3244032
    s_add_u32 m0, s37, 33792
    s_nop 0
    buffer_load_dwordx4 v13, s[12:15], s4 offen nt lds
    s_waitcnt vmcnt(2)
    s_add_u32 s4, s47, 3145728
    s_add_u32 m0, s37, 114688
    s_nop 0
    buffer_load_dwordx4 v13, s[16:19], s4 offen nt lds
    s_add_u32 s4, s47, 3244032
    s_add_u32 m0, s37, 115712
    s_nop 0
    buffer_load_dwordx4 v13, s[16:19], s4 offen nt lds
    s_waitcnt vmcnt(2)
    v_and_b32 v16, 7, v1
    v_lshlrev_b32 v16, 5, v16
    buffer_load_dwordx4 v[20:23], v16, s[84:87], 0 offen sc1
    s_add_u32 s4, s42, 3932160
    s_add_u32 m0, s37, 40960
    s_nop 0
    buffer_load_dwordx4 v13, s[12:15], s4 offen nt lds
    s_add_u32 s4, s42, 4030464
    s_add_u32 m0, s37, 41984
    s_nop 0
    buffer_load_dwordx4 v13, s[12:15], s4 offen nt lds
    s_add_u32 s4, s47, 3932160
    s_add_u32 m0, s37, 122880
    s_nop 0
    buffer_load_dwordx4 v13, s[16:19], s4 offen nt lds
    s_add_u32 s4, s47, 4030464
    s_add_u32 m0, s37, 123904
    s_nop 0
    buffer_load_dwordx4 v13, s[16:19], s4 offen nt lds
    s_add_u32 s4, s42, 4718592
    s_add_u32 m0, s37, 49152
    s_nop 0
    buffer_load_dwordx4 v13, s[12:15], s4 offen nt lds
    s_add_u32 s4, s42, 4816896
    s_add_u32 m0, s37, 50176
    s_nop 0
    buffer_load_dwordx4 v13, s[12:15], s4 offen nt lds
    s_add_u32 s4, s47, 4718592
    s_add_u32 m0, s37, 131072
    s_nop 0
    buffer_load_dwordx4 v13, s[16:19], s4 offen nt lds
    s_add_u32 s4, s47, 4816896
    s_add_u32 m0, s37, 132096
    s_nop 0
    buffer_load_dwordx4 v13, s[16:19], s4 offen nt lds
    s_add_u32 s4, s42, 5505024
    s_add_u32 m0, s37, 57344
    s_nop 0
    buffer_load_dwordx4 v13, s[12:15], s4 offen nt lds
    s_add_u32 s4, s42, 5603328
    s_add_u32 m0, s37, 58368
    s_nop 0
    buffer_load_dwordx4 v13, s[12:15], s4 offen nt lds
    s_add_u32 s4, s47, 5505024
    s_add_u32 m0, s37, 139264
    s_nop 0
    buffer_load_dwordx4 v13, s[16:19], s4 offen nt lds
    s_add_u32 s4, s47, 5603328
    s_add_u32 m0, s37, 140288
    s_nop 0
    buffer_load_dwordx4 v13, s[16:19], s4 offen nt lds
    s_add_u32 s4, s42, 6291456
    s_add_u32 m0, s37, 65536
    s_nop 0
    buffer_load_dwordx4 v13, s[12:15], s4 offen nt lds
    s_add_u32 s4, s42, 6389760
    s_add_u32 m0, s37, 66560
    s_nop 0
    buffer_load_dwordx4 v13, s[12:15], s4 offen nt lds
    s_add_u32 s4, s47, 6291456
    s_add_u32 m0, s37, 147456
    s_nop 0
    buffer_load_dwordx4 v13, s[16:19], s4 offen nt lds
    s_add_u32 s4, s47, 6389760
    s_add_u32 m0, s37, 148480
    s_nop 0
    buffer_load_dwordx4 v13, s[16:19], s4 offen nt lds
    s_mov_b32 s31, 0
    s_waitcnt vmcnt(16)
    s_branch SI_c
SI_l:
    buffer_load_dwordx4 v[20:23], v16, s[84:87], 0 offen sc1
    s_waitcnt vmcnt(0)
SI_c:
    v_bcnt_u32_b32 v17, v20, v23
    v_cmp_lt_u32 s[4:5], 32, v17
    s_and_b32 s6, s4, 0xff
    v_cmp_ne_u32 s[4:5], 32, v17
    s_cmp_eq_u32 s6, 0
    s_cselect_b32 s5, 0xff, 0
    s_and_b32 s4, s4, s5
    v_cmp_gt_u32 vcc, 22, v21
    s_and_b32 vcc_lo, vcc_lo, 0xff
    s_or_b32 vcc_lo, vcc_lo, s4
    s_mov_b32 vcc_hi, 0
    s_cbranch_vccz SI_o
    s_sleep 16
    s_add_u32 s31, s31, 1
    s_cmp_lt_u32 s31, s30
    s_cbranch_scc1 SI_l
    s_mov_b32 s30, 1
SI_o:
    s_mov_b32 s97, s6
    v_and_b32 v67, 3, v1
    v_lshlrev_b32 v67, 7, v67
    s_mov_b32 s23, 65536
    buffer_load_dword v68, v67, s[8:11], s23 offen offset:0 sc1
    s_add_u32 s4, s42, 7077888
    s_add_u32 m0, s37, 73728
    s_nop 0
    buffer_load_dwordx4 v13, s[12:15], s4 offen nt lds
    s_add_u32 s4, s42, 7176192
    s_add_u32 m0, s37, 74752
    s_nop 0
    buffer_load_dwordx4 v13, s[12:15], s4 offen nt lds
    s_add_u32 s4, s47, 7077888
    s_add_u32 m0, s37, 155648
    s_nop 0
    buffer_load_dwordx4 v13, s[16:19], s4 offen nt lds
    s_add_u32 s4, s47, 7176192
    s_add_u32 m0, s37, 156672
    s_nop 0
    buffer_load_dwordx4 v13, s[16:19], s4 offen nt lds
    s_barrier
    s_lshl_b32 s4, s3, 5
    v_xor_b32 v60, s4, v0
    v_add_u32 v61, 81920, v60
    ds_read_b64_tr_b16 a[0:1], v60 offset:0
    ds_read_b64_tr_b16 a[2:3], v60 offset:256
    ds_read_b64_tr_b16 a[4:5], v60 offset:4096
    ds_read_b64_tr_b16 a[6:7], v60 offset:4352
    ds_read_b64_tr_b16 a[8:9], v60 offset:8192
    ds_read_b64_tr_b16 a[10:11], v60 offset:8448
    ds_read_b64_tr_b16 a[12:13], v60 offset:12288
    ds_read_b64_tr_b16 a[14:15], v60 offset:12544
    ds_read_b64_tr_b16 a[16:17], v60 offset:16384
    ds_read_b64_tr_b16 a[18:19], v60 offset:16640
    ds_read_b64_tr_b16 a[20:21], v60 offset:20480
    ds_read_b64_tr_b16 a[22:23], v60 offset:20736
    ds_read_b64_tr_b16 a[24:25], v60 offset:24576
    ds_read_b64_tr_b16 a[26:27], v60 offset:24832
    ds_read_b64_tr_b16 a[28:29], v60 offset:28672
    ds_read_b64_tr_b16 a[30:31], v60 offset:28928
    ds_read_b64_tr_b16 a[32:33], v60 offset:32768
    ds_read_b64_tr_b16 a[34:35], v60 offset:33024
    ds_read_b64_tr_b16 a[36:37], v60 offset:36864
    ds_read_b64_tr_b16 a[38:39], v60 offset:37120
    ds_read_b64_tr_b16 a[80:81], v61 offset:0
    ds_read_b64_tr_b16 a[82:83], v61 offset:256
    ds_read_b64_tr_b16 a[84:85], v61 offset:4096
    ds_read_b64_tr_b16 a[86:87], v61 offset:4352
    ds_read_b64_tr_b16 a[88:89], v61 offset:8192
    ds_read_b64_tr_b16 a[90:91], v61 offset:8448
    ds_read_b64_tr_b16 a[92:93], v61 offset:12288
    ds_read_b64_tr_b16 a[94:95], v61 offset:12544
    ds_read_b64_tr_b16 a[96:97], v61 offset:16384
    ds_read_b64_tr_b16 a[98:99], v61 offset:16640
    ds_read_b64_tr_b16 a[100:101], v61 offset:20480
    ds_read_b64_tr_b16 a[102:103], v61 offset:20736
    ds_read_b64_tr_b16 a[104:105], v61 offset:24576
    ds_read_b64_tr_b16 a[106:107], v61 offset:24832
    ds_read_b64_tr_b16 a[108:109], v61 offset:28672
    ds_read_b64_tr_b16 a[110:111], v61 offset:28928
    ds_read_b64_tr_b16 a[112:113], v61 offset:32768
    ds_read_b64_tr_b16 a[114:115], v61 offset:33024
    ds_read_b64_tr_b16 a[116:117], v61 offset:36864
    ds_read_b64_tr_b16 a[118:119], v61 offset:37120
    s_mul_i32 s27, s3, 10240
    s_add_u32 s28, s27, 16777216
    s_mov_b32 s29, 0
    s_mov_b32 s21, 0
    s_mov_b32 s32, 0
    s_mov_b32 s31, 0
    s_waitcnt vmcnt(4)
    s_branch SH_c
SH_l:
    buffer_load_dword v68, v67, s[8:11], s23 offen sc1
    s_waitcnt vmcnt(0)
SH_c:
    v_cmp_gt_u32 vcc, 1, v68
    s_cbranch_vccz SH_o
    s_sleep 4
    s_add_u32 s31, s31, 1
    s_cmp_lt_u32 s31, s30
    s_cbranch_scc1 SH_l
    s_mov_b32 s30, 1
SH_o:
    s_waitcnt lgkmcnt(0)
    s_barrier
    v_and_b32 v16, 7, v1
    v_lshlrev_b32 v16, 5, v16
    buffer_load_dwordx4 v[20:23], v16, s[84:87], 0 offen sc1
    s_add_u32 s35, s28, 0
    s_add_u32 m0, s27, 0
    s_nop 0
    buffer_load_dwordx4 v2, s[8:11], s35 offen offset:0 sc1 lds
    buffer_load_dwordx4 v2, s[8:11], s35 offen offset:1024 sc1 lds
    buffer_load_dwordx4 v2, s[8:11], s35 offen offset:2048 sc1 lds
    buffer_load_dwordx4 v2, s[8:11], s35 offen offset:3072 sc1 lds
    s_add_u32 s35, s28, 4096
    s_add_u32 m0, s27, 4096
    s_nop 0
    buffer_load_dwordx4 v2, s[8:11], s35 offen offset:0 sc1 lds
    buffer_load_dwordx4 v2, s[8:11], s35 offen offset:1024 sc1 lds
    buffer_load_dwordx4 v2, s[8:11], s35 offen offset:2048 sc1 lds
    buffer_load_dwordx4 v2, s[8:11], s35 offen offset:3072 sc1 lds
    s_add_u32 s35, s28, 8192
    s_add_u32 m0, s27, 8192
    s_nop 0
    buffer_load_dwordx4 v2, s[8:11], s35 offen offset:0 sc1 lds
    buffer_load_dwordx4 v2, s[8:11], s35 offen offset:1024 sc1 lds
    s_waitcnt vmcnt(11)
    s_barrier
    ds_read_b64_tr_b16 a[40:41], v60 offset:40960
    ds_read_b64_tr_b16 a[42:43], v60 offset:41216
    ds_read_b64_tr_b16 a[44:45], v60 offset:45056
    ds_read_b64_tr_b16 a[46:47], v60 offset:45312
    ds_read_b64_tr_b16 a[48:49], v60 offset:49152
    ds_read_b64_tr_b16 a[50:51], v60 offset:49408
    ds_read_b64_tr_b16 a[52:53], v60 offset:53248
    ds_read_b64_tr_b16 a[54:55], v60 offset:53504
    ds_read_b64_tr_b16 a[56:57], v60 offset:57344
    ds_read_b64_tr_b16 a[58:59], v60 offset:57600
    ds_read_b64_tr_b16 a[60:61], v60 offset:61440
    ds_read_b64_tr_b16 a[62:63], v60 offset:61696
    v_add_u32 v60, 65536, v60
    ds_read_b64_tr_b16 a[64:65], v60 offset:0
    ds_read_b64_tr_b16 a[66:67], v60 offset:256
    ds_read_b64_tr_b16 a[68:69], v60 offset:4096
    ds_read_b64_tr_b16 a[70:71], v60 offset:4352
    ds_read_b64_tr_b16 a[72:73], v60 offset:8192
    ds_read_b64_tr_b16 a[74:75], v60 offset:8448
    ds_read_b64_tr_b16 a[76:77], v60 offset:12288
    ds_read_b64_tr_b16 a[78:79], v60 offset:12544
    ds_read_b64_tr_b16 a[120:121], v61 offset:40960
    ds_read_b64_tr_b16 a[122:123], v61 offset:41216
    ds_read_b64_tr_b16 a[124:125], v61 offset:45056
    ds_read_b64_tr_b16 a[126:127], v61 offset:45312
    ds_read_b64_tr_b16 a[128:129], v61 offset:49152
    ds_read_b64_tr_b16 a[130:131], v61 offset:49408
    ds_read_b64_tr_b16 a[132:133], v61 offset:53248
    ds_read_b64_tr_b16 a[134:135], v61 offset:53504
    ds_read_b64_tr_b16 a[136:137], v61 offset:57344
    ds_read_b64_tr_b16 a[138:139], v61 offset:57600
    ds_read_b64_tr_b16 a[140:141], v61 offset:61440
    ds_read_b64_tr_b16 a[142:143], v61 offset:61696
    v_add_u32 v61, 65536, v61
    ds_read_b64_tr_b16 a[144:145], v61 offset:0
    ds_read_b64_tr_b16 a[146:147], v61 offset:256
    ds_read_b64_tr_b16 a[148:149], v61 offset:4096
    ds_read_b64_tr_b16 a[150:151], v61 offset:4352
    ds_read_b64_tr_b16 a[152:153], v61 offset:8192
    ds_read_b64_tr_b16 a[154:155], v61 offset:8448
    ds_read_b64_tr_b16 a[156:157], v61 offset:12288
    ds_read_b64_tr_b16 a[158:159], v61 offset:12544
    s_mov_b32 s31, 0
    s_waitcnt vmcnt(10)
    s_branch SJ_c
SJ_l:
    buffer_load_dwordx4 v[20:23], v16, s[84:87], 0 offen sc1
    s_waitcnt vmcnt(0)
SJ_c:
    v_bcnt_u32_b32 v17, v20, v23
    v_cmp_lt_u32 s[4:5], 32, v17
    s_and_b32 s6, s4, 0xff
    v_cmp_ne_u32 s[4:5], 32, v17
    s_cmp_eq_u32 s6, 0
    s_cselect_b32 s5, 0xff, 0
    s_and_b32 s4, s4, s5
    v_add_u32 v21, v21, v22
    v_cmp_gt_u32 vcc, 32, v21
    s_and_b32 vcc_lo, vcc_lo, 0xff
    s_or_b32 vcc_lo, vcc_lo, s4
    s_mov_b32 vcc_hi, 0
    s_cbranch_vccz SJ_o
    s_sleep 16
    s_add_u32 s31, s31, 1
    s_cmp_lt_u32 s31, s30
    s_cbranch_scc1 SJ_l
    s_mov_b32 s30, 1
SJ_o:
    s_mov_b32 s97, s6
    v_min_u32 v67, 39, v1
    v_lshlrev_b32 v67, 7, v67
    v_min_u32 v70, 3968, v67
    s_mov_b32 s49, 65536
    s_mov_b32 s23, 69632
    s_mov_b32 s47, 74752
    s_waitcnt lgkmcnt(0)
    s_barrier
    s_add_u32 s28, s28, 40960
    s_cmp_lg_u32 s97, 0
    s_cbranch_scc1 Ss_go
Sf_go:
    s_waitcnt vmcnt(0)
    s_barrier
    v_add_u32 v11, s29, v2
    s_xor_b32 s29, s29, 40960
    s_add_u32 s42, s29, s27
    ds_read_b128 a[160:163], v11 offset:0
    ds_read_b128 a[164:167], v11 offset:20480
    ds_read_b128 a[168:171], v11 offset:1024
    ds_read_b128 a[172:175], v11 offset:21504
    ds_read_b128 a[176:179], v11 offset:2048
    ds_read_b128 a[180:183], v11 offset:22528
    s_waitcnt lgkmcnt(5)
    v_mfma_f32_16x16x32_bf16 v[144:147], a[0:3], a[160:163], 0
    ds_read_b128 a[184:187], v11 offset:3072
    v_mfma_f32_16x16x32_bf16 v[152:155], a[80:83], a[160:163], 0
    s_waitcnt lgkmcnt(5)
    v_mfma_f32_16x16x32_bf16 v[148:151], a[0:3], a[164:167], 0
    ds_read_b128 a[188:191], v11 offset:23552
    v_mfma_f32_16x16x32_bf16 v[156:159], a[80:83], a[164:167], 0
    s_waitcnt lgkmcnt(5)
    v_mfma_f32_16x16x32_bf16 v[144:147], a[4:7], a[168:171], v[144:147]
    ds_read_b128 a[160:163], v11 offset:4096
    s_add_u32 s35, s28, 0
    s_add_u32 m0, s42, 0
    v_mfma_f32_16x16x32_bf16 v[152:155], a[84:87], a[168:171], v[152:155]
    buffer_load_dwordx4 v2, s[8:11], s35 offen offset:0 sc1 lds
    s_waitcnt lgkmcnt(5)
    v_mfma_f32_16x16x32_bf16 v[148:151], a[4:7], a[172:175], v[148:151]
    ds_read_b128 a[164:167], v11 offset:24576
    v_mfma_f32_16x16x32_bf16 v[156:159], a[84:87], a[172:175], v[156:159]
    s_waitcnt lgkmcnt(5)
    v_mfma_f32_16x16x32_bf16 v[144:147], a[8:11], a[176:179], v[144:147]
    ds_read_b128 a[168:171], v11 offset:5120
    v_mfma_f32_16x16x32_bf16 v[152:155], a[88:91], a[176:179], v[152:155]
    s_waitcnt lgkmcnt(5)
    v_mfma_f32_16x16x32_bf16 v[148:151], a[8:11], a[180:183], v[148:151]
    ds_read_b128 a[172:175], v11 offset:25600
    v_mfma_f32_16x16x32_bf16 v[156:159], a[88:91], a[180:183], v[156:159]
    buffer_load_dwordx4 v2, s[8:11], s35 offen offset:1024 sc1 lds
    s_waitcnt lgkmcnt(5)
    v_mfma_f32_16x16x32_bf16 v[144:147], a[12:15], a[184:187], v[144:147]
    ds_read_b128 a[176:179], v11 offset:6144
    v_mfma_f32_16x16x32_bf16 v[152:155], a[92:95], a[184:187], v[152:155]
    s_waitcnt lgkmcnt(5)
    v_mfma_f32_16x16x32_bf16 v[148:151], a[12:15], a[188:191], v[148:151]
    ds_read_b128 a[180:183], v11 offset:26624
    v_mfma_f32_16x16x32_bf16 v[156:159], a[92:95], a[188:191], v[156:159]
    s_waitcnt lgkmcnt(5)
    v_mfma_f32_16x16x32_bf16 v[144:147], a[16:19], a[160:163], v[144:147]
    ds_read_b128 a[184:187], v11 offset:7168
    v_mfma_f32_16x16x32_bf16 v[152:155], a[96:99], a[160:163], v[152:155]
    buffer_load_dwordx4 v2, s[8:11], s35 offen offset:2048 sc1 lds
    s_waitcnt lgkmcnt(5)
    v_mfma_f32_16x16x32_bf16 v[148:151], a[16:19], a[164:167], v[148:151]
    ds_read_b128 a[188:191], v11 offset:27648
    v_mfma_f32_16x16x32_bf16 v[156:159], a[96:99], a[164:167], v[156:159]
    s_waitcnt lgkmcnt(5)
    v_mfma_f32_16x16x32_bf16 v[144:147], a[20:23], a[168:171], v[144:147]
    ds_read_b128 a[160:163], v11 offset:8192
    v_mfma_f32_16x16x32_bf16 v[152:155], a[100:103], a[168:171], v[152:155]
    s_waitcnt lgkmcnt(5)
    v_mfma_f32_16x16x32_bf16 v[148:151], a[20:23], a[172:175], v[148:151]
    ds_read_b128 a[164:167], v11 offset:28672
    v_mfma_f32_16x16x32_bf16 v[156:159], a[100:103], a[172:175], v[156:159]
    buffer_load_dwordx4 v2, s[8:11], s35 offen offset:3072 sc1 lds
    s_waitcnt lgkmcnt(5)
    v_mfma_f32_16x16x32_bf16 v[144:147], a[24:27], a[176:179], v[144:147]
    ds_read_b128 a[168:171], v11 offset:9216
    v_mfma_f32_16x16x32_bf16 v[152:155], a[104:107], a[176:179], v[152:155]
    s_waitcnt lgkmcnt(5)
    v_mfma_f32_16x16x32_bf16 v[148:151], a[24:27], a[180:183], v[148:151]
    ds_read_b128 a[172:175], v11 offset:29696
    v_mfma_f32_16x16x32_bf16 v[156:159], a[104:107], a[180:183], v[156:159]
    s_waitcnt lgkmcnt(5)
    v_mfma_f32_16x16x32_bf16 v[144:147], a[28:31], a[184:187], v[144:147]
    ds_read_b128 a[176:179], v11 offset:10240
    s_add_u32 s35, s28, 4096
    s_add_u32 m0, s42, 4096
    v_mfma_f32_16x16x32_bf16 v[152:155], a[108:111], a[184:187], v[152:155]
    buffer_load_dwordx4 v2, s[8:11], s35 offen offset:0 sc1 lds
    s_waitcnt lgkmcnt(5)
    v_mfma_f32_16x16x32_bf16 v[148:151], a[28:31], a[188:191], v[148:151]
    ds_read_b128 a[180:183], v11 offset:30720
    v_mfma_f32_16x16x32_bf16 v[156:159], a[108:111], a[188:191], v[156:159]
    s_waitcnt lgkmcnt(5)
    v_mfma_f32_16x16x32_bf16 v[144:147], a[32:35], a[160:163], v[144:147]
    ds_read_b128 a[184:187], v11 offset:11264
    v_mfma_f32_16x16x32_bf16 v[152:155], a[112:115], a[160:163], v[152:155]
    s_waitcnt lgkmcnt(5)
    v_mfma_f32_16x16x32_bf16 v[148:151], a[32:35], a[164:167], v[148:151]
    ds_read_b128 a[188:191], v11 offset:31744
    v_mfma_f32_16x16x32_bf16 v[156:159], a[112:115], a[164:167], v[156:159]
    buffer_load_dwordx4 v2, s[8:11], s35 offen offset:1024 sc1 lds
    s_waitcnt lgkmcnt(5)
    v_mfma_f32_16x16x32_bf16 v[144:147], a[36:39], a[168:171], v[144:147]
    ds_read_b128 a[160:163], v11 offset:12288
    v_mfma_f32_16x16x32_bf16 v[152:155], a[116:119], a[168:171], v[152:155]
    s_waitcnt lgkmcnt(5)
    v_mfma_f32_16x16x32_bf16 v[148:151], a[36:39], a[172:175], v[148:151]
    ds_read_b128 a[164:167], v11 offset:32768
    v_mfma_f32_16x16x32_bf16 v[156:159], a[116:119], a[172:175], v[156:159]
    s_waitcnt lgkmcnt(5)
    v_mfma_f32_16x16x32_bf16 v[144:147], a[40:43], a[176:179], v[144:147]
    ds_read_b128 a[168:171], v11 offset:13312
    v_mfma_f32_16x16x32_bf16 v[152:155], a[120:123], a[176:179], v[152:155]
    buffer_load_dwordx4 v2, s[8:11], s35 offen offset:2048 sc1 lds
    s_waitcnt lgkmcnt(5)
    v_mfma_f32_16x16x32_bf16 v[148:151], a[40:43], a[180:183], v[148:151]
    ds_read_b128 a[172:175], v11 offset:33792
    v_mfma_f32_16x16x32_bf16 v[156:159], a[120:123], a[180:183], v[156:159]
    s_waitcnt lgkmcnt(5)
    v_mfma_f32_16x16x32_bf16 v[144:147], a[44:47], a[184:187], v[144:147]
    ds_read_b128 a[176:179], v11 offset:14336
    v_mfma_f32_16x16x32_bf16 v[152:155], a[124:127], a[184:187], v[152:155]
    s_waitcnt lgkmcnt(5)
    v_mfma_f32_16x16x32_bf16 v[148:151], a[44:47], a[188:191], v[148:151]
    ds_read_b128 a[180:183], v11 offset:34816
    v_mfma_f32_16x16x32_bf16 v[156:159], a[124:127], a[188:191], v[156:159]
    buffer_load_dwordx4 v2, s[8:11], s35 offen offset:3072 sc1 lds
    s_waitcnt lgkmcnt(5)
    v_mfma_f32_16x16x32_bf16 v[144:147], a[48:51], a[160:163], v[144:147]
    ds_read_b128 a[184:187], v11 offset:15360
    v_mfma_f32_16x16x32_bf16 v[152:155], a[128:131], a[160:163], v[152:155]
    s_waitcnt lgkmcnt(5)
    v_mfma_f32_16x16x32_bf16 v[148:151], a[48:51], a[164:167], v[148:151]
    ds_read_b128 a[188:191], v11 offset:35840
    v_mfma_f32_16x16x32_bf16 v[156:159], a[128:131], a[164:167], v[156:159]
    s_waitcnt lgkmcnt(5)
    v_mfma_f32_16x16x32_bf16 v[144:147], a[52:55], a[168:171], v[144:147]
    ds_read_b128 a[160:163], v11 offset:16384
    s_add_u32 s35, s28, 8192
    s_add_u32 m0, s42, 8192
    v_mfma_f32_16x16x32_bf16 v[152:155], a[132:135], a[168:171], v[152:155]
    buffer_load_dwordx4 v2, s[8:11], s35 offen offset:0 sc1 lds
    s_waitcnt lgkmcnt(5)
    v_mfma_f32_16x16x32_bf16 v[148:151], a[52:55], a[172:175], v[148:151]
    ds_read_b128 a[164:167], v11 offset:36864
    v_mfma_f32_16x16x32_bf16 v[156:159], a[132:135], a[172:175], v[156:159]
    s_waitcnt lgkmcnt(5)
    v_mfma_f32_16x16x32_bf16 v[144:147], a[56:59], a[176:179], v[144:147]
    ds_read_b128 a[168:171], v11 offset:17408
    v_mfma_f32_16x16x32_bf16 v[152:155], a[136:139], a[176:179], v[152:155]
    s_waitcnt lgkmcnt(5)
    v_mfma_f32_16x16x32_bf16 v[148:151], a[56:59], a[180:183], v[148:151]
    ds_read_b128 a[172:175], v11 offset:37888
    v_mfma_f32_16x16x32_bf16 v[156:159], a[136:139], a[180:183], v[156:159]
    buffer_load_dwordx4 v2, s[8:11], s35 offen offset:1024 sc1 lds
    s_waitcnt lgkmcnt(5)
    v_mfma_f32_16x16x32_bf16 v[144:147], a[60:63], a[184:187], v[144:147]
    ds_read_b128 a[176:179], v11 offset:18432
    v_mfma_f32_16x16x32_bf16 v[152:155], a[140:143], a[184:187], v[152:155]
    s_waitcnt lgkmcnt(5)
    v_mfma_f32_16x16x32_bf16 v[148:151], a[60:63], a[188:191], v[148:151]
    ds_read_b128 a[180:183], v11 offset:38912
    v_mfma_f32_16x16x32_bf16 v[156:159], a[140:143], a[188:191], v[156:159]
    s_waitcnt lgkmcnt(5)
    v_mfma_f32_16x16x32_bf16 v[144:147], a[64:67], a[160:163], v[144:147]
    ds_read_b128 a[184:187], v11 offset:19456
    v_mfma_f32_16x16x32_bf16 v[152:155], a[144:147], a[160:163], v[152:155]
    s_waitcnt lgkmcnt(5)
    v_mfma_f32_16x16x32_bf16 v[148:151], a[64:67], a[164:167], v[148:151]
    ds_read_b128 a[188:191], v11 offset:39936
    v_mfma_f32_16x16x32_bf16 v[156:159], a[144:147], a[164:167], v[156:159]
    s_waitcnt lgkmcnt(5)
    v_mfma_f32_16x16x32_bf16 v[144:147], a[68:71], a[168:171], v[144:147]
    v_mfma_f32_16x16x32_bf16 v[152:155], a[148:151], a[168:171], v[152:155]
    s_waitcnt lgkmcnt(4)
    v_mfma_f32_16x16x32_bf16 v[148:151], a[68:71], a[172:175], v[148:151]
    v_mfma_f32_16x16x32_bf16 v[156:159], a[148:151], a[172:175], v[156:159]
    s_waitcnt lgkmcnt(3)
    v_mfma_f32_16x16x32_bf16 v[144:147], a[72:75], a[176:179], v[144:147]
    v_mfma_f32_16x16x32_bf16 v[152:155], a[152:155], a[176:179], v[152:155]
    s_waitcnt lgkmcnt(2)
    v_mfma_f32_16x16x32_bf16 v[148:151], a[72:75], a[180:183], v[148:151]
    v_mfma_f32_16x16x32_bf16 v[156:159], a[152:155], a[180:183], v[156:159]
    s_waitcnt lgkmcnt(1)
    v_mfma_f32_16x16x32_bf16 v[144:147], a[76:79], a[184:187], v[144:147]
    v_mfma_f32_16x16x32_bf16 v[152:155], a[156:159], a[184:187], v[152:155]
    s_waitcnt lgkmcnt(0)
    v_mfma_f32_16x16x32_bf16 v[148:151], a[76:79], a[188:191], v[148:151]
    v_mfma_f32_16x16x32_bf16 v[156:159], a[156:159], a[188:191], v[156:159]
    s_add_u32 s28, s28, 40960
    s_add_u32 s32, s32, 1
    s_mov_b32 s31, 0
SfB0_l:
    buffer_load_dword v68, v70, s[8:11], s49 offen sc1
    s_waitcnt vmcnt(0)
SfB0_c:
    v_cmp_gt_u32 vcc, 1, v68
    s_cbranch_vccz SfB0_o
    s_sleep 2
    s_add_u32 s31, s31, 1
    s_cmp_lt_u32 s31, s30
    s_cbranch_scc1 SfB0_l
    s_mov_b32 s30, 1
SfB0_o:
    v_cvt_pk_bf16_f32 v160, v144, v145
    v_cvt_pk_bf16_f32 v161, v146, v147
    ds_write_b64 v12, v[160:161] offset:0
    v_cvt_pk_bf16_f32 v162, v148, v149
    v_cvt_pk_bf16_f32 v163, v150, v151
    ds_write_b64 v12, v[162:163] offset:2048
    v_cvt_pk_bf16_f32 v164, v152, v153
    v_cvt_pk_bf16_f32 v165, v154, v155
    ds_write_b64 v12, v[164:165] offset:4096
    v_cvt_pk_bf16_f32 v166, v156, v157
    v_cvt_pk_bf16_f32 v167, v158, v159
    ds_write_b64 v12, v[166:167] offset:6144
    s_and_b32 s4, s21, 3
    s_lshl_b32 s4, s4, 16
    s_add_u32 s34, s36, s4
    s_waitcnt lgkmcnt(0)
    s_barrier
    ds_read_b128 v[96:99], v15 offset:0
    ds_read_b128 v[104:107], v62 offset:0
    ds_read_b128 v[100:103], v15 offset:1024
    ds_read_b128 v[108:111], v62 offset:1024
    s_waitcnt lgkmcnt(2)
    v_mfma_f32_16x16x32_bf16 v[128:131], v[96:99], v[104:107], 0
    s_waitcnt lgkmcnt(0)
    v_mfma_f32_16x16x32_bf16 v[128:131], v[100:103], v[108:111], v[128:131]
    s_nop 7
    buffer_store_dwordx4 v[128:131], v63, s[8:11], s34 offen offset:0
Sf_loop:
    s_and_b32 s4, s21, 3
    s_mul_i32 s5, s4, 10240
    s_add_u32 s5, s5, s22
    s_sub_u32 s38, s5, 73728
    s_sub_u32 s39, s5, 81920
    s_mul_i32 s5, s4, 16384
    s_add_u32 s25, s24, s5
    s_xor_b32 s4, s4, 2
    s_mul_i32 s5, s4, 163840
    s_mul_i32 s5, s4, 16384
    s_add_u32 s26, s24, s5
    s_add_u32 s21, s21, 1
    v_mov_b32 v72, 0
    v_mov_b32 v73, 0
    v_mov_b32 v74, 0
    v_mov_b32 v75, 0
    v_mov_b32 v76, 0
    v_mov_b32 v77, 0
    v_mov_b32 v78, 0
    v_mov_b32 v79, 0
    v_mov_b32 v59, s21
    s_cmp_eq_u32 s3, 1
    s_cbranch_scc1 Sf_q1
    s_cmp_eq_u32 s3, 2
    s_cbranch_scc1 Sf_q2
    s_cmp_eq_u32 s3, 3
    s_cbranch_scc1 Sf_q3
Sf_q0:
    buffer_load_dwordx4 v[16:19], v3, s[8:11], s38 offen offset:0 sc1
    buffer_load_dwordx4 v[20:23], v3, s[8:11], s38 offen offset:1024 sc1
    buffer_load_dwordx2 v[56:57], v4, s[8:11], s39 offen offset:0 sc1
    s_mov_b32 s31, -1
Sf0m_l:
    buffer_load_dwordx4 v[16:19], v3, s[8:11], s38 offen offset:0 sc1
    buffer_load_dwordx4 v[20:23], v3, s[8:11], s38 offen offset:1024 sc1
    buffer_load_dwordx2 v[56:57], v4, s[8:11], s39 offen offset:0 sc1
    s_add_u32 s31, s31, 1
    s_cmp_lt_u32 s31, s30
    s_cselect_b32 s30, s30, 1
    s_cbranch_scc0 Sf0m_o
    s_waitcnt vmcnt(3)
    v_max3_u32 v58, v16, v17, v18
    v_max3_u32 v58, v58, v19, v20
    v_max3_u32 v58, v58, v21, v22
    v_max3_u32 v58, v58, v23, v56
    v_max_u32 v58, v58, v57
    v_cmp_eq_u32 vcc, -1, v58
    s_cbranch_vccnz Sf0m_l
Sf0m_o:
    ds_write_b128 v3, v[16:19] offset:8192
    ds_write_b128 v3, v[20:23] offset:9216
    ds_write_b64 v4, v[56:57]
    v_smfmac_f32_16x16x64_bf16 v[72:75], v[16:19], a[0:7], v5
    v_smfmac_f32_16x16x64_bf16 v[76:79], v[16:19], a[80:87], v5
    s_waitcnt lgkmcnt(0)
    s_barrier
    ds_read_b128 v[24:27], v3 offset:10240
    ds_read_b128 v[28:31], v3 offset:11264
    ds_read_b128 v[32:35], v3 offset:12288
    v_smfmac_f32_16x16x64_bf16 v[72:75], v[20:23], a[8:15], v5
    ds_read_b128 v[36:39], v3 offset:13312
    ds_read_b128 v[40:43], v3 offset:14336
    v_smfmac_f32_16x16x64_bf16 v[76:79], v[20:23], a[88:95], v5
    ds_read_b128 v[44:47], v3 offset:15360
    ds_read_b128 v[48:51], v3 offset:16384
    ds_read_b128 v[52:55], v3 offset:17408
    s_waitcnt lgkmcnt(7)
    v_smfmac_f32_16x16x64_bf16 v[72:75], v[24:27], a[16:23], v5
    v_smfmac_f32_16x16x64_bf16 v[76:79], v[24:27], a[96:103], v5
    s_waitcnt lgkmcnt(6)
    v_smfmac_f32_16x16x64_bf16 v[72:75], v[28:31], a[24:31], v5
    v_smfmac_f32_16x16x64_bf16 v[76:79], v[28:31], a[104:111], v5
    s_waitcnt lgkmcnt(5)
    v_smfmac_f32_16x16x64_bf16 v[72:75], v[32:35], a[32:39], v5
    v_smfmac_f32_16x16x64_bf16 v[76:79], v[32:35], a[112:119], v5
    s_waitcnt lgkmcnt(4)
    v_smfmac_f32_16x16x64_bf16 v[72:75], v[36:39], a[40:47], v5
    v_smfmac_f32_16x16x64_bf16 v[76:79], v[36:39], a[120:127], v5
    s_waitcnt lgkmcnt(3)
    v_smfmac_f32_16x16x64_bf16 v[72:75], v[40:43], a[48:55], v5
    v_smfmac_f32_16x16x64_bf16 v[76:79], v[40:43], a[128:135], v5
    s_waitcnt lgkmcnt(2)
    v_smfmac_f32_16x16x64_bf16 v[72:75], v[44:47], a[56:63], v5
    v_smfmac_f32_16x16x64_bf16 v[76:79], v[44:47], a[136:143], v5
    s_waitcnt lgkmcnt(1)
    v_smfmac_f32_16x16x64_bf16 v[72:75], v[48:51], a[64:71], v5
    v_smfmac_f32_16x16x64_bf16 v[76:79], v[48:51], a[144:151], v5
    s_waitcnt lgkmcnt(0)
    v_smfmac_f32_16x16x64_bf16 v[72:75], v[52:55], a[72:79], v5
    v_smfmac_f32_16x16x64_bf16 v[76:79], v[52:55], a[152:159], v5
    s_nop 7
    v_permlane32_swap_b32 v72, v76
    v_permlane32_swap_b32 v73, v77
    v_permlane32_swap_b32 v74, v78
    v_permlane32_swap_b32 v75, v79
    v_pk_add_f32 v[72:73], v[72:73], v[76:77]
    v_pk_add_f32 v[74:75], v[74:75], v[78:79]
    v_cvt_pk_bf16_f32 v94, v72, v73
    v_cvt_pk_bf16_f32 v95, v74, v75
    ds_write_b64 v7, v[94:95]
    s_waitcnt lgkmcnt(0)
    s_barrier
    ds_read_b64_tr_b16 v[120:121], v8 offset:0
    ds_read_b64_tr_b16 v[122:123], v8 offset:640
    ds_read_b64_tr_b16 v[124:125], v8 offset:1280
    ds_read_b64_tr_b16 v[126:127], v8 offset:1920
    s_waitcnt lgkmcnt(2)
    v_mfma_f32_16x16x32_bf16 v[128:131], v[96:99], v[120:123], 0
    s_waitcnt lgkmcnt(0)
    v_mfma_f32_16x16x32_bf16 v[128:131], v[100:103], v[124:127], v[128:131]
    s_nop 7
    buffer_store_dwordx4 v[128:131], v64, s[8:11], s25 offen offset:0
    s_branch Sf_qj
Sf_q1:
    buffer_load_dwordx4 v[16:19], v3, s[8:11], s38 offen offset:0 sc1
    buffer_load_dwordx4 v[20:23], v3, s[8:11], s38 offen offset:1024 sc1
    buffer_load_dwordx2 v[56:57], v4, s[8:11], s39 offen offset:0 sc1
    s_mov_b32 s31, -1
Sf1m_l:
    buffer_load_dwordx4 v[16:19], v3, s[8:11], s38 offen offset:0 sc1
    buffer_load_dwordx4 v[20:23], v3, s[8:11], s38 offen offset:1024 sc1
    buffer_load_dwordx2 v[56:57], v4, s[8:11], s39 offen offset:0 sc1
    s_add_u32 s31, s31, 1
    s_cmp_lt_u32 s31, s30
    s_cselect_b32 s30, s30, 1
    s_cbranch_scc0 Sf1m_o
    s_waitcnt vmcnt(3)
    v_max3_u32 v58, v16, v17, v18
    v_max3_u32 v58, v58, v19, v20
    v_max3_u32 v58, v58, v21, v22
    v_max3_u32 v58, v58, v23, v56
    v_max_u32 v58, v58, v57
    v_cmp_eq_u32 vcc, -1, v58
    s_cbranch_vccnz Sf1m_l
Sf1m_o:
    ds_write_b128 v3, v[16:19] offset:8192
    ds_write_b128 v3, v[20:23] offset:9216
    ds_write_b64 v4, v[56:57]
    v_smfmac_f32_16x16x64_bf16 v[72:75], v[16:19], a[16:23], v5
    v_smfmac_f32_16x16x64_bf16 v[76:79], v[16:19], a[96:103], v5
    s_waitcnt lgkmcnt(0)
    s_barrier
    ds_read_b128 v[24:27], v3 offset:10240
    ds_read_b128 v[28:31], v3 offset:11264
    ds_read_b128 v[32:35], v3 offset:12288
    v_smfmac_f32_16x16x64_bf16 v[72:75], v[20:23], a[24:31], v5
    ds_read_b128 v[36:39], v3 offset:13312
    ds_read_b128 v[40:43], v3 offset:6144
    v_smfmac_f32_16x16x64_bf16 v[76:79], v[20:23], a[104:111], v5
    ds_read_b128 v[44:47], v3 offset:7168
    ds_read_b128 v[48:51], v3 offset:14336
    ds_read_b128 v[52:55], v3 offset:15360
    s_waitcnt lgkmcnt(7)
    v_smfmac_f32_16x16x64_bf16 v[72:75], v[24:27], a[32:39], v5
    v_smfmac_f32_16x16x64_bf16 v[76:79], v[24:27], a[112:119], v5
    s_waitcnt lgkmcnt(6)
    v_smfmac_f32_16x16x64_bf16 v[72:75], v[28:31], a[40:47], v5
    v_smfmac_f32_16x16x64_bf16 v[76:79], v[28:31], a[120:127], v5
    s_waitcnt lgkmcnt(5)
    v_smfmac_f32_16x16x64_bf16 v[72:75], v[32:35], a[48:55], v5
    v_smfmac_f32_16x16x64_bf16 v[76:79], v[32:35], a[128:135], v5
    s_waitcnt lgkmcnt(4)
    v_smfmac_f32_16x16x64_bf16 v[72:75], v[36:39], a[56:63], v5
    v_smfmac_f32_16x16x64_bf16 v[76:79], v[36:39], a[136:143], v5
    s_waitcnt lgkmcnt(3)
    v_smfmac_f32_16x16x64_bf16 v[72:75], v[40:43], a[0:7], v5
    v_smfmac_f32_16x16x64_bf16 v[76:79], v[40:43], a[80:87], v5
    s_waitcnt lgkmcnt(2)
    v_smfmac_f32_16x16x64_bf16 v[72:75], v[44:47], a[8:15], v5
    v_smfmac_f32_16x16x64_bf16 v[76:79], v[44:47], a[88:95], v5
    s_waitcnt lgkmcnt(1)
    v_smfmac_f32_16x16x64_bf16 v[72:75], v[48:51], a[64:71], v5
    v_smfmac_f32_16x16x64_bf16 v[76:79], v[48:51], a[144:151], v5
    s_waitcnt lgkmcnt(0)
    v_smfmac_f32_16x16x64_bf16 v[72:75], v[52:55], a[72:79], v5
    v_smfmac_f32_16x16x64_bf16 v[76:79], v[52:55], a[152:159], v5
    s_nop 7
    v_permlane32_swap_b32 v72, v76
    v_permlane32_swap_b32 v73, v77
    v_permlane32_swap_b32 v74, v78
    v_permlane32_swap_b32 v75, v79
    v_pk_add_f32 v[72:73], v[72:73], v[76:77]
    v_pk_add_f32 v[74:75], v[74:75], v[78:79]
    v_cvt_pk_bf16_f32 v94, v72, v73
    v_cvt_pk_bf16_f32 v95, v74, v75
    ds_write_b64 v7, v[94:95]
    s_waitcnt lgkmcnt(0)
    s_barrier
    ds_read_b64_tr_b16 v[120:121], v8 offset:0
    ds_read_b64_tr_b16 v[122:123], v8 offset:640
    ds_read_b64_tr_b16 v[124:125], v8 offset:1280
    ds_read_b64_tr_b16 v[126:127], v8 offset:1920
    s_waitcnt lgkmcnt(2)
    v_mfma_f32_16x16x32_bf16 v[128:131], v[96:99], v[120:123], 0
    s_waitcnt lgkmcnt(0)
    v_mfma_f32_16x16x32_bf16 v[128:131], v[100:103], v[124:127], v[128:131]
    s_nop 7
    buffer_store_dwordx4 v[128:131], v64, s[8:11], s25 offen offset:0
    s_branch Sf_qj
Sf_q2:
    buffer_load_dwordx4 v[16:19], v3, s[8:11], s38 offen offset:0 sc1
    buffer_load_dwordx4 v[20:23], v3, s[8:11], s38 offen offset:1024 sc1
    buffer_load_dwordx2 v[56:57], v4, s[8:11], s39 offen offset:0 sc1
    s_mov_b32 s31, -1
Sf2m_l:
    buffer_load_dwordx4 v[16:19], v3, s[8:11], s38 offen offset:0 sc1
    buffer_load_dwordx4 v[20:23], v3, s[8:11], s38 offen offset:1024 sc1
    buffer_load_dwordx2 v[56:57], v4, s[8:11], s39 offen offset:0 sc1
    s_add_u32 s31, s31, 1
    s_cmp_lt_u32 s31, s30
    s_cselect_b32 s30, s30, 1
    s_cbranch_scc0 Sf2m_o
    s_waitcnt vmcnt(3)
    v_max3_u32 v58, v16, v17, v18
    v_max3_u32 v58, v58, v19, v20
    v_max3_u32 v58, v58, v21, v22
    v_max3_u32 v58, v58, v23, v56
    v_max_u32 v58, v58, v57
    v_cmp_eq_u32 vcc, -1, v58
    s_cbranch_vccnz Sf2m_l
Sf2m_o:
    ds_write_b128 v3, v[16:19] offset:8192
    ds_write_b128 v3, v[20:23] offset:9216
    ds_write_b64 v4, v[56:57]
    v_smfmac_f32_16x16x64_bf16 v[72:75], v[16:19], a[32:39], v5
    v_smfmac_f32_16x16x64_bf16 v[76:79], v[16:19], a[112:119], v5
    s_waitcnt lgkmcnt(0)
    s_barrier
    ds_read_b128 v[24:27], v3 offset:10240
    ds_read_b128 v[28:31], v3 offset:11264
    ds_read_b128 v[32:35], v3 offset:4096
    v_smfmac_f32_16x16x64_bf16 v[72:75], v[20:23], a[40:47], v5
    ds_read_b128 v[36:39], v3 offset:5120
    ds_read_b128 v[40:43], v3 offset:6144
    v_smfmac_f32_16x16x64_bf16 v[76:79], v[20:23], a[120:127], v5
    ds_read_b128 v[44:47], v3 offset:7168
    ds_read_b128 v[48:51], v3 offset:12288
    ds_read_b128 v[52:55], v3 offset:13312
    s_waitcnt lgkmcnt(7)
    v_smfmac_f32_16x16x64_bf16 v[72:75], v[24:27], a[48:55], v5
    v_smfmac_f32_16x16x64_bf16 v[76:79], v[24:27], a[128:135], v5
    s_waitcnt lgkmcnt(6)
    v_smfmac_f32_16x16x64_bf16 v[72:75], v[28:31], a[56:63], v5
    v_smfmac_f32_16x16x64_bf16 v[76:79], v[28:31], a[136:143], v5
    s_waitcnt lgkmcnt(5)
    v_smfmac_f32_16x16x64_bf16 v[72:75], v[32:35], a[0:7], v5
    v_smfmac_f32_16x16x64_bf16 v[76:79], v[32:35], a[80:87], v5
    s_waitcnt lgkmcnt(4)
    v_smfmac_f32_16x16x64_bf16 v[72:75], v[36:39], a[8:15], v5
    v_smfmac_f32_16x16x64_bf16 v[76:79], v[36:39], a[88:95], v5
    s_waitcnt lgkmcnt(3)
    v_smfmac_f32_16x16x64_bf16 v[72:75], v[40:43], a[16:23], v5
    v_smfmac_f32_16x16x64_bf16 v[76:79], v[40:43], a[96:103], v5
    s_waitcnt lgkmcnt(2)
    v_smfmac_f32_16x16x64_bf16 v[72:75], v[44:47], a[24:31], v5
    v_smfmac_f32_16x16x64_bf16 v[76:79], v[44:47], a[104:111], v5
    s_waitcnt lgkmcnt(1)
    v_smfmac_f32_16x16x64_bf16 v[72:75], v[48:51], a[64:71], v5
    v_smfmac_f32_16x16x64_bf16 v[76:79], v[48:51], a[144:151], v5
    s_waitcnt lgkmcnt(0)
    v_smfmac_f32_16x16x64_bf16 v[72:75], v[52:55], a[72:79], v5
    v_smfmac_f32_16x16x64_bf16 v[76:79], v[52:55], a[152:159], v5
    s_nop 7
    v_permlane32_swap_b32 v72, v76
    v_permlane32_swap_b32 v73, v77
    v_permlane32_swap_b32 v74, v78
    v_permlane32_swap_b32 v75, v79
    v_pk_add_f32 v[72:73], v[72:73], v[76:77]
    v_pk_add_f32 v[74:75], v[74:75], v[78:79]
    v_cvt_pk_bf16_f32 v94, v72, v73
    v_cvt_pk_bf16_f32 v95, v74, v75
    ds_write_b64 v7, v[94:95]
    s_waitcnt lgkmcnt(0)
    s_barrier
    ds_read_b64_tr_b16 v[120:121], v8 offset:0
    ds_read_b64_tr_b16 v[112:113], v6 offset:16
    ds_read_b64_tr_b16 v[122:123], v8 offset:640
    ds_read_b64_tr_b16 v[114:115], v6 offset:656
    ds_read_b64_tr_b16 v[124:125], v8 offset:1280
    ds_read_b64_tr_b16 v[116:117], v6 offset:1296
    ds_read_b64_tr_b16 v[126:127], v8 offset:1920
    ds_read_b64_tr_b16 v[118:119], v6 offset:1936
    s_waitcnt lgkmcnt(4)
    v_mfma_f32_16x16x32_bf16 v[128:131], v[112:115], v[120:123], 0
    s_waitcnt lgkmcnt(0)
    v_mfma_f32_16x16x32_bf16 v[128:131], v[116:119], v[124:127], v[128:131]
    s_nop 7
    v_cndmask_b32 v128, v128, v129, s[40:41]
    v_cndmask_b32 v130, v130, v131, s[40:41]
    v_cndmask_b32 v128, v128, v130, s[90:91]
    buffer_store_dword v128, v65, s[8:11], s25 offen offset:0
    s_branch Sf_qj
Sf_q3:
    buffer_load_dwordx4 v[16:19], v3, s[8:11], s38 offen offset:0 sc1
    buffer_load_dwordx4 v[20:23], v3, s[8:11], s38 offen offset:1024 sc1
    buffer_load_dwordx2 v[56:57], v4, s[8:11], s39 offen offset:0 sc1
    s_mov_b32 s31, -1
Sf3m_l:
    buffer_load_dwordx4 v[16:19], v3, s[8:11], s38 offen offset:0 sc1
    buffer_load_dwordx4 v[20:23], v3, s[8:11], s38 offen offset:1024 sc1
    buffer_load_dwordx2 v[56:57], v4, s[8:11], s39 offen offset:0 sc1
    s_add_u32 s31, s31, 1
    s_cmp_lt_u32 s31, s30
    s_cselect_b32 s30, s30, 1
    s_cbranch_scc0 Sf3m_o
    s_waitcnt vmcnt(3)
    v_max3_u32 v58, v16, v17, v18
    v_max3_u32 v58, v58, v19, v20
    v_max3_u32 v58, v58, v21, v22
    v_max3_u32 v58, v58, v23, v56
    v_max_u32 v58, v58, v57
    v_cmp_eq_u32 vcc, -1, v58
    s_cbranch_vccnz Sf3m_l
Sf3m_o:
    ds_write_b128 v3, v[16:19] offset:8192
    ds_write_b128 v3, v[20:23] offset:9216
    ds_write_b64 v4, v[56:57]
    v_smfmac_f32_16x16x64_bf16 v[72:75], v[16:19], a[48:55], v5
    v_smfmac_f32_16x16x64_bf16 v[76:79], v[16:19], a[128:135], v5
    s_waitcnt lgkmcnt(0)
    s_barrier
    ds_read_b128 v[24:27], v3 offset:2048
    ds_read_b128 v[28:31], v3 offset:3072
    ds_read_b128 v[32:35], v3 offset:4096
    v_smfmac_f32_16x16x64_bf16 v[72:75], v[20:23], a[56:63], v5
    ds_read_b128 v[36:39], v3 offset:5120
    ds_read_b128 v[40:43], v3 offset:6144
    v_smfmac_f32_16x16x64_bf16 v[76:79], v[20:23], a[136:143], v5
    ds_read_b128 v[44:47], v3 offset:7168
    ds_read_b128 v[48:51], v3 offset:10240
    ds_read_b128 v[52:55], v3 offset:11264
    s_waitcnt lgkmcnt(7)
    v_smfmac_f32_16x16x64_bf16 v[72:75], v[24:27], a[0:7], v5
    v_smfmac_f32_16x16x64_bf16 v[76:79], v[24:27], a[80:87], v5
    s_waitcnt lgkmcnt(6)
    v_smfmac_f32_16x16x64_bf16 v[72:75], v[28:31], a[8:15], v5
    v_smfmac_f32_16x16x64_bf16 v[76:79], v[28:31], a[88:95], v5
    s_waitcnt lgkmcnt(5)
    v_smfmac_f32_16x16x64_bf16 v[72:75], v[32:35], a[16:23], v5
    v_smfmac_f32_16x16x64_bf16 v[76:79], v[32:35], a[96:103], v5
    s_waitcnt lgkmcnt(4)
    v_smfmac_f32_16x16x64_bf16 v[72:75], v[36:39], a[24:31], v5
    v_smfmac_f32_16x16x64_bf16 v[76:79], v[36:39], a[104:111], v5
    s_waitcnt lgkmcnt(3)
    v_smfmac_f32_16x16x64_bf16 v[72:75], v[40:43], a[32:39], v5
    v_smfmac_f32_16x16x64_bf16 v[76:79], v[40:43], a[112:119], v5
    s_waitcnt lgkmcnt(2)
    v_smfmac_f32_16x16x64_bf16 v[72:75], v[44:47], a[40:47], v5
    v_smfmac_f32_16x16x64_bf16 v[76:79], v[44:47], a[120:127], v5
    s_waitcnt lgkmcnt(1)
    v_smfmac_f32_16x16x64_bf16 v[72:75], v[48:51], a[64:71], v5
    buffer_store_dword v59, v14, s[8:11], s44 offen offset:0
    v_smfmac_f32_16x16x64_bf16 v[76:79], v[48:51], a[144:151], v5
    s_waitcnt lgkmcnt(0)
    v_smfmac_f32_16x16x64_bf16 v[72:75], v[52:55], a[72:79], v5
    v_smfmac_f32_16x16x64_bf16 v[76:79], v[52:55], a[152:159], v5
    s_nop 7
    v_permlane32_swap_b32 v72, v76
    v_permlane32_swap_b32 v73, v77
    v_permlane32_swap_b32 v74, v78
    v_permlane32_swap_b32 v75, v79
    v_pk_add_f32 v[72:73], v[72:73], v[76:77]
    v_pk_add_f32 v[74:75], v[74:75], v[78:79]
    v_cvt_pk_bf16_f32 v94, v72, v73
    v_cvt_pk_bf16_f32 v95, v74, v75
    ds_write_b64 v7, v[94:95]
    s_waitcnt lgkmcnt(0)
    s_barrier
    ds_read_b64_tr_b16 v[112:113], v6 offset:16
    ds_read_b64_tr_b16 v[114:115], v6 offset:656
    ds_read_b64_tr_b16 v[116:117], v6 offset:1296
    ds_read_b64_tr_b16 v[118:119], v6 offset:1936
    s_waitcnt lgkmcnt(2)
    v_mfma_f32_16x16x32_bf16 v[128:131], v[112:115], v[96:99], 0
    v_mfma_f32_16x16x32_bf16 v[132:135], v[112:115], v[104:107], 0
    s_waitcnt lgkmcnt(0)
    v_mfma_f32_16x16x32_bf16 v[128:131], v[116:119], v[100:103], v[128:131]
    v_mfma_f32_16x16x32_bf16 v[132:135], v[116:119], v[108:111], v[132:135]
    s_nop 7
    s_mov_b32 exec_lo, 0
    v_mov_b32 v128, v132
    v_mov_b32 v129, v133
    v_mov_b32 v130, v134
    v_mov_b32 v131, v135
    s_mov_b32 exec_lo, -1
    buffer_store_dwordx4 v[128:131], v2, s[8:11], s34 offen offset:0
Sf_qj:
    s_cmp_lt_u32 s21, 64
    s_cbranch_scc0 Sf_end
    s_cmp_eq_u32 s32, 14
    s_cbranch_scc0 Sf_h
    s_mov_b32 s31, 0
    s_waitcnt vmcnt(63)
    s_branch SfB1_c
SfB1_l:
    buffer_load_dword v68, v67, s[8:11], s23 offen sc1
    s_waitcnt vmcnt(0)
SfB1_c:
    v_cmp_gt_u32 vcc, 1, v68
    s_cbranch_vccz SfB1_o
    s_sleep 4
    s_add_u32 s31, s31, 1
    s_cmp_lt_u32 s31, s30
    s_cbranch_scc1 SfB1_l
    s_mov_b32 s30, 1
SfB1_o:
    s_mov_b32 s31, 0
    s_waitcnt vmcnt(63)
    s_branch SfB2_c
SfB2_l:
    buffer_load_dword v69, v67, s[8:11], s47 offen sc1
    s_waitcnt vmcnt(0)
SfB2_c:
    v_cmp_gt_u32 vcc, 1, v69
    s_cbranch_vccz SfB2_o
    s_sleep 4
    s_add_u32 s31, s31, 1
    s_cmp_lt_u32 s31, s30
    s_cbranch_scc1 SfB2_l
    s_mov_b32 s30, 1
SfB2_o:
Sf_h:
    v_add_u32 v11, s29, v2
    s_xor_b32 s29, s29, 40960
    s_add_u32 s42, s29, s27
    ds_read_b128 a[160:163], v11 offset:0
    ds_read_b128 a[164:167], v11 offset:20480
    ds_read_b128 a[168:171], v11 offset:1024
    ds_read_b128 a[172:175], v11 offset:21504
    ds_read_b128 a[176:179], v11 offset:2048
    ds_read_b128 a[180:183], v11 offset:22528
    s_waitcnt lgkmcnt(5)
    v_mfma_f32_16x16x32_bf16 v[144:147], a[0:3], a[160:163], 0
    ds_read_b128 a[184:187], v11 offset:3072
    v_mfma_f32_16x16x32_bf16 v[152:155], a[80:83], a[160:163], 0
    s_waitcnt lgkmcnt(5)
    v_mfma_f32_16x16x32_bf16 v[148:151], a[0:3], a[164:167], 0
    ds_read_b128 a[188:191], v11 offset:23552
    v_mfma_f32_16x16x32_bf16 v[156:159], a[80:83], a[164:167], 0
    s_waitcnt lgkmcnt(5)
    v_mfma_f32_16x16x32_bf16 v[144:147], a[4:7], a[168:171], v[144:147]
    ds_read_b128 a[160:163], v11 offset:4096
    s_add_u32 s35, s28, 0
    s_add_u32 m0, s42, 0
    v_mfma_f32_16x16x32_bf16 v[152:155], a[84:87], a[168:171], v[152:155]
    buffer_load_dwordx4 v2, s[8:11], s35 offen offset:0 sc1 lds
    s_waitcnt lgkmcnt(5)
    v_mfma_f32_16x16x32_bf16 v[148:151], a[4:7], a[172:175], v[148:151]
    ds_read_b128 a[164:167], v11 offset:24576
    v_mfma_f32_16x16x32_bf16 v[156:159], a[84:87], a[172:175], v[156:159]
    s_waitcnt lgkmcnt(5)
    v_mfma_f32_16x16x32_bf16 v[144:147], a[8:11], a[176:179], v[144:147]
    ds_read_b128 a[168:171], v11 offset:5120
    v_mfma_f32_16x16x32_bf16 v[152:155], a[88:91], a[176:179], v[152:155]
    s_waitcnt lgkmcnt(5)
    v_mfma_f32_16x16x32_bf16 v[148:151], a[8:11], a[180:183], v[148:151]
    ds_read_b128 a[172:175], v11 offset:25600
    v_mfma_f32_16x16x32_bf16 v[156:159], a[88:91], a[180:183], v[156:159]
    buffer_load_dwordx4 v2, s[8:11], s35 offen offset:1024 sc1 lds
    s_waitcnt lgkmcnt(5)
    v_mfma_f32_16x16x32_bf16 v[144:147], a[12:15], a[184:187], v[144:147]
    ds_read_b128 a[176:179], v11 offset:6144
    v_mfma_f32_16x16x32_bf16 v[152:155], a[92:95], a[184:187], v[152:155]
    s_waitcnt lgkmcnt(5)
    v_mfma_f32_16x16x32_bf16 v[148:151], a[12:15], a[188:191], v[148:151]
    ds_read_b128 a[180:183], v11 offset:26624
    v_mfma_f32_16x16x32_bf16 v[156:159], a[92:95], a[188:191], v[156:159]
    s_waitcnt vmcnt(2)
    v_mov_b32 v10, s21
    s_mov_b64 exec, 1
    buffer_store_dword v10, v9, s[8:11], s33 offen
    s_mov_b64 exec, -1
    s_waitcnt lgkmcnt(5)
    v_mfma_f32_16x16x32_bf16 v[144:147], a[16:19], a[160:163], v[144:147]
    ds_read_b128 a[184:187], v11 offset:7168
    v_mfma_f32_16x16x32_bf16 v[152:155], a[96:99], a[160:163], v[152:155]
    buffer_load_dwordx4 v2, s[8:11], s35 offen offset:2048 sc1 lds
    s_waitcnt lgkmcnt(5)
    v_mfma_f32_16x16x32_bf16 v[148:151], a[16:19], a[164:167], v[148:151]
    ds_read_b128 a[188:191], v11 offset:27648
    v_mfma_f32_16x16x32_bf16 v[156:159], a[96:99], a[164:167], v[156:159]
    buffer_store_dwordx4 v[240:243], v64, s[8:11], s26 offen offset:0
    s_waitcnt lgkmcnt(5)
    v_mfma_f32_16x16x32_bf16 v[144:147], a[20:23], a[168:171], v[144:147]
    ds_read_b128 a[160:163], v11 offset:8192
    v_mfma_f32_16x16x32_bf16 v[152:155], a[100:103], a[168:171], v[152:155]
    buffer_store_dword v240, v65, s[8:11], s26 offen offset:0
    s_waitcnt lgkmcnt(5)
    v_mfma_f32_16x16x32_bf16 v[148:151], a[20:23], a[172:175], v[148:151]
    ds_read_b128 a[164:167], v11 offset:28672
    v_mfma_f32_16x16x32_bf16 v[156:159], a[100:103], a[172:175], v[156:159]
    buffer_load_dwordx4 v2, s[8:11], s35 offen offset:3072 sc1 lds
    s_waitcnt lgkmcnt(5)
    v_mfma_f32_16x16x32_bf16 v[144:147], a[24:27], a[176:179], v[144:147]
    ds_read_b128 a[168:171], v11 offset:9216
    v_mfma_f32_16x16x32_bf16 v[152:155], a[104:107], a[176:179], v[152:155]
    s_waitcnt lgkmcnt(5)
    v_mfma_f32_16x16x32_bf16 v[148:151], a[24:27], a[180:183], v[148:151]
    ds_read_b128 a[172:175], v11 offset:29696
    v_mfma_f32_16x16x32_bf16 v[156:159], a[104:107], a[180:183], v[156:159]
    s_waitcnt lgkmcnt(5)
    v_mfma_f32_16x16x32_bf16 v[144:147], a[28:31], a[184:187], v[144:147]
    ds_read_b128 a[176:179], v11 offset:10240
    s_add_u32 s35, s28, 4096
    s_add_u32 m0, s42, 4096
    v_mfma_f32_16x16x32_bf16 v[152:155], a[108:111], a[184:187], v[152:155]
    buffer_load_dwordx4 v2, s[8:11], s35 offen offset:0 sc1 lds
    s_waitcnt lgkmcnt(5)
    v_mfma_f32_16x16x32_bf16 v[148:151], a[28:31], a[188:191], v[148:151]
    ds_read_b128 a[180:183], v11 offset:30720
    v_mfma_f32_16x16x32_bf16 v[156:159], a[108:111], a[188:191], v[156:159]
    s_waitcnt lgkmcnt(5)
    v_mfma_f32_16x16x32_bf16 v[144:147], a[32:35], a[160:163], v[144:147]
    ds_read_b128 a[184:187], v11 offset:11264
    v_mfma_f32_16x16x32_bf16 v[152:155], a[112:115], a[160:163], v[152:155]
    s_waitcnt lgkmcnt(5)
    v_mfma_f32_16x16x32_bf16 v[148:151], a[32:35], a[164:167], v[148:151]
    ds_read_b128 a[188:191], v11 offset:31744
    v_mfma_f32_16x16x32_bf16 v[156:159], a[112:115], a[164:167], v[156:159]
    buffer_load_dwordx4 v2, s[8:11], s35 offen offset:1024 sc1 lds
    s_waitcnt lgkmcnt(5)
    v_mfma_f32_16x16x32_bf16 v[144:147], a[36:39], a[168:171], v[144:147]
    ds_read_b128 a[160:163], v11 offset:12288
    v_mfma_f32_16x16x32_bf16 v[152:155], a[116:119], a[168:171], v[152:155]
    s_sub_u32 s4, s21, 8
    s_cmp_lt_u32 s4, s45
    s_cselect_b64 exec, -1, 0
    s_lshl_b32 s4, s21, 19
    s_add_u32 s4, s4, s46
    buffer_store_dwordx4 v[240:243], v2, s[8:11], s4 offen offset:0 sc1
    s_mov_b64 exec, -1
    s_waitcnt lgkmcnt(5)
    v_mfma_f32_16x16x32_bf16 v[148:151], a[36:39], a[172:175], v[148:151]
    ds_read_b128 a[164:167], v11 offset:32768
    v_mfma_f32_16x16x32_bf16 v[156:159], a[116:119], a[172:175], v[156:159]
    s_cmp_eq_u32 s21, s88
    s_cselect_b64 exec, -1, 0
    buffer_store_dwordx4 v[240:243], v2, s[8:11], s89 offen offset:0 sc1
    s_mov_b64 exec, -1
    s_waitcnt lgkmcnt(5)
    v_mfma_f32_16x16x32_bf16 v[144:147], a[40:43], a[176:179], v[144:147]
    ds_read_b128 a[168:171], v11 offset:13312
    v_mfma_f32_16x16x32_bf16 v[152:155], a[120:123], a[176:179], v[152:155]
    buffer_load_dwordx4 v2, s[8:11], s35 offen offset:2048 sc1 lds
    s_waitcnt lgkmcnt(5)
    v_mfma_f32_16x16x32_bf16 v[148:151], a[40:43], a[180:183], v[148:151]
    ds_read_b128 a[172:175], v11 offset:33792
    v_mfma_f32_16x16x32_bf16 v[156:159], a[120:123], a[180:183], v[156:159]
    s_waitcnt lgkmcnt(5)
    v_mfma_f32_16x16x32_bf16 v[144:147], a[44:47], a[184:187], v[144:147]
    ds_read_b128 a[176:179], v11 offset:14336
    v_mfma_f32_16x16x32_bf16 v[152:155], a[124:127], a[184:187], v[152:155]
    s_waitcnt lgkmcnt(5)
    v_mfma_f32_16x16x32_bf16 v[148:151], a[44:47], a[188:191], v[148:151]
    ds_read_b128 a[180:183], v11 offset:34816
    v_mfma_f32_16x16x32_bf16 v[156:159], a[124:127], a[188:191], v[156:159]
    buffer_load_dwordx4 v2, s[8:11], s35 offen offset:3072 sc1 lds
    s_waitcnt lgkmcnt(5)
    v_mfma_f32_16x16x32_bf16 v[144:147], a[48:51], a[160:163], v[144:147]
    ds_read_b128 a[184:187], v11 offset:15360
    v_mfma_f32_16x16x32_bf16 v[152:155], a[128:131], a[160:163], v[152:155]
    s_waitcnt lgkmcnt(5)
    v_mfma_f32_16x16x32_bf16 v[148:151], a[48:51], a[164:167], v[148:151]
    ds_read_b128 a[188:191], v11 offset:35840
    v_mfma_f32_16x16x32_bf16 v[156:159], a[128:131], a[164:167], v[156:159]
    s_waitcnt lgkmcnt(5)
    v_mfma_f32_16x16x32_bf16 v[144:147], a[52:55], a[168:171], v[144:147]
    ds_read_b128 a[160:163], v11 offset:16384
    s_add_u32 s35, s28, 8192
    s_add_u32 m0, s42, 8192
    v_mfma_f32_16x16x32_bf16 v[152:155], a[132:135], a[168:171], v[152:155]
    buffer_load_dwordx4 v2, s[8:11], s35 offen offset:0 sc1 lds
    s_waitcnt lgkmcnt(5)
    v_mfma_f32_16x16x32_bf16 v[148:151], a[52:55], a[172:175], v[148:151]
    ds_read_b128 a[164:167], v11 offset:36864
    v_mfma_f32_16x16x32_bf16 v[156:159], a[132:135], a[172:175], v[156:159]
    s_waitcnt lgkmcnt(5)
    v_mfma_f32_16x16x32_bf16 v[144:147], a[56:59], a[176:179], v[144:147]
    ds_read_b128 a[168:171], v11 offset:17408
    v_mfma_f32_16x16x32_bf16 v[152:155], a[136:139], a[176:179], v[152:155]
    s_waitcnt lgkmcnt(5)
    v_mfma_f32_16x16x32_bf16 v[148:151], a[56:59], a[180:183], v[148:151]
    ds_read_b128 a[172:175], v11 offset:37888
    v_mfma_f32_16x16x32_bf16 v[156:159], a[136:139], a[180:183], v[156:159]
    buffer_load_dwordx4 v2, s[8:11], s35 offen offset:1024 sc1 lds
    s_waitcnt lgkmcnt(5)
    v_mfma_f32_16x16x32_bf16 v[144:147], a[60:63], a[184:187], v[144:147]
    ds_read_b128 a[176:179], v11 offset:18432
    v_mfma_f32_16x16x32_bf16 v[152:155], a[140:143], a[184:187], v[152:155]
    s_waitcnt lgkmcnt(5)
    v_mfma_f32_16x16x32_bf16 v[148:151], a[60:63], a[188:191], v[148:151]
    ds_read_b128 a[180:183], v11 offset:38912
    v_mfma_f32_16x16x32_bf16 v[156:159], a[140:143], a[188:191], v[156:159]
    s_waitcnt lgkmcnt(5)
    v_mfma_f32_16x16x32_bf16 v[144:147], a[64:67], a[160:163], v[144:147]
    ds_read_b128 a[184:187], v11 offset:19456
    v_mfma_f32_16x16x32_bf16 v[152:155], a[144:147], a[160:163], v[152:155]
    s_waitcnt lgkmcnt(5)
    v_mfma_f32_16x16x32_bf16 v[148:151], a[64:67], a[164:167], v[148:151]
    ds_read_b128 a[188:191], v11 offset:39936
    v_mfma_f32_16x16x32_bf16 v[156:159], a[144:147], a[164:167], v[156:159]
    s_waitcnt lgkmcnt(5)
    v_mfma_f32_16x16x32_bf16 v[144:147], a[68:71], a[168:171], v[144:147]
    v_mfma_f32_16x16x32_bf16 v[152:155], a[148:151], a[168:171], v[152:155]
    s_waitcnt lgkmcnt(4)
    v_mfma_f32_16x16x32_bf16 v[148:151], a[68:71], a[172:175], v[148:151]
    v_mfma_f32_16x16x32_bf16 v[156:159], a[148:151], a[172:175], v[156:159]
    s_waitcnt lgkmcnt(3)
    v_mfma_f32_16x16x32_bf16 v[144:147], a[72:75], a[176:179], v[144:147]
    v_mfma_f32_16x16x32_bf16 v[152:155], a[152:155], a[176:179], v[152:155]
    s_waitcnt lgkmcnt(2)
    v_mfma_f32_16x16x32_bf16 v[148:151], a[72:75], a[180:183], v[148:151]
    v_mfma_f32_16x16x32_bf16 v[156:159], a[152:155], a[180:183], v[156:159]
    s_waitcnt lgkmcnt(1)
    v_mfma_f32_16x16x32_bf16 v[144:147], a[76:79], a[184:187], v[144:147]
    v_mfma_f32_16x16x32_bf16 v[152:155], a[156:159], a[184:187], v[152:155]
    s_waitcnt lgkmcnt(0)
    v_mfma_f32_16x16x32_bf16 v[148:151], a[76:79], a[188:191], v[148:151]
    v_mfma_f32_16x16x32_bf16 v[156:159], a[156:159], a[188:191], v[156:159]
    s_add_u32 s28, s28, 40960
    s_add_u32 s32, s32, 1
    s_cmp_eq_u32 s32, 12
    s_cbranch_scc0 Sf_n12
    buffer_load_dword v68, v67, s[8:11], s23 offen offset:0 sc1
    buffer_load_dword v69, v67, s[8:11], s47 offen offset:0 sc1
Sf_n12:
    v_cvt_pk_bf16_f32 v160, v144, v145
    v_cvt_pk_bf16_f32 v161, v146, v147
    ds_write_b64 v12, v[160:161] offset:0
    v_cvt_pk_bf16_f32 v162, v148, v149
    v_cvt_pk_bf16_f32 v163, v150, v151
    ds_write_b64 v12, v[162:163] offset:2048
    v_cvt_pk_bf16_f32 v164, v152, v153
    v_cvt_pk_bf16_f32 v165, v154, v155
    ds_write_b64 v12, v[164:165] offset:4096
    v_cvt_pk_bf16_f32 v166, v156, v157
    v_cvt_pk_bf16_f32 v167, v158, v159
    ds_write_b64 v12, v[166:167] offset:6144
    s_and_b32 s4, s21, 3
    s_lshl_b32 s4, s4, 16
    s_add_u32 s34, s36, s4
    s_waitcnt lgkmcnt(0)
    s_barrier
    ds_read_b128 v[96:99], v15 offset:0
    ds_read_b128 v[104:107], v62 offset:0
    ds_read_b128 v[100:103], v15 offset:1024
    ds_read_b128 v[108:111], v62 offset:1024
    s_waitcnt lgkmcnt(2)
    v_mfma_f32_16x16x32_bf16 v[128:131], v[96:99], v[104:107], 0
    s_waitcnt lgkmcnt(0)
    v_mfma_f32_16x16x32_bf16 v[128:131], v[100:103], v[108:111], v[128:131]
    s_nop 7
    buffer_store_dwordx4 v[128:131], v63, s[8:11], s34 offen offset:0
    s_branch Sf_loop
Sf_end:
    s_waitcnt vmcnt(0)
    v_mov_b32 v10, s21
    s_mov_b64 exec, 1
    buffer_store_dword v10, v9, s[8:11], s33 offen
    s_mov_b64 exec, -1
    s_branch R_done
Ss_go:
    s_waitcnt vmcnt(0)
    s_barrier
    v_add_u32 v11, s29, v2
    s_xor_b32 s29, s29, 40960
    s_add_u32 s42, s29, s27
    ds_read_b128 a[160:163], v11 offset:0
    ds_read_b128 a[164:167], v11 offset:20480
    ds_read_b128 a[168:171], v11 offset:1024
    ds_read_b128 a[172:175], v11 offset:21504
    ds_read_b128 a[176:179], v11 offset:2048
    ds_read_b128 a[180:183], v11 offset:22528
    s_waitcnt lgkmcnt(5)
    v_mfma_f32_16x16x32_bf16 v[144:147], a[0:3], a[160:163], 0
    ds_read_b128 a[184:187], v11 offset:3072
    v_mfma_f32_16x16x32_bf16 v[152:155], a[80:83], a[160:163], 0
    s_waitcnt lgkmcnt(5)
    v_mfma_f32_16x16x32_bf16 v[148:151], a[0:3], a[164:167], 0
    ds_read_b128 a[188:191], v11 offset:23552
    v_mfma_f32_16x16x32_bf16 v[156:159], a[80:83], a[164:167], 0
    s_waitcnt lgkmcnt(5)
    v_mfma_f32_16x16x32_bf16 v[144:147], a[4:7], a[168:171], v[144:147]
    ds_read_b128 a[160:163], v11 offset:4096
    s_add_u32 s35, s28, 0
    s_add_u32 m0, s42, 0
    v_mfma_f32_16x16x32_bf16 v[152:155], a[84:87], a[168:171], v[152:155]
    buffer_load_dwordx4 v2, s[8:11], s35 offen offset:0 sc1 lds
    s_waitcnt lgkmcnt(5)
    v_mfma_f32_16x16x32_bf16 v[148:151], a[4:7], a[172:175], v[148:151]
    ds_read_b128 a[164:167], v11 offset:24576
    v_mfma_f32_16x16x32_bf16 v[156:159], a[84:87], a[172:175], v[156:159]
    s_waitcnt lgkmcnt(5)
    v_mfma_f32_16x16x32_bf16 v[144:147], a[8:11], a[176:179], v[144:147]
    ds_read_b128 a[168:171], v11 offset:5120
    v_mfma_f32_16x16x32_bf16 v[152:155], a[88:91], a[176:179], v[152:155]
    s_waitcnt lgkmcnt(5)
    v_mfma_f32_16x16x32_bf16 v[148:151], a[8:11], a[180:183], v[148:151]
    ds_read_b128 a[172:175], v11 offset:25600
    v_mfma_f32_16x16x32_bf16 v[156:159], a[88:91], a[180:183], v[156:159]
    buffer_load_dwordx4 v2, s[8:11], s35 offen offset:1024 sc1 lds
    s_waitcnt lgkmcnt(5)
    v_mfma_f32_16x16x32_bf16 v[144:147], a[12:15], a[184:187], v[144:147]
    ds_read_b128 a[176:179], v11 offset:6144
    v_mfma_f32_16x16x32_bf16 v[152:155], a[92:95], a[184:187], v[152:155]
    s_waitcnt lgkmcnt(5)
    v_mfma_f32_16x16x32_bf16 v[148:151], a[12:15], a[188:191], v[148:151]
    ds_read_b128 a[180:183], v11 offset:26624
    v_mfma_f32_16x16x32_bf16 v[156:159], a[92:95], a[188:191], v[156:159]
    s_waitcnt lgkmcnt(5)
    v_mfma_f32_16x16x32_bf16 v[144:147], a[16:19], a[160:163], v[144:147]
    ds_read_b128 a[184:187], v11 offset:7168
    v_mfma_f32_16x16x32_bf16 v[152:155], a[96:99], a[160:163], v[152:155]
    buffer_load_dwordx4 v2, s[8:11], s35 offen offset:2048 sc1 lds
    s_waitcnt lgkmcnt(5)
    v_mfma_f32_16x16x32_bf16 v[148:151], a[16:19], a[164:167], v[148:151]
    ds_read_b128 a[188:191], v11 offset:27648
    v_mfma_f32_16x16x32_bf16 v[156:159], a[96:99], a[164:167], v[156:159]
    s_waitcnt lgkmcnt(5)
    v_mfma_f32_16x16x32_bf16 v[144:147], a[20:23], a[168:171], v[144:147]
    ds_read_b128 a[160:163], v11 offset:8192
    v_mfma_f32_16x16x32_bf16 v[152:155], a[100:103], a[168:171], v[152:155]
    s_waitcnt lgkmcnt(5)
    v_mfma_f32_16x16x32_bf16 v[148:151], a[20:23], a[172:175], v[148:151]
    ds_read_b128 a[164:167], v11 offset:28672
    v_mfma_f32_16x16x32_bf16 v[156:159], a[100:103], a[172:175], v[156:159]
    buffer_load_dwordx4 v2, s[8:11], s35 offen offset:3072 sc1 lds
    s_waitcnt lgkmcnt(5)
    v_mfma_f32_16x16x32_bf16 v[144:147], a[24:27], a[176:179], v[144:147]
    ds_read_b128 a[168:171], v11 offset:9216
    v_mfma_f32_16x16x32_bf16 v[152:155], a[104:107], a[176:179], v[152:155]
    s_waitcnt lgkmcnt(5)
    v_mfma_f32_16x16x32_bf16 v[148:151], a[24:27], a[180:183], v[148:151]
    ds_read_b128 a[172:175], v11 offset:29696
    v_mfma_f32_16x16x32_bf16 v[156:159], a[104:107], a[180:183], v[156:159]
    s_waitcnt lgkmcnt(5)
    v_mfma_f32_16x16x32_bf16 v[144:147], a[28:31], a[184:187], v[144:147]
    ds_read_b128 a[176:179], v11 offset:10240
    s_add_u32 s35, s28, 4096
    s_add_u32 m0, s42, 4096
    v_mfma_f32_16x16x32_bf16 v[152:155], a[108:111], a[184:187], v[152:155]
    buffer_load_dwordx4 v2, s[8:11], s35 offen offset:0 sc1 lds
    s_waitcnt lgkmcnt(5)
    v_mfma_f32_16x16x32_bf16 v[148:151], a[28:31], a[188:191], v[148:151]
    ds_read_b128 a[180:183], v11 offset:30720
    v_mfma_f32_16x16x32_bf16 v[156:159], a[108:111], a[188:191], v[156:159]
    s_waitcnt lgkmcnt(5)
    v_mfma_f32_16x16x32_bf16 v[144:147], a[32:35], a[160:163], v[144:147]
    ds_read_b128 a[184:187], v11 offset:11264
    v_mfma_f32_16x16x32_bf16 v[152:155], a[112:115], a[160:163], v[152:155]
    s_waitcnt lgkmcnt(5)
    v_mfma_f32_16x16x32_bf16 v[148:151], a[32:35], a[164:167], v[148:151]
    ds_read_b128 a[188:191], v11 offset:31744
    v_mfma_f32_16x16x32_bf16 v[156:159], a[112:115], a[164:167], v[156:159]
    buffer_load_dwordx4 v2, s[8:11], s35 offen offset:1024 sc1 lds
    s_waitcnt lgkmcnt(5)
    v_mfma_f32_16x16x32_bf16 v[144:147], a[36:39], a[168:171], v[144:147]
    ds_read_b128 a[160:163], v11 offset:12288
    v_mfma_f32_16x16x32_bf16 v[152:155], a[116:119], a[168:171], v[152:155]
    s_waitcnt lgkmcnt(5)
    v_mfma_f32_16x16x32_bf16 v[148:151], a[36:39], a[172:175], v[148:151]
    ds_read_b128 a[164:167], v11 offset:32768
    v_mfma_f32_16x16x32_bf16 v[156:159], a[116:119], a[172:175], v[156:159]
    s_waitcnt lgkmcnt(5)
    v_mfma_f32_16x16x32_bf16 v[144:147], a[40:43], a[176:179], v[144:147]
    ds_read_b128 a[168:171], v11 offset:13312
    v_mfma_f32_16x16x32_bf16 v[152:155], a[120:123], a[176:179], v[152:155]
    buffer_load_dwordx4 v2, s[8:11], s35 offen offset:2048 sc1 lds
    s_waitcnt lgkmcnt(5)
    v_mfma_f32_16x16x32_bf16 v[148:151], a[40:43], a[180:183], v[148:151]
    ds_read_b128 a[172:175], v11 offset:33792
    v_mfma_f32_16x16x32_bf16 v[156:159], a[120:123], a[180:183], v[156:159]
    s_waitcnt lgkmcnt(5)
    v_mfma_f32_16x16x32_bf16 v[144:147], a[44:47], a[184:187], v[144:147]
    ds_read_b128 a[176:179], v11 offset:14336
    v_mfma_f32_16x16x32_bf16 v[152:155], a[124:127], a[184:187], v[152:155]
    s_waitcnt lgkmcnt(5)
    v_mfma_f32_16x16x32_bf16 v[148:151], a[44:47], a[188:191], v[148:151]
    ds_read_b128 a[180:183], v11 offset:34816
    v_mfma_f32_16x16x32_bf16 v[156:159], a[124:127], a[188:191], v[156:159]
    buffer_load_dwordx4 v2, s[8:11], s35 offen offset:3072 sc1 lds
    s_waitcnt lgkmcnt(5)
    v_mfma_f32_16x16x32_bf16 v[144:147], a[48:51], a[160:163], v[144:147]
    ds_read_b128 a[184:187], v11 offset:15360
    v_mfma_f32_16x16x32_bf16 v[152:155], a[128:131], a[160:163], v[152:155]
    s_waitcnt lgkmcnt(5)
    v_mfma_f32_16x16x32_bf16 v[148:151], a[48:51], a[164:167], v[148:151]
    ds_read_b128 a[188:191], v11 offset:35840
    v_mfma_f32_16x16x32_bf16 v[156:159], a[128:131], a[164:167], v[156:159]
    s_waitcnt lgkmcnt(5)
    v_mfma_f32_16x16x32_bf16 v[144:147], a[52:55], a[168:171], v[144:147]
    ds_read_b128 a[160:163], v11 offset:16384
    s_add_u32 s35, s28, 8192
    s_add_u32 m0, s42, 8192
    v_mfma_f32_16x16x32_bf16 v[152:155], a[132:135], a[168:171], v[152:155]
    buffer_load_dwordx4 v2, s[8:11], s35 offen offset:0 sc1 lds
    s_waitcnt lgkmcnt(5)
    v_mfma_f32_16x16x32_bf16 v[148:151], a[52:55], a[172:175], v[148:151]
    ds_read_b128 a[164:167], v11 offset:36864
    v_mfma_f32_16x16x32_bf16 v[156:159], a[132:135], a[172:175], v[156:159]
    s_waitcnt lgkmcnt(5)
    v_mfma_f32_16x16x32_bf16 v[144:147], a[56:59], a[176:179], v[144:147]
    ds_read_b128 a[168:171], v11 offset:17408
    v_mfma_f32_16x16x32_bf16 v[152:155], a[136:139], a[176:179], v[152:155]
    s_waitcnt lgkmcnt(5)
    v_mfma_f32_16x16x32_bf16 v[148:151], a[56:59], a[180:183], v[148:151]
    ds_read_b128 a[172:175], v11 offset:37888
    v_mfma_f32_16x16x32_bf16 v[156:159], a[136:139], a[180:183], v[156:159]
    buffer_load_dwordx4 v2, s[8:11], s35 offen offset:1024 sc1 lds
    s_waitcnt lgkmcnt(5)
    v_mfma_f32_16x16x32_bf16 v[144:147], a[60:63], a[184:187], v[144:147]
    ds_read_b128 a[176:179], v11 offset:18432
    v_mfma_f32_16x16x32_bf16 v[152:155], a[140:143], a[184:187], v[152:155]
    s_waitcnt lgkmcnt(5)
    v_mfma_f32_16x16x32_bf16 v[148:151], a[60:63], a[188:191], v[148:151]
    ds_read_b128 a[180:183], v11 offset:38912
    v_mfma_f32_16x16x32_bf16 v[156:159], a[140:143], a[188:191], v[156:159]
    s_waitcnt lgkmcnt(5)
    v_mfma_f32_16x16x32_bf16 v[144:147], a[64:67], a[160:163], v[144:147]
    ds_read_b128 a[184:187], v11 offset:19456
    v_mfma_f32_16x16x32_bf16 v[152:155], a[144:147], a[160:163], v[152:155]
    s_waitcnt lgkmcnt(5)
    v_mfma_f32_16x16x32_bf16 v[148:151], a[64:67], a[164:167], v[148:151]
    ds_read_b128 a[188:191], v11 offset:39936
    v_mfma_f32_16x16x32_bf16 v[156:159], a[144:147], a[164:167], v[156:159]
    s_waitcnt lgkmcnt(5)
    v_mfma_f32_16x16x32_bf16 v[144:147], a[68:71], a[168:171], v[144:147]
    v_mfma_f32_16x16x32_bf16 v[152:155], a[148:151], a[168:171], v[152:155]
    s_waitcnt lgkmcnt(4)
    v_mfma_f32_16x16x32_bf16 v[148:151], a[68:71], a[172:175], v[148:151]
    v_mfma_f32_16x16x32_bf16 v[156:159], a[148:151], a[172:175], v[156:159]
    s_waitcnt lgkmcnt(3)
    v_mfma_f32_16x16x32_bf16 v[144:147], a[72:75], a[176:179], v[144:147]
    v_mfma_f32_16x16x32_bf16 v[152:155], a[152:155], a[176:179], v[152:155]
    s_waitcnt lgkmcnt(2)
    v_mfma_f32_16x16x32_bf16 v[148:151], a[72:75], a[180:183], v[148:151]
    v_mfma_f32_16x16x32_bf16 v[156:159], a[152:155], a[180:183], v[156:159]
    s_waitcnt lgkmcnt(1)
    v_mfma_f32_16x16x32_bf16 v[144:147], a[76:79], a[184:187], v[144:147]
    v_mfma_f32_16x16x32_bf16 v[152:155], a[156:159], a[184:187], v[152:155]
    s_waitcnt lgkmcnt(0)
    v_mfma_f32_16x16x32_bf16 v[148:151], a[76:79], a[188:191], v[148:151]
    v_mfma_f32_16x16x32_bf16 v[156:159], a[156:159], a[188:191], v[156:159]
    s_add_u32 s28, s28, 40960
    s_add_u32 s32, s32, 1
    s_mov_b32 s31, 0
SsB0_l:
    buffer_load_dword v68, v70, s[8:11], s49 offen sc1
    s_waitcnt vmcnt(0)
SsB0_c:
    v_cmp_gt_u32 vcc, 1, v68
    s_cbranch_vccz SsB0_o
    s_sleep 2
    s_add_u32 s31, s31, 1
    s_cmp_lt_u32 s31, s30
    s_cbranch_scc1 SsB0_l
    s_mov_b32 s30, 1
SsB0_o:
    v_cvt_pk_bf16_f32 v160, v144, v145
    v_cvt_pk_bf16_f32 v161, v146, v147
    ds_write_b64 v12, v[160:161] offset:0
    v_cvt_pk_bf16_f32 v162, v148, v149
    v_cvt_pk_bf16_f32 v163, v150, v151
    ds_write_b64 v12, v[162:163] offset:2048
    v_cvt_pk_bf16_f32 v164, v152, v153
    v_cvt_pk_bf16_f32 v165, v154, v155
    ds_write_b64 v12, v[164:165] offset:4096
    v_cvt_pk_bf16_f32 v166, v156, v157
    v_cvt_pk_bf16_f32 v167, v158, v159
    ds_write_b64 v12, v[166:167] offset:6144
    s_and_b32 s4, s21, 3
    s_lshl_b32 s4, s4, 16
    s_add_u32 s34, s36, s4
    s_waitcnt lgkmcnt(0)
    s_barrier
    ds_read_b128 v[96:99], v15 offset:0
    ds_read_b128 v[104:107], v62 offset:0
    ds_read_b128 v[100:103], v15 offset:1024
    ds_read_b128 v[108:111], v62 offset:1024
    s_waitcnt lgkmcnt(2)
    v_mfma_f32_16x16x32_bf16 v[128:131], v[96:99], v[104:107], 0
    s_waitcnt lgkmcnt(0)
    v_mfma_f32_16x16x32_bf16 v[128:131], v[100:103], v[108:111], v[128:131]
    s_nop 7
    buffer_store_dwordx4 v[128:131], v63, s[8:11], s34 offen offset:0 sc1
Ss_loop:
    s_and_b32 s4, s21, 3
    s_mul_i32 s5, s4, 10240
    s_add_u32 s5, s5, s22
    s_sub_u32 s38, s5, 73728
    s_sub_u32 s39, s5, 81920
    s_mul_i32 s5, s4, 16384
    s_add_u32 s25, s24, s5
    s_xor_b32 s4, s4, 2
    s_mul_i32 s5, s4, 163840
    s_mul_i32 s5, s4, 16384
    s_add_u32 s26, s24, s5
    s_add_u32 s21, s21, 1
    v_mov_b32 v72, 0
    v_mov_b32 v73, 0
    v_mov_b32 v74, 0
    v_mov_b32 v75, 0
    v_mov_b32 v76, 0
    v_mov_b32 v77, 0
    v_mov_b32 v78, 0
    v_mov_b32 v79, 0
    v_mov_b32 v59, s21
    s_cmp_eq_u32 s3, 1
    s_cbranch_scc1 Ss_q1
    s_cmp_eq_u32 s3, 2
    s_cbranch_scc1 Ss_q2
    s_cmp_eq_u32 s3, 3
    s_cbranch_scc1 Ss_q3
Ss_q0:
    buffer_load_dwordx4 v[16:19], v3, s[8:11], s38 offen offset:0 sc1
    buffer_load_dwordx4 v[20:23], v3, s[8:11], s38 offen offset:1024 sc1
    buffer_load_dwordx2 v[56:57], v4, s[8:11], s39 offen offset:0 sc1
    s_mov_b32 s31, -1
Ss0m_l:
    buffer_load_dwordx4 v[16:19], v3, s[8:11], s38 offen offset:0 sc1
    buffer_load_dwordx4 v[20:23], v3, s[8:11], s38 offen offset:1024 sc1
    buffer_load_dwordx2 v[56:57], v4, s[8:11], s39 offen offset:0 sc1
    s_add_u32 s31, s31, 1
    s_cmp_lt_u32 s31, s30
    s_cselect_b32 s30, s30, 1
    s_cbranch_scc0 Ss0m_o
    s_waitcnt vmcnt(3)
    v_max3_u32 v58, v16, v17, v18
    v_max3_u32 v58, v58, v19, v20
    v_max3_u32 v58, v58, v21, v22
    v_max3_u32 v58, v58, v23, v56
    v_max_u32 v58, v58, v57
    v_cmp_eq_u32 vcc, -1, v58
    s_cbranch_vccnz Ss0m_l
Ss0m_o:
    ds_write_b128 v3, v[16:19] offset:8192
    ds_write_b128 v3, v[20:23] offset:9216
    ds_write_b64 v4, v[56:57]
    v_smfmac_f32_16x16x64_bf16 v[72:75], v[16:19], a[0:7], v5
    v_smfmac_f32_16x16x64_bf16 v[76:79], v[16:19], a[80:87], v5
    s_waitcnt lgkmcnt(0)
    s_barrier
    ds_read_b128 v[24:27], v3 offset:10240
    ds_read_b128 v[28:31], v3 offset:11264
    ds_read_b128 v[32:35], v3 offset:12288
    v_smfmac_f32_16x16x64_bf16 v[72:75], v[20:23], a[8:15], v5
    ds_read_b128 v[36:39], v3 offset:13312
    ds_read_b128 v[40:43], v3 offset:14336
    v_smfmac_f32_16x16x64_bf16 v[76:79], v[20:23], a[88:95], v5
    ds_read_b128 v[44:47], v3 offset:15360
    ds_read_b128 v[48:51], v3 offset:16384
    ds_read_b128 v[52:55], v3 offset:17408
    s_waitcnt lgkmcnt(7)
    v_smfmac_f32_16x16x64_bf16 v[72:75], v[24:27], a[16:23], v5
    v_smfmac_f32_16x16x64_bf16 v[76:79], v[24:27], a[96:103], v5
    s_waitcnt lgkmcnt(6)
    v_smfmac_f32_16x16x64_bf16 v[72:75], v[28:31], a[24:31], v5
    v_smfmac_f32_16x16x64_bf16 v[76:79], v[28:31], a[104:111], v5
    s_waitcnt lgkmcnt(5)
    v_smfmac_f32_16x16x64_bf16 v[72:75], v[32:35], a[32:39], v5
    v_smfmac_f32_16x16x64_bf16 v[76:79], v[32:35], a[112:119], v5
    s_waitcnt lgkmcnt(4)
    v_smfmac_f32_16x16x64_bf16 v[72:75], v[36:39], a[40:47], v5
    v_smfmac_f32_16x16x64_bf16 v[76:79], v[36:39], a[120:127], v5
    s_waitcnt lgkmcnt(3)
    v_smfmac_f32_16x16x64_bf16 v[72:75], v[40:43], a[48:55], v5
    v_smfmac_f32_16x16x64_bf16 v[76:79], v[40:43], a[128:135], v5
    s_waitcnt lgkmcnt(2)
    v_smfmac_f32_16x16x64_bf16 v[72:75], v[44:47], a[56:63], v5
    v_smfmac_f32_16x16x64_bf16 v[76:79], v[44:47], a[136:143], v5
    s_waitcnt lgkmcnt(1)
    v_smfmac_f32_16x16x64_bf16 v[72:75], v[48:51], a[64:71], v5
    v_smfmac_f32_16x16x64_bf16 v[76:79], v[48:51], a[144:151], v5
    s_waitcnt lgkmcnt(0)
    v_smfmac_f32_16x16x64_bf16 v[72:75], v[52:55], a[72:79], v5
    v_smfmac_f32_16x16x64_bf16 v[76:79], v[52:55], a[152:159], v5
    s_nop 7
    v_permlane32_swap_b32 v72, v76
    v_permlane32_swap_b32 v73, v77
    v_permlane32_swap_b32 v74, v78
    v_permlane32_swap_b32 v75, v79
    v_pk_add_f32 v[72:73], v[72:73], v[76:77]
    v_pk_add_f32 v[74:75], v[74:75], v[78:79]
    v_cvt_pk_bf16_f32 v94, v72, v73
    v_cvt_pk_bf16_f32 v95, v74, v75
    ds_write_b64 v7, v[94:95]
    s_waitcnt lgkmcnt(0)
    s_barrier
    ds_read_b64_tr_b16 v[120:121], v8 offset:0
    ds_read_b64_tr_b16 v[122:123], v8 offset:640
    ds_read_b64_tr_b16 v[124:125], v8 offset:1280
    ds_read_b64_tr_b16 v[126:127], v8 offset:1920
    s_waitcnt lgkmcnt(2)
    v_mfma_f32_16x16x32_bf16 v[128:131], v[96:99], v[120:123], 0
    s_waitcnt lgkmcnt(0)
    v_mfma_f32_16x16x32_bf16 v[128:131], v[100:103], v[124:127], v[128:131]
    s_nop 7
    buffer_store_dwordx4 v[128:131], v64, s[8:11], s25 offen offset:0 sc1
    s_branch Ss_qj
Ss_q1:
    buffer_load_dwordx4 v[16:19], v3, s[8:11], s38 offen offset:0 sc1
    buffer_load_dwordx4 v[20:23], v3, s[8:11], s38 offen offset:1024 sc1
    buffer_load_dwordx2 v[56:57], v4, s[8:11], s39 offen offset:0 sc1
    s_mov_b32 s31, -1
Ss1m_l:
    buffer_load_dwordx4 v[16:19], v3, s[8:11], s38 offen offset:0 sc1
    buffer_load_dwordx4 v[20:23], v3, s[8:11], s38 offen offset:1024 sc1
    buffer_load_dwordx2 v[56:57], v4, s[8:11], s39 offen offset:0 sc1
    s_add_u32 s31, s31, 1
    s_cmp_lt_u32 s31, s30
    s_cselect_b32 s30, s30, 1
    s_cbranch_scc0 Ss1m_o
    s_waitcnt vmcnt(3)
    v_max3_u32 v58, v16, v17, v18
    v_max3_u32 v58, v58, v19, v20
    v_max3_u32 v58, v58, v21, v22
    v_max3_u32 v58, v58, v23, v56
    v_max_u32 v58, v58, v57
    v_cmp_eq_u32 vcc, -1, v58
    s_cbranch_vccnz Ss1m_l
Ss1m_o:
    ds_write_b128 v3, v[16:19] offset:8192
    ds_write_b128 v3, v[20:23] offset:9216
    ds_write_b64 v4, v[56:57]
    v_smfmac_f32_16x16x64_bf16 v[72:75], v[16:19], a[16:23], v5
    v_smfmac_f32_16x16x64_bf16 v[76:79], v[16:19], a[96:103], v5
    s_waitcnt lgkmcnt(0)
    s_barrier
    ds_read_b128 v[24:27], v3 offset:10240
    ds_read_b128 v[28:31], v3 offset:11264
    ds_read_b128 v[32:35], v3 offset:12288
    v_smfmac_f32_16x16x64_bf16 v[72:75], v[20:23], a[24:31], v5
    ds_read_b128 v[36:39], v3 offset:13312
    ds_read_b128 v[40:43], v3 offset:6144
    v_smfmac_f32_16x16x64_bf16 v[76:79], v[20:23], a[104:111], v5
    ds_read_b128 v[44:47], v3 offset:7168
    ds_read_b128 v[48:51], v3 offset:14336
    ds_read_b128 v[52:55], v3 offset:15360
    s_waitcnt lgkmcnt(7)
    v_smfmac_f32_16x16x64_bf16 v[72:75], v[24:27], a[32:39], v5
    v_smfmac_f32_16x16x64_bf16 v[76:79], v[24:27], a[112:119], v5
    s_waitcnt lgkmcnt(6)
    v_smfmac_f32_16x16x64_bf16 v[72:75], v[28:31], a[40:47], v5
    v_smfmac_f32_16x16x64_bf16 v[76:79], v[28:31], a[120:127], v5
    s_waitcnt lgkmcnt(5)
    v_smfmac_f32_16x16x64_bf16 v[72:75], v[32:35], a[48:55], v5
    v_smfmac_f32_16x16x64_bf16 v[76:79], v[32:35], a[128:135], v5
    s_waitcnt lgkmcnt(4)
    v_smfmac_f32_16x16x64_bf16 v[72:75], v[36:39], a[56:63], v5
    v_smfmac_f32_16x16x64_bf16 v[76:79], v[36:39], a[136:143], v5
    s_waitcnt lgkmcnt(3)
    v_smfmac_f32_16x16x64_bf16 v[72:75], v[40:43], a[0:7], v5
    v_smfmac_f32_16x16x64_bf16 v[76:79], v[40:43], a[80:87], v5
    s_waitcnt lgkmcnt(2)
    v_smfmac_f32_16x16x64_bf16 v[72:75], v[44:47], a[8:15], v5
    v_smfmac_f32_16x16x64_bf16 v[76:79], v[44:47], a[88:95], v5
    s_waitcnt lgkmcnt(1)
    v_smfmac_f32_16x16x64_bf16 v[72:75], v[48:51], a[64:71], v5
    v_smfmac_f32_16x16x64_bf16 v[76:79], v[48:51], a[144:151], v5
    s_waitcnt lgkmcnt(0)
    v_smfmac_f32_16x16x64_bf16 v[72:75], v[52:55], a[72:79], v5
    v_smfmac_f32_16x16x64_bf16 v[76:79], v[52:55], a[152:159], v5
    s_nop 7
    v_permlane32_swap_b32 v72, v76
    v_permlane32_swap_b32 v73, v77
    v_permlane32_swap_b32 v74, v78
    v_permlane32_swap_b32 v75, v79
    v_pk_add_f32 v[72:73], v[72:73], v[76:77]
    v_pk_add_f32 v[74:75], v[74:75], v[78:79]
    v_cvt_pk_bf16_f32 v94, v72, v73
    v_cvt_pk_bf16_f32 v95, v74, v75
    ds_write_b64 v7, v[94:95]
    s_waitcnt lgkmcnt(0)
    s_barrier
    ds_read_b64_tr_b16 v[120:121], v8 offset:0
    ds_read_b64_tr_b16 v[122:123], v8 offset:640
    ds_read_b64_tr_b16 v[124:125], v8 offset:1280
    ds_read_b64_tr_b16 v[126:127], v8 offset:1920
    s_waitcnt lgkmcnt(2)
    v_mfma_f32_16x16x32_bf16 v[128:131], v[96:99], v[120:123], 0
    s_waitcnt lgkmcnt(0)
    v_mfma_f32_16x16x32_bf16 v[128:131], v[100:103], v[124:127], v[128:131]
    s_nop 7
    buffer_store_dwordx4 v[128:131], v64, s[8:11], s25 offen offset:0 sc1
    s_branch Ss_qj
Ss_q2:
    buffer_load_dwordx4 v[16:19], v3, s[8:11], s38 offen offset:0 sc1
    buffer_load_dwordx4 v[20:23], v3, s[8:11], s38 offen offset:1024 sc1
    buffer_load_dwordx2 v[56:57], v4, s[8:11], s39 offen offset:0 sc1
    s_mov_b32 s31, -1
Ss2m_l:
    buffer_load_dwordx4 v[16:19], v3, s[8:11], s38 offen offset:0 sc1
    buffer_load_dwordx4 v[20:23], v3, s[8:11], s38 offen offset:1024 sc1
    buffer_load_dwordx2 v[56:57], v4, s[8:11], s39 offen offset:0 sc1
    s_add_u32 s31, s31, 1
    s_cmp_lt_u32 s31, s30
    s_cselect_b32 s30, s30, 1
    s_cbranch_scc0 Ss2m_o
    s_waitcnt vmcnt(3)
    v_max3_u32 v58, v16, v17, v18
    v_max3_u32 v58, v58, v19, v20
    v_max3_u32 v58, v58, v21, v22
    v_max3_u32 v58, v58, v23, v56
    v_max_u32 v58, v58, v57
    v_cmp_eq_u32 vcc, -1, v58
    s_cbranch_vccnz Ss2m_l
Ss2m_o:
    ds_write_b128 v3, v[16:19] offset:8192
    ds_write_b128 v3, v[20:23] offset:9216
    ds_write_b64 v4, v[56:57]
    v_smfmac_f32_16x16x64_bf16 v[72:75], v[16:19], a[32:39], v5
    v_smfmac_f32_16x16x64_bf16 v[76:79], v[16:19], a[112:119], v5
    s_waitcnt lgkmcnt(0)
    s_barrier
    ds_read_b128 v[24:27], v3 offset:10240
    ds_read_b128 v[28:31], v3 offset:11264
    ds_read_b128 v[32:35], v3 offset:4096
    v_smfmac_f32_16x16x64_bf16 v[72:75], v[20:23], a[40:47], v5
    ds_read_b128 v[36:39], v3 offset:5120
    ds_read_b128 v[40:43], v3 offset:6144
    v_smfmac_f32_16x16x64_bf16 v[76:79], v[20:23], a[120:127], v5
    ds_read_b128 v[44:47], v3 offset:7168
    ds_read_b128 v[48:51], v3 offset:12288
    ds_read_b128 v[52:55], v3 offset:13312
    s_waitcnt lgkmcnt(7)
    v_smfmac_f32_16x16x64_bf16 v[72:75], v[24:27], a[48:55], v5
    v_smfmac_f32_16x16x64_bf16 v[76:79], v[24:27], a[128:135], v5
    s_waitcnt lgkmcnt(6)
    v_smfmac_f32_16x16x64_bf16 v[72:75], v[28:31], a[56:63], v5
    v_smfmac_f32_16x16x64_bf16 v[76:79], v[28:31], a[136:143], v5
    s_waitcnt lgkmcnt(5)
    v_smfmac_f32_16x16x64_bf16 v[72:75], v[32:35], a[0:7], v5
    v_smfmac_f32_16x16x64_bf16 v[76:79], v[32:35], a[80:87], v5
    s_waitcnt lgkmcnt(4)
    v_smfmac_f32_16x16x64_bf16 v[72:75], v[36:39], a[8:15], v5
    v_smfmac_f32_16x16x64_bf16 v[76:79], v[36:39], a[88:95], v5
    s_waitcnt lgkmcnt(3)
    v_smfmac_f32_16x16x64_bf16 v[72:75], v[40:43], a[16:23], v5
    v_smfmac_f32_16x16x64_bf16 v[76:79], v[40:43], a[96:103], v5
    s_waitcnt lgkmcnt(2)
    v_smfmac_f32_16x16x64_bf16 v[72:75], v[44:47], a[24:31], v5
    v_smfmac_f32_16x16x64_bf16 v[76:79], v[44:47], a[104:111], v5
    s_waitcnt lgkmcnt(1)
    v_smfmac_f32_16x16x64_bf16 v[72:75], v[48:51], a[64:71], v5
    v_smfmac_f32_16x16x64_bf16 v[76:79], v[48:51], a[144:151], v5
    s_waitcnt lgkmcnt(0)
    v_smfmac_f32_16x16x64_bf16 v[72:75], v[52:55], a[72:79], v5
    v_smfmac_f32_16x16x64_bf16 v[76:79], v[52:55], a[152:159], v5
    s_nop 7
    v_permlane32_swap_b32 v72, v76
    v_permlane32_swap_b32 v73, v77
    v_permlane32_swap_b32 v74, v78
    v_permlane32_swap_b32 v75, v79
    v_pk_add_f32 v[72:73], v[72:73], v[76:77]
    v_pk_add_f32 v[74:75], v[74:75], v[78:79]
    v_cvt_pk_bf16_f32 v94, v72, v73
    v_cvt_pk_bf16_f32 v95, v74, v75
    ds_write_b64 v7, v[94:95]
    s_waitcnt lgkmcnt(0)
    s_barrier
    ds_read_b64_tr_b16 v[120:121], v8 offset:0
    ds_read_b64_tr_b16 v[112:113], v6 offset:16
    ds_read_b64_tr_b16 v[122:123], v8 offset:640
    ds_read_b64_tr_b16 v[114:115], v6 offset:656
    ds_read_b64_tr_b16 v[124:125], v8 offset:1280
    ds_read_b64_tr_b16 v[116:117], v6 offset:1296
    ds_read_b64_tr_b16 v[126:127], v8 offset:1920
    ds_read_b64_tr_b16 v[118:119], v6 offset:1936
    s_waitcnt lgkmcnt(4)
    v_mfma_f32_16x16x32_bf16 v[128:131], v[112:115], v[120:123], 0
    s_waitcnt lgkmcnt(0)
    v_mfma_f32_16x16x32_bf16 v[128:131], v[116:119], v[124:127], v[128:131]
    s_nop 7
    v_cndmask_b32 v128, v128, v129, s[40:41]
    v_cndmask_b32 v130, v130, v131, s[40:41]
    v_cndmask_b32 v128, v128, v130, s[90:91]
    buffer_store_dword v128, v65, s[8:11], s25 offen offset:0 sc1
    s_branch Ss_qj
Ss_q3:
    buffer_load_dwordx4 v[16:19], v3, s[8:11], s38 offen offset:0 sc1
    buffer_load_dwordx4 v[20:23], v3, s[8:11], s38 offen offset:1024 sc1
    buffer_load_dwordx2 v[56:57], v4, s[8:11], s39 offen offset:0 sc1
    s_mov_b32 s31, -1
Ss3m_l:
    buffer_load_dwordx4 v[16:19], v3, s[8:11], s38 offen offset:0 sc1
    buffer_load_dwordx4 v[20:23], v3, s[8:11], s38 offen offset:1024 sc1
    buffer_load_dwordx2 v[56:57], v4, s[8:11], s39 offen offset:0 sc1
    s_add_u32 s31, s31, 1
    s_cmp_lt_u32 s31, s30
    s_cselect_b32 s30, s30, 1
    s_cbranch_scc0 Ss3m_o
    s_waitcnt vmcnt(3)
    v_max3_u32 v58, v16, v17, v18
    v_max3_u32 v58, v58, v19, v20
    v_max3_u32 v58, v58, v21, v22
    v_max3_u32 v58, v58, v23, v56
    v_max_u32 v58, v58, v57
    v_cmp_eq_u32 vcc, -1, v58
    s_cbranch_vccnz Ss3m_l
Ss3m_o:
    ds_write_b128 v3, v[16:19] offset:8192
    ds_write_b128 v3, v[20:23] offset:9216
    ds_write_b64 v4, v[56:57]
    v_smfmac_f32_16x16x64_bf16 v[72:75], v[16:19], a[48:55], v5
    v_smfmac_f32_16x16x64_bf16 v[76:79], v[16:19], a[128:135], v5
    s_waitcnt lgkmcnt(0)
    s_barrier
    ds_read_b128 v[24:27], v3 offset:2048
    ds_read_b128 v[28:31], v3 offset:3072
    ds_read_b128 v[32:35], v3 offset:4096
    v_smfmac_f32_16x16x64_bf16 v[72:75], v[20:23], a[56:63], v5
    ds_read_b128 v[36:39], v3 offset:5120
    ds_read_b128 v[40:43], v3 offset:6144
    v_smfmac_f32_16x16x64_bf16 v[76:79], v[20:23], a[136:143], v5
    ds_read_b128 v[44:47], v3 offset:7168
    ds_read_b128 v[48:51], v3 offset:10240
    ds_read_b128 v[52:55], v3 offset:11264
    s_waitcnt lgkmcnt(7)
    v_smfmac_f32_16x16x64_bf16 v[72:75], v[24:27], a[0:7], v5
    v_smfmac_f32_16x16x64_bf16 v[76:79], v[24:27], a[80:87], v5
    s_waitcnt lgkmcnt(6)
    v_smfmac_f32_16x16x64_bf16 v[72:75], v[28:31], a[8:15], v5
    v_smfmac_f32_16x16x64_bf16 v[76:79], v[28:31], a[88:95], v5
    s_waitcnt lgkmcnt(5)
    v_smfmac_f32_16x16x64_bf16 v[72:75], v[32:35], a[16:23], v5
    v_smfmac_f32_16x16x64_bf16 v[76:79], v[32:35], a[96:103], v5
    s_waitcnt lgkmcnt(4)
    v_smfmac_f32_16x16x64_bf16 v[72:75], v[36:39], a[24:31], v5
    v_smfmac_f32_16x16x64_bf16 v[76:79], v[36:39], a[104:111], v5
    s_waitcnt lgkmcnt(3)
    v_smfmac_f32_16x16x64_bf16 v[72:75], v[40:43], a[32:39], v5
    v_smfmac_f32_16x16x64_bf16 v[76:79], v[40:43], a[112:119], v5
    s_waitcnt lgkmcnt(2)
    v_smfmac_f32_16x16x64_bf16 v[72:75], v[44:47], a[40:47], v5
    v_smfmac_f32_16x16x64_bf16 v[76:79], v[44:47], a[120:127], v5
    s_waitcnt lgkmcnt(1)
    v_smfmac_f32_16x16x64_bf16 v[72:75], v[48:51], a[64:71], v5
    buffer_store_dword v59, v14, s[8:11], s44 offen offset:0 sc1
    v_smfmac_f32_16x16x64_bf16 v[76:79], v[48:51], a[144:151], v5
    s_waitcnt lgkmcnt(0)
    v_smfmac_f32_16x16x64_bf16 v[72:75], v[52:55], a[72:79], v5
    v_smfmac_f32_16x16x64_bf16 v[76:79], v[52:55], a[152:159], v5
    s_nop 7
    v_permlane32_swap_b32 v72, v76
    v_permlane32_swap_b32 v73, v77
    v_permlane32_swap_b32 v74, v78
    v_permlane32_swap_b32 v75, v79
    v_pk_add_f32 v[72:73], v[72:73], v[76:77]
    v_pk_add_f32 v[74:75], v[74:75], v[78:79]
    v_cvt_pk_bf16_f32 v94, v72, v73
    v_cvt_pk_bf16_f32 v95, v74, v75
    ds_write_b64 v7, v[94:95]
    s_waitcnt lgkmcnt(0)
    s_barrier
    ds_read_b64_tr_b16 v[112:113], v6 offset:16
    ds_read_b64_tr_b16 v[114:115], v6 offset:656
    ds_read_b64_tr_b16 v[116:117], v6 offset:1296
    ds_read_b64_tr_b16 v[118:119], v6 offset:1936
    s_waitcnt lgkmcnt(2)
    v_mfma_f32_16x16x32_bf16 v[128:131], v[112:115], v[96:99], 0
    v_mfma_f32_16x16x32_bf16 v[132:135], v[112:115], v[104:107], 0
    s_waitcnt lgkmcnt(0)
    v_mfma_f32_16x16x32_bf16 v[128:131], v[116:119], v[100:103], v[128:131]
    v_mfma_f32_16x16x32_bf16 v[132:135], v[116:119], v[108:111], v[132:135]
    s_nop 7
    s_mov_b32 exec_lo, 0
    v_mov_b32 v128, v132
    v_mov_b32 v129, v133
    v_mov_b32 v130, v134
    v_mov_b32 v131, v135
    s_mov_b32 exec_lo, -1
    buffer_store_dwordx4 v[128:131], v2, s[8:11], s34 offen offset:0 sc1
Ss_qj:
    s_cmp_lt_u32 s21, 64
    s_cbranch_scc0 Ss_end
    s_cmp_eq_u32 s32, 14
    s_cbranch_scc0 Ss_h
    s_mov_b32 s31, 0
    s_waitcnt vmcnt(63)
    s_branch SsB1_c
SsB1_l:
    buffer_load_dword v68, v67, s[8:11], s23 offen sc1
    s_waitcnt vmcnt(0)
SsB1_c:
    v_cmp_gt_u32 vcc, 1, v68
    s_cbranch_vccz SsB1_o
    s_sleep 4
    s_add_u32 s31, s31, 1
    s_cmp_lt_u32 s31, s30
    s_cbranch_scc1 SsB1_l
    s_mov_b32 s30, 1
SsB1_o:
    s_mov_b32 s31, 0
    s_waitcnt vmcnt(63)
    s_branch SsB2_c
SsB2_l:
    buffer_load_dword v69, v67, s[8:11], s47 offen sc1
    s_waitcnt vmcnt(0)
SsB2_c:
    v_cmp_gt_u32 vcc, 1, v69
    s_cbranch_vccz SsB2_o
    s_sleep 4
    s_add_u32 s31, s31, 1
    s_cmp_lt_u32 s31, s30
    s_cbranch_scc1 SsB2_l
    s_mov_b32 s30, 1
SsB2_o:
Ss_h:
    v_add_u32 v11, s29, v2
    s_xor_b32 s29, s29, 40960
    s_add_u32 s42, s29, s27
    ds_read_b128 a[160:163], v11 offset:0
    ds_read_b128 a[164:167], v11 offset:20480
    ds_read_b128 a[168:171], v11 offset:1024
    ds_read_b128 a[172:175], v11 offset:21504
    ds_read_b128 a[176:179], v11 offset:2048
    ds_read_b128 a[180:183], v11 offset:22528
    s_waitcnt lgkmcnt(5)
    v_mfma_f32_16x16x32_bf16 v[144:147], a[0:3], a[160:163], 0
    ds_read_b128 a[184:187], v11 offset:3072
    v_mfma_f32_16x16x32_bf16 v[152:155], a[80:83], a[160:163], 0
    s_waitcnt lgkmcnt(5)
    v_mfma_f32_16x16x32_bf16 v[148:151], a[0:3], a[164:167], 0
    ds_read_b128 a[188:191], v11 offset:23552
    v_mfma_f32_16x16x32_bf16 v[156:159], a[80:83], a[164:167], 0
    s_waitcnt lgkmcnt(5)
    v_mfma_f32_16x16x32_bf16 v[144:147], a[4:7], a[168:171], v[144:147]
    ds_read_b128 a[160:163], v11 offset:4096
    s_add_u32 s35, s28, 0
    s_add_u32 m0, s42, 0
    v_mfma_f32_16x16x32_bf16 v[152:155], a[84:87], a[168:171], v[152:155]
    buffer_load_dwordx4 v2, s[8:11], s35 offen offset:0 sc1 lds
    s_waitcnt lgkmcnt(5)
    v_mfma_f32_16x16x32_bf16 v[148:151], a[4:7], a[172:175], v[148:151]
    ds_read_b128 a[164:167], v11 offset:24576
    v_mfma_f32_16x16x32_bf16 v[156:159], a[84:87], a[172:175], v[156:159]
    s_waitcnt lgkmcnt(5)
    v_mfma_f32_16x16x32_bf16 v[144:147], a[8:11], a[176:179], v[144:147]
    ds_read_b128 a[168:171], v11 offset:5120
    v_mfma_f32_16x16x32_bf16 v[152:155], a[88:91], a[176:179], v[152:155]
    s_waitcnt lgkmcnt(5)
    v_mfma_f32_16x16x32_bf16 v[148:151], a[8:11], a[180:183], v[148:151]
    ds_read_b128 a[172:175], v11 offset:25600
    v_mfma_f32_16x16x32_bf16 v[156:159], a[88:91], a[180:183], v[156:159]
    buffer_load_dwordx4 v2, s[8:11], s35 offen offset:1024 sc1 lds
    s_waitcnt lgkmcnt(5)
    v_mfma_f32_16x16x32_bf16 v[144:147], a[12:15], a[184:187], v[144:147]
    ds_read_b128 a[176:179], v11 offset:6144
    v_mfma_f32_16x16x32_bf16 v[152:155], a[92:95], a[184:187], v[152:155]
    s_waitcnt lgkmcnt(5)
    v_mfma_f32_16x16x32_bf16 v[148:151], a[12:15], a[188:191], v[148:151]
    ds_read_b128 a[180:183], v11 offset:26624
    v_mfma_f32_16x16x32_bf16 v[156:159], a[92:95], a[188:191], v[156:159]
    s_waitcnt vmcnt(2)
    v_mov_b32 v10, s21
    s_mov_b64 exec, 1
    buffer_store_dword v10, v9, s[8:11], s33 offen sc1
    s_mov_b64 exec, -1
    s_waitcnt lgkmcnt(5)
    v_mfma_f32_16x16x32_bf16 v[144:147], a[16:19], a[160:163], v[144:147]
    ds_read_b128 a[184:187], v11 offset:7168
    v_mfma_f32_16x16x32_bf16 v[152:155], a[96:99], a[160:163], v[152:155]
    buffer_load_dwordx4 v2, s[8:11], s35 offen offset:2048 sc1 lds
    s_waitcnt lgkmcnt(5)
    v_mfma_f32_16x16x32_bf16 v[148:151], a[16:19], a[164:167], v[148:151]
    ds_read_b128 a[188:191], v11 offset:27648
    v_mfma_f32_16x16x32_bf16 v[156:159], a[96:99], a[164:167], v[156:159]
    buffer_store_dwordx4 v[240:243], v64, s[8:11], s26 offen offset:0 sc1
    s_waitcnt lgkmcnt(5)
    v_mfma_f32_16x16x32_bf16 v[144:147], a[20:23], a[168:171], v[144:147]
    ds_read_b128 a[160:163], v11 offset:8192
    v_mfma_f32_16x16x32_bf16 v[152:155], a[100:103], a[168:171], v[152:155]
    buffer_store_dword v240, v65, s[8:11], s26 offen offset:0 sc1
    s_waitcnt lgkmcnt(5)
    v_mfma_f32_16x16x32_bf16 v[148:151], a[20:23], a[172:175], v[148:151]
    ds_read_b128 a[164:167], v11 offset:28672
    v_mfma_f32_16x16x32_bf16 v[156:159], a[100:103], a[172:175], v[156:159]
    buffer_load_dwordx4 v2, s[8:11], s35 offen offset:3072 sc1 lds
    s_waitcnt lgkmcnt(5)
    v_mfma_f32_16x16x32_bf16 v[144:147], a[24:27], a[176:179], v[144:147]
    ds_read_b128 a[168:171], v11 offset:9216
    v_mfma_f32_16x16x32_bf16 v[152:155], a[104:107], a[176:179], v[152:155]
    s_waitcnt lgkmcnt(5)
    v_mfma_f32_16x16x32_bf16 v[148:151], a[24:27], a[180:183], v[148:151]
    ds_read_b128 a[172:175], v11 offset:29696
    v_mfma_f32_16x16x32_bf16 v[156:159], a[104:107], a[180:183], v[156:159]
    s_waitcnt lgkmcnt(5)
    v_mfma_f32_16x16x32_bf16 v[144:147], a[28:31], a[184:187], v[144:147]
    ds_read_b128 a[176:179], v11 offset:10240
    s_add_u32 s35, s28, 4096
    s_add_u32 m0, s42, 4096
    v_mfma_f32_16x16x32_bf16 v[152:155], a[108:111], a[184:187], v[152:155]
    buffer_load_dwordx4 v2, s[8:11], s35 offen offset:0 sc1 lds
    s_waitcnt lgkmcnt(5)
    v_mfma_f32_16x16x32_bf16 v[148:151], a[28:31], a[188:191], v[148:151]
    ds_read_b128 a[180:183], v11 offset:30720
    v_mfma_f32_16x16x32_bf16 v[156:159], a[108:111], a[188:191], v[156:159]
    s_waitcnt lgkmcnt(5)
    v_mfma_f32_16x16x32_bf16 v[144:147], a[32:35], a[160:163], v[144:147]
    ds_read_b128 a[184:187], v11 offset:11264
    v_mfma_f32_16x16x32_bf16 v[152:155], a[112:115], a[160:163], v[152:155]
    s_waitcnt lgkmcnt(5)
    v_mfma_f32_16x16x32_bf16 v[148:151], a[32:35], a[164:167], v[148:151]
    ds_read_b128 a[188:191], v11 offset:31744
    v_mfma_f32_16x16x32_bf16 v[156:159], a[112:115], a[164:167], v[156:159]
    buffer_load_dwordx4 v2, s[8:11], s35 offen offset:1024 sc1 lds
    s_waitcnt lgkmcnt(5)
    v_mfma_f32_16x16x32_bf16 v[144:147], a[36:39], a[168:171], v[144:147]
    ds_read_b128 a[160:163], v11 offset:12288
    v_mfma_f32_16x16x32_bf16 v[152:155], a[116:119], a[168:171], v[152:155]
    s_sub_u32 s4, s21, 8
    s_cmp_lt_u32 s4, s45
    s_cselect_b64 exec, -1, 0
    s_lshl_b32 s4, s21, 19
    s_add_u32 s4, s4, s46
    buffer_store_dwordx4 v[240:243], v2, s[8:11], s4 offen offset:0 sc1
    s_mov_b64 exec, -1
    s_waitcnt lgkmcnt(5)
    v_mfma_f32_16x16x32_bf16 v[148:151], a[36:39], a[172:175], v[148:151]
    ds_read_b128 a[164:167], v11 offset:32768
    v_mfma_f32_16x16x32_bf16 v[156:159], a[116:119], a[172:175], v[156:159]
    s_cmp_eq_u32 s21, s88
    s_cselect_b64 exec, -1, 0
    buffer_store_dwordx4 v[240:243], v2, s[8:11], s89 offen offset:0 sc1
    s_mov_b64 exec, -1
    s_waitcnt lgkmcnt(5)
    v_mfma_f32_16x16x32_bf16 v[144:147], a[40:43], a[176:179], v[144:147]
    ds_read_b128 a[168:171], v11 offset:13312
    v_mfma_f32_16x16x32_bf16 v[152:155], a[120:123], a[176:179], v[152:155]
    buffer_load_dwordx4 v2, s[8:11], s35 offen offset:2048 sc1 lds
    s_waitcnt lgkmcnt(5)
    v_mfma_f32_16x16x32_bf16 v[148:151], a[40:43], a[180:183], v[148:151]
    ds_read_b128 a[172:175], v11 offset:33792
    v_mfma_f32_16x16x32_bf16 v[156:159], a[120:123], a[180:183], v[156:159]
    s_waitcnt lgkmcnt(5)
    v_mfma_f32_16x16x32_bf16 v[144:147], a[44:47], a[184:187], v[144:147]
    ds_read_b128 a[176:179], v11 offset:14336
    v_mfma_f32_16x16x32_bf16 v[152:155], a[124:127], a[184:187], v[152:155]
    s_waitcnt lgkmcnt(5)
    v_mfma_f32_16x16x32_bf16 v[148:151], a[44:47], a[188:191], v[148:151]
    ds_read_b128 a[180:183], v11 offset:34816
    v_mfma_f32_16x16x32_bf16 v[156:159], a[124:127], a[188:191], v[156:159]
    buffer_load_dwordx4 v2, s[8:11], s35 offen offset:3072 sc1 lds
    s_waitcnt lgkmcnt(5)
    v_mfma_f32_16x16x32_bf16 v[144:147], a[48:51], a[160:163], v[144:147]
    ds_read_b128 a[184:187], v11 offset:15360
    v_mfma_f32_16x16x32_bf16 v[152:155], a[128:131], a[160:163], v[152:155]
    s_waitcnt lgkmcnt(5)
    v_mfma_f32_16x16x32_bf16 v[148:151], a[48:51], a[164:167], v[148:151]
    ds_read_b128 a[188:191], v11 offset:35840
    v_mfma_f32_16x16x32_bf16 v[156:159], a[128:131], a[164:167], v[156:159]
    s_waitcnt lgkmcnt(5)
    v_mfma_f32_16x16x32_bf16 v[144:147], a[52:55], a[168:171], v[144:147]
    ds_read_b128 a[160:163], v11 offset:16384
    s_add_u32 s35, s28, 8192
    s_add_u32 m0, s42, 8192
    v_mfma_f32_16x16x32_bf16 v[152:155], a[132:135], a[168:171], v[152:155]
    buffer_load_dwordx4 v2, s[8:11], s35 offen offset:0 sc1 lds
    s_waitcnt lgkmcnt(5)
    v_mfma_f32_16x16x32_bf16 v[148:151], a[52:55], a[172:175], v[148:151]
    ds_read_b128 a[164:167], v11 offset:36864
    v_mfma_f32_16x16x32_bf16 v[156:159], a[132:135], a[172:175], v[156:159]
    s_waitcnt lgkmcnt(5)
    v_mfma_f32_16x16x32_bf16 v[144:147], a[56:59], a[176:179], v[144:147]
    ds_read_b128 a[168:171], v11 offset:17408
    v_mfma_f32_16x16x32_bf16 v[152:155], a[136:139], a[176:179], v[152:155]
    s_waitcnt lgkmcnt(5)
    v_mfma_f32_16x16x32_bf16 v[148:151], a[56:59], a[180:183], v[148:151]
    ds_read_b128 a[172:175], v11 offset:37888
    v_mfma_f32_16x16x32_bf16 v[156:159], a[136:139], a[180:183], v[156:159]
    buffer_load_dwordx4 v2, s[8:11], s35 offen offset:1024 sc1 lds
    s_waitcnt lgkmcnt(5)
    v_mfma_f32_16x16x32_bf16 v[144:147], a[60:63], a[184:187], v[144:147]
    ds_read_b128 a[176:179], v11 offset:18432
    v_mfma_f32_16x16x32_bf16 v[152:155], a[140:143], a[184:187], v[152:155]
    s_waitcnt lgkmcnt(5)
    v_mfma_f32_16x16x32_bf16 v[148:151], a[60:63], a[188:191], v[148:151]
    ds_read_b128 a[180:183], v11 offset:38912
    v_mfma_f32_16x16x32_bf16 v[156:159], a[140:143], a[188:191], v[156:159]
    s_waitcnt lgkmcnt(5)
    v_mfma_f32_16x16x32_bf16 v[144:147], a[64:67], a[160:163], v[144:147]
    ds_read_b128 a[184:187], v11 offset:19456
    v_mfma_f32_16x16x32_bf16 v[152:155], a[144:147], a[160:163], v[152:155]
    s_waitcnt lgkmcnt(5)
    v_mfma_f32_16x16x32_bf16 v[148:151], a[64:67], a[164:167], v[148:151]
    ds_read_b128 a[188:191], v11 offset:39936
    v_mfma_f32_16x16x32_bf16 v[156:159], a[144:147], a[164:167], v[156:159]
    s_waitcnt lgkmcnt(5)
    v_mfma_f32_16x16x32_bf16 v[144:147], a[68:71], a[168:171], v[144:147]
    v_mfma_f32_16x16x32_bf16 v[152:155], a[148:151], a[168:171], v[152:155]
    s_waitcnt lgkmcnt(4)
    v_mfma_f32_16x16x32_bf16 v[148:151], a[68:71], a[172:175], v[148:151]
    v_mfma_f32_16x16x32_bf16 v[156:159], a[148:151], a[172:175], v[156:159]
    s_waitcnt lgkmcnt(3)
    v_mfma_f32_16x16x32_bf16 v[144:147], a[72:75], a[176:179], v[144:147]
    v_mfma_f32_16x16x32_bf16 v[152:155], a[152:155], a[176:179], v[152:155]
    s_waitcnt lgkmcnt(2)
    v_mfma_f32_16x16x32_bf16 v[148:151], a[72:75], a[180:183], v[148:151]
    v_mfma_f32_16x16x32_bf16 v[156:159], a[152:155], a[180:183], v[156:159]
    s_waitcnt lgkmcnt(1)
    v_mfma_f32_16x16x32_bf16 v[144:147], a[76:79], a[184:187], v[144:147]
    v_mfma_f32_16x16x32_bf16 v[152:155], a[156:159], a[184:187], v[152:155]
    s_waitcnt lgkmcnt(0)
    v_mfma_f32_16x16x32_bf16 v[148:151], a[76:79], a[188:191], v[148:151]
    v_mfma_f32_16x16x32_bf16 v[156:159], a[156:159], a[188:191], v[156:159]
    s_add_u32 s28, s28, 40960
    s_add_u32 s32, s32, 1
    s_cmp_eq_u32 s32, 12
    s_cbranch_scc0 Ss_n12
    buffer_load_dword v68, v67, s[8:11], s23 offen offset:0 sc1
    buffer_load_dword v69, v67, s[8:11], s47 offen offset:0 sc1
Ss_n12:
    v_cvt_pk_bf16_f32 v160, v144, v145
    v_cvt_pk_bf16_f32 v161, v146, v147
    ds_write_b64 v12, v[160:161] offset:0
    v_cvt_pk_bf16_f32 v162, v148, v149
    v_cvt_pk_bf16_f32 v163, v150, v151
    ds_write_b64 v12, v[162:163] offset:2048
    v_cvt_pk_bf16_f32 v164, v152, v153
    v_cvt_pk_bf16_f32 v165, v154, v155
    ds_write_b64 v12, v[164:165] offset:4096
    v_cvt_pk_bf16_f32 v166, v156, v157
    v_cvt_pk_bf16_f32 v167, v158, v159
    ds_write_b64 v12, v[166:167] offset:6144
    s_and_b32 s4, s21, 3
    s_lshl_b32 s4, s4, 16
    s_add_u32 s34, s36, s4
    s_waitcnt lgkmcnt(0)
    s_barrier
    ds_read_b128 v[96:99], v15 offset:0
    ds_read_b128 v[104:107], v62 offset:0
    ds_read_b128 v[100:103], v15 offset:1024
    ds_read_b128 v[108:111], v62 offset:1024
    s_waitcnt lgkmcnt(2)
    v_mfma_f32_16x16x32_bf16 v[128:131], v[96:99], v[104:107], 0
    s_waitcnt lgkmcnt(0)
    v_mfma_f32_16x16x32_bf16 v[128:131], v[100:103], v[108:111], v[128:131]
    s_nop 7
    buffer_store_dwordx4 v[128:131], v63, s[8:11], s34 offen offset:0 sc1
    s_branch Ss_loop
Ss_end:
    s_waitcnt vmcnt(0)
    v_mov_b32 v10, s21
    s_mov_b64 exec, 1
    buffer_store_dword v10, v9, s[8:11], s33 offen sc1
    s_mov_b64 exec, -1
    s_branch R_done
R_v:
    v_lshlrev_b32 v2, 4, v1
    s_load_dwordx2 s[12:13], s[0:1], 32
    s_load_dwordx2 s[16:17], s[0:1], 32
    s_mov_b32 s14, 7864320
    s_mov_b32 s15, 0x20000
    s_mov_b32 s18, 7864320
    s_mov_b32 s19, 0x20000
    s_waitcnt lgkmcnt(0)
    s_mul_i32 s42, s99, 6
    s_add_u32 s42, s42, s20
    s_sub_u32 s42, s42, 12
    s_lshl_b32 s42, s42, 8
    s_add_u32 s47, s42, 128
    s_lshl_b32 s37, s3, 11
    s_lshl_b32 s4, s3, 4
    s_and_b32 s5, s3, 1
    s_lshl_b32 s5, s5, 1
    v_lshrrev_b32 v60, 3, v1
    v_and_b32 v61, 1, v60
    v_or_b32 v61, s5, v61
    v_add_u32 v60, s4, v60
    v_mul_u32_u24 v13, 12288, v60
    v_bfe_u32 v60, v1, 1, 2
    v_xor_b32 v60, v60, v61
    v_lshlrev_b32 v60, 5, v60
    v_and_b32 v61, 1, v1
    v_lshlrev_b32 v61, 4, v61
    v_add3_u32 v13, v13, v60, v61
    v_lshrrev_b32 v60, 4, v1
    v_lshlrev_b32 v60, 2, v60
    v_bfe_u32 v61, v1, 2, 1
    v_add_u32 v60, v60, v61
    v_bfe_u32 v61, v1, 3, 1
    v_lshlrev_b32 v61, 4, v61
    v_add_u32 v60, v60, v61
    v_lshlrev_b32 v0, 7, v60
    v_bfe_u32 v60, v1, 2, 2
    v_lshlrev_b32 v60, 5, v60
    v_and_b32 v61, 3, v1
    v_lshlrev_b32 v61, 3, v61
    v_add3_u32 v0, v0, v60, v61
    v_mov_b32 v134, 163776
    s_cmp_lg_u32 s3, 0
    s_cbranch_scc1 VC_c
    s_waitcnt vmcnt(0)
    v_readfirstlane_b32 s4, v135
    s_and_b32 s4, s4, s33
    s_nop 0
    v_mov_b32 v135, s4
    ds_write_b32 v134, v135
    s_waitcnt lgkmcnt(0)
VC_c:
    s_barrier
    ds_read_b32 v135, v134
    s_waitcnt lgkmcnt(0)
    v_readfirstlane_b32 s4, v135
    s_cmp_lg_u32 s4, 0
    s_cbranch_scc1 R_ovf
    s_load_dwordx2 s[84:85], s[0:1], 120
    s_mov_b32 s86, 256
    s_mov_b32 s87, 0x20000
    s_waitcnt lgkmcnt(0)
    s_mul_i32 s22, s99, 1048576
    s_add_u32 s22, s22, 8388608
    s_lshl_b32 s33, s20, 4
    s_lshl_b32 s4, s3, 2
    s_add_u32 s33, s33, s4
    s_add_u32 s33, s33, s22
    s_add_u32 s33, s33, 155648
    s_mov_b32 s48, 0xfffffffe
    v_mov_b32 v9, 0
    v_mov_b32 v240, -1
    v_mov_b32 v241, -1
    v_mov_b32 v242, -1
    v_mov_b32 v243, -1
    v_and_b32 v16, 8, v1
    v_mov_b32 v5, 0x4444
    v_mov_b32 v17, 0xeeee
    v_cmp_ne_u32 vcc, 0, v16
    s_nop 1
    v_cndmask_b32 v5, v5, v17, vcc
    s_sub_u32 s4, s20, 12
    s_lshl_b32 s4, s4, 2
    s_add_u32 s4, s4, s3
    s_lshl_b32 s5, s4, 9
    v_lshrrev_b32 v16, 5, v1
    v_lshlrev_b32 v6, 8, v16
    v_and_b32 v16, 15, v1
    v_lshl_add_u32 v6, v16, 4, v6
    v_bfe_u32 v16, v1, 4, 1
    v_lshl_add_u32 v6, v16, 3, v6
    v_add_u32 v6, s5, v6
    s_mul_i32 s5, s4, 43
    s_lshr_b32 s5, s5, 8
    s_mul_i32 s5, s5, 6
    s_add_u32 s4, s4, s5
    s_lshl_b32 s43, s4, 10
    s_add_u32 s43, s43, s22
    s_add_u32 s43, s43, 159744
    s_add_u32 s24, s22, 106496
    s_add_u32 s5, s24, 12288
    buffer_store_dwordx2 v[240:241], v6, s[8:11], s24 offen offset:0 sc1
    buffer_store_dwordx2 v[240:241], v6, s[8:11], s5 offen offset:0 sc1
    s_sub_u32 s4, s20, 12
    s_lshl_b32 s4, s4, 2
    s_add_u32 s4, s4, s3
    s_mul_i32 s5, s4, 43
    s_lshr_b32 s5, s5, 8
    s_mul_i32 s5, s5, 58
    s_add_u32 s4, s4, s5
    s_lshl_b32 s4, s4, 2
    s_add_u32 s44, s4, s22
    s_add_u32 s44, s44, 156672
    v_mov_b32 v14, 0x80000000
    v_writelane_b32 v14, 0, 0
    buffer_store_dword v9, v14, s[8:11], s44 offen offset:0 sc1
    v_mov_b32 v10, 0
    s_mov_b64 exec, 1
    buffer_store_dword v10, v9, s[8:11], s33 offen sc1
    s_mov_b64 exec, -1
    v_and_b32 v16, 15, v1
    v_lshrrev_b32 v17, 4, v1
    v_and_b32 v18, 1, v17
    v_lshlrev_b32 v18, 2, v18
    v_sub_u32 v18, v16, v18
    v_mov_b32 v19, 0x3f80
    v_mov_b32 v20, 0x3f800000
    v_cmp_eq_u32 vcc, 0, v18
    s_nop 1
    v_cndmask_b32 v84, 0, v19, vcc
    v_cmp_eq_u32 vcc, 1, v18
    s_nop 1
    v_cndmask_b32 v84, v84, v20, vcc
    v_cmp_eq_u32 vcc, 2, v18
    s_nop 1
    v_cndmask_b32 v85, 0, v19, vcc
    v_cmp_eq_u32 vcc, 3, v18
    s_nop 1
    v_cndmask_b32 v85, v85, v20, vcc
    v_cmp_eq_u32 vcc, 8, v18
    s_nop 1
    v_cndmask_b32 v86, 0, v19, vcc
    v_cmp_eq_u32 vcc, 9, v18
    s_nop 1
    v_cndmask_b32 v86, v86, v20, vcc
    v_cmp_eq_u32 vcc, 10, v18
    s_nop 1
    v_cndmask_b32 v87, 0, v19, vcc
    v_cmp_eq_u32 vcc, 11, v18
    s_nop 1
    v_cndmask_b32 v87, v87, v20, vcc
    s_lshl_b32 s4, s3, 11
    s_add_u32 s4, s4, 73728
    v_add_u32 v3, s4, v2
    s_lshl_b32 s4, s3, 9
    s_add_u32 s4, s4, 90112
    v_lshl_add_u32 v4, v1, 3, s4
    s_waitcnt vmcnt(0)
    s_barrier
    s_cmp_lg_u32 s3, 0
    s_cbranch_scc1 VA_n
    s_lshl_b32 s4, s99, 5
    s_add_u32 s4, s4, 4
    v_mov_b32 v16, 0
    v_mov_b32 v17, 1
    s_mov_b64 exec, 1
    buffer_atomic_add v17, v16, s[84:87], s4 offen sc1
    s_mov_b64 exec, -1
VA_n:
    s_add_u32 s4, s42, 0
    s_add_u32 m0, s37, 0
    s_nop 0
    buffer_load_dwordx4 v13, s[12:15], s4 offen nt lds
    s_add_u32 s4, s42, 98304
    s_add_u32 m0, s37, 1024
    s_nop 0
    buffer_load_dwordx4 v13, s[12:15], s4 offen nt lds
    s_waitcnt vmcnt(2)
    s_add_u32 s4, s47, 0
    s_add_u32 m0, s37, 81920
    s_nop 0
    buffer_load_dwordx4 v13, s[16:19], s4 offen nt lds
    s_add_u32 s4, s47, 98304
    s_add_u32 m0, s37, 82944
    s_nop 0
    buffer_load_dwordx4 v13, s[16:19], s4 offen nt lds
    s_waitcnt vmcnt(2)
    s_add_u32 s4, s42, 786432
    s_add_u32 m0, s37, 8192
    s_nop 0
    buffer_load_dwordx4 v13, s[12:15], s4 offen nt lds
    s_add_u32 s4, s42, 884736
    s_add_u32 m0, s37, 9216
    s_nop 0
    buffer_load_dwordx4 v13, s[12:15], s4 offen nt lds
    s_waitcnt vmcnt(2)
    s_add_u32 s4, s47, 786432
    s_add_u32 m0, s37, 90112
    s_nop 0
    buffer_load_dwordx4 v13, s[16:19], s4 offen nt lds
    s_add_u32 s4, s47, 884736
    s_add_u32 m0, s37, 91136
    s_nop 0
    buffer_load_dwordx4 v13, s[16:19], s4 offen nt lds
    s_waitcnt vmcnt(2)
    s_add_u32 s4, s42, 1572864
    s_add_u32 m0, s37, 16384
    s_nop 0
    buffer_load_dwordx4 v13, s[12:15], s4 offen nt lds
    s_add_u32 s4, s42, 1671168
    s_add_u32 m0, s37, 17408
    s_nop 0
    buffer_load_dwordx4 v13, s[12:15], s4 offen nt lds
    s_waitcnt vmcnt(2)
    s_add_u32 s4, s47, 1572864
    s_add_u32 m0, s37, 98304
    s_nop 0
    buffer_load_dwordx4 v13, s[16:19], s4 offen nt lds
    s_add_u32 s4, s47, 1671168
    s_add_u32 m0, s37, 99328
    s_nop 0
    buffer_load_dwordx4 v13, s[16:19], s4 offen nt lds
    s_waitcnt vmcnt(2)
    s_add_u32 s4, s42, 2359296
    s_add_u32 m0, s37, 24576
    s_nop 0
    buffer_load_dwordx4 v13, s[12:15], s4 offen nt lds
    s_add_u32 s4, s42, 2457600
    s_add_u32 m0, s37, 25600
    s_nop 0
    buffer_load_dwordx4 v13, s[12:15], s4 offen nt lds
    s_waitcnt vmcnt(2)
    s_add_u32 s4, s47, 2359296
    s_add_u32 m0, s37, 106496
    s_nop 0
    buffer_load_dwordx4 v13, s[16:19], s4 offen nt lds
    s_add_u32 s4, s47, 2457600
    s_add_u32 m0, s37, 107520
    s_nop 0
    buffer_load_dwordx4 v13, s[16:19], s4 offen nt lds
    s_waitcnt vmcnt(2)
    s_add_u32 s4, s42, 3145728
    s_add_u32 m0, s37, 32768
    s_nop 0
    buffer_load_dwordx4 v13, s[12:15], s4 offen nt lds
    s_add_u32 s4, s42, 3244032
    s_add_u32 m0, s37, 33792
    s_nop 0
    buffer_load_dwordx4 v13, s[12:15], s4 offen nt lds
    s_waitcnt vmcnt(2)
    s_add_u32 s4, s47, 3145728
    s_add_u32 m0, s37, 114688
    s_nop 0
    buffer_load_dwordx4 v13, s[16:19], s4 offen nt lds
    s_add_u32 s4, s47, 3244032
    s_add_u32 m0, s37, 115712
    s_nop 0
    buffer_load_dwordx4 v13, s[16:19], s4 offen nt lds
    s_waitcnt vmcnt(2)
    v_and_b32 v16, 7, v1
    v_lshlrev_b32 v16, 5, v16
    buffer_load_dwordx4 v[20:23], v16, s[84:87], 0 offen sc1
    s_add_u32 s4, s42, 3932160
    s_add_u32 m0, s37, 40960
    s_nop 0
    buffer_load_dwordx4 v13, s[12:15], s4 offen nt lds
    s_add_u32 s4, s42, 4030464
    s_add_u32 m0, s37, 41984
    s_nop 0
    buffer_load_dwordx4 v13, s[12:15], s4 offen nt lds
    s_add_u32 s4, s47, 3932160
    s_add_u32 m0, s37, 122880
    s_nop 0
    buffer_load_dwordx4 v13, s[16:19], s4 offen nt lds
    s_add_u32 s4, s47, 4030464
    s_add_u32 m0, s37, 123904
    s_nop 0
    buffer_load_dwordx4 v13, s[16:19], s4 offen nt lds
    s_add_u32 s4, s42, 4718592
    s_add_u32 m0, s37, 49152
    s_nop 0
    buffer_load_dwordx4 v13, s[12:15], s4 offen nt lds
    s_add_u32 s4, s42, 4816896
    s_add_u32 m0, s37, 50176
    s_nop 0
    buffer_load_dwordx4 v13, s[12:15], s4 offen nt lds
    s_add_u32 s4, s47, 4718592
    s_add_u32 m0, s37, 131072
    s_nop 0
    buffer_load_dwordx4 v13, s[16:19], s4 offen nt lds
    s_add_u32 s4, s47, 4816896
    s_add_u32 m0, s37, 132096
    s_nop 0
    buffer_load_dwordx4 v13, s[16:19], s4 offen nt lds
    s_add_u32 s4, s42, 5505024
    s_add_u32 m0, s37, 57344
    s_nop 0
    buffer_load_dwordx4 v13, s[12:15], s4 offen nt lds
    s_add_u32 s4, s42, 5603328
    s_add_u32 m0, s37, 58368
    s_nop 0
    buffer_load_dwordx4 v13, s[12:15], s4 offen nt lds
    s_add_u32 s4, s47, 5505024
    s_add_u32 m0, s37, 139264
    s_nop 0
    buffer_load_dwordx4 v13, s[16:19], s4 offen nt lds
    s_add_u32 s4, s47, 5603328
    s_add_u32 m0, s37, 140288
    s_nop 0
    buffer_load_dwordx4 v13, s[16:19], s4 offen nt lds
    s_add_u32 s4, s42, 6291456
    s_add_u32 m0, s37, 65536
    s_nop 0
    buffer_load_dwordx4 v13, s[12:15], s4 offen nt lds
    s_add_u32 s4, s42, 6389760
    s_add_u32 m0, s37, 66560
    s_nop 0
    buffer_load_dwordx4 v13, s[12:15], s4 offen nt lds
    s_add_u32 s4, s47, 6291456
    s_add_u32 m0, s37, 147456
    s_nop 0
    buffer_load_dwordx4 v13, s[16:19], s4 offen nt lds
    s_add_u32 s4, s47, 6389760
    s_add_u32 m0, s37, 148480
    s_nop 0
    buffer_load_dwordx4 v13, s[16:19], s4 offen nt lds
    s_mov_b32 s31, 0
    s_waitcnt vmcnt(16)
    s_branch VI_c
VI_l:
    buffer_load_dwordx4 v[20:23], v16, s[84:87], 0 offen sc1
    s_waitcnt vmcnt(0)
VI_c:
    v_bcnt_u32_b32 v17, v20, v23
    v_cmp_lt_u32 s[4:5], 32, v17
    s_and_b32 s6, s4, 0xff
    v_cmp_ne_u32 s[4:5], 32, v17
    s_cmp_eq_u32 s6, 0
    s_cselect_b32 s5, 0xff, 0
    s_and_b32 s4, s4, s5
    v_cmp_gt_u32 vcc, 22, v21
    s_and_b32 vcc_lo, vcc_lo, 0xff
    s_or_b32 vcc_lo, vcc_lo, s4
    s_mov_b32 vcc_hi, 0
    s_cbranch_vccz VI_o
    s_sleep 16
    s_add_u32 s31, s31, 1
    s_cmp_lt_u32 s31, s30
    s_cbranch_scc1 VI_l
    s_mov_b32 s30, 1
VI_o:
    s_mov_b32 s97, s6
    v_and_b32 v67, 3, v1
    v_lshlrev_b32 v67, 7, v67
    s_mov_b32 s23, 65536
    buffer_load_dword v68, v67, s[8:11], s23 offen offset:0 sc1
    s_add_u32 s4, s42, 7077888
    s_add_u32 m0, s37, 73728
    s_nop 0
    buffer_load_dwordx4 v13, s[12:15], s4 offen nt lds
    s_add_u32 s4, s42, 7176192
    s_add_u32 m0, s37, 74752
    s_nop 0
    buffer_load_dwordx4 v13, s[12:15], s4 offen nt lds
    s_add_u32 s4, s47, 7077888
    s_add_u32 m0, s37, 155648
    s_nop 0
    buffer_load_dwordx4 v13, s[16:19], s4 offen nt lds
    s_add_u32 s4, s47, 7176192
    s_add_u32 m0, s37, 156672
    s_nop 0
    buffer_load_dwordx4 v13, s[16:19], s4 offen nt lds
    s_barrier
    s_and_b32 s4, s3, 1
    s_lshl_b32 s4, s4, 6
    v_xor_b32 v60, s4, v0
    s_lshr_b32 s4, s3, 1
    s_mul_i32 s4, s4, 81920
    v_add_u32 v60, s4, v60
    v_xor_b32 v61, 32, v60
    ds_read_b64_tr_b16 a[0:1], v60 offset:0
    ds_read_b64_tr_b16 a[2:3], v60 offset:256
    ds_read_b64_tr_b16 a[4:5], v60 offset:4096
    ds_read_b64_tr_b16 a[6:7], v60 offset:4352
    ds_read_b64_tr_b16 a[8:9], v60 offset:8192
    ds_read_b64_tr_b16 a[10:11], v60 offset:8448
    ds_read_b64_tr_b16 a[12:13], v60 offset:12288
    ds_read_b64_tr_b16 a[14:15], v60 offset:12544
    ds_read_b64_tr_b16 a[16:17], v60 offset:16384
    ds_read_b64_tr_b16 a[18:19], v60 offset:16640
    ds_read_b64_tr_b16 a[20:21], v60 offset:20480
    ds_read_b64_tr_b16 a[22:23], v60 offset:20736
    ds_read_b64_tr_b16 a[24:25], v60 offset:24576
    ds_read_b64_tr_b16 a[26:27], v60 offset:24832
    ds_read_b64_tr_b16 a[28:29], v60 offset:28672
    ds_read_b64_tr_b16 a[30:31], v60 offset:28928
    ds_read_b64_tr_b16 a[32:33], v60 offset:32768
    ds_read_b64_tr_b16 a[34:35], v60 offset:33024
    ds_read_b64_tr_b16 a[36:37], v60 offset:36864
    ds_read_b64_tr_b16 a[38:39], v60 offset:37120
    ds_read_b64_tr_b16 a[80:81], v61 offset:0
    ds_read_b64_tr_b16 a[82:83], v61 offset:256
    ds_read_b64_tr_b16 a[84:85], v61 offset:4096
    ds_read_b64_tr_b16 a[86:87], v61 offset:4352
    ds_read_b64_tr_b16 a[88:89], v61 offset:8192
    ds_read_b64_tr_b16 a[90:91], v61 offset:8448
    ds_read_b64_tr_b16 a[92:93], v61 offset:12288
    ds_read_b64_tr_b16 a[94:95], v61 offset:12544
    ds_read_b64_tr_b16 a[96:97], v61 offset:16384
    ds_read_b64_tr_b16 a[98:99], v61 offset:16640
    ds_read_b64_tr_b16 a[100:101], v61 offset:20480
    ds_read_b64_tr_b16 a[102:103], v61 offset:20736
    ds_read_b64_tr_b16 a[104:105], v61 offset:24576
    ds_read_b64_tr_b16 a[106:107], v61 offset:24832
    ds_read_b64_tr_b16 a[108:109], v61 offset:28672
    ds_read_b64_tr_b16 a[110:111], v61 offset:28928
    ds_read_b64_tr_b16 a[112:113], v61 offset:32768
    ds_read_b64_tr_b16 a[114:115], v61 offset:33024
    ds_read_b64_tr_b16 a[116:117], v61 offset:36864
    ds_read_b64_tr_b16 a[118:119], v61 offset:37120
    v_and_b32 v7, 0xf0, v2
    v_lshrrev_b32 v16, 5, v1
    v_lshl_add_u32 v7, v16, 13, v7
    v_bfe_u32 v16, v1, 4, 1
    v_lshl_add_u32 v7, v16, 11, v7
    s_sub_u32 s4, s20, 12
    s_lshl_b32 s4, s4, 2
    s_add_u32 s4, s4, s3
    s_lshr_b32 s6, s4, 1
    s_lshl_b32 s6, s6, 14
    s_and_b32 s7, s4, 1
    s_lshl_b32 s7, s7, 12
    s_add_u32 s6, s6, s7
    s_lshl_b32 s7, s99, 8
    s_add_u32 s6, s6, s7
    s_add_u32 s36, s6, 2097152
    s_cmp_lt_u32 s4, 20
    s_cselect_b32 s4, 0, 0x80000000
    v_add_u32 v7, s4, v7
    s_mul_i32 s27, s3, 10240
    s_add_u32 s28, s27, 16777216
    s_mov_b32 s29, 0
    s_mov_b32 s21, 0
    s_mov_b32 s32, 0
    s_mov_b32 s31, 0
    s_waitcnt vmcnt(4)
    s_branch VH_c
VH_l:
    buffer_load_dword v68, v67, s[8:11], s23 offen sc1
    s_waitcnt vmcnt(0)
VH_c:
    v_cmp_gt_u32 vcc, 1, v68
    s_cbranch_vccz VH_o
    s_sleep 4
    s_add_u32 s31, s31, 1
    s_cmp_lt_u32 s31, s30
    s_cbranch_scc1 VH_l
    s_mov_b32 s30, 1
VH_o:
    s_waitcnt lgkmcnt(0)
    s_barrier
    v_and_b32 v16, 7, v1
    v_lshlrev_b32 v16, 5, v16
    buffer_load_dwordx4 v[20:23], v16, s[84:87], 0 offen sc1
    s_add_u32 s35, s28, 0
    s_add_u32 m0, s27, 0
    s_nop 0
    buffer_load_dwordx4 v2, s[8:11], s35 offen offset:0 sc1 lds
    buffer_load_dwordx4 v2, s[8:11], s35 offen offset:1024 sc1 lds
    buffer_load_dwordx4 v2, s[8:11], s35 offen offset:2048 sc1 lds
    buffer_load_dwordx4 v2, s[8:11], s35 offen offset:3072 sc1 lds
    s_add_u32 s35, s28, 4096
    s_add_u32 m0, s27, 4096
    s_nop 0
    buffer_load_dwordx4 v2, s[8:11], s35 offen offset:0 sc1 lds
    buffer_load_dwordx4 v2, s[8:11], s35 offen offset:1024 sc1 lds
    buffer_load_dwordx4 v2, s[8:11], s35 offen offset:2048 sc1 lds
    buffer_load_dwordx4 v2, s[8:11], s35 offen offset:3072 sc1 lds
    s_add_u32 s35, s28, 8192
    s_add_u32 m0, s27, 8192
    s_nop 0
    buffer_load_dwordx4 v2, s[8:11], s35 offen offset:0 sc1 lds
    buffer_load_dwordx4 v2, s[8:11], s35 offen offset:1024 sc1 lds
    s_waitcnt vmcnt(11)
    s_barrier
    ds_read_b64_tr_b16 a[40:41], v60 offset:40960
    ds_read_b64_tr_b16 a[42:43], v60 offset:41216
    ds_read_b64_tr_b16 a[44:45], v60 offset:45056
    ds_read_b64_tr_b16 a[46:47], v60 offset:45312
    ds_read_b64_tr_b16 a[48:49], v60 offset:49152
    ds_read_b64_tr_b16 a[50:51], v60 offset:49408
    ds_read_b64_tr_b16 a[52:53], v60 offset:53248
    ds_read_b64_tr_b16 a[54:55], v60 offset:53504
    ds_read_b64_tr_b16 a[56:57], v60 offset:57344
    ds_read_b64_tr_b16 a[58:59], v60 offset:57600
    ds_read_b64_tr_b16 a[60:61], v60 offset:61440
    ds_read_b64_tr_b16 a[62:63], v60 offset:61696
    v_add_u32 v60, 65536, v60
    ds_read_b64_tr_b16 a[64:65], v60 offset:0
    ds_read_b64_tr_b16 a[66:67], v60 offset:256
    ds_read_b64_tr_b16 a[68:69], v60 offset:4096
    ds_read_b64_tr_b16 a[70:71], v60 offset:4352
    ds_read_b64_tr_b16 a[72:73], v60 offset:8192
    ds_read_b64_tr_b16 a[74:75], v60 offset:8448
    ds_read_b64_tr_b16 a[76:77], v60 offset:12288
    ds_read_b64_tr_b16 a[78:79], v60 offset:12544
    ds_read_b64_tr_b16 a[120:121], v61 offset:40960
    ds_read_b64_tr_b16 a[122:123], v61 offset:41216
    ds_read_b64_tr_b16 a[124:125], v61 offset:45056
    ds_read_b64_tr_b16 a[126:127], v61 offset:45312
    ds_read_b64_tr_b16 a[128:129], v61 offset:49152
    ds_read_b64_tr_b16 a[130:131], v61 offset:49408
    ds_read_b64_tr_b16 a[132:133], v61 offset:53248
    ds_read_b64_tr_b16 a[134:135], v61 offset:53504
    ds_read_b64_tr_b16 a[136:137], v61 offset:57344
    ds_read_b64_tr_b16 a[138:139], v61 offset:57600
    ds_read_b64_tr_b16 a[140:141], v61 offset:61440
    ds_read_b64_tr_b16 a[142:143], v61 offset:61696
    v_add_u32 v61, 65536, v61
    ds_read_b64_tr_b16 a[144:145], v61 offset:0
    ds_read_b64_tr_b16 a[146:147], v61 offset:256
    ds_read_b64_tr_b16 a[148:149], v61 offset:4096
    ds_read_b64_tr_b16 a[150:151], v61 offset:4352
    ds_read_b64_tr_b16 a[152:153], v61 offset:8192
    ds_read_b64_tr_b16 a[154:155], v61 offset:8448
    ds_read_b64_tr_b16 a[156:157], v61 offset:12288
    ds_read_b64_tr_b16 a[158:159], v61 offset:12544
    s_mov_b32 s31, 0
    s_waitcnt vmcnt(10)
    s_branch VJ_c
VJ_l:
    buffer_load_dwordx4 v[20:23], v16, s[84:87], 0 offen sc1
    s_waitcnt vmcnt(0)
VJ_c:
    v_bcnt_u32_b32 v17, v20, v23
    v_cmp_lt_u32 s[4:5], 32, v17
    s_and_b32 s6, s4, 0xff
    v_cmp_ne_u32 s[4:5], 32, v17
    s_cmp_eq_u32 s6, 0
    s_cselect_b32 s5, 0xff, 0
    s_and_b32 s4, s4, s5
    v_add_u32 v21, v21, v22
    v_cmp_gt_u32 vcc, 32, v21
    s_and_b32 vcc_lo, vcc_lo, 0xff
    s_or_b32 vcc_lo, vcc_lo, s4
    s_mov_b32 vcc_hi, 0
    s_cbranch_vccz VJ_o
    s_sleep 16
    s_add_u32 s31, s31, 1
    s_cmp_lt_u32 s31, s30
    s_cbranch_scc1 VJ_l
    s_mov_b32 s30, 1
VJ_o:
    s_mov_b32 s97, s6
    v_min_u32 v67, 39, v1
    v_lshlrev_b32 v67, 7, v67
    v_min_u32 v70, 3968, v67
    s_mov_b32 s49, 65536
    s_mov_b32 s23, 69632
    s_mov_b32 s47, 74752
    s_waitcnt lgkmcnt(0)
    s_barrier
    s_add_u32 s28, s28, 40960
    s_cmp_lg_u32 s97, 0
    s_cbranch_scc1 Vs_go
Vf_go:
Vf_loop:
    s_and_b32 s4, s21, 3
    s_mul_i32 s5, s4, 10240
    s_add_u32 s5, s5, s22
    s_sub_u32 s38, s5, 73728
    s_sub_u32 s39, s5, 81920
    s_mul_i32 s5, s4, 12288
    s_add_u32 s25, s24, s5
    s_xor_b32 s4, s4, 2
    s_mul_i32 s5, s4, 163840
    s_add_u32 s34, s36, s5
    s_mul_i32 s5, s4, 12288
    s_add_u32 s26, s24, s5
    s_add_u32 s21, s21, 1
    v_mov_b32 v72, 0
    v_mov_b32 v73, 0
    v_mov_b32 v74, 0
    v_mov_b32 v75, 0
    v_mov_b32 v76, 0
    v_mov_b32 v77, 0
    v_mov_b32 v78, 0
    v_mov_b32 v79, 0
    v_mov_b32 v59, s21
    s_cmp_eq_u32 s3, 1
    s_cbranch_scc1 Vf_q1
    s_cmp_eq_u32 s3, 2
    s_cbranch_scc1 Vf_q2
    s_cmp_eq_u32 s3, 3
    s_cbranch_scc1 Vf_q3
Vf_q0:
    buffer_load_dwordx4 v[16:19], v3, s[8:11], s38 offen offset:0 sc1
    buffer_load_dwordx4 v[20:23], v3, s[8:11], s38 offen offset:1024 sc1
    buffer_load_dwordx2 v[56:57], v4, s[8:11], s39 offen offset:0 sc1
    s_mov_b32 s31, -1
Vf0m_l:
    buffer_load_dwordx4 v[16:19], v3, s[8:11], s38 offen offset:0 sc1
    buffer_load_dwordx4 v[20:23], v3, s[8:11], s38 offen offset:1024 sc1
    buffer_load_dwordx2 v[56:57], v4, s[8:11], s39 offen offset:0 sc1
    s_add_u32 s31, s31, 1
    s_cmp_lt_u32 s31, s30
    s_cselect_b32 s30, s30, 1
    s_cbranch_scc0 Vf0m_o
    s_waitcnt vmcnt(3)
    v_max3_u32 v58, v16, v17, v18
    v_max3_u32 v58, v58, v19, v20
    v_max3_u32 v58, v58, v21, v22
    v_max3_u32 v58, v58, v23, v56
    v_max_u32 v58, v58, v57
    v_cmp_eq_u32 vcc, -1, v58
    s_cbranch_vccnz Vf0m_l
Vf0m_o:
    ds_write_b128 v3, v[16:19] offset:8192
    ds_write_b128 v3, v[20:23] offset:9216
    ds_write_b64 v4, v[56:57]
    v_smfmac_f32_16x16x64_bf16 v[72:75], v[16:19], a[0:7], v5
    v_smfmac_f32_16x16x64_bf16 v[76:79], v[16:19], a[80:87], v5
    s_waitcnt lgkmcnt(0)
    s_barrier
    ds_read_b128 v[24:27], v3 offset:10240
    ds_read_b128 v[28:31], v3 offset:11264
    ds_read_b128 v[32:35], v3 offset:12288
    v_smfmac_f32_16x16x64_bf16 v[72:75], v[20:23], a[8:15], v5
    ds_read_b128 v[36:39], v3 offset:13312
    ds_read_b128 v[40:43], v3 offset:14336
    v_smfmac_f32_16x16x64_bf16 v[76:79], v[20:23], a[88:95], v5
    ds_read_b128 v[44:47], v3 offset:15360
    ds_read_b128 v[48:51], v3 offset:16384
    ds_read_b128 v[52:55], v3 offset:17408
    s_waitcnt lgkmcnt(7)
    v_smfmac_f32_16x16x64_bf16 v[72:75], v[24:27], a[16:23], v5
    v_smfmac_f32_16x16x64_bf16 v[76:79], v[24:27], a[96:103], v5
    s_waitcnt lgkmcnt(6)
    v_smfmac_f32_16x16x64_bf16 v[72:75], v[28:31], a[24:31], v5
    v_smfmac_f32_16x16x64_bf16 v[76:79], v[28:31], a[104:111], v5
    s_waitcnt lgkmcnt(5)
    v_smfmac_f32_16x16x64_bf16 v[72:75], v[32:35], a[32:39], v5
    v_smfmac_f32_16x16x64_bf16 v[76:79], v[32:35], a[112:119], v5
    s_waitcnt lgkmcnt(4)
    v_smfmac_f32_16x16x64_bf16 v[72:75], v[36:39], a[40:47], v5
    v_smfmac_f32_16x16x64_bf16 v[76:79], v[36:39], a[120:127], v5
    s_waitcnt lgkmcnt(3)
    v_smfmac_f32_16x16x64_bf16 v[72:75], v[40:43], a[48:55], v5
    v_smfmac_f32_16x16x64_bf16 v[76:79], v[40:43], a[128:135], v5
    s_waitcnt lgkmcnt(2)
    v_smfmac_f32_16x16x64_bf16 v[72:75], v[44:47], a[56:63], v5
    v_smfmac_f32_16x16x64_bf16 v[76:79], v[44:47], a[136:143], v5
    s_waitcnt lgkmcnt(1)
    v_smfmac_f32_16x16x64_bf16 v[72:75], v[48:51], a[64:71], v5
    buffer_store_dword v59, v14, s[8:11], s44 offen offset:0
    v_smfmac_f32_16x16x64_bf16 v[76:79], v[48:51], a[144:151], v5
    s_waitcnt lgkmcnt(0)
    v_smfmac_f32_16x16x64_bf16 v[72:75], v[52:55], a[72:79], v5
    v_smfmac_f32_16x16x64_bf16 v[76:79], v[52:55], a[152:159], v5
    s_nop 3
    v_cvt_pk_bf16_f32 v80, v72, v73
    v_cvt_pk_bf16_f32 v81, v74, v75
    s_nop 1
    v_cvt_pk_bf16_f32 v82, v76, v77
    v_cvt_pk_bf16_f32 v83, v78, v79
    s_nop 1
    v_mfma_f32_16x16x32_bf16 v[88:91], v[80:83], v[84:87], 0
    s_branch Vf_qj
Vf_q1:
    buffer_load_dwordx4 v[16:19], v3, s[8:11], s38 offen offset:0 sc1
    buffer_load_dwordx4 v[20:23], v3, s[8:11], s38 offen offset:1024 sc1
    buffer_load_dwordx2 v[56:57], v4, s[8:11], s39 offen offset:0 sc1
    s_mov_b32 s31, -1
Vf1m_l:
    buffer_load_dwordx4 v[16:19], v3, s[8:11], s38 offen offset:0 sc1
    buffer_load_dwordx4 v[20:23], v3, s[8:11], s38 offen offset:1024 sc1
    buffer_load_dwordx2 v[56:57], v4, s[8:11], s39 offen offset:0 sc1
    s_add_u32 s31, s31, 1
    s_cmp_lt_u32 s31, s30
    s_cselect_b32 s30, s30, 1
    s_cbranch_scc0 Vf1m_o
    s_waitcnt vmcnt(3)
    v_max3_u32 v58, v16, v17, v18
    v_max3_u32 v58, v58, v19, v20
    v_max3_u32 v58, v58, v21, v22
    v_max3_u32 v58, v58, v23, v56
    v_max_u32 v58, v58, v57
    v_cmp_eq_u32 vcc, -1, v58
    s_cbranch_vccnz Vf1m_l
Vf1m_o:
    ds_write_b128 v3, v[16:19] offset:8192
    ds_write_b128 v3, v[20:23] offset:9216
    ds_write_b64 v4, v[56:57]
    v_smfmac_f32_16x16x64_bf16 v[72:75], v[16:19], a[16:23], v5
    v_smfmac_f32_16x16x64_bf16 v[76:79], v[16:19], a[96:103], v5
    s_waitcnt lgkmcnt(0)
    s_barrier
    ds_read_b128 v[24:27], v3 offset:10240
    ds_read_b128 v[28:31], v3 offset:11264
    ds_read_b128 v[32:35], v3 offset:12288
    v_smfmac_f32_16x16x64_bf16 v[72:75], v[20:23], a[24:31], v5
    ds_read_b128 v[36:39], v3 offset:13312
    ds_read_b128 v[40:43], v3 offset:6144
    v_smfmac_f32_16x16x64_bf16 v[76:79], v[20:23], a[104:111], v5
    ds_read_b128 v[44:47], v3 offset:7168
    ds_read_b128 v[48:51], v3 offset:14336
    ds_read_b128 v[52:55], v3 offset:15360
    s_waitcnt lgkmcnt(7)
    v_smfmac_f32_16x16x64_bf16 v[72:75], v[24:27], a[32:39], v5
    v_smfmac_f32_16x16x64_bf16 v[76:79], v[24:27], a[112:119], v5
    s_waitcnt lgkmcnt(6)
    v_smfmac_f32_16x16x64_bf16 v[72:75], v[28:31], a[40:47], v5
    v_smfmac_f32_16x16x64_bf16 v[76:79], v[28:31], a[120:127], v5
    s_waitcnt lgkmcnt(5)
    v_smfmac_f32_16x16x64_bf16 v[72:75], v[32:35], a[48:55], v5
    v_smfmac_f32_16x16x64_bf16 v[76:79], v[32:35], a[128:135], v5
    s_waitcnt lgkmcnt(4)
    v_smfmac_f32_16x16x64_bf16 v[72:75], v[36:39], a[56:63], v5
    v_smfmac_f32_16x16x64_bf16 v[76:79], v[36:39], a[136:143], v5
    s_waitcnt lgkmcnt(3)
    v_smfmac_f32_16x16x64_bf16 v[72:75], v[40:43], a[0:7], v5
    v_smfmac_f32_16x16x64_bf16 v[76:79], v[40:43], a[80:87], v5
    s_waitcnt lgkmcnt(2)
    v_smfmac_f32_16x16x64_bf16 v[72:75], v[44:47], a[8:15], v5
    v_smfmac_f32_16x16x64_bf16 v[76:79], v[44:47], a[88:95], v5
    s_waitcnt lgkmcnt(1)
    v_smfmac_f32_16x16x64_bf16 v[72:75], v[48:51], a[64:71], v5
    buffer_store_dword v59, v14, s[8:11], s44 offen offset:0
    v_smfmac_f32_16x16x64_bf16 v[76:79], v[48:51], a[144:151], v5
    s_waitcnt lgkmcnt(0)
    v_smfmac_f32_16x16x64_bf16 v[72:75], v[52:55], a[72:79], v5
    v_smfmac_f32_16x16x64_bf16 v[76:79], v[52:55], a[152:159], v5
    s_nop 3
    v_cvt_pk_bf16_f32 v80, v72, v73
    v_cvt_pk_bf16_f32 v81, v74, v75
    s_nop 1
    v_cvt_pk_bf16_f32 v82, v76, v77
    v_cvt_pk_bf16_f32 v83, v78, v79
    s_nop 1
    v_mfma_f32_16x16x32_bf16 v[88:91], v[80:83], v[84:87], 0
    s_branch Vf_qj
Vf_q2:
    buffer_load_dwordx4 v[16:19], v3, s[8:11], s38 offen offset:0 sc1
    buffer_load_dwordx4 v[20:23], v3, s[8:11], s38 offen offset:1024 sc1
    buffer_load_dwordx2 v[56:57], v4, s[8:11], s39 offen offset:0 sc1
    s_mov_b32 s31, -1
Vf2m_l:
    buffer_load_dwordx4 v[16:19], v3, s[8:11], s38 offen offset:0 sc1
    buffer_load_dwordx4 v[20:23], v3, s[8:11], s38 offen offset:1024 sc1
    buffer_load_dwordx2 v[56:57], v4, s[8:11], s39 offen offset:0 sc1
    s_add_u32 s31, s31, 1
    s_cmp_lt_u32 s31, s30
    s_cselect_b32 s30, s30, 1
    s_cbranch_scc0 Vf2m_o
    s_waitcnt vmcnt(3)
    v_max3_u32 v58, v16, v17, v18
    v_max3_u32 v58, v58, v19, v20
    v_max3_u32 v58, v58, v21, v22
    v_max3_u32 v58, v58, v23, v56
    v_max_u32 v58, v58, v57
    v_cmp_eq_u32 vcc, -1, v58
    s_cbranch_vccnz Vf2m_l
Vf2m_o:
    ds_write_b128 v3, v[16:19] offset:8192
    ds_write_b128 v3, v[20:23] offset:9216
    ds_write_b64 v4, v[56:57]
    v_smfmac_f32_16x16x64_bf16 v[72:75], v[16:19], a[32:39], v5
    v_smfmac_f32_16x16x64_bf16 v[76:79], v[16:19], a[112:119], v5
    s_waitcnt lgkmcnt(0)
    s_barrier
    ds_read_b128 v[24:27], v3 offset:10240
    ds_read_b128 v[28:31], v3 offset:11264
    ds_read_b128 v[32:35], v3 offset:4096
    v_smfmac_f32_16x16x64_bf16 v[72:75], v[20:23], a[40:47], v5
    ds_read_b128 v[36:39], v3 offset:5120
    ds_read_b128 v[40:43], v3 offset:6144
    v_smfmac_f32_16x16x64_bf16 v[76:79], v[20:23], a[120:127], v5
    ds_read_b128 v[44:47], v3 offset:7168
    ds_read_b128 v[48:51], v3 offset:12288
    ds_read_b128 v[52:55], v3 offset:13312
    s_waitcnt lgkmcnt(7)
    v_smfmac_f32_16x16x64_bf16 v[72:75], v[24:27], a[48:55], v5
    v_smfmac_f32_16x16x64_bf16 v[76:79], v[24:27], a[128:135], v5
    s_waitcnt lgkmcnt(6)
    v_smfmac_f32_16x16x64_bf16 v[72:75], v[28:31], a[56:63], v5
    v_smfmac_f32_16x16x64_bf16 v[76:79], v[28:31], a[136:143], v5
    s_waitcnt lgkmcnt(5)
    v_smfmac_f32_16x16x64_bf16 v[72:75], v[32:35], a[0:7], v5
    v_smfmac_f32_16x16x64_bf16 v[76:79], v[32:35], a[80:87], v5
    s_waitcnt lgkmcnt(4)
    v_smfmac_f32_16x16x64_bf16 v[72:75], v[36:39], a[8:15], v5
    v_smfmac_f32_16x16x64_bf16 v[76:79], v[36:39], a[88:95], v5
    s_waitcnt lgkmcnt(3)
    v_smfmac_f32_16x16x64_bf16 v[72:75], v[40:43], a[16:23], v5
    v_smfmac_f32_16x16x64_bf16 v[76:79], v[40:43], a[96:103], v5
    s_waitcnt lgkmcnt(2)
    v_smfmac_f32_16x16x64_bf16 v[72:75], v[44:47], a[24:31], v5
    v_smfmac_f32_16x16x64_bf16 v[76:79], v[44:47], a[104:111], v5
    s_waitcnt lgkmcnt(1)
    v_smfmac_f32_16x16x64_bf16 v[72:75], v[48:51], a[64:71], v5
    buffer_store_dword v59, v14, s[8:11], s44 offen offset:0
    v_smfmac_f32_16x16x64_bf16 v[76:79], v[48:51], a[144:151], v5
    s_waitcnt lgkmcnt(0)
    v_smfmac_f32_16x16x64_bf16 v[72:75], v[52:55], a[72:79], v5
    v_smfmac_f32_16x16x64_bf16 v[76:79], v[52:55], a[152:159], v5
    s_nop 3
    v_cvt_pk_bf16_f32 v80, v72, v73
    v_cvt_pk_bf16_f32 v81, v74, v75
    s_nop 1
    v_cvt_pk_bf16_f32 v82, v76, v77
    v_cvt_pk_bf16_f32 v83, v78, v79
    s_nop 1
    v_mfma_f32_16x16x32_bf16 v[88:91], v[80:83], v[84:87], 0
    s_branch Vf_qj
Vf_q3:
    buffer_load_dwordx4 v[16:19], v3, s[8:11], s38 offen offset:0 sc1
    buffer_load_dwordx4 v[20:23], v3, s[8:11], s38 offen offset:1024 sc1
    buffer_load_dwordx2 v[56:57], v4, s[8:11], s39 offen offset:0 sc1
    s_mov_b32 s31, -1
Vf3m_l:
    buffer_load_dwordx4 v[16:19], v3, s[8:11], s38 offen offset:0 sc1
    buffer_load_dwordx4 v[20:23], v3, s[8:11], s38 offen offset:1024 sc1
    buffer_load_dwordx2 v[56:57], v4, s[8:11], s39 offen offset:0 sc1
    s_add_u32 s31, s31, 1
    s_cmp_lt_u32 s31, s30
    s_cselect_b32 s30, s30, 1
    s_cbranch_scc0 Vf3m_o
    s_waitcnt vmcnt(3)
    v_max3_u32 v58, v16, v17, v18
    v_max3_u32 v58, v58, v19, v20
    v_max3_u32 v58, v58, v21, v22
    v_max3_u32 v58, v58, v23, v56
    v_max_u32 v58, v58, v57
    v_cmp_eq_u32 vcc, -1, v58
    s_cbranch_vccnz Vf3m_l
Vf3m_o:
    ds_write_b128 v3, v[16:19] offset:8192
    ds_write_b128 v3, v[20:23] offset:9216
    ds_write_b64 v4, v[56:57]
    v_smfmac_f32_16x16x64_bf16 v[72:75], v[16:19], a[48:55], v5
    v_smfmac_f32_16x16x64_bf16 v[76:79], v[16:19], a[128:135], v5
    s_waitcnt lgkmcnt(0)
    s_barrier
    ds_read_b128 v[24:27], v3 offset:2048
    ds_read_b128 v[28:31], v3 offset:3072
    ds_read_b128 v[32:35], v3 offset:4096
    v_smfmac_f32_16x16x64_bf16 v[72:75], v[20:23], a[56:63], v5
    ds_read_b128 v[36:39], v3 offset:5120
    ds_read_b128 v[40:43], v3 offset:6144
    v_smfmac_f32_16x16x64_bf16 v[76:79], v[20:23], a[136:143], v5
    ds_read_b128 v[44:47], v3 offset:7168
    ds_read_b128 v[48:51], v3 offset:10240
    ds_read_b128 v[52:55], v3 offset:11264
    s_waitcnt lgkmcnt(7)
    v_smfmac_f32_16x16x64_bf16 v[72:75], v[24:27], a[0:7], v5
    v_smfmac_f32_16x16x64_bf16 v[76:79], v[24:27], a[80:87], v5
    s_waitcnt lgkmcnt(6)
    v_smfmac_f32_16x16x64_bf16 v[72:75], v[28:31], a[8:15], v5
    v_smfmac_f32_16x16x64_bf16 v[76:79], v[28:31], a[88:95], v5
    s_waitcnt lgkmcnt(5)
    v_smfmac_f32_16x16x64_bf16 v[72:75], v[32:35], a[16:23], v5
    v_smfmac_f32_16x16x64_bf16 v[76:79], v[32:35], a[96:103], v5
    s_waitcnt lgkmcnt(4)
    v_smfmac_f32_16x16x64_bf16 v[72:75], v[36:39], a[24:31], v5
    v_smfmac_f32_16x16x64_bf16 v[76:79], v[36:39], a[104:111], v5
    s_waitcnt lgkmcnt(3)
    v_smfmac_f32_16x16x64_bf16 v[72:75], v[40:43], a[32:39], v5
    v_smfmac_f32_16x16x64_bf16 v[76:79], v[40:43], a[112:119], v5
    s_waitcnt lgkmcnt(2)
    v_smfmac_f32_16x16x64_bf16 v[72:75], v[44:47], a[40:47], v5
    v_smfmac_f32_16x16x64_bf16 v[76:79], v[44:47], a[120:127], v5
    s_waitcnt lgkmcnt(1)
    v_smfmac_f32_16x16x64_bf16 v[72:75], v[48:51], a[64:71], v5
    buffer_store_dword v59, v14, s[8:11], s44 offen offset:0
    v_smfmac_f32_16x16x64_bf16 v[76:79], v[48:51], a[144:151], v5
    s_waitcnt lgkmcnt(0)
    v_smfmac_f32_16x16x64_bf16 v[72:75], v[52:55], a[72:79], v5
    v_smfmac_f32_16x16x64_bf16 v[76:79], v[52:55], a[152:159], v5
    s_nop 3
    v_cvt_pk_bf16_f32 v80, v72, v73
    v_cvt_pk_bf16_f32 v81, v74, v75
    s_nop 1
    v_cvt_pk_bf16_f32 v82, v76, v77
    v_cvt_pk_bf16_f32 v83, v78, v79
    s_nop 1
    v_mfma_f32_16x16x32_bf16 v[88:91], v[80:83], v[84:87], 0
Vf_qj:
    s_nop 7
    v_cvt_pk_bf16_f32 v94, v88, v89
    v_cvt_pk_bf16_f32 v95, v90, v91
    buffer_store_dwordx2 v[94:95], v6, s[8:11], s25 offen offset:0
    s_cmp_lt_u32 s32, 64
    s_cbranch_scc0 Vf_nb
    s_cmp_eq_u32 s32, 14
    s_cbranch_scc0 Vf_h
    s_mov_b32 s31, 0
    s_waitcnt vmcnt(63)
    s_branch VfB1_c
VfB1_l:
    buffer_load_dword v68, v67, s[8:11], s23 offen sc1
    s_waitcnt vmcnt(0)
VfB1_c:
    v_cmp_gt_u32 vcc, 1, v68
    s_cbranch_vccz VfB1_o
    s_sleep 4
    s_add_u32 s31, s31, 1
    s_cmp_lt_u32 s31, s30
    s_cbranch_scc1 VfB1_l
    s_mov_b32 s30, 1
VfB1_o:
    s_mov_b32 s31, 0
    s_waitcnt vmcnt(63)
    s_branch VfB2_c
VfB2_l:
    buffer_load_dword v69, v67, s[8:11], s47 offen sc1
    s_waitcnt vmcnt(0)
VfB2_c:
    v_cmp_gt_u32 vcc, 1, v69
    s_cbranch_vccz VfB2_o
    s_sleep 4
    s_add_u32 s31, s31, 1
    s_cmp_lt_u32 s31, s30
    s_cbranch_scc1 VfB2_l
    s_mov_b32 s30, 1
VfB2_o:
Vf_h:
    v_add_u32 v11, s29, v2
    s_xor_b32 s29, s29, 40960
    s_add_u32 s42, s29, s27
    ds_read_b128 a[160:163], v11 offset:0
    ds_read_b128 a[164:167], v11 offset:20480
    ds_read_b128 a[168:171], v11 offset:1024
    ds_read_b128 a[172:175], v11 offset:21504
    ds_read_b128 a[176:179], v11 offset:2048
    ds_read_b128 a[180:183], v11 offset:22528
    s_waitcnt lgkmcnt(5)
    v_mfma_f32_16x16x32_bf16 v[144:147], a[0:3], a[160:163], 0
    ds_read_b128 a[184:187], v11 offset:3072
    v_mfma_f32_16x16x32_bf16 v[152:155], a[80:83], a[160:163], 0
    s_waitcnt lgkmcnt(5)
    v_mfma_f32_16x16x32_bf16 v[148:151], a[0:3], a[164:167], 0
    ds_read_b128 a[188:191], v11 offset:23552
    v_mfma_f32_16x16x32_bf16 v[156:159], a[80:83], a[164:167], 0
    s_waitcnt lgkmcnt(5)
    v_mfma_f32_16x16x32_bf16 v[144:147], a[4:7], a[168:171], v[144:147]
    ds_read_b128 a[160:163], v11 offset:4096
    s_add_u32 s35, s28, 0
    s_add_u32 m0, s42, 0
    v_mfma_f32_16x16x32_bf16 v[152:155], a[84:87], a[168:171], v[152:155]
    buffer_load_dwordx4 v2, s[8:11], s35 offen offset:0 sc1 lds
    s_waitcnt lgkmcnt(5)
    v_mfma_f32_16x16x32_bf16 v[148:151], a[4:7], a[172:175], v[148:151]
    ds_read_b128 a[164:167], v11 offset:24576
    v_mfma_f32_16x16x32_bf16 v[156:159], a[84:87], a[172:175], v[156:159]
    s_waitcnt lgkmcnt(5)
    v_mfma_f32_16x16x32_bf16 v[144:147], a[8:11], a[176:179], v[144:147]
    ds_read_b128 a[168:171], v11 offset:5120
    v_mfma_f32_16x16x32_bf16 v[152:155], a[88:91], a[176:179], v[152:155]
    s_waitcnt lgkmcnt(5)
    v_mfma_f32_16x16x32_bf16 v[148:151], a[8:11], a[180:183], v[148:151]
    ds_read_b128 a[172:175], v11 offset:25600
    v_mfma_f32_16x16x32_bf16 v[156:159], a[88:91], a[180:183], v[156:159]
    buffer_load_dwordx4 v2, s[8:11], s35 offen offset:1024 sc1 lds
    s_waitcnt lgkmcnt(5)
    v_mfma_f32_16x16x32_bf16 v[144:147], a[12:15], a[184:187], v[144:147]
    ds_read_b128 a[176:179], v11 offset:6144
    v_mfma_f32_16x16x32_bf16 v[152:155], a[92:95], a[184:187], v[152:155]
    s_waitcnt lgkmcnt(5)
    v_mfma_f32_16x16x32_bf16 v[148:151], a[12:15], a[188:191], v[148:151]
    ds_read_b128 a[180:183], v11 offset:26624
    v_mfma_f32_16x16x32_bf16 v[156:159], a[92:95], a[188:191], v[156:159]
    s_waitcnt lgkmcnt(5)
    v_mfma_f32_16x16x32_bf16 v[144:147], a[16:19], a[160:163], v[144:147]
    ds_read_b128 a[184:187], v11 offset:7168
    v_mfma_f32_16x16x32_bf16 v[152:155], a[96:99], a[160:163], v[152:155]
    buffer_load_dwordx4 v2, s[8:11], s35 offen offset:2048 sc1 lds
    s_waitcnt lgkmcnt(5)
    v_mfma_f32_16x16x32_bf16 v[148:151], a[16:19], a[164:167], v[148:151]
    ds_read_b128 a[188:191], v11 offset:27648
    v_mfma_f32_16x16x32_bf16 v[156:159], a[96:99], a[164:167], v[156:159]
    s_waitcnt lgkmcnt(5)
    v_mfma_f32_16x16x32_bf16 v[144:147], a[20:23], a[168:171], v[144:147]
    ds_read_b128 a[160:163], v11 offset:8192
    v_mfma_f32_16x16x32_bf16 v[152:155], a[100:103], a[168:171], v[152:155]
    s_waitcnt lgkmcnt(5)
    v_mfma_f32_16x16x32_bf16 v[148:151], a[20:23], a[172:175], v[148:151]
    ds_read_b128 a[164:167], v11 offset:28672
    v_mfma_f32_16x16x32_bf16 v[156:159], a[100:103], a[172:175], v[156:159]
    buffer_load_dwordx4 v2, s[8:11], s35 offen offset:3072 sc1 lds
    s_waitcnt lgkmcnt(5)
    v_mfma_f32_16x16x32_bf16 v[144:147], a[24:27], a[176:179], v[144:147]
    ds_read_b128 a[168:171], v11 offset:9216
    v_mfma_f32_16x16x32_bf16 v[152:155], a[104:107], a[176:179], v[152:155]
    s_waitcnt lgkmcnt(5)
    v_mfma_f32_16x16x32_bf16 v[148:151], a[24:27], a[180:183], v[148:151]
    ds_read_b128 a[172:175], v11 offset:29696
    v_mfma_f32_16x16x32_bf16 v[156:159], a[104:107], a[180:183], v[156:159]
    s_waitcnt lgkmcnt(5)
    v_mfma_f32_16x16x32_bf16 v[144:147], a[28:31], a[184:187], v[144:147]
    ds_read_b128 a[176:179], v11 offset:10240
    s_add_u32 s35, s28, 4096
    s_add_u32 m0, s42, 4096
    v_mfma_f32_16x16x32_bf16 v[152:155], a[108:111], a[184:187], v[152:155]
    buffer_load_dwordx4 v2, s[8:11], s35 offen offset:0 sc1 lds
    s_waitcnt lgkmcnt(5)
    v_mfma_f32_16x16x32_bf16 v[148:151], a[28:31], a[188:191], v[148:151]
    ds_read_b128 a[180:183], v11 offset:30720
    v_mfma_f32_16x16x32_bf16 v[156:159], a[108:111], a[188:191], v[156:159]
    s_waitcnt lgkmcnt(5)
    v_mfma_f32_16x16x32_bf16 v[144:147], a[32:35], a[160:163], v[144:147]
    ds_read_b128 a[184:187], v11 offset:11264
    v_mfma_f32_16x16x32_bf16 v[152:155], a[112:115], a[160:163], v[152:155]
    s_waitcnt lgkmcnt(5)
    v_mfma_f32_16x16x32_bf16 v[148:151], a[32:35], a[164:167], v[148:151]
    ds_read_b128 a[188:191], v11 offset:31744
    v_mfma_f32_16x16x32_bf16 v[156:159], a[112:115], a[164:167], v[156:159]
    buffer_load_dwordx4 v2, s[8:11], s35 offen offset:1024 sc1 lds
    s_waitcnt lgkmcnt(5)
    v_mfma_f32_16x16x32_bf16 v[144:147], a[36:39], a[168:171], v[144:147]
    ds_read_b128 a[160:163], v11 offset:12288
    v_mfma_f32_16x16x32_bf16 v[152:155], a[116:119], a[168:171], v[152:155]
    s_waitcnt lgkmcnt(5)
    v_mfma_f32_16x16x32_bf16 v[148:151], a[36:39], a[172:175], v[148:151]
    ds_read_b128 a[164:167], v11 offset:32768
    v_mfma_f32_16x16x32_bf16 v[156:159], a[116:119], a[172:175], v[156:159]
    s_waitcnt lgkmcnt(5)
    v_mfma_f32_16x16x32_bf16 v[144:147], a[40:43], a[176:179], v[144:147]
    ds_read_b128 a[168:171], v11 offset:13312
    v_mfma_f32_16x16x32_bf16 v[152:155], a[120:123], a[176:179], v[152:155]
    buffer_load_dwordx4 v2, s[8:11], s35 offen offset:2048 sc1 lds
    s_waitcnt lgkmcnt(5)
    v_mfma_f32_16x16x32_bf16 v[148:151], a[40:43], a[180:183], v[148:151]
    ds_read_b128 a[172:175], v11 offset:33792
    v_mfma_f32_16x16x32_bf16 v[156:159], a[120:123], a[180:183], v[156:159]
    buffer_store_dwordx2 v[240:241], v6, s[8:11], s26 offen offset:0
    buffer_store_dwordx4 v[240:243], v7, s[8:11], s34 offen offset:0 sc1
    s_waitcnt lgkmcnt(5)
    v_mfma_f32_16x16x32_bf16 v[144:147], a[44:47], a[184:187], v[144:147]
    ds_read_b128 a[176:179], v11 offset:14336
    v_mfma_f32_16x16x32_bf16 v[152:155], a[124:127], a[184:187], v[152:155]
    s_waitcnt lgkmcnt(5)
    v_mfma_f32_16x16x32_bf16 v[148:151], a[44:47], a[188:191], v[148:151]
    ds_read_b128 a[180:183], v11 offset:34816
    v_mfma_f32_16x16x32_bf16 v[156:159], a[124:127], a[188:191], v[156:159]
    buffer_load_dwordx4 v2, s[8:11], s35 offen offset:3072 sc1 lds
    s_waitcnt lgkmcnt(5)
    v_mfma_f32_16x16x32_bf16 v[144:147], a[48:51], a[160:163], v[144:147]
    ds_read_b128 a[184:187], v11 offset:15360
    v_mfma_f32_16x16x32_bf16 v[152:155], a[128:131], a[160:163], v[152:155]
    s_waitcnt lgkmcnt(5)
    v_mfma_f32_16x16x32_bf16 v[148:151], a[48:51], a[164:167], v[148:151]
    ds_read_b128 a[188:191], v11 offset:35840
    v_mfma_f32_16x16x32_bf16 v[156:159], a[128:131], a[164:167], v[156:159]
    s_waitcnt lgkmcnt(5)
    v_mfma_f32_16x16x32_bf16 v[144:147], a[52:55], a[168:171], v[144:147]
    ds_read_b128 a[160:163], v11 offset:16384
    s_add_u32 s35, s28, 8192
    s_add_u32 m0, s42, 8192
    v_mfma_f32_16x16x32_bf16 v[152:155], a[132:135], a[168:171], v[152:155]
    buffer_load_dwordx4 v2, s[8:11], s35 offen offset:0 sc1 lds
    s_waitcnt lgkmcnt(5)
    v_mfma_f32_16x16x32_bf16 v[148:151], a[52:55], a[172:175], v[148:151]
    ds_read_b128 a[164:167], v11 offset:36864
    v_mfma_f32_16x16x32_bf16 v[156:159], a[132:135], a[172:175], v[156:159]
    s_waitcnt lgkmcnt(5)
    v_mfma_f32_16x16x32_bf16 v[144:147], a[56:59], a[176:179], v[144:147]
    ds_read_b128 a[168:171], v11 offset:17408
    v_mfma_f32_16x16x32_bf16 v[152:155], a[136:139], a[176:179], v[152:155]
    s_waitcnt lgkmcnt(5)
    v_mfma_f32_16x16x32_bf16 v[148:151], a[56:59], a[180:183], v[148:151]
    ds_read_b128 a[172:175], v11 offset:37888
    v_mfma_f32_16x16x32_bf16 v[156:159], a[136:139], a[180:183], v[156:159]
    buffer_load_dwordx4 v2, s[8:11], s35 offen offset:1024 sc1 lds
    s_waitcnt lgkmcnt(5)
    v_mfma_f32_16x16x32_bf16 v[144:147], a[60:63], a[184:187], v[144:147]
    ds_read_b128 a[176:179], v11 offset:18432
    v_mfma_f32_16x16x32_bf16 v[152:155], a[140:143], a[184:187], v[152:155]
    s_waitcnt lgkmcnt(5)
    v_mfma_f32_16x16x32_bf16 v[148:151], a[60:63], a[188:191], v[148:151]
    ds_read_b128 a[180:183], v11 offset:38912
    v_mfma_f32_16x16x32_bf16 v[156:159], a[140:143], a[188:191], v[156:159]
    s_waitcnt lgkmcnt(5)
    v_mfma_f32_16x16x32_bf16 v[144:147], a[64:67], a[160:163], v[144:147]
    ds_read_b128 a[184:187], v11 offset:19456
    v_mfma_f32_16x16x32_bf16 v[152:155], a[144:147], a[160:163], v[152:155]
    s_waitcnt lgkmcnt(5)
    v_mfma_f32_16x16x32_bf16 v[148:151], a[64:67], a[164:167], v[148:151]
    ds_read_b128 a[188:191], v11 offset:39936
    v_mfma_f32_16x16x32_bf16 v[156:159], a[144:147], a[164:167], v[156:159]
    s_waitcnt lgkmcnt(5)
    v_mfma_f32_16x16x32_bf16 v[144:147], a[68:71], a[168:171], v[144:147]
    v_mfma_f32_16x16x32_bf16 v[152:155], a[148:151], a[168:171], v[152:155]
    s_waitcnt lgkmcnt(4)
    v_mfma_f32_16x16x32_bf16 v[148:151], a[68:71], a[172:175], v[148:151]
    v_mfma_f32_16x16x32_bf16 v[156:159], a[148:151], a[172:175], v[156:159]
    s_waitcnt lgkmcnt(3)
    v_mfma_f32_16x16x32_bf16 v[144:147], a[72:75], a[176:179], v[144:147]
    v_mfma_f32_16x16x32_bf16 v[152:155], a[152:155], a[176:179], v[152:155]
    s_waitcnt lgkmcnt(2)
    v_mfma_f32_16x16x32_bf16 v[148:151], a[72:75], a[180:183], v[148:151]
    v_mfma_f32_16x16x32_bf16 v[156:159], a[152:155], a[180:183], v[156:159]
    s_waitcnt lgkmcnt(1)
    v_mfma_f32_16x16x32_bf16 v[144:147], a[76:79], a[184:187], v[144:147]
    v_mfma_f32_16x16x32_bf16 v[152:155], a[156:159], a[184:187], v[152:155]
    s_waitcnt lgkmcnt(0)
    v_mfma_f32_16x16x32_bf16 v[148:151], a[76:79], a[188:191], v[148:151]
    v_mfma_f32_16x16x32_bf16 v[156:159], a[156:159], a[188:191], v[156:159]
    s_add_u32 s28, s28, 40960
    s_add_u32 s32, s32, 1
    s_cmp_eq_u32 s32, 1
    s_cbranch_scc0 VfB0_o
    s_mov_b32 s31, 0
VfB0_l:
    buffer_load_dword v68, v70, s[8:11], s49 offen sc1
    s_waitcnt vmcnt(0)
VfB0_c:
    v_cmp_gt_u32 vcc, 1, v68
    s_cbranch_vccz VfB0_o
    s_sleep 2
    s_add_u32 s31, s31, 1
    s_cmp_lt_u32 s31, s30
    s_cbranch_scc1 VfB0_l
    s_mov_b32 s30, 1
VfB0_o:
    s_cmp_eq_u32 s32, 12
    s_cbranch_scc0 Vf_n12
    buffer_load_dword v68, v67, s[8:11], s23 offen offset:0 sc1
    buffer_load_dword v69, v67, s[8:11], s47 offen offset:0 sc1
Vf_n12:
    s_add_u32 s4, s32, 3
    s_and_b32 s4, s4, 3
    s_mul_i32 s4, s4, 49152
    s_add_u32 s4, s4, s43
    s_add_u32 s5, s4, 6144
    v_cvt_pk_bf16_f32 v160, v144, v145
    v_cvt_pk_bf16_f32 v161, v152, v153
    v_cvt_pk_bf16_f32 v162, v146, v147
    v_cvt_pk_bf16_f32 v163, v154, v155
    buffer_store_dwordx4 v[160:163], v2, s[8:11], s4 offen offset:0
    v_cvt_pk_bf16_f32 v164, v148, v149
    v_cvt_pk_bf16_f32 v165, v156, v157
    v_cvt_pk_bf16_f32 v166, v150, v151
    v_cvt_pk_bf16_f32 v167, v158, v159
    buffer_store_dwordx4 v[164:167], v2, s[8:11], s5 offen offset:0
    s_waitcnt vmcnt(0)
    v_mov_b32 v10, s32
    s_mov_b64 exec, 1
    buffer_store_dword v10, v9, s[8:11], s33 offen
    s_mov_b64 exec, -1
    s_cmp_lt_u32 s32, 4
    s_cbranch_scc0 Vf_nb
    s_barrier
    s_branch Vf_h
Vf_nb:
    s_cmp_eq_u32 s21, 62
    s_cbranch_scc0 Vf_np
    s_barrier
    buffer_store_dwordx2 v[240:241], v6, s[8:11], s26 offen offset:0
    buffer_store_dwordx4 v[240:243], v7, s[8:11], s34 offen offset:0 sc1
Vf_np:
    s_cmp_lt_u32 s21, 63
    s_cbranch_scc1 Vf_loop
    s_cmp_eq_u32 s21, 64
    s_cbranch_scc1 V_t3
    s_load_dwordx2 s[88:89], s[0:1], 64
    s_mov_b32 s90, 1280
    s_mov_b32 s91, 0x20000
    s_waitcnt lgkmcnt(0)
    v_lshlrev_b32 v71, 2, v1
    v_lshlrev_b32 v70, 3, v1
    s_mov_b32 s4, 5120
    buffer_load_dwordx2 v[146:147], v70, s[8:11], s4 offen offset:0 sc1
    buffer_load_dwordx2 v[148:149], v70, s[8:11], s4 offen offset:512 sc1
    buffer_load_dwordx2 v[150:151], v70, s[8:11], s4 offen offset:1024 sc1
    buffer_load_dwordx2 v[152:153], v70, s[8:11], s4 offen offset:1536 sc1
    buffer_load_dwordx2 v[154:155], v70, s[8:11], s4 offen offset:2048 sc1
    s_mov_b32 s5, 7680
    s_mov_b32 s6, 10240
    s_mov_b32 s7, 12800
    buffer_load_dwordx2 v[100:101], v70, s[8:11], s5 offen offset:0 sc1
    buffer_load_dwordx2 v[110:111], v70, s[8:11], s6 offen offset:0 sc1
    buffer_load_dwordx2 v[120:121], v70, s[8:11], s7 offen offset:0 sc1
    buffer_load_dword v140, v71, s[88:91], 0 offen offset:0
    buffer_load_dwordx2 v[102:103], v70, s[8:11], s5 offen offset:512 sc1
    buffer_load_dwordx2 v[112:113], v70, s[8:11], s6 offen offset:512 sc1
    buffer_load_dwordx2 v[122:123], v70, s[8:11], s7 offen offset:512 sc1
    buffer_load_dword v141, v71, s[88:91], 0 offen offset:256
    buffer_load_dwordx2 v[104:105], v70, s[8:11], s5 offen offset:1024 sc1
    buffer_load_dwordx2 v[114:115], v70, s[8:11], s6 offen offset:1024 sc1
    buffer_load_dwordx2 v[124:125], v70, s[8:11], s7 offen offset:1024 sc1
    buffer_load_dword v142, v71, s[88:91], 0 offen offset:512
    buffer_load_dwordx2 v[106:107], v70, s[8:11], s5 offen offset:1536 sc1
    buffer_load_dwordx2 v[116:117], v70, s[8:11], s6 offen offset:1536 sc1
    buffer_load_dwordx2 v[126:127], v70, s[8:11], s7 offen offset:1536 sc1
    buffer_load_dword v143, v71, s[88:91], 0 offen offset:768
    buffer_load_dwordx2 v[108:109], v70, s[8:11], s5 offen offset:2048 sc1
    buffer_load_dwordx2 v[118:119], v70, s[8:11], s6 offen offset:2048 sc1
    buffer_load_dwordx2 v[128:129], v70, s[8:11], s7 offen offset:2048 sc1
    buffer_load_dword v144, v71, s[88:91], 0 offen offset:1024
    s_waitcnt vmcnt(0)
    v_add_f32 v110, 1.0, v110
    v_cvt_pk_bf16_f32 v110, v110, v110
    v_and_b32 v110, 0xffff0000, v110
    v_add_f32 v111, 1.0, v111
    v_cvt_pk_bf16_f32 v111, v111, v111
    v_and_b32 v111, 0xffff0000, v111
    v_add_f32 v112, 1.0, v112
    v_cvt_pk_bf16_f32 v112, v112, v112
    v_and_b32 v112, 0xffff0000, v112
    v_add_f32 v113, 1.0, v113
    v_cvt_pk_bf16_f32 v113, v113, v113
    v_and_b32 v113, 0xffff0000, v113
    v_add_f32 v114, 1.0, v114
    v_cvt_pk_bf16_f32 v114, v114, v114
    v_and_b32 v114, 0xffff0000, v114
    v_add_f32 v115, 1.0, v115
    v_cvt_pk_bf16_f32 v115, v115, v115
    v_and_b32 v115, 0xffff0000, v115
    v_add_f32 v116, 1.0, v116
    v_cvt_pk_bf16_f32 v116, v116, v116
    v_and_b32 v116, 0xffff0000, v116
    v_add_f32 v117, 1.0, v117
    v_cvt_pk_bf16_f32 v117, v117, v117
    v_and_b32 v117, 0xffff0000, v117
    v_add_f32 v118, 1.0, v118
    v_cvt_pk_bf16_f32 v118, v118, v118
    v_and_b32 v118, 0xffff0000, v118
    v_add_f32 v119, 1.0, v119
    v_cvt_pk_bf16_f32 v119, v119, v119
    v_and_b32 v119, 0xffff0000, v119
    v_lshlrev_b32 v130, 16, v140
    v_and_b32 v131, 0xffff0000, v140
    v_lshlrev_b32 v132, 16, v141
    v_and_b32 v133, 0xffff0000, v141
    v_lshlrev_b32 v134, 16, v142
    v_and_b32 v135, 0xffff0000, v142
    v_lshlrev_b32 v136, 16, v143
    v_and_b32 v137, 0xffff0000, v143
    v_lshlrev_b32 v138, 16, v144
    v_and_b32 v139, 0xffff0000, v144
    s_branch Vf_loop
Vs_go:
Vs_loop:
    s_and_b32 s4, s21, 3
    s_mul_i32 s5, s4, 10240
    s_add_u32 s5, s5, s22
    s_sub_u32 s38, s5, 73728
    s_sub_u32 s39, s5, 81920
    s_mul_i32 s5, s4, 12288
    s_add_u32 s25, s24, s5
    s_xor_b32 s4, s4, 2
    s_mul_i32 s5, s4, 163840
    s_add_u32 s34, s36, s5
    s_mul_i32 s5, s4, 12288
    s_add_u32 s26, s24, s5
    s_add_u32 s21, s21, 1
    v_mov_b32 v72, 0
    v_mov_b32 v73, 0
    v_mov_b32 v74, 0
    v_mov_b32 v75, 0
    v_mov_b32 v76, 0
    v_mov_b32 v77, 0
    v_mov_b32 v78, 0
    v_mov_b32 v79, 0
    v_mov_b32 v59, s21
    s_cmp_eq_u32 s3, 1
    s_cbranch_scc1 Vs_q1
    s_cmp_eq_u32 s3, 2
    s_cbranch_scc1 Vs_q2
    s_cmp_eq_u32 s3, 3
    s_cbranch_scc1 Vs_q3
Vs_q0:
    buffer_load_dwordx4 v[16:19], v3, s[8:11], s38 offen offset:0 sc1
    buffer_load_dwordx4 v[20:23], v3, s[8:11], s38 offen offset:1024 sc1
    buffer_load_dwordx2 v[56:57], v4, s[8:11], s39 offen offset:0 sc1
    s_mov_b32 s31, -1
Vs0m_l:
    buffer_load_dwordx4 v[16:19], v3, s[8:11], s38 offen offset:0 sc1
    buffer_load_dwordx4 v[20:23], v3, s[8:11], s38 offen offset:1024 sc1
    buffer_load_dwordx2 v[56:57], v4, s[8:11], s39 offen offset:0 sc1
    s_add_u32 s31, s31, 1
    s_cmp_lt_u32 s31, s30
    s_cselect_b32 s30, s30, 1
    s_cbranch_scc0 Vs0m_o
    s_waitcnt vmcnt(3)
    v_max3_u32 v58, v16, v17, v18
    v_max3_u32 v58, v58, v19, v20
    v_max3_u32 v58, v58, v21, v22
    v_max3_u32 v58, v58, v23, v56
    v_max_u32 v58, v58, v57
    v_cmp_eq_u32 vcc, -1, v58
    s_cbranch_vccnz Vs0m_l
Vs0m_o:
    ds_write_b128 v3, v[16:19] offset:8192
    ds_write_b128 v3, v[20:23] offset:9216
    ds_write_b64 v4, v[56:57]
    v_smfmac_f32_16x16x64_bf16 v[72:75], v[16:19], a[0:7], v5
    v_smfmac_f32_16x16x64_bf16 v[76:79], v[16:19], a[80:87], v5
    s_waitcnt lgkmcnt(0)
    s_barrier
    ds_read_b128 v[24:27], v3 offset:10240
    ds_read_b128 v[28:31], v3 offset:11264
    ds_read_b128 v[32:35], v3 offset:12288
    v_smfmac_f32_16x16x64_bf16 v[72:75], v[20:23], a[8:15], v5
    ds_read_b128 v[36:39], v3 offset:13312
    ds_read_b128 v[40:43], v3 offset:14336
    v_smfmac_f32_16x16x64_bf16 v[76:79], v[20:23], a[88:95], v5
    ds_read_b128 v[44:47], v3 offset:15360
    ds_read_b128 v[48:51], v3 offset:16384
    ds_read_b128 v[52:55], v3 offset:17408
    s_waitcnt lgkmcnt(7)
    v_smfmac_f32_16x16x64_bf16 v[72:75], v[24:27], a[16:23], v5
    v_smfmac_f32_16x16x64_bf16 v[76:79], v[24:27], a[96:103], v5
    s_waitcnt lgkmcnt(6)
    v_smfmac_f32_16x16x64_bf16 v[72:75], v[28:31], a[24:31], v5
    v_smfmac_f32_16x16x64_bf16 v[76:79], v[28:31], a[104:111], v5
    s_waitcnt lgkmcnt(5)
    v_smfmac_f32_16x16x64_bf16 v[72:75], v[32:35], a[32:39], v5
    v_smfmac_f32_16x16x64_bf16 v[76:79], v[32:35], a[112:119], v5
    s_waitcnt lgkmcnt(4)
    v_smfmac_f32_16x16x64_bf16 v[72:75], v[36:39], a[40:47], v5
    v_smfmac_f32_16x16x64_bf16 v[76:79], v[36:39], a[120:127], v5
    s_waitcnt lgkmcnt(3)
    v_smfmac_f32_16x16x64_bf16 v[72:75], v[40:43], a[48:55], v5
    v_smfmac_f32_16x16x64_bf16 v[76:79], v[40:43], a[128:135], v5
    s_waitcnt lgkmcnt(2)
    v_smfmac_f32_16x16x64_bf16 v[72:75], v[44:47], a[56:63], v5
    v_smfmac_f32_16x16x64_bf16 v[76:79], v[44:47], a[136:143], v5
    s_waitcnt lgkmcnt(1)
    v_smfmac_f32_16x16x64_bf16 v[72:75], v[48:51], a[64:71], v5
    buffer_store_dword v59, v14, s[8:11], s44 offen offset:0 sc1
    v_smfmac_f32_16x16x64_bf16 v[76:79], v[48:51], a[144:151], v5
    s_waitcnt lgkmcnt(0)
    v_smfmac_f32_16x16x64_bf16 v[72:75], v[52:55], a[72:79], v5
    v_smfmac_f32_16x16x64_bf16 v[76:79], v[52:55], a[152:159], v5
    s_nop 3
    v_cvt_pk_bf16_f32 v80, v72, v73
    v_cvt_pk_bf16_f32 v81, v74, v75
    s_nop 1
    v_cvt_pk_bf16_f32 v82, v76, v77
    v_cvt_pk_bf16_f32 v83, v78, v79
    s_nop 1
    v_mfma_f32_16x16x32_bf16 v[88:91], v[80:83], v[84:87], 0
    s_branch Vs_qj
Vs_q1:
    buffer_load_dwordx4 v[16:19], v3, s[8:11], s38 offen offset:0 sc1
    buffer_load_dwordx4 v[20:23], v3, s[8:11], s38 offen offset:1024 sc1
    buffer_load_dwordx2 v[56:57], v4, s[8:11], s39 offen offset:0 sc1
    s_mov_b32 s31, -1
Vs1m_l:
    buffer_load_dwordx4 v[16:19], v3, s[8:11], s38 offen offset:0 sc1
    buffer_load_dwordx4 v[20:23], v3, s[8:11], s38 offen offset:1024 sc1
    buffer_load_dwordx2 v[56:57], v4, s[8:11], s39 offen offset:0 sc1
    s_add_u32 s31, s31, 1
    s_cmp_lt_u32 s31, s30
    s_cselect_b32 s30, s30, 1
    s_cbranch_scc0 Vs1m_o
    s_waitcnt vmcnt(3)
    v_max3_u32 v58, v16, v17, v18
    v_max3_u32 v58, v58, v19, v20
    v_max3_u32 v58, v58, v21, v22
    v_max3_u32 v58, v58, v23, v56
    v_max_u32 v58, v58, v57
    v_cmp_eq_u32 vcc, -1, v58
    s_cbranch_vccnz Vs1m_l
Vs1m_o:
    ds_write_b128 v3, v[16:19] offset:8192
    ds_write_b128 v3, v[20:23] offset:9216
    ds_write_b64 v4, v[56:57]
    v_smfmac_f32_16x16x64_bf16 v[72:75], v[16:19], a[16:23], v5
    v_smfmac_f32_16x16x64_bf16 v[76:79], v[16:19], a[96:103], v5
    s_waitcnt lgkmcnt(0)
    s_barrier
    ds_read_b128 v[24:27], v3 offset:10240
    ds_read_b128 v[28:31], v3 offset:11264
    ds_read_b128 v[32:35], v3 offset:12288
    v_smfmac_f32_16x16x64_bf16 v[72:75], v[20:23], a[24:31], v5
    ds_read_b128 v[36:39], v3 offset:13312
    ds_read_b128 v[40:43], v3 offset:6144
    v_smfmac_f32_16x16x64_bf16 v[76:79], v[20:23], a[104:111], v5
    ds_read_b128 v[44:47], v3 offset:7168
    ds_read_b128 v[48:51], v3 offset:14336
    ds_read_b128 v[52:55], v3 offset:15360
    s_waitcnt lgkmcnt(7)
    v_smfmac_f32_16x16x64_bf16 v[72:75], v[24:27], a[32:39], v5
    v_smfmac_f32_16x16x64_bf16 v[76:79], v[24:27], a[112:119], v5
    s_waitcnt lgkmcnt(6)
    v_smfmac_f32_16x16x64_bf16 v[72:75], v[28:31], a[40:47], v5
    v_smfmac_f32_16x16x64_bf16 v[76:79], v[28:31], a[120:127], v5
    s_waitcnt lgkmcnt(5)
    v_smfmac_f32_16x16x64_bf16 v[72:75], v[32:35], a[48:55], v5
    v_smfmac_f32_16x16x64_bf16 v[76:79], v[32:35], a[128:135], v5
    s_waitcnt lgkmcnt(4)
    v_smfmac_f32_16x16x64_bf16 v[72:75], v[36:39], a[56:63], v5
    v_smfmac_f32_16x16x64_bf16 v[76:79], v[36:39], a[136:143], v5
    s_waitcnt lgkmcnt(3)
    v_smfmac_f32_16x16x64_bf16 v[72:75], v[40:43], a[0:7], v5
    v_smfmac_f32_16x16x64_bf16 v[76:79], v[40:43], a[80:87], v5
    s_waitcnt lgkmcnt(2)
    v_smfmac_f32_16x16x64_bf16 v[72:75], v[44:47], a[8:15], v5
    v_smfmac_f32_16x16x64_bf16 v[76:79], v[44:47], a[88:95], v5
    s_waitcnt lgkmcnt(1)
    v_smfmac_f32_16x16x64_bf16 v[72:75], v[48:51], a[64:71], v5
    buffer_store_dword v59, v14, s[8:11], s44 offen offset:0 sc1
    v_smfmac_f32_16x16x64_bf16 v[76:79], v[48:51], a[144:151], v5
    s_waitcnt lgkmcnt(0)
    v_smfmac_f32_16x16x64_bf16 v[72:75], v[52:55], a[72:79], v5
    v_smfmac_f32_16x16x64_bf16 v[76:79], v[52:55], a[152:159], v5
    s_nop 3
    v_cvt_pk_bf16_f32 v80, v72, v73
    v_cvt_pk_bf16_f32 v81, v74, v75
    s_nop 1
    v_cvt_pk_bf16_f32 v82, v76, v77
    v_cvt_pk_bf16_f32 v83, v78, v79
    s_nop 1
    v_mfma_f32_16x16x32_bf16 v[88:91], v[80:83], v[84:87], 0
    s_branch Vs_qj
Vs_q2:
    buffer_load_dwordx4 v[16:19], v3, s[8:11], s38 offen offset:0 sc1
    buffer_load_dwordx4 v[20:23], v3, s[8:11], s38 offen offset:1024 sc1
    buffer_load_dwordx2 v[56:57], v4, s[8:11], s39 offen offset:0 sc1
    s_mov_b32 s31, -1
Vs2m_l:
    buffer_load_dwordx4 v[16:19], v3, s[8:11], s38 offen offset:0 sc1
    buffer_load_dwordx4 v[20:23], v3, s[8:11], s38 offen offset:1024 sc1
    buffer_load_dwordx2 v[56:57], v4, s[8:11], s39 offen offset:0 sc1
    s_add_u32 s31, s31, 1
    s_cmp_lt_u32 s31, s30
    s_cselect_b32 s30, s30, 1
    s_cbranch_scc0 Vs2m_o
    s_waitcnt vmcnt(3)
    v_max3_u32 v58, v16, v17, v18
    v_max3_u32 v58, v58, v19, v20
    v_max3_u32 v58, v58, v21, v22
    v_max3_u32 v58, v58, v23, v56
    v_max_u32 v58, v58, v57
    v_cmp_eq_u32 vcc, -1, v58
    s_cbranch_vccnz Vs2m_l
Vs2m_o:
    ds_write_b128 v3, v[16:19] offset:8192
    ds_write_b128 v3, v[20:23] offset:9216
    ds_write_b64 v4, v[56:57]
    v_smfmac_f32_16x16x64_bf16 v[72:75], v[16:19], a[32:39], v5
    v_smfmac_f32_16x16x64_bf16 v[76:79], v[16:19], a[112:119], v5
    s_waitcnt lgkmcnt(0)
    s_barrier
    ds_read_b128 v[24:27], v3 offset:10240
    ds_read_b128 v[28:31], v3 offset:11264
    ds_read_b128 v[32:35], v3 offset:4096
    v_smfmac_f32_16x16x64_bf16 v[72:75], v[20:23], a[40:47], v5
    ds_read_b128 v[36:39], v3 offset:5120
    ds_read_b128 v[40:43], v3 offset:6144
    v_smfmac_f32_16x16x64_bf16 v[76:79], v[20:23], a[120:127], v5
    ds_read_b128 v[44:47], v3 offset:7168
    ds_read_b128 v[48:51], v3 offset:12288
    ds_read_b128 v[52:55], v3 offset:13312
    s_waitcnt lgkmcnt(7)
    v_smfmac_f32_16x16x64_bf16 v[72:75], v[24:27], a[48:55], v5
    v_smfmac_f32_16x16x64_bf16 v[76:79], v[24:27], a[128:135], v5
    s_waitcnt lgkmcnt(6)
    v_smfmac_f32_16x16x64_bf16 v[72:75], v[28:31], a[56:63], v5
    v_smfmac_f32_16x16x64_bf16 v[76:79], v[28:31], a[136:143], v5
    s_waitcnt lgkmcnt(5)
    v_smfmac_f32_16x16x64_bf16 v[72:75], v[32:35], a[0:7], v5
    v_smfmac_f32_16x16x64_bf16 v[76:79], v[32:35], a[80:87], v5
    s_waitcnt lgkmcnt(4)
    v_smfmac_f32_16x16x64_bf16 v[72:75], v[36:39], a[8:15], v5
    v_smfmac_f32_16x16x64_bf16 v[76:79], v[36:39], a[88:95], v5
    s_waitcnt lgkmcnt(3)
    v_smfmac_f32_16x16x64_bf16 v[72:75], v[40:43], a[16:23], v5
    v_smfmac_f32_16x16x64_bf16 v[76:79], v[40:43], a[96:103], v5
    s_waitcnt lgkmcnt(2)
    v_smfmac_f32_16x16x64_bf16 v[72:75], v[44:47], a[24:31], v5
    v_smfmac_f32_16x16x64_bf16 v[76:79], v[44:47], a[104:111], v5
    s_waitcnt lgkmcnt(1)
    v_smfmac_f32_16x16x64_bf16 v[72:75], v[48:51], a[64:71], v5
    buffer_store_dword v59, v14, s[8:11], s44 offen offset:0 sc1
    v_smfmac_f32_16x16x64_bf16 v[76:79], v[48:51], a[144:151], v5
    s_waitcnt lgkmcnt(0)
    v_smfmac_f32_16x16x64_bf16 v[72:75], v[52:55], a[72:79], v5
    v_smfmac_f32_16x16x64_bf16 v[76:79], v[52:55], a[152:159], v5
    s_nop 3
    v_cvt_pk_bf16_f32 v80, v72, v73
    v_cvt_pk_bf16_f32 v81, v74, v75
    s_nop 1
    v_cvt_pk_bf16_f32 v82, v76, v77
    v_cvt_pk_bf16_f32 v83, v78, v79
    s_nop 1
    v_mfma_f32_16x16x32_bf16 v[88:91], v[80:83], v[84:87], 0
    s_branch Vs_qj
Vs_q3:
    buffer_load_dwordx4 v[16:19], v3, s[8:11], s38 offen offset:0 sc1
    buffer_load_dwordx4 v[20:23], v3, s[8:11], s38 offen offset:1024 sc1
    buffer_load_dwordx2 v[56:57], v4, s[8:11], s39 offen offset:0 sc1
    s_mov_b32 s31, -1
Vs3m_l:
    buffer_load_dwordx4 v[16:19], v3, s[8:11], s38 offen offset:0 sc1
    buffer_load_dwordx4 v[20:23], v3, s[8:11], s38 offen offset:1024 sc1
    buffer_load_dwordx2 v[56:57], v4, s[8:11], s39 offen offset:0 sc1
    s_add_u32 s31, s31, 1
    s_cmp_lt_u32 s31, s30
    s_cselect_b32 s30, s30, 1
    s_cbranch_scc0 Vs3m_o
    s_waitcnt vmcnt(3)
    v_max3_u32 v58, v16, v17, v18
    v_max3_u32 v58, v58, v19, v20
    v_max3_u32 v58, v58, v21, v22
    v_max3_u32 v58, v58, v23, v56
    v_max_u32 v58, v58, v57
    v_cmp_eq_u32 vcc, -1, v58
    s_cbranch_vccnz Vs3m_l
Vs3m_o:
    ds_write_b128 v3, v[16:19] offset:8192
    ds_write_b128 v3, v[20:23] offset:9216
    ds_write_b64 v4, v[56:57]
    v_smfmac_f32_16x16x64_bf16 v[72:75], v[16:19], a[48:55], v5
    v_smfmac_f32_16x16x64_bf16 v[76:79], v[16:19], a[128:135], v5
    s_waitcnt lgkmcnt(0)
    s_barrier
    ds_read_b128 v[24:27], v3 offset:2048
    ds_read_b128 v[28:31], v3 offset:3072
    ds_read_b128 v[32:35], v3 offset:4096
    v_smfmac_f32_16x16x64_bf16 v[72:75], v[20:23], a[56:63], v5
    ds_read_b128 v[36:39], v3 offset:5120
    ds_read_b128 v[40:43], v3 offset:6144
    v_smfmac_f32_16x16x64_bf16 v[76:79], v[20:23], a[136:143], v5
    ds_read_b128 v[44:47], v3 offset:7168
    ds_read_b128 v[48:51], v3 offset:10240
    ds_read_b128 v[52:55], v3 offset:11264
    s_waitcnt lgkmcnt(7)
    v_smfmac_f32_16x16x64_bf16 v[72:75], v[24:27], a[0:7], v5
    v_smfmac_f32_16x16x64_bf16 v[76:79], v[24:27], a[80:87], v5
    s_waitcnt lgkmcnt(6)
    v_smfmac_f32_16x16x64_bf16 v[72:75], v[28:31], a[8:15], v5
    v_smfmac_f32_16x16x64_bf16 v[76:79], v[28:31], a[88:95], v5
    s_waitcnt lgkmcnt(5)
    v_smfmac_f32_16x16x64_bf16 v[72:75], v[32:35], a[16:23], v5
    v_smfmac_f32_16x16x64_bf16 v[76:79], v[32:35], a[96:103], v5
    s_waitcnt lgkmcnt(4)
    v_smfmac_f32_16x16x64_bf16 v[72:75], v[36:39], a[24:31], v5
    v_smfmac_f32_16x16x64_bf16 v[76:79], v[36:39], a[104:111], v5
    s_waitcnt lgkmcnt(3)
    v_smfmac_f32_16x16x64_bf16 v[72:75], v[40:43], a[32:39], v5
    v_smfmac_f32_16x16x64_bf16 v[76:79], v[40:43], a[112:119], v5
    s_waitcnt lgkmcnt(2)
    v_smfmac_f32_16x16x64_bf16 v[72:75], v[44:47], a[40:47], v5
    v_smfmac_f32_16x16x64_bf16 v[76:79], v[44:47], a[120:127], v5
    s_waitcnt lgkmcnt(1)
    v_smfmac_f32_16x16x64_bf16 v[72:75], v[48:51], a[64:71], v5
    buffer_store_dword v59, v14, s[8:11], s44 offen offset:0 sc1
    v_smfmac_f32_16x16x64_bf16 v[76:79], v[48:51], a[144:151], v5
    s_waitcnt lgkmcnt(0)
    v_smfmac_f32_16x16x64_bf16 v[72:75], v[52:55], a[72:79], v5
    v_smfmac_f32_16x16x64_bf16 v[76:79], v[52:55], a[152:159], v5
    s_nop 3
    v_cvt_pk_bf16_f32 v80, v72, v73
    v_cvt_pk_bf16_f32 v81, v74, v75
    s_nop 1
    v_cvt_pk_bf16_f32 v82, v76, v77
    v_cvt_pk_bf16_f32 v83, v78, v79
    s_nop 1
    v_mfma_f32_16x16x32_bf16 v[88:91], v[80:83], v[84:87], 0
Vs_qj:
    s_nop 7
    v_cvt_pk_bf16_f32 v94, v88, v89
    v_cvt_pk_bf16_f32 v95, v90, v91
    buffer_store_dwordx2 v[94:95], v6, s[8:11], s25 offen offset:0 sc1
    s_cmp_lt_u32 s32, 64
    s_cbranch_scc0 Vs_nb
    s_cmp_eq_u32 s32, 14
    s_cbranch_scc0 Vs_h
    s_mov_b32 s31, 0
    s_waitcnt vmcnt(63)
    s_branch VsB1_c
VsB1_l:
    buffer_load_dword v68, v67, s[8:11], s23 offen sc1
    s_waitcnt vmcnt(0)
VsB1_c:
    v_cmp_gt_u32 vcc, 1, v68
    s_cbranch_vccz VsB1_o
    s_sleep 4
    s_add_u32 s31, s31, 1
    s_cmp_lt_u32 s31, s30
    s_cbranch_scc1 VsB1_l
    s_mov_b32 s30, 1
VsB1_o:
    s_mov_b32 s31, 0
    s_waitcnt vmcnt(63)
    s_branch VsB2_c
VsB2_l:
    buffer_load_dword v69, v67, s[8:11], s47 offen sc1
    s_waitcnt vmcnt(0)
VsB2_c:
    v_cmp_gt_u32 vcc, 1, v69
    s_cbranch_vccz VsB2_o
    s_sleep 4
    s_add_u32 s31, s31, 1
    s_cmp_lt_u32 s31, s30
    s_cbranch_scc1 VsB2_l
    s_mov_b32 s30, 1
VsB2_o:
Vs_h:
    v_add_u32 v11, s29, v2
    s_xor_b32 s29, s29, 40960
    s_add_u32 s42, s29, s27
    ds_read_b128 a[160:163], v11 offset:0
    ds_read_b128 a[164:167], v11 offset:20480
    ds_read_b128 a[168:171], v11 offset:1024
    ds_read_b128 a[172:175], v11 offset:21504
    ds_read_b128 a[176:179], v11 offset:2048
    ds_read_b128 a[180:183], v11 offset:22528
    s_waitcnt lgkmcnt(5)
    v_mfma_f32_16x16x32_bf16 v[144:147], a[0:3], a[160:163], 0
    ds_read_b128 a[184:187], v11 offset:3072
    v_mfma_f32_16x16x32_bf16 v[152:155], a[80:83], a[160:163], 0
    s_waitcnt lgkmcnt(5)
    v_mfma_f32_16x16x32_bf16 v[148:151], a[0:3], a[164:167], 0
    ds_read_b128 a[188:191], v11 offset:23552
    v_mfma_f32_16x16x32_bf16 v[156:159], a[80:83], a[164:167], 0
    s_waitcnt lgkmcnt(5)
    v_mfma_f32_16x16x32_bf16 v[144:147], a[4:7], a[168:171], v[144:147]
    ds_read_b128 a[160:163], v11 offset:4096
    s_add_u32 s35, s28, 0
    s_add_u32 m0, s42, 0
    v_mfma_f32_16x16x32_bf16 v[152:155], a[84:87], a[168:171], v[152:155]
    buffer_load_dwordx4 v2, s[8:11], s35 offen offset:0 sc1 lds
    s_waitcnt lgkmcnt(5)
    v_mfma_f32_16x16x32_bf16 v[148:151], a[4:7], a[172:175], v[148:151]
    ds_read_b128 a[164:167], v11 offset:24576
    v_mfma_f32_16x16x32_bf16 v[156:159], a[84:87], a[172:175], v[156:159]
    s_waitcnt lgkmcnt(5)
    v_mfma_f32_16x16x32_bf16 v[144:147], a[8:11], a[176:179], v[144:147]
    ds_read_b128 a[168:171], v11 offset:5120
    v_mfma_f32_16x16x32_bf16 v[152:155], a[88:91], a[176:179], v[152:155]
    s_waitcnt lgkmcnt(5)
    v_mfma_f32_16x16x32_bf16 v[148:151], a[8:11], a[180:183], v[148:151]
    ds_read_b128 a[172:175], v11 offset:25600
    v_mfma_f32_16x16x32_bf16 v[156:159], a[88:91], a[180:183], v[156:159]
    buffer_load_dwordx4 v2, s[8:11], s35 offen offset:1024 sc1 lds
    s_waitcnt lgkmcnt(5)
    v_mfma_f32_16x16x32_bf16 v[144:147], a[12:15], a[184:187], v[144:147]
    ds_read_b128 a[176:179], v11 offset:6144
    v_mfma_f32_16x16x32_bf16 v[152:155], a[92:95], a[184:187], v[152:155]
    s_waitcnt lgkmcnt(5)
    v_mfma_f32_16x16x32_bf16 v[148:151], a[12:15], a[188:191], v[148:151]
    ds_read_b128 a[180:183], v11 offset:26624
    v_mfma_f32_16x16x32_bf16 v[156:159], a[92:95], a[188:191], v[156:159]
    s_waitcnt lgkmcnt(5)
    v_mfma_f32_16x16x32_bf16 v[144:147], a[16:19], a[160:163], v[144:147]
    ds_read_b128 a[184:187], v11 offset:7168
    v_mfma_f32_16x16x32_bf16 v[152:155], a[96:99], a[160:163], v[152:155]
    buffer_load_dwordx4 v2, s[8:11], s35 offen offset:2048 sc1 lds
    s_waitcnt lgkmcnt(5)
    v_mfma_f32_16x16x32_bf16 v[148:151], a[16:19], a[164:167], v[148:151]
    ds_read_b128 a[188:191], v11 offset:27648
    v_mfma_f32_16x16x32_bf16 v[156:159], a[96:99], a[164:167], v[156:159]
    s_waitcnt lgkmcnt(5)
    v_mfma_f32_16x16x32_bf16 v[144:147], a[20:23], a[168:171], v[144:147]
    ds_read_b128 a[160:163], v11 offset:8192
    v_mfma_f32_16x16x32_bf16 v[152:155], a[100:103], a[168:171], v[152:155]
    s_waitcnt lgkmcnt(5)
    v_mfma_f32_16x16x32_bf16 v[148:151], a[20:23], a[172:175], v[148:151]
    ds_read_b128 a[164:167], v11 offset:28672
    v_mfma_f32_16x16x32_bf16 v[156:159], a[100:103], a[172:175], v[156:159]
    buffer_load_dwordx4 v2, s[8:11], s35 offen offset:3072 sc1 lds
    s_waitcnt lgkmcnt(5)
    v_mfma_f32_16x16x32_bf16 v[144:147], a[24:27], a[176:179], v[144:147]
    ds_read_b128 a[168:171], v11 offset:9216
    v_mfma_f32_16x16x32_bf16 v[152:155], a[104:107], a[176:179], v[152:155]
    s_waitcnt lgkmcnt(5)
    v_mfma_f32_16x16x32_bf16 v[148:151], a[24:27], a[180:183], v[148:151]
    ds_read_b128 a[172:175], v11 offset:29696
    v_mfma_f32_16x16x32_bf16 v[156:159], a[104:107], a[180:183], v[156:159]
    s_waitcnt lgkmcnt(5)
    v_mfma_f32_16x16x32_bf16 v[144:147], a[28:31], a[184:187], v[144:147]
    ds_read_b128 a[176:179], v11 offset:10240
    s_add_u32 s35, s28, 4096
    s_add_u32 m0, s42, 4096
    v_mfma_f32_16x16x32_bf16 v[152:155], a[108:111], a[184:187], v[152:155]
    buffer_load_dwordx4 v2, s[8:11], s35 offen offset:0 sc1 lds
    s_waitcnt lgkmcnt(5)
    v_mfma_f32_16x16x32_bf16 v[148:151], a[28:31], a[188:191], v[148:151]
    ds_read_b128 a[180:183], v11 offset:30720
    v_mfma_f32_16x16x32_bf16 v[156:159], a[108:111], a[188:191], v[156:159]
    s_waitcnt lgkmcnt(5)
    v_mfma_f32_16x16x32_bf16 v[144:147], a[32:35], a[160:163], v[144:147]
    ds_read_b128 a[184:187], v11 offset:11264
    v_mfma_f32_16x16x32_bf16 v[152:155], a[112:115], a[160:163], v[152:155]
    s_waitcnt lgkmcnt(5)
    v_mfma_f32_16x16x32_bf16 v[148:151], a[32:35], a[164:167], v[148:151]
    ds_read_b128 a[188:191], v11 offset:31744
    v_mfma_f32_16x16x32_bf16 v[156:159], a[112:115], a[164:167], v[156:159]
    buffer_load_dwordx4 v2, s[8:11], s35 offen offset:1024 sc1 lds
    s_waitcnt lgkmcnt(5)
    v_mfma_f32_16x16x32_bf16 v[144:147], a[36:39], a[168:171], v[144:147]
    ds_read_b128 a[160:163], v11 offset:12288
    v_mfma_f32_16x16x32_bf16 v[152:155], a[116:119], a[168:171], v[152:155]
    s_waitcnt lgkmcnt(5)
    v_mfma_f32_16x16x32_bf16 v[148:151], a[36:39], a[172:175], v[148:151]
    ds_read_b128 a[164:167], v11 offset:32768
    v_mfma_f32_16x16x32_bf16 v[156:159], a[116:119], a[172:175], v[156:159]
    s_waitcnt lgkmcnt(5)
    v_mfma_f32_16x16x32_bf16 v[144:147], a[40:43], a[176:179], v[144:147]
    ds_read_b128 a[168:171], v11 offset:13312
    v_mfma_f32_16x16x32_bf16 v[152:155], a[120:123], a[176:179], v[152:155]
    buffer_load_dwordx4 v2, s[8:11], s35 offen offset:2048 sc1 lds
    s_waitcnt lgkmcnt(5)
    v_mfma_f32_16x16x32_bf16 v[148:151], a[40:43], a[180:183], v[148:151]
    ds_read_b128 a[172:175], v11 offset:33792
    v_mfma_f32_16x16x32_bf16 v[156:159], a[120:123], a[180:183], v[156:159]
    buffer_store_dwordx2 v[240:241], v6, s[8:11], s26 offen offset:0 sc1
    buffer_store_dwordx4 v[240:243], v7, s[8:11], s34 offen offset:0 sc1
    s_waitcnt lgkmcnt(5)
    v_mfma_f32_16x16x32_bf16 v[144:147], a[44:47], a[184:187], v[144:147]
    ds_read_b128 a[176:179], v11 offset:14336
    v_mfma_f32_16x16x32_bf16 v[152:155], a[124:127], a[184:187], v[152:155]
    s_waitcnt lgkmcnt(5)
    v_mfma_f32_16x16x32_bf16 v[148:151], a[44:47], a[188:191], v[148:151]
    ds_read_b128 a[180:183], v11 offset:34816
    v_mfma_f32_16x16x32_bf16 v[156:159], a[124:127], a[188:191], v[156:159]
    buffer_load_dwordx4 v2, s[8:11], s35 offen offset:3072 sc1 lds
    s_waitcnt lgkmcnt(5)
    v_mfma_f32_16x16x32_bf16 v[144:147], a[48:51], a[160:163], v[144:147]
    ds_read_b128 a[184:187], v11 offset:15360
    v_mfma_f32_16x16x32_bf16 v[152:155], a[128:131], a[160:163], v[152:155]
    s_waitcnt lgkmcnt(5)
    v_mfma_f32_16x16x32_bf16 v[148:151], a[48:51], a[164:167], v[148:151]
    ds_read_b128 a[188:191], v11 offset:35840
    v_mfma_f32_16x16x32_bf16 v[156:159], a[128:131], a[164:167], v[156:159]
    s_waitcnt lgkmcnt(5)
    v_mfma_f32_16x16x32_bf16 v[144:147], a[52:55], a[168:171], v[144:147]
    ds_read_b128 a[160:163], v11 offset:16384
    s_add_u32 s35, s28, 8192
    s_add_u32 m0, s42, 8192
    v_mfma_f32_16x16x32_bf16 v[152:155], a[132:135], a[168:171], v[152:155]
    buffer_load_dwordx4 v2, s[8:11], s35 offen offset:0 sc1 lds
    s_waitcnt lgkmcnt(5)
    v_mfma_f32_16x16x32_bf16 v[148:151], a[52:55], a[172:175], v[148:151]
    ds_read_b128 a[164:167], v11 offset:36864
    v_mfma_f32_16x16x32_bf16 v[156:159], a[132:135], a[172:175], v[156:159]
    s_waitcnt lgkmcnt(5)
    v_mfma_f32_16x16x32_bf16 v[144:147], a[56:59], a[176:179], v[144:147]
    ds_read_b128 a[168:171], v11 offset:17408
    v_mfma_f32_16x16x32_bf16 v[152:155], a[136:139], a[176:179], v[152:155]
    s_waitcnt lgkmcnt(5)
    v_mfma_f32_16x16x32_bf16 v[148:151], a[56:59], a[180:183], v[148:151]
    ds_read_b128 a[172:175], v11 offset:37888
    v_mfma_f32_16x16x32_bf16 v[156:159], a[136:139], a[180:183], v[156:159]
    buffer_load_dwordx4 v2, s[8:11], s35 offen offset:1024 sc1 lds
    s_waitcnt lgkmcnt(5)
    v_mfma_f32_16x16x32_bf16 v[144:147], a[60:63], a[184:187], v[144:147]
    ds_read_b128 a[176:179], v11 offset:18432
    v_mfma_f32_16x16x32_bf16 v[152:155], a[140:143], a[184:187], v[152:155]
    s_waitcnt lgkmcnt(5)
    v_mfma_f32_16x16x32_bf16 v[148:151], a[60:63], a[188:191], v[148:151]
    ds_read_b128 a[180:183], v11 offset:38912
    v_mfma_f32_16x16x32_bf16 v[156:159], a[140:143], a[188:191], v[156:159]
    s_waitcnt lgkmcnt(5)
    v_mfma_f32_16x16x32_bf16 v[144:147], a[64:67], a[160:163], v[144:147]
    ds_read_b128 a[184:187], v11 offset:19456
    v_mfma_f32_16x16x32_bf16 v[152:155], a[144:147], a[160:163], v[152:155]
    s_waitcnt lgkmcnt(5)
    v_mfma_f32_16x16x32_bf16 v[148:151], a[64:67], a[164:167], v[148:151]
    ds_read_b128 a[188:191], v11 offset:39936
    v_mfma_f32_16x16x32_bf16 v[156:159], a[144:147], a[164:167], v[156:159]
    s_waitcnt lgkmcnt(5)
    v_mfma_f32_16x16x32_bf16 v[144:147], a[68:71], a[168:171], v[144:147]
    v_mfma_f32_16x16x32_bf16 v[152:155], a[148:151], a[168:171], v[152:155]
    s_waitcnt lgkmcnt(4)
    v_mfma_f32_16x16x32_bf16 v[148:151], a[68:71], a[172:175], v[148:151]
    v_mfma_f32_16x16x32_bf16 v[156:159], a[148:151], a[172:175], v[156:159]
    s_waitcnt lgkmcnt(3)
    v_mfma_f32_16x16x32_bf16 v[144:147], a[72:75], a[176:179], v[144:147]
    v_mfma_f32_16x16x32_bf16 v[152:155], a[152:155], a[176:179], v[152:155]
    s_waitcnt lgkmcnt(2)
    v_mfma_f32_16x16x32_bf16 v[148:151], a[72:75], a[180:183], v[148:151]
    v_mfma_f32_16x16x32_bf16 v[156:159], a[152:155], a[180:183], v[156:159]
    s_waitcnt lgkmcnt(1)
    v_mfma_f32_16x16x32_bf16 v[144:147], a[76:79], a[184:187], v[144:147]
    v_mfma_f32_16x16x32_bf16 v[152:155], a[156:159], a[184:187], v[152:155]
    s_waitcnt lgkmcnt(0)
    v_mfma_f32_16x16x32_bf16 v[148:151], a[76:79], a[188:191], v[148:151]
    v_mfma_f32_16x16x32_bf16 v[156:159], a[156:159], a[188:191], v[156:159]
    s_add_u32 s28, s28, 40960
    s_add_u32 s32, s32, 1
    s_cmp_eq_u32 s32, 1
    s_cbranch_scc0 VsB0_o
    s_mov_b32 s31, 0
VsB0_l:
    buffer_load_dword v68, v70, s[8:11], s49 offen sc1
    s_waitcnt vmcnt(0)
VsB0_c:
    v_cmp_gt_u32 vcc, 1, v68
    s_cbranch_vccz VsB0_o
    s_sleep 2
    s_add_u32 s31, s31, 1
    s_cmp_lt_u32 s31, s30
    s_cbranch_scc1 VsB0_l
    s_mov_b32 s30, 1
VsB0_o:
    s_cmp_eq_u32 s32, 12
    s_cbranch_scc0 Vs_n12
    buffer_load_dword v68, v67, s[8:11], s23 offen offset:0 sc1
    buffer_load_dword v69, v67, s[8:11], s47 offen offset:0 sc1
Vs_n12:
    s_add_u32 s4, s32, 3
    s_and_b32 s4, s4, 3
    s_mul_i32 s4, s4, 49152
    s_add_u32 s4, s4, s43
    s_add_u32 s5, s4, 6144
    v_cvt_pk_bf16_f32 v160, v144, v145
    v_cvt_pk_bf16_f32 v161, v152, v153
    v_cvt_pk_bf16_f32 v162, v146, v147
    v_cvt_pk_bf16_f32 v163, v154, v155
    buffer_store_dwordx4 v[160:163], v2, s[8:11], s4 offen offset:0 sc1
    v_cvt_pk_bf16_f32 v164, v148, v149
    v_cvt_pk_bf16_f32 v165, v156, v157
    v_cvt_pk_bf16_f32 v166, v150, v151
    v_cvt_pk_bf16_f32 v167, v158, v159
    buffer_store_dwordx4 v[164:167], v2, s[8:11], s5 offen offset:0 sc1
    s_waitcnt vmcnt(0)
    v_mov_b32 v10, s32
    s_mov_b64 exec, 1
    buffer_store_dword v10, v9, s[8:11], s33 offen sc1
    s_mov_b64 exec, -1
    s_cmp_lt_u32 s32, 4
    s_cbranch_scc0 Vs_nb
    s_barrier
    s_branch Vs_h
Vs_nb:
    s_cmp_eq_u32 s21, 62
    s_cbranch_scc0 Vs_np
    s_barrier
    buffer_store_dwordx2 v[240:241], v6, s[8:11], s26 offen offset:0 sc1
    buffer_store_dwordx4 v[240:243], v7, s[8:11], s34 offen offset:0 sc1
Vs_np:
    s_cmp_lt_u32 s21, 63
    s_cbranch_scc1 Vs_loop
    s_cmp_eq_u32 s21, 64
    s_cbranch_scc1 V_t3
    s_load_dwordx2 s[88:89], s[0:1], 64
    s_mov_b32 s90, 1280
    s_mov_b32 s91, 0x20000
    s_waitcnt lgkmcnt(0)
    v_lshlrev_b32 v71, 2, v1
    v_lshlrev_b32 v70, 3, v1
    s_mov_b32 s4, 5120
    buffer_load_dwordx2 v[146:147], v70, s[8:11], s4 offen offset:0 sc1
    buffer_load_dwordx2 v[148:149], v70, s[8:11], s4 offen offset:512 sc1
    buffer_load_dwordx2 v[150:151], v70, s[8:11], s4 offen offset:1024 sc1
    buffer_load_dwordx2 v[152:153], v70, s[8:11], s4 offen offset:1536 sc1
    buffer_load_dwordx2 v[154:155], v70, s[8:11], s4 offen offset:2048 sc1
    s_mov_b32 s5, 7680
    s_mov_b32 s6, 10240
    s_mov_b32 s7, 12800
    buffer_load_dwordx2 v[100:101], v70, s[8:11], s5 offen offset:0 sc1
    buffer_load_dwordx2 v[110:111], v70, s[8:11], s6 offen offset:0 sc1
    buffer_load_dwordx2 v[120:121], v70, s[8:11], s7 offen offset:0 sc1
    buffer_load_dword v140, v71, s[88:91], 0 offen offset:0
    buffer_load_dwordx2 v[102:103], v70, s[8:11], s5 offen offset:512 sc1
    buffer_load_dwordx2 v[112:113], v70, s[8:11], s6 offen offset:512 sc1
    buffer_load_dwordx2 v[122:123], v70, s[8:11], s7 offen offset:512 sc1
    buffer_load_dword v141, v71, s[88:91], 0 offen offset:256
    buffer_load_dwordx2 v[104:105], v70, s[8:11], s5 offen offset:1024 sc1
    buffer_load_dwordx2 v[114:115], v70, s[8:11], s6 offen offset:1024 sc1
    buffer_load_dwordx2 v[124:125], v70, s[8:11], s7 offen offset:1024 sc1
    buffer_load_dword v142, v71, s[88:91], 0 offen offset:512
    buffer_load_dwordx2 v[106:107], v70, s[8:11], s5 offen offset:1536 sc1
    buffer_load_dwordx2 v[116:117], v70, s[8:11], s6 offen offset:1536 sc1
    buffer_load_dwordx2 v[126:127], v70, s[8:11], s7 offen offset:1536 sc1
    buffer_load_dword v143, v71, s[88:91], 0 offen offset:768
    buffer_load_dwordx2 v[108:109], v70, s[8:11], s5 offen offset:2048 sc1
    buffer_load_dwordx2 v[118:119], v70, s[8:11], s6 offen offset:2048 sc1
    buffer_load_dwordx2 v[128:129], v70, s[8:11], s7 offen offset:2048 sc1
    buffer_load_dword v144, v71, s[88:91], 0 offen offset:1024
    s_waitcnt vmcnt(0)
    v_add_f32 v110, 1.0, v110
    v_cvt_pk_bf16_f32 v110, v110, v110
    v_and_b32 v110, 0xffff0000, v110
    v_add_f32 v111, 1.0, v111
    v_cvt_pk_bf16_f32 v111, v111, v111
    v_and_b32 v111, 0xffff0000, v111
    v_add_f32 v112, 1.0, v112
    v_cvt_pk_bf16_f32 v112, v112, v112
    v_and_b32 v112, 0xffff0000, v112
    v_add_f32 v113, 1.0, v113
    v_cvt_pk_bf16_f32 v113, v113, v113
    v_and_b32 v113, 0xffff0000, v113
    v_add_f32 v114, 1.0, v114
    v_cvt_pk_bf16_f32 v114, v114, v114
    v_and_b32 v114, 0xffff0000, v114
    v_add_f32 v115, 1.0, v115
    v_cvt_pk_bf16_f32 v115, v115, v115
    v_and_b32 v115, 0xffff0000, v115
    v_add_f32 v116, 1.0, v116
    v_cvt_pk_bf16_f32 v116, v116, v116
    v_and_b32 v116, 0xffff0000, v116
    v_add_f32 v117, 1.0, v117
    v_cvt_pk_bf16_f32 v117, v117, v117
    v_and_b32 v117, 0xffff0000, v117
    v_add_f32 v118, 1.0, v118
    v_cvt_pk_bf16_f32 v118, v118, v118
    v_and_b32 v118, 0xffff0000, v118
    v_add_f32 v119, 1.0, v119
    v_cvt_pk_bf16_f32 v119, v119, v119
    v_and_b32 v119, 0xffff0000, v119
    v_lshlrev_b32 v130, 16, v140
    v_and_b32 v131, 0xffff0000, v140
    v_lshlrev_b32 v132, 16, v141
    v_and_b32 v133, 0xffff0000, v141
    v_lshlrev_b32 v134, 16, v142
    v_and_b32 v135, 0xffff0000, v142
    v_lshlrev_b32 v136, 16, v143
    v_and_b32 v137, 0xffff0000, v143
    v_lshlrev_b32 v138, 16, v144
    v_and_b32 v139, 0xffff0000, v144
    s_branch Vs_loop
V_t3:
    s_cmp_ge_u32 s20, 16
    s_cbranch_scc1 R_done
    s_waitcnt vmcnt(0)
    s_add_u32 s21, s20, 48
    s_lshl_b32 s96, s99, 2
    s_add_u32 s96, s96, s3
    v_lshlrev_b32 v71, 2, v1
    v_min_u32 v15, 39, v1
    v_lshlrev_b32 v15, 2, v15
    v_add_u32 v15, 155936, v15
    s_load_dwordx2 s[12:13], s[0:1], 0
    s_load_dwordx2 s[16:17], s[0:1], 112
    s_mov_b32 s14, 2621440
    s_mov_b32 s15, 0x20000
    s_mov_b32 s18, 2621440
    s_mov_b32 s19, 0x20000
    s_waitcnt lgkmcnt(0)
    v_lshrrev_b32 v16, 3, v1
    v_lshlrev_b32 v16, 10, v16
    v_and_b32 v17, 7, v1
    v_lshl_add_u32 v16, v17, 2, v16
    s_lshl_b32 s4, s96, 5
    v_add_u32 v16, s4, v16
    s_lshl_b32 s4, s21, 5
    s_add_u32 s4, s4, s96
    s_mul_i32 s24, s4, 1280
    s_add_u32 s25, s24, 59244544
    s_lshl_b32 s5, s4, 2
    s_add_u32 s5, s5, 16384
    s_lshl_b32 s6, s4, 7
    s_add_u32 s6, s6, 61636608
    s_cmp_lt_u32 s4, 1792
    s_cselect_b32 s42, s5, s6
    s_mul_i32 s35, s21, 524288
    s_add_u32 s35, s35, 23068672
    buffer_load_dword v140, v71, s[12:15], s24 offen offset:0
    buffer_load_dword v141, v71, s[12:15], s24 offen offset:256
    buffer_load_dword v142, v71, s[12:15], s24 offen offset:512
    buffer_load_dword v143, v71, s[12:15], s24 offen offset:768
    buffer_load_dword v144, v71, s[12:15], s24 offen offset:1024
    s_mov_b32 s31, 0
V3w_l:
    buffer_load_dword v18, v15, s[8:11], s22 offen sc1
    s_waitcnt vmcnt(0)
V3w_c:
    v_cmp_gt_u32 vcc, s21, v18
    s_cbranch_vccz V3w_o
    s_sleep 1
    s_add_u32 s31, s31, 1
    s_cmp_lt_u32 s31, s30
    s_cbranch_scc1 V3w_l
    s_mov_b32 s30, 1
V3w_o:
    s_mov_b32 s31, 0
V3p_l:
    s_add_u32 s4, s35, 0
    buffer_load_dword v184, v16, s[8:11], s4 offen offset:0 sc1
    s_add_u32 s4, s35, 8192
    buffer_load_dword v185, v16, s[8:11], s4 offen offset:0 sc1
    s_add_u32 s4, s35, 16384
    buffer_load_dword v186, v16, s[8:11], s4 offen offset:0 sc1
    s_add_u32 s4, s35, 24576
    buffer_load_dword v187, v16, s[8:11], s4 offen offset:0 sc1
    s_add_u32 s4, s35, 32768
    buffer_load_dword v188, v16, s[8:11], s4 offen offset:0 sc1
    s_add_u32 s4, s35, 40960
    buffer_load_dword v189, v16, s[8:11], s4 offen offset:0 sc1
    s_add_u32 s4, s35, 49152
    buffer_load_dword v190, v16, s[8:11], s4 offen offset:0 sc1
    s_add_u32 s4, s35, 57344
    buffer_load_dword v191, v16, s[8:11], s4 offen offset:0 sc1
    s_add_u32 s4, s35, 65536
    buffer_load_dword v192, v16, s[8:11], s4 offen offset:0 sc1
    s_add_u32 s4, s35, 73728
    buffer_load_dword v193, v16, s[8:11], s4 offen offset:0 sc1
    s_add_u32 s4, s35, 81920
    buffer_load_dword v194, v16, s[8:11], s4 offen offset:0 sc1
    s_add_u32 s4, s35, 90112
    buffer_load_dword v195, v16, s[8:11], s4 offen offset:0 sc1
    s_add_u32 s4, s35, 98304
    buffer_load_dword v196, v16, s[8:11], s4 offen offset:0 sc1
    s_add_u32 s4, s35, 106496
    buffer_load_dword v197, v16, s[8:11], s4 offen offset:0 sc1
    s_add_u32 s4, s35, 114688
    buffer_load_dword v198, v16, s[8:11], s4 offen offset:0 sc1
    s_add_u32 s4, s35, 122880
    buffer_load_dword v199, v16, s[8:11], s4 offen offset:0 sc1
    s_add_u32 s4, s35, 131072
    buffer_load_dword v200, v16, s[8:11], s4 offen offset:0 sc1
    s_add_u32 s4, s35, 139264
    buffer_load_dword v201, v16, s[8:11], s4 offen offset:0 sc1
    s_add_u32 s4, s35, 147456
    buffer_load_dword v202, v16, s[8:11], s4 offen offset:0 sc1
    s_add_u32 s4, s35, 155648
    buffer_load_dword v203, v16, s[8:11], s4 offen offset:0 sc1
    s_add_u32 s4, s35, 163840
    buffer_load_dword v204, v16, s[8:11], s4 offen offset:0 sc1
    s_add_u32 s4, s35, 172032
    buffer_load_dword v205, v16, s[8:11], s4 offen offset:0 sc1
    s_add_u32 s4, s35, 180224
    buffer_load_dword v206, v16, s[8:11], s4 offen offset:0 sc1
    s_add_u32 s4, s35, 188416
    buffer_load_dword v207, v16, s[8:11], s4 offen offset:0 sc1
    s_add_u32 s4, s35, 196608
    buffer_load_dword v208, v16, s[8:11], s4 offen offset:0 sc1
    s_add_u32 s4, s35, 204800
    buffer_load_dword v209, v16, s[8:11], s4 offen offset:0 sc1
    s_add_u32 s4, s35, 212992
    buffer_load_dword v210, v16, s[8:11], s4 offen offset:0 sc1
    s_add_u32 s4, s35, 221184
    buffer_load_dword v211, v16, s[8:11], s4 offen offset:0 sc1
    s_add_u32 s4, s35, 229376
    buffer_load_dword v212, v16, s[8:11], s4 offen offset:0 sc1
    s_add_u32 s4, s35, 237568
    buffer_load_dword v213, v16, s[8:11], s4 offen offset:0 sc1
    s_add_u32 s4, s35, 245760
    buffer_load_dword v214, v16, s[8:11], s4 offen offset:0 sc1
    s_add_u32 s4, s35, 253952
    buffer_load_dword v215, v16, s[8:11], s4 offen offset:0 sc1
    s_add_u32 s4, s35, 262144
    buffer_load_dword v216, v16, s[8:11], s4 offen offset:0 sc1
    s_add_u32 s4, s35, 270336
    buffer_load_dword v217, v16, s[8:11], s4 offen offset:0 sc1
    s_add_u32 s4, s35, 278528
    buffer_load_dword v218, v16, s[8:11], s4 offen offset:0 sc1
    s_add_u32 s4, s35, 286720
    buffer_load_dword v219, v16, s[8:11], s4 offen offset:0 sc1
    s_add_u32 s4, s35, 294912
    buffer_load_dword v220, v16, s[8:11], s4 offen offset:0 sc1
    s_add_u32 s4, s35, 303104
    buffer_load_dword v221, v16, s[8:11], s4 offen offset:0 sc1
    s_add_u32 s4, s35, 311296
    buffer_load_dword v222, v16, s[8:11], s4 offen offset:0 sc1
    s_add_u32 s4, s35, 319488
    buffer_load_dword v223, v16, s[8:11], s4 offen offset:0 sc1
    s_waitcnt vmcnt(0)
    v_max3_u32 v6, v184, v185, v186
    v_max3_u32 v6, v6, v187, v188
    v_max3_u32 v6, v6, v189, v190
    v_max3_u32 v6, v6, v191, v192
    v_max3_u32 v6, v6, v193, v194
    v_max3_u32 v6, v6, v195, v196
    v_max3_u32 v6, v6, v197, v198
    v_max3_u32 v6, v6, v199, v200
    v_max3_u32 v6, v6, v201, v202
    v_max3_u32 v6, v6, v203, v204
    v_max3_u32 v6, v6, v205, v206
    v_max3_u32 v6, v6, v207, v208
    v_max3_u32 v6, v6, v209, v210
    v_max3_u32 v6, v6, v211, v212
    v_max3_u32 v6, v6, v213, v214
    v_max3_u32 v6, v6, v215, v216
    v_max3_u32 v6, v6, v217, v218
    v_max3_u32 v6, v6, v219, v220
    v_max3_u32 v6, v6, v221, v222
    v_max_u32 v6, v6, v223
    v_cmp_eq_u32 vcc, -1, v6
    s_cbranch_vccz V3p_o
    s_sleep 1
    s_add_u32 s31, s31, 1
    s_cmp_lt_u32 s31, s30
    s_cbranch_scc1 V3p_l
    s_mov_b32 s30, 1
V3p_o:
    v_lshlrev_b32 v160, 16, v184
    v_and_b32 v161, 0xffff0000, v184
    v_lshlrev_b32 v162, 16, v186
    v_and_b32 v163, 0xffff0000, v186
    v_lshlrev_b32 v164, 16, v188
    v_and_b32 v165, 0xffff0000, v188
    v_lshlrev_b32 v166, 16, v190
    v_and_b32 v167, 0xffff0000, v190
    v_lshlrev_b32 v168, 16, v192
    v_and_b32 v169, 0xffff0000, v192
    v_lshlrev_b32 v6, 16, v185
    v_and_b32 v7, 0xffff0000, v185
    v_pk_add_f32 v[160:161], v[160:161], v[6:7]
    v_lshlrev_b32 v6, 16, v187
    v_and_b32 v7, 0xffff0000, v187
    v_pk_add_f32 v[162:163], v[162:163], v[6:7]
    v_lshlrev_b32 v6, 16, v189
    v_and_b32 v7, 0xffff0000, v189
    v_pk_add_f32 v[164:165], v[164:165], v[6:7]
    v_lshlrev_b32 v6, 16, v191
    v_and_b32 v7, 0xffff0000, v191
    v_pk_add_f32 v[166:167], v[166:167], v[6:7]
    v_lshlrev_b32 v6, 16, v193
    v_and_b32 v7, 0xffff0000, v193
    v_pk_add_f32 v[168:169], v[168:169], v[6:7]
    v_lshlrev_b32 v6, 16, v194
    v_and_b32 v7, 0xffff0000, v194
    v_pk_add_f32 v[160:161], v[160:161], v[6:7]
    v_lshlrev_b32 v6, 16, v196
    v_and_b32 v7, 0xffff0000, v196
    v_pk_add_f32 v[162:163], v[162:163], v[6:7]
    v_lshlrev_b32 v6, 16, v198
    v_and_b32 v7, 0xffff0000, v198
    v_pk_add_f32 v[164:165], v[164:165], v[6:7]
    v_lshlrev_b32 v6, 16, v200
    v_and_b32 v7, 0xffff0000, v200
    v_pk_add_f32 v[166:167], v[166:167], v[6:7]
    v_lshlrev_b32 v6, 16, v202
    v_and_b32 v7, 0xffff0000, v202
    v_pk_add_f32 v[168:169], v[168:169], v[6:7]
    v_lshlrev_b32 v6, 16, v195
    v_and_b32 v7, 0xffff0000, v195
    v_pk_add_f32 v[160:161], v[160:161], v[6:7]
    v_lshlrev_b32 v6, 16, v197
    v_and_b32 v7, 0xffff0000, v197
    v_pk_add_f32 v[162:163], v[162:163], v[6:7]
    v_lshlrev_b32 v6, 16, v199
    v_and_b32 v7, 0xffff0000, v199
    v_pk_add_f32 v[164:165], v[164:165], v[6:7]
    v_lshlrev_b32 v6, 16, v201
    v_and_b32 v7, 0xffff0000, v201
    v_pk_add_f32 v[166:167], v[166:167], v[6:7]
    v_lshlrev_b32 v6, 16, v203
    v_and_b32 v7, 0xffff0000, v203
    v_pk_add_f32 v[168:169], v[168:169], v[6:7]
    v_lshlrev_b32 v6, 16, v204
    v_and_b32 v7, 0xffff0000, v204
    v_pk_add_f32 v[160:161], v[160:161], v[6:7]
    v_lshlrev_b32 v6, 16, v206
    v_and_b32 v7, 0xffff0000, v206
    v_pk_add_f32 v[162:163], v[162:163], v[6:7]
    v_lshlrev_b32 v6, 16, v208
    v_and_b32 v7, 0xffff0000, v208
    v_pk_add_f32 v[164:165], v[164:165], v[6:7]
    v_lshlrev_b32 v6, 16, v210
    v_and_b32 v7, 0xffff0000, v210
    v_pk_add_f32 v[166:167], v[166:167], v[6:7]
    v_lshlrev_b32 v6, 16, v212
    v_and_b32 v7, 0xffff0000, v212
    v_pk_add_f32 v[168:169], v[168:169], v[6:7]
    v_lshlrev_b32 v6, 16, v205
    v_and_b32 v7, 0xffff0000, v205
    v_pk_add_f32 v[160:161], v[160:161], v[6:7]
    v_lshlrev_b32 v6, 16, v207
    v_and_b32 v7, 0xffff0000, v207
    v_pk_add_f32 v[162:163], v[162:163], v[6:7]
    v_lshlrev_b32 v6, 16, v209
    v_and_b32 v7, 0xffff0000, v209
    v_pk_add_f32 v[164:165], v[164:165], v[6:7]
    v_lshlrev_b32 v6, 16, v211
    v_and_b32 v7, 0xffff0000, v211
    v_pk_add_f32 v[166:167], v[166:167], v[6:7]
    v_lshlrev_b32 v6, 16, v213
    v_and_b32 v7, 0xffff0000, v213
    v_pk_add_f32 v[168:169], v[168:169], v[6:7]
    v_lshlrev_b32 v6, 16, v214
    v_and_b32 v7, 0xffff0000, v214
    v_pk_add_f32 v[160:161], v[160:161], v[6:7]
    v_lshlrev_b32 v6, 16, v216
    v_and_b32 v7, 0xffff0000, v216
    v_pk_add_f32 v[162:163], v[162:163], v[6:7]
    v_lshlrev_b32 v6, 16, v218
    v_and_b32 v7, 0xffff0000, v218
    v_pk_add_f32 v[164:165], v[164:165], v[6:7]
    v_lshlrev_b32 v6, 16, v220
    v_and_b32 v7, 0xffff0000, v220
    v_pk_add_f32 v[166:167], v[166:167], v[6:7]
    v_lshlrev_b32 v6, 16, v222
    v_and_b32 v7, 0xffff0000, v222
    v_pk_add_f32 v[168:169], v[168:169], v[6:7]
    v_lshlrev_b32 v6, 16, v215
    v_and_b32 v7, 0xffff0000, v215
    v_pk_add_f32 v[160:161], v[160:161], v[6:7]
    v_lshlrev_b32 v6, 16, v217
    v_and_b32 v7, 0xffff0000, v217
    v_pk_add_f32 v[162:163], v[162:163], v[6:7]
    v_lshlrev_b32 v6, 16, v219
    v_and_b32 v7, 0xffff0000, v219
    v_pk_add_f32 v[164:165], v[164:165], v[6:7]
    v_lshlrev_b32 v6, 16, v221
    v_and_b32 v7, 0xffff0000, v221
    v_pk_add_f32 v[166:167], v[166:167], v[6:7]
    v_lshlrev_b32 v6, 16, v223
    v_and_b32 v7, 0xffff0000, v223
    v_pk_add_f32 v[168:169], v[168:169], v[6:7]
    v_cvt_pk_bf16_f32 v161, v160, v161
    v_lshlrev_b32 v160, 16, v161
    v_and_b32 v161, 0xffff0000, v161
    v_mul_f32 v160, v160, v146
    v_mul_f32 v161, v161, v147
    v_cvt_pk_bf16_f32 v161, v160, v161
    v_lshlrev_b32 v160, 16, v161
    v_and_b32 v161, 0xffff0000, v161
    v_lshlrev_b32 v6, 16, v140
    v_and_b32 v7, 0xffff0000, v140
    v_add_f32 v160, v160, v6
    v_add_f32 v161, v161, v7
    v_cvt_pk_bf16_f32 v140, v160, v161
    v_cvt_pk_bf16_f32 v163, v162, v163
    v_lshlrev_b32 v162, 16, v163
    v_and_b32 v163, 0xffff0000, v163
    v_mul_f32 v162, v162, v148
    v_mul_f32 v163, v163, v149
    v_cvt_pk_bf16_f32 v163, v162, v163
    v_lshlrev_b32 v162, 16, v163
    v_and_b32 v163, 0xffff0000, v163
    v_lshlrev_b32 v6, 16, v141
    v_and_b32 v7, 0xffff0000, v141
    v_add_f32 v162, v162, v6
    v_add_f32 v163, v163, v7
    v_cvt_pk_bf16_f32 v141, v162, v163
    v_cvt_pk_bf16_f32 v165, v164, v165
    v_lshlrev_b32 v164, 16, v165
    v_and_b32 v165, 0xffff0000, v165
    v_mul_f32 v164, v164, v150
    v_mul_f32 v165, v165, v151
    v_cvt_pk_bf16_f32 v165, v164, v165
    v_lshlrev_b32 v164, 16, v165
    v_and_b32 v165, 0xffff0000, v165
    v_lshlrev_b32 v6, 16, v142
    v_and_b32 v7, 0xffff0000, v142
    v_add_f32 v164, v164, v6
    v_add_f32 v165, v165, v7
    v_cvt_pk_bf16_f32 v142, v164, v165
    v_cvt_pk_bf16_f32 v167, v166, v167
    v_lshlrev_b32 v166, 16, v167
    v_and_b32 v167, 0xffff0000, v167
    v_mul_f32 v166, v166, v152
    v_mul_f32 v167, v167, v153
    v_cvt_pk_bf16_f32 v167, v166, v167
    v_lshlrev_b32 v166, 16, v167
    v_and_b32 v167, 0xffff0000, v167
    v_lshlrev_b32 v6, 16, v143
    v_and_b32 v7, 0xffff0000, v143
    v_add_f32 v166, v166, v6
    v_add_f32 v167, v167, v7
    v_cvt_pk_bf16_f32 v143, v166, v167
    v_cvt_pk_bf16_f32 v169, v168, v169
    v_lshlrev_b32 v168, 16, v169
    v_and_b32 v169, 0xffff0000, v169
    v_mul_f32 v168, v168, v154
    v_mul_f32 v169, v169, v155
    v_cvt_pk_bf16_f32 v169, v168, v169
    v_lshlrev_b32 v168, 16, v169
    v_and_b32 v169, 0xffff0000, v169
    v_lshlrev_b32 v6, 16, v144
    v_and_b32 v7, 0xffff0000, v144
    v_add_f32 v168, v168, v6
    v_add_f32 v169, v169, v7
    v_cvt_pk_bf16_f32 v144, v168, v169
    v_lshlrev_b32 v160, 16, v140
    v_and_b32 v161, 0xffff0000, v140
    v_lshlrev_b32 v162, 16, v141
    v_and_b32 v163, 0xffff0000, v141
    v_lshlrev_b32 v164, 16, v142
    v_and_b32 v165, 0xffff0000, v142
    v_lshlrev_b32 v166, 16, v143
    v_and_b32 v167, 0xffff0000, v143
    v_lshlrev_b32 v168, 16, v144
    v_and_b32 v169, 0xffff0000, v144
    v_add_f32 v6, v160, v161
    v_add_f32 v6, v6, v162
    v_add_f32 v6, v6, v163
    v_add_f32 v6, v6, v164
    v_add_f32 v6, v6, v165
    v_add_f32 v6, v6, v166
    v_add_f32 v6, v6, v167
    v_add_f32 v6, v6, v168
    v_add_f32 v6, v6, v169
    s_nop 1
    v_add_f32 v6, v6, v6 row_ror:8 row_mask:0xf bank_mask:0xf
    s_nop 1
    v_add_f32 v6, v6, v6 row_ror:4 row_mask:0xf bank_mask:0xf
    s_nop 1
    v_add_f32 v6, v6, v6 row_ror:2 row_mask:0xf bank_mask:0xf
    s_nop 1
    v_add_f32 v6, v6, v6 row_ror:1 row_mask:0xf bank_mask:0xf
    v_mov_b32 v7, v6
    s_nop 1
    v_permlane16_swap_b32 v6, v7
    v_add_f32 v6, v6, v7
    v_mov_b32 v7, v6
    s_nop 1
    v_permlane32_swap_b32 v6, v7
    v_add_f32 v6, v6, v7
    v_mul_f32 v6, 0x3acccccd, v6
    v_sub_f32 v7, v160, v6
    v_mul_f32 v8, v7, v7
    v_sub_f32 v7, v161, v6
    v_fmac_f32 v8, v7, v7
    v_sub_f32 v7, v162, v6
    v_fmac_f32 v8, v7, v7
    v_sub_f32 v7, v163, v6
    v_fmac_f32 v8, v7, v7
    v_sub_f32 v7, v164, v6
    v_fmac_f32 v8, v7, v7
    v_sub_f32 v7, v165, v6
    v_fmac_f32 v8, v7, v7
    v_sub_f32 v7, v166, v6
    v_fmac_f32 v8, v7, v7
    v_sub_f32 v7, v167, v6
    v_fmac_f32 v8, v7, v7
    v_sub_f32 v7, v168, v6
    v_fmac_f32 v8, v7, v7
    v_sub_f32 v7, v169, v6
    v_fmac_f32 v8, v7, v7
    s_nop 1
    v_add_f32 v8, v8, v8 row_ror:8 row_mask:0xf bank_mask:0xf
    s_nop 1
    v_add_f32 v8, v8, v8 row_ror:4 row_mask:0xf bank_mask:0xf
    s_nop 1
    v_add_f32 v8, v8, v8 row_ror:2 row_mask:0xf bank_mask:0xf
    s_nop 1
    v_add_f32 v8, v8, v8 row_ror:1 row_mask:0xf bank_mask:0xf
    v_mov_b32 v7, v8
    s_nop 1
    v_permlane16_swap_b32 v8, v7
    v_add_f32 v8, v8, v7
    v_mov_b32 v7, v8
    s_nop 1
    v_permlane32_swap_b32 v8, v7
    v_add_f32 v8, v8, v7
    v_mul_f32 v8, 0x3acccccd, v8
    v_cvt_pk_bf16_f32 v8, v8, v8
    v_and_b32 v8, 0xffff0000, v8
    v_add_f32 v8, 0x3727c5ac, v8
    v_cvt_pk_bf16_f32 v8, v8, v8
    v_and_b32 v8, 0xffff0000, v8
    v_sqrt_f32 v8, v8
    s_nop 0
    v_cvt_pk_bf16_f32 v8, v8, v8
    v_and_b32 v8, 0xffff0000, v8
    v_rcp_f32 v8, v8
    v_cvt_pk_bf16_f32 v6, v6, v6
    v_and_b32 v6, 0xffff0000, v6
    v_sub_f32 v160, v160, v6
    v_sub_f32 v161, v161, v6
    v_cvt_pk_bf16_f32 v161, v160, v161
    v_lshlrev_b32 v160, 16, v161
    v_and_b32 v161, 0xffff0000, v161
    v_mul_f32 v160, v160, v8
    v_mul_f32 v161, v161, v8
    v_cvt_pk_bf16_f32 v161, v160, v161
    v_lshlrev_b32 v160, 16, v161
    v_and_b32 v161, 0xffff0000, v161
    v_sub_f32 v162, v162, v6
    v_sub_f32 v163, v163, v6
    v_cvt_pk_bf16_f32 v163, v162, v163
    v_lshlrev_b32 v162, 16, v163
    v_and_b32 v163, 0xffff0000, v163
    v_mul_f32 v162, v162, v8
    v_mul_f32 v163, v163, v8
    v_cvt_pk_bf16_f32 v163, v162, v163
    v_lshlrev_b32 v162, 16, v163
    v_and_b32 v163, 0xffff0000, v163
    v_sub_f32 v164, v164, v6
    v_sub_f32 v165, v165, v6
    v_cvt_pk_bf16_f32 v165, v164, v165
    v_lshlrev_b32 v164, 16, v165
    v_and_b32 v165, 0xffff0000, v165
    v_mul_f32 v164, v164, v8
    v_mul_f32 v165, v165, v8
    v_cvt_pk_bf16_f32 v165, v164, v165
    v_lshlrev_b32 v164, 16, v165
    v_and_b32 v165, 0xffff0000, v165
    v_sub_f32 v166, v166, v6
    v_sub_f32 v167, v167, v6
    v_cvt_pk_bf16_f32 v167, v166, v167
    v_lshlrev_b32 v166, 16, v167
    v_and_b32 v167, 0xffff0000, v167
    v_mul_f32 v166, v166, v8
    v_mul_f32 v167, v167, v8
    v_cvt_pk_bf16_f32 v167, v166, v167
    v_lshlrev_b32 v166, 16, v167
    v_and_b32 v167, 0xffff0000, v167
    v_sub_f32 v168, v168, v6
    v_sub_f32 v169, v169, v6
    v_cvt_pk_bf16_f32 v169, v168, v169
    v_lshlrev_b32 v168, 16, v169
    v_and_b32 v169, 0xffff0000, v169
    v_mul_f32 v168, v168, v8
    v_mul_f32 v169, v169, v8
    v_cvt_pk_bf16_f32 v169, v168, v169
    v_lshlrev_b32 v168, 16, v169
    v_and_b32 v169, 0xffff0000, v169
    v_mov_b32 v9, 0
    v_mul_f32 v160, v160, v110
    v_mul_f32 v161, v161, v111
    v_cvt_pk_bf16_f32 v161, v160, v161
    v_lshlrev_b32 v160, 16, v161
    v_and_b32 v161, 0xffff0000, v161
    v_add_f32 v160, v160, v100
    v_add_f32 v161, v161, v101
    v_cvt_pk_bf16_f32 v170, v160, v161
    buffer_store_dword v170, v71, s[8:11], s25 offen offset:0 sc1
    v_lshlrev_b32 v160, 16, v170
    v_and_b32 v161, 0xffff0000, v170
    v_fmac_f32 v9, v160, v130
    v_fmac_f32 v9, v161, v131
    v_mul_f32 v160, v160, v120
    v_mul_f32 v161, v161, v121
    v_cvt_pk_bf16_f32 v161, v160, v161
    v_lshlrev_b32 v160, 16, v161
    v_and_b32 v161, 0xffff0000, v161
    v_lshlrev_b32 v6, 16, v140
    v_and_b32 v7, 0xffff0000, v140
    v_add_f32 v160, v160, v6
    v_add_f32 v161, v161, v7
    v_cvt_pk_bf16_f32 v175, v160, v161
    buffer_store_dword v175, v71, s[16:19], s24 offen offset:0 sc1
    v_mul_f32 v162, v162, v112
    v_mul_f32 v163, v163, v113
    v_cvt_pk_bf16_f32 v163, v162, v163
    v_lshlrev_b32 v162, 16, v163
    v_and_b32 v163, 0xffff0000, v163
    v_add_f32 v162, v162, v102
    v_add_f32 v163, v163, v103
    v_cvt_pk_bf16_f32 v171, v162, v163
    buffer_store_dword v171, v71, s[8:11], s25 offen offset:256 sc1
    v_lshlrev_b32 v162, 16, v171
    v_and_b32 v163, 0xffff0000, v171
    v_fmac_f32 v9, v162, v132
    v_fmac_f32 v9, v163, v133
    v_mul_f32 v162, v162, v122
    v_mul_f32 v163, v163, v123
    v_cvt_pk_bf16_f32 v163, v162, v163
    v_lshlrev_b32 v162, 16, v163
    v_and_b32 v163, 0xffff0000, v163
    v_lshlrev_b32 v6, 16, v141
    v_and_b32 v7, 0xffff0000, v141
    v_add_f32 v162, v162, v6
    v_add_f32 v163, v163, v7
    v_cvt_pk_bf16_f32 v176, v162, v163
    buffer_store_dword v176, v71, s[16:19], s24 offen offset:256 sc1
    v_mul_f32 v164, v164, v114
    v_mul_f32 v165, v165, v115
    v_cvt_pk_bf16_f32 v165, v164, v165
    v_lshlrev_b32 v164, 16, v165
    v_and_b32 v165, 0xffff0000, v165
    v_add_f32 v164, v164, v104
    v_add_f32 v165, v165, v105
    v_cvt_pk_bf16_f32 v172, v164, v165
    buffer_store_dword v172, v71, s[8:11], s25 offen offset:512 sc1
    v_lshlrev_b32 v164, 16, v172
    v_and_b32 v165, 0xffff0000, v172
    v_fmac_f32 v9, v164, v134
    v_fmac_f32 v9, v165, v135
    v_mul_f32 v164, v164, v124
    v_mul_f32 v165, v165, v125
    v_cvt_pk_bf16_f32 v165, v164, v165
    v_lshlrev_b32 v164, 16, v165
    v_and_b32 v165, 0xffff0000, v165
    v_lshlrev_b32 v6, 16, v142
    v_and_b32 v7, 0xffff0000, v142
    v_add_f32 v164, v164, v6
    v_add_f32 v165, v165, v7
    v_cvt_pk_bf16_f32 v177, v164, v165
    buffer_store_dword v177, v71, s[16:19], s24 offen offset:512 sc1
    v_mul_f32 v166, v166, v116
    v_mul_f32 v167, v167, v117
    v_cvt_pk_bf16_f32 v167, v166, v167
    v_lshlrev_b32 v166, 16, v167
    v_and_b32 v167, 0xffff0000, v167
    v_add_f32 v166, v166, v106
    v_add_f32 v167, v167, v107
    v_cvt_pk_bf16_f32 v173, v166, v167
    buffer_store_dword v173, v71, s[8:11], s25 offen offset:768 sc1
    v_lshlrev_b32 v166, 16, v173
    v_and_b32 v167, 0xffff0000, v173
    v_fmac_f32 v9, v166, v136
    v_fmac_f32 v9, v167, v137
    v_mul_f32 v166, v166, v126
    v_mul_f32 v167, v167, v127
    v_cvt_pk_bf16_f32 v167, v166, v167
    v_lshlrev_b32 v166, 16, v167
    v_and_b32 v167, 0xffff0000, v167
    v_lshlrev_b32 v6, 16, v143
    v_and_b32 v7, 0xffff0000, v143
    v_add_f32 v166, v166, v6
    v_add_f32 v167, v167, v7
    v_cvt_pk_bf16_f32 v178, v166, v167
    buffer_store_dword v178, v71, s[16:19], s24 offen offset:768 sc1
    v_mul_f32 v168, v168, v118
    v_mul_f32 v169, v169, v119
    v_cvt_pk_bf16_f32 v169, v168, v169
    v_lshlrev_b32 v168, 16, v169
    v_and_b32 v169, 0xffff0000, v169
    v_add_f32 v168, v168, v108
    v_add_f32 v169, v169, v109
    v_cvt_pk_bf16_f32 v174, v168, v169
    buffer_store_dword v174, v71, s[8:11], s25 offen offset:1024 sc1
    v_lshlrev_b32 v168, 16, v174
    v_and_b32 v169, 0xffff0000, v174
    v_fmac_f32 v9, v168, v138
    v_fmac_f32 v9, v169, v139
    v_mul_f32 v168, v168, v128
    v_mul_f32 v169, v169, v129
    v_cvt_pk_bf16_f32 v169, v168, v169
    v_lshlrev_b32 v168, 16, v169
    v_and_b32 v169, 0xffff0000, v169
    v_lshlrev_b32 v6, 16, v144
    v_and_b32 v7, 0xffff0000, v144
    v_add_f32 v168, v168, v6
    v_add_f32 v169, v169, v7
    v_cvt_pk_bf16_f32 v179, v168, v169
    buffer_store_dword v179, v71, s[16:19], s24 offen offset:1024 sc1
    v_add_f32 v9, v9, v9 row_ror:8 row_mask:0xf bank_mask:0xf
    s_nop 1
    v_add_f32 v9, v9, v9 row_ror:4 row_mask:0xf bank_mask:0xf
    s_nop 1
    v_add_f32 v9, v9, v9 row_ror:2 row_mask:0xf bank_mask:0xf
    s_nop 1
    v_add_f32 v9, v9, v9 row_ror:1 row_mask:0xf bank_mask:0xf
    v_mov_b32 v6, v9
    s_nop 1
    v_permlane16_swap_b32 v9, v6
    v_add_f32 v9, v9, v6
    v_mov_b32 v6, v9
    s_nop 1
    v_permlane32_swap_b32 v9, v6
    v_add_f32 v9, v9, v6
    v_cvt_pk_bf16_f32 v9, v9, v9
    v_and_b32 v9, 0xffff0000, v9
    s_mov_b64 exec, 1
    buffer_store_dword v9, v71, s[8:11], s42 offen sc1
    s_mov_b64 exec, -1
    s_waitcnt vmcnt(0)
    s_add_u32 s4, s24, 56623104
    buffer_store_dword v140, v71, s[8:11], s4 offen offset:0 sc1
    buffer_store_dword v141, v71, s[8:11], s4 offen offset:256 sc1
    buffer_store_dword v142, v71, s[8:11], s4 offen offset:512 sc1
    buffer_store_dword v143, v71, s[8:11], s4 offen offset:768 sc1
    buffer_store_dword v144, v71, s[8:11], s4 offen offset:1024 sc1
    s_branch R_done
R_c:
    s_load_dwordx2 s[12:13], s[0:1], 40
    s_load_dwordx2 s[16:17], s[0:1], 8
    s_load_dwordx2 s[88:89], s[0:1], 0
    s_load_dwordx2 s[84:85], s[0:1], 96
    s_load_dwordx2 s[92:93], s[0:1], 104
    s_mov_b32 s14, 7864320
    s_mov_b32 s15, 0x20000
    s_mov_b32 s18, 10240
    s_mov_b32 s19, 0x20000
    s_mov_b32 s90, 2621440
    s_mov_b32 s91, 0x20000
    s_mov_b32 s86, 1280
    s_mov_b32 s87, 0x20000
    s_mov_b32 s94, 4915200
    s_mov_b32 s95, 0x20000
    s_waitcnt lgkmcnt(0)
    v_lshlrev_b32 v2, 4, v1
    v_lshlrev_b32 v4, 2, v1
    s_mul_i32 s4, s3, 320
    buffer_load_dword v244, v4, s[84:87], s4 offen
    buffer_load_dword v245, v4, s[84:87], s4 offen offset:256
    s_sub_u32 s98, s20, 18
    s_mul_i32 s28, s99, 10
    s_add_u32 s28, s28, s98
    v_lshrrev_b32 v14, 1, v1
    v_mul_u32_u24 v14, 7680, v14
    v_and_b32 v15, 1, v1
    v_lshl_add_u32 v14, v15, 4, v14
    s_mul_i32 s4, s3, 1228800
    s_lshl_b32 s5, s28, 5
    s_add_u32 s4, s4, s5
    s_mul_i32 s29, s3, 5120
    s_add_u32 s29, s29, 139264
    s_add_u32 m0, s29, 0
    s_nop 0
    buffer_load_dwordx4 v14, s[92:95], s4 offen  lds
    s_add_u32 s4, s4, 245760
    s_add_u32 m0, s29, 1024
    s_nop 0
    buffer_load_dwordx4 v14, s[92:95], s4 offen  lds
    s_add_u32 s4, s4, 245760
    s_add_u32 m0, s29, 2048
    s_nop 0
    buffer_load_dwordx4 v14, s[92:95], s4 offen  lds
    s_add_u32 s4, s4, 245760
    s_add_u32 m0, s29, 3072
    s_nop 0
    buffer_load_dwordx4 v14, s[92:95], s4 offen  lds
    s_add_u32 s4, s4, 245760
    s_add_u32 m0, s29, 4096
    s_nop 0
    buffer_load_dwordx4 v14, s[92:95], s4 offen  lds
    s_add_u32 s4, s4, 245760
    s_mul_i32 s42, s99, 983040
    s_lshl_b32 s4, s98, 7
    s_add_u32 s42, s42, s4
    s_add_u32 s21, s28, 32
    s_lshl_b32 s98, s98, 2
    s_add_u32 s98, s98, s3
    s_mul_i32 s4, s3, 5120
    s_add_u32 s23, s4, 98304
    s_mul_i32 s26, s21, 20480
    s_add_u32 s26, s26, s4
    v_and_b32 v16, 7, v1
    v_lshrrev_b32 v17, 4, v1
    v_mul_u32_u24 v19, 1280, v16
    v_lshl_add_u32 v19, v17, 3, v19
    s_lshl_b32 s4, s98, 5
    buffer_load_dwordx2 v[24:25], v19, s[16:19], s4 offen
    s_lshl_b32 s37, s3, 11
    s_lshl_b32 s4, s3, 4
    s_and_b32 s5, s3, 1
    s_lshl_b32 s5, s5, 1
    v_lshrrev_b32 v60, 3, v1
    v_and_b32 v61, 1, v60
    v_or_b32 v61, s5, v61
    v_add_u32 v60, s4, v60
    v_mul_u32_u24 v13, 1280, v60
    v_bfe_u32 v60, v1, 1, 2
    v_xor_b32 v60, v60, v61
    v_lshlrev_b32 v60, 5, v60
    v_and_b32 v61, 1, v1
    v_lshlrev_b32 v61, 4, v61
    v_add3_u32 v13, v13, v60, v61
    v_lshrrev_b32 v60, 4, v1
    v_lshlrev_b32 v60, 2, v60
    v_bfe_u32 v61, v1, 2, 1
    v_add_u32 v60, v60, v61
    v_bfe_u32 v61, v1, 3, 1
    v_lshlrev_b32 v61, 4, v61
    v_add_u32 v60, v60, v61
    v_lshlrev_b32 v0, 7, v60
    v_bfe_u32 v60, v1, 2, 2
    v_lshlrev_b32 v60, 5, v60
    v_and_b32 v61, 3, v1
    v_lshlrev_b32 v61, 3, v61
    v_add3_u32 v0, v0, v60, v61
    v_mov_b32 v134, 163776
    s_cmp_lg_u32 s3, 0
    s_cbranch_scc1 CC_c
    s_waitcnt vmcnt(8)
    v_readfirstlane_b32 s4, v135
    s_and_b32 s4, s4, s33
    s_nop 0
    v_mov_b32 v135, s4
    ds_write_b32 v134, v135
    s_waitcnt lgkmcnt(0)
CC_c:
    s_barrier
    ds_read_b32 v135, v134
    s_waitcnt lgkmcnt(0)
    v_readfirstlane_b32 s4, v135
    s_cmp_lg_u32 s4, 0
    s_cbranch_scc1 R_ovf
    s_load_dwordx2 s[16:17], s[0:1], 120
    s_mov_b32 s18, 256
    s_mov_b32 s19, 0x20000
    s_waitcnt lgkmcnt(0)
    s_mul_i32 s22, s99, 1048576
    s_add_u32 s22, s22, 8388608
    s_lshl_b32 s33, s20, 4
    s_lshl_b32 s4, s3, 2
    s_add_u32 s33, s33, s4
    s_add_u32 s33, s33, s22
    s_add_u32 s33, s33, 155648
    s_mov_b32 s48, 0xfffffffe
    v_mov_b32 v9, 0
    v_mov_b32 v240, -1
    v_mov_b32 v241, -1
    v_mov_b32 v242, -1
    v_mov_b32 v243, -1
    s_lshl_b32 s40, s3, 9
    s_add_u32 s40, s40, 159744
    s_waitcnt vmcnt(6)
    v_lshrrev_b32 v10, 4, v1
    v_lshlrev_b32 v10, 6, v10
    v_bfe_u32 v11, v1, 1, 2
    v_lshl_add_u32 v10, v11, 4, v10
    v_and_b32 v11, 1, v1
    v_lshl_add_u32 v10, v11, 3, v10
    v_bfe_u32 v11, v1, 3, 1
    v_lshl_add_u32 v10, v11, 2, v10
    v_add_u32 v10, s40, v10
    v_lshlrev_b32 v6, 16, v244
    v_and_b32 v7, 0xffff0000, v244
    v_lshlrev_b32 v8, 16, v245
    v_and_b32 v9, 0xffff0000, v245
    v_mul_f32 v16, 0xbfb8aa3b, v6
    v_mul_f32 v17, 0xbfb8aa3b, v7
    v_mul_f32 v18, 0xbfb8aa3b, v8
    v_mul_f32 v19, 0xbfb8aa3b, v9
    v_exp_f32 v16, v16
    v_exp_f32 v17, v17
    v_exp_f32 v18, v18
    v_exp_f32 v19, v19
    v_add_f32 v16, 1.0, v16
    v_add_f32 v17, 1.0, v17
    v_add_f32 v18, 1.0, v18
    v_add_f32 v19, 1.0, v19
    v_rcp_f32 v16, v16
    v_rcp_f32 v17, v17
    v_rcp_f32 v18, v18
    v_rcp_f32 v19, v19
    v_mul_f32 v6, v6, v16
    v_mul_f32 v7, v7, v17
    v_mul_f32 v8, v8, v18
    v_mul_f32 v9, v9, v19
    v_cvt_pk_bf16_f32 v4, v6, v7
    v_cvt_pk_bf16_f32 v5, v8, v9
    v_and_b32 v11, 0x30, v1
    v_add_u32 v11, s40, v11
    ds_write_b32 v10, v4
    ds_write_b32 v10, v5 offset:256
    s_waitcnt lgkmcnt(0)
    ds_read_b128 v[220:223], v11 offset:0
    ds_read_b128 v[224:227], v11 offset:64
    ds_read_b128 v[228:231], v11 offset:128
    ds_read_b128 v[232:235], v11 offset:192
    ds_read_b128 v[236:239], v11 offset:256
    v_mov_b32 v26, 0
    s_waitcnt vmcnt(1)
    s_cmp_lg_u32 s3, 0
    s_cbranch_scc1 CD_i
    v_and_b32 v26, 7, v1
    v_lshlrev_b32 v26, 5, v26
    buffer_load_dwordx4 v[28:31], v26, s[16:19], 0 offen sc1
CD_i:
    v_lshrrev_b32 v14, 4, v1
    v_lshlrev_b32 v14, 2, v14
    v_bfe_u32 v15, v1, 2, 1
    v_add_u32 v14, v14, v15
    v_bfe_u32 v15, v1, 3, 1
    v_lshl_add_u32 v14, v15, 4, v14
    v_lshlrev_b32 v14, 5, v14
    v_and_b32 v15, 3, v1
    v_lshl_add_u32 v14, v15, 3, v14
    v_add_u32 v14, s29, v14
    ds_read_b64_tr_b16 v[40:41], v14 offset:0
    ds_read_b64_tr_b16 v[42:43], v14 offset:64
    ds_read_b64_tr_b16 v[44:45], v14 offset:1024
    ds_read_b64_tr_b16 v[46:47], v14 offset:1088
    ds_read_b64_tr_b16 v[48:49], v14 offset:2048
    ds_read_b64_tr_b16 v[50:51], v14 offset:2112
    ds_read_b64_tr_b16 v[52:53], v14 offset:3072
    ds_read_b64_tr_b16 v[54:55], v14 offset:3136
    ds_read_b64_tr_b16 v[56:57], v14 offset:4096
    ds_read_b64_tr_b16 v[58:59], v14 offset:4160
    v_and_b32 v15, 0x30, v1
    v_add_u32 v15, s29, v15
    s_waitcnt lgkmcnt(0)
    v_mfma_f32_16x16x32_bf16 v[16:19], v[40:43], v[220:223], 0
    v_mfma_f32_16x16x32_bf16 v[16:19], v[44:47], v[224:227], v[16:19]
    v_mfma_f32_16x16x32_bf16 v[16:19], v[48:51], v[228:231], v[16:19]
    v_mfma_f32_16x16x32_bf16 v[16:19], v[52:55], v[232:235], v[16:19]
    v_mfma_f32_16x16x32_bf16 v[16:19], v[56:59], v[236:239], v[16:19]
    s_mov_b32 exec_lo, 0x00010001
    s_mov_b32 exec_hi, 0x00010001
    s_nop 5
    ds_write_b128 v15, v[16:19]
    s_mov_b64 exec, -1
    s_waitcnt lgkmcnt(0)
    s_barrier
    s_cmp_lg_u32 s3, 0
    s_cbranch_scc1 CD_r
    v_lshlrev_b32 v14, 2, v1
    v_add_u32 v15, 139264, v14
    ds_read_b32 v16, v15 offset:0
    ds_read_b32 v17, v15 offset:5120
    ds_read_b32 v18, v15 offset:10240
    ds_read_b32 v19, v15 offset:15360
    s_mov_b32 s31, 0
    s_waitcnt vmcnt(0)
    s_branch CK_c
CK_l:
    buffer_load_dwordx4 v[28:31], v26, s[16:19], 0 offen sc1
    s_waitcnt vmcnt(0)
CK_c:
    v_bcnt_u32_b32 v27, v28, v31
    v_cmp_lt_u32 s[4:5], 32, v27
    s_and_b32 s6, s4, 0xff
    v_cmp_ne_u32 s[4:5], 32, v27
    s_cmp_eq_u32 s6, 0
    s_cselect_b32 s5, 0xff, 0
    s_and_b32 s4, s4, s5
    v_cmp_gt_u32 vcc, 22, v29
    s_and_b32 vcc_lo, vcc_lo, 0xff
    s_or_b32 vcc_lo, vcc_lo, s4
    s_mov_b32 vcc_hi, 0
    s_cbranch_vccz CK_o
    s_sleep 16
    s_add_u32 s31, s31, 1
    s_cmp_lt_u32 s31, s30
    s_cbranch_scc1 CK_l
    s_mov_b32 s30, 1
CK_o:
    s_mov_b32 s97, s6
    v_bfe_u32 v15, v1, 2, 2
    v_lshlrev_b32 v15, 4, v15
    v_bfe_u32 v20, v1, 1, 1
    v_lshl_add_u32 v15, v20, 3, v15
    s_lshr_b32 s5, s28, 1
    s_lshl_b32 s5, s5, 6
    s_and_b32 s6, s28, 1
    s_lshl_b32 s6, s6, 2
    s_add_u32 s5, s5, s6
    s_add_u32 s5, s5, 32768
    s_lshl_b32 s4, s28, 6
    s_add_u32 s4, s4, 0
    s_cmp_ge_u32 s28, 40
    s_cselect_b32 s7, 1.0, 0
    s_waitcnt lgkmcnt(0)
    v_add_f32 v16, v16, v17
    v_add_f32 v18, v18, v19
    v_add_f32 v16, v16, v18
    v_cvt_pk_bf16_f32 v16, v16, v16
    v_and_b32 v16, 0xffff0000, v16
    v_add_f32 v18, s7, v16
    s_nop 1
    v_mov_b32 v17, v18 quad_perm:[1,1,3,3] row_mask:0xf bank_mask:0xf
    v_cvt_pk_bf16_f32 v17, v18, v17
    s_mov_b64 exec, 0x5555
    buffer_store_dword v17, v15, s[8:11], s5 offen sc1
    s_mov_b64 exec, 0xffff
    buffer_store_dword v16, v14, s[8:11], s4 offen sc1
    s_mov_b64 exec, -1
CD_r:
    v_mov_b32 v9, 0
    v_and_b32 v16, 7, v1
    v_lshrrev_b32 v17, 4, v1
    v_bfe_u32 v18, v1, 3, 1
    s_sub_u32 s4, s20, 18
    s_lshl_b32 s4, s4, 9
    s_add_u32 s43, s4, 2801664
    s_lshl_b32 s4, s99, 6
    s_add_u32 s24, s43, s4
    s_and_b32 s4, s99, 3
    s_lshl_b32 s4, s4, 14
    s_add_u32 s43, s43, s4
    s_lshl_b32 s4, s3, 7
    s_add_u32 s43, s43, s4
    s_cmp_eq_u32 s3, 3
    s_cselect_b32 s4, 8, 0
    s_cselect_b32 s44, 255, 0
    s_mov_b32 s45, 0
    v_lshrrev_b32 v198, 0, v1
    v_lshlrev_b32 v198, 13, v198
    v_and_b32 v19, 0, v2
    v_add_u32 v198, v198, v19
    v_mov_b32 v19, 0x80000000
    v_cmp_gt_u32 vcc, s4, v1
    s_nop 1
    v_cndmask_b32 v198, v19, v198, vcc
    s_lshr_b32 s4, s98, 1
    s_lshl_b32 s5, s4, 9
    s_and_b32 s6, s98, 1
    s_lshl_b32 s7, s6, 7
    s_add_u32 s5, s5, s7
    v_lshrrev_b32 v19, 1, v17
    v_lshlrev_b32 v6, 8, v19
    v_lshl_add_u32 v6, v16, 4, v6
    v_and_b32 v19, 1, v17
    v_lshl_add_u32 v6, v19, 3, v6
    v_add_u32 v6, s5, v6
    v_mov_b32 v19, 0x80000000
    v_cmp_ne_u32 vcc, 0, v18
    s_nop 1
    v_cndmask_b32 v6, v6, v19, vcc
    s_lshr_b32 s4, s98, 2
    s_lshl_b32 s4, s4, 14
    s_lshl_b32 s6, s3, 11
    s_add_u32 s4, s4, s6
    v_add_u32 v8, s4, v2
    v_lshrrev_b32 v19, 1, v17
    v_lshlrev_b32 v7, 7, v19
    v_lshl_add_u32 v7, v16, 4, v7
    v_and_b32 v19, 1, v17
    v_lshl_add_u32 v7, v19, 3, v7
    v_lshl_add_u32 v7, v18, 13, v7
    s_lshl_b32 s6, s99, 8
    s_add_u32 s4, s4, s6
    v_add_u32 v7, s4, v7
    v_and_b32 v19, 15, v1
    v_lshlrev_b32 v12, 5, v19
    v_lshl_add_u32 v12, v17, 3, v12
    s_and_b32 s4, s99, 3
    s_mul_i32 s34, s4, 81920
    s_lshr_b32 s4, s98, 3
    s_lshl_b32 s4, s4, 14
    s_add_u32 s34, s34, s4
    s_and_b32 s4, s98, 7
    s_lshl_b32 s4, s4, 10
    s_add_u32 s34, s34, s4
    s_add_u32 s34, s34, 23068672
    s_mov_b64 exec, -1
    s_add_u32 s4, s22, 10240
    s_add_u32 s5, s4, 10240
    buffer_store_dwordx2 v[240:241], v6, s[8:11], s4 offen offset:0 sc1
    buffer_store_dwordx2 v[240:241], v6, s[8:11], s5 offen offset:0 sc1
    s_mov_b32 s4, 2097152
    buffer_store_dwordx2 v[240:241], v7, s[8:11], s4 offen offset:0 sc1
    s_mov_b32 s4, 2260992
    buffer_store_dwordx2 v[240:241], v7, s[8:11], s4 offen offset:0 sc1
    s_mul_i32 s4, s99, 40
    s_add_u32 s4, s4, s98
    s_cmp_lt_u32 s4, 88
    s_cselect_b64 exec, -1, 0
    s_lshl_b32 s4, s4, 10
    s_cmp_lt_u32 s4, 8192
    s_mov_b32 s5, 61857792
    s_cselect_b32 s5, 16384, s5
    s_add_u32 s4, s4, s5
    buffer_store_dwordx4 v[240:243], v2, s[8:11], s4 offen offset:0 sc1
    s_mov_b64 exec, -1
    v_mov_b32 v10, 0
    s_mov_b64 exec, 1
    buffer_store_dword v10, v9, s[8:11], s33 offen sc1
    s_mov_b64 exec, -1
    buffer_store_dword v9, v198, s[8:11], s24 offen offset:0 sc1
    s_lshl_b32 s4, s21, 7
    s_add_u32 s4, s4, 65536
    v_mov_b32 v16, 0
    v_lshlrev_b32 v17, 2, v1
    s_cmp_eq_u32 s3, 0
    s_cselect_b64 exec, 1, 0
    buffer_store_dword v16, v17, s[8:11], s4 offen sc1
    s_mov_b64 exec, -1
    s_waitcnt vmcnt(8)
    v_min_u32 v24, s48, v24
    v_min_u32 v25, s48, v25
    buffer_store_dwordx2 v[24:25], v6, s[8:11], s22 offen offset:0 sc1
    s_add_u32 s4, s26, 0
    s_add_u32 m0, s23, 0
    s_nop 0
    buffer_load_dwordx4 v2, s[88:91], s4 offen offset:0 nt lds
    buffer_load_dwordx4 v2, s[88:91], s4 offen offset:1024 nt lds
    buffer_load_dwordx4 v2, s[88:91], s4 offen offset:2048 nt lds
    buffer_load_dwordx4 v2, s[88:91], s4 offen offset:3072 nt lds
    s_add_u32 s4, s26, 4096
    s_add_u32 m0, s23, 4096
    s_nop 0
    buffer_load_dwordx4 v2, s[88:91], s4 offen offset:0 nt lds
    s_add_u32 s4, s26, 1638400
    s_add_u32 m0, s23, 20480
    s_nop 0
    buffer_load_dwordx4 v2, s[88:91], s4 offen offset:0 nt lds
    buffer_load_dwordx4 v2, s[88:91], s4 offen offset:1024 nt lds
    buffer_load_dwordx4 v2, s[88:91], s4 offen offset:2048 nt lds
    buffer_load_dwordx4 v2, s[88:91], s4 offen offset:3072 nt lds
    s_add_u32 s4, s26, 1642496
    s_add_u32 m0, s23, 24576
    s_nop 0
    buffer_load_dwordx4 v2, s[88:91], s4 offen offset:0 nt lds
    s_waitcnt vmcnt(10)
    s_barrier
    s_cmp_lg_u32 s3, 0
    s_cbranch_scc1 CA_n
    s_lshl_b32 s4, s99, 5
    s_add_u32 s4, s4, 8
    v_mov_b32 v16, 0
    v_mov_b32 v17, 1
    s_mov_b64 exec, 1
    buffer_atomic_add v17, v16, s[16:19], s4 offen sc1
    s_mov_b64 exec, -1
CA_n:
    s_add_u32 s4, s42, 0
    s_add_u32 m0, s37, 0
    s_nop 0
    buffer_load_dwordx4 v13, s[12:15], s4 offen nt lds
    s_add_u32 s4, s42, 10240
    s_add_u32 m0, s37, 1024
    s_nop 0
    buffer_load_dwordx4 v13, s[12:15], s4 offen nt lds
    s_add_u32 s4, s42, 81920
    s_add_u32 m0, s37, 8192
    s_nop 0
    buffer_load_dwordx4 v13, s[12:15], s4 offen nt lds
    s_add_u32 s4, s42, 92160
    s_add_u32 m0, s37, 9216
    s_nop 0
    buffer_load_dwordx4 v13, s[12:15], s4 offen nt lds
    s_add_u32 s4, s42, 163840
    s_add_u32 m0, s37, 16384
    s_nop 0
    buffer_load_dwordx4 v13, s[12:15], s4 offen nt lds
    s_add_u32 s4, s42, 174080
    s_add_u32 m0, s37, 17408
    s_nop 0
    buffer_load_dwordx4 v13, s[12:15], s4 offen nt lds
    s_add_u32 s4, s42, 245760
    s_add_u32 m0, s37, 24576
    s_nop 0
    buffer_load_dwordx4 v13, s[12:15], s4 offen nt lds
    s_add_u32 s4, s42, 256000
    s_add_u32 m0, s37, 25600
    s_nop 0
    buffer_load_dwordx4 v13, s[12:15], s4 offen nt lds
    s_add_u32 s4, s42, 327680
    s_add_u32 m0, s37, 32768
    s_nop 0
    buffer_load_dwordx4 v13, s[12:15], s4 offen nt lds
    s_add_u32 s4, s42, 337920
    s_add_u32 m0, s37, 33792
    s_nop 0
    buffer_load_dwordx4 v13, s[12:15], s4 offen nt lds
    s_add_u32 s4, s42, 409600
    s_add_u32 m0, s37, 40960
    s_nop 0
    buffer_load_dwordx4 v13, s[12:15], s4 offen nt lds
    s_add_u32 s4, s42, 419840
    s_add_u32 m0, s37, 41984
    s_nop 0
    buffer_load_dwordx4 v13, s[12:15], s4 offen nt lds
    s_add_u32 s4, s42, 491520
    s_add_u32 m0, s37, 49152
    s_nop 0
    buffer_load_dwordx4 v13, s[12:15], s4 offen nt lds
    s_add_u32 s4, s42, 501760
    s_add_u32 m0, s37, 50176
    s_nop 0
    buffer_load_dwordx4 v13, s[12:15], s4 offen nt lds
    s_add_u32 s4, s42, 573440
    s_add_u32 m0, s37, 57344
    s_nop 0
    buffer_load_dwordx4 v13, s[12:15], s4 offen nt lds
    s_add_u32 s4, s42, 583680
    s_add_u32 m0, s37, 58368
    s_nop 0
    buffer_load_dwordx4 v13, s[12:15], s4 offen nt lds
    s_add_u32 s4, s42, 655360
    s_add_u32 m0, s37, 65536
    s_nop 0
    buffer_load_dwordx4 v13, s[12:15], s4 offen nt lds
    s_add_u32 s4, s42, 665600
    s_add_u32 m0, s37, 66560
    s_nop 0
    buffer_load_dwordx4 v13, s[12:15], s4 offen nt lds
    s_add_u32 s4, s42, 737280
    s_add_u32 m0, s37, 73728
    s_nop 0
    buffer_load_dwordx4 v13, s[12:15], s4 offen nt lds
    s_add_u32 s4, s42, 747520
    s_add_u32 m0, s37, 74752
    s_nop 0
    buffer_load_dwordx4 v13, s[12:15], s4 offen nt lds
    s_add_u32 s4, s42, 819200
    s_add_u32 m0, s37, 81920
    s_nop 0
    buffer_load_dwordx4 v13, s[12:15], s4 offen nt lds
    s_add_u32 s4, s42, 829440
    s_add_u32 m0, s37, 82944
    s_nop 0
    buffer_load_dwordx4 v13, s[12:15], s4 offen nt lds
    s_add_u32 s4, s42, 901120
    s_add_u32 m0, s37, 90112
    s_nop 0
    buffer_load_dwordx4 v13, s[12:15], s4 offen nt lds
    s_add_u32 s4, s42, 911360
    s_add_u32 m0, s37, 91136
    s_nop 0
    buffer_load_dwordx4 v13, s[12:15], s4 offen nt lds
    v_and_b32 v4, 3, v1
    v_mul_u32_u24 v39, 1280, v4
    v_lshrrev_b32 v5, 4, v1
    v_lshl_add_u32 v39, v5, 6, v39
    v_bfe_u32 v5, v1, 2, 2
    v_lshl_add_u32 v39, v5, 3, v39
    v_add_u32 v39, s23, v39
    v_lshrrev_b32 v5, 2, v1
    v_lshlrev_b32 v3, 8, v5
    v_lshl_add_u32 v3, v4, 4, v3
    s_lshl_b32 s4, s3, 6
    s_add_u32 s4, s4, 98304
    v_add_u32 v3, s4, v3
    s_mul_i32 s27, s21, 20480
    s_mul_i32 s4, s3, 5120
    s_add_u32 s27, s27, s4
    s_add_u32 s27, s27, 16777216
    s_waitcnt vmcnt(24)
    v_add_u32 v12, 0, v39
    s_call_b64 s[100:101], XN_sub
    v_cvt_pk_bf16_f32 v180, v60, v61
    v_cvt_pk_bf16_f32 v181, v62, v63
    v_cvt_pk_bf16_f32 v182, v64, v65
    v_cvt_pk_bf16_f32 v183, v66, v67
    v_cvt_pk_bf16_f32 v184, v68, v69
    v_cvt_pk_bf16_f32 v185, v70, v71
    v_cvt_pk_bf16_f32 v186, v72, v73
    v_cvt_pk_bf16_f32 v187, v74, v75
    v_cvt_pk_bf16_f32 v188, v76, v77
    v_cvt_pk_bf16_f32 v189, v78, v79
    v_cvt_pk_bf16_f32 v190, v80, v81
    v_cvt_pk_bf16_f32 v191, v82, v83
    v_cvt_pk_bf16_f32 v192, v84, v85
    v_cvt_pk_bf16_f32 v193, v86, v87
    v_cvt_pk_bf16_f32 v194, v88, v89
    v_cvt_pk_bf16_f32 v195, v90, v91
    v_cvt_pk_bf16_f32 v196, v92, v93
    v_cvt_pk_bf16_f32 v197, v94, v95
    v_cvt_pk_bf16_f32 v198, v96, v97
    v_cvt_pk_bf16_f32 v199, v98, v99
    s_cmp_lt_u32 s21, 48
    s_cbranch_scc0 CN_1
    v_add_u32 v12, 20480, v39
    s_call_b64 s[100:101], XN_sub
    v_cvt_pk_bf16_f32 v200, v60, v61
    v_cvt_pk_bf16_f32 v201, v62, v63
    v_cvt_pk_bf16_f32 v202, v64, v65
    v_cvt_pk_bf16_f32 v203, v66, v67
    v_cvt_pk_bf16_f32 v204, v68, v69
    v_cvt_pk_bf16_f32 v205, v70, v71
    v_cvt_pk_bf16_f32 v206, v72, v73
    v_cvt_pk_bf16_f32 v207, v74, v75
    v_cvt_pk_bf16_f32 v208, v76, v77
    v_cvt_pk_bf16_f32 v209, v78, v79
    v_cvt_pk_bf16_f32 v210, v80, v81
    v_cvt_pk_bf16_f32 v211, v82, v83
    v_cvt_pk_bf16_f32 v212, v84, v85
    v_cvt_pk_bf16_f32 v213, v86, v87
    v_cvt_pk_bf16_f32 v214, v88, v89
    v_cvt_pk_bf16_f32 v215, v90, v91
    v_cvt_pk_bf16_f32 v216, v92, v93
    v_cvt_pk_bf16_f32 v217, v94, v95
    v_cvt_pk_bf16_f32 v218, v96, v97
    v_cvt_pk_bf16_f32 v219, v98, v99
CN_1:
    v_and_b32 v16, 7, v1
    v_lshlrev_b32 v16, 5, v16
    buffer_load_dwordx4 v[20:23], v16, s[16:19], 0 offen sc1
    s_mov_b32 s31, 0
    s_waitcnt vmcnt(0)
    s_branch CI_c
CI_l:
    buffer_load_dwordx4 v[20:23], v16, s[16:19], 0 offen sc1
    s_waitcnt vmcnt(0)
CI_c:
    v_bcnt_u32_b32 v17, v20, v23
    v_cmp_lt_u32 s[4:5], 32, v17
    s_and_b32 s6, s4, 0xff
    v_cmp_ne_u32 s[4:5], 32, v17
    s_cmp_eq_u32 s6, 0
    s_cselect_b32 s5, 0xff, 0
    s_and_b32 s4, s4, s5
    v_add_u32 v21, v21, v22
    v_cmp_gt_u32 vcc, 32, v21
    s_and_b32 vcc_lo, vcc_lo, 0xff
    s_or_b32 vcc_lo, vcc_lo, s4
    s_mov_b32 vcc_hi, 0
    s_cbranch_vccz CI_o
    s_sleep 16
    s_add_u32 s31, s31, 1
    s_cmp_lt_u32 s31, s30
    s_cbranch_scc1 CI_l
    s_mov_b32 s30, 1
CI_o:
    s_mov_b32 s97, s6
    s_cmp_lg_u32 s3, 0
    s_cbranch_scc1 CW_o
    s_mov_b32 s5, 32768
    s_mov_b32 s31, 0
CW_l:
    buffer_load_dwordx4 v[40:43], v2, s[8:11], s5 offen offset:0 sc1
    buffer_load_dwordx4 v[44:47], v2, s[8:11], s5 offen offset:1024 sc1
    buffer_load_dwordx4 v[48:51], v2, s[8:11], s5 offen offset:1536 sc1
    s_waitcnt vmcnt(0)
    v_max3_u32 v4, v40, v41, v42
    v_max3_u32 v4, v4, v43, v44
    v_max3_u32 v4, v4, v45, v46
    v_max3_u32 v4, v4, v47, v48
    v_max3_u32 v4, v4, v49, v50
    v_max_u32 v4, v4, v51
    v_cmp_eq_u32 vcc, -1, v4
    s_cbranch_vccz CW_o
    s_sleep 4
    s_add_u32 s31, s31, 1
    s_cmp_lt_u32 s31, s30
    s_cbranch_scc1 CW_l
    s_mov_b32 s30, 1
CW_o:
    s_barrier
    v_lshrrev_b32 v10, 2, v1
    v_lshlrev_b32 v10, 4, v10
    s_mov_b64 s[24:25], -1
    s_mov_b32 s5, 32768
    buffer_load_dwordx4 v[160:163], v10, s[8:11], s5 offen offset:0 sc1
    buffer_load_dwordx4 v[164:167], v10, s[8:11], s5 offen offset:256 sc1
    buffer_load_dwordx4 v[168:171], v10, s[8:11], s5 offen offset:512 sc1
    buffer_load_dwordx4 v[172:175], v10, s[8:11], s5 offen offset:768 sc1
    buffer_load_dwordx4 v[176:179], v10, s[8:11], s5 offen offset:1024 sc1
    buffer_load_dwordx4 v[120:123], v10, s[8:11], s5 offen offset:1280 sc1
    buffer_load_dwordx4 v[124:127], v10, s[8:11], s5 offen offset:1536 sc1
    buffer_load_dwordx4 v[128:131], v10, s[8:11], s5 offen offset:1792 sc1
    buffer_load_dwordx4 v[132:135], v10, s[8:11], s5 offen offset:2048 sc1
    buffer_load_dwordx4 v[136:139], v10, s[8:11], s5 offen offset:2304 sc1
    s_waitcnt vmcnt(0)
    v_lshlrev_b32 v100, 16, v120
    v_and_b32 v101, 0xffff0000, v120
    v_lshlrev_b32 v102, 16, v121
    v_and_b32 v103, 0xffff0000, v121
    v_lshlrev_b32 v104, 16, v122
    v_and_b32 v105, 0xffff0000, v122
    v_lshlrev_b32 v106, 16, v123
    v_and_b32 v107, 0xffff0000, v123
    v_lshlrev_b32 v108, 16, v124
    v_and_b32 v109, 0xffff0000, v124
    v_lshlrev_b32 v110, 16, v125
    v_and_b32 v111, 0xffff0000, v125
    v_lshlrev_b32 v112, 16, v126
    v_and_b32 v113, 0xffff0000, v126
    v_lshlrev_b32 v114, 16, v127
    v_and_b32 v115, 0xffff0000, v127
    v_lshlrev_b32 v116, 16, v128
    v_and_b32 v117, 0xffff0000, v128
    v_lshlrev_b32 v118, 16, v129
    v_and_b32 v119, 0xffff0000, v129
    v_lshlrev_b32 v120, 16, v130
    v_and_b32 v121, 0xffff0000, v130
    v_lshlrev_b32 v122, 16, v131
    v_and_b32 v123, 0xffff0000, v131
    v_lshlrev_b32 v124, 16, v132
    v_and_b32 v125, 0xffff0000, v132
    v_lshlrev_b32 v126, 16, v133
    v_and_b32 v127, 0xffff0000, v133
    v_lshlrev_b32 v128, 16, v134
    v_and_b32 v129, 0xffff0000, v134
    v_lshlrev_b32 v130, 16, v135
    v_and_b32 v131, 0xffff0000, v135
    v_lshlrev_b32 v132, 16, v136
    v_and_b32 v133, 0xffff0000, v136
    v_lshlrev_b32 v134, 16, v137
    v_and_b32 v135, 0xffff0000, v137
    v_lshlrev_b32 v136, 16, v138
    v_and_b32 v137, 0xffff0000, v138
    v_lshlrev_b32 v138, 16, v139
    v_and_b32 v139, 0xffff0000, v139
    v_lshlrev_b32 v140, 16, v160
    v_and_b32 v141, 0xffff0000, v160
    v_lshlrev_b32 v142, 16, v161
    v_and_b32 v143, 0xffff0000, v161
    v_lshlrev_b32 v144, 16, v162
    v_and_b32 v145, 0xffff0000, v162
    v_lshlrev_b32 v146, 16, v163
    v_and_b32 v147, 0xffff0000, v163
    v_lshlrev_b32 v148, 16, v164
    v_and_b32 v149, 0xffff0000, v164
    v_lshlrev_b32 v150, 16, v165
    v_and_b32 v151, 0xffff0000, v165
    v_lshlrev_b32 v152, 16, v166
    v_and_b32 v153, 0xffff0000, v166
    v_lshlrev_b32 v154, 16, v167
    v_and_b32 v155, 0xffff0000, v167
    v_lshlrev_b32 v156, 16, v168
    v_and_b32 v157, 0xffff0000, v168
    v_lshlrev_b32 v158, 16, v169
    v_and_b32 v159, 0xffff0000, v169
    v_lshlrev_b32 v160, 16, v170
    v_and_b32 v161, 0xffff0000, v170
    v_lshlrev_b32 v162, 16, v171
    v_and_b32 v163, 0xffff0000, v171
    v_lshlrev_b32 v164, 16, v172
    v_and_b32 v165, 0xffff0000, v172
    v_lshlrev_b32 v166, 16, v173
    v_and_b32 v167, 0xffff0000, v173
    v_lshlrev_b32 v168, 16, v174
    v_and_b32 v169, 0xffff0000, v174
    v_lshlrev_b32 v170, 16, v175
    v_and_b32 v171, 0xffff0000, v175
    v_lshlrev_b32 v172, 16, v176
    v_and_b32 v173, 0xffff0000, v176
    v_lshlrev_b32 v174, 16, v177
    v_and_b32 v175, 0xffff0000, v177
    v_lshlrev_b32 v176, 16, v178
    v_and_b32 v177, 0xffff0000, v178
    v_lshlrev_b32 v178, 16, v179
    v_and_b32 v179, 0xffff0000, v179
    v_lshlrev_b32 v60, 16, v180
    v_and_b32 v61, 0xffff0000, v180
    v_lshlrev_b32 v62, 16, v181
    v_and_b32 v63, 0xffff0000, v181
    v_lshlrev_b32 v64, 16, v182
    v_and_b32 v65, 0xffff0000, v182
    v_lshlrev_b32 v66, 16, v183
    v_and_b32 v67, 0xffff0000, v183
    v_lshlrev_b32 v68, 16, v184
    v_and_b32 v69, 0xffff0000, v184
    v_lshlrev_b32 v70, 16, v185
    v_and_b32 v71, 0xffff0000, v185
    v_lshlrev_b32 v72, 16, v186
    v_and_b32 v73, 0xffff0000, v186
    v_lshlrev_b32 v74, 16, v187
    v_and_b32 v75, 0xffff0000, v187
    v_lshlrev_b32 v76, 16, v188
    v_and_b32 v77, 0xffff0000, v188
    v_lshlrev_b32 v78, 16, v189
    v_and_b32 v79, 0xffff0000, v189
    v_lshlrev_b32 v80, 16, v190
    v_and_b32 v81, 0xffff0000, v190
    v_lshlrev_b32 v82, 16, v191
    v_and_b32 v83, 0xffff0000, v191
    v_lshlrev_b32 v84, 16, v192
    v_and_b32 v85, 0xffff0000, v192
    v_lshlrev_b32 v86, 16, v193
    v_and_b32 v87, 0xffff0000, v193
    v_lshlrev_b32 v88, 16, v194
    v_and_b32 v89, 0xffff0000, v194
    v_lshlrev_b32 v90, 16, v195
    v_and_b32 v91, 0xffff0000, v195
    v_lshlrev_b32 v92, 16, v196
    v_and_b32 v93, 0xffff0000, v196
    v_lshlrev_b32 v94, 16, v197
    v_and_b32 v95, 0xffff0000, v197
    v_lshlrev_b32 v96, 16, v198
    v_and_b32 v97, 0xffff0000, v198
    v_lshlrev_b32 v98, 16, v199
    v_and_b32 v99, 0xffff0000, v199
    v_add_u32 v12, 0, v3
    s_add_u32 s4, s23, 0
    v_add_u32 v11, s4, v2
    s_call_b64 s[100:101], XS_sub
    s_add_u32 s27, s27, 1638400
    s_cmp_lt_u32 s21, 48
    s_cbranch_scc0 CN_2
    v_lshlrev_b32 v60, 16, v200
    v_and_b32 v61, 0xffff0000, v200
    v_lshlrev_b32 v62, 16, v201
    v_and_b32 v63, 0xffff0000, v201
    v_lshlrev_b32 v64, 16, v202
    v_and_b32 v65, 0xffff0000, v202
    v_lshlrev_b32 v66, 16, v203
    v_and_b32 v67, 0xffff0000, v203
    v_lshlrev_b32 v68, 16, v204
    v_and_b32 v69, 0xffff0000, v204
    v_lshlrev_b32 v70, 16, v205
    v_and_b32 v71, 0xffff0000, v205
    v_lshlrev_b32 v72, 16, v206
    v_and_b32 v73, 0xffff0000, v206
    v_lshlrev_b32 v74, 16, v207
    v_and_b32 v75, 0xffff0000, v207
    v_lshlrev_b32 v76, 16, v208
    v_and_b32 v77, 0xffff0000, v208
    v_lshlrev_b32 v78, 16, v209
    v_and_b32 v79, 0xffff0000, v209
    v_lshlrev_b32 v80, 16, v210
    v_and_b32 v81, 0xffff0000, v210
    v_lshlrev_b32 v82, 16, v211
    v_and_b32 v83, 0xffff0000, v211
    v_lshlrev_b32 v84, 16, v212
    v_and_b32 v85, 0xffff0000, v212
    v_lshlrev_b32 v86, 16, v213
    v_and_b32 v87, 0xffff0000, v213
    v_lshlrev_b32 v88, 16, v214
    v_and_b32 v89, 0xffff0000, v214
    v_lshlrev_b32 v90, 16, v215
    v_and_b32 v91, 0xffff0000, v215
    v_lshlrev_b32 v92, 16, v216
    v_and_b32 v93, 0xffff0000, v216
    v_lshlrev_b32 v94, 16, v217
    v_and_b32 v95, 0xffff0000, v217
    v_lshlrev_b32 v96, 16, v218
    v_and_b32 v97, 0xffff0000, v218
    v_lshlrev_b32 v98, 16, v219
    v_and_b32 v99, 0xffff0000, v219
    v_add_u32 v12, 20480, v3
    s_add_u32 s4, s23, 20480
    v_add_u32 v11, s4, v2
    s_call_b64 s[100:101], XS_sub
    s_add_u32 s27, s27, 1638400
CN_2:
    v_mov_b32 v9, 0
    v_and_b32 v16, 7, v1
    v_lshrrev_b32 v17, 4, v1
    v_bfe_u32 v18, v1, 3, 1
    s_sub_u32 s4, s20, 18
    s_lshl_b32 s4, s4, 9
    s_add_u32 s43, s4, 2801664
    s_lshl_b32 s4, s99, 6
    s_add_u32 s24, s43, s4
    s_and_b32 s4, s99, 3
    s_lshl_b32 s4, s4, 14
    s_add_u32 s43, s43, s4
    s_lshl_b32 s4, s3, 7
    s_add_u32 s43, s43, s4
    s_cmp_eq_u32 s3, 3
    s_cselect_b32 s4, 8, 0
    s_cselect_b32 s44, 255, 0
    s_mov_b32 s45, 0
    v_lshrrev_b32 v198, 0, v1
    v_lshlrev_b32 v198, 13, v198
    v_and_b32 v19, 0, v2
    v_add_u32 v198, v198, v19
    v_mov_b32 v19, 0x80000000
    v_cmp_gt_u32 vcc, s4, v1
    s_nop 1
    v_cndmask_b32 v198, v19, v198, vcc
    s_lshr_b32 s4, s98, 1
    s_lshl_b32 s5, s4, 9
    s_and_b32 s6, s98, 1
    s_lshl_b32 s7, s6, 7
    s_add_u32 s5, s5, s7
    v_lshrrev_b32 v19, 1, v17
    v_lshlrev_b32 v6, 8, v19
    v_lshl_add_u32 v6, v16, 4, v6
    v_and_b32 v19, 1, v17
    v_lshl_add_u32 v6, v19, 3, v6
    v_add_u32 v6, s5, v6
    v_mov_b32 v19, 0x80000000
    v_cmp_ne_u32 vcc, 0, v18
    s_nop 1
    v_cndmask_b32 v6, v6, v19, vcc
    s_lshr_b32 s4, s98, 2
    s_lshl_b32 s4, s4, 14
    s_lshl_b32 s6, s3, 11
    s_add_u32 s4, s4, s6
    v_add_u32 v8, s4, v2
    v_lshrrev_b32 v19, 1, v17
    v_lshlrev_b32 v7, 7, v19
    v_lshl_add_u32 v7, v16, 4, v7
    v_and_b32 v19, 1, v17
    v_lshl_add_u32 v7, v19, 3, v7
    v_lshl_add_u32 v7, v18, 13, v7
    s_lshl_b32 s6, s99, 8
    s_add_u32 s4, s4, s6
    v_add_u32 v7, s4, v7
    v_and_b32 v19, 15, v1
    v_lshlrev_b32 v12, 5, v19
    v_lshl_add_u32 v12, v17, 3, v12
    s_and_b32 s4, s99, 3
    s_mul_i32 s34, s4, 81920
    s_lshr_b32 s4, s98, 3
    s_lshl_b32 s4, s4, 14
    s_add_u32 s34, s34, s4
    s_and_b32 s4, s98, 7
    s_lshl_b32 s4, s4, 10
    s_add_u32 s34, s34, s4
    s_add_u32 s34, s34, 23068672
    v_lshrrev_b32 v19, 3, v1
    v_and_b32 v20, 1, v19
    v_mul_u32_u24 v20, 3, v20
    v_sub_u32 v20, 5, v20
    v_min_u32 v4, v16, v20
    v_lshlrev_b32 v4, 2, v4
    v_lshl_add_u32 v4, v19, 7, v4
    v_add_u32 v4, 156672, v4
    v_lshrrev_b32 v19, 3, v1
    v_and_b32 v20, 3, v1
    v_lshlrev_b32 v11, 7, v20
    v_lshl_add_u32 v11, v19, 4, v11
    v_bfe_u32 v20, v1, 2, 1
    v_lshl_add_u32 v11, v20, 2, v11
    s_lshl_b32 s4, s3, 9
    s_add_u32 s4, s4, 98304
    v_add_u32 v11, s4, v11
    v_bfe_u32 v20, v1, 2, 1
    v_lshlrev_b32 v244, 7, v20
    v_lshl_add_u32 v244, v19, 4, v244
    v_and_b32 v20, 3, v1
    v_lshl_add_u32 v244, v20, 1, v244
    s_lshr_b32 s4, s3, 1
    s_lshl_b32 s4, s4, 8
    s_and_b32 s5, s3, 1
    s_lshl_b32 s5, s5, 3
    s_add_u32 s4, s4, s5
    s_add_u32 s4, s4, 100352
    v_add_u32 v244, s4, v244
    v_lshlrev_b32 v14, 7, v17
    v_lshl_add_u32 v14, v16, 4, v14
    v_add_u32 v14, 98304, v14
    v_and_b32 v20, 1, v17
    v_lshlrev_b32 v15, 7, v20
    v_lshl_add_u32 v15, v16, 4, v15
    v_add_u32 v15, 100352, v15
    v_and_b32 v245, 0x1f0, v2
    v_add_u32 v245, 110592, v245
    v_add_u32 v246, 102400, v2
    v_min_u32 v247, 5, v1
    s_mul_i32 s4, s3, 24
    s_add_u32 s4, s4, 155840
    v_lshl_add_u32 v247, v247, 2, s4
    v_and_b32 v248, 7, v1
    v_lshlrev_b32 v248, 2, v248
    v_add_u32 v248, 156096, v248
    s_mov_b32 s49, 0x3dd53b95
    s_lshr_b32 s4, s98, 1
    s_lshl_b32 s5, s4, 9
    s_and_b32 s6, s98, 1
    s_lshl_b32 s7, s6, 7
    s_add_u32 s5, s5, s7
    v_lshlrev_b32 v222, 8, v18
    v_lshl_add_u32 v222, v16, 4, v222
    v_lshl_add_u32 v222, v17, 3, v222
    v_add_u32 v222, s5, v222
    v_mov_b32 v19, 0x80000000
    v_cmp_lt_u32 vcc, 31, v1
    s_nop 1
    v_cndmask_b32 v222, v222, v19, vcc
    v_mov_b32 v19, 0x3f80
    v_mov_b32 v20, 0x3f800000
    v_cmp_eq_u32 vcc, 0, v16
    s_nop 1
    v_cndmask_b32 v224, 0, v19, vcc
    v_cmp_eq_u32 vcc, 1, v16
    s_nop 1
    v_cndmask_b32 v224, v224, v20, vcc
    v_cmp_eq_u32 vcc, 2, v16
    s_nop 1
    v_cndmask_b32 v225, 0, v19, vcc
    v_cmp_eq_u32 vcc, 3, v16
    s_nop 1
    v_cndmask_b32 v225, v225, v20, vcc
    v_cmp_eq_u32 vcc, 4, v16
    s_nop 1
    v_cndmask_b32 v226, 0, v19, vcc
    v_cmp_eq_u32 vcc, 5, v16
    s_nop 1
    v_cndmask_b32 v226, v226, v20, vcc
    v_cmp_eq_u32 vcc, 6, v16
    s_nop 1
    v_cndmask_b32 v227, 0, v19, vcc
    v_cmp_eq_u32 vcc, 7, v16
    s_nop 1
    v_cndmask_b32 v227, v227, v20, vcc
    v_and_b32 v16, 8, v1
    v_mov_b32 v5, 0x4444
    v_mov_b32 v17, 0xeeee
    v_cmp_ne_u32 vcc, 0, v16
    s_nop 1
    v_cndmask_b32 v5, v5, v17, vcc
    s_waitcnt vmcnt(0)
    s_barrier
    s_lshl_b32 s4, s21, 7
    s_add_u32 s4, s4, 65536
    v_mov_b32 v16, 1
    v_lshlrev_b32 v17, 2, v1
    s_cmp_eq_u32 s3, 0
    s_cselect_b64 exec, 1, 0
    buffer_store_dword v16, v17, s[8:11], s4 offen sc1
    s_mov_b64 exec, -1
    s_mul_i32 s4, s3, 24576
    v_add_u32 v0, s4, v0
    v_xor_b32 v60, 0, v0
    ds_read_b64_tr_b16 a[0:1], v60 offset:0
    ds_read_b64_tr_b16 a[2:3], v60 offset:256
    ds_read_b64_tr_b16 a[4:5], v60 offset:4096
    ds_read_b64_tr_b16 a[6:7], v60 offset:4352
    ds_read_b64_tr_b16 a[8:9], v60 offset:8192
    ds_read_b64_tr_b16 a[10:11], v60 offset:8448
    ds_read_b64_tr_b16 a[12:13], v60 offset:12288
    ds_read_b64_tr_b16 a[14:15], v60 offset:12544
    ds_read_b64_tr_b16 a[16:17], v60 offset:16384
    ds_read_b64_tr_b16 a[18:19], v60 offset:16640
    ds_read_b64_tr_b16 a[20:21], v60 offset:20480
    ds_read_b64_tr_b16 a[22:23], v60 offset:20736
    v_xor_b32 v60, 32, v0
    ds_read_b64_tr_b16 a[24:25], v60 offset:0
    ds_read_b64_tr_b16 a[26:27], v60 offset:256
    ds_read_b64_tr_b16 a[28:29], v60 offset:4096
    ds_read_b64_tr_b16 a[30:31], v60 offset:4352
    ds_read_b64_tr_b16 a[32:33], v60 offset:8192
    ds_read_b64_tr_b16 a[34:35], v60 offset:8448
    ds_read_b64_tr_b16 a[36:37], v60 offset:12288
    ds_read_b64_tr_b16 a[38:39], v60 offset:12544
    ds_read_b64_tr_b16 a[40:41], v60 offset:16384
    ds_read_b64_tr_b16 a[42:43], v60 offset:16640
    ds_read_b64_tr_b16 a[44:45], v60 offset:20480
    ds_read_b64_tr_b16 a[46:47], v60 offset:20736
    v_xor_b32 v60, 64, v0
    ds_read_b64_tr_b16 a[48:49], v60 offset:0
    ds_read_b64_tr_b16 a[50:51], v60 offset:256
    ds_read_b64_tr_b16 a[52:53], v60 offset:4096
    ds_read_b64_tr_b16 a[54:55], v60 offset:4352
    ds_read_b64_tr_b16 a[56:57], v60 offset:8192
    ds_read_b64_tr_b16 a[58:59], v60 offset:8448
    ds_read_b64_tr_b16 a[60:61], v60 offset:12288
    ds_read_b64_tr_b16 a[62:63], v60 offset:12544
    ds_read_b64_tr_b16 a[64:65], v60 offset:16384
    ds_read_b64_tr_b16 a[66:67], v60 offset:16640
    ds_read_b64_tr_b16 a[68:69], v60 offset:20480
    ds_read_b64_tr_b16 a[70:71], v60 offset:20736
    v_xor_b32 v60, 96, v0
    ds_read_b64_tr_b16 a[72:73], v60 offset:0
    ds_read_b64_tr_b16 a[74:75], v60 offset:256
    ds_read_b64_tr_b16 a[76:77], v60 offset:4096
    ds_read_b64_tr_b16 a[78:79], v60 offset:4352
    ds_read_b64_tr_b16 a[80:81], v60 offset:8192
    ds_read_b64_tr_b16 a[82:83], v60 offset:8448
    ds_read_b64_tr_b16 a[84:85], v60 offset:12288
    ds_read_b64_tr_b16 a[86:87], v60 offset:12544
    ds_read_b64_tr_b16 a[88:89], v60 offset:16384
    ds_read_b64_tr_b16 a[90:91], v60 offset:16640
    ds_read_b64_tr_b16 a[92:93], v60 offset:20480
    ds_read_b64_tr_b16 a[94:95], v60 offset:20736
    v_and_b32 v16, 31, v1
    v_lshlrev_b32 v16, 7, v16
    s_mov_b32 s23, 65536
    s_mov_b32 s31, 0
CH_l:
    buffer_load_dword v17, v16, s[8:11], s23 offen sc1
    s_waitcnt vmcnt(0)
CH_c:
    v_cmp_gt_u32 vcc, 1, v17
    s_cbranch_vccz CH_o
    s_sleep 4
    s_add_u32 s31, s31, 1
    s_cmp_lt_u32 s31, s30
    s_cbranch_scc1 CH_l
    s_mov_b32 s30, 1
CH_o:
    s_mov_b32 s5, 0
    v_readlane_b32 s4, v17, 20
    s_add_u32 s5, s5, s4
    v_readlane_b32 s4, v17, 21
    s_add_u32 s5, s5, s4
    v_readlane_b32 s4, v17, 22
    s_add_u32 s5, s5, s4
    v_readlane_b32 s4, v17, 23
    s_add_u32 s5, s5, s4
    v_readlane_b32 s4, v17, 24
    s_add_u32 s5, s5, s4
    v_readlane_b32 s4, v17, 25
    s_add_u32 s5, s5, s4
    v_readlane_b32 s4, v17, 26
    s_add_u32 s5, s5, s4
    v_readlane_b32 s4, v17, 27
    s_add_u32 s5, s5, s4
    v_readlane_b32 s4, v17, 28
    s_add_u32 s5, s5, s4
    v_readlane_b32 s4, v17, 29
    s_add_u32 s5, s5, s4
    v_readlane_b32 s4, v17, 30
    s_add_u32 s5, s5, s4
    v_readlane_b32 s4, v17, 31
    s_add_u32 s5, s5, s4
    s_lshr_b32 s4, s5, 16
    s_cmp_gt_u32 s4, 24
    s_cselect_b32 s96, 8192, 0
    s_lshl_b32 s4, s99, 11
    s_xor_b32 s96, s96, s4
    s_and_b32 s96, s96, 8192
    s_waitcnt lgkmcnt(0)
    s_mov_b32 s21, 0
    s_add_u32 s43, s43, s96
    s_add_u32 s37, s43, 64
    s_lshl_b32 s4, s3, 1
    s_cmp_eq_u32 s4, s99
    s_cselect_b32 s95, -1, 0
    s_add_u32 s4, s4, 1
    s_cmp_eq_u32 s4, s99
    s_cselect_b32 s94, -1, 0
    v_add_u32 v8, s96, v8
    s_mul_i32 s27, s3, 12288
    s_add_u32 s27, s27, s22
    s_add_u32 s27, s27, 159744
    s_mov_b32 s36, 196608
    s_sub_u32 s34, s34, 1048576
    s_xor_b32 s4, s96, 8192
    s_add_u32 s34, s34, s4
    s_cmp_lg_u32 s97, 0
    s_cbranch_scc1 Cs_go
Cf_go:
    s_lshl_b32 s4, s3, 12
    v_add_u32 v194, s4, v2
    s_lshl_b32 s4, s3, 11
    s_add_u32 s4, s4, 65536
    v_add_u32 v195, s4, v2
    s_lshr_b32 s4, s3, 1
    s_lshl_b32 s4, s4, 10
    s_and_b32 s5, s3, 1
    s_lshl_b32 s5, s5, 3
    s_add_u32 s4, s4, s5
    s_add_u32 s4, s4, 65536
    v_add_u32 v196, s4, v2
    s_lshl_b32 s4, s3, 10
    v_add_u32 v197, s4, v2
    v_mov_b32 v3, v197
    s_mul_i32 s4, s3, 3072
    s_min_u32 s4, s4, 7168
    s_add_u32 s92, s4, s22
    s_add_u32 s92, s92, 405504
    s_add_u32 s93, s4, 102400
    s_mov_b64 s[84:85], 0
    s_mov_b64 s[86:87], 0
    s_mov_b64 s[88:89], 0
    s_mov_b64 s[90:91], 0
    s_mul_i32 s4, s3, 3072
    s_add_u32 s29, s4, s22
    s_add_u32 s29, s29, 106496
    s_lshl_b32 s4, s3, 12
    s_add_u32 s32, s4, s22
    s_add_u32 s32, s32, 40960
    s_barrier
    s_mov_b32 s31, 0
Cfv1_l:
    buffer_load_dword v250, v247, s[8:11], s22 offen sc1
    s_waitcnt vmcnt(0)
Cfv1_c:
    v_cmp_gt_u32 vcc, 1, v250
    s_cbranch_vccz Cfv1_o
    s_sleep 1
    s_add_u32 s31, s31, 1
    s_cmp_lt_u32 s31, s30
    s_cbranch_scc1 Cfv1_l
    s_mov_b32 s30, 1
Cfv1_o:
    s_add_u32 s4, 1, 3
    s_and_b32 s4, s4, 3
    s_mul_i32 s4, s4, 49152
    s_add_u32 s40, s4, s27
    s_add_u32 s41, s40, 4096
    s_add_u32 s42, s40, 8192
    buffer_load_dwordx4 v[48:51], v2, s[8:11], s40 offen offset:0 sc1
    buffer_load_dwordx4 v[52:55], v2, s[8:11], s40 offen offset:1024 sc1
    buffer_load_dwordx4 v[56:59], v2, s[8:11], s40 offen offset:2048 sc1
    buffer_load_dwordx4 v[60:63], v2, s[8:11], s40 offen offset:3072 sc1
    buffer_load_dwordx4 v[64:67], v2, s[8:11], s41 offen offset:0 sc1
    buffer_load_dwordx4 v[68:71], v2, s[8:11], s41 offen offset:1024 sc1
    buffer_load_dwordx4 v[72:75], v2, s[8:11], s41 offen offset:2048 sc1
    buffer_load_dwordx4 v[76:79], v2, s[8:11], s41 offen offset:3072 sc1
    buffer_load_dwordx4 v[80:83], v2, s[8:11], s42 offen offset:0 sc1
    buffer_load_dwordx4 v[84:87], v2, s[8:11], s42 offen offset:1024 sc1
    buffer_load_dwordx4 v[88:91], v2, s[8:11], s42 offen offset:2048 sc1
    buffer_load_dwordx4 v[92:95], v2, s[8:11], s42 offen offset:3072 sc1
    s_waitcnt vmcnt(0)
    v_mfma_f32_16x16x32_bf16 v[136:139], v[48:51], a[0:3], 0
    v_mfma_f32_16x16x32_bf16 v[144:147], v[48:51], a[24:27], 0
    v_mfma_f32_16x16x32_bf16 v[152:155], v[48:51], a[48:51], 0
    v_mfma_f32_16x16x32_bf16 v[160:163], v[48:51], a[72:75], 0
    v_mfma_f32_16x16x32_bf16 v[140:143], v[72:75], a[0:3], 0
    v_mfma_f32_16x16x32_bf16 v[148:151], v[72:75], a[24:27], 0
    v_mfma_f32_16x16x32_bf16 v[156:159], v[72:75], a[48:51], 0
    v_mfma_f32_16x16x32_bf16 v[164:167], v[72:75], a[72:75], 0
    v_mfma_f32_16x16x32_bf16 v[136:139], v[52:55], a[4:7], v[136:139]
    v_mfma_f32_16x16x32_bf16 v[144:147], v[52:55], a[28:31], v[144:147]
    v_mfma_f32_16x16x32_bf16 v[152:155], v[52:55], a[52:55], v[152:155]
    v_mfma_f32_16x16x32_bf16 v[160:163], v[52:55], a[76:79], v[160:163]
    v_mfma_f32_16x16x32_bf16 v[140:143], v[76:79], a[4:7], v[140:143]
    v_mfma_f32_16x16x32_bf16 v[148:151], v[76:79], a[28:31], v[148:151]
    v_mfma_f32_16x16x32_bf16 v[156:159], v[76:79], a[52:55], v[156:159]
    v_mfma_f32_16x16x32_bf16 v[164:167], v[76:79], a[76:79], v[164:167]
    v_mfma_f32_16x16x32_bf16 v[136:139], v[56:59], a[8:11], v[136:139]
    v_mfma_f32_16x16x32_bf16 v[144:147], v[56:59], a[32:35], v[144:147]
    v_mfma_f32_16x16x32_bf16 v[152:155], v[56:59], a[56:59], v[152:155]
    v_mfma_f32_16x16x32_bf16 v[160:163], v[56:59], a[80:83], v[160:163]
    v_mfma_f32_16x16x32_bf16 v[140:143], v[80:83], a[8:11], v[140:143]
    v_mfma_f32_16x16x32_bf16 v[148:151], v[80:83], a[32:35], v[148:151]
    v_mfma_f32_16x16x32_bf16 v[156:159], v[80:83], a[56:59], v[156:159]
    v_mfma_f32_16x16x32_bf16 v[164:167], v[80:83], a[80:83], v[164:167]
    v_mfma_f32_16x16x32_bf16 v[136:139], v[60:63], a[12:15], v[136:139]
    v_mfma_f32_16x16x32_bf16 v[144:147], v[60:63], a[36:39], v[144:147]
    v_mfma_f32_16x16x32_bf16 v[152:155], v[60:63], a[60:63], v[152:155]
    v_mfma_f32_16x16x32_bf16 v[160:163], v[60:63], a[84:87], v[160:163]
    v_mfma_f32_16x16x32_bf16 v[140:143], v[84:87], a[12:15], v[140:143]
    v_mfma_f32_16x16x32_bf16 v[148:151], v[84:87], a[36:39], v[148:151]
    v_mfma_f32_16x16x32_bf16 v[156:159], v[84:87], a[60:63], v[156:159]
    v_mfma_f32_16x16x32_bf16 v[164:167], v[84:87], a[84:87], v[164:167]
    v_mfma_f32_16x16x32_bf16 v[136:139], v[64:67], a[16:19], v[136:139]
    v_mfma_f32_16x16x32_bf16 v[144:147], v[64:67], a[40:43], v[144:147]
    v_mfma_f32_16x16x32_bf16 v[152:155], v[64:67], a[64:67], v[152:155]
    v_mfma_f32_16x16x32_bf16 v[160:163], v[64:67], a[88:91], v[160:163]
    v_mfma_f32_16x16x32_bf16 v[140:143], v[88:91], a[16:19], v[140:143]
    v_mfma_f32_16x16x32_bf16 v[148:151], v[88:91], a[40:43], v[148:151]
    v_mfma_f32_16x16x32_bf16 v[156:159], v[88:91], a[64:67], v[156:159]
    v_mfma_f32_16x16x32_bf16 v[164:167], v[88:91], a[88:91], v[164:167]
    v_mfma_f32_16x16x32_bf16 v[136:139], v[68:71], a[20:23], v[136:139]
    v_mfma_f32_16x16x32_bf16 v[144:147], v[68:71], a[44:47], v[144:147]
    v_mfma_f32_16x16x32_bf16 v[152:155], v[68:71], a[68:71], v[152:155]
    v_mfma_f32_16x16x32_bf16 v[160:163], v[68:71], a[92:95], v[160:163]
    v_mfma_f32_16x16x32_bf16 v[140:143], v[92:95], a[20:23], v[140:143]
    v_mfma_f32_16x16x32_bf16 v[148:151], v[92:95], a[44:47], v[148:151]
    v_mfma_f32_16x16x32_bf16 v[156:159], v[92:95], a[68:71], v[156:159]
    v_mfma_f32_16x16x32_bf16 v[164:167], v[92:95], a[92:95], v[164:167]
    v_cvt_pk_bf16_f32 v168, v136, v137
    v_cvt_pk_bf16_f32 v169, v140, v141
    v_cvt_pk_bf16_f32 v170, v138, v139
    v_cvt_pk_bf16_f32 v171, v142, v143
    ds_write_b128 v3, v[168:171] offset:0
    v_cvt_pk_bf16_f32 v172, v144, v145
    v_cvt_pk_bf16_f32 v173, v148, v149
    v_cvt_pk_bf16_f32 v174, v146, v147
    v_cvt_pk_bf16_f32 v175, v150, v151
    ds_write_b128 v3, v[172:175] offset:4096
    v_cvt_pk_bf16_f32 v176, v152, v153
    v_cvt_pk_bf16_f32 v177, v156, v157
    v_cvt_pk_bf16_f32 v178, v154, v155
    v_cvt_pk_bf16_f32 v179, v158, v159
    ds_write_b128 v3, v[176:179] offset:8192
    v_cvt_pk_bf16_f32 v180, v160, v161
    v_cvt_pk_bf16_f32 v181, v164, v165
    v_cvt_pk_bf16_f32 v182, v162, v163
    v_cvt_pk_bf16_f32 v183, v166, v167
    ds_write_b128 v3, v[180:183] offset:12288
    s_and_b32 s28, s21, 3
    s_lshl_b32 s4, s28, 14
    v_add_u32 v192, s4, v194
    s_lshl_b32 s4, s28, 13
    v_add_u32 v13, s4, v195
    v_add_u32 v10, s4, v196
    v_xor_b32 v0, 32768, v192
    v_xor_b32 v193, 16384, v13
    s_mul_i32 s4, s28, 12288
    s_add_u32 s38, s4, s29
    s_mul_i32 s4, s28, 16384
    s_add_u32 s39, s4, s32
    s_mul_i32 s4, s28, 10240
    s_add_u32 s25, s4, s22
    s_xor_b32 s4, s28, 2
    s_mul_i32 s4, s4, 10240
    s_add_u32 s26, s4, s22
    s_add_u32 s4, s21, 1
    v_mov_b32 v228, s4
    v_mov_b32 v96, 0
    v_mov_b32 v97, 0
    v_mov_b32 v98, 0
    v_mov_b32 v99, 0
    v_mov_b32 v100, 0
    v_mov_b32 v101, 0
    v_mov_b32 v102, 0
    v_mov_b32 v103, 0
    v_mov_b32 v104, 0
    v_mov_b32 v105, 0
    v_mov_b32 v106, 0
    v_mov_b32 v107, 0
    v_mov_b32 v108, 0
    v_mov_b32 v109, 0
    v_mov_b32 v110, 0
    v_mov_b32 v111, 0
    s_waitcnt lgkmcnt(0)
    s_barrier
    s_mul_i32 s4, s28, 163840
    s_add_u32 s35, s4, 2097152
    s_add_u32 s4, s28, 1
    s_and_b32 s4, s4, 3
    s_lshl_b32 s4, s4, 14
    v_add_u32 v3, s4, v197
    s_add_u32 s46, s21, 3
    s_min_u32 s46, s46, 64
    s_mov_b32 s47, s21
    s_add_u32 s4, s46, 3
    s_and_b32 s4, s4, 3
    s_mul_i32 s4, s4, 49152
    s_add_u32 s40, s4, s27
    s_add_u32 s41, s40, 4096
    s_add_u32 s42, s40, 8192
    s_add_u32 s23, s36, s92
    s_mov_b32 m0, s93
    s_add_u32 s36, s36, 65536
    s_and_b32 s36, s36, 262143
    ds_read_b128 v[120:123], v192 offset:0
    ds_read_b128 v[124:127], v192 offset:1024
    ds_read_b128 v[128:131], v192 offset:2048
    ds_read_b128 v[132:135], v192 offset:3072
Cf_loop:
    s_add_u32 s21, s21, 1
    buffer_load_dword v47, v4, s[8:11], s22 offen offset:0 sc1
    s_nop 15
    s_mov_b32 s31, -1
Cfl_l:
    buffer_load_dword v47, v4, s[8:11], s22 offen offset:0 sc1
    s_add_u32 s31, s31, 1
    s_cmp_lt_u32 s31, s30
    s_cselect_b32 s30, s30, 1
    s_cbranch_scc0 Cfl_o
    s_waitcnt vmcnt(1)
    v_cmp_gt_u32 vcc, s21, v47
    s_cbranch_vccnz Cfl_l
Cfl_o:
    buffer_load_dwordx4 v[16:19], v2, s[8:11], s38 offen offset:0 sc1
    buffer_load_dwordx4 v[20:23], v2, s[8:11], s38 offen offset:1024 sc1
    buffer_load_dwordx4 v[24:27], v2, s[8:11], s38 offen offset:2048 sc1
Cfm_b:
    s_waitcnt vmcnt(2)
    v_smfmac_f32_16x16x64_bf16 v[96:99], v[16:19], a[0:7], v5
    buffer_load_dwordx4 v[28:31], v2, s[8:11], s39 offen offset:0 sc1
    v_smfmac_f32_16x16x64_bf16 v[100:103], v[16:19], a[24:31], v5
    buffer_load_dwordx4 v[32:35], v2, s[8:11], s39 offen offset:1024 sc1
    v_smfmac_f32_16x16x64_bf16 v[104:107], v[16:19], a[48:55], v5
    buffer_load_dwordx4 v[36:39], v2, s[8:11], s39 offen offset:2048 sc1
    v_smfmac_f32_16x16x64_bf16 v[108:111], v[16:19], a[72:79], v5
    buffer_load_dwordx3 v[40:42], v2, s[8:11], s39 offen offset:3072 sc1
    s_waitcnt vmcnt(5)
    v_smfmac_f32_16x16x64_bf16 v[96:99], v[20:23], a[8:15], v5
    v_smfmac_f32_16x16x64_bf16 v[100:103], v[20:23], a[32:39], v5
    v_smfmac_f32_16x16x64_bf16 v[104:107], v[20:23], a[56:63], v5
    v_smfmac_f32_16x16x64_bf16 v[108:111], v[20:23], a[80:87], v5
    s_waitcnt vmcnt(4)
    v_smfmac_f32_16x16x64_bf16 v[96:99], v[24:27], a[16:23], v5
    v_max3_u32 v251, v16, v18, v20
    v_smfmac_f32_16x16x64_bf16 v[100:103], v[24:27], a[40:47], v5
    v_max3_u32 v251, v251, v22, v24
    v_smfmac_f32_16x16x64_bf16 v[104:107], v[24:27], a[64:71], v5
    buffer_load_dword v45, v247, s[8:11], s22 offen offset:0 sc1
    v_max_u32 v251, v251, v26
    v_smfmac_f32_16x16x64_bf16 v[108:111], v[24:27], a[88:95], v5
    buffer_load_dword v46, v248, s[8:11], s22 offen offset:0 sc1
    v_cmp_eq_u32 vcc, -1, v251
    v_cvt_pk_bf16_f32 v112, v96, v97
    v_cvt_pk_bf16_f32 v113, v98, v99
    s_cbranch_vccnz Cfm_s
    ds_write_b64 v10, v[112:113] offset:0
    v_cvt_pk_bf16_f32 v114, v100, v101
    v_cvt_pk_bf16_f32 v115, v102, v103
    ds_write_b64 v10, v[114:115] offset:2048
    v_cvt_pk_bf16_f32 v116, v104, v105
    v_cvt_pk_bf16_f32 v117, v106, v107
    ds_write_b64 v10, v[116:117] offset:4096
    v_cvt_pk_bf16_f32 v118, v108, v109
    v_cvt_pk_bf16_f32 v119, v110, v111
    ds_write_b64 v10, v[118:119] offset:6144
    s_cmp_eq_u32 s21, 64
    s_cbranch_scc1 Cf_end
    s_waitcnt vmcnt(2)
Cfs_b:
    v_max3_u32 v250, v28, v32, v36
    v_pk_add_f32 v[28:29], v[28:29], v[32:33]
    v_pk_add_f32 v[30:31], v[30:31], v[34:35]
    v_max3_u32 v251, v40, v41, v42
    v_add_f32 v40, v40, v41
    v_pk_add_f32 v[28:29], v[28:29], v[36:37]
    v_pk_add_f32 v[30:31], v[30:31], v[38:39]
    v_add_f32 v40, v40, v42
    v_max3_f32 v43, v28, v29, v30
    v_max3_f32 v43, v43, v31, v40
    v_max_u32 v250, v250, v251
    v_cmp_eq_u32 vcc, -1, v250
    v_max_f32 v43, v43, v43 quad_perm:[1,0,3,2] row_mask:0xf bank_mask:0xf
    s_nop 1
    v_max_f32 v43, v43, v43 quad_perm:[2,3,0,1] row_mask:0xf bank_mask:0xf
    s_nop 1
    v_max_f32 v43, v43, v43 row_half_mirror row_mask:0xf bank_mask:0xf
    s_cbranch_vccnz Cfs_s
    v_mul_f32 v43, s49, v43
    v_fma_f32 v28, v28, s49, -v43
    v_fma_f32 v29, v29, s49, -v43
    v_fma_f32 v30, v30, s49, -v43
    v_fma_f32 v31, v31, s49, -v43
    v_fma_f32 v40, v40, s49, -v43
    v_exp_f32 v28, v28
    v_exp_f32 v29, v29
    v_exp_f32 v30, v30
    v_exp_f32 v31, v31
    v_exp_f32 v40, v40
    v_add_f32 v43, v28, v29
    v_add_f32 v44, v30, v31
    v_add_f32 v43, v43, v44
    v_add_f32 v43, v43, v40
    s_nop 1
    v_add_f32 v43, v43, v43 quad_perm:[1,0,3,2] row_mask:0xf bank_mask:0xf
    s_nop 1
    v_add_f32 v43, v43, v43 quad_perm:[2,3,0,1] row_mask:0xf bank_mask:0xf
    s_nop 1
    v_add_f32 v43, v43, v43 row_half_mirror row_mask:0xf bank_mask:0xf
    v_rcp_f32 v43, v43
    s_nop 0
    v_mul_f32 v28, v28, v43
    v_mul_f32 v29, v29, v43
    v_mul_f32 v30, v30, v43
    v_mul_f32 v31, v31, v43
    v_mul_f32 v40, v40, v43
    v_cvt_pk_bf16_f32 v28, v28, v29
    v_cvt_pk_bf16_f32 v29, v30, v31
    v_cvt_pk_bf16_f32 v30, v40, v40
    ds_write2_b32 v11, v28, v29 offset0:0 offset1:2
    ds_write_b16 v244, v30
    s_mov_b64 exec, s[44:45]
    buffer_store_dword v228, v198, s[8:11], s24 offen offset:0 sc1
    s_mov_b64 exec, -1
    s_waitcnt lgkmcnt(0)
    s_barrier
    ds_read_b128 v[168:171], v14 offset:0
    ds_read_b128 v[172:175], v14 offset:512
    ds_read_b128 v[176:179], v14 offset:1024
    ds_read_b128 v[180:183], v14 offset:1536
    ds_read_b128 v[184:187], v15 offset:0
    ds_read_b128 v[112:115], v13 offset:0
    ds_read_b128 v[188:191], v15 offset:256
    ds_read_b128 v[116:119], v13 offset:1024
    s_waitcnt lgkmcnt(7)
    v_mfma_f32_16x16x32_bf16 v[200:203], v[120:123], v[168:171], 0
    s_waitcnt lgkmcnt(6)
    v_mfma_f32_16x16x32_bf16 v[200:203], v[124:127], v[172:175], v[200:203]
    s_waitcnt lgkmcnt(5)
    v_mfma_f32_16x16x32_bf16 v[200:203], v[128:131], v[176:179], v[200:203]
    s_waitcnt lgkmcnt(4)
    v_mfma_f32_16x16x32_bf16 v[200:203], v[132:135], v[180:183], v[200:203]
    s_waitcnt lgkmcnt(2)
    v_mfma_f32_16x16x32_bf16 v[200:203], v[112:115], v[184:187], v[200:203]
    s_waitcnt lgkmcnt(0)
    v_mfma_f32_16x16x32_bf16 v[200:203], v[116:119], v[188:191], v[200:203]
    s_load_dword s84, s[8:9], s37 glc
    s_load_dword s85, s[8:9], s43 glc
    s_nop 5
    v_cvt_pk_bf16_f32 v200, v200, v201
    v_cvt_pk_bf16_f32 v201, v202, v203
    buffer_store_dwordx2 v[200:201], v7, s[8:11], s35 offen offset:0 sc1
    s_cmp_eq_u32 s21, 1
    s_cbranch_scc1 Cf_v1
Cf_v1r:
    v_mfma_f32_16x16x32_bf16 v[136:139], v[48:51], a[0:3], 0
    v_mfma_f32_16x16x32_bf16 v[144:147], v[48:51], a[24:27], 0
    s_waitcnt vmcnt(2)
    v_cmp_gt_u32 vcc, s46, v45
    v_mfma_f32_16x16x32_bf16 v[152:155], v[48:51], a[48:51], 0
    v_cmp_gt_u32 s[6:7], s47, v46
    v_mfma_f32_16x16x32_bf16 v[160:163], v[48:51], a[72:75], 0
    s_and_b32 s28, s21, 3
    s_lshl_b32 s4, s28, 14
    v_mfma_f32_16x16x32_bf16 v[140:143], v[72:75], a[0:3], 0
    s_or_b64 vcc, vcc, s[6:7]
    s_cbranch_vccnz Cf_fw
Cf_fo:
    v_mfma_f32_16x16x32_bf16 v[148:151], v[72:75], a[24:27], 0
    v_add_u32 v192, s4, v194
    s_lshl_b32 s4, s28, 13
    v_mfma_f32_16x16x32_bf16 v[156:159], v[72:75], a[48:51], 0
    v_add_u32 v13, s4, v195
    v_add_u32 v10, s4, v196
    v_mfma_f32_16x16x32_bf16 v[164:167], v[72:75], a[72:75], 0
    buffer_store_dwordx2 v[232:233], v12, s[8:11], s34 offen offset:0 sc1
    buffer_store_dwordx2 v[234:235], v12, s[8:11], s34 offen offset:512 sc1
    s_add_u32 s34, s34, 524288
    s_and_b32 s6, s34, 1572864
    s_cselect_b32 s6, 0, 8192
    s_xor_b32 s34, s34, s6
    v_mfma_f32_16x16x32_bf16 v[136:139], v[52:55], a[4:7], v[136:139]
    s_load_dword s84, s[8:9], s37 glc
    s_load_dword s85, s[8:9], s43 glc
    v_mfma_f32_16x16x32_bf16 v[144:147], v[52:55], a[28:31], v[144:147]
    v_xor_b32 v0, 32768, v192
    v_xor_b32 v193, 16384, v13
    v_mfma_f32_16x16x32_bf16 v[152:155], v[52:55], a[52:55], v[152:155]
    s_mul_i32 s4, s28, 12288
    s_add_u32 s38, s4, s29
    v_mfma_f32_16x16x32_bf16 v[160:163], v[52:55], a[76:79], v[160:163]
    s_mul_i32 s4, s28, 16384
    s_add_u32 s39, s4, s32
    v_mfma_f32_16x16x32_bf16 v[140:143], v[76:79], a[4:7], v[140:143]
    s_mul_i32 s4, s28, 10240
    s_add_u32 s25, s4, s22
    v_mfma_f32_16x16x32_bf16 v[148:151], v[76:79], a[28:31], v[148:151]
    s_xor_b32 s4, s28, 2
    s_mul_i32 s4, s4, 10240
    v_mfma_f32_16x16x32_bf16 v[156:159], v[76:79], a[52:55], v[156:159]
    s_add_u32 s26, s4, s22
    s_add_u32 s4, s21, 1
    v_mfma_f32_16x16x32_bf16 v[164:167], v[76:79], a[76:79], v[164:167]
    v_mov_b32 v228, s4
    v_mov_b32 v96, 0
    v_mfma_f32_16x16x32_bf16 v[136:139], v[56:59], a[8:11], v[136:139]
    s_or_b64 s[6:7], s[84:85], s[94:95]
    s_min_u32 s6, s6, s7
    s_cmp_ge_u32 s6, s21
    s_cbranch_scc0 Cfg_s
Cfg_o:
    s_barrier
    buffer_load_dwordx4 v[204:207], v8, s[8:11], s35 offen offset:0 sc1
    buffer_load_dwordx4 v[208:211], v8, s[8:11], s35 offen offset:1024 sc1
    v_mfma_f32_16x16x32_bf16 v[144:147], v[56:59], a[32:35], v[144:147]
    v_mov_b32 v97, 0
    v_mov_b32 v98, 0
    v_mfma_f32_16x16x32_bf16 v[152:155], v[56:59], a[56:59], v[152:155]
    v_mov_b32 v99, 0
    v_mov_b32 v100, 0
    v_mfma_f32_16x16x32_bf16 v[160:163], v[56:59], a[80:83], v[160:163]
    buffer_load_dwordx4 v2, s[8:11], s23 offen offset:0 sc1 lds
    v_mfma_f32_16x16x32_bf16 v[140:143], v[80:83], a[8:11], v[140:143]
    v_mov_b32 v101, 0
    v_mov_b32 v102, 0
    v_mfma_f32_16x16x32_bf16 v[148:151], v[80:83], a[32:35], v[148:151]
    v_mov_b32 v103, 0
    v_mov_b32 v104, 0
    v_mfma_f32_16x16x32_bf16 v[156:159], v[80:83], a[56:59], v[156:159]
    v_mov_b32 v105, 0
    v_mov_b32 v106, 0
    v_mfma_f32_16x16x32_bf16 v[164:167], v[80:83], a[80:83], v[164:167]
    buffer_load_dwordx4 v2, s[8:11], s23 offen offset:1024 sc1 lds
    v_mfma_f32_16x16x32_bf16 v[136:139], v[60:63], a[12:15], v[136:139]
    v_mov_b32 v107, 0
    v_mov_b32 v108, 0
    v_mfma_f32_16x16x32_bf16 v[144:147], v[60:63], a[36:39], v[144:147]
    v_mov_b32 v109, 0
    v_mov_b32 v110, 0
    v_mfma_f32_16x16x32_bf16 v[152:155], v[60:63], a[60:63], v[152:155]
    v_mov_b32 v111, 0
    v_mfma_f32_16x16x32_bf16 v[160:163], v[60:63], a[84:87], v[160:163]
    buffer_load_dwordx4 v2, s[8:11], s23 offen offset:2048 sc1 lds
    v_mfma_f32_16x16x32_bf16 v[140:143], v[84:87], a[12:15], v[140:143]
    v_mfma_f32_16x16x32_bf16 v[148:151], v[84:87], a[36:39], v[148:151]
    v_mfma_f32_16x16x32_bf16 v[156:159], v[84:87], a[60:63], v[156:159]
    v_mfma_f32_16x16x32_bf16 v[164:167], v[84:87], a[84:87], v[164:167]
    v_mfma_f32_16x16x32_bf16 v[136:139], v[64:67], a[16:19], v[136:139]
    v_mfma_f32_16x16x32_bf16 v[144:147], v[64:67], a[40:43], v[144:147]
    v_mfma_f32_16x16x32_bf16 v[152:155], v[64:67], a[64:67], v[152:155]
    v_mfma_f32_16x16x32_bf16 v[160:163], v[64:67], a[88:91], v[160:163]
    v_mfma_f32_16x16x32_bf16 v[140:143], v[88:91], a[16:19], v[140:143]
    v_mfma_f32_16x16x32_bf16 v[148:151], v[88:91], a[40:43], v[148:151]
    v_mfma_f32_16x16x32_bf16 v[156:159], v[88:91], a[64:67], v[156:159]
    v_mfma_f32_16x16x32_bf16 v[164:167], v[88:91], a[88:91], v[164:167]
    v_mfma_f32_16x16x32_bf16 v[136:139], v[68:71], a[20:23], v[136:139]
    v_mfma_f32_16x16x32_bf16 v[144:147], v[68:71], a[44:47], v[144:147]
    s_waitcnt vmcnt(3)
    v_mfma_f32_16x16x32_bf16 v[32:35], v[224:227], v[204:207], 0
    v_max3_u32 v36, v204, v206, v208
    v_mfma_f32_16x16x32_bf16 v[32:35], v[224:227], v[208:211], v[32:35]
    v_max_u32 v36, v36, v210
    v_cmp_eq_u32 vcc, -1, v36
    s_cbranch_vccnz Cf4_s
Cf4_o:
    s_nop 4
    v_cvt_pk_bf16_f32 v38, v32, v33
    v_cvt_pk_bf16_f32 v39, v34, v35
Cf4_z:
    buffer_store_dwordx2 v[38:39], v222, s[8:11], s25 offen offset:0
    v_mfma_f32_16x16x32_bf16 v[152:155], v[68:71], a[68:71], v[152:155]
    v_mfma_f32_16x16x32_bf16 v[160:163], v[68:71], a[92:95], v[160:163]
    v_mfma_f32_16x16x32_bf16 v[140:143], v[92:95], a[20:23], v[140:143]
    v_mfma_f32_16x16x32_bf16 v[148:151], v[92:95], a[44:47], v[148:151]
    v_mfma_f32_16x16x32_bf16 v[156:159], v[92:95], a[68:71], v[156:159]
    v_mfma_f32_16x16x32_bf16 v[164:167], v[92:95], a[92:95], v[164:167]
    v_cvt_pk_bf16_f32 v168, v136, v137
    v_cvt_pk_bf16_f32 v169, v140, v141
    v_cvt_pk_bf16_f32 v170, v138, v139
    v_cvt_pk_bf16_f32 v171, v142, v143
    ds_write_b128 v3, v[168:171] offset:0
    buffer_load_dwordx4 v[48:51], v2, s[8:11], s40 offen offset:0 sc1
    v_cvt_pk_bf16_f32 v172, v144, v145
    v_cvt_pk_bf16_f32 v173, v148, v149
    v_cvt_pk_bf16_f32 v174, v146, v147
    v_cvt_pk_bf16_f32 v175, v150, v151
    ds_write_b128 v3, v[172:175] offset:4096
    buffer_load_dwordx4 v[72:75], v2, s[8:11], s41 offen offset:2048 sc1
    v_cvt_pk_bf16_f32 v176, v152, v153
    v_cvt_pk_bf16_f32 v177, v156, v157
    v_cvt_pk_bf16_f32 v178, v154, v155
    v_cvt_pk_bf16_f32 v179, v158, v159
    ds_write_b128 v3, v[176:179] offset:8192
    buffer_load_dwordx4 v[52:55], v2, s[8:11], s40 offen offset:1024 sc1
    v_cvt_pk_bf16_f32 v180, v160, v161
    v_cvt_pk_bf16_f32 v181, v164, v165
    v_cvt_pk_bf16_f32 v182, v162, v163
    v_cvt_pk_bf16_f32 v183, v166, v167
    ds_write_b128 v3, v[180:183] offset:12288
    buffer_load_dwordx4 v[76:79], v2, s[8:11], s41 offen offset:3072 sc1
    s_waitcnt vmcnt(5)
    s_waitcnt lgkmcnt(0)
    s_barrier
    ds_read_b128 v[168:171], v0 offset:0
    ds_read_b128 v[136:139], v246 offset:0
    ds_read_b128 v[140:143], v246 offset:1024
    ds_read_b128 v[172:175], v0 offset:1024
    ds_read_b128 v[144:147], v246 offset:2048
    ds_read_b128 v[148:151], v246 offset:3072
    ds_read_b128 v[176:179], v0 offset:2048
    ds_read_b128 v[152:155], v246 offset:4096
    ds_read_b128 v[156:159], v246 offset:5120
    ds_read_b128 v[180:183], v0 offset:3072
    ds_read_b128 v[160:163], v246 offset:6144
    ds_read_b128 v[164:167], v246 offset:7168
    s_waitcnt lgkmcnt(10)
    v_mfma_f32_16x16x32_bf16 v[236:239], v[168:171], v[136:139], 0
    ds_read_b128 v[184:187], v193 offset:0
    buffer_load_dwordx4 v[56:59], v2, s[8:11], s40 offen offset:2048 sc1
    s_waitcnt lgkmcnt(10)
    v_mfma_f32_16x16x32_bf16 v[252:255], v[168:171], v[140:143], 0
    ds_read_b128 v[16:19], v245 offset:0
    buffer_load_dwordx4 v[80:83], v2, s[8:11], s42 offen offset:0 sc1
    s_waitcnt lgkmcnt(9)
    v_mfma_f32_16x16x32_bf16 v[236:239], v[172:175], v[144:147], v[236:239]
    ds_read_b128 v[20:23], v245 offset:512
    buffer_load_dwordx4 v[60:63], v2, s[8:11], s40 offen offset:3072 sc1
    s_waitcnt lgkmcnt(9)
    v_mfma_f32_16x16x32_bf16 v[252:255], v[172:175], v[148:151], v[252:255]
    ds_read_b128 v[188:191], v193 offset:1024
    buffer_load_dwordx4 v[84:87], v2, s[8:11], s42 offen offset:1024 sc1
    s_waitcnt lgkmcnt(8)
    v_mfma_f32_16x16x32_bf16 v[236:239], v[176:179], v[152:155], v[236:239]
    ds_read_b128 v[24:27], v245 offset:1024
    buffer_load_dwordx4 v[64:67], v2, s[8:11], s41 offen offset:0 sc1
    s_waitcnt lgkmcnt(8)
    v_mfma_f32_16x16x32_bf16 v[252:255], v[176:179], v[156:159], v[252:255]
    ds_read_b128 v[28:31], v245 offset:1536
    buffer_load_dwordx4 v[88:91], v2, s[8:11], s42 offen offset:2048 sc1
    s_waitcnt lgkmcnt(7)
    v_mfma_f32_16x16x32_bf16 v[236:239], v[180:183], v[160:163], v[236:239]
    buffer_load_dwordx4 v[68:71], v2, s[8:11], s41 offen offset:1024 sc1
    s_waitcnt lgkmcnt(6)
    v_mfma_f32_16x16x32_bf16 v[252:255], v[180:183], v[164:167], v[252:255]
    buffer_load_dwordx4 v[92:95], v2, s[8:11], s42 offen offset:3072 sc1
    s_waitcnt lgkmcnt(4)
    v_mfma_f32_16x16x32_bf16 v[236:239], v[184:187], v[16:19], v[236:239]
    s_waitcnt lgkmcnt(3)
    v_mfma_f32_16x16x32_bf16 v[252:255], v[184:187], v[20:23], v[252:255]
    s_waitcnt lgkmcnt(1)
    v_mfma_f32_16x16x32_bf16 v[236:239], v[188:191], v[24:27], v[236:239]
    s_waitcnt lgkmcnt(0)
    v_mfma_f32_16x16x32_bf16 v[252:255], v[188:191], v[28:31], v[252:255]
    s_nop 3
    v_cvt_pk_bf16_f32 v232, v236, v237
    v_cvt_pk_bf16_f32 v233, v238, v239
    s_nop 1
    v_cvt_pk_bf16_f32 v234, v252, v253
    v_cvt_pk_bf16_f32 v235, v254, v255
    buffer_store_dwordx2 v[240:241], v6, s[8:11], s26 offen offset:0
    s_mul_i32 s4, s28, 163840
    s_add_u32 s35, s4, 2097152
    s_add_u32 s4, s28, 1
    s_and_b32 s4, s4, 3
    s_lshl_b32 s4, s4, 14
    v_add_u32 v3, s4, v197
    s_add_u32 s46, s21, 3
    s_min_u32 s46, s46, 64
    s_mov_b32 s47, s21
    s_add_u32 s4, s46, 3
    s_and_b32 s4, s4, 3
    s_mul_i32 s4, s4, 49152
    s_add_u32 s40, s4, s27
    s_add_u32 s41, s40, 4096
    s_add_u32 s42, s40, 8192
    s_add_u32 s23, s36, s92
    s_mov_b32 m0, s93
    s_add_u32 s36, s36, 65536
    s_and_b32 s36, s36, 262143
    ds_read_b128 v[120:123], v192 offset:0
    ds_read_b128 v[124:127], v192 offset:1024
    ds_read_b128 v[128:131], v192 offset:2048
    ds_read_b128 v[132:135], v192 offset:3072
    s_branch Cf_loop
Cf_end:
    buffer_store_dwordx2 v[232:233], v12, s[8:11], s34 offen offset:0 sc1
    buffer_store_dwordx2 v[234:235], v12, s[8:11], s34 offen offset:512 sc1
    s_add_u32 s34, s34, 524288
    s_and_b32 s6, s34, 1572864
    s_cselect_b32 s6, 0, 8192
    s_xor_b32 s34, s34, s6
    v_mov_b32 v10, 61
    s_mov_b64 exec, 1
    buffer_store_dword v10, v9, s[8:11], s33 offen
    s_mov_b64 exec, -1
    s_barrier
    s_mov_b32 s31, 0
Cfx1_l:
    buffer_load_dword v250, v248, s[8:11], s22 offen sc1
    s_waitcnt vmcnt(0)
Cfx1_c:
    v_cmp_gt_u32 vcc, 63, v250
    s_cbranch_vccz Cfx1_o
    s_sleep 1
    s_add_u32 s31, s31, 1
    s_cmp_lt_u32 s31, s30
    s_cbranch_scc1 Cfx1_l
    s_mov_b32 s30, 1
Cfx1_o:
    buffer_load_dwordx4 v2, s[8:11], s23 offen offset:0 sc1 lds
    buffer_load_dwordx4 v2, s[8:11], s23 offen offset:1024 sc1 lds
    buffer_load_dwordx4 v2, s[8:11], s23 offen offset:2048 sc1 lds
    v_add_u32 v0, 32768, v194
    v_add_u32 v193, 16384, v195
    s_waitcnt vmcnt(0) lgkmcnt(0)
    s_barrier
    ds_read_b128 v[168:171], v0 offset:0
    ds_read_b128 v[136:139], v246 offset:0
    ds_read_b128 v[140:143], v246 offset:1024
    ds_read_b128 v[172:175], v0 offset:1024
    ds_read_b128 v[144:147], v246 offset:2048
    ds_read_b128 v[148:151], v246 offset:3072
    ds_read_b128 v[176:179], v0 offset:2048
    ds_read_b128 v[152:155], v246 offset:4096
    ds_read_b128 v[156:159], v246 offset:5120
    ds_read_b128 v[180:183], v0 offset:3072
    ds_read_b128 v[160:163], v246 offset:6144
    ds_read_b128 v[164:167], v246 offset:7168
    s_waitcnt lgkmcnt(10)
    v_mfma_f32_16x16x32_bf16 v[236:239], v[168:171], v[136:139], 0
    ds_read_b128 v[184:187], v193 offset:0
    s_waitcnt lgkmcnt(10)
    v_mfma_f32_16x16x32_bf16 v[252:255], v[168:171], v[140:143], 0
    ds_read_b128 v[16:19], v245 offset:0
    s_waitcnt lgkmcnt(9)
    v_mfma_f32_16x16x32_bf16 v[236:239], v[172:175], v[144:147], v[236:239]
    ds_read_b128 v[20:23], v245 offset:512
    s_waitcnt lgkmcnt(9)
    v_mfma_f32_16x16x32_bf16 v[252:255], v[172:175], v[148:151], v[252:255]
    ds_read_b128 v[188:191], v193 offset:1024
    s_waitcnt lgkmcnt(8)
    v_mfma_f32_16x16x32_bf16 v[236:239], v[176:179], v[152:155], v[236:239]
    ds_read_b128 v[24:27], v245 offset:1024
    s_waitcnt lgkmcnt(8)
    v_mfma_f32_16x16x32_bf16 v[252:255], v[176:179], v[156:159], v[252:255]
    ds_read_b128 v[28:31], v245 offset:1536
    s_waitcnt lgkmcnt(7)
    v_mfma_f32_16x16x32_bf16 v[236:239], v[180:183], v[160:163], v[236:239]
    s_waitcnt lgkmcnt(6)
    v_mfma_f32_16x16x32_bf16 v[252:255], v[180:183], v[164:167], v[252:255]
    s_waitcnt lgkmcnt(4)
    v_mfma_f32_16x16x32_bf16 v[236:239], v[184:187], v[16:19], v[236:239]
    s_waitcnt lgkmcnt(3)
    v_mfma_f32_16x16x32_bf16 v[252:255], v[184:187], v[20:23], v[252:255]
    s_waitcnt lgkmcnt(1)
    v_mfma_f32_16x16x32_bf16 v[236:239], v[188:191], v[24:27], v[236:239]
    s_waitcnt lgkmcnt(0)
    v_mfma_f32_16x16x32_bf16 v[252:255], v[188:191], v[28:31], v[252:255]
    s_nop 3
    v_cvt_pk_bf16_f32 v232, v236, v237
    v_cvt_pk_bf16_f32 v233, v238, v239
    s_nop 1
    v_cvt_pk_bf16_f32 v234, v252, v253
    v_cvt_pk_bf16_f32 v235, v254, v255
    buffer_store_dwordx2 v[232:233], v12, s[8:11], s34 offen offset:0 sc1
    buffer_store_dwordx2 v[234:235], v12, s[8:11], s34 offen offset:512 sc1
    s_add_u32 s34, s34, 524288
    s_and_b32 s6, s34, 1572864
    s_cselect_b32 s6, 0, 8192
    s_xor_b32 s34, s34, s6
    v_mov_b32 v10, 62
    s_mov_b64 exec, 1
    buffer_store_dword v10, v9, s[8:11], s33 offen
    s_mov_b64 exec, -1
    s_barrier
    s_mov_b32 s31, 0
Cfx2_l:
    buffer_load_dword v250, v248, s[8:11], s22 offen sc1
    s_waitcnt vmcnt(0)
Cfx2_c:
    v_cmp_gt_u32 vcc, 64, v250
    s_cbranch_vccz Cfx2_o
    s_sleep 1
    s_add_u32 s31, s31, 1
    s_cmp_lt_u32 s31, s30
    s_cbranch_scc1 Cfx2_l
    s_mov_b32 s30, 1
Cfx2_o:
    s_add_u32 s23, s36, s92
    s_mov_b32 m0, s93
    s_add_u32 s36, s36, 65536
    s_and_b32 s36, s36, 262143
    buffer_load_dwordx4 v2, s[8:11], s23 offen offset:0 sc1 lds
    buffer_load_dwordx4 v2, s[8:11], s23 offen offset:1024 sc1 lds
    buffer_load_dwordx4 v2, s[8:11], s23 offen offset:2048 sc1 lds
    v_add_u32 v0, 49152, v194
    v_add_u32 v193, 24576, v195
    s_waitcnt vmcnt(0)
    s_barrier
    ds_read_b128 v[168:171], v0 offset:0
    ds_read_b128 v[136:139], v246 offset:0
    ds_read_b128 v[140:143], v246 offset:1024
    ds_read_b128 v[172:175], v0 offset:1024
    ds_read_b128 v[144:147], v246 offset:2048
    ds_read_b128 v[148:151], v246 offset:3072
    ds_read_b128 v[176:179], v0 offset:2048
    ds_read_b128 v[152:155], v246 offset:4096
    ds_read_b128 v[156:159], v246 offset:5120
    ds_read_b128 v[180:183], v0 offset:3072
    ds_read_b128 v[160:163], v246 offset:6144
    ds_read_b128 v[164:167], v246 offset:7168
    s_waitcnt lgkmcnt(10)
    v_mfma_f32_16x16x32_bf16 v[236:239], v[168:171], v[136:139], 0
    ds_read_b128 v[184:187], v193 offset:0
    s_waitcnt lgkmcnt(10)
    v_mfma_f32_16x16x32_bf16 v[252:255], v[168:171], v[140:143], 0
    ds_read_b128 v[16:19], v245 offset:0
    s_waitcnt lgkmcnt(9)
    v_mfma_f32_16x16x32_bf16 v[236:239], v[172:175], v[144:147], v[236:239]
    ds_read_b128 v[20:23], v245 offset:512
    s_waitcnt lgkmcnt(9)
    v_mfma_f32_16x16x32_bf16 v[252:255], v[172:175], v[148:151], v[252:255]
    ds_read_b128 v[188:191], v193 offset:1024
    s_waitcnt lgkmcnt(8)
    v_mfma_f32_16x16x32_bf16 v[236:239], v[176:179], v[152:155], v[236:239]
    ds_read_b128 v[24:27], v245 offset:1024
    s_waitcnt lgkmcnt(8)
    v_mfma_f32_16x16x32_bf16 v[252:255], v[176:179], v[156:159], v[252:255]
    ds_read_b128 v[28:31], v245 offset:1536
    s_waitcnt lgkmcnt(7)
    v_mfma_f32_16x16x32_bf16 v[236:239], v[180:183], v[160:163], v[236:239]
    s_waitcnt lgkmcnt(6)
    v_mfma_f32_16x16x32_bf16 v[252:255], v[180:183], v[164:167], v[252:255]
    s_waitcnt lgkmcnt(4)
    v_mfma_f32_16x16x32_bf16 v[236:239], v[184:187], v[16:19], v[236:239]
    s_waitcnt lgkmcnt(3)
    v_mfma_f32_16x16x32_bf16 v[252:255], v[184:187], v[20:23], v[252:255]
    s_waitcnt lgkmcnt(1)
    v_mfma_f32_16x16x32_bf16 v[236:239], v[188:191], v[24:27], v[236:239]
    s_waitcnt lgkmcnt(0)
    v_mfma_f32_16x16x32_bf16 v[252:255], v[188:191], v[28:31], v[252:255]
    s_nop 3
    v_cvt_pk_bf16_f32 v232, v236, v237
    v_cvt_pk_bf16_f32 v233, v238, v239
    s_nop 1
    v_cvt_pk_bf16_f32 v234, v252, v253
    v_cvt_pk_bf16_f32 v235, v254, v255
    buffer_store_dwordx2 v[232:233], v12, s[8:11], s34 offen offset:0 sc1
    buffer_store_dwordx2 v[234:235], v12, s[8:11], s34 offen offset:512 sc1
    s_add_u32 s34, s34, 524288
    s_and_b32 s6, s34, 1572864
    s_cselect_b32 s6, 0, 8192
    s_xor_b32 s34, s34, s6
    v_mov_b32 v10, 63
    s_mov_b64 exec, 1
    buffer_store_dword v10, v9, s[8:11], s33 offen
    s_mov_b64 exec, -1
    s_branch R_done
Cf_fw:
    s_mov_b32 s31, 0
Cffv_l:
    buffer_load_dword v250, v247, s[8:11], s22 offen sc1
    s_waitcnt vmcnt(0)
Cffv_c:
    v_cmp_gt_u32 vcc, s46, v250
    s_cbranch_vccz Cffv_o
    s_sleep 1
    s_add_u32 s31, s31, 1
    s_cmp_lt_u32 s31, s30
    s_cbranch_scc1 Cffv_l
    s_mov_b32 s30, 1
Cffv_o:
    s_mov_b32 s31, 0
Cffx_l:
    buffer_load_dword v250, v248, s[8:11], s22 offen sc1
    s_waitcnt vmcnt(0)
Cffx_c:
    v_cmp_gt_u32 vcc, s47, v250
    s_cbranch_vccz Cffx_o
    s_sleep 1
    s_add_u32 s31, s31, 1
    s_cmp_lt_u32 s31, s30
    s_cbranch_scc1 Cffx_l
    s_mov_b32 s30, 1
Cffx_o:
    s_branch Cf_fo
Cf_v1:
    s_mov_b32 s31, 0
Cfv3_l:
    buffer_load_dword v250, v247, s[8:11], s22 offen sc1
    s_waitcnt vmcnt(0)
Cfv3_c:
    v_cmp_gt_u32 vcc, 2, v250
    s_cbranch_vccz Cfv3_o
    s_sleep 1
    s_add_u32 s31, s31, 1
    s_cmp_lt_u32 s31, s30
    s_cbranch_scc1 Cfv3_l
    s_mov_b32 s30, 1
Cfv3_o:
    s_add_u32 s4, 2, 3
    s_and_b32 s4, s4, 3
    s_mul_i32 s4, s4, 49152
    s_add_u32 s40, s4, s27
    s_add_u32 s41, s40, 4096
    s_add_u32 s42, s40, 8192
    buffer_load_dwordx4 v[48:51], v2, s[8:11], s40 offen offset:0 sc1
    buffer_load_dwordx4 v[52:55], v2, s[8:11], s40 offen offset:1024 sc1
    buffer_load_dwordx4 v[56:59], v2, s[8:11], s40 offen offset:2048 sc1
    buffer_load_dwordx4 v[60:63], v2, s[8:11], s40 offen offset:3072 sc1
    buffer_load_dwordx4 v[64:67], v2, s[8:11], s41 offen offset:0 sc1
    buffer_load_dwordx4 v[68:71], v2, s[8:11], s41 offen offset:1024 sc1
    buffer_load_dwordx4 v[72:75], v2, s[8:11], s41 offen offset:2048 sc1
    buffer_load_dwordx4 v[76:79], v2, s[8:11], s41 offen offset:3072 sc1
    buffer_load_dwordx4 v[80:83], v2, s[8:11], s42 offen offset:0 sc1
    buffer_load_dwordx4 v[84:87], v2, s[8:11], s42 offen offset:1024 sc1
    buffer_load_dwordx4 v[88:91], v2, s[8:11], s42 offen offset:2048 sc1
    buffer_load_dwordx4 v[92:95], v2, s[8:11], s42 offen offset:3072 sc1
    s_add_u32 s4, s46, 3
    s_and_b32 s4, s4, 3
    s_mul_i32 s4, s4, 49152
    s_add_u32 s40, s4, s27
    s_add_u32 s41, s40, 4096
    s_add_u32 s42, s40, 8192
    s_waitcnt vmcnt(0)
    s_branch Cf_v1r
Cfm_s:
    s_mov_b32 s31, 0
Cfm_l:
    buffer_load_dwordx4 v[16:19], v2, s[8:11], s38 offen offset:0 sc1
    buffer_load_dwordx4 v[20:23], v2, s[8:11], s38 offen offset:1024 sc1
    buffer_load_dwordx4 v[24:27], v2, s[8:11], s38 offen offset:2048 sc1
    s_nop 7
    v_mov_b32 v96, 0
    v_mov_b32 v97, 0
    v_mov_b32 v98, 0
    v_mov_b32 v99, 0
    v_mov_b32 v100, 0
    v_mov_b32 v101, 0
    v_mov_b32 v102, 0
    v_mov_b32 v103, 0
    v_mov_b32 v104, 0
    v_mov_b32 v105, 0
    v_mov_b32 v106, 0
    v_mov_b32 v107, 0
    v_mov_b32 v108, 0
    v_mov_b32 v109, 0
    v_mov_b32 v110, 0
    v_mov_b32 v111, 0
    s_waitcnt vmcnt(0)
    v_max3_u32 v251, v16, v18, v20
    v_max3_u32 v251, v251, v22, v24
    v_max_u32 v251, v251, v26
    v_cmp_eq_u32 vcc, -1, v251
    s_cbranch_vccz Cfm_b
    s_add_u32 s31, s31, 1
    s_cmp_lt_u32 s31, s30
    s_cbranch_scc1 Cfm_l
    s_mov_b32 s30, 1
    v_min_u32 v16, s48, v16
    v_min_u32 v18, s48, v18
    v_min_u32 v20, s48, v20
    v_min_u32 v22, s48, v22
    v_min_u32 v24, s48, v24
    v_min_u32 v26, s48, v26
    s_branch Cfm_b
Cfg_s:
    s_mov_b32 s31, 0
Cfg_l:
    s_load_dword s84, s[8:9], s37 glc
    s_load_dword s85, s[8:9], s43 glc
    s_or_b64 s[6:7], s[84:85], s[94:95]
    s_min_u32 s6, s6, s7
    s_cmp_ge_u32 s6, s21
    s_cbranch_scc1 Cfg_o
    s_or_b64 s[6:7], s[84:85], s[94:95]
    s_min_u32 s6, s6, s7
    s_cmp_ge_u32 s6, s21
    s_cbranch_scc1 Cfg_o
    s_or_b64 s[6:7], s[84:85], s[94:95]
    s_min_u32 s6, s6, s7
    s_cmp_ge_u32 s6, s21
    s_cbranch_scc1 Cfg_o
    s_or_b64 s[6:7], s[84:85], s[94:95]
    s_min_u32 s6, s6, s7
    s_cmp_ge_u32 s6, s21
    s_cbranch_scc1 Cfg_o
    s_or_b64 s[6:7], s[84:85], s[94:95]
    s_min_u32 s6, s6, s7
    s_cmp_ge_u32 s6, s21
    s_cbranch_scc1 Cfg_o
    s_or_b64 s[6:7], s[84:85], s[94:95]
    s_min_u32 s6, s6, s7
    s_cmp_ge_u32 s6, s21
    s_cbranch_scc1 Cfg_o
    s_add_u32 s31, s31, 1
    s_cmp_lt_u32 s31, s30
    s_cbranch_scc1 Cfg_l
    s_mov_b32 s30, 1
    s_branch Cfg_o
Cf4_s:
    s_mov_b32 s31, 0
Cf4_l:
    buffer_load_dwordx4 v[204:207], v8, s[8:11], s35 offen offset:0 sc1
    buffer_load_dwordx4 v[208:211], v8, s[8:11], s35 offen offset:1024 sc1
    s_waitcnt vmcnt(0)
    v_mfma_f32_16x16x32_bf16 v[32:35], v[224:227], v[204:207], 0
    v_max3_u32 v36, v204, v206, v208
    v_mfma_f32_16x16x32_bf16 v[32:35], v[224:227], v[208:211], v[32:35]
    v_max_u32 v36, v36, v210
    v_cmp_eq_u32 vcc, -1, v36
    s_nop 7
    s_cbranch_vccz Cf4_o
    s_add_u32 s31, s31, 1
    s_cmp_lt_u32 s31, s30
    s_cbranch_scc1 Cf4_l
    s_mov_b32 s30, 1
    v_cvt_pk_bf16_f32 v38, v32, v33
    v_cvt_pk_bf16_f32 v39, v34, v35
    v_min_u32 v38, s48, v38
    v_min_u32 v39, s48, v39
    s_branch Cf4_z
Cfs_s:
    s_mov_b32 s31, 0
Cfs_l:
    buffer_load_dwordx4 v[28:31], v2, s[8:11], s39 offen offset:0 sc1
    buffer_load_dwordx4 v[32:35], v2, s[8:11], s39 offen offset:1024 sc1
    buffer_load_dwordx4 v[36:39], v2, s[8:11], s39 offen offset:2048 sc1
    buffer_load_dwordx3 v[40:42], v2, s[8:11], s39 offen offset:3072 sc1
    s_waitcnt vmcnt(0)
    v_max3_u32 v250, v28, v32, v36
    v_max3_u32 v250, v250, v40, v41
    v_max_u32 v250, v250, v42
    v_cmp_eq_u32 vcc, -1, v250
    s_cbranch_vccz Cfs_b
    s_add_u32 s31, s31, 1
    s_cmp_lt_u32 s31, s30
    s_cbranch_scc1 Cfs_l
    s_mov_b32 s30, 1
    v_min_u32 v28, s48, v28
    v_min_u32 v29, s48, v29
    v_min_u32 v30, s48, v30
    v_min_u32 v31, s48, v31
    v_min_u32 v32, s48, v32
    v_min_u32 v33, s48, v33
    v_min_u32 v34, s48, v34
    v_min_u32 v35, s48, v35
    v_min_u32 v36, s48, v36
    v_min_u32 v37, s48, v37
    v_min_u32 v38, s48, v38
    v_min_u32 v39, s48, v39
    v_min_u32 v40, s48, v40
    v_min_u32 v41, s48, v41
    v_min_u32 v42, s48, v42
    s_branch Cfs_b
Cs_go:
    s_lshl_b32 s4, s3, 12
    v_add_u32 v194, s4, v2
    s_lshl_b32 s4, s3, 11
    s_add_u32 s4, s4, 65536
    v_add_u32 v195, s4, v2
    s_lshr_b32 s4, s3, 1
    s_lshl_b32 s4, s4, 10
    s_and_b32 s5, s3, 1
    s_lshl_b32 s5, s5, 3
    s_add_u32 s4, s4, s5
    s_add_u32 s4, s4, 65536
    v_add_u32 v196, s4, v2
    s_lshl_b32 s4, s3, 10
    v_add_u32 v197, s4, v2
    v_mov_b32 v3, v197
    s_mul_i32 s4, s3, 3072
    s_min_u32 s4, s4, 7168
    s_add_u32 s92, s4, s22
    s_add_u32 s92, s92, 405504
    s_add_u32 s93, s4, 102400
    s_mov_b64 s[84:85], 0
    s_mov_b64 s[86:87], 0
    s_mov_b64 s[88:89], 0
    s_mov_b64 s[90:91], 0
    s_mul_i32 s4, s3, 3072
    s_add_u32 s29, s4, s22
    s_add_u32 s29, s29, 106496
    s_lshl_b32 s4, s3, 12
    s_add_u32 s32, s4, s22
    s_add_u32 s32, s32, 40960
    s_barrier
    s_mov_b32 s31, 0
Csv1_l:
    buffer_load_dword v250, v247, s[8:11], s22 offen sc1
    s_waitcnt vmcnt(0)
Csv1_c:
    v_cmp_gt_u32 vcc, 1, v250
    s_cbranch_vccz Csv1_o
    s_sleep 1
    s_add_u32 s31, s31, 1
    s_cmp_lt_u32 s31, s30
    s_cbranch_scc1 Csv1_l
    s_mov_b32 s30, 1
Csv1_o:
    s_add_u32 s4, 1, 3
    s_and_b32 s4, s4, 3
    s_mul_i32 s4, s4, 49152
    s_add_u32 s40, s4, s27
    s_add_u32 s41, s40, 4096
    s_add_u32 s42, s40, 8192
    buffer_load_dwordx4 v[48:51], v2, s[8:11], s40 offen offset:0 sc1
    buffer_load_dwordx4 v[52:55], v2, s[8:11], s40 offen offset:1024 sc1
    buffer_load_dwordx4 v[56:59], v2, s[8:11], s40 offen offset:2048 sc1
    buffer_load_dwordx4 v[60:63], v2, s[8:11], s40 offen offset:3072 sc1
    buffer_load_dwordx4 v[64:67], v2, s[8:11], s41 offen offset:0 sc1
    buffer_load_dwordx4 v[68:71], v2, s[8:11], s41 offen offset:1024 sc1
    buffer_load_dwordx4 v[72:75], v2, s[8:11], s41 offen offset:2048 sc1
    buffer_load_dwordx4 v[76:79], v2, s[8:11], s41 offen offset:3072 sc1
    buffer_load_dwordx4 v[80:83], v2, s[8:11], s42 offen offset:0 sc1
    buffer_load_dwordx4 v[84:87], v2, s[8:11], s42 offen offset:1024 sc1
    buffer_load_dwordx4 v[88:91], v2, s[8:11], s42 offen offset:2048 sc1
    buffer_load_dwordx4 v[92:95], v2, s[8:11], s42 offen offset:3072 sc1
    s_waitcnt vmcnt(0)
    v_mfma_f32_16x16x32_bf16 v[136:139], v[48:51], a[0:3], 0
    v_mfma_f32_16x16x32_bf16 v[144:147], v[48:51], a[24:27], 0
    v_mfma_f32_16x16x32_bf16 v[152:155], v[48:51], a[48:51], 0
    v_mfma_f32_16x16x32_bf16 v[160:163], v[48:51], a[72:75], 0
    v_mfma_f32_16x16x32_bf16 v[140:143], v[72:75], a[0:3], 0
    v_mfma_f32_16x16x32_bf16 v[148:151], v[72:75], a[24:27], 0
    v_mfma_f32_16x16x32_bf16 v[156:159], v[72:75], a[48:51], 0
    v_mfma_f32_16x16x32_bf16 v[164:167], v[72:75], a[72:75], 0
    v_mfma_f32_16x16x32_bf16 v[136:139], v[52:55], a[4:7], v[136:139]
    v_mfma_f32_16x16x32_bf16 v[144:147], v[52:55], a[28:31], v[144:147]
    v_mfma_f32_16x16x32_bf16 v[152:155], v[52:55], a[52:55], v[152:155]
    v_mfma_f32_16x16x32_bf16 v[160:163], v[52:55], a[76:79], v[160:163]
    v_mfma_f32_16x16x32_bf16 v[140:143], v[76:79], a[4:7], v[140:143]
    v_mfma_f32_16x16x32_bf16 v[148:151], v[76:79], a[28:31], v[148:151]
    v_mfma_f32_16x16x32_bf16 v[156:159], v[76:79], a[52:55], v[156:159]
    v_mfma_f32_16x16x32_bf16 v[164:167], v[76:79], a[76:79], v[164:167]
    v_mfma_f32_16x16x32_bf16 v[136:139], v[56:59], a[8:11], v[136:139]
    v_mfma_f32_16x16x32_bf16 v[144:147], v[56:59], a[32:35], v[144:147]
    v_mfma_f32_16x16x32_bf16 v[152:155], v[56:59], a[56:59], v[152:155]
    v_mfma_f32_16x16x32_bf16 v[160:163], v[56:59], a[80:83], v[160:163]
    v_mfma_f32_16x16x32_bf16 v[140:143], v[80:83], a[8:11], v[140:143]
    v_mfma_f32_16x16x32_bf16 v[148:151], v[80:83], a[32:35], v[148:151]
    v_mfma_f32_16x16x32_bf16 v[156:159], v[80:83], a[56:59], v[156:159]
    v_mfma_f32_16x16x32_bf16 v[164:167], v[80:83], a[80:83], v[164:167]
    v_mfma_f32_16x16x32_bf16 v[136:139], v[60:63], a[12:15], v[136:139]
    v_mfma_f32_16x16x32_bf16 v[144:147], v[60:63], a[36:39], v[144:147]
    v_mfma_f32_16x16x32_bf16 v[152:155], v[60:63], a[60:63], v[152:155]
    v_mfma_f32_16x16x32_bf16 v[160:163], v[60:63], a[84:87], v[160:163]
    v_mfma_f32_16x16x32_bf16 v[140:143], v[84:87], a[12:15], v[140:143]
    v_mfma_f32_16x16x32_bf16 v[148:151], v[84:87], a[36:39], v[148:151]
    v_mfma_f32_16x16x32_bf16 v[156:159], v[84:87], a[60:63], v[156:159]
    v_mfma_f32_16x16x32_bf16 v[164:167], v[84:87], a[84:87], v[164:167]
    v_mfma_f32_16x16x32_bf16 v[136:139], v[64:67], a[16:19], v[136:139]
    v_mfma_f32_16x16x32_bf16 v[144:147], v[64:67], a[40:43], v[144:147]
    v_mfma_f32_16x16x32_bf16 v[152:155], v[64:67], a[64:67], v[152:155]
    v_mfma_f32_16x16x32_bf16 v[160:163], v[64:67], a[88:91], v[160:163]
    v_mfma_f32_16x16x32_bf16 v[140:143], v[88:91], a[16:19], v[140:143]
    v_mfma_f32_16x16x32_bf16 v[148:151], v[88:91], a[40:43], v[148:151]
    v_mfma_f32_16x16x32_bf16 v[156:159], v[88:91], a[64:67], v[156:159]
    v_mfma_f32_16x16x32_bf16 v[164:167], v[88:91], a[88:91], v[164:167]
    v_mfma_f32_16x16x32_bf16 v[136:139], v[68:71], a[20:23], v[136:139]
    v_mfma_f32_16x16x32_bf16 v[144:147], v[68:71], a[44:47], v[144:147]
    v_mfma_f32_16x16x32_bf16 v[152:155], v[68:71], a[68:71], v[152:155]
    v_mfma_f32_16x16x32_bf16 v[160:163], v[68:71], a[92:95], v[160:163]
    v_mfma_f32_16x16x32_bf16 v[140:143], v[92:95], a[20:23], v[140:143]
    v_mfma_f32_16x16x32_bf16 v[148:151], v[92:95], a[44:47], v[148:151]
    v_mfma_f32_16x16x32_bf16 v[156:159], v[92:95], a[68:71], v[156:159]
    v_mfma_f32_16x16x32_bf16 v[164:167], v[92:95], a[92:95], v[164:167]
    v_cvt_pk_bf16_f32 v168, v136, v137
    v_cvt_pk_bf16_f32 v169, v140, v141
    v_cvt_pk_bf16_f32 v170, v138, v139
    v_cvt_pk_bf16_f32 v171, v142, v143
    ds_write_b128 v3, v[168:171] offset:0
    v_cvt_pk_bf16_f32 v172, v144, v145
    v_cvt_pk_bf16_f32 v173, v148, v149
    v_cvt_pk_bf16_f32 v174, v146, v147
    v_cvt_pk_bf16_f32 v175, v150, v151
    ds_write_b128 v3, v[172:175] offset:4096
    v_cvt_pk_bf16_f32 v176, v152, v153
    v_cvt_pk_bf16_f32 v177, v156, v157
    v_cvt_pk_bf16_f32 v178, v154, v155
    v_cvt_pk_bf16_f32 v179, v158, v159
    ds_write_b128 v3, v[176:179] offset:8192
    v_cvt_pk_bf16_f32 v180, v160, v161
    v_cvt_pk_bf16_f32 v181, v164, v165
    v_cvt_pk_bf16_f32 v182, v162, v163
    v_cvt_pk_bf16_f32 v183, v166, v167
    ds_write_b128 v3, v[180:183] offset:12288
    s_and_b32 s28, s21, 3
    s_lshl_b32 s4, s28, 14
    v_add_u32 v192, s4, v194
    s_lshl_b32 s4, s28, 13
    v_add_u32 v13, s4, v195
    v_add_u32 v10, s4, v196
    v_xor_b32 v0, 32768, v192
    v_xor_b32 v193, 16384, v13
    s_mul_i32 s4, s28, 12288
    s_add_u32 s38, s4, s29
    s_mul_i32 s4, s28, 16384
    s_add_u32 s39, s4, s32
    s_mul_i32 s4, s28, 10240
    s_add_u32 s25, s4, s22
    s_xor_b32 s4, s28, 2
    s_mul_i32 s4, s4, 10240
    s_add_u32 s26, s4, s22
    s_add_u32 s4, s21, 1
    v_mov_b32 v228, s4
    v_mov_b32 v96, 0
    v_mov_b32 v97, 0
    v_mov_b32 v98, 0
    v_mov_b32 v99, 0
    v_mov_b32 v100, 0
    v_mov_b32 v101, 0
    v_mov_b32 v102, 0
    v_mov_b32 v103, 0
    v_mov_b32 v104, 0
    v_mov_b32 v105, 0
    v_mov_b32 v106, 0
    v_mov_b32 v107, 0
    v_mov_b32 v108, 0
    v_mov_b32 v109, 0
    v_mov_b32 v110, 0
    v_mov_b32 v111, 0
    s_waitcnt lgkmcnt(0)
    s_barrier
    s_mul_i32 s4, s28, 163840
    s_add_u32 s35, s4, 2097152
    s_add_u32 s4, s28, 1
    s_and_b32 s4, s4, 3
    s_lshl_b32 s4, s4, 14
    v_add_u32 v3, s4, v197
    s_add_u32 s46, s21, 3
    s_min_u32 s46, s46, 64
    s_mov_b32 s47, s21
    s_add_u32 s4, s46, 3
    s_and_b32 s4, s4, 3
    s_mul_i32 s4, s4, 49152
    s_add_u32 s40, s4, s27
    s_add_u32 s41, s40, 4096
    s_add_u32 s42, s40, 8192
    s_add_u32 s23, s36, s92
    s_mov_b32 m0, s93
    s_add_u32 s36, s36, 65536
    s_and_b32 s36, s36, 262143
    ds_read_b128 v[120:123], v192 offset:0
    ds_read_b128 v[124:127], v192 offset:1024
    ds_read_b128 v[128:131], v192 offset:2048
    ds_read_b128 v[132:135], v192 offset:3072
Cs_loop:
    s_add_u32 s21, s21, 1
    buffer_load_dword v47, v4, s[8:11], s22 offen offset:0 sc1
    s_nop 15
    s_mov_b32 s31, -1
Csl_l:
    buffer_load_dword v47, v4, s[8:11], s22 offen offset:0 sc1
    s_add_u32 s31, s31, 1
    s_cmp_lt_u32 s31, s30
    s_cselect_b32 s30, s30, 1
    s_cbranch_scc0 Csl_o
    s_waitcnt vmcnt(1)
    v_cmp_gt_u32 vcc, s21, v47
    s_cbranch_vccnz Csl_l
Csl_o:
    buffer_load_dwordx4 v[16:19], v2, s[8:11], s38 offen offset:0 sc1
    buffer_load_dwordx4 v[20:23], v2, s[8:11], s38 offen offset:1024 sc1
    buffer_load_dwordx4 v[24:27], v2, s[8:11], s38 offen offset:2048 sc1
Csm_b:
    s_waitcnt vmcnt(2)
    v_smfmac_f32_16x16x64_bf16 v[96:99], v[16:19], a[0:7], v5
    buffer_load_dwordx4 v[28:31], v2, s[8:11], s39 offen offset:0 sc1
    v_smfmac_f32_16x16x64_bf16 v[100:103], v[16:19], a[24:31], v5
    buffer_load_dwordx4 v[32:35], v2, s[8:11], s39 offen offset:1024 sc1
    v_smfmac_f32_16x16x64_bf16 v[104:107], v[16:19], a[48:55], v5
    buffer_load_dwordx4 v[36:39], v2, s[8:11], s39 offen offset:2048 sc1
    v_smfmac_f32_16x16x64_bf16 v[108:111], v[16:19], a[72:79], v5
    buffer_load_dwordx3 v[40:42], v2, s[8:11], s39 offen offset:3072 sc1
    s_waitcnt vmcnt(5)
    v_smfmac_f32_16x16x64_bf16 v[96:99], v[20:23], a[8:15], v5
    v_smfmac_f32_16x16x64_bf16 v[100:103], v[20:23], a[32:39], v5
    v_smfmac_f32_16x16x64_bf16 v[104:107], v[20:23], a[56:63], v5
    v_smfmac_f32_16x16x64_bf16 v[108:111], v[20:23], a[80:87], v5
    s_waitcnt vmcnt(4)
    v_smfmac_f32_16x16x64_bf16 v[96:99], v[24:27], a[16:23], v5
    v_max3_u32 v251, v16, v18, v20
    v_smfmac_f32_16x16x64_bf16 v[100:103], v[24:27], a[40:47], v5
    v_max3_u32 v251, v251, v22, v24
    v_smfmac_f32_16x16x64_bf16 v[104:107], v[24:27], a[64:71], v5
    buffer_load_dword v45, v247, s[8:11], s22 offen offset:0 sc1
    v_max_u32 v251, v251, v26
    v_smfmac_f32_16x16x64_bf16 v[108:111], v[24:27], a[88:95], v5
    buffer_load_dword v46, v248, s[8:11], s22 offen offset:0 sc1
    v_cmp_eq_u32 vcc, -1, v251
    v_cvt_pk_bf16_f32 v112, v96, v97
    v_cvt_pk_bf16_f32 v113, v98, v99
    s_cbranch_vccnz Csm_s
    ds_write_b64 v10, v[112:113] offset:0
    v_cvt_pk_bf16_f32 v114, v100, v101
    v_cvt_pk_bf16_f32 v115, v102, v103
    ds_write_b64 v10, v[114:115] offset:2048
    v_cvt_pk_bf16_f32 v116, v104, v105
    v_cvt_pk_bf16_f32 v117, v106, v107
    ds_write_b64 v10, v[116:117] offset:4096
    v_cvt_pk_bf16_f32 v118, v108, v109
    v_cvt_pk_bf16_f32 v119, v110, v111
    ds_write_b64 v10, v[118:119] offset:6144
    s_cmp_eq_u32 s21, 64
    s_cbranch_scc1 Cs_end
    s_waitcnt vmcnt(2)
Css_b:
    v_max3_u32 v250, v28, v32, v36
    v_pk_add_f32 v[28:29], v[28:29], v[32:33]
    v_pk_add_f32 v[30:31], v[30:31], v[34:35]
    v_max3_u32 v251, v40, v41, v42
    v_add_f32 v40, v40, v41
    v_pk_add_f32 v[28:29], v[28:29], v[36:37]
    v_pk_add_f32 v[30:31], v[30:31], v[38:39]
    v_add_f32 v40, v40, v42
    v_max3_f32 v43, v28, v29, v30
    v_max3_f32 v43, v43, v31, v40
    v_max_u32 v250, v250, v251
    v_cmp_eq_u32 vcc, -1, v250
    v_max_f32 v43, v43, v43 quad_perm:[1,0,3,2] row_mask:0xf bank_mask:0xf
    s_nop 1
    v_max_f32 v43, v43, v43 quad_perm:[2,3,0,1] row_mask:0xf bank_mask:0xf
    s_nop 1
    v_max_f32 v43, v43, v43 row_half_mirror row_mask:0xf bank_mask:0xf
    s_cbranch_vccnz Css_s
    v_mul_f32 v43, s49, v43
    v_fma_f32 v28, v28, s49, -v43
    v_fma_f32 v29, v29, s49, -v43
    v_fma_f32 v30, v30, s49, -v43
    v_fma_f32 v31, v31, s49, -v43
    v_fma_f32 v40, v40, s49, -v43
    v_exp_f32 v28, v28
    v_exp_f32 v29, v29
    v_exp_f32 v30, v30
    v_exp_f32 v31, v31
    v_exp_f32 v40, v40
    v_add_f32 v43, v28, v29
    v_add_f32 v44, v30, v31
    v_add_f32 v43, v43, v44
    v_add_f32 v43, v43, v40
    s_nop 1
    v_add_f32 v43, v43, v43 quad_perm:[1,0,3,2] row_mask:0xf bank_mask:0xf
    s_nop 1
    v_add_f32 v43, v43, v43 quad_perm:[2,3,0,1] row_mask:0xf bank_mask:0xf
    s_nop 1
    v_add_f32 v43, v43, v43 row_half_mirror row_mask:0xf bank_mask:0xf
    v_rcp_f32 v43, v43
    s_nop 0
    v_mul_f32 v28, v28, v43
    v_mul_f32 v29, v29, v43
    v_mul_f32 v30, v30, v43
    v_mul_f32 v31, v31, v43
    v_mul_f32 v40, v40, v43
    v_cvt_pk_bf16_f32 v28, v28, v29
    v_cvt_pk_bf16_f32 v29, v30, v31
    v_cvt_pk_bf16_f32 v30, v40, v40
    ds_write2_b32 v11, v28, v29 offset0:0 offset1:2
    ds_write_b16 v244, v30
    s_mov_b64 exec, s[44:45]
    buffer_store_dword v228, v198, s[8:11], s24 offen offset:0 sc1
    s_mov_b64 exec, -1
    s_waitcnt lgkmcnt(0)
    s_barrier
    ds_read_b128 v[168:171], v14 offset:0
    ds_read_b128 v[172:175], v14 offset:512
    ds_read_b128 v[176:179], v14 offset:1024
    ds_read_b128 v[180:183], v14 offset:1536
    ds_read_b128 v[184:187], v15 offset:0
    ds_read_b128 v[112:115], v13 offset:0
    ds_read_b128 v[188:191], v15 offset:256
    ds_read_b128 v[116:119], v13 offset:1024
    s_waitcnt lgkmcnt(7)
    v_mfma_f32_16x16x32_bf16 v[200:203], v[120:123], v[168:171], 0
    s_waitcnt lgkmcnt(6)
    v_mfma_f32_16x16x32_bf16 v[200:203], v[124:127], v[172:175], v[200:203]
    s_waitcnt lgkmcnt(5)
    v_mfma_f32_16x16x32_bf16 v[200:203], v[128:131], v[176:179], v[200:203]
    s_waitcnt lgkmcnt(4)
    v_mfma_f32_16x16x32_bf16 v[200:203], v[132:135], v[180:183], v[200:203]
    s_waitcnt lgkmcnt(2)
    v_mfma_f32_16x16x32_bf16 v[200:203], v[112:115], v[184:187], v[200:203]
    s_waitcnt lgkmcnt(0)
    v_mfma_f32_16x16x32_bf16 v[200:203], v[116:119], v[188:191], v[200:203]
    s_load_dword s84, s[8:9], s37 glc
    s_load_dword s85, s[8:9], s43 glc
    s_nop 5
    v_cvt_pk_bf16_f32 v200, v200, v201
    v_cvt_pk_bf16_f32 v201, v202, v203
    buffer_store_dwordx2 v[200:201], v7, s[8:11], s35 offen offset:0 sc1
    s_cmp_eq_u32 s21, 1
    s_cbranch_scc1 Cs_v1
Cs_v1r:
    v_mfma_f32_16x16x32_bf16 v[136:139], v[48:51], a[0:3], 0
    v_mfma_f32_16x16x32_bf16 v[144:147], v[48:51], a[24:27], 0
    s_waitcnt vmcnt(2)
    v_cmp_gt_u32 vcc, s46, v45
    v_mfma_f32_16x16x32_bf16 v[152:155], v[48:51], a[48:51], 0
    v_cmp_gt_u32 s[6:7], s47, v46
    v_mfma_f32_16x16x32_bf16 v[160:163], v[48:51], a[72:75], 0
    s_and_b32 s28, s21, 3
    s_lshl_b32 s4, s28, 14
    v_mfma_f32_16x16x32_bf16 v[140:143], v[72:75], a[0:3], 0
    s_or_b64 vcc, vcc, s[6:7]
    s_cbranch_vccnz Cs_fw
Cs_fo:
    v_mfma_f32_16x16x32_bf16 v[148:151], v[72:75], a[24:27], 0
    v_add_u32 v192, s4, v194
    s_lshl_b32 s4, s28, 13
    v_mfma_f32_16x16x32_bf16 v[156:159], v[72:75], a[48:51], 0
    v_add_u32 v13, s4, v195
    v_add_u32 v10, s4, v196
    v_mfma_f32_16x16x32_bf16 v[164:167], v[72:75], a[72:75], 0
    buffer_store_dwordx2 v[232:233], v12, s[8:11], s34 offen offset:0 sc1
    buffer_store_dwordx2 v[234:235], v12, s[8:11], s34 offen offset:512 sc1
    s_add_u32 s34, s34, 524288
    s_and_b32 s6, s34, 1572864
    s_cselect_b32 s6, 0, 8192
    s_xor_b32 s34, s34, s6
    v_mfma_f32_16x16x32_bf16 v[136:139], v[52:55], a[4:7], v[136:139]
    s_load_dword s84, s[8:9], s37 glc
    s_load_dword s85, s[8:9], s43 glc
    v_mfma_f32_16x16x32_bf16 v[144:147], v[52:55], a[28:31], v[144:147]
    v_xor_b32 v0, 32768, v192
    v_xor_b32 v193, 16384, v13
    v_mfma_f32_16x16x32_bf16 v[152:155], v[52:55], a[52:55], v[152:155]
    s_mul_i32 s4, s28, 12288
    s_add_u32 s38, s4, s29
    v_mfma_f32_16x16x32_bf16 v[160:163], v[52:55], a[76:79], v[160:163]
    s_mul_i32 s4, s28, 16384
    s_add_u32 s39, s4, s32
    v_mfma_f32_16x16x32_bf16 v[140:143], v[76:79], a[4:7], v[140:143]
    s_mul_i32 s4, s28, 10240
    s_add_u32 s25, s4, s22
    v_mfma_f32_16x16x32_bf16 v[148:151], v[76:79], a[28:31], v[148:151]
    s_xor_b32 s4, s28, 2
    s_mul_i32 s4, s4, 10240
    v_mfma_f32_16x16x32_bf16 v[156:159], v[76:79], a[52:55], v[156:159]
    s_add_u32 s26, s4, s22
    s_add_u32 s4, s21, 1
    v_mfma_f32_16x16x32_bf16 v[164:167], v[76:79], a[76:79], v[164:167]
    v_mov_b32 v228, s4
    v_mov_b32 v96, 0
    v_mfma_f32_16x16x32_bf16 v[136:139], v[56:59], a[8:11], v[136:139]
    s_or_b64 s[6:7], s[84:85], s[94:95]
    s_min_u32 s6, s6, s7
    s_cmp_ge_u32 s6, s21
    s_cbranch_scc0 Csg_s
Csg_o:
    s_barrier
    buffer_load_dwordx4 v[204:207], v8, s[8:11], s35 offen offset:0 sc1
    buffer_load_dwordx4 v[208:211], v8, s[8:11], s35 offen offset:1024 sc1
    v_mfma_f32_16x16x32_bf16 v[144:147], v[56:59], a[32:35], v[144:147]
    v_mov_b32 v97, 0
    v_mov_b32 v98, 0
    v_mfma_f32_16x16x32_bf16 v[152:155], v[56:59], a[56:59], v[152:155]
    v_mov_b32 v99, 0
    v_mov_b32 v100, 0
    v_mfma_f32_16x16x32_bf16 v[160:163], v[56:59], a[80:83], v[160:163]
    buffer_load_dwordx4 v2, s[8:11], s23 offen offset:0 sc1 lds
    v_mfma_f32_16x16x32_bf16 v[140:143], v[80:83], a[8:11], v[140:143]
    v_mov_b32 v101, 0
    v_mov_b32 v102, 0
    v_mfma_f32_16x16x32_bf16 v[148:151], v[80:83], a[32:35], v[148:151]
    v_mov_b32 v103, 0
    v_mov_b32 v104, 0
    v_mfma_f32_16x16x32_bf16 v[156:159], v[80:83], a[56:59], v[156:159]
    v_mov_b32 v105, 0
    v_mov_b32 v106, 0
    v_mfma_f32_16x16x32_bf16 v[164:167], v[80:83], a[80:83], v[164:167]
    buffer_load_dwordx4 v2, s[8:11], s23 offen offset:1024 sc1 lds
    v_mfma_f32_16x16x32_bf16 v[136:139], v[60:63], a[12:15], v[136:139]
    v_mov_b32 v107, 0
    v_mov_b32 v108, 0
    v_mfma_f32_16x16x32_bf16 v[144:147], v[60:63], a[36:39], v[144:147]
    v_mov_b32 v109, 0
    v_mov_b32 v110, 0
    v_mfma_f32_16x16x32_bf16 v[152:155], v[60:63], a[60:63], v[152:155]
    v_mov_b32 v111, 0
    v_mfma_f32_16x16x32_bf16 v[160:163], v[60:63], a[84:87], v[160:163]
    buffer_load_dwordx4 v2, s[8:11], s23 offen offset:2048 sc1 lds
    v_mfma_f32_16x16x32_bf16 v[140:143], v[84:87], a[12:15], v[140:143]
    v_mfma_f32_16x16x32_bf16 v[148:151], v[84:87], a[36:39], v[148:151]
    v_mfma_f32_16x16x32_bf16 v[156:159], v[84:87], a[60:63], v[156:159]
    v_mfma_f32_16x16x32_bf16 v[164:167], v[84:87], a[84:87], v[164:167]
    v_mfma_f32_16x16x32_bf16 v[136:139], v[64:67], a[16:19], v[136:139]
    v_mfma_f32_16x16x32_bf16 v[144:147], v[64:67], a[40:43], v[144:147]
    v_mfma_f32_16x16x32_bf16 v[152:155], v[64:67], a[64:67], v[152:155]
    v_mfma_f32_16x16x32_bf16 v[160:163], v[64:67], a[88:91], v[160:163]
    v_mfma_f32_16x16x32_bf16 v[140:143], v[88:91], a[16:19], v[140:143]
    v_mfma_f32_16x16x32_bf16 v[148:151], v[88:91], a[40:43], v[148:151]
    v_mfma_f32_16x16x32_bf16 v[156:159], v[88:91], a[64:67], v[156:159]
    v_mfma_f32_16x16x32_bf16 v[164:167], v[88:91], a[88:91], v[164:167]
    v_mfma_f32_16x16x32_bf16 v[136:139], v[68:71], a[20:23], v[136:139]
    v_mfma_f32_16x16x32_bf16 v[144:147], v[68:71], a[44:47], v[144:147]
    s_waitcnt vmcnt(3)
    v_mfma_f32_16x16x32_bf16 v[32:35], v[224:227], v[204:207], 0
    v_max3_u32 v36, v204, v206, v208
    v_mfma_f32_16x16x32_bf16 v[32:35], v[224:227], v[208:211], v[32:35]
    v_max_u32 v36, v36, v210
    v_cmp_eq_u32 vcc, -1, v36
    s_cbranch_vccnz Cs4_s
Cs4_o:
    s_nop 4
    v_cvt_pk_bf16_f32 v38, v32, v33
    v_cvt_pk_bf16_f32 v39, v34, v35
Cs4_z:
    buffer_store_dwordx2 v[38:39], v222, s[8:11], s25 offen offset:0 sc1
    v_mfma_f32_16x16x32_bf16 v[152:155], v[68:71], a[68:71], v[152:155]
    v_mfma_f32_16x16x32_bf16 v[160:163], v[68:71], a[92:95], v[160:163]
    v_mfma_f32_16x16x32_bf16 v[140:143], v[92:95], a[20:23], v[140:143]
    v_mfma_f32_16x16x32_bf16 v[148:151], v[92:95], a[44:47], v[148:151]
    v_mfma_f32_16x16x32_bf16 v[156:159], v[92:95], a[68:71], v[156:159]
    v_mfma_f32_16x16x32_bf16 v[164:167], v[92:95], a[92:95], v[164:167]
    v_cvt_pk_bf16_f32 v168, v136, v137
    v_cvt_pk_bf16_f32 v169, v140, v141
    v_cvt_pk_bf16_f32 v170, v138, v139
    v_cvt_pk_bf16_f32 v171, v142, v143
    ds_write_b128 v3, v[168:171] offset:0
    buffer_load_dwordx4 v[48:51], v2, s[8:11], s40 offen offset:0 sc1
    v_cvt_pk_bf16_f32 v172, v144, v145
    v_cvt_pk_bf16_f32 v173, v148, v149
    v_cvt_pk_bf16_f32 v174, v146, v147
    v_cvt_pk_bf16_f32 v175, v150, v151
    ds_write_b128 v3, v[172:175] offset:4096
    buffer_load_dwordx4 v[72:75], v2, s[8:11], s41 offen offset:2048 sc1
    v_cvt_pk_bf16_f32 v176, v152, v153
    v_cvt_pk_bf16_f32 v177, v156, v157
    v_cvt_pk_bf16_f32 v178, v154, v155
    v_cvt_pk_bf16_f32 v179, v158, v159
    ds_write_b128 v3, v[176:179] offset:8192
    buffer_load_dwordx4 v[52:55], v2, s[8:11], s40 offen offset:1024 sc1
    v_cvt_pk_bf16_f32 v180, v160, v161
    v_cvt_pk_bf16_f32 v181, v164, v165
    v_cvt_pk_bf16_f32 v182, v162, v163
    v_cvt_pk_bf16_f32 v183, v166, v167
    ds_write_b128 v3, v[180:183] offset:12288
    buffer_load_dwordx4 v[76:79], v2, s[8:11], s41 offen offset:3072 sc1
    s_waitcnt vmcnt(5)
    s_waitcnt lgkmcnt(0)
    s_barrier
    ds_read_b128 v[168:171], v0 offset:0
    ds_read_b128 v[136:139], v246 offset:0
    ds_read_b128 v[140:143], v246 offset:1024
    ds_read_b128 v[172:175], v0 offset:1024
    ds_read_b128 v[144:147], v246 offset:2048
    ds_read_b128 v[148:151], v246 offset:3072
    ds_read_b128 v[176:179], v0 offset:2048
    ds_read_b128 v[152:155], v246 offset:4096
    ds_read_b128 v[156:159], v246 offset:5120
    ds_read_b128 v[180:183], v0 offset:3072
    ds_read_b128 v[160:163], v246 offset:6144
    ds_read_b128 v[164:167], v246 offset:7168
    s_waitcnt lgkmcnt(10)
    v_mfma_f32_16x16x32_bf16 v[236:239], v[168:171], v[136:139], 0
    ds_read_b128 v[184:187], v193 offset:0
    buffer_load_dwordx4 v[56:59], v2, s[8:11], s40 offen offset:2048 sc1
    s_waitcnt lgkmcnt(10)
    v_mfma_f32_16x16x32_bf16 v[252:255], v[168:171], v[140:143], 0
    ds_read_b128 v[16:19], v245 offset:0
    buffer_load_dwordx4 v[80:83], v2, s[8:11], s42 offen offset:0 sc1
    s_waitcnt lgkmcnt(9)
    v_mfma_f32_16x16x32_bf16 v[236:239], v[172:175], v[144:147], v[236:239]
    ds_read_b128 v[20:23], v245 offset:512
    buffer_load_dwordx4 v[60:63], v2, s[8:11], s40 offen offset:3072 sc1
    s_waitcnt lgkmcnt(9)
    v_mfma_f32_16x16x32_bf16 v[252:255], v[172:175], v[148:151], v[252:255]
    ds_read_b128 v[188:191], v193 offset:1024
    buffer_load_dwordx4 v[84:87], v2, s[8:11], s42 offen offset:1024 sc1
    s_waitcnt lgkmcnt(8)
    v_mfma_f32_16x16x32_bf16 v[236:239], v[176:179], v[152:155], v[236:239]
    ds_read_b128 v[24:27], v245 offset:1024
    buffer_load_dwordx4 v[64:67], v2, s[8:11], s41 offen offset:0 sc1
    s_waitcnt lgkmcnt(8)
    v_mfma_f32_16x16x32_bf16 v[252:255], v[176:179], v[156:159], v[252:255]
    ds_read_b128 v[28:31], v245 offset:1536
    buffer_load_dwordx4 v[88:91], v2, s[8:11], s42 offen offset:2048 sc1
    s_waitcnt lgkmcnt(7)
    v_mfma_f32_16x16x32_bf16 v[236:239], v[180:183], v[160:163], v[236:239]
    buffer_load_dwordx4 v[68:71], v2, s[8:11], s41 offen offset:1024 sc1
    s_waitcnt lgkmcnt(6)
    v_mfma_f32_16x16x32_bf16 v[252:255], v[180:183], v[164:167], v[252:255]
    buffer_load_dwordx4 v[92:95], v2, s[8:11], s42 offen offset:3072 sc1
    s_waitcnt lgkmcnt(4)
    v_mfma_f32_16x16x32_bf16 v[236:239], v[184:187], v[16:19], v[236:239]
    s_waitcnt lgkmcnt(3)
    v_mfma_f32_16x16x32_bf16 v[252:255], v[184:187], v[20:23], v[252:255]
    s_waitcnt lgkmcnt(1)
    v_mfma_f32_16x16x32_bf16 v[236:239], v[188:191], v[24:27], v[236:239]
    s_waitcnt lgkmcnt(0)
    v_mfma_f32_16x16x32_bf16 v[252:255], v[188:191], v[28:31], v[252:255]
    s_nop 3
    v_cvt_pk_bf16_f32 v232, v236, v237
    v_cvt_pk_bf16_f32 v233, v238, v239
    s_nop 1
    v_cvt_pk_bf16_f32 v234, v252, v253
    v_cvt_pk_bf16_f32 v235, v254, v255
    buffer_store_dwordx2 v[240:241], v6, s[8:11], s26 offen offset:0 sc1
    s_mul_i32 s4, s28, 163840
    s_add_u32 s35, s4, 2097152
    s_add_u32 s4, s28, 1
    s_and_b32 s4, s4, 3
    s_lshl_b32 s4, s4, 14
    v_add_u32 v3, s4, v197
    s_add_u32 s46, s21, 3
    s_min_u32 s46, s46, 64
    s_mov_b32 s47, s21
    s_add_u32 s4, s46, 3
    s_and_b32 s4, s4, 3
    s_mul_i32 s4, s4, 49152
    s_add_u32 s40, s4, s27
    s_add_u32 s41, s40, 4096
    s_add_u32 s42, s40, 8192
    s_add_u32 s23, s36, s92
    s_mov_b32 m0, s93
    s_add_u32 s36, s36, 65536
    s_and_b32 s36, s36, 262143
    ds_read_b128 v[120:123], v192 offset:0
    ds_read_b128 v[124:127], v192 offset:1024
    ds_read_b128 v[128:131], v192 offset:2048
    ds_read_b128 v[132:135], v192 offset:3072
    s_branch Cs_loop
Cs_end:
    buffer_store_dwordx2 v[232:233], v12, s[8:11], s34 offen offset:0 sc1
    buffer_store_dwordx2 v[234:235], v12, s[8:11], s34 offen offset:512 sc1
    s_add_u32 s34, s34, 524288
    s_and_b32 s6, s34, 1572864
    s_cselect_b32 s6, 0, 8192
    s_xor_b32 s34, s34, s6
    v_mov_b32 v10, 61
    s_mov_b64 exec, 1
    buffer_store_dword v10, v9, s[8:11], s33 offen sc1
    s_mov_b64 exec, -1
    s_barrier
    s_mov_b32 s31, 0
Csx1_l:
    buffer_load_dword v250, v248, s[8:11], s22 offen sc1
    s_waitcnt vmcnt(0)
Csx1_c:
    v_cmp_gt_u32 vcc, 63, v250
    s_cbranch_vccz Csx1_o
    s_sleep 1
    s_add_u32 s31, s31, 1
    s_cmp_lt_u32 s31, s30
    s_cbranch_scc1 Csx1_l
    s_mov_b32 s30, 1
Csx1_o:
    buffer_load_dwordx4 v2, s[8:11], s23 offen offset:0 sc1 lds
    buffer_load_dwordx4 v2, s[8:11], s23 offen offset:1024 sc1 lds
    buffer_load_dwordx4 v2, s[8:11], s23 offen offset:2048 sc1 lds
    v_add_u32 v0, 32768, v194
    v_add_u32 v193, 16384, v195
    s_waitcnt vmcnt(0) lgkmcnt(0)
    s_barrier
    ds_read_b128 v[168:171], v0 offset:0
    ds_read_b128 v[136:139], v246 offset:0
    ds_read_b128 v[140:143], v246 offset:1024
    ds_read_b128 v[172:175], v0 offset:1024
    ds_read_b128 v[144:147], v246 offset:2048
    ds_read_b128 v[148:151], v246 offset:3072
    ds_read_b128 v[176:179], v0 offset:2048
    ds_read_b128 v[152:155], v246 offset:4096
    ds_read_b128 v[156:159], v246 offset:5120
    ds_read_b128 v[180:183], v0 offset:3072
    ds_read_b128 v[160:163], v246 offset:6144
    ds_read_b128 v[164:167], v246 offset:7168
    s_waitcnt lgkmcnt(10)
    v_mfma_f32_16x16x32_bf16 v[236:239], v[168:171], v[136:139], 0
    ds_read_b128 v[184:187], v193 offset:0
    s_waitcnt lgkmcnt(10)
    v_mfma_f32_16x16x32_bf16 v[252:255], v[168:171], v[140:143], 0
    ds_read_b128 v[16:19], v245 offset:0
    s_waitcnt lgkmcnt(9)
    v_mfma_f32_16x16x32_bf16 v[236:239], v[172:175], v[144:147], v[236:239]
    ds_read_b128 v[20:23], v245 offset:512
    s_waitcnt lgkmcnt(9)
    v_mfma_f32_16x16x32_bf16 v[252:255], v[172:175], v[148:151], v[252:255]
    ds_read_b128 v[188:191], v193 offset:1024
    s_waitcnt lgkmcnt(8)
    v_mfma_f32_16x16x32_bf16 v[236:239], v[176:179], v[152:155], v[236:239]
    ds_read_b128 v[24:27], v245 offset:1024
    s_waitcnt lgkmcnt(8)
    v_mfma_f32_16x16x32_bf16 v[252:255], v[176:179], v[156:159], v[252:255]
    ds_read_b128 v[28:31], v245 offset:1536
    s_waitcnt lgkmcnt(7)
    v_mfma_f32_16x16x32_bf16 v[236:239], v[180:183], v[160:163], v[236:239]
    s_waitcnt lgkmcnt(6)
    v_mfma_f32_16x16x32_bf16 v[252:255], v[180:183], v[164:167], v[252:255]
    s_waitcnt lgkmcnt(4)
    v_mfma_f32_16x16x32_bf16 v[236:239], v[184:187], v[16:19], v[236:239]
    s_waitcnt lgkmcnt(3)
    v_mfma_f32_16x16x32_bf16 v[252:255], v[184:187], v[20:23], v[252:255]
    s_waitcnt lgkmcnt(1)
    v_mfma_f32_16x16x32_bf16 v[236:239], v[188:191], v[24:27], v[236:239]
    s_waitcnt lgkmcnt(0)
    v_mfma_f32_16x16x32_bf16 v[252:255], v[188:191], v[28:31], v[252:255]
    s_nop 3
    v_cvt_pk_bf16_f32 v232, v236, v237
    v_cvt_pk_bf16_f32 v233, v238, v239
    s_nop 1
    v_cvt_pk_bf16_f32 v234, v252, v253
    v_cvt_pk_bf16_f32 v235, v254, v255
    buffer_store_dwordx2 v[232:233], v12, s[8:11], s34 offen offset:0 sc1
    buffer_store_dwordx2 v[234:235], v12, s[8:11], s34 offen offset:512 sc1
    s_add_u32 s34, s34, 524288
    s_and_b32 s6, s34, 1572864
    s_cselect_b32 s6, 0, 8192
    s_xor_b32 s34, s34, s6
    v_mov_b32 v10, 62
    s_mov_b64 exec, 1
    buffer_store_dword v10, v9, s[8:11], s33 offen sc1
    s_mov_b64 exec, -1
    s_barrier
    s_mov_b32 s31, 0
Csx2_l:
    buffer_load_dword v250, v248, s[8:11], s22 offen sc1
    s_waitcnt vmcnt(0)
Csx2_c:
    v_cmp_gt_u32 vcc, 64, v250
    s_cbranch_vccz Csx2_o
    s_sleep 1
    s_add_u32 s31, s31, 1
    s_cmp_lt_u32 s31, s30
    s_cbranch_scc1 Csx2_l
    s_mov_b32 s30, 1
Csx2_o:
    s_add_u32 s23, s36, s92
    s_mov_b32 m0, s93
    s_add_u32 s36, s36, 65536
    s_and_b32 s36, s36, 262143
    buffer_load_dwordx4 v2, s[8:11], s23 offen offset:0 sc1 lds
    buffer_load_dwordx4 v2, s[8:11], s23 offen offset:1024 sc1 lds
    buffer_load_dwordx4 v2, s[8:11], s23 offen offset:2048 sc1 lds
    v_add_u32 v0, 49152, v194
    v_add_u32 v193, 24576, v195
    s_waitcnt vmcnt(0)
    s_barrier
    ds_read_b128 v[168:171], v0 offset:0
    ds_read_b128 v[136:139], v246 offset:0
    ds_read_b128 v[140:143], v246 offset:1024
    ds_read_b128 v[172:175], v0 offset:1024
    ds_read_b128 v[144:147], v246 offset:2048
    ds_read_b128 v[148:151], v246 offset:3072
    ds_read_b128 v[176:179], v0 offset:2048
    ds_read_b128 v[152:155], v246 offset:4096
    ds_read_b128 v[156:159], v246 offset:5120
    ds_read_b128 v[180:183], v0 offset:3072
    ds_read_b128 v[160:163], v246 offset:6144
    ds_read_b128 v[164:167], v246 offset:7168
    s_waitcnt lgkmcnt(10)
    v_mfma_f32_16x16x32_bf16 v[236:239], v[168:171], v[136:139], 0
    ds_read_b128 v[184:187], v193 offset:0
    s_waitcnt lgkmcnt(10)
    v_mfma_f32_16x16x32_bf16 v[252:255], v[168:171], v[140:143], 0
    ds_read_b128 v[16:19], v245 offset:0
    s_waitcnt lgkmcnt(9)
    v_mfma_f32_16x16x32_bf16 v[236:239], v[172:175], v[144:147], v[236:239]
    ds_read_b128 v[20:23], v245 offset:512
    s_waitcnt lgkmcnt(9)
    v_mfma_f32_16x16x32_bf16 v[252:255], v[172:175], v[148:151], v[252:255]
    ds_read_b128 v[188:191], v193 offset:1024
    s_waitcnt lgkmcnt(8)
    v_mfma_f32_16x16x32_bf16 v[236:239], v[176:179], v[152:155], v[236:239]
    ds_read_b128 v[24:27], v245 offset:1024
    s_waitcnt lgkmcnt(8)
    v_mfma_f32_16x16x32_bf16 v[252:255], v[176:179], v[156:159], v[252:255]
    ds_read_b128 v[28:31], v245 offset:1536
    s_waitcnt lgkmcnt(7)
    v_mfma_f32_16x16x32_bf16 v[236:239], v[180:183], v[160:163], v[236:239]
    s_waitcnt lgkmcnt(6)
    v_mfma_f32_16x16x32_bf16 v[252:255], v[180:183], v[164:167], v[252:255]
    s_waitcnt lgkmcnt(4)
    v_mfma_f32_16x16x32_bf16 v[236:239], v[184:187], v[16:19], v[236:239]
    s_waitcnt lgkmcnt(3)
    v_mfma_f32_16x16x32_bf16 v[252:255], v[184:187], v[20:23], v[252:255]
    s_waitcnt lgkmcnt(1)
    v_mfma_f32_16x16x32_bf16 v[236:239], v[188:191], v[24:27], v[236:239]
    s_waitcnt lgkmcnt(0)
    v_mfma_f32_16x16x32_bf16 v[252:255], v[188:191], v[28:31], v[252:255]
    s_nop 3
    v_cvt_pk_bf16_f32 v232, v236, v237
    v_cvt_pk_bf16_f32 v233, v238, v239
    s_nop 1
    v_cvt_pk_bf16_f32 v234, v252, v253
    v_cvt_pk_bf16_f32 v235, v254, v255
    buffer_store_dwordx2 v[232:233], v12, s[8:11], s34 offen offset:0 sc1
    buffer_store_dwordx2 v[234:235], v12, s[8:11], s34 offen offset:512 sc1
    s_add_u32 s34, s34, 524288
    s_and_b32 s6, s34, 1572864
    s_cselect_b32 s6, 0, 8192
    s_xor_b32 s34, s34, s6
    v_mov_b32 v10, 63
    s_mov_b64 exec, 1
    buffer_store_dword v10, v9, s[8:11], s33 offen sc1
    s_mov_b64 exec, -1
    s_branch R_done
Cs_fw:
    s_mov_b32 s31, 0
Csfv_l:
    buffer_load_dword v250, v247, s[8:11], s22 offen sc1
    s_waitcnt vmcnt(0)
Csfv_c:
    v_cmp_gt_u32 vcc, s46, v250
    s_cbranch_vccz Csfv_o
    s_sleep 1
    s_add_u32 s31, s31, 1
    s_cmp_lt_u32 s31, s30
    s_cbranch_scc1 Csfv_l
    s_mov_b32 s30, 1
Csfv_o:
    s_mov_b32 s31, 0
Csfx_l:
    buffer_load_dword v250, v248, s[8:11], s22 offen sc1
    s_waitcnt vmcnt(0)
Csfx_c:
    v_cmp_gt_u32 vcc, s47, v250
    s_cbranch_vccz Csfx_o
    s_sleep 1
    s_add_u32 s31, s31, 1
    s_cmp_lt_u32 s31, s30
    s_cbranch_scc1 Csfx_l
    s_mov_b32 s30, 1
Csfx_o:
    s_branch Cs_fo
Cs_v1:
    s_mov_b32 s31, 0
Csv3_l:
    buffer_load_dword v250, v247, s[8:11], s22 offen sc1
    s_waitcnt vmcnt(0)
Csv3_c:
    v_cmp_gt_u32 vcc, 2, v250
    s_cbranch_vccz Csv3_o
    s_sleep 1
    s_add_u32 s31, s31, 1
    s_cmp_lt_u32 s31, s30
    s_cbranch_scc1 Csv3_l
    s_mov_b32 s30, 1
Csv3_o:
    s_add_u32 s4, 2, 3
    s_and_b32 s4, s4, 3
    s_mul_i32 s4, s4, 49152
    s_add_u32 s40, s4, s27
    s_add_u32 s41, s40, 4096
    s_add_u32 s42, s40, 8192
    buffer_load_dwordx4 v[48:51], v2, s[8:11], s40 offen offset:0 sc1
    buffer_load_dwordx4 v[52:55], v2, s[8:11], s40 offen offset:1024 sc1
    buffer_load_dwordx4 v[56:59], v2, s[8:11], s40 offen offset:2048 sc1
    buffer_load_dwordx4 v[60:63], v2, s[8:11], s40 offen offset:3072 sc1
    buffer_load_dwordx4 v[64:67], v2, s[8:11], s41 offen offset:0 sc1
    buffer_load_dwordx4 v[68:71], v2, s[8:11], s41 offen offset:1024 sc1
    buffer_load_dwordx4 v[72:75], v2, s[8:11], s41 offen offset:2048 sc1
    buffer_load_dwordx4 v[76:79], v2, s[8:11], s41 offen offset:3072 sc1
    buffer_load_dwordx4 v[80:83], v2, s[8:11], s42 offen offset:0 sc1
    buffer_load_dwordx4 v[84:87], v2, s[8:11], s42 offen offset:1024 sc1
    buffer_load_dwordx4 v[88:91], v2, s[8:11], s42 offen offset:2048 sc1
    buffer_load_dwordx4 v[92:95], v2, s[8:11], s42 offen offset:3072 sc1
    s_add_u32 s4, s46, 3
    s_and_b32 s4, s4, 3
    s_mul_i32 s4, s4, 49152
    s_add_u32 s40, s4, s27
    s_add_u32 s41, s40, 4096
    s_add_u32 s42, s40, 8192
    s_waitcnt vmcnt(0)
    s_branch Cs_v1r
Csm_s:
    s_mov_b32 s31, 0
Csm_l:
    buffer_load_dwordx4 v[16:19], v2, s[8:11], s38 offen offset:0 sc1
    buffer_load_dwordx4 v[20:23], v2, s[8:11], s38 offen offset:1024 sc1
    buffer_load_dwordx4 v[24:27], v2, s[8:11], s38 offen offset:2048 sc1
    s_nop 7
    v_mov_b32 v96, 0
    v_mov_b32 v97, 0
    v_mov_b32 v98, 0
    v_mov_b32 v99, 0
    v_mov_b32 v100, 0
    v_mov_b32 v101, 0
    v_mov_b32 v102, 0
    v_mov_b32 v103, 0
    v_mov_b32 v104, 0
    v_mov_b32 v105, 0
    v_mov_b32 v106, 0
    v_mov_b32 v107, 0
    v_mov_b32 v108, 0
    v_mov_b32 v109, 0
    v_mov_b32 v110, 0
    v_mov_b32 v111, 0
    s_waitcnt vmcnt(0)
    v_max3_u32 v251, v16, v18, v20
    v_max3_u32 v251, v251, v22, v24
    v_max_u32 v251, v251, v26
    v_cmp_eq_u32 vcc, -1, v251
    s_cbranch_vccz Csm_b
    s_add_u32 s31, s31, 1
    s_cmp_lt_u32 s31, s30
    s_cbranch_scc1 Csm_l
    s_mov_b32 s30, 1
    v_min_u32 v16, s48, v16
    v_min_u32 v18, s48, v18
    v_min_u32 v20, s48, v20
    v_min_u32 v22, s48, v22
    v_min_u32 v24, s48, v24
    v_min_u32 v26, s48, v26
    s_branch Csm_b
Csg_s:
    s_mov_b32 s31, 0
Csg_l:
    s_load_dword s84, s[8:9], s37 glc
    s_load_dword s85, s[8:9], s43 glc
    s_or_b64 s[6:7], s[84:85], s[94:95]
    s_min_u32 s6, s6, s7
    s_cmp_ge_u32 s6, s21
    s_cbranch_scc1 Csg_o
    s_or_b64 s[6:7], s[84:85], s[94:95]
    s_min_u32 s6, s6, s7
    s_cmp_ge_u32 s6, s21
    s_cbranch_scc1 Csg_o
    s_or_b64 s[6:7], s[84:85], s[94:95]
    s_min_u32 s6, s6, s7
    s_cmp_ge_u32 s6, s21
    s_cbranch_scc1 Csg_o
    s_or_b64 s[6:7], s[84:85], s[94:95]
    s_min_u32 s6, s6, s7
    s_cmp_ge_u32 s6, s21
    s_cbranch_scc1 Csg_o
    s_or_b64 s[6:7], s[84:85], s[94:95]
    s_min_u32 s6, s6, s7
    s_cmp_ge_u32 s6, s21
    s_cbranch_scc1 Csg_o
    s_or_b64 s[6:7], s[84:85], s[94:95]
    s_min_u32 s6, s6, s7
    s_cmp_ge_u32 s6, s21
    s_cbranch_scc1 Csg_o
    s_add_u32 s31, s31, 1
    s_cmp_lt_u32 s31, s30
    s_cbranch_scc1 Csg_l
    s_mov_b32 s30, 1
    s_branch Csg_o
Cs4_s:
    s_mov_b32 s31, 0
Cs4_l:
    buffer_load_dwordx4 v[204:207], v8, s[8:11], s35 offen offset:0 sc1
    buffer_load_dwordx4 v[208:211], v8, s[8:11], s35 offen offset:1024 sc1
    s_waitcnt vmcnt(0)
    v_mfma_f32_16x16x32_bf16 v[32:35], v[224:227], v[204:207], 0
    v_max3_u32 v36, v204, v206, v208
    v_mfma_f32_16x16x32_bf16 v[32:35], v[224:227], v[208:211], v[32:35]
    v_max_u32 v36, v36, v210
    v_cmp_eq_u32 vcc, -1, v36
    s_nop 7
    s_cbranch_vccz Cs4_o
    s_add_u32 s31, s31, 1
    s_cmp_lt_u32 s31, s30
    s_cbranch_scc1 Cs4_l
    s_mov_b32 s30, 1
    v_cvt_pk_bf16_f32 v38, v32, v33
    v_cvt_pk_bf16_f32 v39, v34, v35
    v_min_u32 v38, s48, v38
    v_min_u32 v39, s48, v39
    s_branch Cs4_z
Css_s:
    s_mov_b32 s31, 0
Css_l:
    buffer_load_dwordx4 v[28:31], v2, s[8:11], s39 offen offset:0 sc1
    buffer_load_dwordx4 v[32:35], v2, s[8:11], s39 offen offset:1024 sc1
    buffer_load_dwordx4 v[36:39], v2, s[8:11], s39 offen offset:2048 sc1
    buffer_load_dwordx3 v[40:42], v2, s[8:11], s39 offen offset:3072 sc1
    s_waitcnt vmcnt(0)
    v_max3_u32 v250, v28, v32, v36
    v_max3_u32 v250, v250, v40, v41
    v_max_u32 v250, v250, v42
    v_cmp_eq_u32 vcc, -1, v250
    s_cbranch_vccz Css_b
    s_add_u32 s31, s31, 1
    s_cmp_lt_u32 s31, s30
    s_cbranch_scc1 Css_l
    s_mov_b32 s30, 1
    v_min_u32 v28, s48, v28
    v_min_u32 v29, s48, v29
    v_min_u32 v30, s48, v30
    v_min_u32 v31, s48, v31
    v_min_u32 v32, s48, v32
    v_min_u32 v33, s48, v33
    v_min_u32 v34, s48, v34
    v_min_u32 v35, s48, v35
    v_min_u32 v36, s48, v36
    v_min_u32 v37, s48, v37
    v_min_u32 v38, s48, v38
    v_min_u32 v39, s48, v39
    v_min_u32 v40, s48, v40
    v_min_u32 v41, s48, v41
    v_min_u32 v42, s48, v42
    s_branch Css_b
R_x:
    s_load_dwordx2 s[12:13], s[0:1], 96
    s_load_dwordx2 s[16:17], s[0:1], 104
    s_load_dwordx2 s[84:85], s[0:1], 120
    s_load_dwordx2 s[88:89], s[0:1], 0
    s_mov_b32 s14, 1280
    s_mov_b32 s15, 0x20000
    s_mov_b32 s18, 4915200
    s_mov_b32 s19, 0x20000
    s_mov_b32 s86, 256
    s_mov_b32 s87, 0x20000
    s_mov_b32 s90, 2621440
    s_mov_b32 s91, 0x20000
    s_waitcnt lgkmcnt(0)
    v_lshlrev_b32 v2, 4, v1
    s_lshl_b32 s21, s99, 2
    s_add_u32 s21, s21, s20
    s_sub_u32 s21, s21, 28
    s_mul_i32 s4, s3, 5120
    s_add_u32 s23, s4, 81920
    s_mul_i32 s26, s21, 20480
    s_add_u32 s26, s26, s4
    v_lshlrev_b32 v4, 2, v1
    s_mul_i32 s4, s3, 320
    buffer_load_dword v244, v4, s[12:15], s4 offen
    buffer_load_dword v245, v4, s[12:15], s4 offen offset:256
    s_add_u32 s4, s26, 0
    s_add_u32 m0, s23, 0
    s_nop 0
    buffer_load_dwordx4 v2, s[88:91], s4 offen offset:0 nt lds
    buffer_load_dwordx4 v2, s[88:91], s4 offen offset:1024 nt lds
    buffer_load_dwordx4 v2, s[88:91], s4 offen offset:2048 nt lds
    buffer_load_dwordx4 v2, s[88:91], s4 offen offset:3072 nt lds
    s_add_u32 s4, s26, 4096
    s_add_u32 m0, s23, 4096
    s_nop 0
    buffer_load_dwordx4 v2, s[88:91], s4 offen offset:0 nt lds
    v_lshrrev_b32 v4, 3, v1
    v_and_b32 v5, 1, v4
    v_mul_u32_u24 v14, 7680, v4
    v_bfe_u32 v4, v1, 1, 2
    v_xor_b32 v4, v4, v5
    v_lshlrev_b32 v4, 5, v4
    v_and_b32 v5, 1, v1
    v_lshlrev_b32 v5, 4, v5
    v_add3_u32 v14, v14, v4, v5
    v_xor_b32 v15, 64, v14
    s_mul_i32 s22, s3, 20480
    v_lshrrev_b32 v4, 4, v1
    v_lshlrev_b32 v4, 2, v4
    v_bfe_u32 v5, v1, 2, 1
    v_add_u32 v4, v4, v5
    v_bfe_u32 v5, v1, 3, 1
    v_lshl_add_u32 v4, v5, 4, v4
    v_lshlrev_b32 v32, 7, v4
    v_bfe_u32 v4, v1, 2, 2
    v_lshlrev_b32 v4, 5, v4
    v_and_b32 v5, 3, v1
    v_lshlrev_b32 v5, 3, v5
    v_add3_u32 v32, v32, v4, v5
    v_add_u32 v32, s22, v32
    v_xor_b32 v33, 32, v32
    v_xor_b32 v34, 64, v32
    v_xor_b32 v35, 96, v32
    v_lshrrev_b32 v4, 5, v1
    v_lshlrev_b32 v36, 6, v4
    v_bfe_u32 v4, v1, 2, 2
    v_lshl_add_u32 v36, v4, 4, v36
    v_bfe_u32 v4, v1, 1, 1
    v_lshl_add_u32 v36, v4, 3, v36
    v_bfe_u32 v4, v1, 4, 1
    v_lshl_add_u32 v36, v4, 2, v36
    v_and_b32 v37, 0x30, v1
    v_add_u32 v37, s22, v37
    v_lshlrev_b32 v38, 2, v1
    v_and_b32 v4, 3, v1
    v_mul_u32_u24 v39, 1280, v4
    v_lshrrev_b32 v5, 4, v1
    v_lshl_add_u32 v39, v5, 6, v39
    v_bfe_u32 v5, v1, 2, 2
    v_lshl_add_u32 v39, v5, 3, v39
    v_add_u32 v39, s23, v39
    v_lshrrev_b32 v5, 2, v1
    v_lshlrev_b32 v3, 8, v5
    v_lshl_add_u32 v3, v4, 4, v3
    s_lshl_b32 s4, s3, 6
    s_add_u32 s4, s4, 81920
    v_add_u32 v3, s4, v3
    s_mul_i32 s27, s21, 20480
    s_mul_i32 s4, s3, 5120
    s_add_u32 s27, s27, s4
    s_add_u32 s27, s27, 16777216
    v_mov_b32 v134, 163776
    s_cmp_lg_u32 s3, 0
    s_cbranch_scc1 XC_c
    s_waitcnt vmcnt(7)
    v_readfirstlane_b32 s4, v135
    s_and_b32 s4, s4, s33
    s_nop 0
    v_mov_b32 v135, s4
    ds_write_b32 v134, v135
    s_waitcnt lgkmcnt(0)
XC_c:
    s_barrier
    ds_read_b32 v135, v134
    s_waitcnt lgkmcnt(0)
    v_readfirstlane_b32 s4, v135
    s_cmp_lg_u32 s4, 0
    s_cbranch_scc1 R_ovf
    s_mul_i32 s4, s99, 1048576
    s_lshl_b32 s33, s20, 4
    s_add_u32 s33, s33, s4
    s_lshl_b32 s4, s3, 2
    s_add_u32 s33, s33, s4
    s_add_u32 s33, s33, 8544256
    v_mov_b32 v4, 0
    s_mov_b64 exec, 1
    buffer_store_dword v4, v4, s[8:11], s33 offen sc1
    s_mov_b64 exec, -1
    s_lshl_b32 s4, s21, 7
    s_add_u32 s4, s4, 65536
    v_mov_b32 v16, 0
    v_lshlrev_b32 v17, 2, v1
    s_cmp_eq_u32 s3, 0
    s_cselect_b64 exec, 3, 0
    buffer_store_dword v16, v17, s[8:11], s4 offen sc1
    s_mov_b64 exec, -1
    s_mul_i32 s4, s99, 1048576
    s_add_u32 s4, s4, 8544768
    s_cmp_eq_u32 s20, 30
    s_cselect_b64 exec, 0xff, 0
    buffer_store_dword v16, v17, s[8:11], s4 offen sc1
    s_mov_b64 exec, -1
    v_mov_b32 v16, -1
    v_mov_b32 v17, -1
    v_mov_b32 v18, -1
    v_mov_b32 v19, -1
    s_lshl_b32 s4, s3, 10
    s_add_u32 s4, s4, 32768
    s_cmp_eq_u32 s21, 0
    s_cselect_b64 exec, -1, 0
    buffer_store_dwordx4 v[16:19], v2, s[8:11], s4 offen sc1
    s_mov_b64 exec, -1
    s_waitcnt vmcnt(0)
    s_barrier
    s_cmp_lg_u32 s3, 0
    s_cbranch_scc1 XA_n
    s_lshl_b32 s4, s99, 5
    s_add_u32 s4, s4, 4
    v_mov_b32 v16, 0
    v_mov_b32 v17, 1
    s_mov_b64 exec, 1
    buffer_atomic_add v17, v16, s[84:87], s4 offen sc1
    s_mov_b64 exec, -1
XA_n:
    s_cmp_lt_u32 s21, 20
    s_cbranch_scc1 XD_nv
    s_lshr_b32 s6, s21, 2
    s_lshl_b32 s6, s6, 14
    s_and_b32 s5, s21, 3
    s_lshl_b32 s5, s5, 11
    s_add_u32 s6, s6, s5
    s_lshl_b32 s5, s3, 9
    s_add_u32 s40, s5, s6
    s_add_u32 s40, s40, 2670592
    s_add_u32 s41, s40, 384
    s_load_dword s36, s[8:9], s41
    s_mov_b32 s38, -1
    s_mov_b32 s39, -1
    s_waitcnt lgkmcnt(0)
    s_add_u32 s41, s40, 0
    s_memtime s[4:5]
    s_waitcnt lgkmcnt(0)
    s_load_dword s36, s[8:9], s41
    s_waitcnt lgkmcnt(0)
    s_memtime s[6:7]
    s_waitcnt lgkmcnt(0)
    s_sub_u32 s4, s6, s4
    s_min_u32 s38, s38, s4
    s_add_u32 s41, s40, 8192
    s_memtime s[4:5]
    s_waitcnt lgkmcnt(0)
    s_load_dword s36, s[8:9], s41
    s_waitcnt lgkmcnt(0)
    s_memtime s[6:7]
    s_waitcnt lgkmcnt(0)
    s_sub_u32 s4, s6, s4
    s_min_u32 s39, s39, s4
    s_add_u32 s41, s40, 128
    s_memtime s[4:5]
    s_waitcnt lgkmcnt(0)
    s_load_dword s36, s[8:9], s41
    s_waitcnt lgkmcnt(0)
    s_memtime s[6:7]
    s_waitcnt lgkmcnt(0)
    s_sub_u32 s4, s6, s4
    s_min_u32 s38, s38, s4
    s_add_u32 s41, s40, 8320
    s_memtime s[4:5]
    s_waitcnt lgkmcnt(0)
    s_load_dword s36, s[8:9], s41
    s_waitcnt lgkmcnt(0)
    s_memtime s[6:7]
    s_waitcnt lgkmcnt(0)
    s_sub_u32 s4, s6, s4
    s_min_u32 s39, s39, s4
    s_cmp_lt_u32 s39, s38
    s_cselect_b32 s4, 0, 0x10000
    s_lshl_b32 s5, s3, 2
    s_add_u32 s5, s5, 163792
    v_mov_b32 v4, s5
    v_mov_b32 v5, s4
    ds_write_b32 v4, v5
XD_nv:
    v_lshrrev_b32 v10, 4, v1
    v_lshlrev_b32 v10, 6, v10
    v_bfe_u32 v11, v1, 1, 2
    v_lshl_add_u32 v10, v11, 4, v10
    v_and_b32 v11, 1, v1
    v_lshl_add_u32 v10, v11, 3, v10
    v_bfe_u32 v11, v1, 3, 1
    v_lshl_add_u32 v10, v11, 2, v10
    v_add_u32 v10, s23, v10
    v_lshlrev_b32 v6, 16, v244
    v_and_b32 v7, 0xffff0000, v244
    v_lshlrev_b32 v8, 16, v245
    v_and_b32 v9, 0xffff0000, v245
    v_mul_f32 v16, 0xbfb8aa3b, v6
    v_mul_f32 v17, 0xbfb8aa3b, v7
    v_mul_f32 v18, 0xbfb8aa3b, v8
    v_mul_f32 v19, 0xbfb8aa3b, v9
    v_exp_f32 v16, v16
    v_exp_f32 v17, v17
    v_exp_f32 v18, v18
    v_exp_f32 v19, v19
    v_add_f32 v16, 1.0, v16
    v_add_f32 v17, 1.0, v17
    v_add_f32 v18, 1.0, v18
    v_add_f32 v19, 1.0, v19
    v_rcp_f32 v16, v16
    v_rcp_f32 v17, v17
    v_rcp_f32 v18, v18
    v_rcp_f32 v19, v19
    v_mul_f32 v6, v6, v16
    v_mul_f32 v7, v7, v17
    v_mul_f32 v8, v8, v18
    v_mul_f32 v9, v9, v19
    v_cvt_pk_bf16_f32 v4, v6, v7
    v_cvt_pk_bf16_f32 v5, v8, v9
    v_and_b32 v11, 0x30, v1
    v_add_u32 v11, s23, v11
    v_add_u32 v12, 0, v39
    s_call_b64 s[100:101], XN_sub
    v_cvt_pk_bf16_f32 v180, v60, v61
    v_cvt_pk_bf16_f32 v181, v62, v63
    v_cvt_pk_bf16_f32 v182, v64, v65
    v_cvt_pk_bf16_f32 v183, v66, v67
    v_cvt_pk_bf16_f32 v184, v68, v69
    v_cvt_pk_bf16_f32 v185, v70, v71
    v_cvt_pk_bf16_f32 v186, v72, v73
    v_cvt_pk_bf16_f32 v187, v74, v75
    v_cvt_pk_bf16_f32 v188, v76, v77
    v_cvt_pk_bf16_f32 v189, v78, v79
    v_cvt_pk_bf16_f32 v190, v80, v81
    v_cvt_pk_bf16_f32 v191, v82, v83
    v_cvt_pk_bf16_f32 v192, v84, v85
    v_cvt_pk_bf16_f32 v193, v86, v87
    v_cvt_pk_bf16_f32 v194, v88, v89
    v_cvt_pk_bf16_f32 v195, v90, v91
    v_cvt_pk_bf16_f32 v196, v92, v93
    v_cvt_pk_bf16_f32 v197, v94, v95
    v_cvt_pk_bf16_f32 v198, v96, v97
    v_cvt_pk_bf16_f32 v199, v98, v99
    ds_write_b32 v10, v4
    ds_write_b32 v10, v5 offset:256
    s_waitcnt lgkmcnt(0)
    ds_read_b128 v[220:223], v11 offset:0
    ds_read_b128 v[224:227], v11 offset:64
    ds_read_b128 v[228:231], v11 offset:128
    ds_read_b128 v[232:235], v11 offset:192
    ds_read_b128 v[236:239], v11 offset:256
    v_and_b32 v16, 7, v1
    v_lshlrev_b32 v16, 5, v16
    buffer_load_dwordx4 v[20:23], v16, s[84:87], 0 offen sc1
    s_mov_b32 s31, 0
    s_waitcnt vmcnt(0)
    s_branch XI_c
XI_l:
    buffer_load_dwordx4 v[20:23], v16, s[84:87], 0 offen sc1
    s_waitcnt vmcnt(0)
XI_c:
    v_bcnt_u32_b32 v17, v20, v23
    v_cmp_lt_u32 s[4:5], 32, v17
    s_and_b32 s6, s4, 0xff
    v_cmp_ne_u32 s[4:5], 32, v17
    s_cmp_eq_u32 s6, 0
    s_cselect_b32 s5, 0xff, 0
    s_and_b32 s4, s4, s5
    v_cmp_gt_u32 vcc, 22, v21
    s_and_b32 vcc_lo, vcc_lo, 0xff
    s_or_b32 vcc_lo, vcc_lo, s4
    s_mov_b32 vcc_hi, 0
    s_cbranch_vccz XI_o
    s_sleep 16
    s_add_u32 s31, s31, 1
    s_cmp_lt_u32 s31, s30
    s_cbranch_scc1 XI_l
    s_mov_b32 s30, 1
XI_o:
    s_mov_b32 s97, s6
    s_waitcnt lgkmcnt(0)
    s_cmp_lg_u32 s3, 0
    s_cbranch_scc1 XW_o
    s_mov_b32 s5, 32768
    s_mov_b32 s31, 0
XW_l:
    buffer_load_dwordx4 v[40:43], v2, s[8:11], s5 offen offset:0 sc1
    buffer_load_dwordx4 v[44:47], v2, s[8:11], s5 offen offset:1024 sc1
    buffer_load_dwordx4 v[48:51], v2, s[8:11], s5 offen offset:1536 sc1
    s_waitcnt vmcnt(0)
    v_max3_u32 v4, v40, v41, v42
    v_max3_u32 v4, v4, v43, v44
    v_max3_u32 v4, v4, v45, v46
    v_max3_u32 v4, v4, v47, v48
    v_max3_u32 v4, v4, v49, v50
    v_max_u32 v4, v4, v51
    v_cmp_eq_u32 vcc, -1, v4
    s_cbranch_vccz XW_o
    s_sleep 4
    s_add_u32 s31, s31, 1
    s_cmp_lt_u32 s31, s30
    s_cbranch_scc1 XW_l
    s_mov_b32 s30, 1
XW_o:
    s_barrier
    v_lshrrev_b32 v10, 2, v1
    v_lshlrev_b32 v10, 4, v10
    s_mov_b64 s[24:25], -1
    s_mov_b32 s5, 32768
    buffer_load_dwordx4 v[160:163], v10, s[8:11], s5 offen offset:0 sc1
    buffer_load_dwordx4 v[164:167], v10, s[8:11], s5 offen offset:256 sc1
    buffer_load_dwordx4 v[168:171], v10, s[8:11], s5 offen offset:512 sc1
    buffer_load_dwordx4 v[172:175], v10, s[8:11], s5 offen offset:768 sc1
    buffer_load_dwordx4 v[176:179], v10, s[8:11], s5 offen offset:1024 sc1
    buffer_load_dwordx4 v[120:123], v10, s[8:11], s5 offen offset:1280 sc1
    buffer_load_dwordx4 v[124:127], v10, s[8:11], s5 offen offset:1536 sc1
    buffer_load_dwordx4 v[128:131], v10, s[8:11], s5 offen offset:1792 sc1
    buffer_load_dwordx4 v[132:135], v10, s[8:11], s5 offen offset:2048 sc1
    buffer_load_dwordx4 v[136:139], v10, s[8:11], s5 offen offset:2304 sc1
    s_mov_b32 s36, 1
    s_cmp_lt_u32 s21, 20
    s_cbranch_scc1 XD_nw
    v_mov_b32 v4, 163792
    ds_read_b128 v[16:19], v4
    s_waitcnt lgkmcnt(0)
    v_add3_u32 v16, v16, v17, v18
    v_add_u32 v16, v16, v19
    s_nop 0
    v_readfirstlane_b32 s36, v16
    s_and_b32 s36, s36, 0x70000
    s_add_u32 s36, s36, 1
XD_nw:
    s_waitcnt vmcnt(0)
    v_lshlrev_b32 v100, 16, v120
    v_and_b32 v101, 0xffff0000, v120
    v_lshlrev_b32 v102, 16, v121
    v_and_b32 v103, 0xffff0000, v121
    v_lshlrev_b32 v104, 16, v122
    v_and_b32 v105, 0xffff0000, v122
    v_lshlrev_b32 v106, 16, v123
    v_and_b32 v107, 0xffff0000, v123
    v_lshlrev_b32 v108, 16, v124
    v_and_b32 v109, 0xffff0000, v124
    v_lshlrev_b32 v110, 16, v125
    v_and_b32 v111, 0xffff0000, v125
    v_lshlrev_b32 v112, 16, v126
    v_and_b32 v113, 0xffff0000, v126
    v_lshlrev_b32 v114, 16, v127
    v_and_b32 v115, 0xffff0000, v127
    v_lshlrev_b32 v116, 16, v128
    v_and_b32 v117, 0xffff0000, v128
    v_lshlrev_b32 v118, 16, v129
    v_and_b32 v119, 0xffff0000, v129
    v_lshlrev_b32 v120, 16, v130
    v_and_b32 v121, 0xffff0000, v130
    v_lshlrev_b32 v122, 16, v131
    v_and_b32 v123, 0xffff0000, v131
    v_lshlrev_b32 v124, 16, v132
    v_and_b32 v125, 0xffff0000, v132
    v_lshlrev_b32 v126, 16, v133
    v_and_b32 v127, 0xffff0000, v133
    v_lshlrev_b32 v128, 16, v134
    v_and_b32 v129, 0xffff0000, v134
    v_lshlrev_b32 v130, 16, v135
    v_and_b32 v131, 0xffff0000, v135
    v_lshlrev_b32 v132, 16, v136
    v_and_b32 v133, 0xffff0000, v136
    v_lshlrev_b32 v134, 16, v137
    v_and_b32 v135, 0xffff0000, v137
    v_lshlrev_b32 v136, 16, v138
    v_and_b32 v137, 0xffff0000, v138
    v_lshlrev_b32 v138, 16, v139
    v_and_b32 v139, 0xffff0000, v139
    v_lshlrev_b32 v140, 16, v160
    v_and_b32 v141, 0xffff0000, v160
    v_lshlrev_b32 v142, 16, v161
    v_and_b32 v143, 0xffff0000, v161
    v_lshlrev_b32 v144, 16, v162
    v_and_b32 v145, 0xffff0000, v162
    v_lshlrev_b32 v146, 16, v163
    v_and_b32 v147, 0xffff0000, v163
    v_lshlrev_b32 v148, 16, v164
    v_and_b32 v149, 0xffff0000, v164
    v_lshlrev_b32 v150, 16, v165
    v_and_b32 v151, 0xffff0000, v165
    v_lshlrev_b32 v152, 16, v166
    v_and_b32 v153, 0xffff0000, v166
    v_lshlrev_b32 v154, 16, v167
    v_and_b32 v155, 0xffff0000, v167
    v_lshlrev_b32 v156, 16, v168
    v_and_b32 v157, 0xffff0000, v168
    v_lshlrev_b32 v158, 16, v169
    v_and_b32 v159, 0xffff0000, v169
    v_lshlrev_b32 v160, 16, v170
    v_and_b32 v161, 0xffff0000, v170
    v_lshlrev_b32 v162, 16, v171
    v_and_b32 v163, 0xffff0000, v171
    v_lshlrev_b32 v164, 16, v172
    v_and_b32 v165, 0xffff0000, v172
    v_lshlrev_b32 v166, 16, v173
    v_and_b32 v167, 0xffff0000, v173
    v_lshlrev_b32 v168, 16, v174
    v_and_b32 v169, 0xffff0000, v174
    v_lshlrev_b32 v170, 16, v175
    v_and_b32 v171, 0xffff0000, v175
    v_lshlrev_b32 v172, 16, v176
    v_and_b32 v173, 0xffff0000, v176
    v_lshlrev_b32 v174, 16, v177
    v_and_b32 v175, 0xffff0000, v177
    v_lshlrev_b32 v176, 16, v178
    v_and_b32 v177, 0xffff0000, v178
    v_lshlrev_b32 v178, 16, v179
    v_and_b32 v179, 0xffff0000, v179
    v_lshlrev_b32 v60, 16, v180
    v_and_b32 v61, 0xffff0000, v180
    v_lshlrev_b32 v62, 16, v181
    v_and_b32 v63, 0xffff0000, v181
    v_lshlrev_b32 v64, 16, v182
    v_and_b32 v65, 0xffff0000, v182
    v_lshlrev_b32 v66, 16, v183
    v_and_b32 v67, 0xffff0000, v183
    v_lshlrev_b32 v68, 16, v184
    v_and_b32 v69, 0xffff0000, v184
    v_lshlrev_b32 v70, 16, v185
    v_and_b32 v71, 0xffff0000, v185
    v_lshlrev_b32 v72, 16, v186
    v_and_b32 v73, 0xffff0000, v186
    v_lshlrev_b32 v74, 16, v187
    v_and_b32 v75, 0xffff0000, v187
    v_lshlrev_b32 v76, 16, v188
    v_and_b32 v77, 0xffff0000, v188
    v_lshlrev_b32 v78, 16, v189
    v_and_b32 v79, 0xffff0000, v189
    v_lshlrev_b32 v80, 16, v190
    v_and_b32 v81, 0xffff0000, v190
    v_lshlrev_b32 v82, 16, v191
    v_and_b32 v83, 0xffff0000, v191
    v_lshlrev_b32 v84, 16, v192
    v_and_b32 v85, 0xffff0000, v192
    v_lshlrev_b32 v86, 16, v193
    v_and_b32 v87, 0xffff0000, v193
    v_lshlrev_b32 v88, 16, v194
    v_and_b32 v89, 0xffff0000, v194
    v_lshlrev_b32 v90, 16, v195
    v_and_b32 v91, 0xffff0000, v195
    v_lshlrev_b32 v92, 16, v196
    v_and_b32 v93, 0xffff0000, v196
    v_lshlrev_b32 v94, 16, v197
    v_and_b32 v95, 0xffff0000, v197
    v_lshlrev_b32 v96, 16, v198
    v_and_b32 v97, 0xffff0000, v198
    v_lshlrev_b32 v98, 16, v199
    v_and_b32 v99, 0xffff0000, v199
    v_add_u32 v12, 0, v3
    s_add_u32 s4, s23, 0
    v_add_u32 v11, s4, v2
    s_call_b64 s[100:101], XS_sub
    s_add_u32 s27, s27, 655360
    s_waitcnt vmcnt(0)
    s_barrier
    s_lshl_b32 s4, s21, 7
    s_add_u32 s4, s4, 65536
    v_mov_b32 v16, s36
    v_lshlrev_b32 v17, 2, v1
    s_cmp_eq_u32 s3, 0
    s_cselect_b64 exec, 1, 0
    buffer_store_dword v16, v17, s[8:11], s4 offen sc1
    s_mov_b64 exec, -1
    s_mov_b32 s28, s21
    s_add_u32 s21, s21, 20
XD_ml:
    s_mul_i32 s4, s3, 1228800
    s_lshl_b32 s5, s21, 7
    s_add_u32 s4, s4, s5
    s_add_u32 m0, s22, 0
    s_nop 0
    buffer_load_dwordx4 v14, s[16:19], s4 offen nt lds
    s_add_u32 s4, s4, 61440
    s_add_u32 m0, s22, 1024
    s_nop 0
    buffer_load_dwordx4 v14, s[16:19], s4 offen nt lds
    s_add_u32 s4, s4, 61440
    s_add_u32 m0, s22, 2048
    s_nop 0
    buffer_load_dwordx4 v15, s[16:19], s4 offen nt lds
    s_add_u32 s4, s4, 61440
    s_add_u32 m0, s22, 3072
    s_nop 0
    buffer_load_dwordx4 v15, s[16:19], s4 offen nt lds
    s_add_u32 s4, s4, 61440
    s_add_u32 m0, s22, 4096
    s_nop 0
    buffer_load_dwordx4 v14, s[16:19], s4 offen nt lds
    s_add_u32 s4, s4, 61440
    s_add_u32 m0, s22, 5120
    s_nop 0
    buffer_load_dwordx4 v14, s[16:19], s4 offen nt lds
    s_add_u32 s4, s4, 61440
    s_add_u32 m0, s22, 6144
    s_nop 0
    buffer_load_dwordx4 v15, s[16:19], s4 offen nt lds
    s_add_u32 s4, s4, 61440
    s_add_u32 m0, s22, 7168
    s_nop 0
    buffer_load_dwordx4 v15, s[16:19], s4 offen nt lds
    s_add_u32 s4, s4, 61440
    s_add_u32 m0, s22, 8192
    s_nop 0
    buffer_load_dwordx4 v14, s[16:19], s4 offen nt lds
    s_add_u32 s4, s4, 61440
    s_add_u32 m0, s22, 9216
    s_nop 0
    buffer_load_dwordx4 v14, s[16:19], s4 offen nt lds
    s_add_u32 s4, s4, 61440
    s_add_u32 m0, s22, 10240
    s_nop 0
    buffer_load_dwordx4 v15, s[16:19], s4 offen nt lds
    s_add_u32 s4, s4, 61440
    s_add_u32 m0, s22, 11264
    s_nop 0
    buffer_load_dwordx4 v15, s[16:19], s4 offen nt lds
    s_add_u32 s4, s4, 61440
    s_add_u32 m0, s22, 12288
    s_nop 0
    buffer_load_dwordx4 v14, s[16:19], s4 offen nt lds
    s_add_u32 s4, s4, 61440
    s_add_u32 m0, s22, 13312
    s_nop 0
    buffer_load_dwordx4 v14, s[16:19], s4 offen nt lds
    s_add_u32 s4, s4, 61440
    s_add_u32 m0, s22, 14336
    s_nop 0
    buffer_load_dwordx4 v15, s[16:19], s4 offen nt lds
    s_add_u32 s4, s4, 61440
    s_add_u32 m0, s22, 15360
    s_nop 0
    buffer_load_dwordx4 v15, s[16:19], s4 offen nt lds
    s_add_u32 s4, s4, 61440
    s_add_u32 m0, s22, 16384
    s_nop 0
    buffer_load_dwordx4 v14, s[16:19], s4 offen nt lds
    s_add_u32 s4, s4, 61440
    s_add_u32 m0, s22, 17408
    s_nop 0
    buffer_load_dwordx4 v14, s[16:19], s4 offen nt lds
    s_add_u32 s4, s4, 61440
    s_add_u32 m0, s22, 18432
    s_nop 0
    buffer_load_dwordx4 v15, s[16:19], s4 offen nt lds
    s_add_u32 s4, s4, 61440
    s_add_u32 m0, s22, 19456
    s_nop 0
    buffer_load_dwordx4 v15, s[16:19], s4 offen nt lds
    s_add_u32 s4, s4, 61440
    s_waitcnt vmcnt(0)
    ds_read_b64_tr_b16 a[0:1], v32 offset:0
    ds_read_b64_tr_b16 a[2:3], v32 offset:256
    ds_read_b64_tr_b16 a[4:5], v33 offset:0
    ds_read_b64_tr_b16 a[6:7], v33 offset:256
    ds_read_b64_tr_b16 a[8:9], v34 offset:0
    ds_read_b64_tr_b16 a[10:11], v34 offset:256
    ds_read_b64_tr_b16 a[12:13], v35 offset:0
    ds_read_b64_tr_b16 a[14:15], v35 offset:256
    ds_read_b64_tr_b16 a[16:17], v32 offset:4096
    ds_read_b64_tr_b16 a[18:19], v32 offset:4352
    ds_read_b64_tr_b16 a[20:21], v33 offset:4096
    ds_read_b64_tr_b16 a[22:23], v33 offset:4352
    ds_read_b64_tr_b16 a[24:25], v34 offset:4096
    ds_read_b64_tr_b16 a[26:27], v34 offset:4352
    s_waitcnt lgkmcnt(12)
    v_mfma_f32_16x16x32_bf16 v[16:19], a[0:3], v[220:223], 0
    ds_read_b64_tr_b16 a[28:29], v35 offset:4096
    ds_read_b64_tr_b16 a[30:31], v35 offset:4352
    s_waitcnt lgkmcnt(12)
    v_mfma_f32_16x16x32_bf16 v[20:23], a[4:7], v[220:223], 0
    ds_read_b64_tr_b16 a[32:33], v32 offset:8192
    ds_read_b64_tr_b16 a[34:35], v32 offset:8448
    s_waitcnt lgkmcnt(12)
    v_mfma_f32_16x16x32_bf16 v[24:27], a[8:11], v[220:223], 0
    ds_read_b64_tr_b16 a[36:37], v33 offset:8192
    ds_read_b64_tr_b16 a[38:39], v33 offset:8448
    s_waitcnt lgkmcnt(12)
    v_mfma_f32_16x16x32_bf16 v[28:31], a[12:15], v[220:223], 0
    ds_read_b64_tr_b16 a[40:41], v34 offset:8192
    ds_read_b64_tr_b16 a[42:43], v34 offset:8448
    s_waitcnt lgkmcnt(12)
    v_mfma_f32_16x16x32_bf16 v[16:19], a[16:19], v[224:227], v[16:19]
    ds_read_b64_tr_b16 a[44:45], v35 offset:8192
    ds_read_b64_tr_b16 a[46:47], v35 offset:8448
    s_waitcnt lgkmcnt(12)
    v_mfma_f32_16x16x32_bf16 v[20:23], a[20:23], v[224:227], v[20:23]
    ds_read_b64_tr_b16 a[48:49], v32 offset:12288
    ds_read_b64_tr_b16 a[50:51], v32 offset:12544
    s_waitcnt lgkmcnt(12)
    v_mfma_f32_16x16x32_bf16 v[24:27], a[24:27], v[224:227], v[24:27]
    ds_read_b64_tr_b16 a[52:53], v33 offset:12288
    ds_read_b64_tr_b16 a[54:55], v33 offset:12544
    s_waitcnt lgkmcnt(12)
    v_mfma_f32_16x16x32_bf16 v[28:31], a[28:31], v[224:227], v[28:31]
    ds_read_b64_tr_b16 a[56:57], v34 offset:12288
    ds_read_b64_tr_b16 a[58:59], v34 offset:12544
    s_waitcnt lgkmcnt(12)
    v_mfma_f32_16x16x32_bf16 v[16:19], a[32:35], v[228:231], v[16:19]
    ds_read_b64_tr_b16 a[60:61], v35 offset:12288
    ds_read_b64_tr_b16 a[62:63], v35 offset:12544
    s_waitcnt lgkmcnt(12)
    v_mfma_f32_16x16x32_bf16 v[20:23], a[36:39], v[228:231], v[20:23]
    ds_read_b64_tr_b16 a[64:65], v32 offset:16384
    ds_read_b64_tr_b16 a[66:67], v32 offset:16640
    s_waitcnt lgkmcnt(12)
    v_mfma_f32_16x16x32_bf16 v[24:27], a[40:43], v[228:231], v[24:27]
    ds_read_b64_tr_b16 a[68:69], v33 offset:16384
    ds_read_b64_tr_b16 a[70:71], v33 offset:16640
    s_waitcnt lgkmcnt(12)
    v_mfma_f32_16x16x32_bf16 v[28:31], a[44:47], v[228:231], v[28:31]
    ds_read_b64_tr_b16 a[72:73], v34 offset:16384
    ds_read_b64_tr_b16 a[74:75], v34 offset:16640
    s_waitcnt lgkmcnt(12)
    v_mfma_f32_16x16x32_bf16 v[16:19], a[48:51], v[232:235], v[16:19]
    ds_read_b64_tr_b16 a[76:77], v35 offset:16384
    ds_read_b64_tr_b16 a[78:79], v35 offset:16640
    s_waitcnt lgkmcnt(12)
    v_mfma_f32_16x16x32_bf16 v[20:23], a[52:55], v[232:235], v[20:23]
    s_waitcnt lgkmcnt(10)
    v_mfma_f32_16x16x32_bf16 v[24:27], a[56:59], v[232:235], v[24:27]
    s_waitcnt lgkmcnt(8)
    v_mfma_f32_16x16x32_bf16 v[28:31], a[60:63], v[232:235], v[28:31]
    s_waitcnt lgkmcnt(6)
    v_mfma_f32_16x16x32_bf16 v[16:19], a[64:67], v[236:239], v[16:19]
    s_waitcnt lgkmcnt(4)
    v_mfma_f32_16x16x32_bf16 v[20:23], a[68:71], v[236:239], v[20:23]
    s_waitcnt lgkmcnt(2)
    v_mfma_f32_16x16x32_bf16 v[24:27], a[72:75], v[236:239], v[24:27]
    s_waitcnt lgkmcnt(0)
    v_mfma_f32_16x16x32_bf16 v[28:31], a[76:79], v[236:239], v[28:31]
    s_mov_b32 exec_lo, 0x00010001
    s_mov_b32 exec_hi, 0x00010001
    ds_write_b128 v37, v[16:19] offset:0
    ds_write_b128 v37, v[20:23] offset:64
    ds_write_b128 v37, v[24:27] offset:128
    s_nop 2
    ds_write_b128 v37, v[28:31] offset:192
    s_mov_b64 exec, -1
    s_waitcnt lgkmcnt(0)
    s_barrier
    s_cmp_lg_u32 s3, 0
    s_cbranch_scc1 XD_r2
    ds_read_b32 v16, v38 offset:0
    ds_read_b32 v17, v38 offset:20480
    ds_read_b32 v18, v38 offset:40960
    ds_read_b32 v19, v38 offset:61440
    s_lshl_b32 s4, s21, 8
    s_add_u32 s4, s4, 0
    s_lshl_b32 s5, s21, 7
    s_add_u32 s5, s5, 32768
    s_mov_b32 s6, 0x55555555
    s_cmp_ge_u32 s21, 10
    s_cselect_b32 s7, 1.0, 0
    s_waitcnt lgkmcnt(0)
    v_add_f32 v16, v16, v17
    v_add_f32 v18, v18, v19
    v_add_f32 v16, v16, v18
    v_cvt_pk_bf16_f32 v16, v16, v16
    v_and_b32 v16, 0xffff0000, v16
    v_add_f32 v18, s7, v16
    s_nop 1
    v_mov_b32 v17, v18 quad_perm:[1,1,3,3] row_mask:0xf bank_mask:0xf
    v_cvt_pk_bf16_f32 v17, v18, v17
    s_mov_b32 exec_lo, s6
    s_mov_b32 exec_hi, s6
    buffer_store_dword v17, v36, s[8:11], s5 offen sc1
    s_mov_b64 exec, -1
    buffer_store_dword v16, v38, s[8:11], s4 offen sc1
XD_r2:
    s_barrier
    s_add_u32 s21, s21, 32
    s_cmp_lt_u32 s21, 60
    s_cbranch_scc1 XD_ml
    s_waitcnt vmcnt(0)
    s_lshl_b32 s4, s28, 7
    s_add_u32 s4, s4, 65540
    v_mov_b32 v16, 1
    v_lshlrev_b32 v17, 2, v1
    s_cmp_eq_u32 s3, 0
    s_cselect_b64 exec, 1, 0
    buffer_store_dword v16, v17, s[8:11], s4 offen sc1
    s_mov_b64 exec, -1
    v_and_b32 v16, 7, v1
    v_lshlrev_b32 v16, 5, v16
    buffer_load_dwordx4 v[20:23], v16, s[84:87], 0 offen sc1
    s_mov_b32 s31, 0
    s_waitcnt vmcnt(0)
    s_branch XJ_c
XJ_l:
    buffer_load_dwordx4 v[20:23], v16, s[84:87], 0 offen sc1
    s_waitcnt vmcnt(0)
XJ_c:
    v_bcnt_u32_b32 v17, v20, v23
    v_cmp_lt_u32 s[4:5], 32, v17
    s_and_b32 s6, s4, 0xff
    v_cmp_ne_u32 s[4:5], 32, v17
    s_cmp_eq_u32 s6, 0
    s_cselect_b32 s5, 0xff, 0
    s_and_b32 s4, s4, s5
    v_add_u32 v21, v21, v22
    v_cmp_gt_u32 vcc, 32, v21
    s_and_b32 vcc_lo, vcc_lo, 0xff
    s_or_b32 vcc_lo, vcc_lo, s4
    s_mov_b32 vcc_hi, 0
    s_cbranch_vccz XJ_o
    s_sleep 16
    s_add_u32 s31, s31, 1
    s_cmp_lt_u32 s31, s30
    s_cbranch_scc1 XJ_l
    s_mov_b32 s30, 1
XJ_o:
    s_mov_b32 s97, s6
    s_mul_i32 s22, s99, 1048576
    s_add_u32 s22, s22, 8388608
    s_sub_u32 s34, s20, 28
    s_lshl_b32 s20, s99, 2
    s_add_u32 s20, s20, s34
    s_mov_b32 s28, s34
    s_lshl_b32 s96, s99, 2
    s_add_u32 s96, s96, s3
    s_and_b32 s34, s34, 1
    s_lshl_b32 s34, s34, 1
    s_lshr_b32 s4, s3, 1
    s_add_u32 s34, s34, s4
    s_and_b32 s32, s3, 1
    s_mul_i32 s4, s34, 48
    s_add_u32 s4, s4, 155648
    v_min_u32 v15, 11, v1
    v_lshl_add_u32 v15, v15, 2, s4
    s_mov_b32 s43, 0
    s_barrier
    v_mov_b32 v9, 0
    s_cmp_lt_u32 s28, 2
    s_cbranch_scc1 XM2_o
    v_and_b32 v16, 31, v1
    v_lshlrev_b32 v16, 7, v16
    s_mov_b32 s23, 65540
    s_mov_b32 s31, 0
XM2_l:
    buffer_load_dword v17, v16, s[8:11], s23 offen sc1
    s_waitcnt vmcnt(0)
XM2_c:
    v_cmp_gt_u32 vcc, 1, v17
    s_cbranch_vccz XM2_o
    s_sleep 8
    s_add_u32 s31, s31, 1
    s_cmp_lt_u32 s31, s30
    s_cbranch_scc1 XM2_l
    s_mov_b32 s30, 1
XM2_o:
    s_load_dwordx2 s[12:13], s[0:1], 0
    s_load_dwordx2 s[16:17], s[0:1], 112
    s_mov_b32 s14, 2621440
    s_mov_b32 s15, 0x20000
    s_mov_b32 s18, 2621440
    s_mov_b32 s19, 0x20000
    s_waitcnt lgkmcnt(0)
    s_load_dwordx2 s[84:85], s[0:1], 72
    s_load_dwordx2 s[88:89], s[0:1], 80
    s_load_dwordx2 s[92:93], s[0:1], 88
    s_mov_b32 s86, 1966080
    s_mov_b32 s87, 0x20000
    s_mov_b32 s90, 1966080
    s_mov_b32 s91, 0x20000
    s_mov_b32 s94, 1966080
    s_mov_b32 s95, 0x20000
    s_waitcnt lgkmcnt(0)
    v_mul_u32_u24 v4, 43, v1
    v_lshrrev_b32 v4, 8, v4
    v_mul_u32_u24 v5, 6, v4
    v_sub_u32 v5, v1, v5
    v_mul_u32_u24 v0, 3072, v4
    v_lshl_add_u32 v0, v5, 4, v0
    s_mul_i32 s98, s3, 491520
    s_mul_i32 s5, s20, 96
    s_add_u32 s98, s98, s5
    s_mul_i32 s99, s3, 30720
    s_add_u32 s99, s99, 40960
    s_lshl_b32 s23, s20, 2
    s_add_u32 s23, s23, s3
    s_mul_i32 s23, s23, 15360
    s_mov_b32 s44, 0
    s_mov_b32 s45, 0
    s_mov_b32 s46, 0
    s_mov_b32 s47, 0
    s_mov_b32 s38, 0
    s_mov_b32 s39, 0
    s_mov_b32 s48, 0
    s_mov_b32 s49, 0
    s_cmp_ge_u32 s28, 2
    s_cbranch_scc1 X3_go
    s_cmp_lg_u32 s97, 0
    s_cbranch_scc1 Xs_go
Xf_go:
    s_mul_i32 s26, s34, 12288
    s_add_u32 s26, s26, 356352
    s_lshl_b32 s4, s32, 9
    s_add_u32 s4, s4, 3072
    v_and_b32 v16, 0x1f0, v2
    v_add_u32 v16, s4, v16
    s_lshl_b32 s4, s32, 10
    v_add_u32 v17, s4, v2
    v_lshrrev_b32 v56, 4, v1
    v_lshlrev_b32 v57, 2, v56
    v_and_b32 v58, 15, v1
    v_sub_u32 v57, v57, v58
    s_lshl_b32 s4, s32, 4
    v_subrev_u32 v57, s4, v57
    v_and_b32 v56, 0x1f0, v2
    v_mov_b32 v58, 0xff800000
    s_lshl_b32 s37, s34, 1
    s_add_u32 s37, s37, s32
    s_lshl_b32 s37, s37, 10
    s_and_b32 s40, s34, 2
    s_add_u32 s40, s40, s32
    s_lshl_b32 s40, s40, 9
    s_and_b32 s4, s34, 1
    s_lshl_b32 s4, s4, 3
    s_add_u32 s40, s40, s4
    s_add_u32 s40, s40, 413696
    s_add_u32 s37, s37, 405504
    s_mov_b32 s41, 0x3dd53b95
    s_mov_b32 s21, 0
Xf_loop:
    s_and_b32 s36, s21, 3
    s_lshl_b32 s36, s36, 16
    s_add_u32 s36, s36, s22
    s_add_u32 s35, s36, s26
    s_add_u32 s21, s21, 1
    s_mov_b32 s31, 0
Xfw_l:
    buffer_load_dword v18, v15, s[8:11], s22 offen sc1
    s_waitcnt vmcnt(0)
Xfw_c:
    v_cmp_gt_u32 vcc, s21, v18
    s_cbranch_vccz Xfw_o
    s_sleep 1
    s_add_u32 s31, s31, 1
    s_cmp_lt_u32 s31, s30
    s_cbranch_scc1 Xfw_l
    s_mov_b32 s30, 1
Xfw_o:
    s_add_u32 s4, s35, 0
    buffer_load_dwordx4 v[60:63], v16, s[8:11], s4 offen offset:0 sc1
    buffer_load_dwordx4 v[64:67], v17, s[8:11], s4 offen offset:0 sc1
    buffer_load_dwordx4 v[68:71], v17, s[8:11], s4 offen offset:1024 sc1
    s_add_u32 s4, s35, 4096
    buffer_load_dwordx4 v[72:75], v16, s[8:11], s4 offen offset:0 sc1
    buffer_load_dwordx4 v[76:79], v17, s[8:11], s4 offen offset:0 sc1
    buffer_load_dwordx4 v[80:83], v17, s[8:11], s4 offen offset:1024 sc1
    s_add_u32 s4, s35, 8192
    buffer_load_dwordx4 v[84:87], v16, s[8:11], s4 offen offset:0 sc1
    buffer_load_dwordx4 v[88:91], v17, s[8:11], s4 offen offset:0 sc1
    buffer_load_dwordx4 v[92:95], v17, s[8:11], s4 offen offset:1024 sc1
    s_add_u32 s5, s36, s37
    s_add_u32 s6, s36, s40
    s_waitcnt vmcnt(3)
    v_pk_add_f32 v[60:61], v[60:61], v[72:73]
    v_pk_add_f32 v[62:63], v[62:63], v[74:75]
    v_pk_add_f32 v[64:65], v[64:65], v[76:77]
    v_pk_add_f32 v[66:67], v[66:67], v[78:79]
    v_pk_add_f32 v[68:69], v[68:69], v[80:81]
    v_pk_add_f32 v[70:71], v[70:71], v[82:83]
    s_waitcnt vmcnt(0)
    v_pk_add_f32 v[60:61], v[60:61], v[84:85]
    v_pk_add_f32 v[62:63], v[62:63], v[86:87]
    v_pk_add_f32 v[64:65], v[64:65], v[88:89]
    v_pk_add_f32 v[66:67], v[66:67], v[90:91]
    v_pk_add_f32 v[68:69], v[68:69], v[92:93]
    v_pk_add_f32 v[70:71], v[70:71], v[94:95]
    v_cmp_lt_u32 vcc, 31, v1
    s_nop 1
    v_cndmask_b32 v60, v58, v60, vcc
    v_cndmask_b32 v61, v58, v61, vcc
    v_cndmask_b32 v62, v58, v62, vcc
    v_cndmask_b32 v63, v58, v63, vcc
    v_cmp_ge_i32 vcc, 0, v57
    s_nop 1
    v_cndmask_b32 v64, v58, v64, vcc
    v_cmp_ge_i32 vcc, -1, v57
    s_nop 1
    v_cndmask_b32 v65, v58, v65, vcc
    v_cmp_ge_i32 vcc, -2, v57
    s_nop 1
    v_cndmask_b32 v66, v58, v66, vcc
    v_cmp_ge_i32 vcc, -3, v57
    s_nop 1
    v_cndmask_b32 v67, v58, v67, vcc
    v_cmp_ge_i32 vcc, -16, v57
    s_nop 1
    v_cndmask_b32 v68, v58, v68, vcc
    v_cmp_ge_i32 vcc, -17, v57
    s_nop 1
    v_cndmask_b32 v69, v58, v69, vcc
    v_cmp_ge_i32 vcc, -18, v57
    s_nop 1
    v_cndmask_b32 v70, v58, v70, vcc
    v_cmp_ge_i32 vcc, -19, v57
    s_nop 1
    v_cndmask_b32 v71, v58, v71, vcc
    v_max_f32 v44, v60, v61
    v_max3_f32 v44, v44, v62, v63
    v_max3_f32 v44, v44, v64, v65
    v_max3_f32 v44, v44, v66, v67
    v_max3_f32 v44, v44, v68, v69
    v_max3_f32 v44, v44, v70, v71
    v_mov_b32 v45, v44
    s_nop 1
    v_permlane16_swap_b32 v44, v45
    v_max_f32 v44, v44, v45
    v_mov_b32 v45, v44
    s_nop 1
    v_permlane32_swap_b32 v44, v45
    v_max_f32 v44, v44, v45
    v_mul_f32 v44, s41, v44
    v_fma_f32 v60, v60, s41, -v44
    v_fma_f32 v61, v61, s41, -v44
    v_fma_f32 v62, v62, s41, -v44
    v_fma_f32 v63, v63, s41, -v44
    v_fma_f32 v64, v64, s41, -v44
    v_fma_f32 v65, v65, s41, -v44
    v_fma_f32 v66, v66, s41, -v44
    v_fma_f32 v67, v67, s41, -v44
    v_fma_f32 v68, v68, s41, -v44
    v_fma_f32 v69, v69, s41, -v44
    v_fma_f32 v70, v70, s41, -v44
    v_fma_f32 v71, v71, s41, -v44
    v_exp_f32 v60, v60
    v_exp_f32 v61, v61
    v_exp_f32 v62, v62
    v_exp_f32 v63, v63
    v_exp_f32 v64, v64
    v_exp_f32 v65, v65
    v_exp_f32 v66, v66
    v_exp_f32 v67, v67
    v_exp_f32 v68, v68
    v_exp_f32 v69, v69
    v_exp_f32 v70, v70
    v_exp_f32 v71, v71
    v_add_f32 v44, v60, v61
    v_add_f32 v44, v44, v62
    v_add_f32 v44, v44, v63
    v_add_f32 v44, v44, v64
    v_add_f32 v44, v44, v65
    v_add_f32 v44, v44, v66
    v_add_f32 v44, v44, v67
    v_add_f32 v44, v44, v68
    v_add_f32 v44, v44, v69
    v_add_f32 v44, v44, v70
    v_add_f32 v44, v44, v71
    v_mov_b32 v45, v44
    s_nop 1
    v_permlane16_swap_b32 v44, v45
    v_add_f32 v44, v44, v45
    v_mov_b32 v45, v44
    s_nop 1
    v_permlane32_swap_b32 v44, v45
    v_add_f32 v44, v44, v45
    v_rcp_f32 v44, v44
    s_nop 0
    v_mul_f32 v60, v60, v44
    v_mul_f32 v61, v61, v44
    v_mul_f32 v62, v62, v44
    v_mul_f32 v63, v63, v44
    v_mul_f32 v64, v64, v44
    v_mul_f32 v65, v65, v44
    v_mul_f32 v66, v66, v44
    v_mul_f32 v67, v67, v44
    v_mul_f32 v68, v68, v44
    v_mul_f32 v69, v69, v44
    v_mul_f32 v70, v70, v44
    v_mul_f32 v71, v71, v44
    v_cvt_pk_bf16_f32 v48, v64, v65
    v_cvt_pk_bf16_f32 v49, v68, v69
    v_cvt_pk_bf16_f32 v50, v66, v67
    v_cvt_pk_bf16_f32 v51, v70, v71
    v_cvt_pk_bf16_f32 v52, v60, v61
    v_cvt_pk_bf16_f32 v53, v62, v63
    buffer_store_dwordx4 v[48:51], v2, s[8:11], s5 offen offset:0
    s_mov_b32 exec_lo, 0
    buffer_store_dwordx2 v[52:53], v56, s[8:11], s6 offen offset:0
    s_mov_b64 exec, -1
    s_waitcnt vmcnt(0)
    v_mov_b32 v10, s21
    s_mov_b64 exec, 1
    buffer_store_dword v10, v9, s[8:11], s33 offen
    s_mov_b64 exec, -1
    s_cmp_eq_u32 s21, 64
    s_cbranch_scc1 X_join
    s_bitcmp1_b32 s21, 0
    s_cbranch_scc1 Xf_loop
    s_lshr_b32 s29, s21, 1
    s_sub_u32 s29, s29, 2
    s_cbranch_scc1 Xf_loop
    s_cmp_lt_u32 s29, 2
    s_cbranch_scc1 Xfb_e
    s_cmp_lt_u32 s29, 10
    s_cbranch_scc0 Xfb_a
    s_mov_b32 exec_hi, 0x0fffffff
    s_add_u32 m0, s99, 0
    s_nop 0
    buffer_load_dwordx4 v0, s[84:87], s98 offen lds
    s_add_u32 m0, s99, 15360
    s_nop 0
    buffer_load_dwordx4 v0, s[88:91], s98 offen lds
    s_add_u32 s98, s98, 30720
    s_add_u32 s99, s99, 960
    s_add_u32 m0, s99, 0
    s_nop 0
    buffer_load_dwordx4 v0, s[84:87], s98 offen lds
    s_add_u32 m0, s99, 15360
    s_nop 0
    buffer_load_dwordx4 v0, s[88:91], s98 offen lds
    s_add_u32 s98, s98, 30720
    s_add_u32 s99, s99, 960
    s_mov_b64 exec, -1
    buffer_load_dwordx4 v[96:99], v2, s[92:95], s23 offen offset:0
    buffer_load_dwordx4 v[96:99], v2, s[92:95], s23 offen offset:1024
    s_add_u32 s23, s23, 2048
Xfb_a:
    s_cmp_eq_u32 s29, 11
    s_cbranch_scc0 Xfb_b
    s_waitcnt vmcnt(0)
    v_lshrrev_b32 v12, 4, v1
    v_lshlrev_b32 v12, 3, v12
    v_bfe_u32 v13, v1, 2, 2
    v_add_u32 v12, v12, v13
    v_mul_u32_u24 v12, 96, v12
    v_and_b32 v13, 3, v1
    v_lshlrev_b32 v13, 3, v13
    v_add_u32 v12, v12, v13
    s_mul_i32 s4, s3, 30720
    s_add_u32 s4, s4, 40960
    v_add_u32 v12, s4, v12
    ds_read_b64_tr_b16 a[0:1], v12 offset:0
    ds_read_b64_tr_b16 a[2:3], v12 offset:384
    ds_read_b64_tr_b16 a[4:5], v12 offset:3072
    ds_read_b64_tr_b16 a[6:7], v12 offset:3456
    ds_read_b64_tr_b16 a[8:9], v12 offset:6144
    ds_read_b64_tr_b16 a[10:11], v12 offset:6528
    ds_read_b64_tr_b16 a[12:13], v12 offset:9216
    ds_read_b64_tr_b16 a[14:15], v12 offset:9600
    ds_read_b64_tr_b16 a[16:17], v12 offset:12288
    ds_read_b64_tr_b16 a[18:19], v12 offset:12672
    ds_read_b64_tr_b16 a[20:21], v12 offset:15360
    ds_read_b64_tr_b16 a[22:23], v12 offset:15744
    ds_read_b64_tr_b16 a[24:25], v12 offset:18432
    ds_read_b64_tr_b16 a[26:27], v12 offset:18816
    ds_read_b64_tr_b16 a[28:29], v12 offset:21504
    ds_read_b64_tr_b16 a[30:31], v12 offset:21888
    ds_read_b64_tr_b16 a[32:33], v12 offset:24576
    ds_read_b64_tr_b16 a[34:35], v12 offset:24960
    ds_read_b64_tr_b16 a[36:37], v12 offset:27648
    ds_read_b64_tr_b16 a[38:39], v12 offset:28032
    ds_read_b64_tr_b16 a[40:41], v12 offset:32
    ds_read_b64_tr_b16 a[42:43], v12 offset:416
    ds_read_b64_tr_b16 a[44:45], v12 offset:3104
    ds_read_b64_tr_b16 a[46:47], v12 offset:3488
    ds_read_b64_tr_b16 a[48:49], v12 offset:6176
    ds_read_b64_tr_b16 a[50:51], v12 offset:6560
    ds_read_b64_tr_b16 a[52:53], v12 offset:9248
    ds_read_b64_tr_b16 a[54:55], v12 offset:9632
    ds_read_b64_tr_b16 a[56:57], v12 offset:12320
    ds_read_b64_tr_b16 a[58:59], v12 offset:12704
    ds_read_b64_tr_b16 a[60:61], v12 offset:15392
    ds_read_b64_tr_b16 a[62:63], v12 offset:15776
    ds_read_b64_tr_b16 a[64:65], v12 offset:18464
    ds_read_b64_tr_b16 a[66:67], v12 offset:18848
    ds_read_b64_tr_b16 a[68:69], v12 offset:21536
    ds_read_b64_tr_b16 a[70:71], v12 offset:21920
    ds_read_b64_tr_b16 a[72:73], v12 offset:24608
    ds_read_b64_tr_b16 a[74:75], v12 offset:24992
    ds_read_b64_tr_b16 a[76:77], v12 offset:27680
    ds_read_b64_tr_b16 a[78:79], v12 offset:28064
    ds_read_b64_tr_b16 a[80:81], v12 offset:64
    ds_read_b64_tr_b16 a[82:83], v12 offset:448
    ds_read_b64_tr_b16 a[84:85], v12 offset:3136
    ds_read_b64_tr_b16 a[86:87], v12 offset:3520
    ds_read_b64_tr_b16 a[88:89], v12 offset:6208
    ds_read_b64_tr_b16 a[90:91], v12 offset:6592
    ds_read_b64_tr_b16 a[92:93], v12 offset:9280
    ds_read_b64_tr_b16 a[94:95], v12 offset:9664
    ds_read_b64_tr_b16 a[96:97], v12 offset:12352
    ds_read_b64_tr_b16 a[98:99], v12 offset:12736
    ds_read_b64_tr_b16 a[100:101], v12 offset:15424
    ds_read_b64_tr_b16 a[102:103], v12 offset:15808
    ds_read_b64_tr_b16 a[104:105], v12 offset:18496
    ds_read_b64_tr_b16 a[106:107], v12 offset:18880
    ds_read_b64_tr_b16 a[108:109], v12 offset:21568
    ds_read_b64_tr_b16 a[110:111], v12 offset:21952
    ds_read_b64_tr_b16 a[112:113], v12 offset:24640
    ds_read_b64_tr_b16 a[114:115], v12 offset:25024
    ds_read_b64_tr_b16 a[116:117], v12 offset:27712
    ds_read_b64_tr_b16 a[118:119], v12 offset:28096
    s_waitcnt lgkmcnt(0)
    s_cmp_ge_u32 s20, 20
    s_cbranch_scc1 Xfb_b
    v_lshrrev_b32 v4, 2, v1
    v_mul_u32_u24 v4, 1280, v4
    v_and_b32 v5, 3, v1
    v_lshl_add_u32 v4, v5, 4, v4
    s_mul_i32 s4, s3, 491520
    s_lshl_b32 s5, s20, 6
    s_add_u32 s4, s4, s5
    s_mul_i32 s5, s3, 30720
    s_add_u32 m0, s5, 40960
    s_nop 0
    buffer_load_dwordx4 v4, s[92:95], s4 offen lds
    s_add_u32 s4, s4, 20480
    s_add_u32 m0, s5, 41984
    s_nop 0
    buffer_load_dwordx4 v4, s[92:95], s4 offen lds
    s_add_u32 s4, s4, 20480
    s_add_u32 m0, s5, 43008
    s_nop 0
    buffer_load_dwordx4 v4, s[92:95], s4 offen lds
    s_add_u32 s4, s4, 20480
    s_add_u32 m0, s5, 44032
    s_nop 0
    buffer_load_dwordx4 v4, s[92:95], s4 offen lds
    s_add_u32 s4, s4, 20480
    s_add_u32 m0, s5, 45056
    s_nop 0
    buffer_load_dwordx4 v4, s[92:95], s4 offen lds
    s_add_u32 s4, s4, 20480
    s_add_u32 m0, s5, 46080
    s_nop 0
    buffer_load_dwordx4 v4, s[92:95], s4 offen lds
    s_add_u32 s4, s4, 20480
    s_add_u32 m0, s5, 47104
    s_nop 0
    buffer_load_dwordx4 v4, s[92:95], s4 offen lds
    s_add_u32 s4, s4, 20480
    s_add_u32 m0, s5, 48128
    s_nop 0
    buffer_load_dwordx4 v4, s[92:95], s4 offen lds
    s_add_u32 s4, s4, 20480
    s_add_u32 m0, s5, 49152
    s_nop 0
    buffer_load_dwordx4 v4, s[92:95], s4 offen lds
    s_add_u32 s4, s4, 20480
    s_add_u32 m0, s5, 50176
    s_nop 0
    buffer_load_dwordx4 v4, s[92:95], s4 offen lds
    s_add_u32 s4, s4, 20480
    s_add_u32 m0, s5, 51200
    s_nop 0
    buffer_load_dwordx4 v4, s[92:95], s4 offen lds
    s_add_u32 s4, s4, 20480
    s_add_u32 m0, s5, 52224
    s_nop 0
    buffer_load_dwordx4 v4, s[92:95], s4 offen lds
    s_add_u32 s4, s4, 20480
    s_add_u32 m0, s5, 53248
    s_nop 0
    buffer_load_dwordx4 v4, s[92:95], s4 offen lds
    s_add_u32 s4, s4, 20480
    s_add_u32 m0, s5, 54272
    s_nop 0
    buffer_load_dwordx4 v4, s[92:95], s4 offen lds
    s_add_u32 s4, s4, 20480
    s_add_u32 m0, s5, 55296
    s_nop 0
    buffer_load_dwordx4 v4, s[92:95], s4 offen lds
    s_add_u32 s4, s4, 20480
    s_add_u32 m0, s5, 56320
    s_nop 0
    buffer_load_dwordx4 v4, s[92:95], s4 offen lds
    s_add_u32 s4, s4, 20480
    s_add_u32 m0, s5, 57344
    s_nop 0
    buffer_load_dwordx4 v4, s[92:95], s4 offen lds
    s_add_u32 s4, s4, 20480
    s_add_u32 m0, s5, 58368
    s_nop 0
    buffer_load_dwordx4 v4, s[92:95], s4 offen lds
    s_add_u32 s4, s4, 20480
    s_add_u32 m0, s5, 59392
    s_nop 0
    buffer_load_dwordx4 v4, s[92:95], s4 offen lds
    s_add_u32 s4, s4, 20480
    s_add_u32 m0, s5, 60416
    s_nop 0
    buffer_load_dwordx4 v4, s[92:95], s4 offen lds
    s_add_u32 s4, s4, 20480
    s_add_u32 m0, s5, 61440
    s_nop 0
    buffer_load_dwordx4 v4, s[92:95], s4 offen lds
    s_add_u32 s4, s4, 20480
    s_add_u32 m0, s5, 62464
    s_nop 0
    buffer_load_dwordx4 v4, s[92:95], s4 offen lds
    s_add_u32 s4, s4, 20480
    s_add_u32 m0, s5, 63488
    s_nop 0
    buffer_load_dwordx4 v4, s[92:95], s4 offen lds
    s_add_u32 s4, s4, 20480
    s_add_u32 m0, s5, 64512
    s_nop 0
    buffer_load_dwordx4 v4, s[92:95], s4 offen lds
    s_add_u32 s4, s4, 20480
Xfb_b:
    s_cmp_eq_u32 s29, 13
    s_cbranch_scc0 Xfb_c
    s_waitcnt vmcnt(0)
    v_lshrrev_b32 v12, 4, v1
    v_lshlrev_b32 v12, 3, v12
    v_bfe_u32 v13, v1, 2, 2
    v_add_u32 v12, v12, v13
    v_mul_u32_u24 v12, 64, v12
    v_and_b32 v13, 3, v1
    v_lshlrev_b32 v13, 3, v13
    v_add_u32 v12, v12, v13
    s_mul_i32 s4, s3, 30720
    s_add_u32 s4, s4, 40960
    v_add_u32 v12, s4, v12
    ds_read_b64_tr_b16 a[120:121], v12 offset:0
    ds_read_b64_tr_b16 a[122:123], v12 offset:256
    ds_read_b64_tr_b16 a[124:125], v12 offset:2048
    ds_read_b64_tr_b16 a[126:127], v12 offset:2304
    ds_read_b64_tr_b16 a[128:129], v12 offset:4096
    ds_read_b64_tr_b16 a[130:131], v12 offset:4352
    ds_read_b64_tr_b16 a[132:133], v12 offset:6144
    ds_read_b64_tr_b16 a[134:135], v12 offset:6400
    ds_read_b64_tr_b16 a[136:137], v12 offset:8192
    ds_read_b64_tr_b16 a[138:139], v12 offset:8448
    ds_read_b64_tr_b16 a[140:141], v12 offset:10240
    ds_read_b64_tr_b16 a[142:143], v12 offset:10496
    ds_read_b64_tr_b16 a[144:145], v12 offset:12288
    ds_read_b64_tr_b16 a[146:147], v12 offset:12544
    ds_read_b64_tr_b16 a[148:149], v12 offset:14336
    ds_read_b64_tr_b16 a[150:151], v12 offset:14592
    ds_read_b64_tr_b16 a[152:153], v12 offset:16384
    ds_read_b64_tr_b16 a[154:155], v12 offset:16640
    ds_read_b64_tr_b16 a[156:157], v12 offset:18432
    ds_read_b64_tr_b16 a[158:159], v12 offset:18688
    ds_read_b64_tr_b16 a[160:161], v12 offset:20480
    ds_read_b64_tr_b16 a[162:163], v12 offset:20736
    ds_read_b64_tr_b16 a[164:165], v12 offset:22528
    ds_read_b64_tr_b16 a[166:167], v12 offset:22784
    ds_read_b64_tr_b16 a[168:169], v12 offset:32
    ds_read_b64_tr_b16 a[170:171], v12 offset:288
    ds_read_b64_tr_b16 a[172:173], v12 offset:2080
    ds_read_b64_tr_b16 a[174:175], v12 offset:2336
    ds_read_b64_tr_b16 a[176:177], v12 offset:4128
    ds_read_b64_tr_b16 a[178:179], v12 offset:4384
    ds_read_b64_tr_b16 a[180:181], v12 offset:6176
    ds_read_b64_tr_b16 a[182:183], v12 offset:6432
    ds_read_b64_tr_b16 a[184:185], v12 offset:8224
    ds_read_b64_tr_b16 a[186:187], v12 offset:8480
    ds_read_b64_tr_b16 a[188:189], v12 offset:10272
    ds_read_b64_tr_b16 a[190:191], v12 offset:10528
    ds_read_b64_tr_b16 a[192:193], v12 offset:12320
    ds_read_b64_tr_b16 a[194:195], v12 offset:12576
    ds_read_b64_tr_b16 a[196:197], v12 offset:14368
    ds_read_b64_tr_b16 a[198:199], v12 offset:14624
    ds_read_b64_tr_b16 a[200:201], v12 offset:16416
    ds_read_b64_tr_b16 a[202:203], v12 offset:16672
    ds_read_b64_tr_b16 a[204:205], v12 offset:18464
    ds_read_b64_tr_b16 a[206:207], v12 offset:18720
    ds_read_b64_tr_b16 a[208:209], v12 offset:20512
    ds_read_b64_tr_b16 a[210:211], v12 offset:20768
    ds_read_b64_tr_b16 a[212:213], v12 offset:22560
    ds_read_b64_tr_b16 a[214:215], v12 offset:22816
    s_waitcnt lgkmcnt(0)
Xfb_c:
Xfb_e:
    s_branch Xf_loop
Xs_go:
    s_mul_i32 s26, s34, 12288
    s_add_u32 s26, s26, 356352
    s_lshl_b32 s4, s32, 9
    s_add_u32 s4, s4, 3072
    v_and_b32 v16, 0x1f0, v2
    v_add_u32 v16, s4, v16
    s_lshl_b32 s4, s32, 10
    v_add_u32 v17, s4, v2
    v_lshrrev_b32 v56, 4, v1
    v_lshlrev_b32 v57, 2, v56
    v_and_b32 v58, 15, v1
    v_sub_u32 v57, v57, v58
    s_lshl_b32 s4, s32, 4
    v_subrev_u32 v57, s4, v57
    v_and_b32 v56, 0x1f0, v2
    v_mov_b32 v58, 0xff800000
    s_lshl_b32 s37, s34, 1
    s_add_u32 s37, s37, s32
    s_lshl_b32 s37, s37, 10
    s_and_b32 s40, s34, 2
    s_add_u32 s40, s40, s32
    s_lshl_b32 s40, s40, 9
    s_and_b32 s4, s34, 1
    s_lshl_b32 s4, s4, 3
    s_add_u32 s40, s40, s4
    s_add_u32 s40, s40, 413696
    s_add_u32 s37, s37, 405504
    s_mov_b32 s41, 0x3dd53b95
    s_mov_b32 s21, 0
Xs_loop:
    s_and_b32 s36, s21, 3
    s_lshl_b32 s36, s36, 16
    s_add_u32 s36, s36, s22
    s_add_u32 s35, s36, s26
    s_add_u32 s21, s21, 1
    s_mov_b32 s31, 0
Xsw_l:
    buffer_load_dword v18, v15, s[8:11], s22 offen sc1
    s_waitcnt vmcnt(0)
Xsw_c:
    v_cmp_gt_u32 vcc, s21, v18
    s_cbranch_vccz Xsw_o
    s_sleep 1
    s_add_u32 s31, s31, 1
    s_cmp_lt_u32 s31, s30
    s_cbranch_scc1 Xsw_l
    s_mov_b32 s30, 1
Xsw_o:
    s_add_u32 s4, s35, 0
    buffer_load_dwordx4 v[60:63], v16, s[8:11], s4 offen offset:0 sc1
    buffer_load_dwordx4 v[64:67], v17, s[8:11], s4 offen offset:0 sc1
    buffer_load_dwordx4 v[68:71], v17, s[8:11], s4 offen offset:1024 sc1
    s_add_u32 s4, s35, 4096
    buffer_load_dwordx4 v[72:75], v16, s[8:11], s4 offen offset:0 sc1
    buffer_load_dwordx4 v[76:79], v17, s[8:11], s4 offen offset:0 sc1
    buffer_load_dwordx4 v[80:83], v17, s[8:11], s4 offen offset:1024 sc1
    s_add_u32 s4, s35, 8192
    buffer_load_dwordx4 v[84:87], v16, s[8:11], s4 offen offset:0 sc1
    buffer_load_dwordx4 v[88:91], v17, s[8:11], s4 offen offset:0 sc1
    buffer_load_dwordx4 v[92:95], v17, s[8:11], s4 offen offset:1024 sc1
    s_add_u32 s5, s36, s37
    s_add_u32 s6, s36, s40
    s_waitcnt vmcnt(3)
    v_pk_add_f32 v[60:61], v[60:61], v[72:73]
    v_pk_add_f32 v[62:63], v[62:63], v[74:75]
    v_pk_add_f32 v[64:65], v[64:65], v[76:77]
    v_pk_add_f32 v[66:67], v[66:67], v[78:79]
    v_pk_add_f32 v[68:69], v[68:69], v[80:81]
    v_pk_add_f32 v[70:71], v[70:71], v[82:83]
    s_waitcnt vmcnt(0)
    v_pk_add_f32 v[60:61], v[60:61], v[84:85]
    v_pk_add_f32 v[62:63], v[62:63], v[86:87]
    v_pk_add_f32 v[64:65], v[64:65], v[88:89]
    v_pk_add_f32 v[66:67], v[66:67], v[90:91]
    v_pk_add_f32 v[68:69], v[68:69], v[92:93]
    v_pk_add_f32 v[70:71], v[70:71], v[94:95]
    v_cmp_lt_u32 vcc, 31, v1
    s_nop 1
    v_cndmask_b32 v60, v58, v60, vcc
    v_cndmask_b32 v61, v58, v61, vcc
    v_cndmask_b32 v62, v58, v62, vcc
    v_cndmask_b32 v63, v58, v63, vcc
    v_cmp_ge_i32 vcc, 0, v57
    s_nop 1
    v_cndmask_b32 v64, v58, v64, vcc
    v_cmp_ge_i32 vcc, -1, v57
    s_nop 1
    v_cndmask_b32 v65, v58, v65, vcc
    v_cmp_ge_i32 vcc, -2, v57
    s_nop 1
    v_cndmask_b32 v66, v58, v66, vcc
    v_cmp_ge_i32 vcc, -3, v57
    s_nop 1
    v_cndmask_b32 v67, v58, v67, vcc
    v_cmp_ge_i32 vcc, -16, v57
    s_nop 1
    v_cndmask_b32 v68, v58, v68, vcc
    v_cmp_ge_i32 vcc, -17, v57
    s_nop 1
    v_cndmask_b32 v69, v58, v69, vcc
    v_cmp_ge_i32 vcc, -18, v57
    s_nop 1
    v_cndmask_b32 v70, v58, v70, vcc
    v_cmp_ge_i32 vcc, -19, v57
    s_nop 1
    v_cndmask_b32 v71, v58, v71, vcc
    v_max_f32 v44, v60, v61
    v_max3_f32 v44, v44, v62, v63
    v_max3_f32 v44, v44, v64, v65
    v_max3_f32 v44, v44, v66, v67
    v_max3_f32 v44, v44, v68, v69
    v_max3_f32 v44, v44, v70, v71
    v_mov_b32 v45, v44
    s_nop 1
    v_permlane16_swap_b32 v44, v45
    v_max_f32 v44, v44, v45
    v_mov_b32 v45, v44
    s_nop 1
    v_permlane32_swap_b32 v44, v45
    v_max_f32 v44, v44, v45
    v_mul_f32 v44, s41, v44
    v_fma_f32 v60, v60, s41, -v44
    v_fma_f32 v61, v61, s41, -v44
    v_fma_f32 v62, v62, s41, -v44
    v_fma_f32 v63, v63, s41, -v44
    v_fma_f32 v64, v64, s41, -v44
    v_fma_f32 v65, v65, s41, -v44
    v_fma_f32 v66, v66, s41, -v44
    v_fma_f32 v67, v67, s41, -v44
    v_fma_f32 v68, v68, s41, -v44
    v_fma_f32 v69, v69, s41, -v44
    v_fma_f32 v70, v70, s41, -v44
    v_fma_f32 v71, v71, s41, -v44
    v_exp_f32 v60, v60
    v_exp_f32 v61, v61
    v_exp_f32 v62, v62
    v_exp_f32 v63, v63
    v_exp_f32 v64, v64
    v_exp_f32 v65, v65
    v_exp_f32 v66, v66
    v_exp_f32 v67, v67
    v_exp_f32 v68, v68
    v_exp_f32 v69, v69
    v_exp_f32 v70, v70
    v_exp_f32 v71, v71
    v_add_f32 v44, v60, v61
    v_add_f32 v44, v44, v62
    v_add_f32 v44, v44, v63
    v_add_f32 v44, v44, v64
    v_add_f32 v44, v44, v65
    v_add_f32 v44, v44, v66
    v_add_f32 v44, v44, v67
    v_add_f32 v44, v44, v68
    v_add_f32 v44, v44, v69
    v_add_f32 v44, v44, v70
    v_add_f32 v44, v44, v71
    v_mov_b32 v45, v44
    s_nop 1
    v_permlane16_swap_b32 v44, v45
    v_add_f32 v44, v44, v45
    v_mov_b32 v45, v44
    s_nop 1
    v_permlane32_swap_b32 v44, v45
    v_add_f32 v44, v44, v45
    v_rcp_f32 v44, v44
    s_nop 0
    v_mul_f32 v60, v60, v44
    v_mul_f32 v61, v61, v44
    v_mul_f32 v62, v62, v44
    v_mul_f32 v63, v63, v44
    v_mul_f32 v64, v64, v44
    v_mul_f32 v65, v65, v44
    v_mul_f32 v66, v66, v44
    v_mul_f32 v67, v67, v44
    v_mul_f32 v68, v68, v44
    v_mul_f32 v69, v69, v44
    v_mul_f32 v70, v70, v44
    v_mul_f32 v71, v71, v44
    v_cvt_pk_bf16_f32 v48, v64, v65
    v_cvt_pk_bf16_f32 v49, v68, v69
    v_cvt_pk_bf16_f32 v50, v66, v67
    v_cvt_pk_bf16_f32 v51, v70, v71
    v_cvt_pk_bf16_f32 v52, v60, v61
    v_cvt_pk_bf16_f32 v53, v62, v63
    buffer_store_dwordx4 v[48:51], v2, s[8:11], s5 offen offset:0 sc1
    s_mov_b32 exec_lo, 0
    buffer_store_dwordx2 v[52:53], v56, s[8:11], s6 offen offset:0 sc1
    s_mov_b64 exec, -1
    s_waitcnt vmcnt(0)
    v_mov_b32 v10, s21
    s_mov_b64 exec, 1
    buffer_store_dword v10, v9, s[8:11], s33 offen sc1
    s_mov_b64 exec, -1
    s_cmp_eq_u32 s21, 64
    s_cbranch_scc1 X_join
    s_bitcmp1_b32 s21, 0
    s_cbranch_scc1 Xs_loop
    s_lshr_b32 s29, s21, 1
    s_sub_u32 s29, s29, 2
    s_cbranch_scc1 Xs_loop
    s_cmp_lt_u32 s29, 2
    s_cbranch_scc1 Xsb_e
    s_cmp_lt_u32 s29, 10
    s_cbranch_scc0 Xsb_a
    s_mov_b32 exec_hi, 0x0fffffff
    s_add_u32 m0, s99, 0
    s_nop 0
    buffer_load_dwordx4 v0, s[84:87], s98 offen lds
    s_add_u32 m0, s99, 15360
    s_nop 0
    buffer_load_dwordx4 v0, s[88:91], s98 offen lds
    s_add_u32 s98, s98, 30720
    s_add_u32 s99, s99, 960
    s_add_u32 m0, s99, 0
    s_nop 0
    buffer_load_dwordx4 v0, s[84:87], s98 offen lds
    s_add_u32 m0, s99, 15360
    s_nop 0
    buffer_load_dwordx4 v0, s[88:91], s98 offen lds
    s_add_u32 s98, s98, 30720
    s_add_u32 s99, s99, 960
    s_mov_b64 exec, -1
    buffer_load_dwordx4 v[96:99], v2, s[92:95], s23 offen offset:0
    buffer_load_dwordx4 v[96:99], v2, s[92:95], s23 offen offset:1024
    s_add_u32 s23, s23, 2048
Xsb_a:
    s_cmp_eq_u32 s29, 11
    s_cbranch_scc0 Xsb_b
    s_waitcnt vmcnt(0)
    v_lshrrev_b32 v12, 4, v1
    v_lshlrev_b32 v12, 3, v12
    v_bfe_u32 v13, v1, 2, 2
    v_add_u32 v12, v12, v13
    v_mul_u32_u24 v12, 96, v12
    v_and_b32 v13, 3, v1
    v_lshlrev_b32 v13, 3, v13
    v_add_u32 v12, v12, v13
    s_mul_i32 s4, s3, 30720
    s_add_u32 s4, s4, 40960
    v_add_u32 v12, s4, v12
    ds_read_b64_tr_b16 a[0:1], v12 offset:0
    ds_read_b64_tr_b16 a[2:3], v12 offset:384
    ds_read_b64_tr_b16 a[4:5], v12 offset:3072
    ds_read_b64_tr_b16 a[6:7], v12 offset:3456
    ds_read_b64_tr_b16 a[8:9], v12 offset:6144
    ds_read_b64_tr_b16 a[10:11], v12 offset:6528
    ds_read_b64_tr_b16 a[12:13], v12 offset:9216
    ds_read_b64_tr_b16 a[14:15], v12 offset:9600
    ds_read_b64_tr_b16 a[16:17], v12 offset:12288
    ds_read_b64_tr_b16 a[18:19], v12 offset:12672
    ds_read_b64_tr_b16 a[20:21], v12 offset:15360
    ds_read_b64_tr_b16 a[22:23], v12 offset:15744
    ds_read_b64_tr_b16 a[24:25], v12 offset:18432
    ds_read_b64_tr_b16 a[26:27], v12 offset:18816
    ds_read_b64_tr_b16 a[28:29], v12 offset:21504
    ds_read_b64_tr_b16 a[30:31], v12 offset:21888
    ds_read_b64_tr_b16 a[32:33], v12 offset:24576
    ds_read_b64_tr_b16 a[34:35], v12 offset:24960
    ds_read_b64_tr_b16 a[36:37], v12 offset:27648
    ds_read_b64_tr_b16 a[38:39], v12 offset:28032
    ds_read_b64_tr_b16 a[40:41], v12 offset:32
    ds_read_b64_tr_b16 a[42:43], v12 offset:416
    ds_read_b64_tr_b16 a[44:45], v12 offset:3104
    ds_read_b64_tr_b16 a[46:47], v12 offset:3488
    ds_read_b64_tr_b16 a[48:49], v12 offset:6176
    ds_read_b64_tr_b16 a[50:51], v12 offset:6560
    ds_read_b64_tr_b16 a[52:53], v12 offset:9248
    ds_read_b64_tr_b16 a[54:55], v12 offset:9632
    ds_read_b64_tr_b16 a[56:57], v12 offset:12320
    ds_read_b64_tr_b16 a[58:59], v12 offset:12704
    ds_read_b64_tr_b16 a[60:61], v12 offset:15392
    ds_read_b64_tr_b16 a[62:63], v12 offset:15776
    ds_read_b64_tr_b16 a[64:65], v12 offset:18464
    ds_read_b64_tr_b16 a[66:67], v12 offset:18848
    ds_read_b64_tr_b16 a[68:69], v12 offset:21536
    ds_read_b64_tr_b16 a[70:71], v12 offset:21920
    ds_read_b64_tr_b16 a[72:73], v12 offset:24608
    ds_read_b64_tr_b16 a[74:75], v12 offset:24992
    ds_read_b64_tr_b16 a[76:77], v12 offset:27680
    ds_read_b64_tr_b16 a[78:79], v12 offset:28064
    ds_read_b64_tr_b16 a[80:81], v12 offset:64
    ds_read_b64_tr_b16 a[82:83], v12 offset:448
    ds_read_b64_tr_b16 a[84:85], v12 offset:3136
    ds_read_b64_tr_b16 a[86:87], v12 offset:3520
    ds_read_b64_tr_b16 a[88:89], v12 offset:6208
    ds_read_b64_tr_b16 a[90:91], v12 offset:6592
    ds_read_b64_tr_b16 a[92:93], v12 offset:9280
    ds_read_b64_tr_b16 a[94:95], v12 offset:9664
    ds_read_b64_tr_b16 a[96:97], v12 offset:12352
    ds_read_b64_tr_b16 a[98:99], v12 offset:12736
    ds_read_b64_tr_b16 a[100:101], v12 offset:15424
    ds_read_b64_tr_b16 a[102:103], v12 offset:15808
    ds_read_b64_tr_b16 a[104:105], v12 offset:18496
    ds_read_b64_tr_b16 a[106:107], v12 offset:18880
    ds_read_b64_tr_b16 a[108:109], v12 offset:21568
    ds_read_b64_tr_b16 a[110:111], v12 offset:21952
    ds_read_b64_tr_b16 a[112:113], v12 offset:24640
    ds_read_b64_tr_b16 a[114:115], v12 offset:25024
    ds_read_b64_tr_b16 a[116:117], v12 offset:27712
    ds_read_b64_tr_b16 a[118:119], v12 offset:28096
    s_waitcnt lgkmcnt(0)
    s_cmp_ge_u32 s20, 20
    s_cbranch_scc1 Xsb_b
    v_lshrrev_b32 v4, 2, v1
    v_mul_u32_u24 v4, 1280, v4
    v_and_b32 v5, 3, v1
    v_lshl_add_u32 v4, v5, 4, v4
    s_mul_i32 s4, s3, 491520
    s_lshl_b32 s5, s20, 6
    s_add_u32 s4, s4, s5
    s_mul_i32 s5, s3, 30720
    s_add_u32 m0, s5, 40960
    s_nop 0
    buffer_load_dwordx4 v4, s[92:95], s4 offen lds
    s_add_u32 s4, s4, 20480
    s_add_u32 m0, s5, 41984
    s_nop 0
    buffer_load_dwordx4 v4, s[92:95], s4 offen lds
    s_add_u32 s4, s4, 20480
    s_add_u32 m0, s5, 43008
    s_nop 0
    buffer_load_dwordx4 v4, s[92:95], s4 offen lds
    s_add_u32 s4, s4, 20480
    s_add_u32 m0, s5, 44032
    s_nop 0
    buffer_load_dwordx4 v4, s[92:95], s4 offen lds
    s_add_u32 s4, s4, 20480
    s_add_u32 m0, s5, 45056
    s_nop 0
    buffer_load_dwordx4 v4, s[92:95], s4 offen lds
    s_add_u32 s4, s4, 20480
    s_add_u32 m0, s5, 46080
    s_nop 0
    buffer_load_dwordx4 v4, s[92:95], s4 offen lds
    s_add_u32 s4, s4, 20480
    s_add_u32 m0, s5, 47104
    s_nop 0
    buffer_load_dwordx4 v4, s[92:95], s4 offen lds
    s_add_u32 s4, s4, 20480
    s_add_u32 m0, s5, 48128
    s_nop 0
    buffer_load_dwordx4 v4, s[92:95], s4 offen lds
    s_add_u32 s4, s4, 20480
    s_add_u32 m0, s5, 49152
    s_nop 0
    buffer_load_dwordx4 v4, s[92:95], s4 offen lds
    s_add_u32 s4, s4, 20480
    s_add_u32 m0, s5, 50176
    s_nop 0
    buffer_load_dwordx4 v4, s[92:95], s4 offen lds
    s_add_u32 s4, s4, 20480
    s_add_u32 m0, s5, 51200
    s_nop 0
    buffer_load_dwordx4 v4, s[92:95], s4 offen lds
    s_add_u32 s4, s4, 20480
    s_add_u32 m0, s5, 52224
    s_nop 0
    buffer_load_dwordx4 v4, s[92:95], s4 offen lds
    s_add_u32 s4, s4, 20480
    s_add_u32 m0, s5, 53248
    s_nop 0
    buffer_load_dwordx4 v4, s[92:95], s4 offen lds
    s_add_u32 s4, s4, 20480
    s_add_u32 m0, s5, 54272
    s_nop 0
    buffer_load_dwordx4 v4, s[92:95], s4 offen lds
    s_add_u32 s4, s4, 20480
    s_add_u32 m0, s5, 55296
    s_nop 0
    buffer_load_dwordx4 v4, s[92:95], s4 offen lds
    s_add_u32 s4, s4, 20480
    s_add_u32 m0, s5, 56320
    s_nop 0
    buffer_load_dwordx4 v4, s[92:95], s4 offen lds
    s_add_u32 s4, s4, 20480
    s_add_u32 m0, s5, 57344
    s_nop 0
    buffer_load_dwordx4 v4, s[92:95], s4 offen lds
    s_add_u32 s4, s4, 20480
    s_add_u32 m0, s5, 58368
    s_nop 0
    buffer_load_dwordx4 v4, s[92:95], s4 offen lds
    s_add_u32 s4, s4, 20480
    s_add_u32 m0, s5, 59392
    s_nop 0
    buffer_load_dwordx4 v4, s[92:95], s4 offen lds
    s_add_u32 s4, s4, 20480
    s_add_u32 m0, s5, 60416
    s_nop 0
    buffer_load_dwordx4 v4, s[92:95], s4 offen lds
    s_add_u32 s4, s4, 20480
    s_add_u32 m0, s5, 61440
    s_nop 0
    buffer_load_dwordx4 v4, s[92:95], s4 offen lds
    s_add_u32 s4, s4, 20480
    s_add_u32 m0, s5, 62464
    s_nop 0
    buffer_load_dwordx4 v4, s[92:95], s4 offen lds
    s_add_u32 s4, s4, 20480
    s_add_u32 m0, s5, 63488
    s_nop 0
    buffer_load_dwordx4 v4, s[92:95], s4 offen lds
    s_add_u32 s4, s4, 20480
    s_add_u32 m0, s5, 64512
    s_nop 0
    buffer_load_dwordx4 v4, s[92:95], s4 offen lds
    s_add_u32 s4, s4, 20480
Xsb_b:
    s_cmp_eq_u32 s29, 13
    s_cbranch_scc0 Xsb_c
    s_waitcnt vmcnt(0)
    v_lshrrev_b32 v12, 4, v1
    v_lshlrev_b32 v12, 3, v12
    v_bfe_u32 v13, v1, 2, 2
    v_add_u32 v12, v12, v13
    v_mul_u32_u24 v12, 64, v12
    v_and_b32 v13, 3, v1
    v_lshlrev_b32 v13, 3, v13
    v_add_u32 v12, v12, v13
    s_mul_i32 s4, s3, 30720
    s_add_u32 s4, s4, 40960
    v_add_u32 v12, s4, v12
    ds_read_b64_tr_b16 a[120:121], v12 offset:0
    ds_read_b64_tr_b16 a[122:123], v12 offset:256
    ds_read_b64_tr_b16 a[124:125], v12 offset:2048
    ds_read_b64_tr_b16 a[126:127], v12 offset:2304
    ds_read_b64_tr_b16 a[128:129], v12 offset:4096
    ds_read_b64_tr_b16 a[130:131], v12 offset:4352
    ds_read_b64_tr_b16 a[132:133], v12 offset:6144
    ds_read_b64_tr_b16 a[134:135], v12 offset:6400
    ds_read_b64_tr_b16 a[136:137], v12 offset:8192
    ds_read_b64_tr_b16 a[138:139], v12 offset:8448
    ds_read_b64_tr_b16 a[140:141], v12 offset:10240
    ds_read_b64_tr_b16 a[142:143], v12 offset:10496
    ds_read_b64_tr_b16 a[144:145], v12 offset:12288
    ds_read_b64_tr_b16 a[146:147], v12 offset:12544
    ds_read_b64_tr_b16 a[148:149], v12 offset:14336
    ds_read_b64_tr_b16 a[150:151], v12 offset:14592
    ds_read_b64_tr_b16 a[152:153], v12 offset:16384
    ds_read_b64_tr_b16 a[154:155], v12 offset:16640
    ds_read_b64_tr_b16 a[156:157], v12 offset:18432
    ds_read_b64_tr_b16 a[158:159], v12 offset:18688
    ds_read_b64_tr_b16 a[160:161], v12 offset:20480
    ds_read_b64_tr_b16 a[162:163], v12 offset:20736
    ds_read_b64_tr_b16 a[164:165], v12 offset:22528
    ds_read_b64_tr_b16 a[166:167], v12 offset:22784
    ds_read_b64_tr_b16 a[168:169], v12 offset:32
    ds_read_b64_tr_b16 a[170:171], v12 offset:288
    ds_read_b64_tr_b16 a[172:173], v12 offset:2080
    ds_read_b64_tr_b16 a[174:175], v12 offset:2336
    ds_read_b64_tr_b16 a[176:177], v12 offset:4128
    ds_read_b64_tr_b16 a[178:179], v12 offset:4384
    ds_read_b64_tr_b16 a[180:181], v12 offset:6176
    ds_read_b64_tr_b16 a[182:183], v12 offset:6432
    ds_read_b64_tr_b16 a[184:185], v12 offset:8224
    ds_read_b64_tr_b16 a[186:187], v12 offset:8480
    ds_read_b64_tr_b16 a[188:189], v12 offset:10272
    ds_read_b64_tr_b16 a[190:191], v12 offset:10528
    ds_read_b64_tr_b16 a[192:193], v12 offset:12320
    ds_read_b64_tr_b16 a[194:195], v12 offset:12576
    ds_read_b64_tr_b16 a[196:197], v12 offset:14368
    ds_read_b64_tr_b16 a[198:199], v12 offset:14624
    ds_read_b64_tr_b16 a[200:201], v12 offset:16416
    ds_read_b64_tr_b16 a[202:203], v12 offset:16672
    ds_read_b64_tr_b16 a[204:205], v12 offset:18464
    ds_read_b64_tr_b16 a[206:207], v12 offset:18720
    ds_read_b64_tr_b16 a[208:209], v12 offset:20512
    ds_read_b64_tr_b16 a[210:211], v12 offset:20768
    ds_read_b64_tr_b16 a[212:213], v12 offset:22560
    ds_read_b64_tr_b16 a[214:215], v12 offset:22816
    s_waitcnt lgkmcnt(0)
Xsb_c:
Xsb_e:
    s_branch Xs_loop
X3_go:
    s_load_dwordx2 s[24:25], s[0:1], 64
    s_mov_b32 s26, 1280
    s_mov_b32 s27, 0x20000
    s_waitcnt lgkmcnt(0)
    v_lshlrev_b32 v3, 2, v1
    v_lshlrev_b32 v11, 3, v1
    s_mov_b32 s4, 5120
    buffer_load_dwordx2 v[146:147], v11, s[8:11], s4 offen offset:0 sc1
    buffer_load_dwordx2 v[148:149], v11, s[8:11], s4 offen offset:512 sc1
    buffer_load_dwordx2 v[150:151], v11, s[8:11], s4 offen offset:1024 sc1
    buffer_load_dwordx2 v[152:153], v11, s[8:11], s4 offen offset:1536 sc1
    buffer_load_dwordx2 v[154:155], v11, s[8:11], s4 offen offset:2048 sc1
    s_mov_b32 s5, 7680
    s_mov_b32 s6, 10240
    s_mov_b32 s7, 12800
    buffer_load_dwordx2 v[100:101], v11, s[8:11], s5 offen offset:0 sc1
    buffer_load_dwordx2 v[110:111], v11, s[8:11], s6 offen offset:0 sc1
    buffer_load_dwordx2 v[120:121], v11, s[8:11], s7 offen offset:0 sc1
    buffer_load_dword v140, v3, s[24:27], 0 offen offset:0
    buffer_load_dwordx2 v[102:103], v11, s[8:11], s5 offen offset:512 sc1
    buffer_load_dwordx2 v[112:113], v11, s[8:11], s6 offen offset:512 sc1
    buffer_load_dwordx2 v[122:123], v11, s[8:11], s7 offen offset:512 sc1
    buffer_load_dword v141, v3, s[24:27], 0 offen offset:256
    buffer_load_dwordx2 v[104:105], v11, s[8:11], s5 offen offset:1024 sc1
    buffer_load_dwordx2 v[114:115], v11, s[8:11], s6 offen offset:1024 sc1
    buffer_load_dwordx2 v[124:125], v11, s[8:11], s7 offen offset:1024 sc1
    buffer_load_dword v142, v3, s[24:27], 0 offen offset:512
    buffer_load_dwordx2 v[106:107], v11, s[8:11], s5 offen offset:1536 sc1
    buffer_load_dwordx2 v[116:117], v11, s[8:11], s6 offen offset:1536 sc1
    buffer_load_dwordx2 v[126:127], v11, s[8:11], s7 offen offset:1536 sc1
    buffer_load_dword v143, v3, s[24:27], 0 offen offset:768
    buffer_load_dwordx2 v[108:109], v11, s[8:11], s5 offen offset:2048 sc1
    buffer_load_dwordx2 v[118:119], v11, s[8:11], s6 offen offset:2048 sc1
    buffer_load_dwordx2 v[128:129], v11, s[8:11], s7 offen offset:2048 sc1
    buffer_load_dword v144, v3, s[24:27], 0 offen offset:1024
    s_waitcnt vmcnt(0)
    v_add_f32 v110, 1.0, v110
    v_cvt_pk_bf16_f32 v110, v110, v110
    v_and_b32 v110, 0xffff0000, v110
    v_add_f32 v111, 1.0, v111
    v_cvt_pk_bf16_f32 v111, v111, v111
    v_and_b32 v111, 0xffff0000, v111
    v_add_f32 v112, 1.0, v112
    v_cvt_pk_bf16_f32 v112, v112, v112
    v_and_b32 v112, 0xffff0000, v112
    v_add_f32 v113, 1.0, v113
    v_cvt_pk_bf16_f32 v113, v113, v113
    v_and_b32 v113, 0xffff0000, v113
    v_add_f32 v114, 1.0, v114
    v_cvt_pk_bf16_f32 v114, v114, v114
    v_and_b32 v114, 0xffff0000, v114
    v_add_f32 v115, 1.0, v115
    v_cvt_pk_bf16_f32 v115, v115, v115
    v_and_b32 v115, 0xffff0000, v115
    v_add_f32 v116, 1.0, v116
    v_cvt_pk_bf16_f32 v116, v116, v116
    v_and_b32 v116, 0xffff0000, v116
    v_add_f32 v117, 1.0, v117
    v_cvt_pk_bf16_f32 v117, v117, v117
    v_and_b32 v117, 0xffff0000, v117
    v_add_f32 v118, 1.0, v118
    v_cvt_pk_bf16_f32 v118, v118, v118
    v_and_b32 v118, 0xffff0000, v118
    v_add_f32 v119, 1.0, v119
    v_cvt_pk_bf16_f32 v119, v119, v119
    v_and_b32 v119, 0xffff0000, v119
    v_lshlrev_b32 v130, 16, v140
    v_and_b32 v131, 0xffff0000, v140
    v_lshlrev_b32 v132, 16, v141
    v_and_b32 v133, 0xffff0000, v141
    v_lshlrev_b32 v134, 16, v142
    v_and_b32 v135, 0xffff0000, v142
    v_lshlrev_b32 v136, 16, v143
    v_and_b32 v137, 0xffff0000, v143
    v_lshlrev_b32 v138, 16, v144
    v_and_b32 v139, 0xffff0000, v144
    s_sub_u32 s21, s28, 2
    s_lshl_b32 s28, s28, 2
    s_add_u32 s28, s28, s3
X3_loop:
    s_cmp_lt_u32 s21, 57
    s_cselect_b32 s4, 5, 3
    s_add_u32 s35, s21, s4
    s_mov_b32 s31, 0
X3w_l:
    buffer_load_dword v18, v15, s[8:11], s22 offen sc1
    s_waitcnt vmcnt(0)
X3w_c:
    v_cmp_gt_u32 vcc, s35, v18
    s_cbranch_vccz X3w_o
    s_sleep 4
    s_add_u32 s31, s31, 1
    s_cmp_lt_u32 s31, s30
    s_cbranch_scc1 X3w_l
    s_mov_b32 s30, 1
X3w_o:
    v_lshrrev_b32 v16, 3, v1
    v_lshlrev_b32 v16, 10, v16
    v_and_b32 v17, 7, v1
    v_lshl_add_u32 v16, v17, 2, v16
    s_lshl_b32 s4, s96, 5
    v_add_u32 v16, s4, v16
    s_lshl_b32 s4, s21, 5
    s_add_u32 s4, s4, s96
    s_mul_i32 s24, s4, 1280
    s_add_u32 s25, s24, 59244544
    s_lshl_b32 s5, s4, 2
    s_add_u32 s5, s5, 16384
    s_lshl_b32 s6, s4, 7
    s_add_u32 s6, s6, 61636608
    s_cmp_lt_u32 s4, 1792
    s_cselect_b32 s42, s5, s6
    s_mul_i32 s35, s21, 524288
    s_add_u32 s35, s35, 23068672
    buffer_load_dword v140, v3, s[12:15], s24 offen offset:0
    buffer_load_dword v141, v3, s[12:15], s24 offen offset:256
    buffer_load_dword v142, v3, s[12:15], s24 offen offset:512
    buffer_load_dword v143, v3, s[12:15], s24 offen offset:768
    buffer_load_dword v144, v3, s[12:15], s24 offen offset:1024
    s_mov_b32 s31, 0
X3p_l:
    s_add_u32 s4, s35, 0
    buffer_load_dword v184, v16, s[8:11], s4 offen offset:0 sc1
    s_add_u32 s4, s35, 8192
    buffer_load_dword v185, v16, s[8:11], s4 offen offset:0 sc1
    s_add_u32 s4, s35, 16384
    buffer_load_dword v186, v16, s[8:11], s4 offen offset:0 sc1
    s_add_u32 s4, s35, 24576
    buffer_load_dword v187, v16, s[8:11], s4 offen offset:0 sc1
    s_add_u32 s4, s35, 32768
    buffer_load_dword v188, v16, s[8:11], s4 offen offset:0 sc1
    s_add_u32 s4, s35, 40960
    buffer_load_dword v189, v16, s[8:11], s4 offen offset:0 sc1
    s_add_u32 s4, s35, 49152
    buffer_load_dword v190, v16, s[8:11], s4 offen offset:0 sc1
    s_add_u32 s4, s35, 57344
    buffer_load_dword v191, v16, s[8:11], s4 offen offset:0 sc1
    s_add_u32 s4, s35, 65536
    buffer_load_dword v192, v16, s[8:11], s4 offen offset:0 sc1
    s_add_u32 s4, s35, 73728
    buffer_load_dword v193, v16, s[8:11], s4 offen offset:0 sc1
    s_add_u32 s4, s35, 81920
    buffer_load_dword v194, v16, s[8:11], s4 offen offset:0 sc1
    s_add_u32 s4, s35, 90112
    buffer_load_dword v195, v16, s[8:11], s4 offen offset:0 sc1
    s_add_u32 s4, s35, 98304
    buffer_load_dword v196, v16, s[8:11], s4 offen offset:0 sc1
    s_add_u32 s4, s35, 106496
    buffer_load_dword v197, v16, s[8:11], s4 offen offset:0 sc1
    s_add_u32 s4, s35, 114688
    buffer_load_dword v198, v16, s[8:11], s4 offen offset:0 sc1
    s_add_u32 s4, s35, 122880
    buffer_load_dword v199, v16, s[8:11], s4 offen offset:0 sc1
    s_add_u32 s4, s35, 131072
    buffer_load_dword v200, v16, s[8:11], s4 offen offset:0 sc1
    s_add_u32 s4, s35, 139264
    buffer_load_dword v201, v16, s[8:11], s4 offen offset:0 sc1
    s_add_u32 s4, s35, 147456
    buffer_load_dword v202, v16, s[8:11], s4 offen offset:0 sc1
    s_add_u32 s4, s35, 155648
    buffer_load_dword v203, v16, s[8:11], s4 offen offset:0 sc1
    s_add_u32 s4, s35, 163840
    buffer_load_dword v204, v16, s[8:11], s4 offen offset:0 sc1
    s_add_u32 s4, s35, 172032
    buffer_load_dword v205, v16, s[8:11], s4 offen offset:0 sc1
    s_add_u32 s4, s35, 180224
    buffer_load_dword v206, v16, s[8:11], s4 offen offset:0 sc1
    s_add_u32 s4, s35, 188416
    buffer_load_dword v207, v16, s[8:11], s4 offen offset:0 sc1
    s_add_u32 s4, s35, 196608
    buffer_load_dword v208, v16, s[8:11], s4 offen offset:0 sc1
    s_add_u32 s4, s35, 204800
    buffer_load_dword v209, v16, s[8:11], s4 offen offset:0 sc1
    s_add_u32 s4, s35, 212992
    buffer_load_dword v210, v16, s[8:11], s4 offen offset:0 sc1
    s_add_u32 s4, s35, 221184
    buffer_load_dword v211, v16, s[8:11], s4 offen offset:0 sc1
    s_add_u32 s4, s35, 229376
    buffer_load_dword v212, v16, s[8:11], s4 offen offset:0 sc1
    s_add_u32 s4, s35, 237568
    buffer_load_dword v213, v16, s[8:11], s4 offen offset:0 sc1
    s_add_u32 s4, s35, 245760
    buffer_load_dword v214, v16, s[8:11], s4 offen offset:0 sc1
    s_add_u32 s4, s35, 253952
    buffer_load_dword v215, v16, s[8:11], s4 offen offset:0 sc1
    s_add_u32 s4, s35, 262144
    buffer_load_dword v216, v16, s[8:11], s4 offen offset:0 sc1
    s_add_u32 s4, s35, 270336
    buffer_load_dword v217, v16, s[8:11], s4 offen offset:0 sc1
    s_add_u32 s4, s35, 278528
    buffer_load_dword v218, v16, s[8:11], s4 offen offset:0 sc1
    s_add_u32 s4, s35, 286720
    buffer_load_dword v219, v16, s[8:11], s4 offen offset:0 sc1
    s_add_u32 s4, s35, 294912
    buffer_load_dword v220, v16, s[8:11], s4 offen offset:0 sc1
    s_add_u32 s4, s35, 303104
    buffer_load_dword v221, v16, s[8:11], s4 offen offset:0 sc1
    s_add_u32 s4, s35, 311296
    buffer_load_dword v222, v16, s[8:11], s4 offen offset:0 sc1
    s_add_u32 s4, s35, 319488
    buffer_load_dword v223, v16, s[8:11], s4 offen offset:0 sc1
    s_waitcnt vmcnt(0)
    v_max3_u32 v6, v184, v185, v186
    v_max3_u32 v6, v6, v187, v188
    v_max3_u32 v6, v6, v189, v190
    v_max3_u32 v6, v6, v191, v192
    v_max3_u32 v6, v6, v193, v194
    v_max3_u32 v6, v6, v195, v196
    v_max3_u32 v6, v6, v197, v198
    v_max3_u32 v6, v6, v199, v200
    v_max3_u32 v6, v6, v201, v202
    v_max3_u32 v6, v6, v203, v204
    v_max3_u32 v6, v6, v205, v206
    v_max3_u32 v6, v6, v207, v208
    v_max3_u32 v6, v6, v209, v210
    v_max3_u32 v6, v6, v211, v212
    v_max3_u32 v6, v6, v213, v214
    v_max3_u32 v6, v6, v215, v216
    v_max3_u32 v6, v6, v217, v218
    v_max3_u32 v6, v6, v219, v220
    v_max3_u32 v6, v6, v221, v222
    v_max_u32 v6, v6, v223
    v_cmp_eq_u32 vcc, -1, v6
    s_cbranch_vccz X3p_o
    s_sleep 1
    s_add_u32 s31, s31, 1
    s_cmp_lt_u32 s31, s30
    s_cbranch_scc1 X3p_l
    s_mov_b32 s30, 1
X3p_o:
    v_lshlrev_b32 v160, 16, v184
    v_and_b32 v161, 0xffff0000, v184
    v_lshlrev_b32 v162, 16, v186
    v_and_b32 v163, 0xffff0000, v186
    v_lshlrev_b32 v164, 16, v188
    v_and_b32 v165, 0xffff0000, v188
    v_lshlrev_b32 v166, 16, v190
    v_and_b32 v167, 0xffff0000, v190
    v_lshlrev_b32 v168, 16, v192
    v_and_b32 v169, 0xffff0000, v192
    v_lshlrev_b32 v6, 16, v185
    v_and_b32 v7, 0xffff0000, v185
    v_pk_add_f32 v[160:161], v[160:161], v[6:7]
    v_lshlrev_b32 v6, 16, v187
    v_and_b32 v7, 0xffff0000, v187
    v_pk_add_f32 v[162:163], v[162:163], v[6:7]
    v_lshlrev_b32 v6, 16, v189
    v_and_b32 v7, 0xffff0000, v189
    v_pk_add_f32 v[164:165], v[164:165], v[6:7]
    v_lshlrev_b32 v6, 16, v191
    v_and_b32 v7, 0xffff0000, v191
    v_pk_add_f32 v[166:167], v[166:167], v[6:7]
    v_lshlrev_b32 v6, 16, v193
    v_and_b32 v7, 0xffff0000, v193
    v_pk_add_f32 v[168:169], v[168:169], v[6:7]
    v_lshlrev_b32 v6, 16, v194
    v_and_b32 v7, 0xffff0000, v194
    v_pk_add_f32 v[160:161], v[160:161], v[6:7]
    v_lshlrev_b32 v6, 16, v196
    v_and_b32 v7, 0xffff0000, v196
    v_pk_add_f32 v[162:163], v[162:163], v[6:7]
    v_lshlrev_b32 v6, 16, v198
    v_and_b32 v7, 0xffff0000, v198
    v_pk_add_f32 v[164:165], v[164:165], v[6:7]
    v_lshlrev_b32 v6, 16, v200
    v_and_b32 v7, 0xffff0000, v200
    v_pk_add_f32 v[166:167], v[166:167], v[6:7]
    v_lshlrev_b32 v6, 16, v202
    v_and_b32 v7, 0xffff0000, v202
    v_pk_add_f32 v[168:169], v[168:169], v[6:7]
    v_lshlrev_b32 v6, 16, v195
    v_and_b32 v7, 0xffff0000, v195
    v_pk_add_f32 v[160:161], v[160:161], v[6:7]
    v_lshlrev_b32 v6, 16, v197
    v_and_b32 v7, 0xffff0000, v197
    v_pk_add_f32 v[162:163], v[162:163], v[6:7]
    v_lshlrev_b32 v6, 16, v199
    v_and_b32 v7, 0xffff0000, v199
    v_pk_add_f32 v[164:165], v[164:165], v[6:7]
    v_lshlrev_b32 v6, 16, v201
    v_and_b32 v7, 0xffff0000, v201
    v_pk_add_f32 v[166:167], v[166:167], v[6:7]
    v_lshlrev_b32 v6, 16, v203
    v_and_b32 v7, 0xffff0000, v203
    v_pk_add_f32 v[168:169], v[168:169], v[6:7]
    v_lshlrev_b32 v6, 16, v204
    v_and_b32 v7, 0xffff0000, v204
    v_pk_add_f32 v[160:161], v[160:161], v[6:7]
    v_lshlrev_b32 v6, 16, v206
    v_and_b32 v7, 0xffff0000, v206
    v_pk_add_f32 v[162:163], v[162:163], v[6:7]
    v_lshlrev_b32 v6, 16, v208
    v_and_b32 v7, 0xffff0000, v208
    v_pk_add_f32 v[164:165], v[164:165], v[6:7]
    v_lshlrev_b32 v6, 16, v210
    v_and_b32 v7, 0xffff0000, v210
    v_pk_add_f32 v[166:167], v[166:167], v[6:7]
    v_lshlrev_b32 v6, 16, v212
    v_and_b32 v7, 0xffff0000, v212
    v_pk_add_f32 v[168:169], v[168:169], v[6:7]
    v_lshlrev_b32 v6, 16, v205
    v_and_b32 v7, 0xffff0000, v205
    v_pk_add_f32 v[160:161], v[160:161], v[6:7]
    v_lshlrev_b32 v6, 16, v207
    v_and_b32 v7, 0xffff0000, v207
    v_pk_add_f32 v[162:163], v[162:163], v[6:7]
    v_lshlrev_b32 v6, 16, v209
    v_and_b32 v7, 0xffff0000, v209
    v_pk_add_f32 v[164:165], v[164:165], v[6:7]
    v_lshlrev_b32 v6, 16, v211
    v_and_b32 v7, 0xffff0000, v211
    v_pk_add_f32 v[166:167], v[166:167], v[6:7]
    v_lshlrev_b32 v6, 16, v213
    v_and_b32 v7, 0xffff0000, v213
    v_pk_add_f32 v[168:169], v[168:169], v[6:7]
    v_lshlrev_b32 v6, 16, v214
    v_and_b32 v7, 0xffff0000, v214
    v_pk_add_f32 v[160:161], v[160:161], v[6:7]
    v_lshlrev_b32 v6, 16, v216
    v_and_b32 v7, 0xffff0000, v216
    v_pk_add_f32 v[162:163], v[162:163], v[6:7]
    v_lshlrev_b32 v6, 16, v218
    v_and_b32 v7, 0xffff0000, v218
    v_pk_add_f32 v[164:165], v[164:165], v[6:7]
    v_lshlrev_b32 v6, 16, v220
    v_and_b32 v7, 0xffff0000, v220
    v_pk_add_f32 v[166:167], v[166:167], v[6:7]
    v_lshlrev_b32 v6, 16, v222
    v_and_b32 v7, 0xffff0000, v222
    v_pk_add_f32 v[168:169], v[168:169], v[6:7]
    v_lshlrev_b32 v6, 16, v215
    v_and_b32 v7, 0xffff0000, v215
    v_pk_add_f32 v[160:161], v[160:161], v[6:7]
    v_lshlrev_b32 v6, 16, v217
    v_and_b32 v7, 0xffff0000, v217
    v_pk_add_f32 v[162:163], v[162:163], v[6:7]
    v_lshlrev_b32 v6, 16, v219
    v_and_b32 v7, 0xffff0000, v219
    v_pk_add_f32 v[164:165], v[164:165], v[6:7]
    v_lshlrev_b32 v6, 16, v221
    v_and_b32 v7, 0xffff0000, v221
    v_pk_add_f32 v[166:167], v[166:167], v[6:7]
    v_lshlrev_b32 v6, 16, v223
    v_and_b32 v7, 0xffff0000, v223
    v_pk_add_f32 v[168:169], v[168:169], v[6:7]
    v_cvt_pk_bf16_f32 v161, v160, v161
    v_lshlrev_b32 v160, 16, v161
    v_and_b32 v161, 0xffff0000, v161
    v_mul_f32 v160, v160, v146
    v_mul_f32 v161, v161, v147
    v_cvt_pk_bf16_f32 v161, v160, v161
    v_lshlrev_b32 v160, 16, v161
    v_and_b32 v161, 0xffff0000, v161
    v_lshlrev_b32 v6, 16, v140
    v_and_b32 v7, 0xffff0000, v140
    v_add_f32 v160, v160, v6
    v_add_f32 v161, v161, v7
    v_cvt_pk_bf16_f32 v140, v160, v161
    v_cvt_pk_bf16_f32 v163, v162, v163
    v_lshlrev_b32 v162, 16, v163
    v_and_b32 v163, 0xffff0000, v163
    v_mul_f32 v162, v162, v148
    v_mul_f32 v163, v163, v149
    v_cvt_pk_bf16_f32 v163, v162, v163
    v_lshlrev_b32 v162, 16, v163
    v_and_b32 v163, 0xffff0000, v163
    v_lshlrev_b32 v6, 16, v141
    v_and_b32 v7, 0xffff0000, v141
    v_add_f32 v162, v162, v6
    v_add_f32 v163, v163, v7
    v_cvt_pk_bf16_f32 v141, v162, v163
    v_cvt_pk_bf16_f32 v165, v164, v165
    v_lshlrev_b32 v164, 16, v165
    v_and_b32 v165, 0xffff0000, v165
    v_mul_f32 v164, v164, v150
    v_mul_f32 v165, v165, v151
    v_cvt_pk_bf16_f32 v165, v164, v165
    v_lshlrev_b32 v164, 16, v165
    v_and_b32 v165, 0xffff0000, v165
    v_lshlrev_b32 v6, 16, v142
    v_and_b32 v7, 0xffff0000, v142
    v_add_f32 v164, v164, v6
    v_add_f32 v165, v165, v7
    v_cvt_pk_bf16_f32 v142, v164, v165
    v_cvt_pk_bf16_f32 v167, v166, v167
    v_lshlrev_b32 v166, 16, v167
    v_and_b32 v167, 0xffff0000, v167
    v_mul_f32 v166, v166, v152
    v_mul_f32 v167, v167, v153
    v_cvt_pk_bf16_f32 v167, v166, v167
    v_lshlrev_b32 v166, 16, v167
    v_and_b32 v167, 0xffff0000, v167
    v_lshlrev_b32 v6, 16, v143
    v_and_b32 v7, 0xffff0000, v143
    v_add_f32 v166, v166, v6
    v_add_f32 v167, v167, v7
    v_cvt_pk_bf16_f32 v143, v166, v167
    v_cvt_pk_bf16_f32 v169, v168, v169
    v_lshlrev_b32 v168, 16, v169
    v_and_b32 v169, 0xffff0000, v169
    v_mul_f32 v168, v168, v154
    v_mul_f32 v169, v169, v155
    v_cvt_pk_bf16_f32 v169, v168, v169
    v_lshlrev_b32 v168, 16, v169
    v_and_b32 v169, 0xffff0000, v169
    v_lshlrev_b32 v6, 16, v144
    v_and_b32 v7, 0xffff0000, v144
    v_add_f32 v168, v168, v6
    v_add_f32 v169, v169, v7
    v_cvt_pk_bf16_f32 v144, v168, v169
    s_add_u32 s4, s24, 56623104
    buffer_store_dword v140, v3, s[8:11], s4 offen offset:0 sc1
    buffer_store_dword v141, v3, s[8:11], s4 offen offset:256 sc1
    buffer_store_dword v142, v3, s[8:11], s4 offen offset:512 sc1
    buffer_store_dword v143, v3, s[8:11], s4 offen offset:768 sc1
    buffer_store_dword v144, v3, s[8:11], s4 offen offset:1024 sc1
    v_lshlrev_b32 v160, 16, v140
    v_and_b32 v161, 0xffff0000, v140
    v_lshlrev_b32 v162, 16, v141
    v_and_b32 v163, 0xffff0000, v141
    v_lshlrev_b32 v164, 16, v142
    v_and_b32 v165, 0xffff0000, v142
    v_lshlrev_b32 v166, 16, v143
    v_and_b32 v167, 0xffff0000, v143
    v_lshlrev_b32 v168, 16, v144
    v_and_b32 v169, 0xffff0000, v144
    v_add_f32 v6, v160, v161
    v_add_f32 v6, v6, v162
    v_add_f32 v6, v6, v163
    v_add_f32 v6, v6, v164
    v_add_f32 v6, v6, v165
    v_add_f32 v6, v6, v166
    v_add_f32 v6, v6, v167
    v_add_f32 v6, v6, v168
    v_add_f32 v6, v6, v169
    s_nop 1
    v_add_f32 v6, v6, v6 row_ror:8 row_mask:0xf bank_mask:0xf
    s_nop 1
    v_add_f32 v6, v6, v6 row_ror:4 row_mask:0xf bank_mask:0xf
    s_nop 1
    v_add_f32 v6, v6, v6 row_ror:2 row_mask:0xf bank_mask:0xf
    s_nop 1
    v_add_f32 v6, v6, v6 row_ror:1 row_mask:0xf bank_mask:0xf
    v_mov_b32 v7, v6
    s_nop 1
    v_permlane16_swap_b32 v6, v7
    v_add_f32 v6, v6, v7
    v_mov_b32 v7, v6
    s_nop 1
    v_permlane32_swap_b32 v6, v7
    v_add_f32 v6, v6, v7
    v_mul_f32 v6, 0x3acccccd, v6
    v_sub_f32 v7, v160, v6
    v_mul_f32 v8, v7, v7
    v_sub_f32 v7, v161, v6
    v_fmac_f32 v8, v7, v7
    v_sub_f32 v7, v162, v6
    v_fmac_f32 v8, v7, v7
    v_sub_f32 v7, v163, v6
    v_fmac_f32 v8, v7, v7
    v_sub_f32 v7, v164, v6
    v_fmac_f32 v8, v7, v7
    v_sub_f32 v7, v165, v6
    v_fmac_f32 v8, v7, v7
    v_sub_f32 v7, v166, v6
    v_fmac_f32 v8, v7, v7
    v_sub_f32 v7, v167, v6
    v_fmac_f32 v8, v7, v7
    v_sub_f32 v7, v168, v6
    v_fmac_f32 v8, v7, v7
    v_sub_f32 v7, v169, v6
    v_fmac_f32 v8, v7, v7
    s_nop 1
    v_add_f32 v8, v8, v8 row_ror:8 row_mask:0xf bank_mask:0xf
    s_nop 1
    v_add_f32 v8, v8, v8 row_ror:4 row_mask:0xf bank_mask:0xf
    s_nop 1
    v_add_f32 v8, v8, v8 row_ror:2 row_mask:0xf bank_mask:0xf
    s_nop 1
    v_add_f32 v8, v8, v8 row_ror:1 row_mask:0xf bank_mask:0xf
    v_mov_b32 v7, v8
    s_nop 1
    v_permlane16_swap_b32 v8, v7
    v_add_f32 v8, v8, v7
    v_mov_b32 v7, v8
    s_nop 1
    v_permlane32_swap_b32 v8, v7
    v_add_f32 v8, v8, v7
    v_mul_f32 v8, 0x3acccccd, v8
    v_cvt_pk_bf16_f32 v8, v8, v8
    v_and_b32 v8, 0xffff0000, v8
    v_add_f32 v8, 0x3727c5ac, v8
    v_cvt_pk_bf16_f32 v8, v8, v8
    v_and_b32 v8, 0xffff0000, v8
    v_sqrt_f32 v8, v8
    s_nop 0
    v_cvt_pk_bf16_f32 v8, v8, v8
    v_and_b32 v8, 0xffff0000, v8
    v_rcp_f32 v8, v8
    v_cvt_pk_bf16_f32 v6, v6, v6
    v_and_b32 v6, 0xffff0000, v6
    v_sub_f32 v160, v160, v6
    v_sub_f32 v161, v161, v6
    v_cvt_pk_bf16_f32 v161, v160, v161
    v_lshlrev_b32 v160, 16, v161
    v_and_b32 v161, 0xffff0000, v161
    v_mul_f32 v160, v160, v8
    v_mul_f32 v161, v161, v8
    v_cvt_pk_bf16_f32 v161, v160, v161
    v_lshlrev_b32 v160, 16, v161
    v_and_b32 v161, 0xffff0000, v161
    v_sub_f32 v162, v162, v6
    v_sub_f32 v163, v163, v6
    v_cvt_pk_bf16_f32 v163, v162, v163
    v_lshlrev_b32 v162, 16, v163
    v_and_b32 v163, 0xffff0000, v163
    v_mul_f32 v162, v162, v8
    v_mul_f32 v163, v163, v8
    v_cvt_pk_bf16_f32 v163, v162, v163
    v_lshlrev_b32 v162, 16, v163
    v_and_b32 v163, 0xffff0000, v163
    v_sub_f32 v164, v164, v6
    v_sub_f32 v165, v165, v6
    v_cvt_pk_bf16_f32 v165, v164, v165
    v_lshlrev_b32 v164, 16, v165
    v_and_b32 v165, 0xffff0000, v165
    v_mul_f32 v164, v164, v8
    v_mul_f32 v165, v165, v8
    v_cvt_pk_bf16_f32 v165, v164, v165
    v_lshlrev_b32 v164, 16, v165
    v_and_b32 v165, 0xffff0000, v165
    v_sub_f32 v166, v166, v6
    v_sub_f32 v167, v167, v6
    v_cvt_pk_bf16_f32 v167, v166, v167
    v_lshlrev_b32 v166, 16, v167
    v_and_b32 v167, 0xffff0000, v167
    v_mul_f32 v166, v166, v8
    v_mul_f32 v167, v167, v8
    v_cvt_pk_bf16_f32 v167, v166, v167
    v_lshlrev_b32 v166, 16, v167
    v_and_b32 v167, 0xffff0000, v167
    v_sub_f32 v168, v168, v6
    v_sub_f32 v169, v169, v6
    v_cvt_pk_bf16_f32 v169, v168, v169
    v_lshlrev_b32 v168, 16, v169
    v_and_b32 v169, 0xffff0000, v169
    v_mul_f32 v168, v168, v8
    v_mul_f32 v169, v169, v8
    v_cvt_pk_bf16_f32 v169, v168, v169
    v_lshlrev_b32 v168, 16, v169
    v_and_b32 v169, 0xffff0000, v169
    v_mov_b32 v9, 0
    v_mul_f32 v160, v160, v110
    v_mul_f32 v161, v161, v111
    v_cvt_pk_bf16_f32 v161, v160, v161
    v_lshlrev_b32 v160, 16, v161
    v_and_b32 v161, 0xffff0000, v161
    v_add_f32 v160, v160, v100
    v_add_f32 v161, v161, v101
    v_cvt_pk_bf16_f32 v170, v160, v161
    buffer_store_dword v170, v3, s[8:11], s25 offen offset:0 sc1
    v_lshlrev_b32 v160, 16, v170
    v_and_b32 v161, 0xffff0000, v170
    v_fmac_f32 v9, v160, v130
    v_fmac_f32 v9, v161, v131
    v_mul_f32 v160, v160, v120
    v_mul_f32 v161, v161, v121
    v_cvt_pk_bf16_f32 v161, v160, v161
    v_lshlrev_b32 v160, 16, v161
    v_and_b32 v161, 0xffff0000, v161
    v_lshlrev_b32 v6, 16, v140
    v_and_b32 v7, 0xffff0000, v140
    v_add_f32 v160, v160, v6
    v_add_f32 v161, v161, v7
    v_cvt_pk_bf16_f32 v175, v160, v161
    buffer_store_dword v175, v3, s[16:19], s24 offen offset:0 sc1
    v_mul_f32 v162, v162, v112
    v_mul_f32 v163, v163, v113
    v_cvt_pk_bf16_f32 v163, v162, v163
    v_lshlrev_b32 v162, 16, v163
    v_and_b32 v163, 0xffff0000, v163
    v_add_f32 v162, v162, v102
    v_add_f32 v163, v163, v103
    v_cvt_pk_bf16_f32 v171, v162, v163
    buffer_store_dword v171, v3, s[8:11], s25 offen offset:256 sc1
    v_lshlrev_b32 v162, 16, v171
    v_and_b32 v163, 0xffff0000, v171
    v_fmac_f32 v9, v162, v132
    v_fmac_f32 v9, v163, v133
    v_mul_f32 v162, v162, v122
    v_mul_f32 v163, v163, v123
    v_cvt_pk_bf16_f32 v163, v162, v163
    v_lshlrev_b32 v162, 16, v163
    v_and_b32 v163, 0xffff0000, v163
    v_lshlrev_b32 v6, 16, v141
    v_and_b32 v7, 0xffff0000, v141
    v_add_f32 v162, v162, v6
    v_add_f32 v163, v163, v7
    v_cvt_pk_bf16_f32 v176, v162, v163
    buffer_store_dword v176, v3, s[16:19], s24 offen offset:256 sc1
    v_mul_f32 v164, v164, v114
    v_mul_f32 v165, v165, v115
    v_cvt_pk_bf16_f32 v165, v164, v165
    v_lshlrev_b32 v164, 16, v165
    v_and_b32 v165, 0xffff0000, v165
    v_add_f32 v164, v164, v104
    v_add_f32 v165, v165, v105
    v_cvt_pk_bf16_f32 v172, v164, v165
    buffer_store_dword v172, v3, s[8:11], s25 offen offset:512 sc1
    v_lshlrev_b32 v164, 16, v172
    v_and_b32 v165, 0xffff0000, v172
    v_fmac_f32 v9, v164, v134
    v_fmac_f32 v9, v165, v135
    v_mul_f32 v164, v164, v124
    v_mul_f32 v165, v165, v125
    v_cvt_pk_bf16_f32 v165, v164, v165
    v_lshlrev_b32 v164, 16, v165
    v_and_b32 v165, 0xffff0000, v165
    v_lshlrev_b32 v6, 16, v142
    v_and_b32 v7, 0xffff0000, v142
    v_add_f32 v164, v164, v6
    v_add_f32 v165, v165, v7
    v_cvt_pk_bf16_f32 v177, v164, v165
    buffer_store_dword v177, v3, s[16:19], s24 offen offset:512 sc1
    v_mul_f32 v166, v166, v116
    v_mul_f32 v167, v167, v117
    v_cvt_pk_bf16_f32 v167, v166, v167
    v_lshlrev_b32 v166, 16, v167
    v_and_b32 v167, 0xffff0000, v167
    v_add_f32 v166, v166, v106
    v_add_f32 v167, v167, v107
    v_cvt_pk_bf16_f32 v173, v166, v167
    buffer_store_dword v173, v3, s[8:11], s25 offen offset:768 sc1
    v_lshlrev_b32 v166, 16, v173
    v_and_b32 v167, 0xffff0000, v173
    v_fmac_f32 v9, v166, v136
    v_fmac_f32 v9, v167, v137
    v_mul_f32 v166, v166, v126
    v_mul_f32 v167, v167, v127
    v_cvt_pk_bf16_f32 v167, v166, v167
    v_lshlrev_b32 v166, 16, v167
    v_and_b32 v167, 0xffff0000, v167
    v_lshlrev_b32 v6, 16, v143
    v_and_b32 v7, 0xffff0000, v143
    v_add_f32 v166, v166, v6
    v_add_f32 v167, v167, v7
    v_cvt_pk_bf16_f32 v178, v166, v167
    buffer_store_dword v178, v3, s[16:19], s24 offen offset:768 sc1
    v_mul_f32 v168, v168, v118
    v_mul_f32 v169, v169, v119
    v_cvt_pk_bf16_f32 v169, v168, v169
    v_lshlrev_b32 v168, 16, v169
    v_and_b32 v169, 0xffff0000, v169
    v_add_f32 v168, v168, v108
    v_add_f32 v169, v169, v109
    v_cvt_pk_bf16_f32 v174, v168, v169
    buffer_store_dword v174, v3, s[8:11], s25 offen offset:1024 sc1
    v_lshlrev_b32 v168, 16, v174
    v_and_b32 v169, 0xffff0000, v174
    v_fmac_f32 v9, v168, v138
    v_fmac_f32 v9, v169, v139
    v_mul_f32 v168, v168, v128
    v_mul_f32 v169, v169, v129
    v_cvt_pk_bf16_f32 v169, v168, v169
    v_lshlrev_b32 v168, 16, v169
    v_and_b32 v169, 0xffff0000, v169
    v_lshlrev_b32 v6, 16, v144
    v_and_b32 v7, 0xffff0000, v144
    v_add_f32 v168, v168, v6
    v_add_f32 v169, v169, v7
    v_cvt_pk_bf16_f32 v179, v168, v169
    buffer_store_dword v179, v3, s[16:19], s24 offen offset:1024 sc1
    v_add_f32 v9, v9, v9 row_ror:8 row_mask:0xf bank_mask:0xf
    s_nop 1
    v_add_f32 v9, v9, v9 row_ror:4 row_mask:0xf bank_mask:0xf
    s_nop 1
    v_add_f32 v9, v9, v9 row_ror:2 row_mask:0xf bank_mask:0xf
    s_nop 1
    v_add_f32 v9, v9, v9 row_ror:1 row_mask:0xf bank_mask:0xf
    v_mov_b32 v6, v9
    s_nop 1
    v_permlane16_swap_b32 v9, v6
    v_add_f32 v9, v9, v6
    v_mov_b32 v6, v9
    s_nop 1
    v_permlane32_swap_b32 v9, v6
    v_add_f32 v9, v9, v6
    v_cvt_pk_bf16_f32 v9, v9, v9
    v_and_b32 v9, 0xffff0000, v9
    s_waitcnt vmcnt(0)
    s_mov_b64 exec, 1
    buffer_store_dword v9, v3, s[8:11], s42 offen sc1
    s_mov_b64 exec, -1
    s_add_u32 s21, s21, 2
    s_cmp_ge_u32 s21, 60
    s_cbranch_scc1 X_join
    s_lshr_b32 s29, s21, 1
    s_cmp_lt_u32 s29, 2
    s_cbranch_scc1 X3b_e
    s_cmp_lt_u32 s29, 10
    s_cbranch_scc0 X3b_a
    s_mov_b32 exec_hi, 0x0fffffff
    s_add_u32 m0, s99, 0
    s_nop 0
    buffer_load_dwordx4 v0, s[84:87], s98 offen lds
    s_add_u32 m0, s99, 15360
    s_nop 0
    buffer_load_dwordx4 v0, s[88:91], s98 offen lds
    s_add_u32 s98, s98, 30720
    s_add_u32 s99, s99, 960
    s_add_u32 m0, s99, 0
    s_nop 0
    buffer_load_dwordx4 v0, s[84:87], s98 offen lds
    s_add_u32 m0, s99, 15360
    s_nop 0
    buffer_load_dwordx4 v0, s[88:91], s98 offen lds
    s_add_u32 s98, s98, 30720
    s_add_u32 s99, s99, 960
    s_mov_b64 exec, -1
    buffer_load_dwordx4 v[96:99], v2, s[92:95], s23 offen offset:0
    buffer_load_dwordx4 v[96:99], v2, s[92:95], s23 offen offset:1024
    s_add_u32 s23, s23, 2048
X3b_a:
    s_cmp_eq_u32 s29, 11
    s_cbranch_scc0 X3b_b
    s_waitcnt vmcnt(0)
    v_lshrrev_b32 v12, 4, v1
    v_lshlrev_b32 v12, 3, v12
    v_bfe_u32 v13, v1, 2, 2
    v_add_u32 v12, v12, v13
    v_mul_u32_u24 v12, 96, v12
    v_and_b32 v13, 3, v1
    v_lshlrev_b32 v13, 3, v13
    v_add_u32 v12, v12, v13
    s_mul_i32 s4, s3, 30720
    s_add_u32 s4, s4, 40960
    v_add_u32 v12, s4, v12
    ds_read_b64_tr_b16 a[0:1], v12 offset:0
    ds_read_b64_tr_b16 a[2:3], v12 offset:384
    ds_read_b64_tr_b16 a[4:5], v12 offset:3072
    ds_read_b64_tr_b16 a[6:7], v12 offset:3456
    ds_read_b64_tr_b16 a[8:9], v12 offset:6144
    ds_read_b64_tr_b16 a[10:11], v12 offset:6528
    ds_read_b64_tr_b16 a[12:13], v12 offset:9216
    ds_read_b64_tr_b16 a[14:15], v12 offset:9600
    ds_read_b64_tr_b16 a[16:17], v12 offset:12288
    ds_read_b64_tr_b16 a[18:19], v12 offset:12672
    ds_read_b64_tr_b16 a[20:21], v12 offset:15360
    ds_read_b64_tr_b16 a[22:23], v12 offset:15744
    ds_read_b64_tr_b16 a[24:25], v12 offset:18432
    ds_read_b64_tr_b16 a[26:27], v12 offset:18816
    ds_read_b64_tr_b16 a[28:29], v12 offset:21504
    ds_read_b64_tr_b16 a[30:31], v12 offset:21888
    ds_read_b64_tr_b16 a[32:33], v12 offset:24576
    ds_read_b64_tr_b16 a[34:35], v12 offset:24960
    ds_read_b64_tr_b16 a[36:37], v12 offset:27648
    ds_read_b64_tr_b16 a[38:39], v12 offset:28032
    ds_read_b64_tr_b16 a[40:41], v12 offset:32
    ds_read_b64_tr_b16 a[42:43], v12 offset:416
    ds_read_b64_tr_b16 a[44:45], v12 offset:3104
    ds_read_b64_tr_b16 a[46:47], v12 offset:3488
    ds_read_b64_tr_b16 a[48:49], v12 offset:6176
    ds_read_b64_tr_b16 a[50:51], v12 offset:6560
    ds_read_b64_tr_b16 a[52:53], v12 offset:9248
    ds_read_b64_tr_b16 a[54:55], v12 offset:9632
    ds_read_b64_tr_b16 a[56:57], v12 offset:12320
    ds_read_b64_tr_b16 a[58:59], v12 offset:12704
    ds_read_b64_tr_b16 a[60:61], v12 offset:15392
    ds_read_b64_tr_b16 a[62:63], v12 offset:15776
    ds_read_b64_tr_b16 a[64:65], v12 offset:18464
    ds_read_b64_tr_b16 a[66:67], v12 offset:18848
    ds_read_b64_tr_b16 a[68:69], v12 offset:21536
    ds_read_b64_tr_b16 a[70:71], v12 offset:21920
    ds_read_b64_tr_b16 a[72:73], v12 offset:24608
    ds_read_b64_tr_b16 a[74:75], v12 offset:24992
    ds_read_b64_tr_b16 a[76:77], v12 offset:27680
    ds_read_b64_tr_b16 a[78:79], v12 offset:28064
    ds_read_b64_tr_b16 a[80:81], v12 offset:64
    ds_read_b64_tr_b16 a[82:83], v12 offset:448
    ds_read_b64_tr_b16 a[84:85], v12 offset:3136
    ds_read_b64_tr_b16 a[86:87], v12 offset:3520
    ds_read_b64_tr_b16 a[88:89], v12 offset:6208
    ds_read_b64_tr_b16 a[90:91], v12 offset:6592
    ds_read_b64_tr_b16 a[92:93], v12 offset:9280
    ds_read_b64_tr_b16 a[94:95], v12 offset:9664
    ds_read_b64_tr_b16 a[96:97], v12 offset:12352
    ds_read_b64_tr_b16 a[98:99], v12 offset:12736
    ds_read_b64_tr_b16 a[100:101], v12 offset:15424
    ds_read_b64_tr_b16 a[102:103], v12 offset:15808
    ds_read_b64_tr_b16 a[104:105], v12 offset:18496
    ds_read_b64_tr_b16 a[106:107], v12 offset:18880
    ds_read_b64_tr_b16 a[108:109], v12 offset:21568
    ds_read_b64_tr_b16 a[110:111], v12 offset:21952
    ds_read_b64_tr_b16 a[112:113], v12 offset:24640
    ds_read_b64_tr_b16 a[114:115], v12 offset:25024
    ds_read_b64_tr_b16 a[116:117], v12 offset:27712
    ds_read_b64_tr_b16 a[118:119], v12 offset:28096
    s_waitcnt lgkmcnt(0)
    s_cmp_ge_u32 s20, 20
    s_cbranch_scc1 X3b_b
    v_lshrrev_b32 v4, 2, v1
    v_mul_u32_u24 v4, 1280, v4
    v_and_b32 v5, 3, v1
    v_lshl_add_u32 v4, v5, 4, v4
    s_mul_i32 s4, s3, 491520
    s_lshl_b32 s5, s20, 6
    s_add_u32 s4, s4, s5
    s_mul_i32 s5, s3, 30720
    s_add_u32 m0, s5, 40960
    s_nop 0
    buffer_load_dwordx4 v4, s[92:95], s4 offen lds
    s_add_u32 s4, s4, 20480
    s_add_u32 m0, s5, 41984
    s_nop 0
    buffer_load_dwordx4 v4, s[92:95], s4 offen lds
    s_add_u32 s4, s4, 20480
    s_add_u32 m0, s5, 43008
    s_nop 0
    buffer_load_dwordx4 v4, s[92:95], s4 offen lds
    s_add_u32 s4, s4, 20480
    s_add_u32 m0, s5, 44032
    s_nop 0
    buffer_load_dwordx4 v4, s[92:95], s4 offen lds
    s_add_u32 s4, s4, 20480
    s_add_u32 m0, s5, 45056
    s_nop 0
    buffer_load_dwordx4 v4, s[92:95], s4 offen lds
    s_add_u32 s4, s4, 20480
    s_add_u32 m0, s5, 46080
    s_nop 0
    buffer_load_dwordx4 v4, s[92:95], s4 offen lds
    s_add_u32 s4, s4, 20480
    s_add_u32 m0, s5, 47104
    s_nop 0
    buffer_load_dwordx4 v4, s[92:95], s4 offen lds
    s_add_u32 s4, s4, 20480
    s_add_u32 m0, s5, 48128
    s_nop 0
    buffer_load_dwordx4 v4, s[92:95], s4 offen lds
    s_add_u32 s4, s4, 20480
    s_add_u32 m0, s5, 49152
    s_nop 0
    buffer_load_dwordx4 v4, s[92:95], s4 offen lds
    s_add_u32 s4, s4, 20480
    s_add_u32 m0, s5, 50176
    s_nop 0
    buffer_load_dwordx4 v4, s[92:95], s4 offen lds
    s_add_u32 s4, s4, 20480
    s_add_u32 m0, s5, 51200
    s_nop 0
    buffer_load_dwordx4 v4, s[92:95], s4 offen lds
    s_add_u32 s4, s4, 20480
    s_add_u32 m0, s5, 52224
    s_nop 0
    buffer_load_dwordx4 v4, s[92:95], s4 offen lds
    s_add_u32 s4, s4, 20480
    s_add_u32 m0, s5, 53248
    s_nop 0
    buffer_load_dwordx4 v4, s[92:95], s4 offen lds
    s_add_u32 s4, s4, 20480
    s_add_u32 m0, s5, 54272
    s_nop 0
    buffer_load_dwordx4 v4, s[92:95], s4 offen lds
    s_add_u32 s4, s4, 20480
    s_add_u32 m0, s5, 55296
    s_nop 0
    buffer_load_dwordx4 v4, s[92:95], s4 offen lds
    s_add_u32 s4, s4, 20480
    s_add_u32 m0, s5, 56320
    s_nop 0
    buffer_load_dwordx4 v4, s[92:95], s4 offen lds
    s_add_u32 s4, s4, 20480
    s_add_u32 m0, s5, 57344
    s_nop 0
    buffer_load_dwordx4 v4, s[92:95], s4 offen lds
    s_add_u32 s4, s4, 20480
    s_add_u32 m0, s5, 58368
    s_nop 0
    buffer_load_dwordx4 v4, s[92:95], s4 offen lds
    s_add_u32 s4, s4, 20480
    s_add_u32 m0, s5, 59392
    s_nop 0
    buffer_load_dwordx4 v4, s[92:95], s4 offen lds
    s_add_u32 s4, s4, 20480
    s_add_u32 m0, s5, 60416
    s_nop 0
    buffer_load_dwordx4 v4, s[92:95], s4 offen lds
    s_add_u32 s4, s4, 20480
    s_add_u32 m0, s5, 61440
    s_nop 0
    buffer_load_dwordx4 v4, s[92:95], s4 offen lds
    s_add_u32 s4, s4, 20480
    s_add_u32 m0, s5, 62464
    s_nop 0
    buffer_load_dwordx4 v4, s[92:95], s4 offen lds
    s_add_u32 s4, s4, 20480
    s_add_u32 m0, s5, 63488
    s_nop 0
    buffer_load_dwordx4 v4, s[92:95], s4 offen lds
    s_add_u32 s4, s4, 20480
    s_add_u32 m0, s5, 64512
    s_nop 0
    buffer_load_dwordx4 v4, s[92:95], s4 offen lds
    s_add_u32 s4, s4, 20480
X3b_b:
    s_cmp_eq_u32 s29, 13
    s_cbranch_scc0 X3b_c
    s_waitcnt vmcnt(0)
    v_lshrrev_b32 v12, 4, v1
    v_lshlrev_b32 v12, 3, v12
    v_bfe_u32 v13, v1, 2, 2
    v_add_u32 v12, v12, v13
    v_mul_u32_u24 v12, 64, v12
    v_and_b32 v13, 3, v1
    v_lshlrev_b32 v13, 3, v13
    v_add_u32 v12, v12, v13
    s_mul_i32 s4, s3, 30720
    s_add_u32 s4, s4, 40960
    v_add_u32 v12, s4, v12
    ds_read_b64_tr_b16 a[120:121], v12 offset:0
    ds_read_b64_tr_b16 a[122:123], v12 offset:256
    ds_read_b64_tr_b16 a[124:125], v12 offset:2048
    ds_read_b64_tr_b16 a[126:127], v12 offset:2304
    ds_read_b64_tr_b16 a[128:129], v12 offset:4096
    ds_read_b64_tr_b16 a[130:131], v12 offset:4352
    ds_read_b64_tr_b16 a[132:133], v12 offset:6144
    ds_read_b64_tr_b16 a[134:135], v12 offset:6400
    ds_read_b64_tr_b16 a[136:137], v12 offset:8192
    ds_read_b64_tr_b16 a[138:139], v12 offset:8448
    ds_read_b64_tr_b16 a[140:141], v12 offset:10240
    ds_read_b64_tr_b16 a[142:143], v12 offset:10496
    ds_read_b64_tr_b16 a[144:145], v12 offset:12288
    ds_read_b64_tr_b16 a[146:147], v12 offset:12544
    ds_read_b64_tr_b16 a[148:149], v12 offset:14336
    ds_read_b64_tr_b16 a[150:151], v12 offset:14592
    ds_read_b64_tr_b16 a[152:153], v12 offset:16384
    ds_read_b64_tr_b16 a[154:155], v12 offset:16640
    ds_read_b64_tr_b16 a[156:157], v12 offset:18432
    ds_read_b64_tr_b16 a[158:159], v12 offset:18688
    ds_read_b64_tr_b16 a[160:161], v12 offset:20480
    ds_read_b64_tr_b16 a[162:163], v12 offset:20736
    ds_read_b64_tr_b16 a[164:165], v12 offset:22528
    ds_read_b64_tr_b16 a[166:167], v12 offset:22784
    ds_read_b64_tr_b16 a[168:169], v12 offset:32
    ds_read_b64_tr_b16 a[170:171], v12 offset:288
    ds_read_b64_tr_b16 a[172:173], v12 offset:2080
    ds_read_b64_tr_b16 a[174:175], v12 offset:2336
    ds_read_b64_tr_b16 a[176:177], v12 offset:4128
    ds_read_b64_tr_b16 a[178:179], v12 offset:4384
    ds_read_b64_tr_b16 a[180:181], v12 offset:6176
    ds_read_b64_tr_b16 a[182:183], v12 offset:6432
    ds_read_b64_tr_b16 a[184:185], v12 offset:8224
    ds_read_b64_tr_b16 a[186:187], v12 offset:8480
    ds_read_b64_tr_b16 a[188:189], v12 offset:10272
    ds_read_b64_tr_b16 a[190:191], v12 offset:10528
    ds_read_b64_tr_b16 a[192:193], v12 offset:12320
    ds_read_b64_tr_b16 a[194:195], v12 offset:12576
    ds_read_b64_tr_b16 a[196:197], v12 offset:14368
    ds_read_b64_tr_b16 a[198:199], v12 offset:14624
    ds_read_b64_tr_b16 a[200:201], v12 offset:16416
    ds_read_b64_tr_b16 a[202:203], v12 offset:16672
    ds_read_b64_tr_b16 a[204:205], v12 offset:18464
    ds_read_b64_tr_b16 a[206:207], v12 offset:18720
    ds_read_b64_tr_b16 a[208:209], v12 offset:20512
    ds_read_b64_tr_b16 a[210:211], v12 offset:20768
    ds_read_b64_tr_b16 a[212:213], v12 offset:22560
    ds_read_b64_tr_b16 a[214:215], v12 offset:22816
    s_waitcnt lgkmcnt(0)
X3b_c:
X3b_e:
    s_cmp_lg_u32 s28, 8
    s_cbranch_scc1 X3_loop
    s_cmp_lt_u32 s29, 3
    s_cbranch_scc1 X3_loop
    s_call_b64 s[100:101], XG_sub
    s_branch X3_loop
X_join:
    s_add_u32 s26, s22, 156160
    v_and_b32 v4, 7, v1
    v_mul_u32_u24 v4, 3072, v4
    v_lshrrev_b32 v5, 4, v1
    v_lshl_add_u32 v16, v5, 3, v4
    s_mul_i32 s4, s20, 96
    s_lshl_b32 s5, s3, 5
    s_add_u32 s4, s4, s5
    v_add_u32 v16, s4, v16
    v_lshlrev_b32 v18, 4, v5
    v_add_u32 v17, v18, v4
    s_mul_i32 s4, s3, 768
    v_add_u32 v17, s4, v17
    s_mul_i32 s4, s3, 6144
    v_add_u32 v19, s4, v2
    s_lshl_b32 s4, s3, 11
    v_add_u32 v20, s4, v2
    s_lshl_b32 s4, s3, 10
    v_add_u32 v21, s4, v2
    s_lshl_b32 s22, s20, 6
    s_and_b32 s4, s3, 1
    s_lshl_b32 s4, s4, 5
    s_add_u32 s22, s22, s4
    s_min_u32 s22, s22, 1248
    s_lshl_b32 s4, s22, 1
    s_add_u32 s4, s4, 12800
    buffer_load_dwordx4 v[22:25], v18, s[8:11], s4 offen sc1
    s_lshl_b32 s4, s20, 2
    s_add_u32 s4, s4, s3
    s_min_u32 s4, s4, 47
    s_lshl_b32 s4, s4, 10
    s_add_u32 s4, s4, 61898752
    buffer_load_dwordx4 v[112:115], v2, s[8:11], s4 offen sc1
    v_and_b32 v27, 7, v1
    v_lshlrev_b32 v27, 2, v27
    s_cmp_lg_u32 s28, 8
    s_cbranch_scc1 XE_b
XE_m:
    s_call_b64 s[100:101], XG_sub
    s_cmp_lt_u32 s43, 1920
    s_cbranch_scc1 XE_m
    v_writelane_b32 v26, s44, 0
    v_writelane_b32 v26, s45, 1
    v_writelane_b32 v26, s46, 2
    v_writelane_b32 v26, s47, 3
    v_writelane_b32 v26, s38, 4
    v_writelane_b32 v26, s39, 5
    v_writelane_b32 v26, s48, 6
    v_writelane_b32 v26, s49, 7
    s_mov_b64 exec, 0xff
    buffer_store_dword v26, v27, s[8:11], s26 offen sc1
    s_mov_b64 exec, -1
XE_b:
    s_mov_b32 s31, 0
XL_l:
    buffer_load_dword v26, v27, s[8:11], s26 offen sc1
    s_waitcnt vmcnt(0)
XL_c:
    v_cmp_gt_u32 vcc, 1, v26
    s_cbranch_vccz XL_o
    s_sleep 1
    s_add_u32 s31, s31, 1
    s_cmp_lt_u32 s31, s30
    s_cbranch_scc1 XL_l
    s_mov_b32 s30, 1
XL_o:
    s_mov_b32 s43, 1920
    v_readlane_b32 s44, v26, 0
    v_readlane_b32 s45, v26, 1
    v_readlane_b32 s46, v26, 2
    v_readlane_b32 s47, v26, 3
    v_readlane_b32 s38, v26, 4
    v_readlane_b32 s39, v26, 5
    v_readlane_b32 s48, v26, 6
    v_readlane_b32 s49, v26, 7
    s_mov_b32 s97, 1
    s_mov_b32 s23, 61898752
    s_call_b64 s[100:101], XM_sub
    s_mov_b32 s27, 0
    s_call_b64 s[100:101], XG_sub
    s_call_b64 s[100:101], XG_sub
    s_cmp_eq_u32 s27, 0
    s_cbranch_scc1 XE_st
    s_mov_b32 s23, 61923328
    s_call_b64 s[100:101], XM_sub
XE_st:
    s_cmp_ge_u32 s20, 20
    s_cbranch_scc1 XE_e
    s_cmp_ge_u32 s3, 2
    s_cbranch_scc1 XE_e
    s_mov_b32 exec_lo, 0x00ff00ff
    s_mov_b32 exec_hi, 0x00ff00ff
    buffer_store_dwordx2 v[28:29], v27, s[16:19], 0 offen sc1
    s_mov_b64 exec, -1
XE_e:
    s_branch R_done
XM_sub:
    s_barrier
    s_mov_b32 exec_lo, 0x01010101
    s_mov_b32 exec_hi, 0x01010101
    v_mov_b32 v26, s44
    s_lshl_b64 exec, exec, 1
    v_mov_b32 v26, s45
    s_lshl_b64 exec, exec, 1
    v_mov_b32 v26, s46
    s_lshl_b64 exec, exec, 1
    v_mov_b32 v26, s47
    s_lshl_b64 exec, exec, 1
    v_mov_b32 v26, s38
    s_lshl_b64 exec, exec, 1
    v_mov_b32 v26, s39
    s_lshl_b64 exec, exec, 1
    v_mov_b32 v26, s48
    s_lshl_b64 exec, exec, 1
    v_mov_b32 v26, s49
    s_mov_b64 exec, -1
    v_and_b32 v27, 0x7ff, v26
    v_sub_u32 v27, 0x7ff, v27
    v_mul_u32_u24 v27, 1280, v27
    v_add_u32 v30, v27, v18
    s_mul_i32 s5, s3, 320
    s_add_u32 s5, s5, 59244544
    s_mov_b32 s31, 0
XH_l:
    buffer_load_dwordx4 v[96:99], v30, s[8:11], s5 offen offset:0 sc1
    buffer_load_dwordx4 v[100:103], v30, s[8:11], s5 offen offset:64 sc1
    buffer_load_dwordx4 v[104:107], v30, s[8:11], s5 offen offset:128 sc1
    buffer_load_dwordx4 v[108:111], v30, s[8:11], s5 offen offset:192 sc1
    buffer_load_dwordx4 v[112:115], v30, s[8:11], s5 offen offset:256 sc1
    s_waitcnt vmcnt(0)
    v_max3_u32 v31, v96, v97, v98
    v_max3_u32 v31, v31, v99, v100
    v_max3_u32 v31, v31, v101, v102
    v_max3_u32 v31, v31, v103, v104
    v_max3_u32 v31, v31, v105, v106
    v_max3_u32 v31, v31, v107, v108
    v_max3_u32 v31, v31, v109, v110
    v_max3_u32 v31, v31, v111, v112
    v_max3_u32 v31, v31, v113, v114
    v_max_u32 v31, v31, v115
    v_cmp_eq_u32 vcc, -1, v31
    s_cbranch_vccz XH_o
    s_sleep 1
    s_add_u32 s31, s31, 1
    s_cmp_lt_u32 s31, s30
    s_cbranch_scc1 XH_l
    s_mov_b32 s30, 1
XH_o:
    v_mfma_f32_16x16x32_bf16 v[116:119], a[0:3], v[96:99], 0
    v_mfma_f32_16x16x32_bf16 v[120:123], a[20:23], v[96:99], 0
    v_mfma_f32_16x16x32_bf16 v[124:127], a[40:43], v[96:99], 0
    v_mfma_f32_16x16x32_bf16 v[128:131], a[60:63], v[96:99], 0
    v_mfma_f32_16x16x32_bf16 v[132:135], a[80:83], v[96:99], 0
    v_mfma_f32_16x16x32_bf16 v[136:139], a[100:103], v[96:99], 0
    v_mfma_f32_16x16x32_bf16 v[116:119], a[4:7], v[100:103], v[116:119]
    v_mfma_f32_16x16x32_bf16 v[120:123], a[24:27], v[100:103], v[120:123]
    v_mfma_f32_16x16x32_bf16 v[124:127], a[44:47], v[100:103], v[124:127]
    v_mfma_f32_16x16x32_bf16 v[128:131], a[64:67], v[100:103], v[128:131]
    v_mfma_f32_16x16x32_bf16 v[132:135], a[84:87], v[100:103], v[132:135]
    v_mfma_f32_16x16x32_bf16 v[136:139], a[104:107], v[100:103], v[136:139]
    v_mfma_f32_16x16x32_bf16 v[116:119], a[8:11], v[104:107], v[116:119]
    v_mfma_f32_16x16x32_bf16 v[120:123], a[28:31], v[104:107], v[120:123]
    v_mfma_f32_16x16x32_bf16 v[124:127], a[48:51], v[104:107], v[124:127]
    v_mfma_f32_16x16x32_bf16 v[128:131], a[68:71], v[104:107], v[128:131]
    v_mfma_f32_16x16x32_bf16 v[132:135], a[88:91], v[104:107], v[132:135]
    v_mfma_f32_16x16x32_bf16 v[136:139], a[108:111], v[104:107], v[136:139]
    v_mfma_f32_16x16x32_bf16 v[116:119], a[12:15], v[108:111], v[116:119]
    v_mfma_f32_16x16x32_bf16 v[120:123], a[32:35], v[108:111], v[120:123]
    v_mfma_f32_16x16x32_bf16 v[124:127], a[52:55], v[108:111], v[124:127]
    v_mfma_f32_16x16x32_bf16 v[128:131], a[72:75], v[108:111], v[128:131]
    v_mfma_f32_16x16x32_bf16 v[132:135], a[92:95], v[108:111], v[132:135]
    v_mfma_f32_16x16x32_bf16 v[136:139], a[112:115], v[108:111], v[136:139]
    v_mfma_f32_16x16x32_bf16 v[116:119], a[16:19], v[112:115], v[116:119]
    v_mfma_f32_16x16x32_bf16 v[120:123], a[36:39], v[112:115], v[120:123]
    v_mfma_f32_16x16x32_bf16 v[124:127], a[56:59], v[112:115], v[124:127]
    v_mfma_f32_16x16x32_bf16 v[128:131], a[76:79], v[112:115], v[128:131]
    v_mfma_f32_16x16x32_bf16 v[132:135], a[96:99], v[112:115], v[132:135]
    v_mfma_f32_16x16x32_bf16 v[136:139], a[116:119], v[112:115], v[136:139]
    ds_write_b128 v19, v[116:119] offset:0
    ds_write_b128 v19, v[120:123] offset:1024
    ds_write_b128 v19, v[124:127] offset:2048
    ds_write_b128 v19, v[128:131] offset:3072
    ds_write_b128 v19, v[132:135] offset:4096
    s_nop 2
    ds_write_b128 v19, v[136:139] offset:5120
    v_lshrrev_b32 v30, 1, v18
    v_add3_u32 v27, v27, v30, s22
    s_waitcnt lgkmcnt(0)
    s_barrier
    s_cmp_eq_u32 s3, 3
    s_cbranch_scc1 XM_ng
    ds_read_b128 v[96:99], v20 offset:0
    ds_read_b128 v[100:103], v20 offset:1024
    ds_read_b128 v[104:107], v20 offset:6144
    ds_read_b128 v[108:111], v20 offset:7168
    ds_read_b128 v[112:115], v20 offset:12288
    ds_read_b128 v[116:119], v20 offset:13312
    ds_read_b128 v[120:123], v20 offset:18432
    ds_read_b128 v[124:127], v20 offset:19456
    s_waitcnt lgkmcnt(4)
    v_pk_add_f32 v[96:97], v[96:97], v[104:105]
    v_pk_add_f32 v[98:99], v[98:99], v[106:107]
    v_pk_add_f32 v[100:101], v[100:101], v[108:109]
    v_pk_add_f32 v[102:103], v[102:103], v[110:111]
    s_waitcnt lgkmcnt(2)
    v_pk_add_f32 v[96:97], v[96:97], v[112:113]
    v_pk_add_f32 v[98:99], v[98:99], v[114:115]
    v_pk_add_f32 v[100:101], v[100:101], v[116:117]
    v_pk_add_f32 v[102:103], v[102:103], v[118:119]
    s_waitcnt lgkmcnt(0)
    v_pk_add_f32 v[96:97], v[96:97], v[120:121]
    v_pk_add_f32 v[98:99], v[98:99], v[122:123]
    v_pk_add_f32 v[100:101], v[100:101], v[124:125]
    v_pk_add_f32 v[102:103], v[102:103], v[126:127]
    v_cvt_pk_bf16_f32 v100, v96, v100
    v_lshlrev_b32 v96, 16, v100
    v_and_b32 v100, 0xffff0000, v100
    v_mul_f32 v108, 0xbfb8aa3b, v96
    v_exp_f32 v108, v108
    s_nop 0
    v_add_f32 v108, 1.0, v108
    v_rcp_f32 v104, v108
    v_cvt_pk_bf16_f32 v101, v97, v101
    v_lshlrev_b32 v97, 16, v101
    v_and_b32 v101, 0xffff0000, v101
    v_mul_f32 v109, 0xbfb8aa3b, v97
    v_exp_f32 v109, v109
    s_nop 0
    v_add_f32 v109, 1.0, v109
    v_rcp_f32 v105, v109
    v_cvt_pk_bf16_f32 v102, v98, v102
    v_lshlrev_b32 v98, 16, v102
    v_and_b32 v102, 0xffff0000, v102
    v_mul_f32 v110, 0xbfb8aa3b, v98
    v_exp_f32 v110, v110
    s_nop 0
    v_add_f32 v110, 1.0, v110
    v_rcp_f32 v106, v110
    v_cvt_pk_bf16_f32 v103, v99, v103
    v_lshlrev_b32 v99, 16, v103
    v_and_b32 v103, 0xffff0000, v103
    v_mul_f32 v111, 0xbfb8aa3b, v99
    v_exp_f32 v111, v111
    s_nop 0
    v_add_f32 v111, 1.0, v111
    v_rcp_f32 v107, v111
    v_mul_f32 v96, v96, v104
    v_mul_f32 v97, v97, v105
    v_mul_f32 v98, v98, v106
    v_mul_f32 v99, v99, v107
    v_cvt_pk_bf16_f32 v97, v96, v97
    v_lshlrev_b32 v96, 16, v97
    v_and_b32 v97, 0xffff0000, v97
    v_cvt_pk_bf16_f32 v99, v98, v99
    v_lshlrev_b32 v98, 16, v99
    v_and_b32 v99, 0xffff0000, v99
    v_mul_f32 v96, v96, v100
    v_mul_f32 v97, v97, v101
    v_mul_f32 v98, v98, v102
    v_mul_f32 v99, v99, v103
    v_cvt_pk_bf16_f32 v96, v96, v97
    v_cvt_pk_bf16_f32 v97, v98, v99
    s_mov_b32 exec_lo, 0x00ff00ff
    s_mov_b32 exec_hi, 0x00ff00ff
    s_cmp_lg_u32 s97, 0
    s_cbranch_scc1 XM_sl
    buffer_store_dwordx2 v[96:97], v16, s[8:11], s23 offen
    s_branch XM_sb
XM_sl:
    buffer_store_dwordx2 v[96:97], v16, s[8:11], s23 offen sc1
XM_sb:
    s_mov_b64 exec, -1
XM_ng:
    s_cmp_ge_u32 s20, 20
    s_cbranch_scc1 XM_r
    s_mov_b32 s6, 59244544
    s_mov_b32 s7, 56623104
    buffer_load_dwordx2 v[144:145], v27, s[8:11], s6 offen sc1
    buffer_load_dwordx2 v[146:147], v27, s[8:11], s7 offen sc1
    buffer_load_dwordx4 v[96:99], v17, s[8:11], s23 offen offset:0 sc1
    buffer_load_dwordx4 v[100:103], v17, s[8:11], s23 offen offset:64 sc1
    buffer_load_dwordx4 v[104:107], v17, s[8:11], s23 offen offset:128 sc1
    buffer_load_dwordx4 v[108:111], v17, s[8:11], s23 offen offset:192 sc1
    buffer_load_dwordx4 v[112:115], v17, s[8:11], s23 offen offset:256 sc1
    buffer_load_dwordx4 v[116:119], v17, s[8:11], s23 offen offset:320 sc1
    buffer_load_dwordx4 v[120:123], v17, s[8:11], s23 offen offset:384 sc1
    buffer_load_dwordx4 v[124:127], v17, s[8:11], s23 offen offset:448 sc1
    buffer_load_dwordx4 v[128:131], v17, s[8:11], s23 offen offset:512 sc1
    buffer_load_dwordx4 v[132:135], v17, s[8:11], s23 offen offset:576 sc1
    buffer_load_dwordx4 v[136:139], v17, s[8:11], s23 offen offset:640 sc1
    buffer_load_dwordx4 v[140:143], v17, s[8:11], s23 offen offset:704 sc1
    v_and_b32 v30, 0xffff0000, v26
    v_ashrrev_i32 v31, 31, v30
    v_not_b32 v31, v31
    v_or_b32 v31, 0x80000000, v31
    v_xor_b32 v30, v30, v31
    v_and_b32 v30, 0xffff0000, v30
    v_mul_f32 v31, 0xbfb8aa3b, v30
    v_exp_f32 v31, v31
    s_nop 0
    v_add_f32 v31, 1.0, v31
    v_rcp_f32 v30, v31
    s_nop 0
    v_cvt_pk_bf16_f32 v30, v30, v30
    v_and_b32 v30, 0xffff0000, v30
    s_mov_b32 s31, 0
    s_waitcnt vmcnt(0)
    v_max3_u32 v31, v144, v145, v146
    v_max3_u32 v31, v31, v147, v96
    v_max3_u32 v31, v31, v97, v98
    v_max3_u32 v31, v31, v99, v100
    v_max3_u32 v31, v31, v101, v102
    v_max3_u32 v31, v31, v103, v104
    v_max3_u32 v31, v31, v105, v106
    v_max3_u32 v31, v31, v107, v108
    v_max3_u32 v31, v31, v109, v110
    v_max3_u32 v31, v31, v111, v112
    v_max3_u32 v31, v31, v113, v114
    v_max3_u32 v31, v31, v115, v116
    v_max3_u32 v31, v31, v117, v118
    v_max3_u32 v31, v31, v119, v120
    v_max3_u32 v31, v31, v121, v122
    v_max3_u32 v31, v31, v123, v124
    v_max3_u32 v31, v31, v125, v126
    v_max3_u32 v31, v31, v127, v128
    v_max3_u32 v31, v31, v129, v130
    v_max3_u32 v31, v31, v131, v132
    v_max3_u32 v31, v31, v133, v134
    v_max3_u32 v31, v31, v135, v136
    v_max3_u32 v31, v31, v137, v138
    v_max3_u32 v31, v31, v139, v140
    v_max3_u32 v31, v31, v141, v142
    v_max_u32 v31, v31, v143
    v_cmp_eq_u32 vcc, -1, v31
    s_cbranch_vccz XA_o
XA_l:
    s_mov_b32 s4, 0
    s_sleep 1
    v_max3_u32 v31, v144, v145, v146
    v_max_u32 v31, v31, v147
    v_cmp_eq_u32 vcc, -1, v31
    s_cbranch_vccz XA_k0
    buffer_load_dwordx2 v[144:145], v27, s[8:11], s6 offen sc1
    buffer_load_dwordx2 v[146:147], v27, s[8:11], s7 offen sc1
    s_mov_b32 s4, 1
XA_k0:
    v_max3_u32 v31, v96, v97, v98
    v_max3_u32 v31, v31, v99, v100
    v_max3_u32 v31, v31, v101, v102
    v_max3_u32 v31, v31, v103, v104
    v_max3_u32 v31, v31, v105, v106
    v_max_u32 v31, v31, v107
    v_cmp_eq_u32 vcc, -1, v31
    s_cbranch_vccz XA_k1
    buffer_load_dwordx4 v[96:99], v17, s[8:11], s23 offen offset:0 sc1
    buffer_load_dwordx4 v[100:103], v17, s[8:11], s23 offen offset:64 sc1
    buffer_load_dwordx4 v[104:107], v17, s[8:11], s23 offen offset:128 sc1
    s_mov_b32 s4, 1
XA_k1:
    v_max3_u32 v31, v108, v109, v110
    v_max3_u32 v31, v31, v111, v112
    v_max3_u32 v31, v31, v113, v114
    v_max3_u32 v31, v31, v115, v116
    v_max3_u32 v31, v31, v117, v118
    v_max_u32 v31, v31, v119
    v_cmp_eq_u32 vcc, -1, v31
    s_cbranch_vccz XA_k2
    buffer_load_dwordx4 v[108:111], v17, s[8:11], s23 offen offset:192 sc1
    buffer_load_dwordx4 v[112:115], v17, s[8:11], s23 offen offset:256 sc1
    buffer_load_dwordx4 v[116:119], v17, s[8:11], s23 offen offset:320 sc1
    s_mov_b32 s4, 1
XA_k2:
    v_max3_u32 v31, v120, v121, v122
    v_max3_u32 v31, v31, v123, v124
    v_max3_u32 v31, v31, v125, v126
    v_max3_u32 v31, v31, v127, v128
    v_max3_u32 v31, v31, v129, v130
    v_max_u32 v31, v31, v131
    v_cmp_eq_u32 vcc, -1, v31
    s_cbranch_vccz XA_k3
    buffer_load_dwordx4 v[120:123], v17, s[8:11], s23 offen offset:384 sc1
    buffer_load_dwordx4 v[124:127], v17, s[8:11], s23 offen offset:448 sc1
    buffer_load_dwordx4 v[128:131], v17, s[8:11], s23 offen offset:512 sc1
    s_mov_b32 s4, 1
XA_k3:
    v_max3_u32 v31, v132, v133, v134
    v_max3_u32 v31, v31, v135, v136
    v_max3_u32 v31, v31, v137, v138
    v_max3_u32 v31, v31, v139, v140
    v_max3_u32 v31, v31, v141, v142
    v_max_u32 v31, v31, v143
    v_cmp_eq_u32 vcc, -1, v31
    s_cbranch_vccz XA_k4
    buffer_load_dwordx4 v[132:135], v17, s[8:11], s23 offen offset:576 sc1
    buffer_load_dwordx4 v[136:139], v17, s[8:11], s23 offen offset:640 sc1
    buffer_load_dwordx4 v[140:143], v17, s[8:11], s23 offen offset:704 sc1
    s_mov_b32 s4, 1
XA_k4:
    s_cmp_eq_u32 s4, 0
    s_cbranch_scc1 XA_o
    s_waitcnt vmcnt(0)
    s_add_u32 s31, s31, 1
    s_cmp_lt_u32 s31, s30
    s_cbranch_scc1 XA_l
    s_mov_b32 s30, 1
XA_o:
    v_mfma_f32_16x16x32_bf16 v[148:151], a[120:123], v[96:99], 0
    v_mfma_f32_16x16x32_bf16 v[152:155], a[168:171], v[96:99], 0
    v_mfma_f32_16x16x32_bf16 v[148:151], a[124:127], v[100:103], v[148:151]
    v_mfma_f32_16x16x32_bf16 v[152:155], a[172:175], v[100:103], v[152:155]
    v_mfma_f32_16x16x32_bf16 v[148:151], a[128:131], v[104:107], v[148:151]
    v_mfma_f32_16x16x32_bf16 v[152:155], a[176:179], v[104:107], v[152:155]
    v_mfma_f32_16x16x32_bf16 v[148:151], a[132:135], v[108:111], v[148:151]
    v_mfma_f32_16x16x32_bf16 v[152:155], a[180:183], v[108:111], v[152:155]
    v_mfma_f32_16x16x32_bf16 v[148:151], a[136:139], v[112:115], v[148:151]
    v_mfma_f32_16x16x32_bf16 v[152:155], a[184:187], v[112:115], v[152:155]
    v_mfma_f32_16x16x32_bf16 v[148:151], a[140:143], v[116:119], v[148:151]
    v_mfma_f32_16x16x32_bf16 v[152:155], a[188:191], v[116:119], v[152:155]
    v_mfma_f32_16x16x32_bf16 v[148:151], a[144:147], v[120:123], v[148:151]
    v_mfma_f32_16x16x32_bf16 v[152:155], a[192:195], v[120:123], v[152:155]
    v_mfma_f32_16x16x32_bf16 v[148:151], a[148:151], v[124:127], v[148:151]
    v_mfma_f32_16x16x32_bf16 v[152:155], a[196:199], v[124:127], v[152:155]
    v_mfma_f32_16x16x32_bf16 v[148:151], a[152:155], v[128:131], v[148:151]
    v_mfma_f32_16x16x32_bf16 v[152:155], a[200:203], v[128:131], v[152:155]
    v_mfma_f32_16x16x32_bf16 v[148:151], a[156:159], v[132:135], v[148:151]
    v_mfma_f32_16x16x32_bf16 v[152:155], a[204:207], v[132:135], v[152:155]
    v_mfma_f32_16x16x32_bf16 v[148:151], a[160:163], v[136:139], v[148:151]
    v_mfma_f32_16x16x32_bf16 v[152:155], a[208:211], v[136:139], v[152:155]
    v_mfma_f32_16x16x32_bf16 v[148:151], a[164:167], v[140:143], v[148:151]
    v_mfma_f32_16x16x32_bf16 v[152:155], a[212:215], v[140:143], v[152:155]
    s_nop 3
    ds_write_b128 v20, v[148:151] offset:24576
    s_nop 2
    ds_write_b128 v20, v[152:155] offset:25600
    s_waitcnt lgkmcnt(0)
    s_barrier
    s_cmp_ge_u32 s3, 2
    s_cbranch_scc1 XM_r
    ds_read_b128 v[96:99], v21 offset:24576
    ds_read_b128 v[100:103], v21 offset:26624
    ds_read_b128 v[104:107], v21 offset:28672
    ds_read_b128 v[108:111], v21 offset:30720
    s_waitcnt lgkmcnt(0)
    v_pk_add_f32 v[96:97], v[96:97], v[100:101]
    v_pk_add_f32 v[98:99], v[98:99], v[102:103]
    v_pk_add_f32 v[96:97], v[96:97], v[104:105]
    v_pk_add_f32 v[98:99], v[98:99], v[106:107]
    v_pk_add_f32 v[96:97], v[96:97], v[108:109]
    v_pk_add_f32 v[98:99], v[98:99], v[110:111]
    v_cvt_pk_bf16_f32 v97, v96, v97
    v_lshlrev_b32 v96, 16, v97
    v_and_b32 v97, 0xffff0000, v97
    v_mul_f32 v96, v96, v30
    v_mul_f32 v97, v97, v30
    v_cvt_pk_bf16_f32 v97, v96, v97
    v_lshlrev_b32 v96, 16, v97
    v_and_b32 v97, 0xffff0000, v97
    v_lshlrev_b32 v104, 16, v144
    v_and_b32 v105, 0xffff0000, v144
    v_add_f32 v96, v96, v104
    v_add_f32 v97, v97, v105
    v_cvt_pk_bf16_f32 v97, v96, v97
    v_lshlrev_b32 v96, 16, v97
    v_and_b32 v97, 0xffff0000, v97
    v_mul_f32 v96, v96, v22
    v_mul_f32 v97, v97, v23
    v_cvt_pk_bf16_f32 v97, v96, v97
    v_lshlrev_b32 v96, 16, v97
    v_and_b32 v97, 0xffff0000, v97
    v_lshlrev_b32 v104, 16, v146
    v_and_b32 v105, 0xffff0000, v146
    v_add_f32 v96, v96, v104
    v_add_f32 v97, v97, v105
    v_cvt_pk_bf16_f32 v28, v96, v97
    v_cvt_pk_bf16_f32 v99, v98, v99
    v_lshlrev_b32 v98, 16, v99
    v_and_b32 v99, 0xffff0000, v99
    v_mul_f32 v98, v98, v30
    v_mul_f32 v99, v99, v30
    v_cvt_pk_bf16_f32 v99, v98, v99
    v_lshlrev_b32 v98, 16, v99
    v_and_b32 v99, 0xffff0000, v99
    v_lshlrev_b32 v104, 16, v145
    v_and_b32 v105, 0xffff0000, v145
    v_add_f32 v98, v98, v104
    v_add_f32 v99, v99, v105
    v_cvt_pk_bf16_f32 v99, v98, v99
    v_lshlrev_b32 v98, 16, v99
    v_and_b32 v99, 0xffff0000, v99
    v_mul_f32 v98, v98, v24
    v_mul_f32 v99, v99, v25
    v_cvt_pk_bf16_f32 v99, v98, v99
    v_lshlrev_b32 v98, 16, v99
    v_and_b32 v99, 0xffff0000, v99
    v_lshlrev_b32 v104, 16, v147
    v_and_b32 v105, 0xffff0000, v147
    v_add_f32 v98, v98, v104
    v_add_f32 v99, v99, v105
    v_cvt_pk_bf16_f32 v29, v98, v99
XM_r:
    s_setpc_b64 s[100:101]
XG_sub:
    s_lshl_b32 s4, s43, 2
    s_add_u32 s4, s4, 16384
    s_lshl_b32 s5, s43, 7
    s_add_u32 s5, s5, 61636608
    s_cmp_lt_u32 s43, 1792
    s_cselect_b32 s5, s4, s5
    s_cselect_b32 s4, 2, 7
    v_lshlrev_b32 v93, s4, v1
    s_sub_u32 s4, 0x7ff, s43
    v_sub_u32 v94, s4, v1
    s_add_u32 s43, s43, 64
    s_mov_b32 s31, 0
XG_l:
    buffer_load_dword v92, v93, s[8:11], s5 offen sc1
    s_waitcnt vmcnt(0)
    v_max_u32 v95, v92, v92
    v_cmp_eq_u32 vcc, -1, v95
    s_cbranch_vccz XG_o
    s_sleep 1
    s_add_u32 s31, s31, 1
    s_cmp_lt_u32 s31, s30
    s_cbranch_scc1 XG_l
    s_mov_b32 s30, 1
XG_o:
    v_ashrrev_i32 v95, 31, v92
    v_or_b32 v95, 0x80000000, v95
    v_xor_b32 v92, v92, v95
    v_and_b32 v92, 0xffff0000, v92
    v_or_b32 v92, v92, v94
    s_mov_b64 s[6:7], -1
XG_i:
    v_cmp_lt_u32 vcc, s49, v92
    s_and_b64 s[6:7], s[6:7], vcc
    s_cbranch_scc0 XG_d
    s_mov_b32 s27, 1
    s_ff1_i32_b64 s4, s[6:7]
    v_readlane_b32 s5, v92, s4
    s_bitset0_b64 s[6:7], s4
    s_min_u32 s4, s5, s44
    s_max_u32 s44, s5, s44
    s_min_u32 s5, s4, s45
    s_max_u32 s45, s4, s45
    s_min_u32 s4, s5, s46
    s_max_u32 s46, s5, s46
    s_min_u32 s5, s4, s47
    s_max_u32 s47, s4, s47
    s_min_u32 s4, s5, s38
    s_max_u32 s38, s5, s38
    s_min_u32 s5, s4, s39
    s_max_u32 s39, s4, s39
    s_min_u32 s4, s5, s48
    s_max_u32 s48, s5, s48
    s_min_u32 s5, s4, s49
    s_max_u32 s49, s4, s49
    s_branch XG_i
XG_d:
    s_setpc_b64 s[100:101]
XN_sub:
    ds_read2_b64 v[40:43], v12 offset0:0 offset1:4
    ds_read2_b64 v[44:47], v12 offset0:32 offset1:36
    ds_read2_b64 v[48:51], v12 offset0:64 offset1:68
    ds_read2_b64 v[52:55], v12 offset0:96 offset1:100
    ds_read2_b64 v[56:59], v12 offset0:128 offset1:132
    s_waitcnt lgkmcnt(4)
    v_lshlrev_b32 v60, 16, v40
    v_and_b32 v61, 0xffff0000, v40
    v_lshlrev_b32 v62, 16, v42
    v_and_b32 v63, 0xffff0000, v42
    v_lshlrev_b32 v64, 16, v41
    v_and_b32 v65, 0xffff0000, v41
    v_lshlrev_b32 v66, 16, v43
    v_and_b32 v67, 0xffff0000, v43
    s_waitcnt lgkmcnt(3)
    v_lshlrev_b32 v68, 16, v44
    v_and_b32 v69, 0xffff0000, v44
    v_lshlrev_b32 v70, 16, v46
    v_and_b32 v71, 0xffff0000, v46
    v_lshlrev_b32 v72, 16, v45
    v_and_b32 v73, 0xffff0000, v45
    v_lshlrev_b32 v74, 16, v47
    v_and_b32 v75, 0xffff0000, v47
    s_waitcnt lgkmcnt(2)
    v_lshlrev_b32 v76, 16, v48
    v_and_b32 v77, 0xffff0000, v48
    v_lshlrev_b32 v78, 16, v50
    v_and_b32 v79, 0xffff0000, v50
    v_lshlrev_b32 v80, 16, v49
    v_and_b32 v81, 0xffff0000, v49
    v_lshlrev_b32 v82, 16, v51
    v_and_b32 v83, 0xffff0000, v51
    s_waitcnt lgkmcnt(1)
    v_lshlrev_b32 v84, 16, v52
    v_and_b32 v85, 0xffff0000, v52
    v_lshlrev_b32 v86, 16, v54
    v_and_b32 v87, 0xffff0000, v54
    v_lshlrev_b32 v88, 16, v53
    v_and_b32 v89, 0xffff0000, v53
    v_lshlrev_b32 v90, 16, v55
    v_and_b32 v91, 0xffff0000, v55
    s_waitcnt lgkmcnt(0)
    v_lshlrev_b32 v92, 16, v56
    v_and_b32 v93, 0xffff0000, v56
    v_lshlrev_b32 v94, 16, v58
    v_and_b32 v95, 0xffff0000, v58
    v_lshlrev_b32 v96, 16, v57
    v_and_b32 v97, 0xffff0000, v57
    v_lshlrev_b32 v98, 16, v59
    v_and_b32 v99, 0xffff0000, v59
    v_pk_add_f32 v[16:17], v[60:61], v[68:69]
    v_pk_add_f32 v[18:19], v[62:63], v[70:71]
    v_pk_add_f32 v[20:21], v[64:65], v[72:73]
    v_pk_add_f32 v[22:23], v[66:67], v[74:75]
    v_pk_add_f32 v[16:17], v[16:17], v[76:77]
    v_pk_add_f32 v[18:19], v[18:19], v[78:79]
    v_pk_add_f32 v[20:21], v[20:21], v[80:81]
    v_pk_add_f32 v[22:23], v[22:23], v[82:83]
    v_pk_add_f32 v[16:17], v[16:17], v[84:85]
    v_pk_add_f32 v[18:19], v[18:19], v[86:87]
    v_pk_add_f32 v[20:21], v[20:21], v[88:89]
    v_pk_add_f32 v[22:23], v[22:23], v[90:91]
    v_pk_add_f32 v[16:17], v[16:17], v[92:93]
    v_pk_add_f32 v[18:19], v[18:19], v[94:95]
    v_pk_add_f32 v[20:21], v[20:21], v[96:97]
    v_pk_add_f32 v[22:23], v[22:23], v[98:99]
    v_pk_add_f32 v[16:17], v[16:17], v[18:19]
    v_pk_add_f32 v[20:21], v[20:21], v[22:23]
    v_pk_add_f32 v[16:17], v[16:17], v[20:21]
    v_add_f32 v16, v16, v17
    s_nop 1
    v_add_f32 v16, v16, v16 row_ror:4 row_mask:0xf bank_mask:0xf
    s_nop 1
    v_add_f32 v16, v16, v16 row_ror:8 row_mask:0xf bank_mask:0xf
    v_mov_b32 v17, v16
    s_nop 1
    v_permlane16_swap_b32 v16, v17
    v_add_f32 v16, v16, v17
    v_mov_b32 v17, v16
    s_nop 1
    v_permlane32_swap_b32 v16, v17
    v_add_f32 v16, v16, v17
    v_mul_f32 v6, 0xbacccccd, v16
    v_mov_b32 v7, v6
    v_pk_add_f32 v[40:41], v[60:61], v[6:7]
    v_pk_add_f32 v[42:43], v[62:63], v[6:7]
    v_pk_add_f32 v[44:45], v[64:65], v[6:7]
    v_pk_add_f32 v[46:47], v[66:67], v[6:7]
    v_pk_mul_f32 v[16:17], v[40:41], v[40:41]
    v_pk_mul_f32 v[18:19], v[42:43], v[42:43]
    v_pk_mul_f32 v[20:21], v[44:45], v[44:45]
    v_pk_mul_f32 v[22:23], v[46:47], v[46:47]
    v_pk_add_f32 v[48:49], v[68:69], v[6:7]
    v_pk_add_f32 v[50:51], v[70:71], v[6:7]
    v_pk_add_f32 v[52:53], v[72:73], v[6:7]
    v_pk_add_f32 v[54:55], v[74:75], v[6:7]
    v_pk_fma_f32 v[16:17], v[48:49], v[48:49], v[16:17]
    v_pk_fma_f32 v[18:19], v[50:51], v[50:51], v[18:19]
    v_pk_fma_f32 v[20:21], v[52:53], v[52:53], v[20:21]
    v_pk_fma_f32 v[22:23], v[54:55], v[54:55], v[22:23]
    v_pk_add_f32 v[40:41], v[76:77], v[6:7]
    v_pk_add_f32 v[42:43], v[78:79], v[6:7]
    v_pk_add_f32 v[44:45], v[80:81], v[6:7]
    v_pk_add_f32 v[46:47], v[82:83], v[6:7]
    v_pk_fma_f32 v[16:17], v[40:41], v[40:41], v[16:17]
    v_pk_fma_f32 v[18:19], v[42:43], v[42:43], v[18:19]
    v_pk_fma_f32 v[20:21], v[44:45], v[44:45], v[20:21]
    v_pk_fma_f32 v[22:23], v[46:47], v[46:47], v[22:23]
    v_pk_add_f32 v[48:49], v[84:85], v[6:7]
    v_pk_add_f32 v[50:51], v[86:87], v[6:7]
    v_pk_add_f32 v[52:53], v[88:89], v[6:7]
    v_pk_add_f32 v[54:55], v[90:91], v[6:7]
    v_pk_fma_f32 v[16:17], v[48:49], v[48:49], v[16:17]
    v_pk_fma_f32 v[18:19], v[50:51], v[50:51], v[18:19]
    v_pk_fma_f32 v[20:21], v[52:53], v[52:53], v[20:21]
    v_pk_fma_f32 v[22:23], v[54:55], v[54:55], v[22:23]
    v_pk_add_f32 v[40:41], v[92:93], v[6:7]
    v_pk_add_f32 v[42:43], v[94:95], v[6:7]
    v_pk_add_f32 v[44:45], v[96:97], v[6:7]
    v_pk_add_f32 v[46:47], v[98:99], v[6:7]
    v_pk_fma_f32 v[16:17], v[40:41], v[40:41], v[16:17]
    v_pk_fma_f32 v[18:19], v[42:43], v[42:43], v[18:19]
    v_pk_fma_f32 v[20:21], v[44:45], v[44:45], v[20:21]
    v_pk_fma_f32 v[22:23], v[46:47], v[46:47], v[22:23]
    v_cvt_pk_bf16_f32 v6, v6, v6
    v_and_b32 v6, 0xffff0000, v6
    v_mov_b32 v7, v6
    v_pk_add_f32 v[16:17], v[16:17], v[18:19]
    v_pk_add_f32 v[20:21], v[20:21], v[22:23]
    v_pk_add_f32 v[16:17], v[16:17], v[20:21]
    v_add_f32 v16, v16, v17
    s_nop 1
    v_add_f32 v16, v16, v16 row_ror:4 row_mask:0xf bank_mask:0xf
    s_nop 1
    v_add_f32 v16, v16, v16 row_ror:8 row_mask:0xf bank_mask:0xf
    v_mov_b32 v17, v16
    s_nop 1
    v_permlane16_swap_b32 v16, v17
    v_add_f32 v16, v16, v17
    v_mov_b32 v17, v16
    s_nop 1
    v_permlane32_swap_b32 v16, v17
    v_add_f32 v16, v16, v17
    v_mul_f32 v8, 0x3acccccd, v16
    v_pk_add_f32 v[60:61], v[60:61], v[6:7]
    v_pk_add_f32 v[62:63], v[62:63], v[6:7]
    v_cvt_pk_bf16_f32 v8, v8, v8
    v_pk_add_f32 v[64:65], v[64:65], v[6:7]
    v_pk_add_f32 v[66:67], v[66:67], v[6:7]
    v_and_b32 v8, 0xffff0000, v8
    v_pk_add_f32 v[68:69], v[68:69], v[6:7]
    v_pk_add_f32 v[70:71], v[70:71], v[6:7]
    v_add_f32 v8, 0x3727c5ac, v8
    v_pk_add_f32 v[72:73], v[72:73], v[6:7]
    v_pk_add_f32 v[74:75], v[74:75], v[6:7]
    v_cvt_pk_bf16_f32 v8, v8, v8
    v_pk_add_f32 v[76:77], v[76:77], v[6:7]
    v_pk_add_f32 v[78:79], v[78:79], v[6:7]
    v_and_b32 v8, 0xffff0000, v8
    v_pk_add_f32 v[80:81], v[80:81], v[6:7]
    v_pk_add_f32 v[82:83], v[82:83], v[6:7]
    v_sqrt_f32 v8, v8
    v_pk_add_f32 v[84:85], v[84:85], v[6:7]
    v_pk_add_f32 v[86:87], v[86:87], v[6:7]
    v_cvt_pk_bf16_f32 v8, v8, v8
    v_pk_add_f32 v[88:89], v[88:89], v[6:7]
    v_pk_add_f32 v[90:91], v[90:91], v[6:7]
    v_and_b32 v8, 0xffff0000, v8
    v_pk_add_f32 v[92:93], v[92:93], v[6:7]
    v_pk_add_f32 v[94:95], v[94:95], v[6:7]
    v_rcp_f32 v8, v8
    v_pk_add_f32 v[96:97], v[96:97], v[6:7]
    v_pk_add_f32 v[98:99], v[98:99], v[6:7]
    v_mov_b32 v9, v8
    v_cvt_pk_bf16_f32 v40, v60, v61
    v_cvt_pk_bf16_f32 v41, v62, v63
    v_cvt_pk_bf16_f32 v42, v64, v65
    v_cvt_pk_bf16_f32 v43, v66, v67
    v_cvt_pk_bf16_f32 v44, v68, v69
    v_cvt_pk_bf16_f32 v45, v70, v71
    v_cvt_pk_bf16_f32 v46, v72, v73
    v_cvt_pk_bf16_f32 v47, v74, v75
    v_cvt_pk_bf16_f32 v48, v76, v77
    v_cvt_pk_bf16_f32 v49, v78, v79
    v_cvt_pk_bf16_f32 v50, v80, v81
    v_cvt_pk_bf16_f32 v51, v82, v83
    v_cvt_pk_bf16_f32 v52, v84, v85
    v_cvt_pk_bf16_f32 v53, v86, v87
    v_cvt_pk_bf16_f32 v54, v88, v89
    v_cvt_pk_bf16_f32 v55, v90, v91
    v_cvt_pk_bf16_f32 v56, v92, v93
    v_cvt_pk_bf16_f32 v57, v94, v95
    v_cvt_pk_bf16_f32 v58, v96, v97
    v_cvt_pk_bf16_f32 v59, v98, v99
    v_lshlrev_b32 v60, 16, v40
    v_and_b32 v61, 0xffff0000, v40
    v_lshlrev_b32 v62, 16, v41
    v_and_b32 v63, 0xffff0000, v41
    v_lshlrev_b32 v64, 16, v42
    v_and_b32 v65, 0xffff0000, v42
    v_lshlrev_b32 v66, 16, v43
    v_and_b32 v67, 0xffff0000, v43
    v_lshlrev_b32 v68, 16, v44
    v_and_b32 v69, 0xffff0000, v44
    v_lshlrev_b32 v70, 16, v45
    v_and_b32 v71, 0xffff0000, v45
    v_lshlrev_b32 v72, 16, v46
    v_and_b32 v73, 0xffff0000, v46
    v_lshlrev_b32 v74, 16, v47
    v_and_b32 v75, 0xffff0000, v47
    v_lshlrev_b32 v76, 16, v48
    v_and_b32 v77, 0xffff0000, v48
    v_lshlrev_b32 v78, 16, v49
    v_and_b32 v79, 0xffff0000, v49
    v_lshlrev_b32 v80, 16, v50
    v_and_b32 v81, 0xffff0000, v50
    v_lshlrev_b32 v82, 16, v51
    v_and_b32 v83, 0xffff0000, v51
    v_lshlrev_b32 v84, 16, v52
    v_and_b32 v85, 0xffff0000, v52
    v_lshlrev_b32 v86, 16, v53
    v_and_b32 v87, 0xffff0000, v53
    v_lshlrev_b32 v88, 16, v54
    v_and_b32 v89, 0xffff0000, v54
    v_lshlrev_b32 v90, 16, v55
    v_and_b32 v91, 0xffff0000, v55
    v_lshlrev_b32 v92, 16, v56
    v_and_b32 v93, 0xffff0000, v56
    v_lshlrev_b32 v94, 16, v57
    v_and_b32 v95, 0xffff0000, v57
    v_lshlrev_b32 v96, 16, v58
    v_and_b32 v97, 0xffff0000, v58
    v_lshlrev_b32 v98, 16, v59
    v_and_b32 v99, 0xffff0000, v59
    v_pk_mul_f32 v[60:61], v[60:61], v[8:9]
    v_pk_mul_f32 v[62:63], v[62:63], v[8:9]
    v_pk_mul_f32 v[64:65], v[64:65], v[8:9]
    v_pk_mul_f32 v[66:67], v[66:67], v[8:9]
    v_pk_mul_f32 v[68:69], v[68:69], v[8:9]
    v_pk_mul_f32 v[70:71], v[70:71], v[8:9]
    v_pk_mul_f32 v[72:73], v[72:73], v[8:9]
    v_pk_mul_f32 v[74:75], v[74:75], v[8:9]
    v_pk_mul_f32 v[76:77], v[76:77], v[8:9]
    v_pk_mul_f32 v[78:79], v[78:79], v[8:9]
    v_pk_mul_f32 v[80:81], v[80:81], v[8:9]
    v_pk_mul_f32 v[82:83], v[82:83], v[8:9]
    v_pk_mul_f32 v[84:85], v[84:85], v[8:9]
    v_pk_mul_f32 v[86:87], v[86:87], v[8:9]
    v_pk_mul_f32 v[88:89], v[88:89], v[8:9]
    v_pk_mul_f32 v[90:91], v[90:91], v[8:9]
    v_pk_mul_f32 v[92:93], v[92:93], v[8:9]
    v_pk_mul_f32 v[94:95], v[94:95], v[8:9]
    v_pk_mul_f32 v[96:97], v[96:97], v[8:9]
    v_pk_mul_f32 v[98:99], v[98:99], v[8:9]
    s_setpc_b64 s[100:101]
XS_sub:
    v_pk_mul_f32 v[60:61], v[60:61], v[100:101]
    v_pk_mul_f32 v[62:63], v[62:63], v[102:103]
    v_pk_mul_f32 v[64:65], v[64:65], v[104:105]
    v_pk_mul_f32 v[66:67], v[66:67], v[106:107]
    v_pk_mul_f32 v[68:69], v[68:69], v[108:109]
    v_pk_mul_f32 v[70:71], v[70:71], v[110:111]
    v_pk_mul_f32 v[72:73], v[72:73], v[112:113]
    v_pk_mul_f32 v[74:75], v[74:75], v[114:115]
    v_pk_mul_f32 v[76:77], v[76:77], v[116:117]
    v_pk_mul_f32 v[78:79], v[78:79], v[118:119]
    v_pk_mul_f32 v[80:81], v[80:81], v[120:121]
    v_pk_mul_f32 v[82:83], v[82:83], v[122:123]
    v_pk_mul_f32 v[84:85], v[84:85], v[124:125]
    v_pk_mul_f32 v[86:87], v[86:87], v[126:127]
    v_pk_mul_f32 v[88:89], v[88:89], v[128:129]
    v_pk_mul_f32 v[90:91], v[90:91], v[130:131]
    v_pk_mul_f32 v[92:93], v[92:93], v[132:133]
    v_pk_mul_f32 v[94:95], v[94:95], v[134:135]
    v_pk_mul_f32 v[96:97], v[96:97], v[136:137]
    v_pk_mul_f32 v[98:99], v[98:99], v[138:139]
    v_cvt_pk_bf16_f32 v40, v60, v61
    v_cvt_pk_bf16_f32 v41, v62, v63
    v_cvt_pk_bf16_f32 v42, v64, v65
    v_cvt_pk_bf16_f32 v43, v66, v67
    v_cvt_pk_bf16_f32 v44, v68, v69
    v_cvt_pk_bf16_f32 v45, v70, v71
    v_cvt_pk_bf16_f32 v46, v72, v73
    v_cvt_pk_bf16_f32 v47, v74, v75
    v_cvt_pk_bf16_f32 v48, v76, v77
    v_cvt_pk_bf16_f32 v49, v78, v79
    v_cvt_pk_bf16_f32 v50, v80, v81
    v_cvt_pk_bf16_f32 v51, v82, v83
    v_cvt_pk_bf16_f32 v52, v84, v85
    v_cvt_pk_bf16_f32 v53, v86, v87
    v_cvt_pk_bf16_f32 v54, v88, v89
    v_cvt_pk_bf16_f32 v55, v90, v91
    v_cvt_pk_bf16_f32 v56, v92, v93
    v_cvt_pk_bf16_f32 v57, v94, v95
    v_cvt_pk_bf16_f32 v58, v96, v97
    v_cvt_pk_bf16_f32 v59, v98, v99
    v_lshlrev_b32 v60, 16, v40
    v_and_b32 v61, 0xffff0000, v40
    v_lshlrev_b32 v62, 16, v41
    v_and_b32 v63, 0xffff0000, v41
    v_lshlrev_b32 v64, 16, v42
    v_and_b32 v65, 0xffff0000, v42
    v_lshlrev_b32 v66, 16, v43
    v_and_b32 v67, 0xffff0000, v43
    v_lshlrev_b32 v68, 16, v44
    v_and_b32 v69, 0xffff0000, v44
    v_lshlrev_b32 v70, 16, v45
    v_and_b32 v71, 0xffff0000, v45
    v_lshlrev_b32 v72, 16, v46
    v_and_b32 v73, 0xffff0000, v46
    v_lshlrev_b32 v74, 16, v47
    v_and_b32 v75, 0xffff0000, v47
    v_lshlrev_b32 v76, 16, v48
    v_and_b32 v77, 0xffff0000, v48
    v_lshlrev_b32 v78, 16, v49
    v_and_b32 v79, 0xffff0000, v49
    v_lshlrev_b32 v80, 16, v50
    v_and_b32 v81, 0xffff0000, v50
    v_lshlrev_b32 v82, 16, v51
    v_and_b32 v83, 0xffff0000, v51
    v_lshlrev_b32 v84, 16, v52
    v_and_b32 v85, 0xffff0000, v52
    v_lshlrev_b32 v86, 16, v53
    v_and_b32 v87, 0xffff0000, v53
    v_lshlrev_b32 v88, 16, v54
    v_and_b32 v89, 0xffff0000, v54
    v_lshlrev_b32 v90, 16, v55
    v_and_b32 v91, 0xffff0000, v55
    v_lshlrev_b32 v92, 16, v56
    v_and_b32 v93, 0xffff0000, v56
    v_lshlrev_b32 v94, 16, v57
    v_and_b32 v95, 0xffff0000, v57
    v_lshlrev_b32 v96, 16, v58
    v_and_b32 v97, 0xffff0000, v58
    v_lshlrev_b32 v98, 16, v59
    v_and_b32 v99, 0xffff0000, v59
    v_pk_add_f32 v[60:61], v[60:61], v[140:141]
    v_pk_add_f32 v[62:63], v[62:63], v[142:143]
    v_pk_add_f32 v[64:65], v[64:65], v[144:145]
    v_pk_add_f32 v[66:67], v[66:67], v[146:147]
    v_pk_add_f32 v[68:69], v[68:69], v[148:149]
    v_pk_add_f32 v[70:71], v[70:71], v[150:151]
    v_pk_add_f32 v[72:73], v[72:73], v[152:153]
    v_pk_add_f32 v[74:75], v[74:75], v[154:155]
    v_pk_add_f32 v[76:77], v[76:77], v[156:157]
    v_pk_add_f32 v[78:79], v[78:79], v[158:159]
    v_pk_add_f32 v[80:81], v[80:81], v[160:161]
    v_pk_add_f32 v[82:83], v[82:83], v[162:163]
    v_pk_add_f32 v[84:85], v[84:85], v[164:165]
    v_pk_add_f32 v[86:87], v[86:87], v[166:167]
    v_pk_add_f32 v[88:89], v[88:89], v[168:169]
    v_pk_add_f32 v[90:91], v[90:91], v[170:171]
    v_pk_add_f32 v[92:93], v[92:93], v[172:173]
    v_pk_add_f32 v[94:95], v[94:95], v[174:175]
    v_pk_add_f32 v[96:97], v[96:97], v[176:177]
    v_pk_add_f32 v[98:99], v[98:99], v[178:179]
    v_cvt_pk_bf16_f32 v40, v60, v61
    v_cvt_pk_bf16_f32 v41, v62, v63
    v_cvt_pk_bf16_f32 v42, v64, v65
    v_cvt_pk_bf16_f32 v43, v66, v67
    v_cvt_pk_bf16_f32 v44, v68, v69
    v_cvt_pk_bf16_f32 v45, v70, v71
    v_cvt_pk_bf16_f32 v46, v72, v73
    v_cvt_pk_bf16_f32 v47, v74, v75
    v_cvt_pk_bf16_f32 v48, v76, v77
    v_cvt_pk_bf16_f32 v49, v78, v79
    v_cvt_pk_bf16_f32 v50, v80, v81
    v_cvt_pk_bf16_f32 v51, v82, v83
    v_cvt_pk_bf16_f32 v52, v84, v85
    v_cvt_pk_bf16_f32 v53, v86, v87
    v_cvt_pk_bf16_f32 v54, v88, v89
    v_cvt_pk_bf16_f32 v55, v90, v91
    v_cvt_pk_bf16_f32 v56, v92, v93
    v_cvt_pk_bf16_f32 v57, v94, v95
    v_cvt_pk_bf16_f32 v58, v96, v97
    v_cvt_pk_bf16_f32 v59, v98, v99
    s_mov_b64 exec, s[24:25]
    ds_write_b128 v12, v[40:43] offset:0
    ds_write_b128 v12, v[44:47] offset:4096
    ds_write_b128 v12, v[48:51] offset:8192
    ds_write_b128 v12, v[52:55] offset:12288
    ds_write_b128 v12, v[56:59] offset:16384
    s_waitcnt lgkmcnt(0)
    s_barrier
    s_cbranch_execz XS_r
    ds_read_b128 v[40:43], v11 offset:0
    ds_read_b128 v[44:47], v11 offset:1024
    ds_read_b128 v[48:51], v11 offset:2048
    ds_read_b128 v[52:55], v11 offset:3072
    ds_read_b128 v[56:59], v11 offset:4096
    s_add_u32 s4, s27, 4096
    s_waitcnt lgkmcnt(4)
    buffer_store_dwordx4 v[40:43], v2, s[8:11], s27 offen offset:0 sc1
    s_waitcnt lgkmcnt(3)
    buffer_store_dwordx4 v[44:47], v2, s[8:11], s27 offen offset:1024 sc1
    s_waitcnt lgkmcnt(2)
    buffer_store_dwordx4 v[48:51], v2, s[8:11], s27 offen offset:2048 sc1
    s_waitcnt lgkmcnt(1)
    buffer_store_dwordx4 v[52:55], v2, s[8:11], s27 offen offset:3072 sc1
    s_waitcnt lgkmcnt(0)
    buffer_store_dwordx4 v[56:59], v2, s[8:11], s4 offen offset:0 sc1
XS_r:
    s_mov_b64 exec, -1
    s_setpc_b64 s[100:101]
R_ovf:
    s_waitcnt vmcnt(0) lgkmcnt(0)
    s_barrier
    s_load_dwordx2 s[12:13], s[0:1], 120
    s_mov_b32 s14, 256
    s_mov_b32 s15, 0x20000
    s_waitcnt lgkmcnt(0)
    v_mov_b32 v4, 0
    s_cmp_lg_u32 s3, 0
    s_cbranch_scc1 RO_b
    s_getreg_b32 s22, hwreg(HW_REG_XCC_ID)
    s_and_b32 s22, s22, 7
    s_lshl_b32 s21, s22, 5
    v_mov_b32 v5, 1
    s_mov_b64 exec, 1
    buffer_atomic_add v5, v4, s[12:15], s21 offen offset:12 sc0 sc1
    s_mov_b64 exec, -1
    v_and_b32 v6, 7, v1
    v_lshlrev_b32 v6, 5, v6
    s_waitcnt vmcnt(0)
    v_readfirstlane_b32 s20, v5
    s_mov_b32 s31, 0
RO_l:
    buffer_load_dwordx4 v[8:11], v6, s[12:15], 0 offen sc1
    s_waitcnt vmcnt(0)
    v_bcnt_u32_b32 v7, v8, v11
    v_cmp_lt_u32 s[4:5], 32, v7
    s_and_b32 s23, s4, 0xff
    v_cmp_ne_u32 s[4:5], 32, v7
    s_cmp_eq_u32 s23, 0
    s_cselect_b32 s5, 0xff, 0
    s_and_b32 s4, s4, s5
    s_mov_b32 s5, 0
    s_mov_b32 s24, s20
    v_readlane_b32 s4, v7, 0
    s_add_u32 s5, s5, s4
    v_readlane_b32 s4, v11, 0
    s_cmp_gt_u32 s22, 0
    s_cselect_b32 s4, s4, 0
    s_add_u32 s24, s24, s4
    v_readlane_b32 s4, v7, 1
    s_add_u32 s5, s5, s4
    v_readlane_b32 s4, v11, 1
    s_cmp_gt_u32 s22, 1
    s_cselect_b32 s4, s4, 0
    s_add_u32 s24, s24, s4
    v_readlane_b32 s4, v7, 2
    s_add_u32 s5, s5, s4
    v_readlane_b32 s4, v11, 2
    s_cmp_gt_u32 s22, 2
    s_cselect_b32 s4, s4, 0
    s_add_u32 s24, s24, s4
    v_readlane_b32 s4, v7, 3
    s_add_u32 s5, s5, s4
    v_readlane_b32 s4, v11, 3
    s_cmp_gt_u32 s22, 3
    s_cselect_b32 s4, s4, 0
    s_add_u32 s24, s24, s4
    v_readlane_b32 s4, v7, 4
    s_add_u32 s5, s5, s4
    v_readlane_b32 s4, v11, 4
    s_cmp_gt_u32 s22, 4
    s_cselect_b32 s4, s4, 0
    s_add_u32 s24, s24, s4
    v_readlane_b32 s4, v7, 5
    s_add_u32 s5, s5, s4
    v_readlane_b32 s4, v11, 5
    s_cmp_gt_u32 s22, 5
    s_cselect_b32 s4, s4, 0
    s_add_u32 s24, s24, s4
    v_readlane_b32 s4, v7, 6
    s_add_u32 s5, s5, s4
    v_readlane_b32 s4, v11, 6
    s_cmp_gt_u32 s22, 6
    s_cselect_b32 s4, s4, 0
    s_add_u32 s24, s24, s4
    v_readlane_b32 s4, v7, 7
    s_add_u32 s5, s5, s4
    v_readlane_b32 s4, v11, 7
    s_cmp_gt_u32 s22, 7
    s_cselect_b32 s4, s4, 0
    s_add_u32 s24, s24, s4
    s_cmp_ge_u32 s5, 256
    s_cbranch_scc1 RO_o
    s_sleep 4
    s_add_u32 s31, s31, 1
    s_cmp_lt_u32 s31, 0x80000
    s_cbranch_scc1 RO_l
    s_mov_b32 s21, 256
    s_branch RO_w
RO_o:
    v_mov_b32 v7, v8
    s_cmp_eq_u32 s23, 0
    s_cselect_b32 s21, s21, 0
    s_cselect_b32 s20, s20, s24
RO_x:
    s_lshr_b32 s6, s21, 5
    s_nop 4
    v_readlane_b32 s4, v7, s6
    s_bcnt0_i32_b32 s5, s4
    s_cmp_lt_u32 s20, s5
    s_cbranch_scc1 RO_f
    s_sub_u32 s20, s20, s5
    s_add_u32 s21, s21, 32
    s_cmp_lt_u32 s21, 256
    s_cbranch_scc1 RO_x
    s_branch RO_w
RO_f:
    s_ff0_i32_b32 s5, s4
    s_bitset1_b32 s4, s5
    s_sub_u32 s20, s20, 1
    s_cbranch_scc0 RO_f
    s_add_u32 s21, s21, s5
RO_w:
    v_mov_b32 v5, s21
    ds_write_b32 v4, v5
    s_waitcnt lgkmcnt(0)
RO_b:
    s_barrier
    ds_read_b32 v5, v4
    s_waitcnt lgkmcnt(0)
    v_readfirstlane_b32 s20, v5
    s_barrier
    s_cmp_ge_u32 s20, 256
    s_cbranch_scc1 R_exit
    s_lshr_b32 s4, s20, 5
    s_and_b32 s20, s20, 31
    s_mov_b32 s33, 0
    s_branch R_disp
R_c8:
    v_mov_b32 v133, 163776
    s_cmp_lg_u32 s3, 0
    s_cbranch_scc1 R_c8b
    s_mov_b32 s31, 0
    s_sleep 8
R_c8l:
    v_mov_b32 v135, 0
    s_mov_b64 exec, 1
    buffer_atomic_or v135, v134, s[12:15], s5 offen sc0 sc1
    s_mov_b64 exec, -1
    s_waitcnt vmcnt(0)
    v_readfirstlane_b32 s6, v135
    s_lshr_b32 s6, s6, s7
    s_and_b32 s6, s6, 0xff
    s_bcnt1_i32_b32 s21, s6
    s_add_u32 s31, s31, 1
    s_cmp_ge_u32 s31, 40
    s_cselect_b32 s21, 8, s21
    s_cmp_lt_u32 s21, 7
    s_cbranch_scc1 R_c8l
    s_ff0_i32_b32 s6, s6
    s_add_u32 s6, s6, s7
    s_cmp_eq_u32 s21, 7
    s_cselect_b32 s20, s6, s20
    v_mov_b32 v135, s20
    ds_write_b32 v133, v135
    s_waitcnt lgkmcnt(0)
R_c8b:
    s_barrier
    ds_read_b32 v135, v133
    s_waitcnt lgkmcnt(0)
    v_readfirstlane_b32 s20, v135
    s_barrier
    s_branch R_clm
R_done:
    s_waitcnt vmcnt(0)
R_exit:
    s_endpgm
.section .rodata,"a"
.p2align 6
.amdhsa_kernel rec_kernel
  .amdhsa_next_free_vgpr 512
  .amdhsa_next_free_sgpr 102
  .amdhsa_accum_offset 256
  .amdhsa_group_segment_fixed_size 0
  .amdhsa_kernarg_size 136
  .amdhsa_user_sgpr_count 2
  .amdhsa_user_sgpr_kernarg_segment_ptr 1
  .amdhsa_system_sgpr_workgroup_id_x 1
.end_amdhsa_kernel
```

```asm
; @launch kernel=rec_kernel grid=(256,1,1) block=(256,1,1) lds=163840
.amdgcn_target "amdgcn-amd-amdhsa--gfx950"
.text
.globl rec_kernel
.p2align 8
.type rec_kernel,@function
rec_kernel:
    s_cmp_ge_u32 s2, 256
    s_cbranch_scc1 R_exit
    s_load_dwordx2 s[8:9], s[0:1], 128
    s_load_dwordx2 s[12:13], s[0:1], 120
    s_mov_b32 s10, 268435456
    s_mov_b32 s11, 0x20000
    s_mov_b32 s14, 256
    s_mov_b32 s15, 0x20000
    s_waitcnt lgkmcnt(0)
    s_getreg_b32 s4, hwreg(HW_REG_XCC_ID)
    s_getreg_b32 s5, hwreg(HW_REG_HW_ID)
    s_and_b32 s4, s4, 7
    s_bfe_u32 s20, s5, 0x30008
    s_bfe_u32 s6, s5, 0x1000b
    s_bfe_u32 s5, s5, 131085
    s_lshl_b32 s7, s5, 3
    s_add_u32 s20, s20, s7
    v_and_b32 v1, 63, v0
    v_lshrrev_b32 v2, 6, v0
    s_nop 0
    v_readfirstlane_b32 s3, v2
    s_mov_b32 s30, 65536
    s_lshl_b32 s5, s4, 5
    v_mov_b32 v134, 0
    s_cmp_lg_u32 s6, 0
    s_cbranch_scc1 R_c8
R_clm:
    s_lshl_b32 s33, 1, s20
    s_cmp_lg_u32 s3, 0
    s_cbranch_scc1 R_disp
    v_mov_b32 v135, s33
    s_mov_b64 exec, 1
    buffer_atomic_or v135, v134, s[12:15], s5 offen sc0 sc1
    s_mov_b64 exec, -1
R_disp:
    s_mov_b32 s99, s4
    s_lshl_b32 s51, s4, 5
    s_add_u32 s51, s51, s20
    s_mov_b32 s82, 0
    s_cmp_ge_u32 s20, 28
    s_cbranch_scc1 R_x
    s_cmp_ge_u32 s20, 18
    s_cbranch_scc1 R_c
    s_cmp_ge_u32 s20, 12
    s_cbranch_scc1 R_v
    v_lshlrev_b32 v2, 4, v1
    s_load_dwordx2 s[12:13], s[0:1], 16
    s_load_dwordx2 s[16:17], s[0:1], 24
    s_mov_b32 s14, 7864320
    s_mov_b32 s15, 0x20000
    s_mov_b32 s18, 7864320
    s_mov_b32 s19, 0x20000
    s_waitcnt lgkmcnt(0)
    s_mul_i32 s42, s99, 12
    s_add_u32 s42, s42, s20
    s_lshl_b32 s42, s42, 7
    s_mov_b32 s47, s42
    s_lshl_b32 s37, s3, 11
    s_lshl_b32 s4, s3, 4
    s_and_b32 s5, s3, 1
    s_lshl_b32 s5, s5, 1
    v_lshrrev_b32 v60, 3, v1
    v_and_b32 v61, 1, v60
    v_or_b32 v61, s5, v61
    v_add_u32 v60, s4, v60
    v_mul_u32_u24 v13, 12288, v60
    v_bfe_u32 v60, v1, 1, 2
    v_xor_b32 v60, v60, v61
    v_lshlrev_b32 v60, 5, v60
    v_and_b32 v61, 1, v1
    v_lshlrev_b32 v61, 4, v61
    v_add3_u32 v13, v13, v60, v61
    v_lshrrev_b32 v60, 4, v1
    v_lshlrev_b32 v60, 2, v60
    v_bfe_u32 v61, v1, 2, 1
    v_add_u32 v60, v60, v61
    v_bfe_u32 v61, v1, 3, 1
    v_lshlrev_b32 v61, 4, v61
    v_add_u32 v60, v60, v61
    v_lshlrev_b32 v0, 7, v60
    v_bfe_u32 v60, v1, 2, 2
    v_lshlrev_b32 v60, 5, v60
    v_and_b32 v61, 3, v1
    v_lshlrev_b32 v61, 3, v61
    v_add3_u32 v0, v0, v60, v61
    v_mov_b32 v134, 163776
    s_cmp_lg_u32 s3, 0
    s_cbranch_scc1 SC_c
    s_waitcnt vmcnt(0)
    v_readfirstlane_b32 s4, v135
    s_and_b32 s4, s4, s33
    s_nop 0
    v_mov_b32 v135, s4
    ds_write_b32 v134, v135
    s_waitcnt lgkmcnt(0)
SC_c:
    s_barrier
    ds_read_b32 v135, v134
    s_waitcnt lgkmcnt(0)
    v_readfirstlane_b32 s4, v135
    s_cmp_lg_u32 s4, 0
    s_cbranch_scc1 R_ovf
    s_load_dwordx2 s[84:85], s[0:1], 120
    s_mov_b32 s86, 256
    s_mov_b32 s87, 0x20000
    s_waitcnt lgkmcnt(0)
    s_mul_i32 s22, s99, 1048576
    s_add_u32 s22, s22, 8388608
    s_lshl_b32 s33, s20, 4
    s_lshl_b32 s4, s3, 2
    s_add_u32 s33, s33, s4
    s_add_u32 s33, s33, s22
    s_add_u32 s33, s33, 155648
    s_mov_b32 s48, 0xfffffffe
    v_mov_b32 v9, 0
    v_mov_b32 v240, -1
    v_mov_b32 v241, -1
    v_mov_b32 v242, -1
    v_mov_b32 v243, -1
    v_and_b32 v16, 8, v1
    v_mov_b32 v5, 0x4444
    v_mov_b32 v17, 0xeeee
    v_cmp_ne_u32 vcc, 0, v16
    s_nop 1
    v_cndmask_b32 v5, v5, v17, vcc
    s_mul_i32 s4, s20, 43
    s_lshr_b32 s4, s4, 7
    s_mul_i32 s5, s4, 3
    s_sub_u32 s5, s20, s5
    s_lshl_b32 s4, s4, 12
    s_lshl_b32 s6, s5, 10
    s_add_u32 s6, s6, s4
    s_lshl_b32 s7, s3, 6
    s_add_u32 s6, s6, s7
    s_lshl_b32 s5, s5, 2
    s_add_u32 s5, s5, s4
    s_add_u32 s5, s5, 3072
    v_and_b32 v16, 7, v1
    v_lshrrev_b32 v17, 4, v1
    v_bfe_u32 v18, v1, 3, 1
    v_lshlrev_b32 v19, 7, v16
    v_mov_b32 v64, 0x80000000
    v_mov_b32 v65, 0x80000000
    v_mov_b32 v14, 0x80000000
    s_cmp_lt_u32 s3, 2
    s_cselect_b32 exec_lo, 0x00ff00ff, 0
    s_mov_b32 exec_hi, exec_lo
    v_lshl_add_u32 v64, v17, 4, v19
    v_add_u32 v64, s6, v64
    s_cmp_eq_u32 s3, 2
    s_cselect_b64 exec, -1, 0
    v_lshl_add_u32 v65, v17, 5, v19
    v_lshl_add_u32 v65, v18, 4, v65
    v_add_u32 v65, s5, v65
    s_cmp_eq_u32 s3, 3
    s_cselect_b64 exec, 1, 0
    v_mov_b32 v14, 0
    s_mov_b64 exec, -1
    s_add_u32 s24, s22, 40960
    s_add_u32 s5, s24, 16384
    s_mul_i32 s4, s20, 43
    s_lshr_b32 s4, s4, 7
    s_mul_i32 s4, s4, 61
    s_add_u32 s4, s4, s20
    s_lshl_b32 s4, s4, 2
    s_add_u32 s44, s4, s22
    s_add_u32 s44, s44, 156800
    buffer_store_dwordx4 v[240:243], v64, s[8:11], s24 offen offset:0 sc1
    buffer_store_dword v240, v65, s[8:11], s24 offen offset:0 sc1
    buffer_store_dwordx4 v[240:243], v64, s[8:11], s5 offen offset:0 sc1
    buffer_store_dword v240, v65, s[8:11], s5 offen offset:0 sc1
    buffer_store_dword v9, v14, s[8:11], s44 offen offset:0 sc1
    v_mov_b32 v10, 0
    s_mov_b64 exec, 1
    buffer_store_dword v10, v9, s[8:11], s33 offen sc1
    s_mov_b64 exec, -1
    v_and_b32 v16, 15, v1
    v_lshrrev_b32 v17, 4, v1
    v_and_b32 v18, 1, v17
    v_lshlrev_b32 v18, 2, v18
    v_sub_u32 v18, v16, v18
    v_mov_b32 v19, 0x3f80
    v_mov_b32 v20, 0x3f800000
    v_cmp_eq_u32 vcc, 0, v18
    s_nop 1
    v_cndmask_b32 v84, 0, v19, vcc
    v_cmp_eq_u32 vcc, 1, v18
    s_nop 1
    v_cndmask_b32 v84, v84, v20, vcc
    v_cmp_eq_u32 vcc, 2, v18
    s_nop 1
    v_cndmask_b32 v85, 0, v19, vcc
    v_cmp_eq_u32 vcc, 3, v18
    s_nop 1
    v_cndmask_b32 v85, v85, v20, vcc
    v_cmp_eq_u32 vcc, 8, v18
    s_nop 1
    v_cndmask_b32 v86, 0, v19, vcc
    v_cmp_eq_u32 vcc, 9, v18
    s_nop 1
    v_cndmask_b32 v86, v86, v20, vcc
    v_cmp_eq_u32 vcc, 10, v18
    s_nop 1
    v_cndmask_b32 v87, 0, v19, vcc
    v_cmp_eq_u32 vcc, 11, v18
    s_nop 1
    v_cndmask_b32 v87, v87, v20, vcc
    s_lshl_b32 s4, s3, 11
    s_add_u32 s4, s4, 73728
    v_add_u32 v3, s4, v2
    s_lshl_b32 s4, s3, 9
    s_add_u32 s4, s4, 90112
    v_lshl_add_u32 v4, v1, 3, s4
    s_mul_i32 s4, s3, 640
    s_add_u32 s4, s4, 92160
    v_mul_u32_u24 v7, 40, v16
    v_lshl_add_u32 v7, v17, 3, v7
    v_add_u32 v7, s4, v7
    v_lshrrev_b32 v18, 2, v1
    v_mul_u32_u24 v18, 40, v18
    v_add_u32 v18, 92160, v18
    v_and_b32 v19, 1, v1
    v_lshl_add_u32 v8, v19, 3, v18
    s_cmp_eq_u32 s3, 2
    s_cselect_b32 s4, 1, 0
    v_bfe_u32 v19, v1, s4, 1
    v_lshl_add_u32 v6, v19, 3, v18
    s_lshr_b32 s4, s3, 1
    s_lshl_b32 s4, s4, 10
    s_and_b32 s5, s3, 1
    s_lshl_b32 s5, s5, 3
    s_add_u32 s4, s4, s5
    s_add_u32 s4, s4, 96256
    v_add_u32 v12, s4, v2
    s_lshl_b32 s4, s3, 2
    s_lshr_b32 s5, 0x0232, s4
    s_and_b32 s5, s5, 3
    s_lshl_b32 s5, s5, 11
    s_add_u32 s5, s5, 96256
    v_add_u32 v15, s5, v2
    s_min_u32 s5, s3, 1
    s_lshl_b32 s5, s5, 11
    s_add_u32 s5, s5, 96256
    v_add_u32 v62, s5, v2
    s_lshr_b32 s5, 0x3120, s4
    s_and_b32 s5, s5, 3
    s_lshl_b32 s5, s5, 10
    s_lshl_b32 s36, s20, 12
    s_add_u32 s36, s36, s5
    s_add_u32 s36, s36, s22
    s_add_u32 s36, s36, 356352
    s_cmp_eq_u32 s3, 3
    s_cselect_b32 s5, 0x80000000, 0
    v_add_u32 v63, s5, v2
    s_lshl_b32 s4, s20, 2
    s_add_u32 s4, s4, s3
    s_lshr_b32 s5, s4, 3
    s_lshl_b32 s5, s5, 14
    s_and_b32 s6, s4, 7
    s_lshl_b32 s6, s6, 10
    s_add_u32 s5, s5, s6
    s_and_b32 s6, s99, 3
    s_mul_i32 s6, s6, 81920
    s_add_u32 s5, s5, s6
    s_and_b32 s6, s99, 4
    s_lshl_b32 s6, s6, 11
    s_add_u32 s5, s5, s6
    s_add_u32 s46, s5, 48758784
    s_cmp_lt_u32 s4, 40
    s_cselect_b32 s45, 7, 0
    s_cselect_b32 s88, 20, 99
    s_mul_i32 s5, s99, 40
    s_add_u32 s5, s5, s4
    s_lshl_b32 s5, s5, 10
    s_cmp_lt_u32 s5, 163840
    s_cselect_b32 s6, 0, 2457600
    s_add_u32 s5, s5, s6
    s_add_u32 s89, s5, 59080704
    s_mov_b32 s40, 0xff00ff00
    s_mov_b32 s41, 0xff00ff00
    s_mov_b32 s90, 0xffff0000
    s_mov_b32 s91, 0xffff0000
    s_waitcnt vmcnt(0)
    s_barrier
    s_cmp_lg_u32 s3, 0
    s_cbranch_scc1 SA_n
    s_lshl_b32 s4, s99, 5
    s_add_u32 s4, s4, 4
    v_mov_b32 v16, 0
    v_mov_b32 v17, 1
    s_mov_b64 exec, 1
    buffer_atomic_add v17, v16, s[84:87], s4 offen sc1
    s_mov_b64 exec, -1
SA_n:
    s_add_u32 s4, s42, 0
    s_add_u32 m0, s37, 0
    s_nop 0
    buffer_load_dwordx4 v13, s[12:15], s4 offen nt lds
    s_add_u32 s4, s42, 98304
    s_add_u32 m0, s37, 1024
    s_nop 0
    buffer_load_dwordx4 v13, s[12:15], s4 offen nt lds
    s_waitcnt vmcnt(2)
    s_add_u32 s4, s47, 0
    s_add_u32 m0, s37, 81920
    s_nop 0
    buffer_load_dwordx4 v13, s[16:19], s4 offen nt lds
    s_add_u32 s4, s47, 98304
    s_add_u32 m0, s37, 82944
    s_nop 0
    buffer_load_dwordx4 v13, s[16:19], s4 offen nt lds
    s_waitcnt vmcnt(2)
    s_add_u32 s4, s42, 786432
    s_add_u32 m0, s37, 8192
    s_nop 0
    buffer_load_dwordx4 v13, s[12:15], s4 offen nt lds
    s_add_u32 s4, s42, 884736
    s_add_u32 m0, s37, 9216
    s_nop 0
    buffer_load_dwordx4 v13, s[12:15], s4 offen nt lds
    s_waitcnt vmcnt(2)
    s_add_u32 s4, s47, 786432
    s_add_u32 m0, s37, 90112
    s_nop 0
    buffer_load_dwordx4 v13, s[16:19], s4 offen nt lds
    s_add_u32 s4, s47, 884736
    s_add_u32 m0, s37, 91136
    s_nop 0
    buffer_load_dwordx4 v13, s[16:19], s4 offen nt lds
    s_waitcnt vmcnt(2)
    s_add_u32 s4, s42, 1572864
    s_add_u32 m0, s37, 16384
    s_nop 0
    buffer_load_dwordx4 v13, s[12:15], s4 offen nt lds
    s_add_u32 s4, s42, 1671168
    s_add_u32 m0, s37, 17408
    s_nop 0
    buffer_load_dwordx4 v13, s[12:15], s4 offen nt lds
    s_waitcnt vmcnt(2)
    s_add_u32 s4, s47, 1572864
    s_add_u32 m0, s37, 98304
    s_nop 0
    buffer_load_dwordx4 v13, s[16:19], s4 offen nt lds
    s_add_u32 s4, s47, 1671168
    s_add_u32 m0, s37, 99328
    s_nop 0
    buffer_load_dwordx4 v13, s[16:19], s4 offen nt lds
    s_waitcnt vmcnt(2)
    s_add_u32 s4, s42, 2359296
    s_add_u32 m0, s37, 24576
    s_nop 0
    buffer_load_dwordx4 v13, s[12:15], s4 offen nt lds
    s_add_u32 s4, s42, 2457600
    s_add_u32 m0, s37, 25600
    s_nop 0
    buffer_load_dwordx4 v13, s[12:15], s4 offen nt lds
    s_waitcnt vmcnt(2)
    s_add_u32 s4, s47, 2359296
    s_add_u32 m0, s37, 106496
    s_nop 0
    buffer_load_dwordx4 v13, s[16:19], s4 offen nt lds
    s_add_u32 s4, s47, 2457600
    s_add_u32 m0, s37, 107520
    s_nop 0
    buffer_load_dwordx4 v13, s[16:19], s4 offen nt lds
    s_waitcnt vmcnt(2)
    s_add_u32 s4, s42, 3145728
    s_add_u32 m0, s37, 32768
    s_nop 0
    buffer_load_dwordx4 v13, s[12:15], s4 offen nt lds
    s_add_u32 s4, s42, 3244032
    s_add_u32 m0, s37, 33792
    s_nop 0
    buffer_load_dwordx4 v13, s[12:15], s4 offen nt lds
    s_waitcnt vmcnt(2)
    s_add_u32 s4, s47, 3145728
    s_add_u32 m0, s37, 114688
    s_nop 0
    buffer_load_dwordx4 v13, s[16:19], s4 offen nt lds
    s_add_u32 s4, s47, 3244032
    s_add_u32 m0, s37, 115712
    s_nop 0
    buffer_load_dwordx4 v13, s[16:19], s4 offen nt lds
    s_waitcnt vmcnt(2)
    v_and_b32 v16, 7, v1
    v_lshlrev_b32 v16, 5, v16
    buffer_load_dwordx4 v[20:23], v16, s[84:87], 0 offen sc1
    s_add_u32 s4, s42, 3932160
    s_add_u32 m0, s37, 40960
    s_nop 0
    buffer_load_dwordx4 v13, s[12:15], s4 offen nt lds
    s_add_u32 s4, s42, 4030464
    s_add_u32 m0, s37, 41984
    s_nop 0
    buffer_load_dwordx4 v13, s[12:15], s4 offen nt lds
    s_add_u32 s4, s47, 3932160
    s_add_u32 m0, s37, 122880
    s_nop 0
    buffer_load_dwordx4 v13, s[16:19], s4 offen nt lds
    s_add_u32 s4, s47, 4030464
    s_add_u32 m0, s37, 123904
    s_nop 0
    buffer_load_dwordx4 v13, s[16:19], s4 offen nt lds
    s_add_u32 s4, s42, 4718592
    s_add_u32 m0, s37, 49152
    s_nop 0
    buffer_load_dwordx4 v13, s[12:15], s4 offen nt lds
    s_add_u32 s4, s42, 4816896
    s_add_u32 m0, s37, 50176
    s_nop 0
    buffer_load_dwordx4 v13, s[12:15], s4 offen nt lds
    s_add_u32 s4, s47, 4718592
    s_add_u32 m0, s37, 131072
    s_nop 0
    buffer_load_dwordx4 v13, s[16:19], s4 offen nt lds
    s_add_u32 s4, s47, 4816896
    s_add_u32 m0, s37, 132096
    s_nop 0
    buffer_load_dwordx4 v13, s[16:19], s4 offen nt lds
    s_add_u32 s4, s42, 5505024
    s_add_u32 m0, s37, 57344
    s_nop 0
    buffer_load_dwordx4 v13, s[12:15], s4 offen nt lds
    s_add_u32 s4, s42, 5603328
    s_add_u32 m0, s37, 58368
    s_nop 0
    buffer_load_dwordx4 v13, s[12:15], s4 offen nt lds
    s_add_u32 s4, s47, 5505024
    s_add_u32 m0, s37, 139264
    s_nop 0
    buffer_load_dwordx4 v13, s[16:19], s4 offen nt lds
    s_add_u32 s4, s47, 5603328
    s_add_u32 m0, s37, 140288
    s_nop 0
    buffer_load_dwordx4 v13, s[16:19], s4 offen nt lds
    s_add_u32 s4, s42, 6291456
    s_add_u32 m0, s37, 65536
    s_nop 0
    buffer_load_dwordx4 v13, s[12:15], s4 offen nt lds
    s_add_u32 s4, s42, 6389760
    s_add_u32 m0, s37, 66560
    s_nop 0
    buffer_load_dwordx4 v13, s[12:15], s4 offen nt lds
    s_add_u32 s4, s47, 6291456
    s_add_u32 m0, s37, 147456
    s_nop 0
    buffer_load_dwordx4 v13, s[16:19], s4 offen nt lds
    s_add_u32 s4, s47, 6389760
    s_add_u32 m0, s37, 148480
    s_nop 0
    buffer_load_dwordx4 v13, s[16:19], s4 offen nt lds
    s_mov_b32 s31, 0
    s_waitcnt vmcnt(16)
    s_branch SI_c
SI_l:
    buffer_load_dwordx4 v[20:23], v16, s[84:87], 0 offen sc1
    s_waitcnt vmcnt(0)
SI_c:
    v_bcnt_u32_b32 v17, v20, v23
    v_cmp_lt_u32 s[4:5], 32, v17
    s_and_b32 s6, s4, 0xff
    v_cmp_ne_u32 s[4:5], 32, v17
    s_cmp_eq_u32 s6, 0
    s_cselect_b32 s5, 0xff, 0
    s_and_b32 s4, s4, s5
    v_cmp_gt_u32 vcc, 22, v21
    s_and_b32 vcc_lo, vcc_lo, 0xff
    s_or_b32 vcc_lo, vcc_lo, s4
    s_mov_b32 vcc_hi, 0
    s_cbranch_vccz SI_o
    s_sleep 16
    s_add_u32 s31, s31, 1
    s_cmp_lt_u32 s31, s30
    s_cbranch_scc1 SI_l
    s_mov_b32 s30, 1
SI_o:
    s_mov_b32 s97, s6
    v_and_b32 v67, 3, v1
    v_lshlrev_b32 v67, 7, v67
    s_mov_b32 s23, 65536
    buffer_load_dword v68, v67, s[8:11], s23 offen offset:0 sc1
    s_add_u32 s4, s42, 7077888
    s_add_u32 m0, s37, 73728
    s_nop 0
    buffer_load_dwordx4 v13, s[12:15], s4 offen nt lds
    s_add_u32 s4, s42, 7176192
    s_add_u32 m0, s37, 74752
    s_nop 0
    buffer_load_dwordx4 v13, s[12:15], s4 offen nt lds
    s_add_u32 s4, s47, 7077888
    s_add_u32 m0, s37, 155648
    s_nop 0
    buffer_load_dwordx4 v13, s[16:19], s4 offen nt lds
    s_add_u32 s4, s47, 7176192
    s_add_u32 m0, s37, 156672
    s_nop 0
    buffer_load_dwordx4 v13, s[16:19], s4 offen nt lds
    s_barrier
    s_lshl_b32 s4, s3, 5
    v_xor_b32 v60, s4, v0
    v_add_u32 v61, 81920, v60
    ds_read_b64_tr_b16 a[0:1], v60 offset:0
    ds_read_b64_tr_b16 a[2:3], v60 offset:256
    ds_read_b64_tr_b16 a[4:5], v60 offset:4096
    ds_read_b64_tr_b16 a[6:7], v60 offset:4352
    ds_read_b64_tr_b16 a[8:9], v60 offset:8192
    ds_read_b64_tr_b16 a[10:11], v60 offset:8448
    ds_read_b64_tr_b16 a[12:13], v60 offset:12288
    ds_read_b64_tr_b16 a[14:15], v60 offset:12544
    ds_read_b64_tr_b16 a[16:17], v60 offset:16384
    ds_read_b64_tr_b16 a[18:19], v60 offset:16640
    ds_read_b64_tr_b16 a[20:21], v60 offset:20480
    ds_read_b64_tr_b16 a[22:23], v60 offset:20736
    ds_read_b64_tr_b16 a[24:25], v60 offset:24576
    ds_read_b64_tr_b16 a[26:27], v60 offset:24832
    ds_read_b64_tr_b16 a[28:29], v60 offset:28672
    ds_read_b64_tr_b16 a[30:31], v60 offset:28928
    ds_read_b64_tr_b16 a[32:33], v60 offset:32768
    ds_read_b64_tr_b16 a[34:35], v60 offset:33024
    ds_read_b64_tr_b16 a[36:37], v60 offset:36864
    ds_read_b64_tr_b16 a[38:39], v60 offset:37120
    ds_read_b64_tr_b16 a[80:81], v61 offset:0
    ds_read_b64_tr_b16 a[82:83], v61 offset:256
    ds_read_b64_tr_b16 a[84:85], v61 offset:4096
    ds_read_b64_tr_b16 a[86:87], v61 offset:4352
    ds_read_b64_tr_b16 a[88:89], v61 offset:8192
    ds_read_b64_tr_b16 a[90:91], v61 offset:8448
    ds_read_b64_tr_b16 a[92:93], v61 offset:12288
    ds_read_b64_tr_b16 a[94:95], v61 offset:12544
    ds_read_b64_tr_b16 a[96:97], v61 offset:16384
    ds_read_b64_tr_b16 a[98:99], v61 offset:16640
    ds_read_b64_tr_b16 a[100:101], v61 offset:20480
    ds_read_b64_tr_b16 a[102:103], v61 offset:20736
    ds_read_b64_tr_b16 a[104:105], v61 offset:24576
    ds_read_b64_tr_b16 a[106:107], v61 offset:24832
    ds_read_b64_tr_b16 a[108:109], v61 offset:28672
    ds_read_b64_tr_b16 a[110:111], v61 offset:28928
    ds_read_b64_tr_b16 a[112:113], v61 offset:32768
    ds_read_b64_tr_b16 a[114:115], v61 offset:33024
    ds_read_b64_tr_b16 a[116:117], v61 offset:36864
    ds_read_b64_tr_b16 a[118:119], v61 offset:37120
    s_mul_i32 s27, s3, 10240
    s_add_u32 s28, s27, 16777216
    s_mov_b32 s29, 0
    s_mov_b32 s21, 0
    s_mov_b32 s32, 0
    s_mov_b32 s31, 0
    s_waitcnt vmcnt(4)
    s_branch SH_c
SH_l:
    buffer_load_dword v68, v67, s[8:11], s23 offen sc1
    s_waitcnt vmcnt(0)
SH_c:
    v_cmp_gt_u32 vcc, 1, v68
    s_cbranch_vccz SH_o
    s_sleep 4
    s_add_u32 s31, s31, 1
    s_cmp_lt_u32 s31, s30
    s_cbranch_scc1 SH_l
    s_mov_b32 s30, 1
SH_o:
    s_waitcnt lgkmcnt(0)
    s_barrier
    v_and_b32 v16, 7, v1
    v_lshlrev_b32 v16, 5, v16
    buffer_load_dwordx4 v[20:23], v16, s[84:87], 0 offen sc1
    s_add_u32 s35, s28, 0
    s_add_u32 m0, s27, 0
    s_nop 0
    buffer_load_dwordx4 v2, s[8:11], s35 offen offset:0 sc1 lds
    buffer_load_dwordx4 v2, s[8:11], s35 offen offset:1024 sc1 lds
    buffer_load_dwordx4 v2, s[8:11], s35 offen offset:2048 sc1 lds
    buffer_load_dwordx4 v2, s[8:11], s35 offen offset:3072 sc1 lds
    s_add_u32 s35, s28, 4096
    s_add_u32 m0, s27, 4096
    s_nop 0
    buffer_load_dwordx4 v2, s[8:11], s35 offen offset:0 sc1 lds
    buffer_load_dwordx4 v2, s[8:11], s35 offen offset:1024 sc1 lds
    buffer_load_dwordx4 v2, s[8:11], s35 offen offset:2048 sc1 lds
    buffer_load_dwordx4 v2, s[8:11], s35 offen offset:3072 sc1 lds
    s_add_u32 s35, s28, 8192
    s_add_u32 m0, s27, 8192
    s_nop 0
    buffer_load_dwordx4 v2, s[8:11], s35 offen offset:0 sc1 lds
    buffer_load_dwordx4 v2, s[8:11], s35 offen offset:1024 sc1 lds
    s_waitcnt vmcnt(11)
    s_barrier
    ds_read_b64_tr_b16 a[40:41], v60 offset:40960
    ds_read_b64_tr_b16 a[42:43], v60 offset:41216
    ds_read_b64_tr_b16 a[44:45], v60 offset:45056
    ds_read_b64_tr_b16 a[46:47], v60 offset:45312
    ds_read_b64_tr_b16 a[48:49], v60 offset:49152
    ds_read_b64_tr_b16 a[50:51], v60 offset:49408
    ds_read_b64_tr_b16 a[52:53], v60 offset:53248
    ds_read_b64_tr_b16 a[54:55], v60 offset:53504
    ds_read_b64_tr_b16 a[56:57], v60 offset:57344
    ds_read_b64_tr_b16 a[58:59], v60 offset:57600
    ds_read_b64_tr_b16 a[60:61], v60 offset:61440
    ds_read_b64_tr_b16 a[62:63], v60 offset:61696
    v_add_u32 v60, 65536, v60
    ds_read_b64_tr_b16 a[64:65], v60 offset:0
    ds_read_b64_tr_b16 a[66:67], v60 offset:256
    ds_read_b64_tr_b16 a[68:69], v60 offset:4096
    ds_read_b64_tr_b16 a[70:71], v60 offset:4352
    ds_read_b64_tr_b16 a[72:73], v60 offset:8192
    ds_read_b64_tr_b16 a[74:75], v60 offset:8448
    ds_read_b64_tr_b16 a[76:77], v60 offset:12288
    ds_read_b64_tr_b16 a[78:79], v60 offset:12544
    ds_read_b64_tr_b16 a[120:121], v61 offset:40960
    ds_read_b64_tr_b16 a[122:123], v61 offset:41216
    ds_read_b64_tr_b16 a[124:125], v61 offset:45056
    ds_read_b64_tr_b16 a[126:127], v61 offset:45312
    ds_read_b64_tr_b16 a[128:129], v61 offset:49152
    ds_read_b64_tr_b16 a[130:131], v61 offset:49408
    ds_read_b64_tr_b16 a[132:133], v61 offset:53248
    ds_read_b64_tr_b16 a[134:135], v61 offset:53504
    ds_read_b64_tr_b16 a[136:137], v61 offset:57344
    ds_read_b64_tr_b16 a[138:139], v61 offset:57600
    ds_read_b64_tr_b16 a[140:141], v61 offset:61440
    ds_read_b64_tr_b16 a[142:143], v61 offset:61696
    v_add_u32 v61, 65536, v61
    ds_read_b64_tr_b16 a[144:145], v61 offset:0
    ds_read_b64_tr_b16 a[146:147], v61 offset:256
    ds_read_b64_tr_b16 a[148:149], v61 offset:4096
    ds_read_b64_tr_b16 a[150:151], v61 offset:4352
    ds_read_b64_tr_b16 a[152:153], v61 offset:8192
    ds_read_b64_tr_b16 a[154:155], v61 offset:8448
    ds_read_b64_tr_b16 a[156:157], v61 offset:12288
    ds_read_b64_tr_b16 a[158:159], v61 offset:12544
    s_mov_b32 s31, 0
    s_waitcnt vmcnt(10)
    s_branch SJ_c
SJ_l:
    buffer_load_dwordx4 v[20:23], v16, s[84:87], 0 offen sc1
    s_waitcnt vmcnt(0)
SJ_c:
    v_bcnt_u32_b32 v17, v20, v23
    v_cmp_lt_u32 s[4:5], 32, v17
    s_and_b32 s6, s4, 0xff
    v_cmp_ne_u32 s[4:5], 32, v17
    s_cmp_eq_u32 s6, 0
    s_cselect_b32 s5, 0xff, 0
    s_and_b32 s4, s4, s5
    v_add_u32 v21, v21, v22
    v_cmp_gt_u32 vcc, 32, v21
    s_and_b32 vcc_lo, vcc_lo, 0xff
    s_or_b32 vcc_lo, vcc_lo, s4
    s_mov_b32 vcc_hi, 0
    s_cbranch_vccz SJ_o
    s_sleep 16
    s_add_u32 s31, s31, 1
    s_cmp_lt_u32 s31, s30
    s_cbranch_scc1 SJ_l
    s_mov_b32 s30, 1
SJ_o:
    s_mov_b32 s97, s6
    v_min_u32 v67, 39, v1
    v_lshlrev_b32 v67, 7, v67
    v_min_u32 v70, 3968, v67
    s_mov_b32 s49, 65536
    s_mov_b32 s23, 69632
    s_mov_b32 s47, 74752
    s_waitcnt lgkmcnt(0)
    s_barrier
    s_add_u32 s28, s28, 40960
    s_cmp_lg_u32 s97, 0
    s_cbranch_scc1 Ss_go
Sf_go:
    s_waitcnt vmcnt(0)
    s_barrier
    v_add_u32 v11, s29, v2
    s_xor_b32 s29, s29, 40960
    s_add_u32 s42, s29, s27
    ds_read_b128 a[160:163], v11 offset:0
    ds_read_b128 a[164:167], v11 offset:20480
    ds_read_b128 a[168:171], v11 offset:1024
    ds_read_b128 a[172:175], v11 offset:21504
    ds_read_b128 a[176:179], v11 offset:2048
    ds_read_b128 a[180:183], v11 offset:22528
    s_waitcnt lgkmcnt(5)
    v_mfma_f32_16x16x32_bf16 v[144:147], a[0:3], a[160:163], 0
    ds_read_b128 a[184:187], v11 offset:3072
    v_mfma_f32_16x16x32_bf16 v[152:155], a[80:83], a[160:163], 0
    s_waitcnt lgkmcnt(5)
    v_mfma_f32_16x16x32_bf16 v[148:151], a[0:3], a[164:167], 0
    ds_read_b128 a[188:191], v11 offset:23552
    v_mfma_f32_16x16x32_bf16 v[156:159], a[80:83], a[164:167], 0
    s_waitcnt lgkmcnt(5)
    v_mfma_f32_16x16x32_bf16 v[144:147], a[4:7], a[168:171], v[144:147]
    ds_read_b128 a[160:163], v11 offset:4096
    s_add_u32 s35, s28, 0
    s_add_u32 m0, s42, 0
    v_mfma_f32_16x16x32_bf16 v[152:155], a[84:87], a[168:171], v[152:155]
    buffer_load_dwordx4 v2, s[8:11], s35 offen offset:0 sc1 lds
    s_waitcnt lgkmcnt(5)
    v_mfma_f32_16x16x32_bf16 v[148:151], a[4:7], a[172:175], v[148:151]
    ds_read_b128 a[164:167], v11 offset:24576
    v_mfma_f32_16x16x32_bf16 v[156:159], a[84:87], a[172:175], v[156:159]
    s_waitcnt lgkmcnt(5)
    v_mfma_f32_16x16x32_bf16 v[144:147], a[8:11], a[176:179], v[144:147]
    ds_read_b128 a[168:171], v11 offset:5120
    v_mfma_f32_16x16x32_bf16 v[152:155], a[88:91], a[176:179], v[152:155]
    s_waitcnt lgkmcnt(5)
    v_mfma_f32_16x16x32_bf16 v[148:151], a[8:11], a[180:183], v[148:151]
    ds_read_b128 a[172:175], v11 offset:25600
    v_mfma_f32_16x16x32_bf16 v[156:159], a[88:91], a[180:183], v[156:159]
    buffer_load_dwordx4 v2, s[8:11], s35 offen offset:1024 sc1 lds
    s_waitcnt lgkmcnt(5)
    v_mfma_f32_16x16x32_bf16 v[144:147], a[12:15], a[184:187], v[144:147]
    ds_read_b128 a[176:179], v11 offset:6144
    v_mfma_f32_16x16x32_bf16 v[152:155], a[92:95], a[184:187], v[152:155]
    s_waitcnt lgkmcnt(5)
    v_mfma_f32_16x16x32_bf16 v[148:151], a[12:15], a[188:191], v[148:151]
    ds_read_b128 a[180:183], v11 offset:26624
    v_mfma_f32_16x16x32_bf16 v[156:159], a[92:95], a[188:191], v[156:159]
    s_waitcnt lgkmcnt(5)
    v_mfma_f32_16x16x32_bf16 v[144:147], a[16:19], a[160:163], v[144:147]
    ds_read_b128 a[184:187], v11 offset:7168
    v_mfma_f32_16x16x32_bf16 v[152:155], a[96:99], a[160:163], v[152:155]
    buffer_load_dwordx4 v2, s[8:11], s35 offen offset:2048 sc1 lds
    s_waitcnt lgkmcnt(5)
    v_mfma_f32_16x16x32_bf16 v[148:151], a[16:19], a[164:167], v[148:151]
    ds_read_b128 a[188:191], v11 offset:27648
    v_mfma_f32_16x16x32_bf16 v[156:159], a[96:99], a[164:167], v[156:159]
    s_waitcnt lgkmcnt(5)
    v_mfma_f32_16x16x32_bf16 v[144:147], a[20:23], a[168:171], v[144:147]
    ds_read_b128 a[160:163], v11 offset:8192
    v_mfma_f32_16x16x32_bf16 v[152:155], a[100:103], a[168:171], v[152:155]
    s_waitcnt lgkmcnt(5)
    v_mfma_f32_16x16x32_bf16 v[148:151], a[20:23], a[172:175], v[148:151]
    ds_read_b128 a[164:167], v11 offset:28672
    v_mfma_f32_16x16x32_bf16 v[156:159], a[100:103], a[172:175], v[156:159]
    buffer_load_dwordx4 v2, s[8:11], s35 offen offset:3072 sc1 lds
    s_waitcnt lgkmcnt(5)
    v_mfma_f32_16x16x32_bf16 v[144:147], a[24:27], a[176:179], v[144:147]
    ds_read_b128 a[168:171], v11 offset:9216
    v_mfma_f32_16x16x32_bf16 v[152:155], a[104:107], a[176:179], v[152:155]
    s_waitcnt lgkmcnt(5)
    v_mfma_f32_16x16x32_bf16 v[148:151], a[24:27], a[180:183], v[148:151]
    ds_read_b128 a[172:175], v11 offset:29696
    v_mfma_f32_16x16x32_bf16 v[156:159], a[104:107], a[180:183], v[156:159]
    s_waitcnt lgkmcnt(5)
    v_mfma_f32_16x16x32_bf16 v[144:147], a[28:31], a[184:187], v[144:147]
    ds_read_b128 a[176:179], v11 offset:10240
    s_add_u32 s35, s28, 4096
    s_add_u32 m0, s42, 4096
    v_mfma_f32_16x16x32_bf16 v[152:155], a[108:111], a[184:187], v[152:155]
    buffer_load_dwordx4 v2, s[8:11], s35 offen offset:0 sc1 lds
    s_waitcnt lgkmcnt(5)
    v_mfma_f32_16x16x32_bf16 v[148:151], a[28:31], a[188:191], v[148:151]
    ds_read_b128 a[180:183], v11 offset:30720
    v_mfma_f32_16x16x32_bf16 v[156:159], a[108:111], a[188:191], v[156:159]
    s_waitcnt lgkmcnt(5)
    v_mfma_f32_16x16x32_bf16 v[144:147], a[32:35], a[160:163], v[144:147]
    ds_read_b128 a[184:187], v11 offset:11264
    v_mfma_f32_16x16x32_bf16 v[152:155], a[112:115], a[160:163], v[152:155]
    s_waitcnt lgkmcnt(5)
    v_mfma_f32_16x16x32_bf16 v[148:151], a[32:35], a[164:167], v[148:151]
    ds_read_b128 a[188:191], v11 offset:31744
    v_mfma_f32_16x16x32_bf16 v[156:159], a[112:115], a[164:167], v[156:159]
    buffer_load_dwordx4 v2, s[8:11], s35 offen offset:1024 sc1 lds
    s_waitcnt lgkmcnt(5)
    v_mfma_f32_16x16x32_bf16 v[144:147], a[36:39], a[168:171], v[144:147]
    ds_read_b128 a[160:163], v11 offset:12288
    v_mfma_f32_16x16x32_bf16 v[152:155], a[116:119], a[168:171], v[152:155]
    s_waitcnt lgkmcnt(5)
    v_mfma_f32_16x16x32_bf16 v[148:151], a[36:39], a[172:175], v[148:151]
    ds_read_b128 a[164:167], v11 offset:32768
    v_mfma_f32_16x16x32_bf16 v[156:159], a[116:119], a[172:175], v[156:159]
    s_waitcnt lgkmcnt(5)
    v_mfma_f32_16x16x32_bf16 v[144:147], a[40:43], a[176:179], v[144:147]
    ds_read_b128 a[168:171], v11 offset:13312
    v_mfma_f32_16x16x32_bf16 v[152:155], a[120:123], a[176:179], v[152:155]
    buffer_load_dwordx4 v2, s[8:11], s35 offen offset:2048 sc1 lds
    s_waitcnt lgkmcnt(5)
    v_mfma_f32_16x16x32_bf16 v[148:151], a[40:43], a[180:183], v[148:151]
    ds_read_b128 a[172:175], v11 offset:33792
    v_mfma_f32_16x16x32_bf16 v[156:159], a[120:123], a[180:183], v[156:159]
    s_waitcnt lgkmcnt(5)
    v_mfma_f32_16x16x32_bf16 v[144:147], a[44:47], a[184:187], v[144:147]
    ds_read_b128 a[176:179], v11 offset:14336
    v_mfma_f32_16x16x32_bf16 v[152:155], a[124:127], a[184:187], v[152:155]
    s_waitcnt lgkmcnt(5)
    v_mfma_f32_16x16x32_bf16 v[148:151], a[44:47], a[188:191], v[148:151]
    ds_read_b128 a[180:183], v11 offset:34816
    v_mfma_f32_16x16x32_bf16 v[156:159], a[124:127], a[188:191], v[156:159]
    buffer_load_dwordx4 v2, s[8:11], s35 offen offset:3072 sc1 lds
    s_waitcnt lgkmcnt(5)
    v_mfma_f32_16x16x32_bf16 v[144:147], a[48:51], a[160:163], v[144:147]
    ds_read_b128 a[184:187], v11 offset:15360
    v_mfma_f32_16x16x32_bf16 v[152:155], a[128:131], a[160:163], v[152:155]
    s_waitcnt lgkmcnt(5)
    v_mfma_f32_16x16x32_bf16 v[148:151], a[48:51], a[164:167], v[148:151]
    ds_read_b128 a[188:191], v11 offset:35840
    v_mfma_f32_16x16x32_bf16 v[156:159], a[128:131], a[164:167], v[156:159]
    s_waitcnt lgkmcnt(5)
    v_mfma_f32_16x16x32_bf16 v[144:147], a[52:55], a[168:171], v[144:147]
    ds_read_b128 a[160:163], v11 offset:16384
    s_add_u32 s35, s28, 8192
    s_add_u32 m0, s42, 8192
    v_mfma_f32_16x16x32_bf16 v[152:155], a[132:135], a[168:171], v[152:155]
    buffer_load_dwordx4 v2, s[8:11], s35 offen offset:0 sc1 lds
    s_waitcnt lgkmcnt(5)
    v_mfma_f32_16x16x32_bf16 v[148:151], a[52:55], a[172:175], v[148:151]
    ds_read_b128 a[164:167], v11 offset:36864
    v_mfma_f32_16x16x32_bf16 v[156:159], a[132:135], a[172:175], v[156:159]
    s_waitcnt lgkmcnt(5)
    v_mfma_f32_16x16x32_bf16 v[144:147], a[56:59], a[176:179], v[144:147]
    ds_read_b128 a[168:171], v11 offset:17408
    v_mfma_f32_16x16x32_bf16 v[152:155], a[136:139], a[176:179], v[152:155]
    s_waitcnt lgkmcnt(5)
    v_mfma_f32_16x16x32_bf16 v[148:151], a[56:59], a[180:183], v[148:151]
    ds_read_b128 a[172:175], v11 offset:37888
    v_mfma_f32_16x16x32_bf16 v[156:159], a[136:139], a[180:183], v[156:159]
    buffer_load_dwordx4 v2, s[8:11], s35 offen offset:1024 sc1 lds
    s_waitcnt lgkmcnt(5)
    v_mfma_f32_16x16x32_bf16 v[144:147], a[60:63], a[184:187], v[144:147]
    ds_read_b128 a[176:179], v11 offset:18432
    v_mfma_f32_16x16x32_bf16 v[152:155], a[140:143], a[184:187], v[152:155]
    s_waitcnt lgkmcnt(5)
    v_mfma_f32_16x16x32_bf16 v[148:151], a[60:63], a[188:191], v[148:151]
    ds_read_b128 a[180:183], v11 offset:38912
    v_mfma_f32_16x16x32_bf16 v[156:159], a[140:143], a[188:191], v[156:159]
    s_waitcnt lgkmcnt(5)
    v_mfma_f32_16x16x32_bf16 v[144:147], a[64:67], a[160:163], v[144:147]
    ds_read_b128 a[184:187], v11 offset:19456
    v_mfma_f32_16x16x32_bf16 v[152:155], a[144:147], a[160:163], v[152:155]
    s_waitcnt lgkmcnt(5)
    v_mfma_f32_16x16x32_bf16 v[148:151], a[64:67], a[164:167], v[148:151]
    ds_read_b128 a[188:191], v11 offset:39936
    v_mfma_f32_16x16x32_bf16 v[156:159], a[144:147], a[164:167], v[156:159]
    s_waitcnt lgkmcnt(5)
    v_mfma_f32_16x16x32_bf16 v[144:147], a[68:71], a[168:171], v[144:147]
    v_mfma_f32_16x16x32_bf16 v[152:155], a[148:151], a[168:171], v[152:155]
    s_waitcnt lgkmcnt(4)
    v_mfma_f32_16x16x32_bf16 v[148:151], a[68:71], a[172:175], v[148:151]
    v_mfma_f32_16x16x32_bf16 v[156:159], a[148:151], a[172:175], v[156:159]
    s_waitcnt lgkmcnt(3)
    v_mfma_f32_16x16x32_bf16 v[144:147], a[72:75], a[176:179], v[144:147]
    v_mfma_f32_16x16x32_bf16 v[152:155], a[152:155], a[176:179], v[152:155]
    s_waitcnt lgkmcnt(2)
    v_mfma_f32_16x16x32_bf16 v[148:151], a[72:75], a[180:183], v[148:151]
    v_mfma_f32_16x16x32_bf16 v[156:159], a[152:155], a[180:183], v[156:159]
    s_waitcnt lgkmcnt(1)
    v_mfma_f32_16x16x32_bf16 v[144:147], a[76:79], a[184:187], v[144:147]
    v_mfma_f32_16x16x32_bf16 v[152:155], a[156:159], a[184:187], v[152:155]
    s_waitcnt lgkmcnt(0)
    v_mfma_f32_16x16x32_bf16 v[148:151], a[76:79], a[188:191], v[148:151]
    v_mfma_f32_16x16x32_bf16 v[156:159], a[156:159], a[188:191], v[156:159]
    s_add_u32 s28, s28, 40960
    s_add_u32 s32, s32, 1
    s_mov_b32 s31, 0
SfB0_l:
    buffer_load_dword v68, v70, s[8:11], s49 offen sc1
    s_waitcnt vmcnt(0)
SfB0_c:
    v_cmp_gt_u32 vcc, 1, v68
    s_cbranch_vccz SfB0_o
    s_sleep 2
    s_add_u32 s31, s31, 1
    s_cmp_lt_u32 s31, s30
    s_cbranch_scc1 SfB0_l
    s_mov_b32 s30, 1
SfB0_o:
    v_cvt_pk_bf16_f32 v160, v144, v145
    v_cvt_pk_bf16_f32 v161, v146, v147
    ds_write_b64 v12, v[160:161] offset:0
    v_cvt_pk_bf16_f32 v162, v148, v149
    v_cvt_pk_bf16_f32 v163, v150, v151
    ds_write_b64 v12, v[162:163] offset:2048
    v_cvt_pk_bf16_f32 v164, v152, v153
    v_cvt_pk_bf16_f32 v165, v154, v155
    ds_write_b64 v12, v[164:165] offset:4096
    v_cvt_pk_bf16_f32 v166, v156, v157
    v_cvt_pk_bf16_f32 v167, v158, v159
    ds_write_b64 v12, v[166:167] offset:6144
    s_and_b32 s4, s21, 3
    s_lshl_b32 s4, s4, 16
    s_add_u32 s34, s36, s4
    s_waitcnt lgkmcnt(0)
    s_barrier
    ds_read_b128 v[96:99], v15 offset:0
    ds_read_b128 v[104:107], v62 offset:0
    ds_read_b128 v[100:103], v15 offset:1024
    ds_read_b128 v[108:111], v62 offset:1024
    s_waitcnt lgkmcnt(2)
    v_mfma_f32_16x16x32_bf16 v[128:131], v[96:99], v[104:107], 0
    s_waitcnt lgkmcnt(0)
    v_mfma_f32_16x16x32_bf16 v[128:131], v[100:103], v[108:111], v[128:131]
    s_nop 7
    buffer_store_dwordx4 v[128:131], v63, s[8:11], s34 offen offset:0
Sf_loop:
    s_and_b32 s4, s21, 3
    s_mul_i32 s5, s4, 10240
    s_add_u32 s5, s5, s22
    s_sub_u32 s38, s5, 73728
    s_sub_u32 s39, s5, 81920
    s_mul_i32 s5, s4, 16384
    s_add_u32 s25, s24, s5
    s_xor_b32 s4, s4, 2
    s_mul_i32 s5, s4, 163840
    s_mul_i32 s5, s4, 16384
    s_add_u32 s26, s24, s5
    s_add_u32 s21, s21, 1
    v_mov_b32 v72, 0
    v_mov_b32 v73, 0
    v_mov_b32 v74, 0
    v_mov_b32 v75, 0
    v_mov_b32 v76, 0
    v_mov_b32 v77, 0
    v_mov_b32 v78, 0
    v_mov_b32 v79, 0
    v_mov_b32 v59, s21
    s_cmp_eq_u32 s3, 1
    s_cbranch_scc1 Sf_q1
    s_cmp_eq_u32 s3, 2
    s_cbranch_scc1 Sf_q2
    s_cmp_eq_u32 s3, 3
    s_cbranch_scc1 Sf_q3
Sf_q0:
    s_mov_b64 s[4:5], -1
    s_mov_b64 s[6:7], -1
    s_mov_b64 s[92:93], -1
    s_mov_b32 s31, -1
Sf0m_l:
    s_mov_b64 exec, s[4:5]
    buffer_load_dwordx4 v[16:19], v3, s[8:11], s38 offen offset:0 sc1
    s_mov_b64 exec, s[6:7]
    buffer_load_dwordx4 v[20:23], v3, s[8:11], s38 offen offset:1024 sc1
    s_mov_b64 exec, s[92:93]
    buffer_load_dwordx2 v[56:57], v4, s[8:11], s39 offen offset:0 sc1
    s_mov_b64 exec, -1
    s_add_u32 s31, s31, 1
    s_cmp_lt_u32 s31, s30
    s_cselect_b32 s30, s30, 1
    s_cbranch_scc0 Sf0m_o
    s_waitcnt vmcnt(0)
    v_max3_u32 v58, v16, v17, v18
    v_max3_u32 v60, v20, v21, v22
    v_max_u32 v61, v56, v57
    v_max_u32 v58, v58, v19
    v_max_u32 v60, v60, v23
    v_cmp_eq_u32 s[92:93], -1, v61
    v_cmp_eq_u32 s[4:5], -1, v58
    v_cmp_eq_u32 s[6:7], -1, v60
    s_or_b64 s[94:95], s[92:93], s[4:5]
    s_or_b64 s[94:95], s[94:95], s[6:7]
    s_cbranch_scc1 Sf0m_l
Sf0m_o:
    ds_write_b128 v3, v[16:19] offset:8192
    ds_write_b128 v3, v[20:23] offset:9216
    ds_write_b64 v4, v[56:57]
    v_smfmac_f32_16x16x64_bf16 v[72:75], v[16:19], a[0:7], v5
    v_smfmac_f32_16x16x64_bf16 v[76:79], v[16:19], a[80:87], v5
    s_waitcnt lgkmcnt(0)
    s_barrier
    ds_read_b128 v[24:27], v3 offset:10240
    ds_read_b128 v[28:31], v3 offset:11264
    ds_read_b128 v[32:35], v3 offset:12288
    v_smfmac_f32_16x16x64_bf16 v[72:75], v[20:23], a[8:15], v5
    ds_read_b128 v[36:39], v3 offset:13312
    ds_read_b128 v[40:43], v3 offset:14336
    v_smfmac_f32_16x16x64_bf16 v[76:79], v[20:23], a[88:95], v5
    ds_read_b128 v[44:47], v3 offset:15360
    ds_read_b128 v[48:51], v3 offset:16384
    ds_read_b128 v[52:55], v3 offset:17408
    s_waitcnt lgkmcnt(7)
    v_smfmac_f32_16x16x64_bf16 v[72:75], v[24:27], a[16:23], v5
    v_smfmac_f32_16x16x64_bf16 v[76:79], v[24:27], a[96:103], v5
    s_waitcnt lgkmcnt(6)
    v_smfmac_f32_16x16x64_bf16 v[72:75], v[28:31], a[24:31], v5
    v_smfmac_f32_16x16x64_bf16 v[76:79], v[28:31], a[104:111], v5
    s_waitcnt lgkmcnt(5)
    v_smfmac_f32_16x16x64_bf16 v[72:75], v[32:35], a[32:39], v5
    v_smfmac_f32_16x16x64_bf16 v[76:79], v[32:35], a[112:119], v5
    s_waitcnt lgkmcnt(4)
    v_smfmac_f32_16x16x64_bf16 v[72:75], v[36:39], a[40:47], v5
    v_smfmac_f32_16x16x64_bf16 v[76:79], v[36:39], a[120:127], v5
    s_waitcnt lgkmcnt(3)
    v_smfmac_f32_16x16x64_bf16 v[72:75], v[40:43], a[48:55], v5
    v_smfmac_f32_16x16x64_bf16 v[76:79], v[40:43], a[128:135], v5
    s_waitcnt lgkmcnt(2)
    v_smfmac_f32_16x16x64_bf16 v[72:75], v[44:47], a[56:63], v5
    v_smfmac_f32_16x16x64_bf16 v[76:79], v[44:47], a[136:143], v5
    s_waitcnt lgkmcnt(1)
    v_smfmac_f32_16x16x64_bf16 v[72:75], v[48:51], a[64:71], v5
    v_smfmac_f32_16x16x64_bf16 v[76:79], v[48:51], a[144:151], v5
    s_waitcnt lgkmcnt(0)
    v_smfmac_f32_16x16x64_bf16 v[72:75], v[52:55], a[72:79], v5
    v_smfmac_f32_16x16x64_bf16 v[76:79], v[52:55], a[152:159], v5
    s_nop 7
    v_permlane32_swap_b32 v72, v76
    v_permlane32_swap_b32 v73, v77
    v_permlane32_swap_b32 v74, v78
    v_permlane32_swap_b32 v75, v79
    v_pk_add_f32 v[72:73], v[72:73], v[76:77]
    v_pk_add_f32 v[74:75], v[74:75], v[78:79]
    v_cvt_pk_bf16_f32 v94, v72, v73
    v_cvt_pk_bf16_f32 v95, v74, v75
    ds_write_b64 v7, v[94:95]
    s_waitcnt lgkmcnt(0)
    s_barrier
    ds_read_b64_tr_b16 v[120:121], v8 offset:0
    ds_read_b64_tr_b16 v[122:123], v8 offset:640
    ds_read_b64_tr_b16 v[124:125], v8 offset:1280
    ds_read_b64_tr_b16 v[126:127], v8 offset:1920
    s_waitcnt lgkmcnt(2)
    v_mfma_f32_16x16x32_bf16 v[128:131], v[96:99], v[120:123], 0
    s_waitcnt lgkmcnt(0)
    v_mfma_f32_16x16x32_bf16 v[128:131], v[100:103], v[124:127], v[128:131]
    s_nop 7
    buffer_store_dwordx4 v[128:131], v64, s[8:11], s25 offen offset:0
    s_branch Sf_qj
Sf_q1:
    s_mov_b64 s[4:5], -1
    s_mov_b64 s[6:7], -1
    s_mov_b64 s[92:93], -1
    s_mov_b32 s31, -1
Sf1m_l:
    s_mov_b64 exec, s[4:5]
    buffer_load_dwordx4 v[16:19], v3, s[8:11], s38 offen offset:0 sc1
    s_mov_b64 exec, s[6:7]
    buffer_load_dwordx4 v[20:23], v3, s[8:11], s38 offen offset:1024 sc1
    s_mov_b64 exec, s[92:93]
    buffer_load_dwordx2 v[56:57], v4, s[8:11], s39 offen offset:0 sc1
    s_mov_b64 exec, -1
    s_add_u32 s31, s31, 1
    s_cmp_lt_u32 s31, s30
    s_cselect_b32 s30, s30, 1
    s_cbranch_scc0 Sf1m_o
    s_waitcnt vmcnt(0)
    v_max3_u32 v58, v16, v17, v18
    v_max3_u32 v60, v20, v21, v22
    v_max_u32 v61, v56, v57
    v_max_u32 v58, v58, v19
    v_max_u32 v60, v60, v23
    v_cmp_eq_u32 s[92:93], -1, v61
    v_cmp_eq_u32 s[4:5], -1, v58
    v_cmp_eq_u32 s[6:7], -1, v60
    s_or_b64 s[94:95], s[92:93], s[4:5]
    s_or_b64 s[94:95], s[94:95], s[6:7]
    s_cbranch_scc1 Sf1m_l
Sf1m_o:
    ds_write_b128 v3, v[16:19] offset:8192
    ds_write_b128 v3, v[20:23] offset:9216
    ds_write_b64 v4, v[56:57]
    v_smfmac_f32_16x16x64_bf16 v[72:75], v[16:19], a[16:23], v5
    v_smfmac_f32_16x16x64_bf16 v[76:79], v[16:19], a[96:103], v5
    s_waitcnt lgkmcnt(0)
    s_barrier
    ds_read_b128 v[24:27], v3 offset:10240
    ds_read_b128 v[28:31], v3 offset:11264
    ds_read_b128 v[32:35], v3 offset:12288
    v_smfmac_f32_16x16x64_bf16 v[72:75], v[20:23], a[24:31], v5
    ds_read_b128 v[36:39], v3 offset:13312
    ds_read_b128 v[40:43], v3 offset:6144
    v_smfmac_f32_16x16x64_bf16 v[76:79], v[20:23], a[104:111], v5
    ds_read_b128 v[44:47], v3 offset:7168
    ds_read_b128 v[48:51], v3 offset:14336
    ds_read_b128 v[52:55], v3 offset:15360
    s_waitcnt lgkmcnt(7)
    v_smfmac_f32_16x16x64_bf16 v[72:75], v[24:27], a[32:39], v5
    v_smfmac_f32_16x16x64_bf16 v[76:79], v[24:27], a[112:119], v5
    s_waitcnt lgkmcnt(6)
    v_smfmac_f32_16x16x64_bf16 v[72:75], v[28:31], a[40:47], v5
    v_smfmac_f32_16x16x64_bf16 v[76:79], v[28:31], a[120:127], v5
    s_waitcnt lgkmcnt(5)
    v_smfmac_f32_16x16x64_bf16 v[72:75], v[32:35], a[48:55], v5
    v_smfmac_f32_16x16x64_bf16 v[76:79], v[32:35], a[128:135], v5
    s_waitcnt lgkmcnt(4)
    v_smfmac_f32_16x16x64_bf16 v[72:75], v[36:39], a[56:63], v5
    v_smfmac_f32_16x16x64_bf16 v[76:79], v[36:39], a[136:143], v5
    s_waitcnt lgkmcnt(3)
    v_smfmac_f32_16x16x64_bf16 v[72:75], v[40:43], a[0:7], v5
    v_smfmac_f32_16x16x64_bf16 v[76:79], v[40:43], a[80:87], v5
    s_waitcnt lgkmcnt(2)
    v_smfmac_f32_16x16x64_bf16 v[72:75], v[44:47], a[8:15], v5
    v_smfmac_f32_16x16x64_bf16 v[76:79], v[44:47], a[88:95], v5
    s_waitcnt lgkmcnt(1)
    v_smfmac_f32_16x16x64_bf16 v[72:75], v[48:51], a[64:71], v5
    v_smfmac_f32_16x16x64_bf16 v[76:79], v[48:51], a[144:151], v5
    s_waitcnt lgkmcnt(0)
    v_smfmac_f32_16x16x64_bf16 v[72:75], v[52:55], a[72:79], v5
    v_smfmac_f32_16x16x64_bf16 v[76:79], v[52:55], a[152:159], v5
    s_nop 7
    v_permlane32_swap_b32 v72, v76
    v_permlane32_swap_b32 v73, v77
    v_permlane32_swap_b32 v74, v78
    v_permlane32_swap_b32 v75, v79
    v_pk_add_f32 v[72:73], v[72:73], v[76:77]
    v_pk_add_f32 v[74:75], v[74:75], v[78:79]
    v_cvt_pk_bf16_f32 v94, v72, v73
    v_cvt_pk_bf16_f32 v95, v74, v75
    ds_write_b64 v7, v[94:95]
    s_waitcnt lgkmcnt(0)
    s_barrier
    ds_read_b64_tr_b16 v[120:121], v8 offset:0
    ds_read_b64_tr_b16 v[122:123], v8 offset:640
    ds_read_b64_tr_b16 v[124:125], v8 offset:1280
    ds_read_b64_tr_b16 v[126:127], v8 offset:1920
    s_waitcnt lgkmcnt(2)
    v_mfma_f32_16x16x32_bf16 v[128:131], v[96:99], v[120:123], 0
    s_waitcnt lgkmcnt(0)
    v_mfma_f32_16x16x32_bf16 v[128:131], v[100:103], v[124:127], v[128:131]
    s_nop 7
    buffer_store_dwordx4 v[128:131], v64, s[8:11], s25 offen offset:0
    s_branch Sf_qj
Sf_q2:
    s_mov_b64 s[4:5], -1
    s_mov_b64 s[6:7], -1
    s_mov_b64 s[92:93], -1
    s_mov_b32 s31, -1
Sf2m_l:
    s_mov_b64 exec, s[4:5]
    buffer_load_dwordx4 v[16:19], v3, s[8:11], s38 offen offset:0 sc1
    s_mov_b64 exec, s[6:7]
    buffer_load_dwordx4 v[20:23], v3, s[8:11], s38 offen offset:1024 sc1
    s_mov_b64 exec, s[92:93]
    buffer_load_dwordx2 v[56:57], v4, s[8:11], s39 offen offset:0 sc1
    s_mov_b64 exec, -1
    s_add_u32 s31, s31, 1
    s_cmp_lt_u32 s31, s30
    s_cselect_b32 s30, s30, 1
    s_cbranch_scc0 Sf2m_o
    s_waitcnt vmcnt(0)
    v_max3_u32 v58, v16, v17, v18
    v_max3_u32 v60, v20, v21, v22
    v_max_u32 v61, v56, v57
    v_max_u32 v58, v58, v19
    v_max_u32 v60, v60, v23
    v_cmp_eq_u32 s[92:93], -1, v61
    v_cmp_eq_u32 s[4:5], -1, v58
    v_cmp_eq_u32 s[6:7], -1, v60
    s_or_b64 s[94:95], s[92:93], s[4:5]
    s_or_b64 s[94:95], s[94:95], s[6:7]
    s_cbranch_scc1 Sf2m_l
Sf2m_o:
    ds_write_b128 v3, v[16:19] offset:8192
    ds_write_b128 v3, v[20:23] offset:9216
    ds_write_b64 v4, v[56:57]
    v_smfmac_f32_16x16x64_bf16 v[72:75], v[16:19], a[32:39], v5
    v_smfmac_f32_16x16x64_bf16 v[76:79], v[16:19], a[112:119], v5
    s_waitcnt lgkmcnt(0)
    s_barrier
    ds_read_b128 v[24:27], v3 offset:10240
    ds_read_b128 v[28:31], v3 offset:11264
    ds_read_b128 v[32:35], v3 offset:4096
    v_smfmac_f32_16x16x64_bf16 v[72:75], v[20:23], a[40:47], v5
    ds_read_b128 v[36:39], v3 offset:5120
    ds_read_b128 v[40:43], v3 offset:6144
    v_smfmac_f32_16x16x64_bf16 v[76:79], v[20:23], a[120:127], v5
    ds_read_b128 v[44:47], v3 offset:7168
    ds_read_b128 v[48:51], v3 offset:12288
    ds_read_b128 v[52:55], v3 offset:13312
    s_waitcnt lgkmcnt(7)
    v_smfmac_f32_16x16x64_bf16 v[72:75], v[24:27], a[48:55], v5
    v_smfmac_f32_16x16x64_bf16 v[76:79], v[24:27], a[128:135], v5
    s_waitcnt lgkmcnt(6)
    v_smfmac_f32_16x16x64_bf16 v[72:75], v[28:31], a[56:63], v5
    v_smfmac_f32_16x16x64_bf16 v[76:79], v[28:31], a[136:143], v5
    s_waitcnt lgkmcnt(5)
    v_smfmac_f32_16x16x64_bf16 v[72:75], v[32:35], a[0:7], v5
    v_smfmac_f32_16x16x64_bf16 v[76:79], v[32:35], a[80:87], v5
    s_waitcnt lgkmcnt(4)
    v_smfmac_f32_16x16x64_bf16 v[72:75], v[36:39], a[8:15], v5
    v_smfmac_f32_16x16x64_bf16 v[76:79], v[36:39], a[88:95], v5
    s_waitcnt lgkmcnt(3)
    v_smfmac_f32_16x16x64_bf16 v[72:75], v[40:43], a[16:23], v5
    v_smfmac_f32_16x16x64_bf16 v[76:79], v[40:43], a[96:103], v5
    s_waitcnt lgkmcnt(2)
    v_smfmac_f32_16x16x64_bf16 v[72:75], v[44:47], a[24:31], v5
    v_smfmac_f32_16x16x64_bf16 v[76:79], v[44:47], a[104:111], v5
    s_waitcnt lgkmcnt(1)
    v_smfmac_f32_16x16x64_bf16 v[72:75], v[48:51], a[64:71], v5
    v_smfmac_f32_16x16x64_bf16 v[76:79], v[48:51], a[144:151], v5
    s_waitcnt lgkmcnt(0)
    v_smfmac_f32_16x16x64_bf16 v[72:75], v[52:55], a[72:79], v5
    v_smfmac_f32_16x16x64_bf16 v[76:79], v[52:55], a[152:159], v5
    s_nop 7
    v_permlane32_swap_b32 v72, v76
    v_permlane32_swap_b32 v73, v77
    v_permlane32_swap_b32 v74, v78
    v_permlane32_swap_b32 v75, v79
    v_pk_add_f32 v[72:73], v[72:73], v[76:77]
    v_pk_add_f32 v[74:75], v[74:75], v[78:79]
    v_cvt_pk_bf16_f32 v94, v72, v73
    v_cvt_pk_bf16_f32 v95, v74, v75
    ds_write_b64 v7, v[94:95]
    s_waitcnt lgkmcnt(0)
    s_barrier
    ds_read_b64_tr_b16 v[120:121], v8 offset:0
    ds_read_b64_tr_b16 v[112:113], v6 offset:16
    ds_read_b64_tr_b16 v[122:123], v8 offset:640
    ds_read_b64_tr_b16 v[114:115], v6 offset:656
    ds_read_b64_tr_b16 v[124:125], v8 offset:1280
    ds_read_b64_tr_b16 v[116:117], v6 offset:1296
    ds_read_b64_tr_b16 v[126:127], v8 offset:1920
    ds_read_b64_tr_b16 v[118:119], v6 offset:1936
    s_waitcnt lgkmcnt(4)
    v_mfma_f32_16x16x32_bf16 v[128:131], v[112:115], v[120:123], 0
    s_waitcnt lgkmcnt(0)
    v_mfma_f32_16x16x32_bf16 v[128:131], v[116:119], v[124:127], v[128:131]
    s_nop 7
    v_cndmask_b32 v128, v128, v129, s[40:41]
    v_cndmask_b32 v130, v130, v131, s[40:41]
    v_cndmask_b32 v128, v128, v130, s[90:91]
    buffer_store_dword v128, v65, s[8:11], s25 offen offset:0
    s_branch Sf_qj
Sf_q3:
    s_mov_b64 s[4:5], -1
    s_mov_b64 s[6:7], -1
    s_mov_b64 s[92:93], -1
    s_mov_b32 s31, -1
Sf3m_l:
    s_mov_b64 exec, s[4:5]
    buffer_load_dwordx4 v[16:19], v3, s[8:11], s38 offen offset:0 sc1
    s_mov_b64 exec, s[6:7]
    buffer_load_dwordx4 v[20:23], v3, s[8:11], s38 offen offset:1024 sc1
    s_mov_b64 exec, s[92:93]
    buffer_load_dwordx2 v[56:57], v4, s[8:11], s39 offen offset:0 sc1
    s_mov_b64 exec, -1
    s_add_u32 s31, s31, 1
    s_cmp_lt_u32 s31, s30
    s_cselect_b32 s30, s30, 1
    s_cbranch_scc0 Sf3m_o
    s_waitcnt vmcnt(0)
    v_max3_u32 v58, v16, v17, v18
    v_max3_u32 v60, v20, v21, v22
    v_max_u32 v61, v56, v57
    v_max_u32 v58, v58, v19
    v_max_u32 v60, v60, v23
    v_cmp_eq_u32 s[92:93], -1, v61
    v_cmp_eq_u32 s[4:5], -1, v58
    v_cmp_eq_u32 s[6:7], -1, v60
    s_or_b64 s[94:95], s[92:93], s[4:5]
    s_or_b64 s[94:95], s[94:95], s[6:7]
    s_cbranch_scc1 Sf3m_l
Sf3m_o:
    ds_write_b128 v3, v[16:19] offset:8192
    ds_write_b128 v3, v[20:23] offset:9216
    ds_write_b64 v4, v[56:57]
    v_smfmac_f32_16x16x64_bf16 v[72:75], v[16:19], a[48:55], v5
    v_smfmac_f32_16x16x64_bf16 v[76:79], v[16:19], a[128:135], v5
    s_waitcnt lgkmcnt(0)
    s_barrier
    ds_read_b128 v[24:27], v3 offset:2048
    ds_read_b128 v[28:31], v3 offset:3072
    ds_read_b128 v[32:35], v3 offset:4096
    v_smfmac_f32_16x16x64_bf16 v[72:75], v[20:23], a[56:63], v5
    ds_read_b128 v[36:39], v3 offset:5120
    ds_read_b128 v[40:43], v3 offset:6144
    v_smfmac_f32_16x16x64_bf16 v[76:79], v[20:23], a[136:143], v5
    ds_read_b128 v[44:47], v3 offset:7168
    ds_read_b128 v[48:51], v3 offset:10240
    ds_read_b128 v[52:55], v3 offset:11264
    s_waitcnt lgkmcnt(7)
    v_smfmac_f32_16x16x64_bf16 v[72:75], v[24:27], a[0:7], v5
    v_smfmac_f32_16x16x64_bf16 v[76:79], v[24:27], a[80:87], v5
    s_waitcnt lgkmcnt(6)
    v_smfmac_f32_16x16x64_bf16 v[72:75], v[28:31], a[8:15], v5
    v_smfmac_f32_16x16x64_bf16 v[76:79], v[28:31], a[88:95], v5
    s_waitcnt lgkmcnt(5)
    v_smfmac_f32_16x16x64_bf16 v[72:75], v[32:35], a[16:23], v5
    v_smfmac_f32_16x16x64_bf16 v[76:79], v[32:35], a[96:103], v5
    s_waitcnt lgkmcnt(4)
    v_smfmac_f32_16x16x64_bf16 v[72:75], v[36:39], a[24:31], v5
    v_smfmac_f32_16x16x64_bf16 v[76:79], v[36:39], a[104:111], v5
    s_waitcnt lgkmcnt(3)
    v_smfmac_f32_16x16x64_bf16 v[72:75], v[40:43], a[32:39], v5
    v_smfmac_f32_16x16x64_bf16 v[76:79], v[40:43], a[112:119], v5
    s_waitcnt lgkmcnt(2)
    v_smfmac_f32_16x16x64_bf16 v[72:75], v[44:47], a[40:47], v5
    v_smfmac_f32_16x16x64_bf16 v[76:79], v[44:47], a[120:127], v5
    s_waitcnt lgkmcnt(1)
    v_smfmac_f32_16x16x64_bf16 v[72:75], v[48:51], a[64:71], v5
    buffer_store_dword v59, v14, s[8:11], s44 offen offset:0
    v_smfmac_f32_16x16x64_bf16 v[76:79], v[48:51], a[144:151], v5
    s_waitcnt lgkmcnt(0)
    v_smfmac_f32_16x16x64_bf16 v[72:75], v[52:55], a[72:79], v5
    v_smfmac_f32_16x16x64_bf16 v[76:79], v[52:55], a[152:159], v5
    s_nop 7
    v_permlane32_swap_b32 v72, v76
    v_permlane32_swap_b32 v73, v77
    v_permlane32_swap_b32 v74, v78
    v_permlane32_swap_b32 v75, v79
    v_pk_add_f32 v[72:73], v[72:73], v[76:77]
    v_pk_add_f32 v[74:75], v[74:75], v[78:79]
    v_cvt_pk_bf16_f32 v94, v72, v73
    v_cvt_pk_bf16_f32 v95, v74, v75
    ds_write_b64 v7, v[94:95]
    s_waitcnt lgkmcnt(0)
    s_barrier
    ds_read_b64_tr_b16 v[112:113], v6 offset:16
    ds_read_b64_tr_b16 v[114:115], v6 offset:656
    ds_read_b64_tr_b16 v[116:117], v6 offset:1296
    ds_read_b64_tr_b16 v[118:119], v6 offset:1936
    s_waitcnt lgkmcnt(2)
    v_mfma_f32_16x16x32_bf16 v[128:131], v[112:115], v[96:99], 0
    v_mfma_f32_16x16x32_bf16 v[132:135], v[112:115], v[104:107], 0
    s_waitcnt lgkmcnt(0)
    v_mfma_f32_16x16x32_bf16 v[128:131], v[116:119], v[100:103], v[128:131]
    v_mfma_f32_16x16x32_bf16 v[132:135], v[116:119], v[108:111], v[132:135]
    s_nop 7
    s_mov_b32 exec_lo, 0
    v_mov_b32 v128, v132
    v_mov_b32 v129, v133
    v_mov_b32 v130, v134
    v_mov_b32 v131, v135
    s_mov_b32 exec_lo, -1
    buffer_store_dwordx4 v[128:131], v2, s[8:11], s34 offen offset:0
Sf_qj:
    s_cmp_lt_u32 s21, 64
    s_cbranch_scc0 Sf_end
    s_cmp_eq_u32 s32, 14
    s_cbranch_scc0 Sf_h
    s_mov_b32 s31, 0
    s_waitcnt vmcnt(63)
    s_branch SfB1_c
SfB1_l:
    buffer_load_dword v68, v67, s[8:11], s23 offen sc1
    s_waitcnt vmcnt(0)
SfB1_c:
    v_cmp_gt_u32 vcc, 1, v68
    s_cbranch_vccz SfB1_o
    s_sleep 4
    s_add_u32 s31, s31, 1
    s_cmp_lt_u32 s31, s30
    s_cbranch_scc1 SfB1_l
    s_mov_b32 s30, 1
SfB1_o:
    s_mov_b32 s31, 0
    s_waitcnt vmcnt(63)
    s_branch SfB2_c
SfB2_l:
    buffer_load_dword v69, v67, s[8:11], s47 offen sc1
    s_waitcnt vmcnt(0)
SfB2_c:
    v_cmp_gt_u32 vcc, 1, v69
    s_cbranch_vccz SfB2_o
    s_sleep 4
    s_add_u32 s31, s31, 1
    s_cmp_lt_u32 s31, s30
    s_cbranch_scc1 SfB2_l
    s_mov_b32 s30, 1
SfB2_o:
Sf_h:
    v_add_u32 v11, s29, v2
    s_xor_b32 s29, s29, 40960
    s_add_u32 s42, s29, s27
    ds_read_b128 a[160:163], v11 offset:0
    ds_read_b128 a[164:167], v11 offset:20480
    ds_read_b128 a[168:171], v11 offset:1024
    ds_read_b128 a[172:175], v11 offset:21504
    ds_read_b128 a[176:179], v11 offset:2048
    ds_read_b128 a[180:183], v11 offset:22528
    s_waitcnt lgkmcnt(5)
    v_mfma_f32_16x16x32_bf16 v[144:147], a[0:3], a[160:163], 0
    ds_read_b128 a[184:187], v11 offset:3072
    v_mfma_f32_16x16x32_bf16 v[152:155], a[80:83], a[160:163], 0
    s_waitcnt lgkmcnt(5)
    v_mfma_f32_16x16x32_bf16 v[148:151], a[0:3], a[164:167], 0
    ds_read_b128 a[188:191], v11 offset:23552
    v_mfma_f32_16x16x32_bf16 v[156:159], a[80:83], a[164:167], 0
    s_waitcnt lgkmcnt(5)
    v_mfma_f32_16x16x32_bf16 v[144:147], a[4:7], a[168:171], v[144:147]
    ds_read_b128 a[160:163], v11 offset:4096
    s_add_u32 s35, s28, 0
    s_add_u32 m0, s42, 0
    v_mfma_f32_16x16x32_bf16 v[152:155], a[84:87], a[168:171], v[152:155]
    buffer_load_dwordx4 v2, s[8:11], s35 offen offset:0 sc1 lds
    s_waitcnt lgkmcnt(5)
    v_mfma_f32_16x16x32_bf16 v[148:151], a[4:7], a[172:175], v[148:151]
    ds_read_b128 a[164:167], v11 offset:24576
    v_mfma_f32_16x16x32_bf16 v[156:159], a[84:87], a[172:175], v[156:159]
    s_waitcnt lgkmcnt(5)
    v_mfma_f32_16x16x32_bf16 v[144:147], a[8:11], a[176:179], v[144:147]
    ds_read_b128 a[168:171], v11 offset:5120
    v_mfma_f32_16x16x32_bf16 v[152:155], a[88:91], a[176:179], v[152:155]
    s_waitcnt lgkmcnt(5)
    v_mfma_f32_16x16x32_bf16 v[148:151], a[8:11], a[180:183], v[148:151]
    ds_read_b128 a[172:175], v11 offset:25600
    v_mfma_f32_16x16x32_bf16 v[156:159], a[88:91], a[180:183], v[156:159]
    buffer_load_dwordx4 v2, s[8:11], s35 offen offset:1024 sc1 lds
    s_waitcnt lgkmcnt(5)
    v_mfma_f32_16x16x32_bf16 v[144:147], a[12:15], a[184:187], v[144:147]
    ds_read_b128 a[176:179], v11 offset:6144
    v_mfma_f32_16x16x32_bf16 v[152:155], a[92:95], a[184:187], v[152:155]
    s_waitcnt lgkmcnt(5)
    v_mfma_f32_16x16x32_bf16 v[148:151], a[12:15], a[188:191], v[148:151]
    ds_read_b128 a[180:183], v11 offset:26624
    v_mfma_f32_16x16x32_bf16 v[156:159], a[92:95], a[188:191], v[156:159]
    s_waitcnt vmcnt(2)
    v_mov_b32 v10, s21
    s_mov_b64 exec, 1
    buffer_store_dword v10, v9, s[8:11], s33 offen
    s_mov_b64 exec, -1
    s_waitcnt lgkmcnt(5)
    v_mfma_f32_16x16x32_bf16 v[144:147], a[16:19], a[160:163], v[144:147]
    ds_read_b128 a[184:187], v11 offset:7168
    v_mfma_f32_16x16x32_bf16 v[152:155], a[96:99], a[160:163], v[152:155]
    buffer_load_dwordx4 v2, s[8:11], s35 offen offset:2048 sc1 lds
    s_waitcnt lgkmcnt(5)
    v_mfma_f32_16x16x32_bf16 v[148:151], a[16:19], a[164:167], v[148:151]
    ds_read_b128 a[188:191], v11 offset:27648
    v_mfma_f32_16x16x32_bf16 v[156:159], a[96:99], a[164:167], v[156:159]
    buffer_store_dwordx4 v[240:243], v64, s[8:11], s26 offen offset:0
    s_waitcnt lgkmcnt(5)
    v_mfma_f32_16x16x32_bf16 v[144:147], a[20:23], a[168:171], v[144:147]
    ds_read_b128 a[160:163], v11 offset:8192
    v_mfma_f32_16x16x32_bf16 v[152:155], a[100:103], a[168:171], v[152:155]
    buffer_store_dword v240, v65, s[8:11], s26 offen offset:0
    s_waitcnt lgkmcnt(5)
    v_mfma_f32_16x16x32_bf16 v[148:151], a[20:23], a[172:175], v[148:151]
    ds_read_b128 a[164:167], v11 offset:28672
    v_mfma_f32_16x16x32_bf16 v[156:159], a[100:103], a[172:175], v[156:159]
    buffer_load_dwordx4 v2, s[8:11], s35 offen offset:3072 sc1 lds
    s_waitcnt lgkmcnt(5)
    v_mfma_f32_16x16x32_bf16 v[144:147], a[24:27], a[176:179], v[144:147]
    ds_read_b128 a[168:171], v11 offset:9216
    v_mfma_f32_16x16x32_bf16 v[152:155], a[104:107], a[176:179], v[152:155]
    s_waitcnt lgkmcnt(5)
    v_mfma_f32_16x16x32_bf16 v[148:151], a[24:27], a[180:183], v[148:151]
    ds_read_b128 a[172:175], v11 offset:29696
    v_mfma_f32_16x16x32_bf16 v[156:159], a[104:107], a[180:183], v[156:159]
    s_waitcnt lgkmcnt(5)
    v_mfma_f32_16x16x32_bf16 v[144:147], a[28:31], a[184:187], v[144:147]
    ds_read_b128 a[176:179], v11 offset:10240
    s_add_u32 s35, s28, 4096
    s_add_u32 m0, s42, 4096
    v_mfma_f32_16x16x32_bf16 v[152:155], a[108:111], a[184:187], v[152:155]
    buffer_load_dwordx4 v2, s[8:11], s35 offen offset:0 sc1 lds
    s_waitcnt lgkmcnt(5)
    v_mfma_f32_16x16x32_bf16 v[148:151], a[28:31], a[188:191], v[148:151]
    ds_read_b128 a[180:183], v11 offset:30720
    v_mfma_f32_16x16x32_bf16 v[156:159], a[108:111], a[188:191], v[156:159]
    s_waitcnt lgkmcnt(5)
    v_mfma_f32_16x16x32_bf16 v[144:147], a[32:35], a[160:163], v[144:147]
    ds_read_b128 a[184:187], v11 offset:11264
    v_mfma_f32_16x16x32_bf16 v[152:155], a[112:115], a[160:163], v[152:155]
    s_waitcnt lgkmcnt(5)
    v_mfma_f32_16x16x32_bf16 v[148:151], a[32:35], a[164:167], v[148:151]
    ds_read_b128 a[188:191], v11 offset:31744
    v_mfma_f32_16x16x32_bf16 v[156:159], a[112:115], a[164:167], v[156:159]
    buffer_load_dwordx4 v2, s[8:11], s35 offen offset:1024 sc1 lds
    s_waitcnt lgkmcnt(5)
    v_mfma_f32_16x16x32_bf16 v[144:147], a[36:39], a[168:171], v[144:147]
    ds_read_b128 a[160:163], v11 offset:12288
    v_mfma_f32_16x16x32_bf16 v[152:155], a[116:119], a[168:171], v[152:155]
    s_sub_u32 s4, s21, 8
    s_cmp_lt_u32 s4, s45
    s_cselect_b64 exec, -1, 0
    s_lshl_b32 s4, s21, 19
    s_add_u32 s4, s4, s46
    buffer_store_dwordx4 v[240:243], v2, s[8:11], s4 offen offset:0 sc1
    s_mov_b64 exec, -1
    s_waitcnt lgkmcnt(5)
    v_mfma_f32_16x16x32_bf16 v[148:151], a[36:39], a[172:175], v[148:151]
    ds_read_b128 a[164:167], v11 offset:32768
    v_mfma_f32_16x16x32_bf16 v[156:159], a[116:119], a[172:175], v[156:159]
    s_cmp_eq_u32 s21, s88
    s_cselect_b64 exec, -1, 0
    buffer_store_dwordx4 v[240:243], v2, s[8:11], s89 offen offset:0 sc1
    s_mov_b64 exec, -1
    s_waitcnt lgkmcnt(5)
    v_mfma_f32_16x16x32_bf16 v[144:147], a[40:43], a[176:179], v[144:147]
    ds_read_b128 a[168:171], v11 offset:13312
    v_mfma_f32_16x16x32_bf16 v[152:155], a[120:123], a[176:179], v[152:155]
    buffer_load_dwordx4 v2, s[8:11], s35 offen offset:2048 sc1 lds
    s_waitcnt lgkmcnt(5)
    v_mfma_f32_16x16x32_bf16 v[148:151], a[40:43], a[180:183], v[148:151]
    ds_read_b128 a[172:175], v11 offset:33792
    v_mfma_f32_16x16x32_bf16 v[156:159], a[120:123], a[180:183], v[156:159]
    s_waitcnt lgkmcnt(5)
    v_mfma_f32_16x16x32_bf16 v[144:147], a[44:47], a[184:187], v[144:147]
    ds_read_b128 a[176:179], v11 offset:14336
    v_mfma_f32_16x16x32_bf16 v[152:155], a[124:127], a[184:187], v[152:155]
    s_waitcnt lgkmcnt(5)
    v_mfma_f32_16x16x32_bf16 v[148:151], a[44:47], a[188:191], v[148:151]
    ds_read_b128 a[180:183], v11 offset:34816
    v_mfma_f32_16x16x32_bf16 v[156:159], a[124:127], a[188:191], v[156:159]
    buffer_load_dwordx4 v2, s[8:11], s35 offen offset:3072 sc1 lds
    s_waitcnt lgkmcnt(5)
    v_mfma_f32_16x16x32_bf16 v[144:147], a[48:51], a[160:163], v[144:147]
    ds_read_b128 a[184:187], v11 offset:15360
    v_mfma_f32_16x16x32_bf16 v[152:155], a[128:131], a[160:163], v[152:155]
    s_waitcnt lgkmcnt(5)
    v_mfma_f32_16x16x32_bf16 v[148:151], a[48:51], a[164:167], v[148:151]
    ds_read_b128 a[188:191], v11 offset:35840
    v_mfma_f32_16x16x32_bf16 v[156:159], a[128:131], a[164:167], v[156:159]
    s_waitcnt lgkmcnt(5)
    v_mfma_f32_16x16x32_bf16 v[144:147], a[52:55], a[168:171], v[144:147]
    ds_read_b128 a[160:163], v11 offset:16384
    s_add_u32 s35, s28, 8192
    s_add_u32 m0, s42, 8192
    v_mfma_f32_16x16x32_bf16 v[152:155], a[132:135], a[168:171], v[152:155]
    buffer_load_dwordx4 v2, s[8:11], s35 offen offset:0 sc1 lds
    s_waitcnt lgkmcnt(5)
    v_mfma_f32_16x16x32_bf16 v[148:151], a[52:55], a[172:175], v[148:151]
    ds_read_b128 a[164:167], v11 offset:36864
    v_mfma_f32_16x16x32_bf16 v[156:159], a[132:135], a[172:175], v[156:159]
    s_waitcnt lgkmcnt(5)
    v_mfma_f32_16x16x32_bf16 v[144:147], a[56:59], a[176:179], v[144:147]
    ds_read_b128 a[168:171], v11 offset:17408
    v_mfma_f32_16x16x32_bf16 v[152:155], a[136:139], a[176:179], v[152:155]
    s_waitcnt lgkmcnt(5)
    v_mfma_f32_16x16x32_bf16 v[148:151], a[56:59], a[180:183], v[148:151]
    ds_read_b128 a[172:175], v11 offset:37888
    v_mfma_f32_16x16x32_bf16 v[156:159], a[136:139], a[180:183], v[156:159]
    buffer_load_dwordx4 v2, s[8:11], s35 offen offset:1024 sc1 lds
    s_waitcnt lgkmcnt(5)
    v_mfma_f32_16x16x32_bf16 v[144:147], a[60:63], a[184:187], v[144:147]
    ds_read_b128 a[176:179], v11 offset:18432
    v_mfma_f32_16x16x32_bf16 v[152:155], a[140:143], a[184:187], v[152:155]
    s_waitcnt lgkmcnt(5)
    v_mfma_f32_16x16x32_bf16 v[148:151], a[60:63], a[188:191], v[148:151]
    ds_read_b128 a[180:183], v11 offset:38912
    v_mfma_f32_16x16x32_bf16 v[156:159], a[140:143], a[188:191], v[156:159]
    s_waitcnt lgkmcnt(5)
    v_mfma_f32_16x16x32_bf16 v[144:147], a[64:67], a[160:163], v[144:147]
    ds_read_b128 a[184:187], v11 offset:19456
    v_mfma_f32_16x16x32_bf16 v[152:155], a[144:147], a[160:163], v[152:155]
    s_waitcnt lgkmcnt(5)
    v_mfma_f32_16x16x32_bf16 v[148:151], a[64:67], a[164:167], v[148:151]
    ds_read_b128 a[188:191], v11 offset:39936
    v_mfma_f32_16x16x32_bf16 v[156:159], a[144:147], a[164:167], v[156:159]
    s_waitcnt lgkmcnt(5)
    v_mfma_f32_16x16x32_bf16 v[144:147], a[68:71], a[168:171], v[144:147]
    v_mfma_f32_16x16x32_bf16 v[152:155], a[148:151], a[168:171], v[152:155]
    s_waitcnt lgkmcnt(4)
    v_mfma_f32_16x16x32_bf16 v[148:151], a[68:71], a[172:175], v[148:151]
    v_mfma_f32_16x16x32_bf16 v[156:159], a[148:151], a[172:175], v[156:159]
    s_waitcnt lgkmcnt(3)
    v_mfma_f32_16x16x32_bf16 v[144:147], a[72:75], a[176:179], v[144:147]
    v_mfma_f32_16x16x32_bf16 v[152:155], a[152:155], a[176:179], v[152:155]
    s_waitcnt lgkmcnt(2)
    v_mfma_f32_16x16x32_bf16 v[148:151], a[72:75], a[180:183], v[148:151]
    v_mfma_f32_16x16x32_bf16 v[156:159], a[152:155], a[180:183], v[156:159]
    s_waitcnt lgkmcnt(1)
    v_mfma_f32_16x16x32_bf16 v[144:147], a[76:79], a[184:187], v[144:147]
    v_mfma_f32_16x16x32_bf16 v[152:155], a[156:159], a[184:187], v[152:155]
    s_waitcnt lgkmcnt(0)
    v_mfma_f32_16x16x32_bf16 v[148:151], a[76:79], a[188:191], v[148:151]
    v_mfma_f32_16x16x32_bf16 v[156:159], a[156:159], a[188:191], v[156:159]
    s_add_u32 s28, s28, 40960
    s_add_u32 s32, s32, 1
    s_cmp_eq_u32 s32, 12
    s_cbranch_scc0 Sf_n12
    buffer_load_dword v68, v67, s[8:11], s23 offen offset:0 sc1
    buffer_load_dword v69, v67, s[8:11], s47 offen offset:0 sc1
Sf_n12:
    v_cvt_pk_bf16_f32 v160, v144, v145
    v_cvt_pk_bf16_f32 v161, v146, v147
    ds_write_b64 v12, v[160:161] offset:0
    v_cvt_pk_bf16_f32 v162, v148, v149
    v_cvt_pk_bf16_f32 v163, v150, v151
    ds_write_b64 v12, v[162:163] offset:2048
    v_cvt_pk_bf16_f32 v164, v152, v153
    v_cvt_pk_bf16_f32 v165, v154, v155
    ds_write_b64 v12, v[164:165] offset:4096
    v_cvt_pk_bf16_f32 v166, v156, v157
    v_cvt_pk_bf16_f32 v167, v158, v159
    ds_write_b64 v12, v[166:167] offset:6144
    s_and_b32 s4, s21, 3
    s_lshl_b32 s4, s4, 16
    s_add_u32 s34, s36, s4
    s_waitcnt lgkmcnt(0)
    s_barrier
    ds_read_b128 v[96:99], v15 offset:0
    ds_read_b128 v[104:107], v62 offset:0
    ds_read_b128 v[100:103], v15 offset:1024
    ds_read_b128 v[108:111], v62 offset:1024
    s_waitcnt lgkmcnt(2)
    v_mfma_f32_16x16x32_bf16 v[128:131], v[96:99], v[104:107], 0
    s_waitcnt lgkmcnt(0)
    v_mfma_f32_16x16x32_bf16 v[128:131], v[100:103], v[108:111], v[128:131]
    s_nop 7
    buffer_store_dwordx4 v[128:131], v63, s[8:11], s34 offen offset:0
    s_branch Sf_loop
Sf_end:
    s_waitcnt vmcnt(0)
    v_mov_b32 v10, s21
    s_mov_b64 exec, 1
    buffer_store_dword v10, v9, s[8:11], s33 offen
    s_mov_b64 exec, -1
    s_branch R_done
Ss_go:
    s_waitcnt vmcnt(0)
    s_barrier
    v_add_u32 v11, s29, v2
    s_xor_b32 s29, s29, 40960
    s_add_u32 s42, s29, s27
    ds_read_b128 a[160:163], v11 offset:0
    ds_read_b128 a[164:167], v11 offset:20480
    ds_read_b128 a[168:171], v11 offset:1024
    ds_read_b128 a[172:175], v11 offset:21504
    ds_read_b128 a[176:179], v11 offset:2048
    ds_read_b128 a[180:183], v11 offset:22528
    s_waitcnt lgkmcnt(5)
    v_mfma_f32_16x16x32_bf16 v[144:147], a[0:3], a[160:163], 0
    ds_read_b128 a[184:187], v11 offset:3072
    v_mfma_f32_16x16x32_bf16 v[152:155], a[80:83], a[160:163], 0
    s_waitcnt lgkmcnt(5)
    v_mfma_f32_16x16x32_bf16 v[148:151], a[0:3], a[164:167], 0
    ds_read_b128 a[188:191], v11 offset:23552
    v_mfma_f32_16x16x32_bf16 v[156:159], a[80:83], a[164:167], 0
    s_waitcnt lgkmcnt(5)
    v_mfma_f32_16x16x32_bf16 v[144:147], a[4:7], a[168:171], v[144:147]
    ds_read_b128 a[160:163], v11 offset:4096
    s_add_u32 s35, s28, 0
    s_add_u32 m0, s42, 0
    v_mfma_f32_16x16x32_bf16 v[152:155], a[84:87], a[168:171], v[152:155]
    buffer_load_dwordx4 v2, s[8:11], s35 offen offset:0 sc1 lds
    s_waitcnt lgkmcnt(5)
    v_mfma_f32_16x16x32_bf16 v[148:151], a[4:7], a[172:175], v[148:151]
    ds_read_b128 a[164:167], v11 offset:24576
    v_mfma_f32_16x16x32_bf16 v[156:159], a[84:87], a[172:175], v[156:159]
    s_waitcnt lgkmcnt(5)
    v_mfma_f32_16x16x32_bf16 v[144:147], a[8:11], a[176:179], v[144:147]
    ds_read_b128 a[168:171], v11 offset:5120
    v_mfma_f32_16x16x32_bf16 v[152:155], a[88:91], a[176:179], v[152:155]
    s_waitcnt lgkmcnt(5)
    v_mfma_f32_16x16x32_bf16 v[148:151], a[8:11], a[180:183], v[148:151]
    ds_read_b128 a[172:175], v11 offset:25600
    v_mfma_f32_16x16x32_bf16 v[156:159], a[88:91], a[180:183], v[156:159]
    buffer_load_dwordx4 v2, s[8:11], s35 offen offset:1024 sc1 lds
    s_waitcnt lgkmcnt(5)
    v_mfma_f32_16x16x32_bf16 v[144:147], a[12:15], a[184:187], v[144:147]
    ds_read_b128 a[176:179], v11 offset:6144
    v_mfma_f32_16x16x32_bf16 v[152:155], a[92:95], a[184:187], v[152:155]
    s_waitcnt lgkmcnt(5)
    v_mfma_f32_16x16x32_bf16 v[148:151], a[12:15], a[188:191], v[148:151]
    ds_read_b128 a[180:183], v11 offset:26624
    v_mfma_f32_16x16x32_bf16 v[156:159], a[92:95], a[188:191], v[156:159]
    s_waitcnt lgkmcnt(5)
    v_mfma_f32_16x16x32_bf16 v[144:147], a[16:19], a[160:163], v[144:147]
    ds_read_b128 a[184:187], v11 offset:7168
    v_mfma_f32_16x16x32_bf16 v[152:155], a[96:99], a[160:163], v[152:155]
    buffer_load_dwordx4 v2, s[8:11], s35 offen offset:2048 sc1 lds
    s_waitcnt lgkmcnt(5)
    v_mfma_f32_16x16x32_bf16 v[148:151], a[16:19], a[164:167], v[148:151]
    ds_read_b128 a[188:191], v11 offset:27648
    v_mfma_f32_16x16x32_bf16 v[156:159], a[96:99], a[164:167], v[156:159]
    s_waitcnt lgkmcnt(5)
    v_mfma_f32_16x16x32_bf16 v[144:147], a[20:23], a[168:171], v[144:147]
    ds_read_b128 a[160:163], v11 offset:8192
    v_mfma_f32_16x16x32_bf16 v[152:155], a[100:103], a[168:171], v[152:155]
    s_waitcnt lgkmcnt(5)
    v_mfma_f32_16x16x32_bf16 v[148:151], a[20:23], a[172:175], v[148:151]
    ds_read_b128 a[164:167], v11 offset:28672
    v_mfma_f32_16x16x32_bf16 v[156:159], a[100:103], a[172:175], v[156:159]
    buffer_load_dwordx4 v2, s[8:11], s35 offen offset:3072 sc1 lds
    s_waitcnt lgkmcnt(5)
    v_mfma_f32_16x16x32_bf16 v[144:147], a[24:27], a[176:179], v[144:147]
    ds_read_b128 a[168:171], v11 offset:9216
    v_mfma_f32_16x16x32_bf16 v[152:155], a[104:107], a[176:179], v[152:155]
    s_waitcnt lgkmcnt(5)
    v_mfma_f32_16x16x32_bf16 v[148:151], a[24:27], a[180:183], v[148:151]
    ds_read_b128 a[172:175], v11 offset:29696
    v_mfma_f32_16x16x32_bf16 v[156:159], a[104:107], a[180:183], v[156:159]
    s_waitcnt lgkmcnt(5)
    v_mfma_f32_16x16x32_bf16 v[144:147], a[28:31], a[184:187], v[144:147]
    ds_read_b128 a[176:179], v11 offset:10240
    s_add_u32 s35, s28, 4096
    s_add_u32 m0, s42, 4096
    v_mfma_f32_16x16x32_bf16 v[152:155], a[108:111], a[184:187], v[152:155]
    buffer_load_dwordx4 v2, s[8:11], s35 offen offset:0 sc1 lds
    s_waitcnt lgkmcnt(5)
    v_mfma_f32_16x16x32_bf16 v[148:151], a[28:31], a[188:191], v[148:151]
    ds_read_b128 a[180:183], v11 offset:30720
    v_mfma_f32_16x16x32_bf16 v[156:159], a[108:111], a[188:191], v[156:159]
    s_waitcnt lgkmcnt(5)
    v_mfma_f32_16x16x32_bf16 v[144:147], a[32:35], a[160:163], v[144:147]
    ds_read_b128 a[184:187], v11 offset:11264
    v_mfma_f32_16x16x32_bf16 v[152:155], a[112:115], a[160:163], v[152:155]
    s_waitcnt lgkmcnt(5)
    v_mfma_f32_16x16x32_bf16 v[148:151], a[32:35], a[164:167], v[148:151]
    ds_read_b128 a[188:191], v11 offset:31744
    v_mfma_f32_16x16x32_bf16 v[156:159], a[112:115], a[164:167], v[156:159]
    buffer_load_dwordx4 v2, s[8:11], s35 offen offset:1024 sc1 lds
    s_waitcnt lgkmcnt(5)
    v_mfma_f32_16x16x32_bf16 v[144:147], a[36:39], a[168:171], v[144:147]
    ds_read_b128 a[160:163], v11 offset:12288
    v_mfma_f32_16x16x32_bf16 v[152:155], a[116:119], a[168:171], v[152:155]
    s_waitcnt lgkmcnt(5)
    v_mfma_f32_16x16x32_bf16 v[148:151], a[36:39], a[172:175], v[148:151]
    ds_read_b128 a[164:167], v11 offset:32768
    v_mfma_f32_16x16x32_bf16 v[156:159], a[116:119], a[172:175], v[156:159]
    s_waitcnt lgkmcnt(5)
    v_mfma_f32_16x16x32_bf16 v[144:147], a[40:43], a[176:179], v[144:147]
    ds_read_b128 a[168:171], v11 offset:13312
    v_mfma_f32_16x16x32_bf16 v[152:155], a[120:123], a[176:179], v[152:155]
    buffer_load_dwordx4 v2, s[8:11], s35 offen offset:2048 sc1 lds
    s_waitcnt lgkmcnt(5)
    v_mfma_f32_16x16x32_bf16 v[148:151], a[40:43], a[180:183], v[148:151]
    ds_read_b128 a[172:175], v11 offset:33792
    v_mfma_f32_16x16x32_bf16 v[156:159], a[120:123], a[180:183], v[156:159]
    s_waitcnt lgkmcnt(5)
    v_mfma_f32_16x16x32_bf16 v[144:147], a[44:47], a[184:187], v[144:147]
    ds_read_b128 a[176:179], v11 offset:14336
    v_mfma_f32_16x16x32_bf16 v[152:155], a[124:127], a[184:187], v[152:155]
    s_waitcnt lgkmcnt(5)
    v_mfma_f32_16x16x32_bf16 v[148:151], a[44:47], a[188:191], v[148:151]
    ds_read_b128 a[180:183], v11 offset:34816
    v_mfma_f32_16x16x32_bf16 v[156:159], a[124:127], a[188:191], v[156:159]
    buffer_load_dwordx4 v2, s[8:11], s35 offen offset:3072 sc1 lds
    s_waitcnt lgkmcnt(5)
    v_mfma_f32_16x16x32_bf16 v[144:147], a[48:51], a[160:163], v[144:147]
    ds_read_b128 a[184:187], v11 offset:15360
    v_mfma_f32_16x16x32_bf16 v[152:155], a[128:131], a[160:163], v[152:155]
    s_waitcnt lgkmcnt(5)
    v_mfma_f32_16x16x32_bf16 v[148:151], a[48:51], a[164:167], v[148:151]
    ds_read_b128 a[188:191], v11 offset:35840
    v_mfma_f32_16x16x32_bf16 v[156:159], a[128:131], a[164:167], v[156:159]
    s_waitcnt lgkmcnt(5)
    v_mfma_f32_16x16x32_bf16 v[144:147], a[52:55], a[168:171], v[144:147]
    ds_read_b128 a[160:163], v11 offset:16384
    s_add_u32 s35, s28, 8192
    s_add_u32 m0, s42, 8192
    v_mfma_f32_16x16x32_bf16 v[152:155], a[132:135], a[168:171], v[152:155]
    buffer_load_dwordx4 v2, s[8:11], s35 offen offset:0 sc1 lds
    s_waitcnt lgkmcnt(5)
    v_mfma_f32_16x16x32_bf16 v[148:151], a[52:55], a[172:175], v[148:151]
    ds_read_b128 a[164:167], v11 offset:36864
    v_mfma_f32_16x16x32_bf16 v[156:159], a[132:135], a[172:175], v[156:159]
    s_waitcnt lgkmcnt(5)
    v_mfma_f32_16x16x32_bf16 v[144:147], a[56:59], a[176:179], v[144:147]
    ds_read_b128 a[168:171], v11 offset:17408
    v_mfma_f32_16x16x32_bf16 v[152:155], a[136:139], a[176:179], v[152:155]
    s_waitcnt lgkmcnt(5)
    v_mfma_f32_16x16x32_bf16 v[148:151], a[56:59], a[180:183], v[148:151]
    ds_read_b128 a[172:175], v11 offset:37888
    v_mfma_f32_16x16x32_bf16 v[156:159], a[136:139], a[180:183], v[156:159]
    buffer_load_dwordx4 v2, s[8:11], s35 offen offset:1024 sc1 lds
    s_waitcnt lgkmcnt(5)
    v_mfma_f32_16x16x32_bf16 v[144:147], a[60:63], a[184:187], v[144:147]
    ds_read_b128 a[176:179], v11 offset:18432
    v_mfma_f32_16x16x32_bf16 v[152:155], a[140:143], a[184:187], v[152:155]
    s_waitcnt lgkmcnt(5)
    v_mfma_f32_16x16x32_bf16 v[148:151], a[60:63], a[188:191], v[148:151]
    ds_read_b128 a[180:183], v11 offset:38912
    v_mfma_f32_16x16x32_bf16 v[156:159], a[140:143], a[188:191], v[156:159]
    s_waitcnt lgkmcnt(5)
    v_mfma_f32_16x16x32_bf16 v[144:147], a[64:67], a[160:163], v[144:147]
    ds_read_b128 a[184:187], v11 offset:19456
    v_mfma_f32_16x16x32_bf16 v[152:155], a[144:147], a[160:163], v[152:155]
    s_waitcnt lgkmcnt(5)
    v_mfma_f32_16x16x32_bf16 v[148:151], a[64:67], a[164:167], v[148:151]
    ds_read_b128 a[188:191], v11 offset:39936
    v_mfma_f32_16x16x32_bf16 v[156:159], a[144:147], a[164:167], v[156:159]
    s_waitcnt lgkmcnt(5)
    v_mfma_f32_16x16x32_bf16 v[144:147], a[68:71], a[168:171], v[144:147]
    v_mfma_f32_16x16x32_bf16 v[152:155], a[148:151], a[168:171], v[152:155]
    s_waitcnt lgkmcnt(4)
    v_mfma_f32_16x16x32_bf16 v[148:151], a[68:71], a[172:175], v[148:151]
    v_mfma_f32_16x16x32_bf16 v[156:159], a[148:151], a[172:175], v[156:159]
    s_waitcnt lgkmcnt(3)
    v_mfma_f32_16x16x32_bf16 v[144:147], a[72:75], a[176:179], v[144:147]
    v_mfma_f32_16x16x32_bf16 v[152:155], a[152:155], a[176:179], v[152:155]
    s_waitcnt lgkmcnt(2)
    v_mfma_f32_16x16x32_bf16 v[148:151], a[72:75], a[180:183], v[148:151]
    v_mfma_f32_16x16x32_bf16 v[156:159], a[152:155], a[180:183], v[156:159]
    s_waitcnt lgkmcnt(1)
    v_mfma_f32_16x16x32_bf16 v[144:147], a[76:79], a[184:187], v[144:147]
    v_mfma_f32_16x16x32_bf16 v[152:155], a[156:159], a[184:187], v[152:155]
    s_waitcnt lgkmcnt(0)
    v_mfma_f32_16x16x32_bf16 v[148:151], a[76:79], a[188:191], v[148:151]
    v_mfma_f32_16x16x32_bf16 v[156:159], a[156:159], a[188:191], v[156:159]
    s_add_u32 s28, s28, 40960
    s_add_u32 s32, s32, 1
    s_mov_b32 s31, 0
SsB0_l:
    buffer_load_dword v68, v70, s[8:11], s49 offen sc1
    s_waitcnt vmcnt(0)
SsB0_c:
    v_cmp_gt_u32 vcc, 1, v68
    s_cbranch_vccz SsB0_o
    s_sleep 2
    s_add_u32 s31, s31, 1
    s_cmp_lt_u32 s31, s30
    s_cbranch_scc1 SsB0_l
    s_mov_b32 s30, 1
SsB0_o:
    v_cvt_pk_bf16_f32 v160, v144, v145
    v_cvt_pk_bf16_f32 v161, v146, v147
    ds_write_b64 v12, v[160:161] offset:0
    v_cvt_pk_bf16_f32 v162, v148, v149
    v_cvt_pk_bf16_f32 v163, v150, v151
    ds_write_b64 v12, v[162:163] offset:2048
    v_cvt_pk_bf16_f32 v164, v152, v153
    v_cvt_pk_bf16_f32 v165, v154, v155
    ds_write_b64 v12, v[164:165] offset:4096
    v_cvt_pk_bf16_f32 v166, v156, v157
    v_cvt_pk_bf16_f32 v167, v158, v159
    ds_write_b64 v12, v[166:167] offset:6144
    s_and_b32 s4, s21, 3
    s_lshl_b32 s4, s4, 16
    s_add_u32 s34, s36, s4
    s_waitcnt lgkmcnt(0)
    s_barrier
    ds_read_b128 v[96:99], v15 offset:0
    ds_read_b128 v[104:107], v62 offset:0
    ds_read_b128 v[100:103], v15 offset:1024
    ds_read_b128 v[108:111], v62 offset:1024
    s_waitcnt lgkmcnt(2)
    v_mfma_f32_16x16x32_bf16 v[128:131], v[96:99], v[104:107], 0
    s_waitcnt lgkmcnt(0)
    v_mfma_f32_16x16x32_bf16 v[128:131], v[100:103], v[108:111], v[128:131]
    s_nop 7
    buffer_store_dwordx4 v[128:131], v63, s[8:11], s34 offen offset:0 sc1
Ss_loop:
    s_and_b32 s4, s21, 3
    s_mul_i32 s5, s4, 10240
    s_add_u32 s5, s5, s22
    s_sub_u32 s38, s5, 73728
    s_sub_u32 s39, s5, 81920
    s_mul_i32 s5, s4, 16384
    s_add_u32 s25, s24, s5
    s_xor_b32 s4, s4, 2
    s_mul_i32 s5, s4, 163840
    s_mul_i32 s5, s4, 16384
    s_add_u32 s26, s24, s5
    s_add_u32 s21, s21, 1
    v_mov_b32 v72, 0
    v_mov_b32 v73, 0
    v_mov_b32 v74, 0
    v_mov_b32 v75, 0
    v_mov_b32 v76, 0
    v_mov_b32 v77, 0
    v_mov_b32 v78, 0
    v_mov_b32 v79, 0
    v_mov_b32 v59, s21
    s_cmp_eq_u32 s3, 1
    s_cbranch_scc1 Ss_q1
    s_cmp_eq_u32 s3, 2
    s_cbranch_scc1 Ss_q2
    s_cmp_eq_u32 s3, 3
    s_cbranch_scc1 Ss_q3
Ss_q0:
    s_mov_b64 s[4:5], -1
    s_mov_b64 s[6:7], -1
    s_mov_b64 s[92:93], -1
    s_mov_b32 s31, -1
Ss0m_l:
    s_mov_b64 exec, s[4:5]
    buffer_load_dwordx4 v[16:19], v3, s[8:11], s38 offen offset:0 sc1
    s_mov_b64 exec, s[6:7]
    buffer_load_dwordx4 v[20:23], v3, s[8:11], s38 offen offset:1024 sc1
    s_mov_b64 exec, s[92:93]
    buffer_load_dwordx2 v[56:57], v4, s[8:11], s39 offen offset:0 sc1
    s_mov_b64 exec, -1
    s_add_u32 s31, s31, 1
    s_cmp_lt_u32 s31, s30
    s_cselect_b32 s30, s30, 1
    s_cbranch_scc0 Ss0m_o
    s_waitcnt vmcnt(0)
    v_max3_u32 v58, v16, v17, v18
    v_max3_u32 v60, v20, v21, v22
    v_max_u32 v61, v56, v57
    v_max_u32 v58, v58, v19
    v_max_u32 v60, v60, v23
    v_cmp_eq_u32 s[92:93], -1, v61
    v_cmp_eq_u32 s[4:5], -1, v58
    v_cmp_eq_u32 s[6:7], -1, v60
    s_or_b64 s[94:95], s[92:93], s[4:5]
    s_or_b64 s[94:95], s[94:95], s[6:7]
    s_cbranch_scc1 Ss0m_l
Ss0m_o:
    ds_write_b128 v3, v[16:19] offset:8192
    ds_write_b128 v3, v[20:23] offset:9216
    ds_write_b64 v4, v[56:57]
    v_smfmac_f32_16x16x64_bf16 v[72:75], v[16:19], a[0:7], v5
    v_smfmac_f32_16x16x64_bf16 v[76:79], v[16:19], a[80:87], v5
    s_waitcnt lgkmcnt(0)
    s_barrier
    ds_read_b128 v[24:27], v3 offset:10240
    ds_read_b128 v[28:31], v3 offset:11264
    ds_read_b128 v[32:35], v3 offset:12288
    v_smfmac_f32_16x16x64_bf16 v[72:75], v[20:23], a[8:15], v5
    ds_read_b128 v[36:39], v3 offset:13312
    ds_read_b128 v[40:43], v3 offset:14336
    v_smfmac_f32_16x16x64_bf16 v[76:79], v[20:23], a[88:95], v5
    ds_read_b128 v[44:47], v3 offset:15360
    ds_read_b128 v[48:51], v3 offset:16384
    ds_read_b128 v[52:55], v3 offset:17408
    s_waitcnt lgkmcnt(7)
    v_smfmac_f32_16x16x64_bf16 v[72:75], v[24:27], a[16:23], v5
    v_smfmac_f32_16x16x64_bf16 v[76:79], v[24:27], a[96:103], v5
    s_waitcnt lgkmcnt(6)
    v_smfmac_f32_16x16x64_bf16 v[72:75], v[28:31], a[24:31], v5
    v_smfmac_f32_16x16x64_bf16 v[76:79], v[28:31], a[104:111], v5
    s_waitcnt lgkmcnt(5)
    v_smfmac_f32_16x16x64_bf16 v[72:75], v[32:35], a[32:39], v5
    v_smfmac_f32_16x16x64_bf16 v[76:79], v[32:35], a[112:119], v5
    s_waitcnt lgkmcnt(4)
    v_smfmac_f32_16x16x64_bf16 v[72:75], v[36:39], a[40:47], v5
    v_smfmac_f32_16x16x64_bf16 v[76:79], v[36:39], a[120:127], v5
    s_waitcnt lgkmcnt(3)
    v_smfmac_f32_16x16x64_bf16 v[72:75], v[40:43], a[48:55], v5
    v_smfmac_f32_16x16x64_bf16 v[76:79], v[40:43], a[128:135], v5
    s_waitcnt lgkmcnt(2)
    v_smfmac_f32_16x16x64_bf16 v[72:75], v[44:47], a[56:63], v5
    v_smfmac_f32_16x16x64_bf16 v[76:79], v[44:47], a[136:143], v5
    s_waitcnt lgkmcnt(1)
    v_smfmac_f32_16x16x64_bf16 v[72:75], v[48:51], a[64:71], v5
    v_smfmac_f32_16x16x64_bf16 v[76:79], v[48:51], a[144:151], v5
    s_waitcnt lgkmcnt(0)
    v_smfmac_f32_16x16x64_bf16 v[72:75], v[52:55], a[72:79], v5
    v_smfmac_f32_16x16x64_bf16 v[76:79], v[52:55], a[152:159], v5
    s_nop 7
    v_permlane32_swap_b32 v72, v76
    v_permlane32_swap_b32 v73, v77
    v_permlane32_swap_b32 v74, v78
    v_permlane32_swap_b32 v75, v79
    v_pk_add_f32 v[72:73], v[72:73], v[76:77]
    v_pk_add_f32 v[74:75], v[74:75], v[78:79]
    v_cvt_pk_bf16_f32 v94, v72, v73
    v_cvt_pk_bf16_f32 v95, v74, v75
    ds_write_b64 v7, v[94:95]
    s_waitcnt lgkmcnt(0)
    s_barrier
    ds_read_b64_tr_b16 v[120:121], v8 offset:0
    ds_read_b64_tr_b16 v[122:123], v8 offset:640
    ds_read_b64_tr_b16 v[124:125], v8 offset:1280
    ds_read_b64_tr_b16 v[126:127], v8 offset:1920
    s_waitcnt lgkmcnt(2)
    v_mfma_f32_16x16x32_bf16 v[128:131], v[96:99], v[120:123], 0
    s_waitcnt lgkmcnt(0)
    v_mfma_f32_16x16x32_bf16 v[128:131], v[100:103], v[124:127], v[128:131]
    s_nop 7
    buffer_store_dwordx4 v[128:131], v64, s[8:11], s25 offen offset:0 sc1
    s_branch Ss_qj
Ss_q1:
    s_mov_b64 s[4:5], -1
    s_mov_b64 s[6:7], -1
    s_mov_b64 s[92:93], -1
    s_mov_b32 s31, -1
Ss1m_l:
    s_mov_b64 exec, s[4:5]
    buffer_load_dwordx4 v[16:19], v3, s[8:11], s38 offen offset:0 sc1
    s_mov_b64 exec, s[6:7]
    buffer_load_dwordx4 v[20:23], v3, s[8:11], s38 offen offset:1024 sc1
    s_mov_b64 exec, s[92:93]
    buffer_load_dwordx2 v[56:57], v4, s[8:11], s39 offen offset:0 sc1
    s_mov_b64 exec, -1
    s_add_u32 s31, s31, 1
    s_cmp_lt_u32 s31, s30
    s_cselect_b32 s30, s30, 1
    s_cbranch_scc0 Ss1m_o
    s_waitcnt vmcnt(0)
    v_max3_u32 v58, v16, v17, v18
    v_max3_u32 v60, v20, v21, v22
    v_max_u32 v61, v56, v57
    v_max_u32 v58, v58, v19
    v_max_u32 v60, v60, v23
    v_cmp_eq_u32 s[92:93], -1, v61
    v_cmp_eq_u32 s[4:5], -1, v58
    v_cmp_eq_u32 s[6:7], -1, v60
    s_or_b64 s[94:95], s[92:93], s[4:5]
    s_or_b64 s[94:95], s[94:95], s[6:7]
    s_cbranch_scc1 Ss1m_l
Ss1m_o:
    ds_write_b128 v3, v[16:19] offset:8192
    ds_write_b128 v3, v[20:23] offset:9216
    ds_write_b64 v4, v[56:57]
    v_smfmac_f32_16x16x64_bf16 v[72:75], v[16:19], a[16:23], v5
    v_smfmac_f32_16x16x64_bf16 v[76:79], v[16:19], a[96:103], v5
    s_waitcnt lgkmcnt(0)
    s_barrier
    ds_read_b128 v[24:27], v3 offset:10240
    ds_read_b128 v[28:31], v3 offset:11264
    ds_read_b128 v[32:35], v3 offset:12288
    v_smfmac_f32_16x16x64_bf16 v[72:75], v[20:23], a[24:31], v5
    ds_read_b128 v[36:39], v3 offset:13312
    ds_read_b128 v[40:43], v3 offset:6144
    v_smfmac_f32_16x16x64_bf16 v[76:79], v[20:23], a[104:111], v5
    ds_read_b128 v[44:47], v3 offset:7168
    ds_read_b128 v[48:51], v3 offset:14336
    ds_read_b128 v[52:55], v3 offset:15360
    s_waitcnt lgkmcnt(7)
    v_smfmac_f32_16x16x64_bf16 v[72:75], v[24:27], a[32:39], v5
    v_smfmac_f32_16x16x64_bf16 v[76:79], v[24:27], a[112:119], v5
    s_waitcnt lgkmcnt(6)
    v_smfmac_f32_16x16x64_bf16 v[72:75], v[28:31], a[40:47], v5
    v_smfmac_f32_16x16x64_bf16 v[76:79], v[28:31], a[120:127], v5
    s_waitcnt lgkmcnt(5)
    v_smfmac_f32_16x16x64_bf16 v[72:75], v[32:35], a[48:55], v5
    v_smfmac_f32_16x16x64_bf16 v[76:79], v[32:35], a[128:135], v5
    s_waitcnt lgkmcnt(4)
    v_smfmac_f32_16x16x64_bf16 v[72:75], v[36:39], a[56:63], v5
    v_smfmac_f32_16x16x64_bf16 v[76:79], v[36:39], a[136:143], v5
    s_waitcnt lgkmcnt(3)
    v_smfmac_f32_16x16x64_bf16 v[72:75], v[40:43], a[0:7], v5
    v_smfmac_f32_16x16x64_bf16 v[76:79], v[40:43], a[80:87], v5
    s_waitcnt lgkmcnt(2)
    v_smfmac_f32_16x16x64_bf16 v[72:75], v[44:47], a[8:15], v5
    v_smfmac_f32_16x16x64_bf16 v[76:79], v[44:47], a[88:95], v5
    s_waitcnt lgkmcnt(1)
    v_smfmac_f32_16x16x64_bf16 v[72:75], v[48:51], a[64:71], v5
    v_smfmac_f32_16x16x64_bf16 v[76:79], v[48:51], a[144:151], v5
    s_waitcnt lgkmcnt(0)
    v_smfmac_f32_16x16x64_bf16 v[72:75], v[52:55], a[72:79], v5
    v_smfmac_f32_16x16x64_bf16 v[76:79], v[52:55], a[152:159], v5
    s_nop 7
    v_permlane32_swap_b32 v72, v76
    v_permlane32_swap_b32 v73, v77
    v_permlane32_swap_b32 v74, v78
    v_permlane32_swap_b32 v75, v79
    v_pk_add_f32 v[72:73], v[72:73], v[76:77]
    v_pk_add_f32 v[74:75], v[74:75], v[78:79]
    v_cvt_pk_bf16_f32 v94, v72, v73
    v_cvt_pk_bf16_f32 v95, v74, v75
    ds_write_b64 v7, v[94:95]
    s_waitcnt lgkmcnt(0)
    s_barrier
    ds_read_b64_tr_b16 v[120:121], v8 offset:0
    ds_read_b64_tr_b16 v[122:123], v8 offset:640
    ds_read_b64_tr_b16 v[124:125], v8 offset:1280
    ds_read_b64_tr_b16 v[126:127], v8 offset:1920
    s_waitcnt lgkmcnt(2)
    v_mfma_f32_16x16x32_bf16 v[128:131], v[96:99], v[120:123], 0
    s_waitcnt lgkmcnt(0)
    v_mfma_f32_16x16x32_bf16 v[128:131], v[100:103], v[124:127], v[128:131]
    s_nop 7
    buffer_store_dwordx4 v[128:131], v64, s[8:11], s25 offen offset:0 sc1
    s_branch Ss_qj
Ss_q2:
    s_mov_b64 s[4:5], -1
    s_mov_b64 s[6:7], -1
    s_mov_b64 s[92:93], -1
    s_mov_b32 s31, -1
Ss2m_l:
    s_mov_b64 exec, s[4:5]
    buffer_load_dwordx4 v[16:19], v3, s[8:11], s38 offen offset:0 sc1
    s_mov_b64 exec, s[6:7]
    buffer_load_dwordx4 v[20:23], v3, s[8:11], s38 offen offset:1024 sc1
    s_mov_b64 exec, s[92:93]
    buffer_load_dwordx2 v[56:57], v4, s[8:11], s39 offen offset:0 sc1
    s_mov_b64 exec, -1
    s_add_u32 s31, s31, 1
    s_cmp_lt_u32 s31, s30
    s_cselect_b32 s30, s30, 1
    s_cbranch_scc0 Ss2m_o
    s_waitcnt vmcnt(0)
    v_max3_u32 v58, v16, v17, v18
    v_max3_u32 v60, v20, v21, v22
    v_max_u32 v61, v56, v57
    v_max_u32 v58, v58, v19
    v_max_u32 v60, v60, v23
    v_cmp_eq_u32 s[92:93], -1, v61
    v_cmp_eq_u32 s[4:5], -1, v58
    v_cmp_eq_u32 s[6:7], -1, v60
    s_or_b64 s[94:95], s[92:93], s[4:5]
    s_or_b64 s[94:95], s[94:95], s[6:7]
    s_cbranch_scc1 Ss2m_l
Ss2m_o:
    ds_write_b128 v3, v[16:19] offset:8192
    ds_write_b128 v3, v[20:23] offset:9216
    ds_write_b64 v4, v[56:57]
    v_smfmac_f32_16x16x64_bf16 v[72:75], v[16:19], a[32:39], v5
    v_smfmac_f32_16x16x64_bf16 v[76:79], v[16:19], a[112:119], v5
    s_waitcnt lgkmcnt(0)
    s_barrier
    ds_read_b128 v[24:27], v3 offset:10240
    ds_read_b128 v[28:31], v3 offset:11264
    ds_read_b128 v[32:35], v3 offset:4096
    v_smfmac_f32_16x16x64_bf16 v[72:75], v[20:23], a[40:47], v5
    ds_read_b128 v[36:39], v3 offset:5120
    ds_read_b128 v[40:43], v3 offset:6144
    v_smfmac_f32_16x16x64_bf16 v[76:79], v[20:23], a[120:127], v5
    ds_read_b128 v[44:47], v3 offset:7168
    ds_read_b128 v[48:51], v3 offset:12288
    ds_read_b128 v[52:55], v3 offset:13312
    s_waitcnt lgkmcnt(7)
    v_smfmac_f32_16x16x64_bf16 v[72:75], v[24:27], a[48:55], v5
    v_smfmac_f32_16x16x64_bf16 v[76:79], v[24:27], a[128:135], v5
    s_waitcnt lgkmcnt(6)
    v_smfmac_f32_16x16x64_bf16 v[72:75], v[28:31], a[56:63], v5
    v_smfmac_f32_16x16x64_bf16 v[76:79], v[28:31], a[136:143], v5
    s_waitcnt lgkmcnt(5)
    v_smfmac_f32_16x16x64_bf16 v[72:75], v[32:35], a[0:7], v5
    v_smfmac_f32_16x16x64_bf16 v[76:79], v[32:35], a[80:87], v5
    s_waitcnt lgkmcnt(4)
    v_smfmac_f32_16x16x64_bf16 v[72:75], v[36:39], a[8:15], v5
    v_smfmac_f32_16x16x64_bf16 v[76:79], v[36:39], a[88:95], v5
    s_waitcnt lgkmcnt(3)
    v_smfmac_f32_16x16x64_bf16 v[72:75], v[40:43], a[16:23], v5
    v_smfmac_f32_16x16x64_bf16 v[76:79], v[40:43], a[96:103], v5
    s_waitcnt lgkmcnt(2)
    v_smfmac_f32_16x16x64_bf16 v[72:75], v[44:47], a[24:31], v5
    v_smfmac_f32_16x16x64_bf16 v[76:79], v[44:47], a[104:111], v5
    s_waitcnt lgkmcnt(1)
    v_smfmac_f32_16x16x64_bf16 v[72:75], v[48:51], a[64:71], v5
    v_smfmac_f32_16x16x64_bf16 v[76:79], v[48:51], a[144:151], v5
    s_waitcnt lgkmcnt(0)
    v_smfmac_f32_16x16x64_bf16 v[72:75], v[52:55], a[72:79], v5
    v_smfmac_f32_16x16x64_bf16 v[76:79], v[52:55], a[152:159], v5
    s_nop 7
    v_permlane32_swap_b32 v72, v76
    v_permlane32_swap_b32 v73, v77
    v_permlane32_swap_b32 v74, v78
    v_permlane32_swap_b32 v75, v79
    v_pk_add_f32 v[72:73], v[72:73], v[76:77]
    v_pk_add_f32 v[74:75], v[74:75], v[78:79]
    v_cvt_pk_bf16_f32 v94, v72, v73
    v_cvt_pk_bf16_f32 v95, v74, v75
    ds_write_b64 v7, v[94:95]
    s_waitcnt lgkmcnt(0)
    s_barrier
    ds_read_b64_tr_b16 v[120:121], v8 offset:0
    ds_read_b64_tr_b16 v[112:113], v6 offset:16
    ds_read_b64_tr_b16 v[122:123], v8 offset:640
    ds_read_b64_tr_b16 v[114:115], v6 offset:656
    ds_read_b64_tr_b16 v[124:125], v8 offset:1280
    ds_read_b64_tr_b16 v[116:117], v6 offset:1296
    ds_read_b64_tr_b16 v[126:127], v8 offset:1920
    ds_read_b64_tr_b16 v[118:119], v6 offset:1936
    s_waitcnt lgkmcnt(4)
    v_mfma_f32_16x16x32_bf16 v[128:131], v[112:115], v[120:123], 0
    s_waitcnt lgkmcnt(0)
    v_mfma_f32_16x16x32_bf16 v[128:131], v[116:119], v[124:127], v[128:131]
    s_nop 7
    v_cndmask_b32 v128, v128, v129, s[40:41]
    v_cndmask_b32 v130, v130, v131, s[40:41]
    v_cndmask_b32 v128, v128, v130, s[90:91]
    buffer_store_dword v128, v65, s[8:11], s25 offen offset:0 sc1
    s_branch Ss_qj
Ss_q3:
    s_mov_b64 s[4:5], -1
    s_mov_b64 s[6:7], -1
    s_mov_b64 s[92:93], -1
    s_mov_b32 s31, -1
Ss3m_l:
    s_mov_b64 exec, s[4:5]
    buffer_load_dwordx4 v[16:19], v3, s[8:11], s38 offen offset:0 sc1
    s_mov_b64 exec, s[6:7]
    buffer_load_dwordx4 v[20:23], v3, s[8:11], s38 offen offset:1024 sc1
    s_mov_b64 exec, s[92:93]
    buffer_load_dwordx2 v[56:57], v4, s[8:11], s39 offen offset:0 sc1
    s_mov_b64 exec, -1
    s_add_u32 s31, s31, 1
    s_cmp_lt_u32 s31, s30
    s_cselect_b32 s30, s30, 1
    s_cbranch_scc0 Ss3m_o
    s_waitcnt vmcnt(0)
    v_max3_u32 v58, v16, v17, v18
    v_max3_u32 v60, v20, v21, v22
    v_max_u32 v61, v56, v57
    v_max_u32 v58, v58, v19
    v_max_u32 v60, v60, v23
    v_cmp_eq_u32 s[92:93], -1, v61
    v_cmp_eq_u32 s[4:5], -1, v58
    v_cmp_eq_u32 s[6:7], -1, v60
    s_or_b64 s[94:95], s[92:93], s[4:5]
    s_or_b64 s[94:95], s[94:95], s[6:7]
    s_cbranch_scc1 Ss3m_l
Ss3m_o:
    ds_write_b128 v3, v[16:19] offset:8192
    ds_write_b128 v3, v[20:23] offset:9216
    ds_write_b64 v4, v[56:57]
    v_smfmac_f32_16x16x64_bf16 v[72:75], v[16:19], a[48:55], v5
    v_smfmac_f32_16x16x64_bf16 v[76:79], v[16:19], a[128:135], v5
    s_waitcnt lgkmcnt(0)
    s_barrier
    ds_read_b128 v[24:27], v3 offset:2048
    ds_read_b128 v[28:31], v3 offset:3072
    ds_read_b128 v[32:35], v3 offset:4096
    v_smfmac_f32_16x16x64_bf16 v[72:75], v[20:23], a[56:63], v5
    ds_read_b128 v[36:39], v3 offset:5120
    ds_read_b128 v[40:43], v3 offset:6144
    v_smfmac_f32_16x16x64_bf16 v[76:79], v[20:23], a[136:143], v5
    ds_read_b128 v[44:47], v3 offset:7168
    ds_read_b128 v[48:51], v3 offset:10240
    ds_read_b128 v[52:55], v3 offset:11264
    s_waitcnt lgkmcnt(7)
    v_smfmac_f32_16x16x64_bf16 v[72:75], v[24:27], a[0:7], v5
    v_smfmac_f32_16x16x64_bf16 v[76:79], v[24:27], a[80:87], v5
    s_waitcnt lgkmcnt(6)
    v_smfmac_f32_16x16x64_bf16 v[72:75], v[28:31], a[8:15], v5
    v_smfmac_f32_16x16x64_bf16 v[76:79], v[28:31], a[88:95], v5
    s_waitcnt lgkmcnt(5)
    v_smfmac_f32_16x16x64_bf16 v[72:75], v[32:35], a[16:23], v5
    v_smfmac_f32_16x16x64_bf16 v[76:79], v[32:35], a[96:103], v5
    s_waitcnt lgkmcnt(4)
    v_smfmac_f32_16x16x64_bf16 v[72:75], v[36:39], a[24:31], v5
    v_smfmac_f32_16x16x64_bf16 v[76:79], v[36:39], a[104:111], v5
    s_waitcnt lgkmcnt(3)
    v_smfmac_f32_16x16x64_bf16 v[72:75], v[40:43], a[32:39], v5
    v_smfmac_f32_16x16x64_bf16 v[76:79], v[40:43], a[112:119], v5
    s_waitcnt lgkmcnt(2)
    v_smfmac_f32_16x16x64_bf16 v[72:75], v[44:47], a[40:47], v5
    v_smfmac_f32_16x16x64_bf16 v[76:79], v[44:47], a[120:127], v5
    s_waitcnt lgkmcnt(1)
    v_smfmac_f32_16x16x64_bf16 v[72:75], v[48:51], a[64:71], v5
    buffer_store_dword v59, v14, s[8:11], s44 offen offset:0 sc1
    v_smfmac_f32_16x16x64_bf16 v[76:79], v[48:51], a[144:151], v5
    s_waitcnt lgkmcnt(0)
    v_smfmac_f32_16x16x64_bf16 v[72:75], v[52:55], a[72:79], v5
    v_smfmac_f32_16x16x64_bf16 v[76:79], v[52:55], a[152:159], v5
    s_nop 7
    v_permlane32_swap_b32 v72, v76
    v_permlane32_swap_b32 v73, v77
    v_permlane32_swap_b32 v74, v78
    v_permlane32_swap_b32 v75, v79
    v_pk_add_f32 v[72:73], v[72:73], v[76:77]
    v_pk_add_f32 v[74:75], v[74:75], v[78:79]
    v_cvt_pk_bf16_f32 v94, v72, v73
    v_cvt_pk_bf16_f32 v95, v74, v75
    ds_write_b64 v7, v[94:95]
    s_waitcnt lgkmcnt(0)
    s_barrier
    ds_read_b64_tr_b16 v[112:113], v6 offset:16
    ds_read_b64_tr_b16 v[114:115], v6 offset:656
    ds_read_b64_tr_b16 v[116:117], v6 offset:1296
    ds_read_b64_tr_b16 v[118:119], v6 offset:1936
    s_waitcnt lgkmcnt(2)
    v_mfma_f32_16x16x32_bf16 v[128:131], v[112:115], v[96:99], 0
    v_mfma_f32_16x16x32_bf16 v[132:135], v[112:115], v[104:107], 0
    s_waitcnt lgkmcnt(0)
    v_mfma_f32_16x16x32_bf16 v[128:131], v[116:119], v[100:103], v[128:131]
    v_mfma_f32_16x16x32_bf16 v[132:135], v[116:119], v[108:111], v[132:135]
    s_nop 7
    s_mov_b32 exec_lo, 0
    v_mov_b32 v128, v132
    v_mov_b32 v129, v133
    v_mov_b32 v130, v134
    v_mov_b32 v131, v135
    s_mov_b32 exec_lo, -1
    buffer_store_dwordx4 v[128:131], v2, s[8:11], s34 offen offset:0 sc1
Ss_qj:
    s_cmp_lt_u32 s21, 64
    s_cbranch_scc0 Ss_end
    s_cmp_eq_u32 s32, 14
    s_cbranch_scc0 Ss_h
    s_mov_b32 s31, 0
    s_waitcnt vmcnt(63)
    s_branch SsB1_c
SsB1_l:
    buffer_load_dword v68, v67, s[8:11], s23 offen sc1
    s_waitcnt vmcnt(0)
SsB1_c:
    v_cmp_gt_u32 vcc, 1, v68
    s_cbranch_vccz SsB1_o
    s_sleep 4
    s_add_u32 s31, s31, 1
    s_cmp_lt_u32 s31, s30
    s_cbranch_scc1 SsB1_l
    s_mov_b32 s30, 1
SsB1_o:
    s_mov_b32 s31, 0
    s_waitcnt vmcnt(63)
    s_branch SsB2_c
SsB2_l:
    buffer_load_dword v69, v67, s[8:11], s47 offen sc1
    s_waitcnt vmcnt(0)
SsB2_c:
    v_cmp_gt_u32 vcc, 1, v69
    s_cbranch_vccz SsB2_o
    s_sleep 4
    s_add_u32 s31, s31, 1
    s_cmp_lt_u32 s31, s30
    s_cbranch_scc1 SsB2_l
    s_mov_b32 s30, 1
SsB2_o:
Ss_h:
    v_add_u32 v11, s29, v2
    s_xor_b32 s29, s29, 40960
    s_add_u32 s42, s29, s27
    ds_read_b128 a[160:163], v11 offset:0
    ds_read_b128 a[164:167], v11 offset:20480
    ds_read_b128 a[168:171], v11 offset:1024
    ds_read_b128 a[172:175], v11 offset:21504
    ds_read_b128 a[176:179], v11 offset:2048
    ds_read_b128 a[180:183], v11 offset:22528
    s_waitcnt lgkmcnt(5)
    v_mfma_f32_16x16x32_bf16 v[144:147], a[0:3], a[160:163], 0
    ds_read_b128 a[184:187], v11 offset:3072
    v_mfma_f32_16x16x32_bf16 v[152:155], a[80:83], a[160:163], 0
    s_waitcnt lgkmcnt(5)
    v_mfma_f32_16x16x32_bf16 v[148:151], a[0:3], a[164:167], 0
    ds_read_b128 a[188:191], v11 offset:23552
    v_mfma_f32_16x16x32_bf16 v[156:159], a[80:83], a[164:167], 0
    s_waitcnt lgkmcnt(5)
    v_mfma_f32_16x16x32_bf16 v[144:147], a[4:7], a[168:171], v[144:147]
    ds_read_b128 a[160:163], v11 offset:4096
    s_add_u32 s35, s28, 0
    s_add_u32 m0, s42, 0
    v_mfma_f32_16x16x32_bf16 v[152:155], a[84:87], a[168:171], v[152:155]
    buffer_load_dwordx4 v2, s[8:11], s35 offen offset:0 sc1 lds
    s_waitcnt lgkmcnt(5)
    v_mfma_f32_16x16x32_bf16 v[148:151], a[4:7], a[172:175], v[148:151]
    ds_read_b128 a[164:167], v11 offset:24576
    v_mfma_f32_16x16x32_bf16 v[156:159], a[84:87], a[172:175], v[156:159]
    s_waitcnt lgkmcnt(5)
    v_mfma_f32_16x16x32_bf16 v[144:147], a[8:11], a[176:179], v[144:147]
    ds_read_b128 a[168:171], v11 offset:5120
    v_mfma_f32_16x16x32_bf16 v[152:155], a[88:91], a[176:179], v[152:155]
    s_waitcnt lgkmcnt(5)
    v_mfma_f32_16x16x32_bf16 v[148:151], a[8:11], a[180:183], v[148:151]
    ds_read_b128 a[172:175], v11 offset:25600
    v_mfma_f32_16x16x32_bf16 v[156:159], a[88:91], a[180:183], v[156:159]
    buffer_load_dwordx4 v2, s[8:11], s35 offen offset:1024 sc1 lds
    s_waitcnt lgkmcnt(5)
    v_mfma_f32_16x16x32_bf16 v[144:147], a[12:15], a[184:187], v[144:147]
    ds_read_b128 a[176:179], v11 offset:6144
    v_mfma_f32_16x16x32_bf16 v[152:155], a[92:95], a[184:187], v[152:155]
    s_waitcnt lgkmcnt(5)
    v_mfma_f32_16x16x32_bf16 v[148:151], a[12:15], a[188:191], v[148:151]
    ds_read_b128 a[180:183], v11 offset:26624
    v_mfma_f32_16x16x32_bf16 v[156:159], a[92:95], a[188:191], v[156:159]
    s_waitcnt vmcnt(2)
    v_mov_b32 v10, s21
    s_mov_b64 exec, 1
    buffer_store_dword v10, v9, s[8:11], s33 offen sc1
    s_mov_b64 exec, -1
    s_waitcnt lgkmcnt(5)
    v_mfma_f32_16x16x32_bf16 v[144:147], a[16:19], a[160:163], v[144:147]
    ds_read_b128 a[184:187], v11 offset:7168
    v_mfma_f32_16x16x32_bf16 v[152:155], a[96:99], a[160:163], v[152:155]
    buffer_load_dwordx4 v2, s[8:11], s35 offen offset:2048 sc1 lds
    s_waitcnt lgkmcnt(5)
    v_mfma_f32_16x16x32_bf16 v[148:151], a[16:19], a[164:167], v[148:151]
    ds_read_b128 a[188:191], v11 offset:27648
    v_mfma_f32_16x16x32_bf16 v[156:159], a[96:99], a[164:167], v[156:159]
    buffer_store_dwordx4 v[240:243], v64, s[8:11], s26 offen offset:0 sc1
    s_waitcnt lgkmcnt(5)
    v_mfma_f32_16x16x32_bf16 v[144:147], a[20:23], a[168:171], v[144:147]
    ds_read_b128 a[160:163], v11 offset:8192
    v_mfma_f32_16x16x32_bf16 v[152:155], a[100:103], a[168:171], v[152:155]
    buffer_store_dword v240, v65, s[8:11], s26 offen offset:0 sc1
    s_waitcnt lgkmcnt(5)
    v_mfma_f32_16x16x32_bf16 v[148:151], a[20:23], a[172:175], v[148:151]
    ds_read_b128 a[164:167], v11 offset:28672
    v_mfma_f32_16x16x32_bf16 v[156:159], a[100:103], a[172:175], v[156:159]
    buffer_load_dwordx4 v2, s[8:11], s35 offen offset:3072 sc1 lds
    s_waitcnt lgkmcnt(5)
    v_mfma_f32_16x16x32_bf16 v[144:147], a[24:27], a[176:179], v[144:147]
    ds_read_b128 a[168:171], v11 offset:9216
    v_mfma_f32_16x16x32_bf16 v[152:155], a[104:107], a[176:179], v[152:155]
    s_waitcnt lgkmcnt(5)
    v_mfma_f32_16x16x32_bf16 v[148:151], a[24:27], a[180:183], v[148:151]
    ds_read_b128 a[172:175], v11 offset:29696
    v_mfma_f32_16x16x32_bf16 v[156:159], a[104:107], a[180:183], v[156:159]
    s_waitcnt lgkmcnt(5)
    v_mfma_f32_16x16x32_bf16 v[144:147], a[28:31], a[184:187], v[144:147]
    ds_read_b128 a[176:179], v11 offset:10240
    s_add_u32 s35, s28, 4096
    s_add_u32 m0, s42, 4096
    v_mfma_f32_16x16x32_bf16 v[152:155], a[108:111], a[184:187], v[152:155]
    buffer_load_dwordx4 v2, s[8:11], s35 offen offset:0 sc1 lds
    s_waitcnt lgkmcnt(5)
    v_mfma_f32_16x16x32_bf16 v[148:151], a[28:31], a[188:191], v[148:151]
    ds_read_b128 a[180:183], v11 offset:30720
    v_mfma_f32_16x16x32_bf16 v[156:159], a[108:111], a[188:191], v[156:159]
    s_waitcnt lgkmcnt(5)
    v_mfma_f32_16x16x32_bf16 v[144:147], a[32:35], a[160:163], v[144:147]
    ds_read_b128 a[184:187], v11 offset:11264
    v_mfma_f32_16x16x32_bf16 v[152:155], a[112:115], a[160:163], v[152:155]
    s_waitcnt lgkmcnt(5)
    v_mfma_f32_16x16x32_bf16 v[148:151], a[32:35], a[164:167], v[148:151]
    ds_read_b128 a[188:191], v11 offset:31744
    v_mfma_f32_16x16x32_bf16 v[156:159], a[112:115], a[164:167], v[156:159]
    buffer_load_dwordx4 v2, s[8:11], s35 offen offset:1024 sc1 lds
    s_waitcnt lgkmcnt(5)
    v_mfma_f32_16x16x32_bf16 v[144:147], a[36:39], a[168:171], v[144:147]
    ds_read_b128 a[160:163], v11 offset:12288
    v_mfma_f32_16x16x32_bf16 v[152:155], a[116:119], a[168:171], v[152:155]
    s_sub_u32 s4, s21, 8
    s_cmp_lt_u32 s4, s45
    s_cselect_b64 exec, -1, 0
    s_lshl_b32 s4, s21, 19
    s_add_u32 s4, s4, s46
    buffer_store_dwordx4 v[240:243], v2, s[8:11], s4 offen offset:0 sc1
    s_mov_b64 exec, -1
    s_waitcnt lgkmcnt(5)
    v_mfma_f32_16x16x32_bf16 v[148:151], a[36:39], a[172:175], v[148:151]
    ds_read_b128 a[164:167], v11 offset:32768
    v_mfma_f32_16x16x32_bf16 v[156:159], a[116:119], a[172:175], v[156:159]
    s_cmp_eq_u32 s21, s88
    s_cselect_b64 exec, -1, 0
    buffer_store_dwordx4 v[240:243], v2, s[8:11], s89 offen offset:0 sc1
    s_mov_b64 exec, -1
    s_waitcnt lgkmcnt(5)
    v_mfma_f32_16x16x32_bf16 v[144:147], a[40:43], a[176:179], v[144:147]
    ds_read_b128 a[168:171], v11 offset:13312
    v_mfma_f32_16x16x32_bf16 v[152:155], a[120:123], a[176:179], v[152:155]
    buffer_load_dwordx4 v2, s[8:11], s35 offen offset:2048 sc1 lds
    s_waitcnt lgkmcnt(5)
    v_mfma_f32_16x16x32_bf16 v[148:151], a[40:43], a[180:183], v[148:151]
    ds_read_b128 a[172:175], v11 offset:33792
    v_mfma_f32_16x16x32_bf16 v[156:159], a[120:123], a[180:183], v[156:159]
    s_waitcnt lgkmcnt(5)
    v_mfma_f32_16x16x32_bf16 v[144:147], a[44:47], a[184:187], v[144:147]
    ds_read_b128 a[176:179], v11 offset:14336
    v_mfma_f32_16x16x32_bf16 v[152:155], a[124:127], a[184:187], v[152:155]
    s_waitcnt lgkmcnt(5)
    v_mfma_f32_16x16x32_bf16 v[148:151], a[44:47], a[188:191], v[148:151]
    ds_read_b128 a[180:183], v11 offset:34816
    v_mfma_f32_16x16x32_bf16 v[156:159], a[124:127], a[188:191], v[156:159]
    buffer_load_dwordx4 v2, s[8:11], s35 offen offset:3072 sc1 lds
    s_waitcnt lgkmcnt(5)
    v_mfma_f32_16x16x32_bf16 v[144:147], a[48:51], a[160:163], v[144:147]
    ds_read_b128 a[184:187], v11 offset:15360
    v_mfma_f32_16x16x32_bf16 v[152:155], a[128:131], a[160:163], v[152:155]
    s_waitcnt lgkmcnt(5)
    v_mfma_f32_16x16x32_bf16 v[148:151], a[48:51], a[164:167], v[148:151]
    ds_read_b128 a[188:191], v11 offset:35840
    v_mfma_f32_16x16x32_bf16 v[156:159], a[128:131], a[164:167], v[156:159]
    s_waitcnt lgkmcnt(5)
    v_mfma_f32_16x16x32_bf16 v[144:147], a[52:55], a[168:171], v[144:147]
    ds_read_b128 a[160:163], v11 offset:16384
    s_add_u32 s35, s28, 8192
    s_add_u32 m0, s42, 8192
    v_mfma_f32_16x16x32_bf16 v[152:155], a[132:135], a[168:171], v[152:155]
    buffer_load_dwordx4 v2, s[8:11], s35 offen offset:0 sc1 lds
    s_waitcnt lgkmcnt(5)
    v_mfma_f32_16x16x32_bf16 v[148:151], a[52:55], a[172:175], v[148:151]
    ds_read_b128 a[164:167], v11 offset:36864
    v_mfma_f32_16x16x32_bf16 v[156:159], a[132:135], a[172:175], v[156:159]
    s_waitcnt lgkmcnt(5)
    v_mfma_f32_16x16x32_bf16 v[144:147], a[56:59], a[176:179], v[144:147]
    ds_read_b128 a[168:171], v11 offset:17408
    v_mfma_f32_16x16x32_bf16 v[152:155], a[136:139], a[176:179], v[152:155]
    s_waitcnt lgkmcnt(5)
    v_mfma_f32_16x16x32_bf16 v[148:151], a[56:59], a[180:183], v[148:151]
    ds_read_b128 a[172:175], v11 offset:37888
    v_mfma_f32_16x16x32_bf16 v[156:159], a[136:139], a[180:183], v[156:159]
    buffer_load_dwordx4 v2, s[8:11], s35 offen offset:1024 sc1 lds
    s_waitcnt lgkmcnt(5)
    v_mfma_f32_16x16x32_bf16 v[144:147], a[60:63], a[184:187], v[144:147]
    ds_read_b128 a[176:179], v11 offset:18432
    v_mfma_f32_16x16x32_bf16 v[152:155], a[140:143], a[184:187], v[152:155]
    s_waitcnt lgkmcnt(5)
    v_mfma_f32_16x16x32_bf16 v[148:151], a[60:63], a[188:191], v[148:151]
    ds_read_b128 a[180:183], v11 offset:38912
    v_mfma_f32_16x16x32_bf16 v[156:159], a[140:143], a[188:191], v[156:159]
    s_waitcnt lgkmcnt(5)
    v_mfma_f32_16x16x32_bf16 v[144:147], a[64:67], a[160:163], v[144:147]
    ds_read_b128 a[184:187], v11 offset:19456
    v_mfma_f32_16x16x32_bf16 v[152:155], a[144:147], a[160:163], v[152:155]
    s_waitcnt lgkmcnt(5)
    v_mfma_f32_16x16x32_bf16 v[148:151], a[64:67], a[164:167], v[148:151]
    ds_read_b128 a[188:191], v11 offset:39936
    v_mfma_f32_16x16x32_bf16 v[156:159], a[144:147], a[164:167], v[156:159]
    s_waitcnt lgkmcnt(5)
    v_mfma_f32_16x16x32_bf16 v[144:147], a[68:71], a[168:171], v[144:147]
    v_mfma_f32_16x16x32_bf16 v[152:155], a[148:151], a[168:171], v[152:155]
    s_waitcnt lgkmcnt(4)
    v_mfma_f32_16x16x32_bf16 v[148:151], a[68:71], a[172:175], v[148:151]
    v_mfma_f32_16x16x32_bf16 v[156:159], a[148:151], a[172:175], v[156:159]
    s_waitcnt lgkmcnt(3)
    v_mfma_f32_16x16x32_bf16 v[144:147], a[72:75], a[176:179], v[144:147]
    v_mfma_f32_16x16x32_bf16 v[152:155], a[152:155], a[176:179], v[152:155]
    s_waitcnt lgkmcnt(2)
    v_mfma_f32_16x16x32_bf16 v[148:151], a[72:75], a[180:183], v[148:151]
    v_mfma_f32_16x16x32_bf16 v[156:159], a[152:155], a[180:183], v[156:159]
    s_waitcnt lgkmcnt(1)
    v_mfma_f32_16x16x32_bf16 v[144:147], a[76:79], a[184:187], v[144:147]
    v_mfma_f32_16x16x32_bf16 v[152:155], a[156:159], a[184:187], v[152:155]
    s_waitcnt lgkmcnt(0)
    v_mfma_f32_16x16x32_bf16 v[148:151], a[76:79], a[188:191], v[148:151]
    v_mfma_f32_16x16x32_bf16 v[156:159], a[156:159], a[188:191], v[156:159]
    s_add_u32 s28, s28, 40960
    s_add_u32 s32, s32, 1
    s_cmp_eq_u32 s32, 12
    s_cbranch_scc0 Ss_n12
    buffer_load_dword v68, v67, s[8:11], s23 offen offset:0 sc1
    buffer_load_dword v69, v67, s[8:11], s47 offen offset:0 sc1
Ss_n12:
    v_cvt_pk_bf16_f32 v160, v144, v145
    v_cvt_pk_bf16_f32 v161, v146, v147
    ds_write_b64 v12, v[160:161] offset:0
    v_cvt_pk_bf16_f32 v162, v148, v149
    v_cvt_pk_bf16_f32 v163, v150, v151
    ds_write_b64 v12, v[162:163] offset:2048
    v_cvt_pk_bf16_f32 v164, v152, v153
    v_cvt_pk_bf16_f32 v165, v154, v155
    ds_write_b64 v12, v[164:165] offset:4096
    v_cvt_pk_bf16_f32 v166, v156, v157
    v_cvt_pk_bf16_f32 v167, v158, v159
    ds_write_b64 v12, v[166:167] offset:6144
    s_and_b32 s4, s21, 3
    s_lshl_b32 s4, s4, 16
    s_add_u32 s34, s36, s4
    s_waitcnt lgkmcnt(0)
    s_barrier
    ds_read_b128 v[96:99], v15 offset:0
    ds_read_b128 v[104:107], v62 offset:0
    ds_read_b128 v[100:103], v15 offset:1024
    ds_read_b128 v[108:111], v62 offset:1024
    s_waitcnt lgkmcnt(2)
    v_mfma_f32_16x16x32_bf16 v[128:131], v[96:99], v[104:107], 0
    s_waitcnt lgkmcnt(0)
    v_mfma_f32_16x16x32_bf16 v[128:131], v[100:103], v[108:111], v[128:131]
    s_nop 7
    buffer_store_dwordx4 v[128:131], v63, s[8:11], s34 offen offset:0 sc1
    s_branch Ss_loop
Ss_end:
    s_waitcnt vmcnt(0)
    v_mov_b32 v10, s21
    s_mov_b64 exec, 1
    buffer_store_dword v10, v9, s[8:11], s33 offen sc1
    s_mov_b64 exec, -1
    s_branch R_done
R_v:
    v_lshlrev_b32 v2, 4, v1
    s_load_dwordx2 s[12:13], s[0:1], 32
    s_load_dwordx2 s[16:17], s[0:1], 32
    s_mov_b32 s14, 7864320
    s_mov_b32 s15, 0x20000
    s_mov_b32 s18, 7864320
    s_mov_b32 s19, 0x20000
    s_waitcnt lgkmcnt(0)
    s_mul_i32 s42, s99, 6
    s_add_u32 s42, s42, s20
    s_sub_u32 s42, s42, 12
    s_lshl_b32 s42, s42, 8
    s_add_u32 s47, s42, 128
    s_lshl_b32 s37, s3, 11
    s_lshl_b32 s4, s3, 4
    s_and_b32 s5, s3, 1
    s_lshl_b32 s5, s5, 1
    v_lshrrev_b32 v60, 3, v1
    v_and_b32 v61, 1, v60
    v_or_b32 v61, s5, v61
    v_add_u32 v60, s4, v60
    v_mul_u32_u24 v13, 12288, v60
    v_bfe_u32 v60, v1, 1, 2
    v_xor_b32 v60, v60, v61
    v_lshlrev_b32 v60, 5, v60
    v_and_b32 v61, 1, v1
    v_lshlrev_b32 v61, 4, v61
    v_add3_u32 v13, v13, v60, v61
    v_lshrrev_b32 v60, 4, v1
    v_lshlrev_b32 v60, 2, v60
    v_bfe_u32 v61, v1, 2, 1
    v_add_u32 v60, v60, v61
    v_bfe_u32 v61, v1, 3, 1
    v_lshlrev_b32 v61, 4, v61
    v_add_u32 v60, v60, v61
    v_lshlrev_b32 v0, 7, v60
    v_bfe_u32 v60, v1, 2, 2
    v_lshlrev_b32 v60, 5, v60
    v_and_b32 v61, 3, v1
    v_lshlrev_b32 v61, 3, v61
    v_add3_u32 v0, v0, v60, v61
    v_mov_b32 v134, 163776
    s_cmp_lg_u32 s3, 0
    s_cbranch_scc1 VC_c
    s_waitcnt vmcnt(0)
    v_readfirstlane_b32 s4, v135
    s_and_b32 s4, s4, s33
    s_nop 0
    v_mov_b32 v135, s4
    ds_write_b32 v134, v135
    s_waitcnt lgkmcnt(0)
VC_c:
    s_barrier
    ds_read_b32 v135, v134
    s_waitcnt lgkmcnt(0)
    v_readfirstlane_b32 s4, v135
    s_cmp_lg_u32 s4, 0
    s_cbranch_scc1 R_ovf
    s_load_dwordx2 s[84:85], s[0:1], 120
    s_mov_b32 s86, 256
    s_mov_b32 s87, 0x20000
    s_waitcnt lgkmcnt(0)
    s_mul_i32 s22, s99, 1048576
    s_add_u32 s22, s22, 8388608
    s_lshl_b32 s33, s20, 4
    s_lshl_b32 s4, s3, 2
    s_add_u32 s33, s33, s4
    s_add_u32 s33, s33, s22
    s_add_u32 s33, s33, 155648
    s_mov_b32 s48, 0xfffffffe
    v_mov_b32 v9, 0
    v_mov_b32 v240, -1
    v_mov_b32 v241, -1
    v_mov_b32 v242, -1
    v_mov_b32 v243, -1
    v_and_b32 v16, 8, v1
    v_mov_b32 v5, 0x4444
    v_mov_b32 v17, 0xeeee
    v_cmp_ne_u32 vcc, 0, v16
    s_nop 1
    v_cndmask_b32 v5, v5, v17, vcc
    s_sub_u32 s4, s20, 12
    s_lshl_b32 s4, s4, 2
    s_add_u32 s4, s4, s3
    s_lshl_b32 s5, s4, 9
    v_lshrrev_b32 v16, 5, v1
    v_lshlrev_b32 v6, 8, v16
    v_and_b32 v16, 15, v1
    v_lshl_add_u32 v6, v16, 4, v6
    v_bfe_u32 v16, v1, 4, 1
    v_lshl_add_u32 v6, v16, 3, v6
    v_add_u32 v6, s5, v6
    s_mul_i32 s5, s4, 43
    s_lshr_b32 s5, s5, 8
    s_mul_i32 s5, s5, 6
    s_add_u32 s4, s4, s5
    s_lshl_b32 s43, s4, 10
    s_add_u32 s43, s43, s22
    s_add_u32 s43, s43, 159744
    s_add_u32 s24, s22, 106496
    s_add_u32 s5, s24, 12288
    buffer_store_dwordx2 v[240:241], v6, s[8:11], s24 offen offset:0 sc1
    buffer_store_dwordx2 v[240:241], v6, s[8:11], s5 offen offset:0 sc1
    s_sub_u32 s4, s20, 12
    s_lshl_b32 s4, s4, 2
    s_add_u32 s4, s4, s3
    s_mul_i32 s5, s4, 43
    s_lshr_b32 s5, s5, 8
    s_mul_i32 s5, s5, 58
    s_add_u32 s4, s4, s5
    s_lshl_b32 s4, s4, 2
    s_add_u32 s44, s4, s22
    s_add_u32 s44, s44, 156672
    v_mov_b32 v14, 0x80000000
    v_writelane_b32 v14, 0, 0
    buffer_store_dword v9, v14, s[8:11], s44 offen offset:0 sc1
    v_mov_b32 v10, 0
    s_mov_b64 exec, 1
    buffer_store_dword v10, v9, s[8:11], s33 offen sc1
    s_mov_b64 exec, -1
    v_and_b32 v16, 15, v1
    v_lshrrev_b32 v17, 4, v1
    v_and_b32 v18, 1, v17
    v_lshlrev_b32 v18, 2, v18
    v_sub_u32 v18, v16, v18
    v_mov_b32 v19, 0x3f80
    v_mov_b32 v20, 0x3f800000
    v_cmp_eq_u32 vcc, 0, v18
    s_nop 1
    v_cndmask_b32 v84, 0, v19, vcc
    v_cmp_eq_u32 vcc, 1, v18
    s_nop 1
    v_cndmask_b32 v84, v84, v20, vcc
    v_cmp_eq_u32 vcc, 2, v18
    s_nop 1
    v_cndmask_b32 v85, 0, v19, vcc
    v_cmp_eq_u32 vcc, 3, v18
    s_nop 1
    v_cndmask_b32 v85, v85, v20, vcc
    v_cmp_eq_u32 vcc, 8, v18
    s_nop 1
    v_cndmask_b32 v86, 0, v19, vcc
    v_cmp_eq_u32 vcc, 9, v18
    s_nop 1
    v_cndmask_b32 v86, v86, v20, vcc
    v_cmp_eq_u32 vcc, 10, v18
    s_nop 1
    v_cndmask_b32 v87, 0, v19, vcc
    v_cmp_eq_u32 vcc, 11, v18
    s_nop 1
    v_cndmask_b32 v87, v87, v20, vcc
    s_lshl_b32 s4, s3, 11
    s_add_u32 s4, s4, 73728
    v_add_u32 v3, s4, v2
    s_lshl_b32 s4, s3, 9
    s_add_u32 s4, s4, 90112
    v_lshl_add_u32 v4, v1, 3, s4
    s_waitcnt vmcnt(0)
    s_barrier
    s_cmp_lg_u32 s3, 0
    s_cbranch_scc1 VA_n
    s_lshl_b32 s4, s99, 5
    s_add_u32 s4, s4, 4
    v_mov_b32 v16, 0
    v_mov_b32 v17, 1
    s_mov_b64 exec, 1
    buffer_atomic_add v17, v16, s[84:87], s4 offen sc1
    s_mov_b64 exec, -1
VA_n:
    s_add_u32 s4, s42, 0
    s_add_u32 m0, s37, 0
    s_nop 0
    buffer_load_dwordx4 v13, s[12:15], s4 offen nt lds
    s_add_u32 s4, s42, 98304
    s_add_u32 m0, s37, 1024
    s_nop 0
    buffer_load_dwordx4 v13, s[12:15], s4 offen nt lds
    s_waitcnt vmcnt(2)
    s_add_u32 s4, s47, 0
    s_add_u32 m0, s37, 81920
    s_nop 0
    buffer_load_dwordx4 v13, s[16:19], s4 offen nt lds
    s_add_u32 s4, s47, 98304
    s_add_u32 m0, s37, 82944
    s_nop 0
    buffer_load_dwordx4 v13, s[16:19], s4 offen nt lds
    s_waitcnt vmcnt(2)
    s_add_u32 s4, s42, 786432
    s_add_u32 m0, s37, 8192
    s_nop 0
    buffer_load_dwordx4 v13, s[12:15], s4 offen nt lds
    s_add_u32 s4, s42, 884736
    s_add_u32 m0, s37, 9216
    s_nop 0
    buffer_load_dwordx4 v13, s[12:15], s4 offen nt lds
    s_waitcnt vmcnt(2)
    s_add_u32 s4, s47, 786432
    s_add_u32 m0, s37, 90112
    s_nop 0
    buffer_load_dwordx4 v13, s[16:19], s4 offen nt lds
    s_add_u32 s4, s47, 884736
    s_add_u32 m0, s37, 91136
    s_nop 0
    buffer_load_dwordx4 v13, s[16:19], s4 offen nt lds
    s_waitcnt vmcnt(2)
    s_add_u32 s4, s42, 1572864
    s_add_u32 m0, s37, 16384
    s_nop 0
    buffer_load_dwordx4 v13, s[12:15], s4 offen nt lds
    s_add_u32 s4, s42, 1671168
    s_add_u32 m0, s37, 17408
    s_nop 0
    buffer_load_dwordx4 v13, s[12:15], s4 offen nt lds
    s_waitcnt vmcnt(2)
    s_add_u32 s4, s47, 1572864
    s_add_u32 m0, s37, 98304
    s_nop 0
    buffer_load_dwordx4 v13, s[16:19], s4 offen nt lds
    s_add_u32 s4, s47, 1671168
    s_add_u32 m0, s37, 99328
    s_nop 0
    buffer_load_dwordx4 v13, s[16:19], s4 offen nt lds
    s_waitcnt vmcnt(2)
    s_add_u32 s4, s42, 2359296
    s_add_u32 m0, s37, 24576
    s_nop 0
    buffer_load_dwordx4 v13, s[12:15], s4 offen nt lds
    s_add_u32 s4, s42, 2457600
    s_add_u32 m0, s37, 25600
    s_nop 0
    buffer_load_dwordx4 v13, s[12:15], s4 offen nt lds
    s_waitcnt vmcnt(2)
    s_add_u32 s4, s47, 2359296
    s_add_u32 m0, s37, 106496
    s_nop 0
    buffer_load_dwordx4 v13, s[16:19], s4 offen nt lds
    s_add_u32 s4, s47, 2457600
    s_add_u32 m0, s37, 107520
    s_nop 0
    buffer_load_dwordx4 v13, s[16:19], s4 offen nt lds
    s_waitcnt vmcnt(2)
    s_add_u32 s4, s42, 3145728
    s_add_u32 m0, s37, 32768
    s_nop 0
    buffer_load_dwordx4 v13, s[12:15], s4 offen nt lds
    s_add_u32 s4, s42, 3244032
    s_add_u32 m0, s37, 33792
    s_nop 0
    buffer_load_dwordx4 v13, s[12:15], s4 offen nt lds
    s_waitcnt vmcnt(2)
    s_add_u32 s4, s47, 3145728
    s_add_u32 m0, s37, 114688
    s_nop 0
    buffer_load_dwordx4 v13, s[16:19], s4 offen nt lds
    s_add_u32 s4, s47, 3244032
    s_add_u32 m0, s37, 115712
    s_nop 0
    buffer_load_dwordx4 v13, s[16:19], s4 offen nt lds
    s_waitcnt vmcnt(2)
    v_and_b32 v16, 7, v1
    v_lshlrev_b32 v16, 5, v16
    buffer_load_dwordx4 v[20:23], v16, s[84:87], 0 offen sc1
    s_add_u32 s4, s42, 3932160
    s_add_u32 m0, s37, 40960
    s_nop 0
    buffer_load_dwordx4 v13, s[12:15], s4 offen nt lds
    s_add_u32 s4, s42, 4030464
    s_add_u32 m0, s37, 41984
    s_nop 0
    buffer_load_dwordx4 v13, s[12:15], s4 offen nt lds
    s_add_u32 s4, s47, 3932160
    s_add_u32 m0, s37, 122880
    s_nop 0
    buffer_load_dwordx4 v13, s[16:19], s4 offen nt lds
    s_add_u32 s4, s47, 4030464
    s_add_u32 m0, s37, 123904
    s_nop 0
    buffer_load_dwordx4 v13, s[16:19], s4 offen nt lds
    s_add_u32 s4, s42, 4718592
    s_add_u32 m0, s37, 49152
    s_nop 0
    buffer_load_dwordx4 v13, s[12:15], s4 offen nt lds
    s_add_u32 s4, s42, 4816896
    s_add_u32 m0, s37, 50176
    s_nop 0
    buffer_load_dwordx4 v13, s[12:15], s4 offen nt lds
    s_add_u32 s4, s47, 4718592
    s_add_u32 m0, s37, 131072
    s_nop 0
    buffer_load_dwordx4 v13, s[16:19], s4 offen nt lds
    s_add_u32 s4, s47, 4816896
    s_add_u32 m0, s37, 132096
    s_nop 0
    buffer_load_dwordx4 v13, s[16:19], s4 offen nt lds
    s_add_u32 s4, s42, 5505024
    s_add_u32 m0, s37, 57344
    s_nop 0
    buffer_load_dwordx4 v13, s[12:15], s4 offen nt lds
    s_add_u32 s4, s42, 5603328
    s_add_u32 m0, s37, 58368
    s_nop 0
    buffer_load_dwordx4 v13, s[12:15], s4 offen nt lds
    s_add_u32 s4, s47, 5505024
    s_add_u32 m0, s37, 139264
    s_nop 0
    buffer_load_dwordx4 v13, s[16:19], s4 offen nt lds
    s_add_u32 s4, s47, 5603328
    s_add_u32 m0, s37, 140288
    s_nop 0
    buffer_load_dwordx4 v13, s[16:19], s4 offen nt lds
    s_add_u32 s4, s42, 6291456
    s_add_u32 m0, s37, 65536
    s_nop 0
    buffer_load_dwordx4 v13, s[12:15], s4 offen nt lds
    s_add_u32 s4, s42, 6389760
    s_add_u32 m0, s37, 66560
    s_nop 0
    buffer_load_dwordx4 v13, s[12:15], s4 offen nt lds
    s_add_u32 s4, s47, 6291456
    s_add_u32 m0, s37, 147456
    s_nop 0
    buffer_load_dwordx4 v13, s[16:19], s4 offen nt lds
    s_add_u32 s4, s47, 6389760
    s_add_u32 m0, s37, 148480
    s_nop 0
    buffer_load_dwordx4 v13, s[16:19], s4 offen nt lds
    s_mov_b32 s31, 0
    s_waitcnt vmcnt(16)
    s_branch VI_c
VI_l:
    buffer_load_dwordx4 v[20:23], v16, s[84:87], 0 offen sc1
    s_waitcnt vmcnt(0)
VI_c:
    v_bcnt_u32_b32 v17, v20, v23
    v_cmp_lt_u32 s[4:5], 32, v17
    s_and_b32 s6, s4, 0xff
    v_cmp_ne_u32 s[4:5], 32, v17
    s_cmp_eq_u32 s6, 0
    s_cselect_b32 s5, 0xff, 0
    s_and_b32 s4, s4, s5
    v_cmp_gt_u32 vcc, 22, v21
    s_and_b32 vcc_lo, vcc_lo, 0xff
    s_or_b32 vcc_lo, vcc_lo, s4
    s_mov_b32 vcc_hi, 0
    s_cbranch_vccz VI_o
    s_sleep 16
    s_add_u32 s31, s31, 1
    s_cmp_lt_u32 s31, s30
    s_cbranch_scc1 VI_l
    s_mov_b32 s30, 1
VI_o:
    s_mov_b32 s97, s6
    v_and_b32 v67, 3, v1
    v_lshlrev_b32 v67, 7, v67
    s_mov_b32 s23, 65536
    buffer_load_dword v68, v67, s[8:11], s23 offen offset:0 sc1
    s_add_u32 s4, s42, 7077888
    s_add_u32 m0, s37, 73728
    s_nop 0
    buffer_load_dwordx4 v13, s[12:15], s4 offen nt lds
    s_add_u32 s4, s42, 7176192
    s_add_u32 m0, s37, 74752
    s_nop 0
    buffer_load_dwordx4 v13, s[12:15], s4 offen nt lds
    s_add_u32 s4, s47, 7077888
    s_add_u32 m0, s37, 155648
    s_nop 0
    buffer_load_dwordx4 v13, s[16:19], s4 offen nt lds
    s_add_u32 s4, s47, 7176192
    s_add_u32 m0, s37, 156672
    s_nop 0
    buffer_load_dwordx4 v13, s[16:19], s4 offen nt lds
    s_barrier
    s_and_b32 s4, s3, 1
    s_lshl_b32 s4, s4, 6
    v_xor_b32 v60, s4, v0
    s_lshr_b32 s4, s3, 1
    s_mul_i32 s4, s4, 81920
    v_add_u32 v60, s4, v60
    v_xor_b32 v61, 32, v60
    ds_read_b64_tr_b16 a[0:1], v60 offset:0
    ds_read_b64_tr_b16 a[2:3], v60 offset:256
    ds_read_b64_tr_b16 a[4:5], v60 offset:4096
    ds_read_b64_tr_b16 a[6:7], v60 offset:4352
    ds_read_b64_tr_b16 a[8:9], v60 offset:8192
    ds_read_b64_tr_b16 a[10:11], v60 offset:8448
    ds_read_b64_tr_b16 a[12:13], v60 offset:12288
    ds_read_b64_tr_b16 a[14:15], v60 offset:12544
    ds_read_b64_tr_b16 a[16:17], v60 offset:16384
    ds_read_b64_tr_b16 a[18:19], v60 offset:16640
    ds_read_b64_tr_b16 a[20:21], v60 offset:20480
    ds_read_b64_tr_b16 a[22:23], v60 offset:20736
    ds_read_b64_tr_b16 a[24:25], v60 offset:24576
    ds_read_b64_tr_b16 a[26:27], v60 offset:24832
    ds_read_b64_tr_b16 a[28:29], v60 offset:28672
    ds_read_b64_tr_b16 a[30:31], v60 offset:28928
    ds_read_b64_tr_b16 a[32:33], v60 offset:32768
    ds_read_b64_tr_b16 a[34:35], v60 offset:33024
    ds_read_b64_tr_b16 a[36:37], v60 offset:36864
    ds_read_b64_tr_b16 a[38:39], v60 offset:37120
    ds_read_b64_tr_b16 a[80:81], v61 offset:0
    ds_read_b64_tr_b16 a[82:83], v61 offset:256
    ds_read_b64_tr_b16 a[84:85], v61 offset:4096
    ds_read_b64_tr_b16 a[86:87], v61 offset:4352
    ds_read_b64_tr_b16 a[88:89], v61 offset:8192
    ds_read_b64_tr_b16 a[90:91], v61 offset:8448
    ds_read_b64_tr_b16 a[92:93], v61 offset:12288
    ds_read_b64_tr_b16 a[94:95], v61 offset:12544
    ds_read_b64_tr_b16 a[96:97], v61 offset:16384
    ds_read_b64_tr_b16 a[98:99], v61 offset:16640
    ds_read_b64_tr_b16 a[100:101], v61 offset:20480
    ds_read_b64_tr_b16 a[102:103], v61 offset:20736
    ds_read_b64_tr_b16 a[104:105], v61 offset:24576
    ds_read_b64_tr_b16 a[106:107], v61 offset:24832
    ds_read_b64_tr_b16 a[108:109], v61 offset:28672
    ds_read_b64_tr_b16 a[110:111], v61 offset:28928
    ds_read_b64_tr_b16 a[112:113], v61 offset:32768
    ds_read_b64_tr_b16 a[114:115], v61 offset:33024
    ds_read_b64_tr_b16 a[116:117], v61 offset:36864
    ds_read_b64_tr_b16 a[118:119], v61 offset:37120
    v_and_b32 v7, 0xf0, v2
    v_lshrrev_b32 v16, 5, v1
    v_lshl_add_u32 v7, v16, 13, v7
    v_bfe_u32 v16, v1, 4, 1
    v_lshl_add_u32 v7, v16, 11, v7
    s_sub_u32 s4, s20, 12
    s_lshl_b32 s4, s4, 2
    s_add_u32 s4, s4, s3
    s_lshr_b32 s6, s4, 1
    s_lshl_b32 s6, s6, 14
    s_and_b32 s7, s4, 1
    s_lshl_b32 s7, s7, 12
    s_add_u32 s6, s6, s7
    s_lshl_b32 s7, s99, 8
    s_add_u32 s6, s6, s7
    s_add_u32 s36, s6, 2097152
    s_cmp_lt_u32 s4, 20
    s_cselect_b32 s4, 0, 0x80000000
    v_add_u32 v7, s4, v7
    s_mul_i32 s27, s3, 10240
    s_add_u32 s28, s27, 16777216
    s_mov_b32 s29, 0
    s_mov_b32 s21, 0
    s_mov_b32 s32, 0
    s_mov_b32 s31, 0
    s_waitcnt vmcnt(4)
    s_branch VH_c
VH_l:
    buffer_load_dword v68, v67, s[8:11], s23 offen sc1
    s_waitcnt vmcnt(0)
VH_c:
    v_cmp_gt_u32 vcc, 1, v68
    s_cbranch_vccz VH_o
    s_sleep 4
    s_add_u32 s31, s31, 1
    s_cmp_lt_u32 s31, s30
    s_cbranch_scc1 VH_l
    s_mov_b32 s30, 1
VH_o:
    s_waitcnt lgkmcnt(0)
    s_barrier
    v_and_b32 v16, 7, v1
    v_lshlrev_b32 v16, 5, v16
    buffer_load_dwordx4 v[20:23], v16, s[84:87], 0 offen sc1
    s_add_u32 s35, s28, 0
    s_add_u32 m0, s27, 0
    s_nop 0
    buffer_load_dwordx4 v2, s[8:11], s35 offen offset:0 sc1 lds
    buffer_load_dwordx4 v2, s[8:11], s35 offen offset:1024 sc1 lds
    buffer_load_dwordx4 v2, s[8:11], s35 offen offset:2048 sc1 lds
    buffer_load_dwordx4 v2, s[8:11], s35 offen offset:3072 sc1 lds
    s_add_u32 s35, s28, 4096
    s_add_u32 m0, s27, 4096
    s_nop 0
    buffer_load_dwordx4 v2, s[8:11], s35 offen offset:0 sc1 lds
    buffer_load_dwordx4 v2, s[8:11], s35 offen offset:1024 sc1 lds
    buffer_load_dwordx4 v2, s[8:11], s35 offen offset:2048 sc1 lds
    buffer_load_dwordx4 v2, s[8:11], s35 offen offset:3072 sc1 lds
    s_add_u32 s35, s28, 8192
    s_add_u32 m0, s27, 8192
    s_nop 0
    buffer_load_dwordx4 v2, s[8:11], s35 offen offset:0 sc1 lds
    buffer_load_dwordx4 v2, s[8:11], s35 offen offset:1024 sc1 lds
    s_waitcnt vmcnt(11)
    s_barrier
    ds_read_b64_tr_b16 a[40:41], v60 offset:40960
    ds_read_b64_tr_b16 a[42:43], v60 offset:41216
    ds_read_b64_tr_b16 a[44:45], v60 offset:45056
    ds_read_b64_tr_b16 a[46:47], v60 offset:45312
    ds_read_b64_tr_b16 a[48:49], v60 offset:49152
    ds_read_b64_tr_b16 a[50:51], v60 offset:49408
    ds_read_b64_tr_b16 a[52:53], v60 offset:53248
    ds_read_b64_tr_b16 a[54:55], v60 offset:53504
    ds_read_b64_tr_b16 a[56:57], v60 offset:57344
    ds_read_b64_tr_b16 a[58:59], v60 offset:57600
    ds_read_b64_tr_b16 a[60:61], v60 offset:61440
    ds_read_b64_tr_b16 a[62:63], v60 offset:61696
    v_add_u32 v60, 65536, v60
    ds_read_b64_tr_b16 a[64:65], v60 offset:0
    ds_read_b64_tr_b16 a[66:67], v60 offset:256
    ds_read_b64_tr_b16 a[68:69], v60 offset:4096
    ds_read_b64_tr_b16 a[70:71], v60 offset:4352
    ds_read_b64_tr_b16 a[72:73], v60 offset:8192
    ds_read_b64_tr_b16 a[74:75], v60 offset:8448
    ds_read_b64_tr_b16 a[76:77], v60 offset:12288
    ds_read_b64_tr_b16 a[78:79], v60 offset:12544
    ds_read_b64_tr_b16 a[120:121], v61 offset:40960
    ds_read_b64_tr_b16 a[122:123], v61 offset:41216
    ds_read_b64_tr_b16 a[124:125], v61 offset:45056
    ds_read_b64_tr_b16 a[126:127], v61 offset:45312
    ds_read_b64_tr_b16 a[128:129], v61 offset:49152
    ds_read_b64_tr_b16 a[130:131], v61 offset:49408
    ds_read_b64_tr_b16 a[132:133], v61 offset:53248
    ds_read_b64_tr_b16 a[134:135], v61 offset:53504
    ds_read_b64_tr_b16 a[136:137], v61 offset:57344
    ds_read_b64_tr_b16 a[138:139], v61 offset:57600
    ds_read_b64_tr_b16 a[140:141], v61 offset:61440
    ds_read_b64_tr_b16 a[142:143], v61 offset:61696
    v_add_u32 v61, 65536, v61
    ds_read_b64_tr_b16 a[144:145], v61 offset:0
    ds_read_b64_tr_b16 a[146:147], v61 offset:256
    ds_read_b64_tr_b16 a[148:149], v61 offset:4096
    ds_read_b64_tr_b16 a[150:151], v61 offset:4352
    ds_read_b64_tr_b16 a[152:153], v61 offset:8192
    ds_read_b64_tr_b16 a[154:155], v61 offset:8448
    ds_read_b64_tr_b16 a[156:157], v61 offset:12288
    ds_read_b64_tr_b16 a[158:159], v61 offset:12544
    s_mov_b32 s31, 0
    s_waitcnt vmcnt(10)
    s_branch VJ_c
VJ_l:
    buffer_load_dwordx4 v[20:23], v16, s[84:87], 0 offen sc1
    s_waitcnt vmcnt(0)
VJ_c:
    v_bcnt_u32_b32 v17, v20, v23
    v_cmp_lt_u32 s[4:5], 32, v17
    s_and_b32 s6, s4, 0xff
    v_cmp_ne_u32 s[4:5], 32, v17
    s_cmp_eq_u32 s6, 0
    s_cselect_b32 s5, 0xff, 0
    s_and_b32 s4, s4, s5
    v_add_u32 v21, v21, v22
    v_cmp_gt_u32 vcc, 32, v21
    s_and_b32 vcc_lo, vcc_lo, 0xff
    s_or_b32 vcc_lo, vcc_lo, s4
    s_mov_b32 vcc_hi, 0
    s_cbranch_vccz VJ_o
    s_sleep 16
    s_add_u32 s31, s31, 1
    s_cmp_lt_u32 s31, s30
    s_cbranch_scc1 VJ_l
    s_mov_b32 s30, 1
VJ_o:
    s_mov_b32 s97, s6
    v_min_u32 v67, 39, v1
    v_lshlrev_b32 v67, 7, v67
    v_min_u32 v70, 3968, v67
    s_mov_b32 s49, 65536
    s_mov_b32 s23, 69632
    s_mov_b32 s47, 74752
    s_waitcnt lgkmcnt(0)
    s_barrier
    s_add_u32 s28, s28, 40960
    s_cmp_lg_u32 s97, 0
    s_cbranch_scc1 Vs_go
Vf_go:
Vf_loop:
    s_and_b32 s4, s21, 3
    s_mul_i32 s5, s4, 10240
    s_add_u32 s5, s5, s22
    s_sub_u32 s38, s5, 73728
    s_sub_u32 s39, s5, 81920
    s_mul_i32 s5, s4, 12288
    s_add_u32 s25, s24, s5
    s_xor_b32 s4, s4, 2
    s_mul_i32 s5, s4, 163840
    s_add_u32 s34, s36, s5
    s_mul_i32 s5, s4, 12288
    s_add_u32 s26, s24, s5
    s_add_u32 s21, s21, 1
    v_mov_b32 v72, 0
    v_mov_b32 v73, 0
    v_mov_b32 v74, 0
    v_mov_b32 v75, 0
    v_mov_b32 v76, 0
    v_mov_b32 v77, 0
    v_mov_b32 v78, 0
    v_mov_b32 v79, 0
    v_mov_b32 v59, s21
    s_cmp_eq_u32 s3, 1
    s_cbranch_scc1 Vf_q1
    s_cmp_eq_u32 s3, 2
    s_cbranch_scc1 Vf_q2
    s_cmp_eq_u32 s3, 3
    s_cbranch_scc1 Vf_q3
Vf_q0:
    s_mov_b64 s[4:5], -1
    s_mov_b64 s[6:7], -1
    s_mov_b64 s[92:93], -1
    s_mov_b32 s31, -1
Vf0m_l:
    s_mov_b64 exec, s[4:5]
    buffer_load_dwordx4 v[16:19], v3, s[8:11], s38 offen offset:0 sc1
    s_mov_b64 exec, s[6:7]
    buffer_load_dwordx4 v[20:23], v3, s[8:11], s38 offen offset:1024 sc1
    s_mov_b64 exec, s[92:93]
    buffer_load_dwordx2 v[56:57], v4, s[8:11], s39 offen offset:0 sc1
    s_mov_b64 exec, -1
    s_add_u32 s31, s31, 1
    s_cmp_lt_u32 s31, s30
    s_cselect_b32 s30, s30, 1
    s_cbranch_scc0 Vf0m_o
    s_waitcnt vmcnt(0)
    v_max3_u32 v58, v16, v17, v18
    v_max3_u32 v60, v20, v21, v22
    v_max_u32 v61, v56, v57
    v_max_u32 v58, v58, v19
    v_max_u32 v60, v60, v23
    v_cmp_eq_u32 s[92:93], -1, v61
    v_cmp_eq_u32 s[4:5], -1, v58
    v_cmp_eq_u32 s[6:7], -1, v60
    s_or_b64 s[94:95], s[92:93], s[4:5]
    s_or_b64 s[94:95], s[94:95], s[6:7]
    s_cbranch_scc1 Vf0m_l
Vf0m_o:
    ds_write_b128 v3, v[16:19] offset:8192
    ds_write_b128 v3, v[20:23] offset:9216
    ds_write_b64 v4, v[56:57]
    v_smfmac_f32_16x16x64_bf16 v[72:75], v[16:19], a[0:7], v5
    v_smfmac_f32_16x16x64_bf16 v[76:79], v[16:19], a[80:87], v5
    s_waitcnt lgkmcnt(0)
    s_barrier
    ds_read_b128 v[24:27], v3 offset:10240
    ds_read_b128 v[28:31], v3 offset:11264
    ds_read_b128 v[32:35], v3 offset:12288
    v_smfmac_f32_16x16x64_bf16 v[72:75], v[20:23], a[8:15], v5
    ds_read_b128 v[36:39], v3 offset:13312
    ds_read_b128 v[40:43], v3 offset:14336
    v_smfmac_f32_16x16x64_bf16 v[76:79], v[20:23], a[88:95], v5
    ds_read_b128 v[44:47], v3 offset:15360
    ds_read_b128 v[48:51], v3 offset:16384
    ds_read_b128 v[52:55], v3 offset:17408
    s_waitcnt lgkmcnt(7)
    v_smfmac_f32_16x16x64_bf16 v[72:75], v[24:27], a[16:23], v5
    v_smfmac_f32_16x16x64_bf16 v[76:79], v[24:27], a[96:103], v5
    s_waitcnt lgkmcnt(6)
    v_smfmac_f32_16x16x64_bf16 v[72:75], v[28:31], a[24:31], v5
    v_smfmac_f32_16x16x64_bf16 v[76:79], v[28:31], a[104:111], v5
    s_waitcnt lgkmcnt(5)
    v_smfmac_f32_16x16x64_bf16 v[72:75], v[32:35], a[32:39], v5
    v_smfmac_f32_16x16x64_bf16 v[76:79], v[32:35], a[112:119], v5
    s_waitcnt lgkmcnt(4)
    v_smfmac_f32_16x16x64_bf16 v[72:75], v[36:39], a[40:47], v5
    v_smfmac_f32_16x16x64_bf16 v[76:79], v[36:39], a[120:127], v5
    s_waitcnt lgkmcnt(3)
    v_smfmac_f32_16x16x64_bf16 v[72:75], v[40:43], a[48:55], v5
    v_smfmac_f32_16x16x64_bf16 v[76:79], v[40:43], a[128:135], v5
    s_waitcnt lgkmcnt(2)
    v_smfmac_f32_16x16x64_bf16 v[72:75], v[44:47], a[56:63], v5
    v_smfmac_f32_16x16x64_bf16 v[76:79], v[44:47], a[136:143], v5
    s_waitcnt lgkmcnt(1)
    v_smfmac_f32_16x16x64_bf16 v[72:75], v[48:51], a[64:71], v5
    buffer_store_dword v59, v14, s[8:11], s44 offen offset:0
    v_smfmac_f32_16x16x64_bf16 v[76:79], v[48:51], a[144:151], v5
    s_waitcnt lgkmcnt(0)
    v_smfmac_f32_16x16x64_bf16 v[72:75], v[52:55], a[72:79], v5
    v_smfmac_f32_16x16x64_bf16 v[76:79], v[52:55], a[152:159], v5
    s_nop 3
    v_cvt_pk_bf16_f32 v80, v72, v73
    v_cvt_pk_bf16_f32 v81, v74, v75
    s_nop 1
    v_cvt_pk_bf16_f32 v82, v76, v77
    v_cvt_pk_bf16_f32 v83, v78, v79
    s_nop 1
    v_mfma_f32_16x16x32_bf16 v[88:91], v[80:83], v[84:87], 0
    s_branch Vf_qj
Vf_q1:
    s_mov_b64 s[4:5], -1
    s_mov_b64 s[6:7], -1
    s_mov_b64 s[92:93], -1
    s_mov_b32 s31, -1
Vf1m_l:
    s_mov_b64 exec, s[4:5]
    buffer_load_dwordx4 v[16:19], v3, s[8:11], s38 offen offset:0 sc1
    s_mov_b64 exec, s[6:7]
    buffer_load_dwordx4 v[20:23], v3, s[8:11], s38 offen offset:1024 sc1
    s_mov_b64 exec, s[92:93]
    buffer_load_dwordx2 v[56:57], v4, s[8:11], s39 offen offset:0 sc1
    s_mov_b64 exec, -1
    s_add_u32 s31, s31, 1
    s_cmp_lt_u32 s31, s30
    s_cselect_b32 s30, s30, 1
    s_cbranch_scc0 Vf1m_o
    s_waitcnt vmcnt(0)
    v_max3_u32 v58, v16, v17, v18
    v_max3_u32 v60, v20, v21, v22
    v_max_u32 v61, v56, v57
    v_max_u32 v58, v58, v19
    v_max_u32 v60, v60, v23
    v_cmp_eq_u32 s[92:93], -1, v61
    v_cmp_eq_u32 s[4:5], -1, v58
    v_cmp_eq_u32 s[6:7], -1, v60
    s_or_b64 s[94:95], s[92:93], s[4:5]
    s_or_b64 s[94:95], s[94:95], s[6:7]
    s_cbranch_scc1 Vf1m_l
Vf1m_o:
    ds_write_b128 v3, v[16:19] offset:8192
    ds_write_b128 v3, v[20:23] offset:9216
    ds_write_b64 v4, v[56:57]
    v_smfmac_f32_16x16x64_bf16 v[72:75], v[16:19], a[16:23], v5
    v_smfmac_f32_16x16x64_bf16 v[76:79], v[16:19], a[96:103], v5
    s_waitcnt lgkmcnt(0)
    s_barrier
    ds_read_b128 v[24:27], v3 offset:10240
    ds_read_b128 v[28:31], v3 offset:11264
    ds_read_b128 v[32:35], v3 offset:12288
    v_smfmac_f32_16x16x64_bf16 v[72:75], v[20:23], a[24:31], v5
    ds_read_b128 v[36:39], v3 offset:13312
    ds_read_b128 v[40:43], v3 offset:6144
    v_smfmac_f32_16x16x64_bf16 v[76:79], v[20:23], a[104:111], v5
    ds_read_b128 v[44:47], v3 offset:7168
    ds_read_b128 v[48:51], v3 offset:14336
    ds_read_b128 v[52:55], v3 offset:15360
    s_waitcnt lgkmcnt(7)
    v_smfmac_f32_16x16x64_bf16 v[72:75], v[24:27], a[32:39], v5
    v_smfmac_f32_16x16x64_bf16 v[76:79], v[24:27], a[112:119], v5
    s_waitcnt lgkmcnt(6)
    v_smfmac_f32_16x16x64_bf16 v[72:75], v[28:31], a[40:47], v5
    v_smfmac_f32_16x16x64_bf16 v[76:79], v[28:31], a[120:127], v5
    s_waitcnt lgkmcnt(5)
    v_smfmac_f32_16x16x64_bf16 v[72:75], v[32:35], a[48:55], v5
    v_smfmac_f32_16x16x64_bf16 v[76:79], v[32:35], a[128:135], v5
    s_waitcnt lgkmcnt(4)
    v_smfmac_f32_16x16x64_bf16 v[72:75], v[36:39], a[56:63], v5
    v_smfmac_f32_16x16x64_bf16 v[76:79], v[36:39], a[136:143], v5
    s_waitcnt lgkmcnt(3)
    v_smfmac_f32_16x16x64_bf16 v[72:75], v[40:43], a[0:7], v5
    v_smfmac_f32_16x16x64_bf16 v[76:79], v[40:43], a[80:87], v5
    s_waitcnt lgkmcnt(2)
    v_smfmac_f32_16x16x64_bf16 v[72:75], v[44:47], a[8:15], v5
    v_smfmac_f32_16x16x64_bf16 v[76:79], v[44:47], a[88:95], v5
    s_waitcnt lgkmcnt(1)
    v_smfmac_f32_16x16x64_bf16 v[72:75], v[48:51], a[64:71], v5
    buffer_store_dword v59, v14, s[8:11], s44 offen offset:0
    v_smfmac_f32_16x16x64_bf16 v[76:79], v[48:51], a[144:151], v5
    s_waitcnt lgkmcnt(0)
    v_smfmac_f32_16x16x64_bf16 v[72:75], v[52:55], a[72:79], v5
    v_smfmac_f32_16x16x64_bf16 v[76:79], v[52:55], a[152:159], v5
    s_nop 3
    v_cvt_pk_bf16_f32 v80, v72, v73
    v_cvt_pk_bf16_f32 v81, v74, v75
    s_nop 1
    v_cvt_pk_bf16_f32 v82, v76, v77
    v_cvt_pk_bf16_f32 v83, v78, v79
    s_nop 1
    v_mfma_f32_16x16x32_bf16 v[88:91], v[80:83], v[84:87], 0
    s_branch Vf_qj
Vf_q2:
    s_mov_b64 s[4:5], -1
    s_mov_b64 s[6:7], -1
    s_mov_b64 s[92:93], -1
    s_mov_b32 s31, -1
Vf2m_l:
    s_mov_b64 exec, s[4:5]
    buffer_load_dwordx4 v[16:19], v3, s[8:11], s38 offen offset:0 sc1
    s_mov_b64 exec, s[6:7]
    buffer_load_dwordx4 v[20:23], v3, s[8:11], s38 offen offset:1024 sc1
    s_mov_b64 exec, s[92:93]
    buffer_load_dwordx2 v[56:57], v4, s[8:11], s39 offen offset:0 sc1
    s_mov_b64 exec, -1
    s_add_u32 s31, s31, 1
    s_cmp_lt_u32 s31, s30
    s_cselect_b32 s30, s30, 1
    s_cbranch_scc0 Vf2m_o
    s_waitcnt vmcnt(0)
    v_max3_u32 v58, v16, v17, v18
    v_max3_u32 v60, v20, v21, v22
    v_max_u32 v61, v56, v57
    v_max_u32 v58, v58, v19
    v_max_u32 v60, v60, v23
    v_cmp_eq_u32 s[92:93], -1, v61
    v_cmp_eq_u32 s[4:5], -1, v58
    v_cmp_eq_u32 s[6:7], -1, v60
    s_or_b64 s[94:95], s[92:93], s[4:5]
    s_or_b64 s[94:95], s[94:95], s[6:7]
    s_cbranch_scc1 Vf2m_l
Vf2m_o:
    ds_write_b128 v3, v[16:19] offset:8192
    ds_write_b128 v3, v[20:23] offset:9216
    ds_write_b64 v4, v[56:57]
    v_smfmac_f32_16x16x64_bf16 v[72:75], v[16:19], a[32:39], v5
    v_smfmac_f32_16x16x64_bf16 v[76:79], v[16:19], a[112:119], v5
    s_waitcnt lgkmcnt(0)
    s_barrier
    ds_read_b128 v[24:27], v3 offset:10240
    ds_read_b128 v[28:31], v3 offset:11264
    ds_read_b128 v[32:35], v3 offset:4096
    v_smfmac_f32_16x16x64_bf16 v[72:75], v[20:23], a[40:47], v5
    ds_read_b128 v[36:39], v3 offset:5120
    ds_read_b128 v[40:43], v3 offset:6144
    v_smfmac_f32_16x16x64_bf16 v[76:79], v[20:23], a[120:127], v5
    ds_read_b128 v[44:47], v3 offset:7168
    ds_read_b128 v[48:51], v3 offset:12288
    ds_read_b128 v[52:55], v3 offset:13312
    s_waitcnt lgkmcnt(7)
    v_smfmac_f32_16x16x64_bf16 v[72:75], v[24:27], a[48:55], v5
    v_smfmac_f32_16x16x64_bf16 v[76:79], v[24:27], a[128:135], v5
    s_waitcnt lgkmcnt(6)
    v_smfmac_f32_16x16x64_bf16 v[72:75], v[28:31], a[56:63], v5
    v_smfmac_f32_16x16x64_bf16 v[76:79], v[28:31], a[136:143], v5
    s_waitcnt lgkmcnt(5)
    v_smfmac_f32_16x16x64_bf16 v[72:75], v[32:35], a[0:7], v5
    v_smfmac_f32_16x16x64_bf16 v[76:79], v[32:35], a[80:87], v5
    s_waitcnt lgkmcnt(4)
    v_smfmac_f32_16x16x64_bf16 v[72:75], v[36:39], a[8:15], v5
    v_smfmac_f32_16x16x64_bf16 v[76:79], v[36:39], a[88:95], v5
    s_waitcnt lgkmcnt(3)
    v_smfmac_f32_16x16x64_bf16 v[72:75], v[40:43], a[16:23], v5
    v_smfmac_f32_16x16x64_bf16 v[76:79], v[40:43], a[96:103], v5
    s_waitcnt lgkmcnt(2)
    v_smfmac_f32_16x16x64_bf16 v[72:75], v[44:47], a[24:31], v5
    v_smfmac_f32_16x16x64_bf16 v[76:79], v[44:47], a[104:111], v5
    s_waitcnt lgkmcnt(1)
    v_smfmac_f32_16x16x64_bf16 v[72:75], v[48:51], a[64:71], v5
    buffer_store_dword v59, v14, s[8:11], s44 offen offset:0
    v_smfmac_f32_16x16x64_bf16 v[76:79], v[48:51], a[144:151], v5
    s_waitcnt lgkmcnt(0)
    v_smfmac_f32_16x16x64_bf16 v[72:75], v[52:55], a[72:79], v5
    v_smfmac_f32_16x16x64_bf16 v[76:79], v[52:55], a[152:159], v5
    s_nop 3
    v_cvt_pk_bf16_f32 v80, v72, v73
    v_cvt_pk_bf16_f32 v81, v74, v75
    s_nop 1
    v_cvt_pk_bf16_f32 v82, v76, v77
    v_cvt_pk_bf16_f32 v83, v78, v79
    s_nop 1
    v_mfma_f32_16x16x32_bf16 v[88:91], v[80:83], v[84:87], 0
    s_branch Vf_qj
Vf_q3:
    s_mov_b64 s[4:5], -1
    s_mov_b64 s[6:7], -1
    s_mov_b64 s[92:93], -1
    s_mov_b32 s31, -1
Vf3m_l:
    s_mov_b64 exec, s[4:5]
    buffer_load_dwordx4 v[16:19], v3, s[8:11], s38 offen offset:0 sc1
    s_mov_b64 exec, s[6:7]
    buffer_load_dwordx4 v[20:23], v3, s[8:11], s38 offen offset:1024 sc1
    s_mov_b64 exec, s[92:93]
    buffer_load_dwordx2 v[56:57], v4, s[8:11], s39 offen offset:0 sc1
    s_mov_b64 exec, -1
    s_add_u32 s31, s31, 1
    s_cmp_lt_u32 s31, s30
    s_cselect_b32 s30, s30, 1
    s_cbranch_scc0 Vf3m_o
    s_waitcnt vmcnt(0)
    v_max3_u32 v58, v16, v17, v18
    v_max3_u32 v60, v20, v21, v22
    v_max_u32 v61, v56, v57
    v_max_u32 v58, v58, v19
    v_max_u32 v60, v60, v23
    v_cmp_eq_u32 s[92:93], -1, v61
    v_cmp_eq_u32 s[4:5], -1, v58
    v_cmp_eq_u32 s[6:7], -1, v60
    s_or_b64 s[94:95], s[92:93], s[4:5]
    s_or_b64 s[94:95], s[94:95], s[6:7]
    s_cbranch_scc1 Vf3m_l
Vf3m_o:
    ds_write_b128 v3, v[16:19] offset:8192
    ds_write_b128 v3, v[20:23] offset:9216
    ds_write_b64 v4, v[56:57]
    v_smfmac_f32_16x16x64_bf16 v[72:75], v[16:19], a[48:55], v5
    v_smfmac_f32_16x16x64_bf16 v[76:79], v[16:19], a[128:135], v5
    s_waitcnt lgkmcnt(0)
    s_barrier
    ds_read_b128 v[24:27], v3 offset:2048
    ds_read_b128 v[28:31], v3 offset:3072
    ds_read_b128 v[32:35], v3 offset:4096
    v_smfmac_f32_16x16x64_bf16 v[72:75], v[20:23], a[56:63], v5
    ds_read_b128 v[36:39], v3 offset:5120
    ds_read_b128 v[40:43], v3 offset:6144
    v_smfmac_f32_16x16x64_bf16 v[76:79], v[20:23], a[136:143], v5
    ds_read_b128 v[44:47], v3 offset:7168
    ds_read_b128 v[48:51], v3 offset:10240
    ds_read_b128 v[52:55], v3 offset:11264
    s_waitcnt lgkmcnt(7)
    v_smfmac_f32_16x16x64_bf16 v[72:75], v[24:27], a[0:7], v5
    v_smfmac_f32_16x16x64_bf16 v[76:79], v[24:27], a[80:87], v5
    s_waitcnt lgkmcnt(6)
    v_smfmac_f32_16x16x64_bf16 v[72:75], v[28:31], a[8:15], v5
    v_smfmac_f32_16x16x64_bf16 v[76:79], v[28:31], a[88:95], v5
    s_waitcnt lgkmcnt(5)
    v_smfmac_f32_16x16x64_bf16 v[72:75], v[32:35], a[16:23], v5
    v_smfmac_f32_16x16x64_bf16 v[76:79], v[32:35], a[96:103], v5
    s_waitcnt lgkmcnt(4)
    v_smfmac_f32_16x16x64_bf16 v[72:75], v[36:39], a[24:31], v5
    v_smfmac_f32_16x16x64_bf16 v[76:79], v[36:39], a[104:111], v5
    s_waitcnt lgkmcnt(3)
    v_smfmac_f32_16x16x64_bf16 v[72:75], v[40:43], a[32:39], v5
    v_smfmac_f32_16x16x64_bf16 v[76:79], v[40:43], a[112:119], v5
    s_waitcnt lgkmcnt(2)
    v_smfmac_f32_16x16x64_bf16 v[72:75], v[44:47], a[40:47], v5
    v_smfmac_f32_16x16x64_bf16 v[76:79], v[44:47], a[120:127], v5
    s_waitcnt lgkmcnt(1)
    v_smfmac_f32_16x16x64_bf16 v[72:75], v[48:51], a[64:71], v5
    buffer_store_dword v59, v14, s[8:11], s44 offen offset:0
    v_smfmac_f32_16x16x64_bf16 v[76:79], v[48:51], a[144:151], v5
    s_waitcnt lgkmcnt(0)
    v_smfmac_f32_16x16x64_bf16 v[72:75], v[52:55], a[72:79], v5
    v_smfmac_f32_16x16x64_bf16 v[76:79], v[52:55], a[152:159], v5
    s_nop 3
    v_cvt_pk_bf16_f32 v80, v72, v73
    v_cvt_pk_bf16_f32 v81, v74, v75
    s_nop 1
    v_cvt_pk_bf16_f32 v82, v76, v77
    v_cvt_pk_bf16_f32 v83, v78, v79
    s_nop 1
    v_mfma_f32_16x16x32_bf16 v[88:91], v[80:83], v[84:87], 0
Vf_qj:
    s_nop 7
    v_cvt_pk_bf16_f32 v94, v88, v89
    v_cvt_pk_bf16_f32 v95, v90, v91
    buffer_store_dwordx2 v[94:95], v6, s[8:11], s25 offen offset:0
    s_cmp_lt_u32 s32, 64
    s_cbranch_scc0 Vf_nb
    s_cmp_eq_u32 s32, 14
    s_cbranch_scc0 Vf_h
    s_mov_b32 s31, 0
    s_waitcnt vmcnt(63)
    s_branch VfB1_c
VfB1_l:
    buffer_load_dword v68, v67, s[8:11], s23 offen sc1
    s_waitcnt vmcnt(0)
VfB1_c:
    v_cmp_gt_u32 vcc, 1, v68
    s_cbranch_vccz VfB1_o
    s_sleep 4
    s_add_u32 s31, s31, 1
    s_cmp_lt_u32 s31, s30
    s_cbranch_scc1 VfB1_l
    s_mov_b32 s30, 1
VfB1_o:
    s_mov_b32 s31, 0
    s_waitcnt vmcnt(63)
    s_branch VfB2_c
VfB2_l:
    buffer_load_dword v69, v67, s[8:11], s47 offen sc1
    s_waitcnt vmcnt(0)
VfB2_c:
    v_cmp_gt_u32 vcc, 1, v69
    s_cbranch_vccz VfB2_o
    s_sleep 4
    s_add_u32 s31, s31, 1
    s_cmp_lt_u32 s31, s30
    s_cbranch_scc1 VfB2_l
    s_mov_b32 s30, 1
VfB2_o:
Vf_h:
    v_add_u32 v11, s29, v2
    s_xor_b32 s29, s29, 40960
    s_add_u32 s42, s29, s27
    ds_read_b128 a[160:163], v11 offset:0
    ds_read_b128 a[164:167], v11 offset:20480
    ds_read_b128 a[168:171], v11 offset:1024
    ds_read_b128 a[172:175], v11 offset:21504
    ds_read_b128 a[176:179], v11 offset:2048
    ds_read_b128 a[180:183], v11 offset:22528
    s_waitcnt lgkmcnt(5)
    v_mfma_f32_16x16x32_bf16 v[144:147], a[0:3], a[160:163], 0
    ds_read_b128 a[184:187], v11 offset:3072
    v_mfma_f32_16x16x32_bf16 v[152:155], a[80:83], a[160:163], 0
    s_waitcnt lgkmcnt(5)
    v_mfma_f32_16x16x32_bf16 v[148:151], a[0:3], a[164:167], 0
    ds_read_b128 a[188:191], v11 offset:23552
    v_mfma_f32_16x16x32_bf16 v[156:159], a[80:83], a[164:167], 0
    s_waitcnt lgkmcnt(5)
    v_mfma_f32_16x16x32_bf16 v[144:147], a[4:7], a[168:171], v[144:147]
    ds_read_b128 a[160:163], v11 offset:4096
    s_add_u32 s35, s28, 0
    s_add_u32 m0, s42, 0
    v_mfma_f32_16x16x32_bf16 v[152:155], a[84:87], a[168:171], v[152:155]
    buffer_load_dwordx4 v2, s[8:11], s35 offen offset:0 sc1 lds
    s_waitcnt lgkmcnt(5)
    v_mfma_f32_16x16x32_bf16 v[148:151], a[4:7], a[172:175], v[148:151]
    ds_read_b128 a[164:167], v11 offset:24576
    v_mfma_f32_16x16x32_bf16 v[156:159], a[84:87], a[172:175], v[156:159]
    s_waitcnt lgkmcnt(5)
    v_mfma_f32_16x16x32_bf16 v[144:147], a[8:11], a[176:179], v[144:147]
    ds_read_b128 a[168:171], v11 offset:5120
    v_mfma_f32_16x16x32_bf16 v[152:155], a[88:91], a[176:179], v[152:155]
    s_waitcnt lgkmcnt(5)
    v_mfma_f32_16x16x32_bf16 v[148:151], a[8:11], a[180:183], v[148:151]
    ds_read_b128 a[172:175], v11 offset:25600
    v_mfma_f32_16x16x32_bf16 v[156:159], a[88:91], a[180:183], v[156:159]
    buffer_load_dwordx4 v2, s[8:11], s35 offen offset:1024 sc1 lds
    s_waitcnt lgkmcnt(5)
    v_mfma_f32_16x16x32_bf16 v[144:147], a[12:15], a[184:187], v[144:147]
    ds_read_b128 a[176:179], v11 offset:6144
    v_mfma_f32_16x16x32_bf16 v[152:155], a[92:95], a[184:187], v[152:155]
    s_waitcnt lgkmcnt(5)
    v_mfma_f32_16x16x32_bf16 v[148:151], a[12:15], a[188:191], v[148:151]
    ds_read_b128 a[180:183], v11 offset:26624
    v_mfma_f32_16x16x32_bf16 v[156:159], a[92:95], a[188:191], v[156:159]
    s_waitcnt lgkmcnt(5)
    v_mfma_f32_16x16x32_bf16 v[144:147], a[16:19], a[160:163], v[144:147]
    ds_read_b128 a[184:187], v11 offset:7168
    v_mfma_f32_16x16x32_bf16 v[152:155], a[96:99], a[160:163], v[152:155]
    buffer_load_dwordx4 v2, s[8:11], s35 offen offset:2048 sc1 lds
    s_waitcnt lgkmcnt(5)
    v_mfma_f32_16x16x32_bf16 v[148:151], a[16:19], a[164:167], v[148:151]
    ds_read_b128 a[188:191], v11 offset:27648
    v_mfma_f32_16x16x32_bf16 v[156:159], a[96:99], a[164:167], v[156:159]
    s_waitcnt lgkmcnt(5)
    v_mfma_f32_16x16x32_bf16 v[144:147], a[20:23], a[168:171], v[144:147]
    ds_read_b128 a[160:163], v11 offset:8192
    v_mfma_f32_16x16x32_bf16 v[152:155], a[100:103], a[168:171], v[152:155]
    s_waitcnt lgkmcnt(5)
    v_mfma_f32_16x16x32_bf16 v[148:151], a[20:23], a[172:175], v[148:151]
    ds_read_b128 a[164:167], v11 offset:28672
    v_mfma_f32_16x16x32_bf16 v[156:159], a[100:103], a[172:175], v[156:159]
    buffer_load_dwordx4 v2, s[8:11], s35 offen offset:3072 sc1 lds
    s_waitcnt lgkmcnt(5)
    v_mfma_f32_16x16x32_bf16 v[144:147], a[24:27], a[176:179], v[144:147]
    ds_read_b128 a[168:171], v11 offset:9216
    v_mfma_f32_16x16x32_bf16 v[152:155], a[104:107], a[176:179], v[152:155]
    s_waitcnt lgkmcnt(5)
    v_mfma_f32_16x16x32_bf16 v[148:151], a[24:27], a[180:183], v[148:151]
    ds_read_b128 a[172:175], v11 offset:29696
    v_mfma_f32_16x16x32_bf16 v[156:159], a[104:107], a[180:183], v[156:159]
    s_waitcnt lgkmcnt(5)
    v_mfma_f32_16x16x32_bf16 v[144:147], a[28:31], a[184:187], v[144:147]
    ds_read_b128 a[176:179], v11 offset:10240
    s_add_u32 s35, s28, 4096
    s_add_u32 m0, s42, 4096
    v_mfma_f32_16x16x32_bf16 v[152:155], a[108:111], a[184:187], v[152:155]
    buffer_load_dwordx4 v2, s[8:11], s35 offen offset:0 sc1 lds
    s_waitcnt lgkmcnt(5)
    v_mfma_f32_16x16x32_bf16 v[148:151], a[28:31], a[188:191], v[148:151]
    ds_read_b128 a[180:183], v11 offset:30720
    v_mfma_f32_16x16x32_bf16 v[156:159], a[108:111], a[188:191], v[156:159]
    s_waitcnt lgkmcnt(5)
    v_mfma_f32_16x16x32_bf16 v[144:147], a[32:35], a[160:163], v[144:147]
    ds_read_b128 a[184:187], v11 offset:11264
    v_mfma_f32_16x16x32_bf16 v[152:155], a[112:115], a[160:163], v[152:155]
    s_waitcnt lgkmcnt(5)
    v_mfma_f32_16x16x32_bf16 v[148:151], a[32:35], a[164:167], v[148:151]
    ds_read_b128 a[188:191], v11 offset:31744
    v_mfma_f32_16x16x32_bf16 v[156:159], a[112:115], a[164:167], v[156:159]
    buffer_load_dwordx4 v2, s[8:11], s35 offen offset:1024 sc1 lds
    s_waitcnt lgkmcnt(5)
    v_mfma_f32_16x16x32_bf16 v[144:147], a[36:39], a[168:171], v[144:147]
    ds_read_b128 a[160:163], v11 offset:12288
    v_mfma_f32_16x16x32_bf16 v[152:155], a[116:119], a[168:171], v[152:155]
    s_waitcnt lgkmcnt(5)
    v_mfma_f32_16x16x32_bf16 v[148:151], a[36:39], a[172:175], v[148:151]
    ds_read_b128 a[164:167], v11 offset:32768
    v_mfma_f32_16x16x32_bf16 v[156:159], a[116:119], a[172:175], v[156:159]
    s_waitcnt lgkmcnt(5)
    v_mfma_f32_16x16x32_bf16 v[144:147], a[40:43], a[176:179], v[144:147]
    ds_read_b128 a[168:171], v11 offset:13312
    v_mfma_f32_16x16x32_bf16 v[152:155], a[120:123], a[176:179], v[152:155]
    buffer_load_dwordx4 v2, s[8:11], s35 offen offset:2048 sc1 lds
    s_waitcnt lgkmcnt(5)
    v_mfma_f32_16x16x32_bf16 v[148:151], a[40:43], a[180:183], v[148:151]
    ds_read_b128 a[172:175], v11 offset:33792
    v_mfma_f32_16x16x32_bf16 v[156:159], a[120:123], a[180:183], v[156:159]
    buffer_store_dwordx2 v[240:241], v6, s[8:11], s26 offen offset:0
    buffer_store_dwordx4 v[240:243], v7, s[8:11], s34 offen offset:0 sc1
    s_waitcnt lgkmcnt(5)
    v_mfma_f32_16x16x32_bf16 v[144:147], a[44:47], a[184:187], v[144:147]
    ds_read_b128 a[176:179], v11 offset:14336
    v_mfma_f32_16x16x32_bf16 v[152:155], a[124:127], a[184:187], v[152:155]
    s_waitcnt lgkmcnt(5)
    v_mfma_f32_16x16x32_bf16 v[148:151], a[44:47], a[188:191], v[148:151]
    ds_read_b128 a[180:183], v11 offset:34816
    v_mfma_f32_16x16x32_bf16 v[156:159], a[124:127], a[188:191], v[156:159]
    buffer_load_dwordx4 v2, s[8:11], s35 offen offset:3072 sc1 lds
    s_waitcnt lgkmcnt(5)
    v_mfma_f32_16x16x32_bf16 v[144:147], a[48:51], a[160:163], v[144:147]
    ds_read_b128 a[184:187], v11 offset:15360
    v_mfma_f32_16x16x32_bf16 v[152:155], a[128:131], a[160:163], v[152:155]
    s_waitcnt lgkmcnt(5)
    v_mfma_f32_16x16x32_bf16 v[148:151], a[48:51], a[164:167], v[148:151]
    ds_read_b128 a[188:191], v11 offset:35840
    v_mfma_f32_16x16x32_bf16 v[156:159], a[128:131], a[164:167], v[156:159]
    s_waitcnt lgkmcnt(5)
    v_mfma_f32_16x16x32_bf16 v[144:147], a[52:55], a[168:171], v[144:147]
    ds_read_b128 a[160:163], v11 offset:16384
    s_add_u32 s35, s28, 8192
    s_add_u32 m0, s42, 8192
    v_mfma_f32_16x16x32_bf16 v[152:155], a[132:135], a[168:171], v[152:155]
    buffer_load_dwordx4 v2, s[8:11], s35 offen offset:0 sc1 lds
    s_waitcnt lgkmcnt(5)
    v_mfma_f32_16x16x32_bf16 v[148:151], a[52:55], a[172:175], v[148:151]
    ds_read_b128 a[164:167], v11 offset:36864
    v_mfma_f32_16x16x32_bf16 v[156:159], a[132:135], a[172:175], v[156:159]
    s_waitcnt lgkmcnt(5)
    v_mfma_f32_16x16x32_bf16 v[144:147], a[56:59], a[176:179], v[144:147]
    ds_read_b128 a[168:171], v11 offset:17408
    v_mfma_f32_16x16x32_bf16 v[152:155], a[136:139], a[176:179], v[152:155]
    s_waitcnt lgkmcnt(5)
    v_mfma_f32_16x16x32_bf16 v[148:151], a[56:59], a[180:183], v[148:151]
    ds_read_b128 a[172:175], v11 offset:37888
    v_mfma_f32_16x16x32_bf16 v[156:159], a[136:139], a[180:183], v[156:159]
    buffer_load_dwordx4 v2, s[8:11], s35 offen offset:1024 sc1 lds
    s_waitcnt lgkmcnt(5)
    v_mfma_f32_16x16x32_bf16 v[144:147], a[60:63], a[184:187], v[144:147]
    ds_read_b128 a[176:179], v11 offset:18432
    v_mfma_f32_16x16x32_bf16 v[152:155], a[140:143], a[184:187], v[152:155]
    s_waitcnt lgkmcnt(5)
    v_mfma_f32_16x16x32_bf16 v[148:151], a[60:63], a[188:191], v[148:151]
    ds_read_b128 a[180:183], v11 offset:38912
    v_mfma_f32_16x16x32_bf16 v[156:159], a[140:143], a[188:191], v[156:159]
    s_waitcnt lgkmcnt(5)
    v_mfma_f32_16x16x32_bf16 v[144:147], a[64:67], a[160:163], v[144:147]
    ds_read_b128 a[184:187], v11 offset:19456
    v_mfma_f32_16x16x32_bf16 v[152:155], a[144:147], a[160:163], v[152:155]
    s_waitcnt lgkmcnt(5)
    v_mfma_f32_16x16x32_bf16 v[148:151], a[64:67], a[164:167], v[148:151]
    ds_read_b128 a[188:191], v11 offset:39936
    v_mfma_f32_16x16x32_bf16 v[156:159], a[144:147], a[164:167], v[156:159]
    s_waitcnt lgkmcnt(5)
    v_mfma_f32_16x16x32_bf16 v[144:147], a[68:71], a[168:171], v[144:147]
    v_mfma_f32_16x16x32_bf16 v[152:155], a[148:151], a[168:171], v[152:155]
    s_waitcnt lgkmcnt(4)
    v_mfma_f32_16x16x32_bf16 v[148:151], a[68:71], a[172:175], v[148:151]
    v_mfma_f32_16x16x32_bf16 v[156:159], a[148:151], a[172:175], v[156:159]
    s_waitcnt lgkmcnt(3)
    v_mfma_f32_16x16x32_bf16 v[144:147], a[72:75], a[176:179], v[144:147]
    v_mfma_f32_16x16x32_bf16 v[152:155], a[152:155], a[176:179], v[152:155]
    s_waitcnt lgkmcnt(2)
    v_mfma_f32_16x16x32_bf16 v[148:151], a[72:75], a[180:183], v[148:151]
    v_mfma_f32_16x16x32_bf16 v[156:159], a[152:155], a[180:183], v[156:159]
    s_waitcnt lgkmcnt(1)
    v_mfma_f32_16x16x32_bf16 v[144:147], a[76:79], a[184:187], v[144:147]
    v_mfma_f32_16x16x32_bf16 v[152:155], a[156:159], a[184:187], v[152:155]
    s_waitcnt lgkmcnt(0)
    v_mfma_f32_16x16x32_bf16 v[148:151], a[76:79], a[188:191], v[148:151]
    v_mfma_f32_16x16x32_bf16 v[156:159], a[156:159], a[188:191], v[156:159]
    s_add_u32 s28, s28, 40960
    s_add_u32 s32, s32, 1
    s_cmp_eq_u32 s32, 1
    s_cbranch_scc0 VfB0_o
    s_mov_b32 s31, 0
VfB0_l:
    buffer_load_dword v68, v70, s[8:11], s49 offen sc1
    s_waitcnt vmcnt(0)
VfB0_c:
    v_cmp_gt_u32 vcc, 1, v68
    s_cbranch_vccz VfB0_o
    s_sleep 2
    s_add_u32 s31, s31, 1
    s_cmp_lt_u32 s31, s30
    s_cbranch_scc1 VfB0_l
    s_mov_b32 s30, 1
VfB0_o:
    s_cmp_eq_u32 s32, 12
    s_cbranch_scc0 Vf_n12
    buffer_load_dword v68, v67, s[8:11], s23 offen offset:0 sc1
    buffer_load_dword v69, v67, s[8:11], s47 offen offset:0 sc1
Vf_n12:
    s_add_u32 s4, s32, 3
    s_and_b32 s4, s4, 3
    s_mul_i32 s4, s4, 49152
    s_add_u32 s4, s4, s43
    s_add_u32 s5, s4, 6144
    v_cvt_pk_bf16_f32 v160, v144, v145
    v_cvt_pk_bf16_f32 v161, v152, v153
    v_cvt_pk_bf16_f32 v162, v146, v147
    v_cvt_pk_bf16_f32 v163, v154, v155
    buffer_store_dwordx4 v[160:163], v2, s[8:11], s4 offen offset:0
    v_cvt_pk_bf16_f32 v164, v148, v149
    v_cvt_pk_bf16_f32 v165, v156, v157
    v_cvt_pk_bf16_f32 v166, v150, v151
    v_cvt_pk_bf16_f32 v167, v158, v159
    buffer_store_dwordx4 v[164:167], v2, s[8:11], s5 offen offset:0
    s_waitcnt vmcnt(0)
    v_mov_b32 v10, s32
    s_mov_b64 exec, 1
    buffer_store_dword v10, v9, s[8:11], s33 offen
    s_mov_b64 exec, -1
    s_cmp_lt_u32 s32, 4
    s_cbranch_scc0 Vf_nb
    s_barrier
    s_branch Vf_h
Vf_nb:
    s_cmp_eq_u32 s21, 62
    s_cbranch_scc0 Vf_np
    s_barrier
    buffer_store_dwordx2 v[240:241], v6, s[8:11], s26 offen offset:0
    buffer_store_dwordx4 v[240:243], v7, s[8:11], s34 offen offset:0 sc1
Vf_np:
    s_cmp_lt_u32 s21, 63
    s_cbranch_scc1 Vf_loop
    s_cmp_eq_u32 s21, 64
    s_cbranch_scc1 V_t3
    s_load_dwordx2 s[88:89], s[0:1], 64
    s_mov_b32 s90, 1280
    s_mov_b32 s91, 0x20000
    s_waitcnt lgkmcnt(0)
    v_lshlrev_b32 v71, 2, v1
    v_lshlrev_b32 v70, 3, v1
    s_mov_b32 s4, 5120
    buffer_load_dwordx2 v[146:147], v70, s[8:11], s4 offen offset:0 sc1
    buffer_load_dwordx2 v[148:149], v70, s[8:11], s4 offen offset:512 sc1
    buffer_load_dwordx2 v[150:151], v70, s[8:11], s4 offen offset:1024 sc1
    buffer_load_dwordx2 v[152:153], v70, s[8:11], s4 offen offset:1536 sc1
    buffer_load_dwordx2 v[154:155], v70, s[8:11], s4 offen offset:2048 sc1
    s_mov_b32 s5, 7680
    s_mov_b32 s6, 10240
    s_mov_b32 s7, 12800
    buffer_load_dwordx2 v[100:101], v70, s[8:11], s5 offen offset:0 sc1
    buffer_load_dwordx2 v[110:111], v70, s[8:11], s6 offen offset:0 sc1
    buffer_load_dwordx2 v[120:121], v70, s[8:11], s7 offen offset:0 sc1
    buffer_load_dword v140, v71, s[88:91], 0 offen offset:0
    buffer_load_dwordx2 v[102:103], v70, s[8:11], s5 offen offset:512 sc1
    buffer_load_dwordx2 v[112:113], v70, s[8:11], s6 offen offset:512 sc1
    buffer_load_dwordx2 v[122:123], v70, s[8:11], s7 offen offset:512 sc1
    buffer_load_dword v141, v71, s[88:91], 0 offen offset:256
    buffer_load_dwordx2 v[104:105], v70, s[8:11], s5 offen offset:1024 sc1
    buffer_load_dwordx2 v[114:115], v70, s[8:11], s6 offen offset:1024 sc1
    buffer_load_dwordx2 v[124:125], v70, s[8:11], s7 offen offset:1024 sc1
    buffer_load_dword v142, v71, s[88:91], 0 offen offset:512
    buffer_load_dwordx2 v[106:107], v70, s[8:11], s5 offen offset:1536 sc1
    buffer_load_dwordx2 v[116:117], v70, s[8:11], s6 offen offset:1536 sc1
    buffer_load_dwordx2 v[126:127], v70, s[8:11], s7 offen offset:1536 sc1
    buffer_load_dword v143, v71, s[88:91], 0 offen offset:768
    buffer_load_dwordx2 v[108:109], v70, s[8:11], s5 offen offset:2048 sc1
    buffer_load_dwordx2 v[118:119], v70, s[8:11], s6 offen offset:2048 sc1
    buffer_load_dwordx2 v[128:129], v70, s[8:11], s7 offen offset:2048 sc1
    buffer_load_dword v144, v71, s[88:91], 0 offen offset:1024
    s_waitcnt vmcnt(0)
    v_add_f32 v110, 1.0, v110
    v_cvt_pk_bf16_f32 v110, v110, v110
    v_and_b32 v110, 0xffff0000, v110
    v_add_f32 v111, 1.0, v111
    v_cvt_pk_bf16_f32 v111, v111, v111
    v_and_b32 v111, 0xffff0000, v111
    v_add_f32 v112, 1.0, v112
    v_cvt_pk_bf16_f32 v112, v112, v112
    v_and_b32 v112, 0xffff0000, v112
    v_add_f32 v113, 1.0, v113
    v_cvt_pk_bf16_f32 v113, v113, v113
    v_and_b32 v113, 0xffff0000, v113
    v_add_f32 v114, 1.0, v114
    v_cvt_pk_bf16_f32 v114, v114, v114
    v_and_b32 v114, 0xffff0000, v114
    v_add_f32 v115, 1.0, v115
    v_cvt_pk_bf16_f32 v115, v115, v115
    v_and_b32 v115, 0xffff0000, v115
    v_add_f32 v116, 1.0, v116
    v_cvt_pk_bf16_f32 v116, v116, v116
    v_and_b32 v116, 0xffff0000, v116
    v_add_f32 v117, 1.0, v117
    v_cvt_pk_bf16_f32 v117, v117, v117
    v_and_b32 v117, 0xffff0000, v117
    v_add_f32 v118, 1.0, v118
    v_cvt_pk_bf16_f32 v118, v118, v118
    v_and_b32 v118, 0xffff0000, v118
    v_add_f32 v119, 1.0, v119
    v_cvt_pk_bf16_f32 v119, v119, v119
    v_and_b32 v119, 0xffff0000, v119
    v_lshlrev_b32 v130, 16, v140
    v_and_b32 v131, 0xffff0000, v140
    v_lshlrev_b32 v132, 16, v141
    v_and_b32 v133, 0xffff0000, v141
    v_lshlrev_b32 v134, 16, v142
    v_and_b32 v135, 0xffff0000, v142
    v_lshlrev_b32 v136, 16, v143
    v_and_b32 v137, 0xffff0000, v143
    v_lshlrev_b32 v138, 16, v144
    v_and_b32 v139, 0xffff0000, v144
    s_branch Vf_loop
Vs_go:
Vs_loop:
    s_and_b32 s4, s21, 3
    s_mul_i32 s5, s4, 10240
    s_add_u32 s5, s5, s22
    s_sub_u32 s38, s5, 73728
    s_sub_u32 s39, s5, 81920
    s_mul_i32 s5, s4, 12288
    s_add_u32 s25, s24, s5
    s_xor_b32 s4, s4, 2
    s_mul_i32 s5, s4, 163840
    s_add_u32 s34, s36, s5
    s_mul_i32 s5, s4, 12288
    s_add_u32 s26, s24, s5
    s_add_u32 s21, s21, 1
    v_mov_b32 v72, 0
    v_mov_b32 v73, 0
    v_mov_b32 v74, 0
    v_mov_b32 v75, 0
    v_mov_b32 v76, 0
    v_mov_b32 v77, 0
    v_mov_b32 v78, 0
    v_mov_b32 v79, 0
    v_mov_b32 v59, s21
    s_cmp_eq_u32 s3, 1
    s_cbranch_scc1 Vs_q1
    s_cmp_eq_u32 s3, 2
    s_cbranch_scc1 Vs_q2
    s_cmp_eq_u32 s3, 3
    s_cbranch_scc1 Vs_q3
Vs_q0:
    s_mov_b64 s[4:5], -1
    s_mov_b64 s[6:7], -1
    s_mov_b64 s[92:93], -1
    s_mov_b32 s31, -1
Vs0m_l:
    s_mov_b64 exec, s[4:5]
    buffer_load_dwordx4 v[16:19], v3, s[8:11], s38 offen offset:0 sc1
    s_mov_b64 exec, s[6:7]
    buffer_load_dwordx4 v[20:23], v3, s[8:11], s38 offen offset:1024 sc1
    s_mov_b64 exec, s[92:93]
    buffer_load_dwordx2 v[56:57], v4, s[8:11], s39 offen offset:0 sc1
    s_mov_b64 exec, -1
    s_add_u32 s31, s31, 1
    s_cmp_lt_u32 s31, s30
    s_cselect_b32 s30, s30, 1
    s_cbranch_scc0 Vs0m_o
    s_waitcnt vmcnt(0)
    v_max3_u32 v58, v16, v17, v18
    v_max3_u32 v60, v20, v21, v22
    v_max_u32 v61, v56, v57
    v_max_u32 v58, v58, v19
    v_max_u32 v60, v60, v23
    v_cmp_eq_u32 s[92:93], -1, v61
    v_cmp_eq_u32 s[4:5], -1, v58
    v_cmp_eq_u32 s[6:7], -1, v60
    s_or_b64 s[94:95], s[92:93], s[4:5]
    s_or_b64 s[94:95], s[94:95], s[6:7]
    s_cbranch_scc1 Vs0m_l
Vs0m_o:
    ds_write_b128 v3, v[16:19] offset:8192
    ds_write_b128 v3, v[20:23] offset:9216
    ds_write_b64 v4, v[56:57]
    v_smfmac_f32_16x16x64_bf16 v[72:75], v[16:19], a[0:7], v5
    v_smfmac_f32_16x16x64_bf16 v[76:79], v[16:19], a[80:87], v5
    s_waitcnt lgkmcnt(0)
    s_barrier
    ds_read_b128 v[24:27], v3 offset:10240
    ds_read_b128 v[28:31], v3 offset:11264
    ds_read_b128 v[32:35], v3 offset:12288
    v_smfmac_f32_16x16x64_bf16 v[72:75], v[20:23], a[8:15], v5
    ds_read_b128 v[36:39], v3 offset:13312
    ds_read_b128 v[40:43], v3 offset:14336
    v_smfmac_f32_16x16x64_bf16 v[76:79], v[20:23], a[88:95], v5
    ds_read_b128 v[44:47], v3 offset:15360
    ds_read_b128 v[48:51], v3 offset:16384
    ds_read_b128 v[52:55], v3 offset:17408
    s_waitcnt lgkmcnt(7)
    v_smfmac_f32_16x16x64_bf16 v[72:75], v[24:27], a[16:23], v5
    v_smfmac_f32_16x16x64_bf16 v[76:79], v[24:27], a[96:103], v5
    s_waitcnt lgkmcnt(6)
    v_smfmac_f32_16x16x64_bf16 v[72:75], v[28:31], a[24:31], v5
    v_smfmac_f32_16x16x64_bf16 v[76:79], v[28:31], a[104:111], v5
    s_waitcnt lgkmcnt(5)
    v_smfmac_f32_16x16x64_bf16 v[72:75], v[32:35], a[32:39], v5
    v_smfmac_f32_16x16x64_bf16 v[76:79], v[32:35], a[112:119], v5
    s_waitcnt lgkmcnt(4)
    v_smfmac_f32_16x16x64_bf16 v[72:75], v[36:39], a[40:47], v5
    v_smfmac_f32_16x16x64_bf16 v[76:79], v[36:39], a[120:127], v5
    s_waitcnt lgkmcnt(3)
    v_smfmac_f32_16x16x64_bf16 v[72:75], v[40:43], a[48:55], v5
    v_smfmac_f32_16x16x64_bf16 v[76:79], v[40:43], a[128:135], v5
    s_waitcnt lgkmcnt(2)
    v_smfmac_f32_16x16x64_bf16 v[72:75], v[44:47], a[56:63], v5
    v_smfmac_f32_16x16x64_bf16 v[76:79], v[44:47], a[136:143], v5
    s_waitcnt lgkmcnt(1)
    v_smfmac_f32_16x16x64_bf16 v[72:75], v[48:51], a[64:71], v5
    buffer_store_dword v59, v14, s[8:11], s44 offen offset:0 sc1
    v_smfmac_f32_16x16x64_bf16 v[76:79], v[48:51], a[144:151], v5
    s_waitcnt lgkmcnt(0)
    v_smfmac_f32_16x16x64_bf16 v[72:75], v[52:55], a[72:79], v5
    v_smfmac_f32_16x16x64_bf16 v[76:79], v[52:55], a[152:159], v5
    s_nop 3
    v_cvt_pk_bf16_f32 v80, v72, v73
    v_cvt_pk_bf16_f32 v81, v74, v75
    s_nop 1
    v_cvt_pk_bf16_f32 v82, v76, v77
    v_cvt_pk_bf16_f32 v83, v78, v79
    s_nop 1
    v_mfma_f32_16x16x32_bf16 v[88:91], v[80:83], v[84:87], 0
    s_branch Vs_qj
Vs_q1:
    s_mov_b64 s[4:5], -1
    s_mov_b64 s[6:7], -1
    s_mov_b64 s[92:93], -1
    s_mov_b32 s31, -1
Vs1m_l:
    s_mov_b64 exec, s[4:5]
    buffer_load_dwordx4 v[16:19], v3, s[8:11], s38 offen offset:0 sc1
    s_mov_b64 exec, s[6:7]
    buffer_load_dwordx4 v[20:23], v3, s[8:11], s38 offen offset:1024 sc1
    s_mov_b64 exec, s[92:93]
    buffer_load_dwordx2 v[56:57], v4, s[8:11], s39 offen offset:0 sc1
    s_mov_b64 exec, -1
    s_add_u32 s31, s31, 1
    s_cmp_lt_u32 s31, s30
    s_cselect_b32 s30, s30, 1
    s_cbranch_scc0 Vs1m_o
    s_waitcnt vmcnt(0)
    v_max3_u32 v58, v16, v17, v18
    v_max3_u32 v60, v20, v21, v22
    v_max_u32 v61, v56, v57
    v_max_u32 v58, v58, v19
    v_max_u32 v60, v60, v23
    v_cmp_eq_u32 s[92:93], -1, v61
    v_cmp_eq_u32 s[4:5], -1, v58
    v_cmp_eq_u32 s[6:7], -1, v60
    s_or_b64 s[94:95], s[92:93], s[4:5]
    s_or_b64 s[94:95], s[94:95], s[6:7]
    s_cbranch_scc1 Vs1m_l
Vs1m_o:
    ds_write_b128 v3, v[16:19] offset:8192
    ds_write_b128 v3, v[20:23] offset:9216
    ds_write_b64 v4, v[56:57]
    v_smfmac_f32_16x16x64_bf16 v[72:75], v[16:19], a[16:23], v5
    v_smfmac_f32_16x16x64_bf16 v[76:79], v[16:19], a[96:103], v5
    s_waitcnt lgkmcnt(0)
    s_barrier
    ds_read_b128 v[24:27], v3 offset:10240
    ds_read_b128 v[28:31], v3 offset:11264
    ds_read_b128 v[32:35], v3 offset:12288
    v_smfmac_f32_16x16x64_bf16 v[72:75], v[20:23], a[24:31], v5
    ds_read_b128 v[36:39], v3 offset:13312
    ds_read_b128 v[40:43], v3 offset:6144
    v_smfmac_f32_16x16x64_bf16 v[76:79], v[20:23], a[104:111], v5
    ds_read_b128 v[44:47], v3 offset:7168
    ds_read_b128 v[48:51], v3 offset:14336
    ds_read_b128 v[52:55], v3 offset:15360
    s_waitcnt lgkmcnt(7)
    v_smfmac_f32_16x16x64_bf16 v[72:75], v[24:27], a[32:39], v5
    v_smfmac_f32_16x16x64_bf16 v[76:79], v[24:27], a[112:119], v5
    s_waitcnt lgkmcnt(6)
    v_smfmac_f32_16x16x64_bf16 v[72:75], v[28:31], a[40:47], v5
    v_smfmac_f32_16x16x64_bf16 v[76:79], v[28:31], a[120:127], v5
    s_waitcnt lgkmcnt(5)
    v_smfmac_f32_16x16x64_bf16 v[72:75], v[32:35], a[48:55], v5
    v_smfmac_f32_16x16x64_bf16 v[76:79], v[32:35], a[128:135], v5
    s_waitcnt lgkmcnt(4)
    v_smfmac_f32_16x16x64_bf16 v[72:75], v[36:39], a[56:63], v5
    v_smfmac_f32_16x16x64_bf16 v[76:79], v[36:39], a[136:143], v5
    s_waitcnt lgkmcnt(3)
    v_smfmac_f32_16x16x64_bf16 v[72:75], v[40:43], a[0:7], v5
    v_smfmac_f32_16x16x64_bf16 v[76:79], v[40:43], a[80:87], v5
    s_waitcnt lgkmcnt(2)
    v_smfmac_f32_16x16x64_bf16 v[72:75], v[44:47], a[8:15], v5
    v_smfmac_f32_16x16x64_bf16 v[76:79], v[44:47], a[88:95], v5
    s_waitcnt lgkmcnt(1)
    v_smfmac_f32_16x16x64_bf16 v[72:75], v[48:51], a[64:71], v5
    buffer_store_dword v59, v14, s[8:11], s44 offen offset:0 sc1
    v_smfmac_f32_16x16x64_bf16 v[76:79], v[48:51], a[144:151], v5
    s_waitcnt lgkmcnt(0)
    v_smfmac_f32_16x16x64_bf16 v[72:75], v[52:55], a[72:79], v5
    v_smfmac_f32_16x16x64_bf16 v[76:79], v[52:55], a[152:159], v5
    s_nop 3
    v_cvt_pk_bf16_f32 v80, v72, v73
    v_cvt_pk_bf16_f32 v81, v74, v75
    s_nop 1
    v_cvt_pk_bf16_f32 v82, v76, v77
    v_cvt_pk_bf16_f32 v83, v78, v79
    s_nop 1
    v_mfma_f32_16x16x32_bf16 v[88:91], v[80:83], v[84:87], 0
    s_branch Vs_qj
Vs_q2:
    s_mov_b64 s[4:5], -1
    s_mov_b64 s[6:7], -1
    s_mov_b64 s[92:93], -1
    s_mov_b32 s31, -1
Vs2m_l:
    s_mov_b64 exec, s[4:5]
    buffer_load_dwordx4 v[16:19], v3, s[8:11], s38 offen offset:0 sc1
    s_mov_b64 exec, s[6:7]
    buffer_load_dwordx4 v[20:23], v3, s[8:11], s38 offen offset:1024 sc1
    s_mov_b64 exec, s[92:93]
    buffer_load_dwordx2 v[56:57], v4, s[8:11], s39 offen offset:0 sc1
    s_mov_b64 exec, -1
    s_add_u32 s31, s31, 1
    s_cmp_lt_u32 s31, s30
    s_cselect_b32 s30, s30, 1
    s_cbranch_scc0 Vs2m_o
    s_waitcnt vmcnt(0)
    v_max3_u32 v58, v16, v17, v18
    v_max3_u32 v60, v20, v21, v22
    v_max_u32 v61, v56, v57
    v_max_u32 v58, v58, v19
    v_max_u32 v60, v60, v23
    v_cmp_eq_u32 s[92:93], -1, v61
    v_cmp_eq_u32 s[4:5], -1, v58
    v_cmp_eq_u32 s[6:7], -1, v60
    s_or_b64 s[94:95], s[92:93], s[4:5]
    s_or_b64 s[94:95], s[94:95], s[6:7]
    s_cbranch_scc1 Vs2m_l
Vs2m_o:
    ds_write_b128 v3, v[16:19] offset:8192
    ds_write_b128 v3, v[20:23] offset:9216
    ds_write_b64 v4, v[56:57]
    v_smfmac_f32_16x16x64_bf16 v[72:75], v[16:19], a[32:39], v5
    v_smfmac_f32_16x16x64_bf16 v[76:79], v[16:19], a[112:119], v5
    s_waitcnt lgkmcnt(0)
    s_barrier
    ds_read_b128 v[24:27], v3 offset:10240
    ds_read_b128 v[28:31], v3 offset:11264
    ds_read_b128 v[32:35], v3 offset:4096
    v_smfmac_f32_16x16x64_bf16 v[72:75], v[20:23], a[40:47], v5
    ds_read_b128 v[36:39], v3 offset:5120
    ds_read_b128 v[40:43], v3 offset:6144
    v_smfmac_f32_16x16x64_bf16 v[76:79], v[20:23], a[120:127], v5
    ds_read_b128 v[44:47], v3 offset:7168
    ds_read_b128 v[48:51], v3 offset:12288
    ds_read_b128 v[52:55], v3 offset:13312
    s_waitcnt lgkmcnt(7)
    v_smfmac_f32_16x16x64_bf16 v[72:75], v[24:27], a[48:55], v5
    v_smfmac_f32_16x16x64_bf16 v[76:79], v[24:27], a[128:135], v5
    s_waitcnt lgkmcnt(6)
    v_smfmac_f32_16x16x64_bf16 v[72:75], v[28:31], a[56:63], v5
    v_smfmac_f32_16x16x64_bf16 v[76:79], v[28:31], a[136:143], v5
    s_waitcnt lgkmcnt(5)
    v_smfmac_f32_16x16x64_bf16 v[72:75], v[32:35], a[0:7], v5
    v_smfmac_f32_16x16x64_bf16 v[76:79], v[32:35], a[80:87], v5
    s_waitcnt lgkmcnt(4)
    v_smfmac_f32_16x16x64_bf16 v[72:75], v[36:39], a[8:15], v5
    v_smfmac_f32_16x16x64_bf16 v[76:79], v[36:39], a[88:95], v5
    s_waitcnt lgkmcnt(3)
    v_smfmac_f32_16x16x64_bf16 v[72:75], v[40:43], a[16:23], v5
    v_smfmac_f32_16x16x64_bf16 v[76:79], v[40:43], a[96:103], v5
    s_waitcnt lgkmcnt(2)
    v_smfmac_f32_16x16x64_bf16 v[72:75], v[44:47], a[24:31], v5
    v_smfmac_f32_16x16x64_bf16 v[76:79], v[44:47], a[104:111], v5
    s_waitcnt lgkmcnt(1)
    v_smfmac_f32_16x16x64_bf16 v[72:75], v[48:51], a[64:71], v5
    buffer_store_dword v59, v14, s[8:11], s44 offen offset:0 sc1
    v_smfmac_f32_16x16x64_bf16 v[76:79], v[48:51], a[144:151], v5
    s_waitcnt lgkmcnt(0)
    v_smfmac_f32_16x16x64_bf16 v[72:75], v[52:55], a[72:79], v5
    v_smfmac_f32_16x16x64_bf16 v[76:79], v[52:55], a[152:159], v5
    s_nop 3
    v_cvt_pk_bf16_f32 v80, v72, v73
    v_cvt_pk_bf16_f32 v81, v74, v75
    s_nop 1
    v_cvt_pk_bf16_f32 v82, v76, v77
    v_cvt_pk_bf16_f32 v83, v78, v79
    s_nop 1
    v_mfma_f32_16x16x32_bf16 v[88:91], v[80:83], v[84:87], 0
    s_branch Vs_qj
Vs_q3:
    s_mov_b64 s[4:5], -1
    s_mov_b64 s[6:7], -1
    s_mov_b64 s[92:93], -1
    s_mov_b32 s31, -1
Vs3m_l:
    s_mov_b64 exec, s[4:5]
    buffer_load_dwordx4 v[16:19], v3, s[8:11], s38 offen offset:0 sc1
    s_mov_b64 exec, s[6:7]
    buffer_load_dwordx4 v[20:23], v3, s[8:11], s38 offen offset:1024 sc1
    s_mov_b64 exec, s[92:93]
    buffer_load_dwordx2 v[56:57], v4, s[8:11], s39 offen offset:0 sc1
    s_mov_b64 exec, -1
    s_add_u32 s31, s31, 1
    s_cmp_lt_u32 s31, s30
    s_cselect_b32 s30, s30, 1
    s_cbranch_scc0 Vs3m_o
    s_waitcnt vmcnt(0)
    v_max3_u32 v58, v16, v17, v18
    v_max3_u32 v60, v20, v21, v22
    v_max_u32 v61, v56, v57
    v_max_u32 v58, v58, v19
    v_max_u32 v60, v60, v23
    v_cmp_eq_u32 s[92:93], -1, v61
    v_cmp_eq_u32 s[4:5], -1, v58
    v_cmp_eq_u32 s[6:7], -1, v60
    s_or_b64 s[94:95], s[92:93], s[4:5]
    s_or_b64 s[94:95], s[94:95], s[6:7]
    s_cbranch_scc1 Vs3m_l
Vs3m_o:
    ds_write_b128 v3, v[16:19] offset:8192
    ds_write_b128 v3, v[20:23] offset:9216
    ds_write_b64 v4, v[56:57]
    v_smfmac_f32_16x16x64_bf16 v[72:75], v[16:19], a[48:55], v5
    v_smfmac_f32_16x16x64_bf16 v[76:79], v[16:19], a[128:135], v5
    s_waitcnt lgkmcnt(0)
    s_barrier
    ds_read_b128 v[24:27], v3 offset:2048
    ds_read_b128 v[28:31], v3 offset:3072
    ds_read_b128 v[32:35], v3 offset:4096
    v_smfmac_f32_16x16x64_bf16 v[72:75], v[20:23], a[56:63], v5
    ds_read_b128 v[36:39], v3 offset:5120
    ds_read_b128 v[40:43], v3 offset:6144
    v_smfmac_f32_16x16x64_bf16 v[76:79], v[20:23], a[136:143], v5
    ds_read_b128 v[44:47], v3 offset:7168
    ds_read_b128 v[48:51], v3 offset:10240
    ds_read_b128 v[52:55], v3 offset:11264
    s_waitcnt lgkmcnt(7)
    v_smfmac_f32_16x16x64_bf16 v[72:75], v[24:27], a[0:7], v5
    v_smfmac_f32_16x16x64_bf16 v[76:79], v[24:27], a[80:87], v5
    s_waitcnt lgkmcnt(6)
    v_smfmac_f32_16x16x64_bf16 v[72:75], v[28:31], a[8:15], v5
    v_smfmac_f32_16x16x64_bf16 v[76:79], v[28:31], a[88:95], v5
    s_waitcnt lgkmcnt(5)
    v_smfmac_f32_16x16x64_bf16 v[72:75], v[32:35], a[16:23], v5
    v_smfmac_f32_16x16x64_bf16 v[76:79], v[32:35], a[96:103], v5
    s_waitcnt lgkmcnt(4)
    v_smfmac_f32_16x16x64_bf16 v[72:75], v[36:39], a[24:31], v5
    v_smfmac_f32_16x16x64_bf16 v[76:79], v[36:39], a[104:111], v5
    s_waitcnt lgkmcnt(3)
    v_smfmac_f32_16x16x64_bf16 v[72:75], v[40:43], a[32:39], v5
    v_smfmac_f32_16x16x64_bf16 v[76:79], v[40:43], a[112:119], v5
    s_waitcnt lgkmcnt(2)
    v_smfmac_f32_16x16x64_bf16 v[72:75], v[44:47], a[40:47], v5
    v_smfmac_f32_16x16x64_bf16 v[76:79], v[44:47], a[120:127], v5
    s_waitcnt lgkmcnt(1)
    v_smfmac_f32_16x16x64_bf16 v[72:75], v[48:51], a[64:71], v5
    buffer_store_dword v59, v14, s[8:11], s44 offen offset:0 sc1
    v_smfmac_f32_16x16x64_bf16 v[76:79], v[48:51], a[144:151], v5
    s_waitcnt lgkmcnt(0)
    v_smfmac_f32_16x16x64_bf16 v[72:75], v[52:55], a[72:79], v5
    v_smfmac_f32_16x16x64_bf16 v[76:79], v[52:55], a[152:159], v5
    s_nop 3
    v_cvt_pk_bf16_f32 v80, v72, v73
    v_cvt_pk_bf16_f32 v81, v74, v75
    s_nop 1
    v_cvt_pk_bf16_f32 v82, v76, v77
    v_cvt_pk_bf16_f32 v83, v78, v79
    s_nop 1
    v_mfma_f32_16x16x32_bf16 v[88:91], v[80:83], v[84:87], 0
Vs_qj:
    s_nop 7
    v_cvt_pk_bf16_f32 v94, v88, v89
    v_cvt_pk_bf16_f32 v95, v90, v91
    buffer_store_dwordx2 v[94:95], v6, s[8:11], s25 offen offset:0 sc1
    s_cmp_lt_u32 s32, 64
    s_cbranch_scc0 Vs_nb
    s_cmp_eq_u32 s32, 14
    s_cbranch_scc0 Vs_h
    s_mov_b32 s31, 0
    s_waitcnt vmcnt(63)
    s_branch VsB1_c
VsB1_l:
    buffer_load_dword v68, v67, s[8:11], s23 offen sc1
    s_waitcnt vmcnt(0)
VsB1_c:
    v_cmp_gt_u32 vcc, 1, v68
    s_cbranch_vccz VsB1_o
    s_sleep 4
    s_add_u32 s31, s31, 1
    s_cmp_lt_u32 s31, s30
    s_cbranch_scc1 VsB1_l
    s_mov_b32 s30, 1
VsB1_o:
    s_mov_b32 s31, 0
    s_waitcnt vmcnt(63)
    s_branch VsB2_c
VsB2_l:
    buffer_load_dword v69, v67, s[8:11], s47 offen sc1
    s_waitcnt vmcnt(0)
VsB2_c:
    v_cmp_gt_u32 vcc, 1, v69
    s_cbranch_vccz VsB2_o
    s_sleep 4
    s_add_u32 s31, s31, 1
    s_cmp_lt_u32 s31, s30
    s_cbranch_scc1 VsB2_l
    s_mov_b32 s30, 1
VsB2_o:
Vs_h:
    v_add_u32 v11, s29, v2
    s_xor_b32 s29, s29, 40960
    s_add_u32 s42, s29, s27
    ds_read_b128 a[160:163], v11 offset:0
    ds_read_b128 a[164:167], v11 offset:20480
    ds_read_b128 a[168:171], v11 offset:1024
    ds_read_b128 a[172:175], v11 offset:21504
    ds_read_b128 a[176:179], v11 offset:2048
    ds_read_b128 a[180:183], v11 offset:22528
    s_waitcnt lgkmcnt(5)
    v_mfma_f32_16x16x32_bf16 v[144:147], a[0:3], a[160:163], 0
    ds_read_b128 a[184:187], v11 offset:3072
    v_mfma_f32_16x16x32_bf16 v[152:155], a[80:83], a[160:163], 0
    s_waitcnt lgkmcnt(5)
    v_mfma_f32_16x16x32_bf16 v[148:151], a[0:3], a[164:167], 0
    ds_read_b128 a[188:191], v11 offset:23552
    v_mfma_f32_16x16x32_bf16 v[156:159], a[80:83], a[164:167], 0
    s_waitcnt lgkmcnt(5)
    v_mfma_f32_16x16x32_bf16 v[144:147], a[4:7], a[168:171], v[144:147]
    ds_read_b128 a[160:163], v11 offset:4096
    s_add_u32 s35, s28, 0
    s_add_u32 m0, s42, 0
    v_mfma_f32_16x16x32_bf16 v[152:155], a[84:87], a[168:171], v[152:155]
    buffer_load_dwordx4 v2, s[8:11], s35 offen offset:0 sc1 lds
    s_waitcnt lgkmcnt(5)
    v_mfma_f32_16x16x32_bf16 v[148:151], a[4:7], a[172:175], v[148:151]
    ds_read_b128 a[164:167], v11 offset:24576
    v_mfma_f32_16x16x32_bf16 v[156:159], a[84:87], a[172:175], v[156:159]
    s_waitcnt lgkmcnt(5)
    v_mfma_f32_16x16x32_bf16 v[144:147], a[8:11], a[176:179], v[144:147]
    ds_read_b128 a[168:171], v11 offset:5120
    v_mfma_f32_16x16x32_bf16 v[152:155], a[88:91], a[176:179], v[152:155]
    s_waitcnt lgkmcnt(5)
    v_mfma_f32_16x16x32_bf16 v[148:151], a[8:11], a[180:183], v[148:151]
    ds_read_b128 a[172:175], v11 offset:25600
    v_mfma_f32_16x16x32_bf16 v[156:159], a[88:91], a[180:183], v[156:159]
    buffer_load_dwordx4 v2, s[8:11], s35 offen offset:1024 sc1 lds
    s_waitcnt lgkmcnt(5)
    v_mfma_f32_16x16x32_bf16 v[144:147], a[12:15], a[184:187], v[144:147]
    ds_read_b128 a[176:179], v11 offset:6144
    v_mfma_f32_16x16x32_bf16 v[152:155], a[92:95], a[184:187], v[152:155]
    s_waitcnt lgkmcnt(5)
    v_mfma_f32_16x16x32_bf16 v[148:151], a[12:15], a[188:191], v[148:151]
    ds_read_b128 a[180:183], v11 offset:26624
    v_mfma_f32_16x16x32_bf16 v[156:159], a[92:95], a[188:191], v[156:159]
    s_waitcnt lgkmcnt(5)
    v_mfma_f32_16x16x32_bf16 v[144:147], a[16:19], a[160:163], v[144:147]
    ds_read_b128 a[184:187], v11 offset:7168
    v_mfma_f32_16x16x32_bf16 v[152:155], a[96:99], a[160:163], v[152:155]
    buffer_load_dwordx4 v2, s[8:11], s35 offen offset:2048 sc1 lds
    s_waitcnt lgkmcnt(5)
    v_mfma_f32_16x16x32_bf16 v[148:151], a[16:19], a[164:167], v[148:151]
    ds_read_b128 a[188:191], v11 offset:27648
    v_mfma_f32_16x16x32_bf16 v[156:159], a[96:99], a[164:167], v[156:159]
    s_waitcnt lgkmcnt(5)
    v_mfma_f32_16x16x32_bf16 v[144:147], a[20:23], a[168:171], v[144:147]
    ds_read_b128 a[160:163], v11 offset:8192
    v_mfma_f32_16x16x32_bf16 v[152:155], a[100:103], a[168:171], v[152:155]
    s_waitcnt lgkmcnt(5)
    v_mfma_f32_16x16x32_bf16 v[148:151], a[20:23], a[172:175], v[148:151]
    ds_read_b128 a[164:167], v11 offset:28672
    v_mfma_f32_16x16x32_bf16 v[156:159], a[100:103], a[172:175], v[156:159]
    buffer_load_dwordx4 v2, s[8:11], s35 offen offset:3072 sc1 lds
    s_waitcnt lgkmcnt(5)
    v_mfma_f32_16x16x32_bf16 v[144:147], a[24:27], a[176:179], v[144:147]
    ds_read_b128 a[168:171], v11 offset:9216
    v_mfma_f32_16x16x32_bf16 v[152:155], a[104:107], a[176:179], v[152:155]
    s_waitcnt lgkmcnt(5)
    v_mfma_f32_16x16x32_bf16 v[148:151], a[24:27], a[180:183], v[148:151]
    ds_read_b128 a[172:175], v11 offset:29696
    v_mfma_f32_16x16x32_bf16 v[156:159], a[104:107], a[180:183], v[156:159]
    s_waitcnt lgkmcnt(5)
    v_mfma_f32_16x16x32_bf16 v[144:147], a[28:31], a[184:187], v[144:147]
    ds_read_b128 a[176:179], v11 offset:10240
    s_add_u32 s35, s28, 4096
    s_add_u32 m0, s42, 4096
    v_mfma_f32_16x16x32_bf16 v[152:155], a[108:111], a[184:187], v[152:155]
    buffer_load_dwordx4 v2, s[8:11], s35 offen offset:0 sc1 lds
    s_waitcnt lgkmcnt(5)
    v_mfma_f32_16x16x32_bf16 v[148:151], a[28:31], a[188:191], v[148:151]
    ds_read_b128 a[180:183], v11 offset:30720
    v_mfma_f32_16x16x32_bf16 v[156:159], a[108:111], a[188:191], v[156:159]
    s_waitcnt lgkmcnt(5)
    v_mfma_f32_16x16x32_bf16 v[144:147], a[32:35], a[160:163], v[144:147]
    ds_read_b128 a[184:187], v11 offset:11264
    v_mfma_f32_16x16x32_bf16 v[152:155], a[112:115], a[160:163], v[152:155]
    s_waitcnt lgkmcnt(5)
    v_mfma_f32_16x16x32_bf16 v[148:151], a[32:35], a[164:167], v[148:151]
    ds_read_b128 a[188:191], v11 offset:31744
    v_mfma_f32_16x16x32_bf16 v[156:159], a[112:115], a[164:167], v[156:159]
    buffer_load_dwordx4 v2, s[8:11], s35 offen offset:1024 sc1 lds
    s_waitcnt lgkmcnt(5)
    v_mfma_f32_16x16x32_bf16 v[144:147], a[36:39], a[168:171], v[144:147]
    ds_read_b128 a[160:163], v11 offset:12288
    v_mfma_f32_16x16x32_bf16 v[152:155], a[116:119], a[168:171], v[152:155]
    s_waitcnt lgkmcnt(5)
    v_mfma_f32_16x16x32_bf16 v[148:151], a[36:39], a[172:175], v[148:151]
    ds_read_b128 a[164:167], v11 offset:32768
    v_mfma_f32_16x16x32_bf16 v[156:159], a[116:119], a[172:175], v[156:159]
    s_waitcnt lgkmcnt(5)
    v_mfma_f32_16x16x32_bf16 v[144:147], a[40:43], a[176:179], v[144:147]
    ds_read_b128 a[168:171], v11 offset:13312
    v_mfma_f32_16x16x32_bf16 v[152:155], a[120:123], a[176:179], v[152:155]
    buffer_load_dwordx4 v2, s[8:11], s35 offen offset:2048 sc1 lds
    s_waitcnt lgkmcnt(5)
    v_mfma_f32_16x16x32_bf16 v[148:151], a[40:43], a[180:183], v[148:151]
    ds_read_b128 a[172:175], v11 offset:33792
    v_mfma_f32_16x16x32_bf16 v[156:159], a[120:123], a[180:183], v[156:159]
    buffer_store_dwordx2 v[240:241], v6, s[8:11], s26 offen offset:0 sc1
    buffer_store_dwordx4 v[240:243], v7, s[8:11], s34 offen offset:0 sc1
    s_waitcnt lgkmcnt(5)
    v_mfma_f32_16x16x32_bf16 v[144:147], a[44:47], a[184:187], v[144:147]
    ds_read_b128 a[176:179], v11 offset:14336
    v_mfma_f32_16x16x32_bf16 v[152:155], a[124:127], a[184:187], v[152:155]
    s_waitcnt lgkmcnt(5)
    v_mfma_f32_16x16x32_bf16 v[148:151], a[44:47], a[188:191], v[148:151]
    ds_read_b128 a[180:183], v11 offset:34816
    v_mfma_f32_16x16x32_bf16 v[156:159], a[124:127], a[188:191], v[156:159]
    buffer_load_dwordx4 v2, s[8:11], s35 offen offset:3072 sc1 lds
    s_waitcnt lgkmcnt(5)
    v_mfma_f32_16x16x32_bf16 v[144:147], a[48:51], a[160:163], v[144:147]
    ds_read_b128 a[184:187], v11 offset:15360
    v_mfma_f32_16x16x32_bf16 v[152:155], a[128:131], a[160:163], v[152:155]
    s_waitcnt lgkmcnt(5)
    v_mfma_f32_16x16x32_bf16 v[148:151], a[48:51], a[164:167], v[148:151]
    ds_read_b128 a[188:191], v11 offset:35840
    v_mfma_f32_16x16x32_bf16 v[156:159], a[128:131], a[164:167], v[156:159]
    s_waitcnt lgkmcnt(5)
    v_mfma_f32_16x16x32_bf16 v[144:147], a[52:55], a[168:171], v[144:147]
    ds_read_b128 a[160:163], v11 offset:16384
    s_add_u32 s35, s28, 8192
    s_add_u32 m0, s42, 8192
    v_mfma_f32_16x16x32_bf16 v[152:155], a[132:135], a[168:171], v[152:155]
    buffer_load_dwordx4 v2, s[8:11], s35 offen offset:0 sc1 lds
    s_waitcnt lgkmcnt(5)
    v_mfma_f32_16x16x32_bf16 v[148:151], a[52:55], a[172:175], v[148:151]
    ds_read_b128 a[164:167], v11 offset:36864
    v_mfma_f32_16x16x32_bf16 v[156:159], a[132:135], a[172:175], v[156:159]
    s_waitcnt lgkmcnt(5)
    v_mfma_f32_16x16x32_bf16 v[144:147], a[56:59], a[176:179], v[144:147]
    ds_read_b128 a[168:171], v11 offset:17408
    v_mfma_f32_16x16x32_bf16 v[152:155], a[136:139], a[176:179], v[152:155]
    s_waitcnt lgkmcnt(5)
    v_mfma_f32_16x16x32_bf16 v[148:151], a[56:59], a[180:183], v[148:151]
    ds_read_b128 a[172:175], v11 offset:37888
    v_mfma_f32_16x16x32_bf16 v[156:159], a[136:139], a[180:183], v[156:159]
    buffer_load_dwordx4 v2, s[8:11], s35 offen offset:1024 sc1 lds
    s_waitcnt lgkmcnt(5)
    v_mfma_f32_16x16x32_bf16 v[144:147], a[60:63], a[184:187], v[144:147]
    ds_read_b128 a[176:179], v11 offset:18432
    v_mfma_f32_16x16x32_bf16 v[152:155], a[140:143], a[184:187], v[152:155]
    s_waitcnt lgkmcnt(5)
    v_mfma_f32_16x16x32_bf16 v[148:151], a[60:63], a[188:191], v[148:151]
    ds_read_b128 a[180:183], v11 offset:38912
    v_mfma_f32_16x16x32_bf16 v[156:159], a[140:143], a[188:191], v[156:159]
    s_waitcnt lgkmcnt(5)
    v_mfma_f32_16x16x32_bf16 v[144:147], a[64:67], a[160:163], v[144:147]
    ds_read_b128 a[184:187], v11 offset:19456
    v_mfma_f32_16x16x32_bf16 v[152:155], a[144:147], a[160:163], v[152:155]
    s_waitcnt lgkmcnt(5)
    v_mfma_f32_16x16x32_bf16 v[148:151], a[64:67], a[164:167], v[148:151]
    ds_read_b128 a[188:191], v11 offset:39936
    v_mfma_f32_16x16x32_bf16 v[156:159], a[144:147], a[164:167], v[156:159]
    s_waitcnt lgkmcnt(5)
    v_mfma_f32_16x16x32_bf16 v[144:147], a[68:71], a[168:171], v[144:147]
    v_mfma_f32_16x16x32_bf16 v[152:155], a[148:151], a[168:171], v[152:155]
    s_waitcnt lgkmcnt(4)
    v_mfma_f32_16x16x32_bf16 v[148:151], a[68:71], a[172:175], v[148:151]
    v_mfma_f32_16x16x32_bf16 v[156:159], a[148:151], a[172:175], v[156:159]
    s_waitcnt lgkmcnt(3)
    v_mfma_f32_16x16x32_bf16 v[144:147], a[72:75], a[176:179], v[144:147]
    v_mfma_f32_16x16x32_bf16 v[152:155], a[152:155], a[176:179], v[152:155]
    s_waitcnt lgkmcnt(2)
    v_mfma_f32_16x16x32_bf16 v[148:151], a[72:75], a[180:183], v[148:151]
    v_mfma_f32_16x16x32_bf16 v[156:159], a[152:155], a[180:183], v[156:159]
    s_waitcnt lgkmcnt(1)
    v_mfma_f32_16x16x32_bf16 v[144:147], a[76:79], a[184:187], v[144:147]
    v_mfma_f32_16x16x32_bf16 v[152:155], a[156:159], a[184:187], v[152:155]
    s_waitcnt lgkmcnt(0)
    v_mfma_f32_16x16x32_bf16 v[148:151], a[76:79], a[188:191], v[148:151]
    v_mfma_f32_16x16x32_bf16 v[156:159], a[156:159], a[188:191], v[156:159]
    s_add_u32 s28, s28, 40960
    s_add_u32 s32, s32, 1
    s_cmp_eq_u32 s32, 1
    s_cbranch_scc0 VsB0_o
    s_mov_b32 s31, 0
VsB0_l:
    buffer_load_dword v68, v70, s[8:11], s49 offen sc1
    s_waitcnt vmcnt(0)
VsB0_c:
    v_cmp_gt_u32 vcc, 1, v68
    s_cbranch_vccz VsB0_o
    s_sleep 2
    s_add_u32 s31, s31, 1
    s_cmp_lt_u32 s31, s30
    s_cbranch_scc1 VsB0_l
    s_mov_b32 s30, 1
VsB0_o:
    s_cmp_eq_u32 s32, 12
    s_cbranch_scc0 Vs_n12
    buffer_load_dword v68, v67, s[8:11], s23 offen offset:0 sc1
    buffer_load_dword v69, v67, s[8:11], s47 offen offset:0 sc1
Vs_n12:
    s_add_u32 s4, s32, 3
    s_and_b32 s4, s4, 3
    s_mul_i32 s4, s4, 49152
    s_add_u32 s4, s4, s43
    s_add_u32 s5, s4, 6144
    v_cvt_pk_bf16_f32 v160, v144, v145
    v_cvt_pk_bf16_f32 v161, v152, v153
    v_cvt_pk_bf16_f32 v162, v146, v147
    v_cvt_pk_bf16_f32 v163, v154, v155
    buffer_store_dwordx4 v[160:163], v2, s[8:11], s4 offen offset:0 sc1
    v_cvt_pk_bf16_f32 v164, v148, v149
    v_cvt_pk_bf16_f32 v165, v156, v157
    v_cvt_pk_bf16_f32 v166, v150, v151
    v_cvt_pk_bf16_f32 v167, v158, v159
    buffer_store_dwordx4 v[164:167], v2, s[8:11], s5 offen offset:0 sc1
    s_waitcnt vmcnt(0)
    v_mov_b32 v10, s32
    s_mov_b64 exec, 1
    buffer_store_dword v10, v9, s[8:11], s33 offen sc1
    s_mov_b64 exec, -1
    s_cmp_lt_u32 s32, 4
    s_cbranch_scc0 Vs_nb
    s_barrier
    s_branch Vs_h
Vs_nb:
    s_cmp_eq_u32 s21, 62
    s_cbranch_scc0 Vs_np
    s_barrier
    buffer_store_dwordx2 v[240:241], v6, s[8:11], s26 offen offset:0 sc1
    buffer_store_dwordx4 v[240:243], v7, s[8:11], s34 offen offset:0 sc1
Vs_np:
    s_cmp_lt_u32 s21, 63
    s_cbranch_scc1 Vs_loop
    s_cmp_eq_u32 s21, 64
    s_cbranch_scc1 V_t3
    s_load_dwordx2 s[88:89], s[0:1], 64
    s_mov_b32 s90, 1280
    s_mov_b32 s91, 0x20000
    s_waitcnt lgkmcnt(0)
    v_lshlrev_b32 v71, 2, v1
    v_lshlrev_b32 v70, 3, v1
    s_mov_b32 s4, 5120
    buffer_load_dwordx2 v[146:147], v70, s[8:11], s4 offen offset:0 sc1
    buffer_load_dwordx2 v[148:149], v70, s[8:11], s4 offen offset:512 sc1
    buffer_load_dwordx2 v[150:151], v70, s[8:11], s4 offen offset:1024 sc1
    buffer_load_dwordx2 v[152:153], v70, s[8:11], s4 offen offset:1536 sc1
    buffer_load_dwordx2 v[154:155], v70, s[8:11], s4 offen offset:2048 sc1
    s_mov_b32 s5, 7680
    s_mov_b32 s6, 10240
    s_mov_b32 s7, 12800
    buffer_load_dwordx2 v[100:101], v70, s[8:11], s5 offen offset:0 sc1
    buffer_load_dwordx2 v[110:111], v70, s[8:11], s6 offen offset:0 sc1
    buffer_load_dwordx2 v[120:121], v70, s[8:11], s7 offen offset:0 sc1
    buffer_load_dword v140, v71, s[88:91], 0 offen offset:0
    buffer_load_dwordx2 v[102:103], v70, s[8:11], s5 offen offset:512 sc1
    buffer_load_dwordx2 v[112:113], v70, s[8:11], s6 offen offset:512 sc1
    buffer_load_dwordx2 v[122:123], v70, s[8:11], s7 offen offset:512 sc1
    buffer_load_dword v141, v71, s[88:91], 0 offen offset:256
    buffer_load_dwordx2 v[104:105], v70, s[8:11], s5 offen offset:1024 sc1
    buffer_load_dwordx2 v[114:115], v70, s[8:11], s6 offen offset:1024 sc1
    buffer_load_dwordx2 v[124:125], v70, s[8:11], s7 offen offset:1024 sc1
    buffer_load_dword v142, v71, s[88:91], 0 offen offset:512
    buffer_load_dwordx2 v[106:107], v70, s[8:11], s5 offen offset:1536 sc1
    buffer_load_dwordx2 v[116:117], v70, s[8:11], s6 offen offset:1536 sc1
    buffer_load_dwordx2 v[126:127], v70, s[8:11], s7 offen offset:1536 sc1
    buffer_load_dword v143, v71, s[88:91], 0 offen offset:768
    buffer_load_dwordx2 v[108:109], v70, s[8:11], s5 offen offset:2048 sc1
    buffer_load_dwordx2 v[118:119], v70, s[8:11], s6 offen offset:2048 sc1
    buffer_load_dwordx2 v[128:129], v70, s[8:11], s7 offen offset:2048 sc1
    buffer_load_dword v144, v71, s[88:91], 0 offen offset:1024
    s_waitcnt vmcnt(0)
    v_add_f32 v110, 1.0, v110
    v_cvt_pk_bf16_f32 v110, v110, v110
    v_and_b32 v110, 0xffff0000, v110
    v_add_f32 v111, 1.0, v111
    v_cvt_pk_bf16_f32 v111, v111, v111
    v_and_b32 v111, 0xffff0000, v111
    v_add_f32 v112, 1.0, v112
    v_cvt_pk_bf16_f32 v112, v112, v112
    v_and_b32 v112, 0xffff0000, v112
    v_add_f32 v113, 1.0, v113
    v_cvt_pk_bf16_f32 v113, v113, v113
    v_and_b32 v113, 0xffff0000, v113
    v_add_f32 v114, 1.0, v114
    v_cvt_pk_bf16_f32 v114, v114, v114
    v_and_b32 v114, 0xffff0000, v114
    v_add_f32 v115, 1.0, v115
    v_cvt_pk_bf16_f32 v115, v115, v115
    v_and_b32 v115, 0xffff0000, v115
    v_add_f32 v116, 1.0, v116
    v_cvt_pk_bf16_f32 v116, v116, v116
    v_and_b32 v116, 0xffff0000, v116
    v_add_f32 v117, 1.0, v117
    v_cvt_pk_bf16_f32 v117, v117, v117
    v_and_b32 v117, 0xffff0000, v117
    v_add_f32 v118, 1.0, v118
    v_cvt_pk_bf16_f32 v118, v118, v118
    v_and_b32 v118, 0xffff0000, v118
    v_add_f32 v119, 1.0, v119
    v_cvt_pk_bf16_f32 v119, v119, v119
    v_and_b32 v119, 0xffff0000, v119
    v_lshlrev_b32 v130, 16, v140
    v_and_b32 v131, 0xffff0000, v140
    v_lshlrev_b32 v132, 16, v141
    v_and_b32 v133, 0xffff0000, v141
    v_lshlrev_b32 v134, 16, v142
    v_and_b32 v135, 0xffff0000, v142
    v_lshlrev_b32 v136, 16, v143
    v_and_b32 v137, 0xffff0000, v143
    v_lshlrev_b32 v138, 16, v144
    v_and_b32 v139, 0xffff0000, v144
    s_branch Vs_loop
V_t3:
    s_cmp_ge_u32 s20, 16
    s_cbranch_scc1 R_done
    s_waitcnt vmcnt(0)
    s_add_u32 s21, s20, 48
    s_lshl_b32 s96, s99, 2
    s_add_u32 s96, s96, s3
    v_lshlrev_b32 v3, 2, v1
    v_min_u32 v15, 39, v1
    v_lshlrev_b32 v15, 2, v15
    v_add_u32 v15, 155936, v15
    s_load_dwordx2 s[12:13], s[0:1], 0
    s_load_dwordx2 s[16:17], s[0:1], 112
    s_mov_b32 s14, 2621440
    s_mov_b32 s15, 0x20000
    s_mov_b32 s18, 2621440
    s_mov_b32 s19, 0x20000
    s_waitcnt lgkmcnt(0)
    v_lshrrev_b32 v16, 3, v1
    v_lshlrev_b32 v16, 10, v16
    v_and_b32 v17, 7, v1
    v_lshl_add_u32 v16, v17, 2, v16
    s_lshl_b32 s4, s96, 5
    v_add_u32 v16, s4, v16
    s_lshl_b32 s4, s21, 5
    s_add_u32 s4, s4, s96
    s_mul_i32 s24, s4, 1280
    s_add_u32 s25, s24, 59244544
    s_lshl_b32 s5, s4, 2
    s_add_u32 s5, s5, 16384
    s_lshl_b32 s6, s4, 7
    s_add_u32 s6, s6, 61636608
    s_cmp_lt_u32 s4, 1792
    s_cselect_b32 s42, s5, s6
    s_mul_i32 s35, s21, 524288
    s_add_u32 s35, s35, 23068672
    buffer_load_dword v224, v3, s[12:15], s24 offen offset:0
    buffer_load_dword v225, v3, s[12:15], s24 offen offset:256
    buffer_load_dword v226, v3, s[12:15], s24 offen offset:512
    buffer_load_dword v227, v3, s[12:15], s24 offen offset:768
    buffer_load_dword v228, v3, s[12:15], s24 offen offset:1024
    s_mov_b32 s31, 0
V3w_l:
    buffer_load_dword v18, v15, s[8:11], s22 offen sc1
    s_waitcnt vmcnt(0)
V3w_c:
    v_cmp_gt_u32 vcc, s21, v18
    s_cbranch_vccz V3w_o
    s_sleep 1
    s_add_u32 s31, s31, 1
    s_cmp_lt_u32 s31, s30
    s_cbranch_scc1 V3w_l
    s_mov_b32 s30, 1
V3w_o:
    s_call_b64 s[100:101], T3_sub
    s_mov_b64 exec, 1
    buffer_store_dword v9, v3, s[8:11], s42 offen sc1
    s_mov_b64 exec, -1
    s_waitcnt vmcnt(0)
    s_add_u32 s4, s24, 56623104
    buffer_store_dword v140, v3, s[8:11], s4 offen offset:0 sc1
    buffer_store_dword v141, v3, s[8:11], s4 offen offset:256 sc1
    buffer_store_dword v142, v3, s[8:11], s4 offen offset:512 sc1
    buffer_store_dword v143, v3, s[8:11], s4 offen offset:768 sc1
    buffer_store_dword v144, v3, s[8:11], s4 offen offset:1024 sc1
    s_branch R_done
R_c:
    s_load_dwordx2 s[12:13], s[0:1], 40
    s_load_dwordx2 s[16:17], s[0:1], 8
    s_load_dwordx2 s[88:89], s[0:1], 0
    s_load_dwordx2 s[84:85], s[0:1], 96
    s_load_dwordx2 s[92:93], s[0:1], 104
    s_mov_b32 s14, 7864320
    s_mov_b32 s15, 0x20000
    s_mov_b32 s18, 10240
    s_mov_b32 s19, 0x20000
    s_mov_b32 s90, 2621440
    s_mov_b32 s91, 0x20000
    s_mov_b32 s86, 1280
    s_mov_b32 s87, 0x20000
    s_mov_b32 s94, 4915200
    s_mov_b32 s95, 0x20000
    s_waitcnt lgkmcnt(0)
    v_lshlrev_b32 v2, 4, v1
    v_lshlrev_b32 v4, 2, v1
    s_mul_i32 s4, s3, 320
    buffer_load_dword v244, v4, s[84:87], s4 offen
    buffer_load_dword v245, v4, s[84:87], s4 offen offset:256
    s_sub_u32 s98, s20, 18
    s_mul_i32 s28, s99, 10
    s_add_u32 s28, s28, s98
    v_lshrrev_b32 v14, 1, v1
    v_mul_u32_u24 v14, 7680, v14
    v_and_b32 v15, 1, v1
    v_lshl_add_u32 v14, v15, 4, v14
    s_mul_i32 s4, s3, 1228800
    s_lshl_b32 s5, s28, 5
    s_add_u32 s4, s4, s5
    s_mul_i32 s29, s3, 5120
    s_add_u32 s29, s29, 139264
    s_add_u32 m0, s29, 0
    s_nop 0
    buffer_load_dwordx4 v14, s[92:95], s4 offen  lds
    s_add_u32 s4, s4, 245760
    s_add_u32 m0, s29, 1024
    s_nop 0
    buffer_load_dwordx4 v14, s[92:95], s4 offen  lds
    s_add_u32 s4, s4, 245760
    s_add_u32 m0, s29, 2048
    s_nop 0
    buffer_load_dwordx4 v14, s[92:95], s4 offen  lds
    s_add_u32 s4, s4, 245760
    s_add_u32 m0, s29, 3072
    s_nop 0
    buffer_load_dwordx4 v14, s[92:95], s4 offen  lds
    s_add_u32 s4, s4, 245760
    s_add_u32 m0, s29, 4096
    s_nop 0
    buffer_load_dwordx4 v14, s[92:95], s4 offen  lds
    s_add_u32 s4, s4, 245760
    s_mul_i32 s42, s99, 983040
    s_lshl_b32 s4, s98, 7
    s_add_u32 s42, s42, s4
    s_add_u32 s21, s28, 32
    s_lshl_b32 s98, s98, 2
    s_add_u32 s98, s98, s3
    s_mul_i32 s4, s3, 5120
    s_add_u32 s23, s4, 98304
    s_mul_i32 s26, s21, 20480
    s_add_u32 s26, s26, s4
    v_and_b32 v16, 7, v1
    v_lshrrev_b32 v17, 4, v1
    v_mul_u32_u24 v19, 1280, v16
    v_lshl_add_u32 v19, v17, 3, v19
    s_lshl_b32 s4, s98, 5
    buffer_load_dwordx2 v[24:25], v19, s[16:19], s4 offen
    s_lshl_b32 s37, s3, 11
    s_lshl_b32 s4, s3, 4
    s_and_b32 s5, s3, 1
    s_lshl_b32 s5, s5, 1
    v_lshrrev_b32 v60, 3, v1
    v_and_b32 v61, 1, v60
    v_or_b32 v61, s5, v61
    v_add_u32 v60, s4, v60
    v_mul_u32_u24 v13, 1280, v60
    v_bfe_u32 v60, v1, 1, 2
    v_xor_b32 v60, v60, v61
    v_lshlrev_b32 v60, 5, v60
    v_and_b32 v61, 1, v1
    v_lshlrev_b32 v61, 4, v61
    v_add3_u32 v13, v13, v60, v61
    v_lshrrev_b32 v60, 4, v1
    v_lshlrev_b32 v60, 2, v60
    v_bfe_u32 v61, v1, 2, 1
    v_add_u32 v60, v60, v61
    v_bfe_u32 v61, v1, 3, 1
    v_lshlrev_b32 v61, 4, v61
    v_add_u32 v60, v60, v61
    v_lshlrev_b32 v0, 7, v60
    v_bfe_u32 v60, v1, 2, 2
    v_lshlrev_b32 v60, 5, v60
    v_and_b32 v61, 3, v1
    v_lshlrev_b32 v61, 3, v61
    v_add3_u32 v0, v0, v60, v61
    v_mov_b32 v134, 163776
    s_cmp_lg_u32 s3, 0
    s_cbranch_scc1 CC_c
    s_waitcnt vmcnt(8)
    v_readfirstlane_b32 s4, v135
    s_and_b32 s4, s4, s33
    s_nop 0
    v_mov_b32 v135, s4
    ds_write_b32 v134, v135
    s_waitcnt lgkmcnt(0)
CC_c:
    s_barrier
    ds_read_b32 v135, v134
    s_waitcnt lgkmcnt(0)
    v_readfirstlane_b32 s4, v135
    s_cmp_lg_u32 s4, 0
    s_cbranch_scc1 R_ovf
    s_load_dwordx2 s[16:17], s[0:1], 120
    s_mov_b32 s18, 256
    s_mov_b32 s19, 0x20000
    s_waitcnt lgkmcnt(0)
    s_mul_i32 s22, s99, 1048576
    s_add_u32 s22, s22, 8388608
    s_lshl_b32 s33, s20, 4
    s_lshl_b32 s4, s3, 2
    s_add_u32 s33, s33, s4
    s_add_u32 s33, s33, s22
    s_add_u32 s33, s33, 155648
    s_mov_b32 s48, 0xfffffffe
    v_mov_b32 v9, 0
    v_mov_b32 v240, -1
    v_mov_b32 v241, -1
    v_mov_b32 v242, -1
    v_mov_b32 v243, -1
    s_lshl_b32 s40, s3, 9
    s_add_u32 s40, s40, 159744
    s_waitcnt vmcnt(6)
    v_lshrrev_b32 v10, 4, v1
    v_lshlrev_b32 v10, 6, v10
    v_bfe_u32 v11, v1, 1, 2
    v_lshl_add_u32 v10, v11, 4, v10
    v_and_b32 v11, 1, v1
    v_lshl_add_u32 v10, v11, 3, v10
    v_bfe_u32 v11, v1, 3, 1
    v_lshl_add_u32 v10, v11, 2, v10
    v_add_u32 v10, s40, v10
    v_lshlrev_b32 v6, 16, v244
    v_and_b32 v7, 0xffff0000, v244
    v_lshlrev_b32 v8, 16, v245
    v_and_b32 v9, 0xffff0000, v245
    v_mul_f32 v16, 0xbfb8aa3b, v6
    v_mul_f32 v17, 0xbfb8aa3b, v7
    v_mul_f32 v18, 0xbfb8aa3b, v8
    v_mul_f32 v19, 0xbfb8aa3b, v9
    v_exp_f32 v16, v16
    v_exp_f32 v17, v17
    v_exp_f32 v18, v18
    v_exp_f32 v19, v19
    v_add_f32 v16, 1.0, v16
    v_add_f32 v17, 1.0, v17
    v_add_f32 v18, 1.0, v18
    v_add_f32 v19, 1.0, v19
    v_rcp_f32 v16, v16
    v_rcp_f32 v17, v17
    v_rcp_f32 v18, v18
    v_rcp_f32 v19, v19
    v_mul_f32 v6, v6, v16
    v_mul_f32 v7, v7, v17
    v_mul_f32 v8, v8, v18
    v_mul_f32 v9, v9, v19
    v_cvt_pk_bf16_f32 v4, v6, v7
    v_cvt_pk_bf16_f32 v5, v8, v9
    v_and_b32 v11, 0x30, v1
    v_add_u32 v11, s40, v11
    ds_write_b32 v10, v4
    ds_write_b32 v10, v5 offset:256
    s_waitcnt lgkmcnt(0)
    ds_read_b128 v[220:223], v11 offset:0
    ds_read_b128 v[224:227], v11 offset:64
    ds_read_b128 v[228:231], v11 offset:128
    ds_read_b128 v[232:235], v11 offset:192
    ds_read_b128 v[236:239], v11 offset:256
    v_mov_b32 v26, 0
    s_waitcnt vmcnt(1)
    s_cmp_lg_u32 s3, 0
    s_cbranch_scc1 CD_i
    v_and_b32 v26, 7, v1
    v_lshlrev_b32 v26, 5, v26
    buffer_load_dwordx4 v[28:31], v26, s[16:19], 0 offen sc1
CD_i:
    v_lshrrev_b32 v14, 4, v1
    v_lshlrev_b32 v14, 2, v14
    v_bfe_u32 v15, v1, 2, 1
    v_add_u32 v14, v14, v15
    v_bfe_u32 v15, v1, 3, 1
    v_lshl_add_u32 v14, v15, 4, v14
    v_lshlrev_b32 v14, 5, v14
    v_and_b32 v15, 3, v1
    v_lshl_add_u32 v14, v15, 3, v14
    v_add_u32 v14, s29, v14
    ds_read_b64_tr_b16 v[40:41], v14 offset:0
    ds_read_b64_tr_b16 v[42:43], v14 offset:64
    ds_read_b64_tr_b16 v[44:45], v14 offset:1024
    ds_read_b64_tr_b16 v[46:47], v14 offset:1088
    ds_read_b64_tr_b16 v[48:49], v14 offset:2048
    ds_read_b64_tr_b16 v[50:51], v14 offset:2112
    ds_read_b64_tr_b16 v[52:53], v14 offset:3072
    ds_read_b64_tr_b16 v[54:55], v14 offset:3136
    ds_read_b64_tr_b16 v[56:57], v14 offset:4096
    ds_read_b64_tr_b16 v[58:59], v14 offset:4160
    v_and_b32 v15, 0x30, v1
    v_add_u32 v15, s29, v15
    s_waitcnt lgkmcnt(0)
    v_mfma_f32_16x16x32_bf16 v[16:19], v[40:43], v[220:223], 0
    v_mfma_f32_16x16x32_bf16 v[16:19], v[44:47], v[224:227], v[16:19]
    v_mfma_f32_16x16x32_bf16 v[16:19], v[48:51], v[228:231], v[16:19]
    v_mfma_f32_16x16x32_bf16 v[16:19], v[52:55], v[232:235], v[16:19]
    v_mfma_f32_16x16x32_bf16 v[16:19], v[56:59], v[236:239], v[16:19]
    s_mov_b32 exec_lo, 0x00010001
    s_mov_b32 exec_hi, 0x00010001
    s_nop 5
    ds_write_b128 v15, v[16:19]
    s_mov_b64 exec, -1
    s_waitcnt lgkmcnt(0)
    s_barrier
    s_cmp_lg_u32 s3, 0
    s_cbranch_scc1 CD_r
    v_lshlrev_b32 v14, 2, v1
    v_add_u32 v15, 139264, v14
    ds_read_b32 v16, v15 offset:0
    ds_read_b32 v17, v15 offset:5120
    ds_read_b32 v18, v15 offset:10240
    ds_read_b32 v19, v15 offset:15360
    s_mov_b32 s31, 0
    s_waitcnt vmcnt(0)
    s_branch CK_c
CK_l:
    buffer_load_dwordx4 v[28:31], v26, s[16:19], 0 offen sc1
    s_waitcnt vmcnt(0)
CK_c:
    v_bcnt_u32_b32 v27, v28, v31
    v_cmp_lt_u32 s[4:5], 32, v27
    s_and_b32 s6, s4, 0xff
    v_cmp_ne_u32 s[4:5], 32, v27
    s_cmp_eq_u32 s6, 0
    s_cselect_b32 s5, 0xff, 0
    s_and_b32 s4, s4, s5
    v_cmp_gt_u32 vcc, 22, v29
    s_and_b32 vcc_lo, vcc_lo, 0xff
    s_or_b32 vcc_lo, vcc_lo, s4
    s_mov_b32 vcc_hi, 0
    s_cbranch_vccz CK_o
    s_sleep 16
    s_add_u32 s31, s31, 1
    s_cmp_lt_u32 s31, s30
    s_cbranch_scc1 CK_l
    s_mov_b32 s30, 1
CK_o:
    s_mov_b32 s97, s6
    v_bfe_u32 v15, v1, 2, 2
    v_lshlrev_b32 v15, 4, v15
    v_bfe_u32 v20, v1, 1, 1
    v_lshl_add_u32 v15, v20, 3, v15
    s_lshr_b32 s5, s28, 1
    s_lshl_b32 s5, s5, 6
    s_and_b32 s6, s28, 1
    s_lshl_b32 s6, s6, 2
    s_add_u32 s5, s5, s6
    s_add_u32 s5, s5, 32768
    s_lshl_b32 s4, s28, 6
    s_add_u32 s4, s4, 0
    s_cmp_ge_u32 s28, 40
    s_cselect_b32 s7, 1.0, 0
    s_waitcnt lgkmcnt(0)
    v_add_f32 v16, v16, v17
    v_add_f32 v18, v18, v19
    v_add_f32 v16, v16, v18
    v_cvt_pk_bf16_f32 v16, v16, v16
    v_and_b32 v16, 0xffff0000, v16
    v_add_f32 v18, s7, v16
    s_nop 1
    v_mov_b32 v17, v18 quad_perm:[1,1,3,3] row_mask:0xf bank_mask:0xf
    v_cvt_pk_bf16_f32 v17, v18, v17
    s_mov_b64 exec, 0x5555
    buffer_store_dword v17, v15, s[8:11], s5 offen sc1
    s_mov_b64 exec, 0xffff
    buffer_store_dword v16, v14, s[8:11], s4 offen sc1
    s_mov_b64 exec, -1
CD_r:
    v_mov_b32 v9, 0
    v_and_b32 v16, 7, v1
    v_lshrrev_b32 v17, 4, v1
    v_bfe_u32 v18, v1, 3, 1
    s_sub_u32 s4, s20, 18
    s_lshl_b32 s4, s4, 9
    s_add_u32 s43, s4, 2801664
    s_lshl_b32 s4, s99, 6
    s_add_u32 s24, s43, s4
    s_and_b32 s4, s99, 3
    s_lshl_b32 s4, s4, 14
    s_add_u32 s43, s43, s4
    s_lshl_b32 s4, s3, 7
    s_add_u32 s43, s43, s4
    s_cmp_eq_u32 s3, 0
    s_cselect_b32 s4, 8, 0
    s_cselect_b32 s44, 255, 0
    s_mov_b32 s45, 0
    v_lshrrev_b32 v198, 0, v1
    v_lshlrev_b32 v198, 13, v198
    v_and_b32 v19, 0, v2
    v_add_u32 v198, v198, v19
    v_mov_b32 v19, 0x80000000
    v_cmp_gt_u32 vcc, s4, v1
    s_nop 1
    v_cndmask_b32 v198, v19, v198, vcc
    s_lshr_b32 s4, s98, 1
    s_lshl_b32 s5, s4, 9
    s_and_b32 s6, s98, 1
    s_lshl_b32 s7, s6, 7
    s_add_u32 s5, s5, s7
    v_lshrrev_b32 v19, 1, v17
    v_lshlrev_b32 v6, 8, v19
    v_lshl_add_u32 v6, v16, 4, v6
    v_and_b32 v19, 1, v17
    v_lshl_add_u32 v6, v19, 3, v6
    v_add_u32 v6, s5, v6
    v_mov_b32 v19, 0x80000000
    v_cmp_ne_u32 vcc, 0, v18
    s_nop 1
    v_cndmask_b32 v6, v6, v19, vcc
    s_lshr_b32 s4, s98, 2
    s_lshl_b32 s4, s4, 14
    s_lshl_b32 s6, s3, 11
    s_add_u32 s4, s4, s6
    v_add_u32 v8, s4, v2
    v_lshrrev_b32 v19, 1, v17
    v_lshlrev_b32 v7, 7, v19
    v_lshl_add_u32 v7, v16, 4, v7
    v_and_b32 v19, 1, v17
    v_lshl_add_u32 v7, v19, 3, v7
    v_lshl_add_u32 v7, v18, 13, v7
    s_lshl_b32 s6, s99, 8
    s_add_u32 s4, s4, s6
    v_add_u32 v7, s4, v7
    v_and_b32 v19, 15, v1
    v_lshlrev_b32 v12, 5, v19
    v_lshl_add_u32 v12, v17, 3, v12
    s_and_b32 s4, s99, 3
    s_mul_i32 s34, s4, 81920
    s_lshr_b32 s4, s98, 3
    s_lshl_b32 s4, s4, 14
    s_add_u32 s34, s34, s4
    s_and_b32 s4, s98, 7
    s_lshl_b32 s4, s4, 10
    s_add_u32 s34, s34, s4
    s_add_u32 s34, s34, 23068672
    s_mov_b64 exec, -1
    s_add_u32 s4, s22, 10240
    s_add_u32 s5, s4, 10240
    buffer_store_dwordx2 v[240:241], v6, s[8:11], s4 offen offset:0 sc1
    buffer_store_dwordx2 v[240:241], v6, s[8:11], s5 offen offset:0 sc1
    s_mov_b32 s4, 2097152
    buffer_store_dwordx2 v[240:241], v7, s[8:11], s4 offen offset:0 sc1
    s_mov_b32 s4, 2260992
    buffer_store_dwordx2 v[240:241], v7, s[8:11], s4 offen offset:0 sc1
    s_mul_i32 s4, s99, 40
    s_add_u32 s4, s4, s98
    s_cmp_lt_u32 s4, 88
    s_cselect_b64 exec, -1, 0
    s_lshl_b32 s4, s4, 10
    s_cmp_lt_u32 s4, 8192
    s_mov_b32 s5, 61857792
    s_cselect_b32 s5, 16384, s5
    s_add_u32 s4, s4, s5
    buffer_store_dwordx4 v[240:243], v2, s[8:11], s4 offen offset:0 sc1
    s_mov_b64 exec, -1
    v_mov_b32 v10, 0
    s_mov_b64 exec, 1
    buffer_store_dword v10, v9, s[8:11], s33 offen sc1
    s_mov_b64 exec, -1
    buffer_store_dword v9, v198, s[8:11], s24 offen offset:0 sc1
    s_lshl_b32 s4, s21, 7
    s_add_u32 s4, s4, 65536
    v_mov_b32 v16, 0
    v_lshlrev_b32 v17, 2, v1
    s_cmp_eq_u32 s3, 0
    s_cselect_b64 exec, 1, 0
    buffer_store_dword v16, v17, s[8:11], s4 offen sc1
    s_mov_b64 exec, -1
    s_waitcnt vmcnt(8)
    v_min_u32 v24, s48, v24
    v_min_u32 v25, s48, v25
    buffer_store_dwordx2 v[24:25], v6, s[8:11], s22 offen offset:0 sc1
    s_add_u32 s4, s26, 0
    s_add_u32 m0, s23, 0
    s_nop 0
    buffer_load_dwordx4 v2, s[88:91], s4 offen offset:0 nt lds
    buffer_load_dwordx4 v2, s[88:91], s4 offen offset:1024 nt lds
    buffer_load_dwordx4 v2, s[88:91], s4 offen offset:2048 nt lds
    buffer_load_dwordx4 v2, s[88:91], s4 offen offset:3072 nt lds
    s_add_u32 s4, s26, 4096
    s_add_u32 m0, s23, 4096
    s_nop 0
    buffer_load_dwordx4 v2, s[88:91], s4 offen offset:0 nt lds
    s_add_u32 s4, s26, 1638400
    s_add_u32 m0, s23, 20480
    s_nop 0
    buffer_load_dwordx4 v2, s[88:91], s4 offen offset:0 nt lds
    buffer_load_dwordx4 v2, s[88:91], s4 offen offset:1024 nt lds
    buffer_load_dwordx4 v2, s[88:91], s4 offen offset:2048 nt lds
    buffer_load_dwordx4 v2, s[88:91], s4 offen offset:3072 nt lds
    s_add_u32 s4, s26, 1642496
    s_add_u32 m0, s23, 24576
    s_nop 0
    buffer_load_dwordx4 v2, s[88:91], s4 offen offset:0 nt lds
    s_waitcnt vmcnt(10)
    s_barrier
    s_cmp_lg_u32 s3, 0
    s_cbranch_scc1 CA_n
    s_lshl_b32 s4, s99, 5
    s_add_u32 s4, s4, 8
    v_mov_b32 v16, 0
    v_mov_b32 v17, 1
    s_mov_b64 exec, 1
    buffer_atomic_add v17, v16, s[16:19], s4 offen sc1
    s_mov_b64 exec, -1
CA_n:
    s_add_u32 s4, s42, 0
    s_add_u32 m0, s37, 0
    s_nop 0
    buffer_load_dwordx4 v13, s[12:15], s4 offen nt lds
    s_add_u32 s4, s42, 10240
    s_add_u32 m0, s37, 1024
    s_nop 0
    buffer_load_dwordx4 v13, s[12:15], s4 offen nt lds
    s_add_u32 s4, s42, 81920
    s_add_u32 m0, s37, 8192
    s_nop 0
    buffer_load_dwordx4 v13, s[12:15], s4 offen nt lds
    s_add_u32 s4, s42, 92160
    s_add_u32 m0, s37, 9216
    s_nop 0
    buffer_load_dwordx4 v13, s[12:15], s4 offen nt lds
    s_add_u32 s4, s42, 163840
    s_add_u32 m0, s37, 16384
    s_nop 0
    buffer_load_dwordx4 v13, s[12:15], s4 offen nt lds
    s_add_u32 s4, s42, 174080
    s_add_u32 m0, s37, 17408
    s_nop 0
    buffer_load_dwordx4 v13, s[12:15], s4 offen nt lds
    s_add_u32 s4, s42, 245760
    s_add_u32 m0, s37, 24576
    s_nop 0
    buffer_load_dwordx4 v13, s[12:15], s4 offen nt lds
    s_add_u32 s4, s42, 256000
    s_add_u32 m0, s37, 25600
    s_nop 0
    buffer_load_dwordx4 v13, s[12:15], s4 offen nt lds
    s_add_u32 s4, s42, 327680
    s_add_u32 m0, s37, 32768
    s_nop 0
    buffer_load_dwordx4 v13, s[12:15], s4 offen nt lds
    s_add_u32 s4, s42, 337920
    s_add_u32 m0, s37, 33792
    s_nop 0
    buffer_load_dwordx4 v13, s[12:15], s4 offen nt lds
    s_add_u32 s4, s42, 409600
    s_add_u32 m0, s37, 40960
    s_nop 0
    buffer_load_dwordx4 v13, s[12:15], s4 offen nt lds
    s_add_u32 s4, s42, 419840
    s_add_u32 m0, s37, 41984
    s_nop 0
    buffer_load_dwordx4 v13, s[12:15], s4 offen nt lds
    s_add_u32 s4, s42, 491520
    s_add_u32 m0, s37, 49152
    s_nop 0
    buffer_load_dwordx4 v13, s[12:15], s4 offen nt lds
    s_add_u32 s4, s42, 501760
    s_add_u32 m0, s37, 50176
    s_nop 0
    buffer_load_dwordx4 v13, s[12:15], s4 offen nt lds
    s_add_u32 s4, s42, 573440
    s_add_u32 m0, s37, 57344
    s_nop 0
    buffer_load_dwordx4 v13, s[12:15], s4 offen nt lds
    s_add_u32 s4, s42, 583680
    s_add_u32 m0, s37, 58368
    s_nop 0
    buffer_load_dwordx4 v13, s[12:15], s4 offen nt lds
    s_add_u32 s4, s42, 655360
    s_add_u32 m0, s37, 65536
    s_nop 0
    buffer_load_dwordx4 v13, s[12:15], s4 offen nt lds
    s_add_u32 s4, s42, 665600
    s_add_u32 m0, s37, 66560
    s_nop 0
    buffer_load_dwordx4 v13, s[12:15], s4 offen nt lds
    s_add_u32 s4, s42, 737280
    s_add_u32 m0, s37, 73728
    s_nop 0
    buffer_load_dwordx4 v13, s[12:15], s4 offen nt lds
    s_add_u32 s4, s42, 747520
    s_add_u32 m0, s37, 74752
    s_nop 0
    buffer_load_dwordx4 v13, s[12:15], s4 offen nt lds
    s_add_u32 s4, s42, 819200
    s_add_u32 m0, s37, 81920
    s_nop 0
    buffer_load_dwordx4 v13, s[12:15], s4 offen nt lds
    s_add_u32 s4, s42, 829440
    s_add_u32 m0, s37, 82944
    s_nop 0
    buffer_load_dwordx4 v13, s[12:15], s4 offen nt lds
    s_add_u32 s4, s42, 901120
    s_add_u32 m0, s37, 90112
    s_nop 0
    buffer_load_dwordx4 v13, s[12:15], s4 offen nt lds
    s_add_u32 s4, s42, 911360
    s_add_u32 m0, s37, 91136
    s_nop 0
    buffer_load_dwordx4 v13, s[12:15], s4 offen nt lds
    v_and_b32 v4, 3, v1
    v_mul_u32_u24 v39, 1280, v4
    v_lshrrev_b32 v5, 4, v1
    v_lshl_add_u32 v39, v5, 6, v39
    v_bfe_u32 v5, v1, 2, 2
    v_lshl_add_u32 v39, v5, 3, v39
    v_add_u32 v39, s23, v39
    v_lshrrev_b32 v5, 2, v1
    v_lshlrev_b32 v3, 8, v5
    v_lshl_add_u32 v3, v4, 4, v3
    s_lshl_b32 s4, s3, 6
    s_add_u32 s4, s4, 98304
    v_add_u32 v3, s4, v3
    s_mul_i32 s27, s21, 20480
    s_mul_i32 s4, s3, 5120
    s_add_u32 s27, s27, s4
    s_add_u32 s27, s27, 16777216
    s_waitcnt vmcnt(24)
    v_add_u32 v12, 0, v39
    s_call_b64 s[100:101], XN_sub
    v_cvt_pk_bf16_f32 v180, v60, v61
    v_cvt_pk_bf16_f32 v181, v62, v63
    v_cvt_pk_bf16_f32 v182, v64, v65
    v_cvt_pk_bf16_f32 v183, v66, v67
    v_cvt_pk_bf16_f32 v184, v68, v69
    v_cvt_pk_bf16_f32 v185, v70, v71
    v_cvt_pk_bf16_f32 v186, v72, v73
    v_cvt_pk_bf16_f32 v187, v74, v75
    v_cvt_pk_bf16_f32 v188, v76, v77
    v_cvt_pk_bf16_f32 v189, v78, v79
    v_cvt_pk_bf16_f32 v190, v80, v81
    v_cvt_pk_bf16_f32 v191, v82, v83
    v_cvt_pk_bf16_f32 v192, v84, v85
    v_cvt_pk_bf16_f32 v193, v86, v87
    v_cvt_pk_bf16_f32 v194, v88, v89
    v_cvt_pk_bf16_f32 v195, v90, v91
    v_cvt_pk_bf16_f32 v196, v92, v93
    v_cvt_pk_bf16_f32 v197, v94, v95
    v_cvt_pk_bf16_f32 v198, v96, v97
    v_cvt_pk_bf16_f32 v199, v98, v99
    s_cmp_lt_u32 s21, 48
    s_cbranch_scc0 CN_1
    v_add_u32 v12, 20480, v39
    s_call_b64 s[100:101], XN_sub
    v_cvt_pk_bf16_f32 v200, v60, v61
    v_cvt_pk_bf16_f32 v201, v62, v63
    v_cvt_pk_bf16_f32 v202, v64, v65
    v_cvt_pk_bf16_f32 v203, v66, v67
    v_cvt_pk_bf16_f32 v204, v68, v69
    v_cvt_pk_bf16_f32 v205, v70, v71
    v_cvt_pk_bf16_f32 v206, v72, v73
    v_cvt_pk_bf16_f32 v207, v74, v75
    v_cvt_pk_bf16_f32 v208, v76, v77
    v_cvt_pk_bf16_f32 v209, v78, v79
    v_cvt_pk_bf16_f32 v210, v80, v81
    v_cvt_pk_bf16_f32 v211, v82, v83
    v_cvt_pk_bf16_f32 v212, v84, v85
    v_cvt_pk_bf16_f32 v213, v86, v87
    v_cvt_pk_bf16_f32 v214, v88, v89
    v_cvt_pk_bf16_f32 v215, v90, v91
    v_cvt_pk_bf16_f32 v216, v92, v93
    v_cvt_pk_bf16_f32 v217, v94, v95
    v_cvt_pk_bf16_f32 v218, v96, v97
    v_cvt_pk_bf16_f32 v219, v98, v99
CN_1:
    v_and_b32 v16, 7, v1
    v_lshlrev_b32 v16, 5, v16
    buffer_load_dwordx4 v[20:23], v16, s[16:19], 0 offen sc1
    s_mov_b32 s31, 0
    s_waitcnt vmcnt(0)
    s_branch CI_c
CI_l:
    buffer_load_dwordx4 v[20:23], v16, s[16:19], 0 offen sc1
    s_waitcnt vmcnt(0)
CI_c:
    v_bcnt_u32_b32 v17, v20, v23
    v_cmp_lt_u32 s[4:5], 32, v17
    s_and_b32 s6, s4, 0xff
    v_cmp_ne_u32 s[4:5], 32, v17
    s_cmp_eq_u32 s6, 0
    s_cselect_b32 s5, 0xff, 0
    s_and_b32 s4, s4, s5
    v_add_u32 v21, v21, v22
    v_cmp_gt_u32 vcc, 32, v21
    s_and_b32 vcc_lo, vcc_lo, 0xff
    s_or_b32 vcc_lo, vcc_lo, s4
    s_mov_b32 vcc_hi, 0
    s_cbranch_vccz CI_o
    s_sleep 16
    s_add_u32 s31, s31, 1
    s_cmp_lt_u32 s31, s30
    s_cbranch_scc1 CI_l
    s_mov_b32 s30, 1
CI_o:
    s_mov_b32 s97, s6
    s_cmp_lg_u32 s3, 0
    s_cbranch_scc1 CW_o
    s_mov_b32 s5, 32768
    s_mov_b32 s31, 0
CW_l:
    buffer_load_dwordx4 v[40:43], v2, s[8:11], s5 offen offset:0 sc1
    buffer_load_dwordx4 v[44:47], v2, s[8:11], s5 offen offset:1024 sc1
    buffer_load_dwordx4 v[48:51], v2, s[8:11], s5 offen offset:1536 sc1
    s_waitcnt vmcnt(0)
    v_max3_u32 v4, v40, v41, v42
    v_max3_u32 v4, v4, v43, v44
    v_max3_u32 v4, v4, v45, v46
    v_max3_u32 v4, v4, v47, v48
    v_max3_u32 v4, v4, v49, v50
    v_max_u32 v4, v4, v51
    v_cmp_eq_u32 vcc, -1, v4
    s_cbranch_vccz CW_o
    s_sleep 4
    s_add_u32 s31, s31, 1
    s_cmp_lt_u32 s31, s30
    s_cbranch_scc1 CW_l
    s_mov_b32 s30, 1
CW_o:
    s_barrier
    v_lshrrev_b32 v10, 2, v1
    v_lshlrev_b32 v10, 4, v10
    s_mov_b64 s[24:25], -1
    s_mov_b32 s5, 32768
    buffer_load_dwordx4 v[160:163], v10, s[8:11], s5 offen offset:0 sc1
    buffer_load_dwordx4 v[164:167], v10, s[8:11], s5 offen offset:256 sc1
    buffer_load_dwordx4 v[168:171], v10, s[8:11], s5 offen offset:512 sc1
    buffer_load_dwordx4 v[172:175], v10, s[8:11], s5 offen offset:768 sc1
    buffer_load_dwordx4 v[176:179], v10, s[8:11], s5 offen offset:1024 sc1
    buffer_load_dwordx4 v[120:123], v10, s[8:11], s5 offen offset:1280 sc1
    buffer_load_dwordx4 v[124:127], v10, s[8:11], s5 offen offset:1536 sc1
    buffer_load_dwordx4 v[128:131], v10, s[8:11], s5 offen offset:1792 sc1
    buffer_load_dwordx4 v[132:135], v10, s[8:11], s5 offen offset:2048 sc1
    buffer_load_dwordx4 v[136:139], v10, s[8:11], s5 offen offset:2304 sc1
    s_waitcnt vmcnt(0)
    v_lshlrev_b32 v100, 16, v120
    v_and_b32 v101, 0xffff0000, v120
    v_lshlrev_b32 v102, 16, v121
    v_and_b32 v103, 0xffff0000, v121
    v_lshlrev_b32 v104, 16, v122
    v_and_b32 v105, 0xffff0000, v122
    v_lshlrev_b32 v106, 16, v123
    v_and_b32 v107, 0xffff0000, v123
    v_lshlrev_b32 v108, 16, v124
    v_and_b32 v109, 0xffff0000, v124
    v_lshlrev_b32 v110, 16, v125
    v_and_b32 v111, 0xffff0000, v125
    v_lshlrev_b32 v112, 16, v126
    v_and_b32 v113, 0xffff0000, v126
    v_lshlrev_b32 v114, 16, v127
    v_and_b32 v115, 0xffff0000, v127
    v_lshlrev_b32 v116, 16, v128
    v_and_b32 v117, 0xffff0000, v128
    v_lshlrev_b32 v118, 16, v129
    v_and_b32 v119, 0xffff0000, v129
    v_lshlrev_b32 v120, 16, v130
    v_and_b32 v121, 0xffff0000, v130
    v_lshlrev_b32 v122, 16, v131
    v_and_b32 v123, 0xffff0000, v131
    v_lshlrev_b32 v124, 16, v132
    v_and_b32 v125, 0xffff0000, v132
    v_lshlrev_b32 v126, 16, v133
    v_and_b32 v127, 0xffff0000, v133
    v_lshlrev_b32 v128, 16, v134
    v_and_b32 v129, 0xffff0000, v134
    v_lshlrev_b32 v130, 16, v135
    v_and_b32 v131, 0xffff0000, v135
    v_lshlrev_b32 v132, 16, v136
    v_and_b32 v133, 0xffff0000, v136
    v_lshlrev_b32 v134, 16, v137
    v_and_b32 v135, 0xffff0000, v137
    v_lshlrev_b32 v136, 16, v138
    v_and_b32 v137, 0xffff0000, v138
    v_lshlrev_b32 v138, 16, v139
    v_and_b32 v139, 0xffff0000, v139
    v_lshlrev_b32 v140, 16, v160
    v_and_b32 v141, 0xffff0000, v160
    v_lshlrev_b32 v142, 16, v161
    v_and_b32 v143, 0xffff0000, v161
    v_lshlrev_b32 v144, 16, v162
    v_and_b32 v145, 0xffff0000, v162
    v_lshlrev_b32 v146, 16, v163
    v_and_b32 v147, 0xffff0000, v163
    v_lshlrev_b32 v148, 16, v164
    v_and_b32 v149, 0xffff0000, v164
    v_lshlrev_b32 v150, 16, v165
    v_and_b32 v151, 0xffff0000, v165
    v_lshlrev_b32 v152, 16, v166
    v_and_b32 v153, 0xffff0000, v166
    v_lshlrev_b32 v154, 16, v167
    v_and_b32 v155, 0xffff0000, v167
    v_lshlrev_b32 v156, 16, v168
    v_and_b32 v157, 0xffff0000, v168
    v_lshlrev_b32 v158, 16, v169
    v_and_b32 v159, 0xffff0000, v169
    v_lshlrev_b32 v160, 16, v170
    v_and_b32 v161, 0xffff0000, v170
    v_lshlrev_b32 v162, 16, v171
    v_and_b32 v163, 0xffff0000, v171
    v_lshlrev_b32 v164, 16, v172
    v_and_b32 v165, 0xffff0000, v172
    v_lshlrev_b32 v166, 16, v173
    v_and_b32 v167, 0xffff0000, v173
    v_lshlrev_b32 v168, 16, v174
    v_and_b32 v169, 0xffff0000, v174
    v_lshlrev_b32 v170, 16, v175
    v_and_b32 v171, 0xffff0000, v175
    v_lshlrev_b32 v172, 16, v176
    v_and_b32 v173, 0xffff0000, v176
    v_lshlrev_b32 v174, 16, v177
    v_and_b32 v175, 0xffff0000, v177
    v_lshlrev_b32 v176, 16, v178
    v_and_b32 v177, 0xffff0000, v178
    v_lshlrev_b32 v178, 16, v179
    v_and_b32 v179, 0xffff0000, v179
    v_lshlrev_b32 v60, 16, v180
    v_and_b32 v61, 0xffff0000, v180
    v_lshlrev_b32 v62, 16, v181
    v_and_b32 v63, 0xffff0000, v181
    v_lshlrev_b32 v64, 16, v182
    v_and_b32 v65, 0xffff0000, v182
    v_lshlrev_b32 v66, 16, v183
    v_and_b32 v67, 0xffff0000, v183
    v_lshlrev_b32 v68, 16, v184
    v_and_b32 v69, 0xffff0000, v184
    v_lshlrev_b32 v70, 16, v185
    v_and_b32 v71, 0xffff0000, v185
    v_lshlrev_b32 v72, 16, v186
    v_and_b32 v73, 0xffff0000, v186
    v_lshlrev_b32 v74, 16, v187
    v_and_b32 v75, 0xffff0000, v187
    v_lshlrev_b32 v76, 16, v188
    v_and_b32 v77, 0xffff0000, v188
    v_lshlrev_b32 v78, 16, v189
    v_and_b32 v79, 0xffff0000, v189
    v_lshlrev_b32 v80, 16, v190
    v_and_b32 v81, 0xffff0000, v190
    v_lshlrev_b32 v82, 16, v191
    v_and_b32 v83, 0xffff0000, v191
    v_lshlrev_b32 v84, 16, v192
    v_and_b32 v85, 0xffff0000, v192
    v_lshlrev_b32 v86, 16, v193
    v_and_b32 v87, 0xffff0000, v193
    v_lshlrev_b32 v88, 16, v194
    v_and_b32 v89, 0xffff0000, v194
    v_lshlrev_b32 v90, 16, v195
    v_and_b32 v91, 0xffff0000, v195
    v_lshlrev_b32 v92, 16, v196
    v_and_b32 v93, 0xffff0000, v196
    v_lshlrev_b32 v94, 16, v197
    v_and_b32 v95, 0xffff0000, v197
    v_lshlrev_b32 v96, 16, v198
    v_and_b32 v97, 0xffff0000, v198
    v_lshlrev_b32 v98, 16, v199
    v_and_b32 v99, 0xffff0000, v199
    v_add_u32 v12, 0, v3
    s_add_u32 s4, s23, 0
    v_add_u32 v11, s4, v2
    s_call_b64 s[100:101], XS_sub
    s_add_u32 s27, s27, 1638400
    s_cmp_lt_u32 s21, 48
    s_cbranch_scc0 CN_2
    v_lshlrev_b32 v60, 16, v200
    v_and_b32 v61, 0xffff0000, v200
    v_lshlrev_b32 v62, 16, v201
    v_and_b32 v63, 0xffff0000, v201
    v_lshlrev_b32 v64, 16, v202
    v_and_b32 v65, 0xffff0000, v202
    v_lshlrev_b32 v66, 16, v203
    v_and_b32 v67, 0xffff0000, v203
    v_lshlrev_b32 v68, 16, v204
    v_and_b32 v69, 0xffff0000, v204
    v_lshlrev_b32 v70, 16, v205
    v_and_b32 v71, 0xffff0000, v205
    v_lshlrev_b32 v72, 16, v206
    v_and_b32 v73, 0xffff0000, v206
    v_lshlrev_b32 v74, 16, v207
    v_and_b32 v75, 0xffff0000, v207
    v_lshlrev_b32 v76, 16, v208
    v_and_b32 v77, 0xffff0000, v208
    v_lshlrev_b32 v78, 16, v209
    v_and_b32 v79, 0xffff0000, v209
    v_lshlrev_b32 v80, 16, v210
    v_and_b32 v81, 0xffff0000, v210
    v_lshlrev_b32 v82, 16, v211
    v_and_b32 v83, 0xffff0000, v211
    v_lshlrev_b32 v84, 16, v212
    v_and_b32 v85, 0xffff0000, v212
    v_lshlrev_b32 v86, 16, v213
    v_and_b32 v87, 0xffff0000, v213
    v_lshlrev_b32 v88, 16, v214
    v_and_b32 v89, 0xffff0000, v214
    v_lshlrev_b32 v90, 16, v215
    v_and_b32 v91, 0xffff0000, v215
    v_lshlrev_b32 v92, 16, v216
    v_and_b32 v93, 0xffff0000, v216
    v_lshlrev_b32 v94, 16, v217
    v_and_b32 v95, 0xffff0000, v217
    v_lshlrev_b32 v96, 16, v218
    v_and_b32 v97, 0xffff0000, v218
    v_lshlrev_b32 v98, 16, v219
    v_and_b32 v99, 0xffff0000, v219
    v_add_u32 v12, 20480, v3
    s_add_u32 s4, s23, 20480
    v_add_u32 v11, s4, v2
    s_call_b64 s[100:101], XS_sub
    s_add_u32 s27, s27, 1638400
CN_2:
    v_mov_b32 v9, 0
    v_and_b32 v16, 7, v1
    v_lshrrev_b32 v17, 4, v1
    v_bfe_u32 v18, v1, 3, 1
    s_sub_u32 s4, s20, 18
    s_lshl_b32 s4, s4, 9
    s_add_u32 s43, s4, 2801664
    s_lshl_b32 s4, s99, 6
    s_add_u32 s24, s43, s4
    s_and_b32 s4, s99, 3
    s_lshl_b32 s4, s4, 14
    s_add_u32 s43, s43, s4
    s_lshl_b32 s4, s3, 7
    s_add_u32 s43, s43, s4
    s_cmp_eq_u32 s3, 0
    s_cselect_b32 s4, 8, 0
    s_cselect_b32 s44, 255, 0
    s_mov_b32 s45, 0
    v_lshrrev_b32 v198, 0, v1
    v_lshlrev_b32 v198, 13, v198
    v_and_b32 v19, 0, v2
    v_add_u32 v198, v198, v19
    v_mov_b32 v19, 0x80000000
    v_cmp_gt_u32 vcc, s4, v1
    s_nop 1
    v_cndmask_b32 v198, v19, v198, vcc
    s_lshr_b32 s4, s98, 1
    s_lshl_b32 s5, s4, 9
    s_and_b32 s6, s98, 1
    s_lshl_b32 s7, s6, 7
    s_add_u32 s5, s5, s7
    v_lshrrev_b32 v19, 1, v17
    v_lshlrev_b32 v6, 8, v19
    v_lshl_add_u32 v6, v16, 4, v6
    v_and_b32 v19, 1, v17
    v_lshl_add_u32 v6, v19, 3, v6
    v_add_u32 v6, s5, v6
    v_mov_b32 v19, 0x80000000
    v_cmp_ne_u32 vcc, 0, v18
    s_nop 1
    v_cndmask_b32 v6, v6, v19, vcc
    s_lshr_b32 s4, s98, 2
    s_lshl_b32 s4, s4, 14
    s_lshl_b32 s6, s3, 11
    s_add_u32 s4, s4, s6
    v_add_u32 v8, s4, v2
    v_lshrrev_b32 v19, 1, v17
    v_lshlrev_b32 v7, 7, v19
    v_lshl_add_u32 v7, v16, 4, v7
    v_and_b32 v19, 1, v17
    v_lshl_add_u32 v7, v19, 3, v7
    v_lshl_add_u32 v7, v18, 13, v7
    s_lshl_b32 s6, s99, 8
    s_add_u32 s4, s4, s6
    v_add_u32 v7, s4, v7
    v_and_b32 v19, 15, v1
    v_lshlrev_b32 v12, 5, v19
    v_lshl_add_u32 v12, v17, 3, v12
    s_and_b32 s4, s99, 3
    s_mul_i32 s34, s4, 81920
    s_lshr_b32 s4, s98, 3
    s_lshl_b32 s4, s4, 14
    s_add_u32 s34, s34, s4
    s_and_b32 s4, s98, 7
    s_lshl_b32 s4, s4, 10
    s_add_u32 s34, s34, s4
    s_add_u32 s34, s34, 23068672
    v_lshrrev_b32 v19, 3, v1
    v_and_b32 v20, 1, v19
    v_mul_u32_u24 v20, 3, v20
    v_sub_u32 v20, 5, v20
    v_min_u32 v4, v16, v20
    v_lshlrev_b32 v4, 2, v4
    v_lshl_add_u32 v4, v19, 7, v4
    v_add_u32 v4, 156672, v4
    v_lshrrev_b32 v19, 3, v1
    v_and_b32 v20, 3, v1
    v_lshlrev_b32 v11, 7, v20
    v_lshrrev_b32 v20, 1, v20
    v_lshl_add_u32 v11, v20, 6, v11
    v_lshl_add_u32 v11, v19, 4, v11
    v_bfe_u32 v20, v1, 2, 1
    v_lshl_add_u32 v11, v20, 2, v11
    s_mul_i32 s4, s3, 768
    s_add_u32 s4, s4, 98304
    v_add_u32 v11, s4, v11
    v_bfe_u32 v20, v1, 2, 1
    v_lshlrev_b32 v244, 7, v20
    v_lshl_add_u32 v244, v19, 4, v244
    v_and_b32 v20, 3, v1
    v_lshl_add_u32 v244, v20, 1, v244
    s_lshr_b32 s4, s3, 1
    s_lshl_b32 s4, s4, 8
    s_and_b32 s5, s3, 1
    s_lshl_b32 s5, s5, 3
    s_add_u32 s4, s4, s5
    s_add_u32 s4, s4, 101376
    v_add_u32 v244, s4, v244
    v_lshlrev_b32 v14, 7, v17
    v_lshrrev_b32 v20, 1, v17
    v_lshl_add_u32 v14, v20, 6, v14
    v_lshl_add_u32 v14, v16, 4, v14
    v_add_u32 v14, 98304, v14
    v_and_b32 v20, 1, v17
    v_lshlrev_b32 v15, 7, v20
    v_lshl_add_u32 v15, v16, 4, v15
    v_add_u32 v15, 101376, v15
    v_and_b32 v245, 0x1f0, v2
    v_add_u32 v245, 110592, v245
    v_add_u32 v246, 102400, v2
    v_min_u32 v247, 5, v1
    s_mul_i32 s4, s3, 24
    s_add_u32 s4, s4, 155840
    v_lshl_add_u32 v247, v247, 2, s4
    v_and_b32 v248, 7, v1
    v_lshlrev_b32 v248, 2, v248
    v_add_u32 v248, 156096, v248
    s_mov_b32 s49, 0x3dd53b95
    s_lshr_b32 s4, s98, 1
    s_lshl_b32 s5, s4, 9
    s_and_b32 s6, s98, 1
    s_lshl_b32 s7, s6, 7
    s_add_u32 s5, s5, s7
    v_lshlrev_b32 v222, 8, v18
    v_lshl_add_u32 v222, v16, 4, v222
    v_lshl_add_u32 v222, v17, 3, v222
    v_add_u32 v222, s5, v222
    v_mov_b32 v19, 0x80000000
    v_cmp_lt_u32 vcc, 31, v1
    s_nop 1
    v_cndmask_b32 v222, v222, v19, vcc
    v_mov_b32 v19, 0x3f80
    v_mov_b32 v20, 0x3f800000
    v_cmp_eq_u32 vcc, 0, v16
    s_nop 1
    v_cndmask_b32 v224, 0, v19, vcc
    v_cmp_eq_u32 vcc, 1, v16
    s_nop 1
    v_cndmask_b32 v224, v224, v20, vcc
    v_cmp_eq_u32 vcc, 2, v16
    s_nop 1
    v_cndmask_b32 v225, 0, v19, vcc
    v_cmp_eq_u32 vcc, 3, v16
    s_nop 1
    v_cndmask_b32 v225, v225, v20, vcc
    v_cmp_eq_u32 vcc, 4, v16
    s_nop 1
    v_cndmask_b32 v226, 0, v19, vcc
    v_cmp_eq_u32 vcc, 5, v16
    s_nop 1
    v_cndmask_b32 v226, v226, v20, vcc
    v_cmp_eq_u32 vcc, 6, v16
    s_nop 1
    v_cndmask_b32 v227, 0, v19, vcc
    v_cmp_eq_u32 vcc, 7, v16
    s_nop 1
    v_cndmask_b32 v227, v227, v20, vcc
    v_and_b32 v16, 8, v1
    v_mov_b32 v5, 0x4444
    v_mov_b32 v17, 0xeeee
    v_cmp_ne_u32 vcc, 0, v16
    s_nop 1
    v_cndmask_b32 v5, v5, v17, vcc
    s_waitcnt vmcnt(0)
    s_barrier
    s_lshl_b32 s4, s21, 7
    s_add_u32 s4, s4, 65536
    v_mov_b32 v16, 1
    v_lshlrev_b32 v17, 2, v1
    s_cmp_eq_u32 s3, 0
    s_cselect_b64 exec, 1, 0
    buffer_store_dword v16, v17, s[8:11], s4 offen sc1
    s_mov_b64 exec, -1
    s_mul_i32 s4, s3, 24576
    v_add_u32 v0, s4, v0
    v_xor_b32 v60, 0, v0
    ds_read_b64_tr_b16 a[0:1], v60 offset:0
    ds_read_b64_tr_b16 a[2:3], v60 offset:256
    ds_read_b64_tr_b16 a[4:5], v60 offset:4096
    ds_read_b64_tr_b16 a[6:7], v60 offset:4352
    ds_read_b64_tr_b16 a[8:9], v60 offset:8192
    ds_read_b64_tr_b16 a[10:11], v60 offset:8448
    ds_read_b64_tr_b16 a[12:13], v60 offset:12288
    ds_read_b64_tr_b16 a[14:15], v60 offset:12544
    ds_read_b64_tr_b16 a[16:17], v60 offset:16384
    ds_read_b64_tr_b16 a[18:19], v60 offset:16640
    ds_read_b64_tr_b16 a[20:21], v60 offset:20480
    ds_read_b64_tr_b16 a[22:23], v60 offset:20736
    v_xor_b32 v60, 32, v0
    ds_read_b64_tr_b16 a[24:25], v60 offset:0
    ds_read_b64_tr_b16 a[26:27], v60 offset:256
    ds_read_b64_tr_b16 a[28:29], v60 offset:4096
    ds_read_b64_tr_b16 a[30:31], v60 offset:4352
    ds_read_b64_tr_b16 a[32:33], v60 offset:8192
    ds_read_b64_tr_b16 a[34:35], v60 offset:8448
    ds_read_b64_tr_b16 a[36:37], v60 offset:12288
    ds_read_b64_tr_b16 a[38:39], v60 offset:12544
    ds_read_b64_tr_b16 a[40:41], v60 offset:16384
    ds_read_b64_tr_b16 a[42:43], v60 offset:16640
    ds_read_b64_tr_b16 a[44:45], v60 offset:20480
    ds_read_b64_tr_b16 a[46:47], v60 offset:20736
    v_xor_b32 v60, 64, v0
    ds_read_b64_tr_b16 a[48:49], v60 offset:0
    ds_read_b64_tr_b16 a[50:51], v60 offset:256
    ds_read_b64_tr_b16 a[52:53], v60 offset:4096
    ds_read_b64_tr_b16 a[54:55], v60 offset:4352
    ds_read_b64_tr_b16 a[56:57], v60 offset:8192
    ds_read_b64_tr_b16 a[58:59], v60 offset:8448
    ds_read_b64_tr_b16 a[60:61], v60 offset:12288
    ds_read_b64_tr_b16 a[62:63], v60 offset:12544
    ds_read_b64_tr_b16 a[64:65], v60 offset:16384
    ds_read_b64_tr_b16 a[66:67], v60 offset:16640
    ds_read_b64_tr_b16 a[68:69], v60 offset:20480
    ds_read_b64_tr_b16 a[70:71], v60 offset:20736
    v_xor_b32 v60, 96, v0
    ds_read_b64_tr_b16 a[72:73], v60 offset:0
    ds_read_b64_tr_b16 a[74:75], v60 offset:256
    ds_read_b64_tr_b16 a[76:77], v60 offset:4096
    ds_read_b64_tr_b16 a[78:79], v60 offset:4352
    ds_read_b64_tr_b16 a[80:81], v60 offset:8192
    ds_read_b64_tr_b16 a[82:83], v60 offset:8448
    ds_read_b64_tr_b16 a[84:85], v60 offset:12288
    ds_read_b64_tr_b16 a[86:87], v60 offset:12544
    ds_read_b64_tr_b16 a[88:89], v60 offset:16384
    ds_read_b64_tr_b16 a[90:91], v60 offset:16640
    ds_read_b64_tr_b16 a[92:93], v60 offset:20480
    ds_read_b64_tr_b16 a[94:95], v60 offset:20736
    v_and_b32 v16, 31, v1
    v_lshlrev_b32 v16, 7, v16
    s_mov_b32 s23, 65536
    s_mov_b32 s31, 0
CH_l:
    buffer_load_dword v17, v16, s[8:11], s23 offen sc1
    s_waitcnt vmcnt(0)
CH_c:
    v_cmp_gt_u32 vcc, 1, v17
    s_cbranch_vccz CH_o
    s_sleep 4
    s_add_u32 s31, s31, 1
    s_cmp_lt_u32 s31, s30
    s_cbranch_scc1 CH_l
    s_mov_b32 s30, 1
CH_o:
    s_mov_b32 s5, 0
    v_readlane_b32 s4, v17, 20
    s_add_u32 s5, s5, s4
    v_readlane_b32 s4, v17, 21
    s_add_u32 s5, s5, s4
    v_readlane_b32 s4, v17, 22
    s_add_u32 s5, s5, s4
    v_readlane_b32 s4, v17, 23
    s_add_u32 s5, s5, s4
    v_readlane_b32 s4, v17, 24
    s_add_u32 s5, s5, s4
    v_readlane_b32 s4, v17, 25
    s_add_u32 s5, s5, s4
    v_readlane_b32 s4, v17, 26
    s_add_u32 s5, s5, s4
    v_readlane_b32 s4, v17, 27
    s_add_u32 s5, s5, s4
    v_readlane_b32 s4, v17, 28
    s_add_u32 s5, s5, s4
    v_readlane_b32 s4, v17, 29
    s_add_u32 s5, s5, s4
    v_readlane_b32 s4, v17, 30
    s_add_u32 s5, s5, s4
    v_readlane_b32 s4, v17, 31
    s_add_u32 s5, s5, s4
    s_lshr_b32 s4, s5, 16
    s_cmp_gt_u32 s4, 24
    s_cselect_b32 s96, 8192, 0
    s_lshl_b32 s4, s99, 11
    s_xor_b32 s96, s96, s4
    s_and_b32 s96, s96, 8192
    s_waitcnt lgkmcnt(0)
    s_mov_b32 s21, 0
    s_add_u32 s43, s43, s96
    s_add_u32 s37, s43, 64
    s_lshl_b32 s4, s3, 1
    s_cmp_eq_u32 s4, s99
    s_cselect_b32 s95, -1, 0
    s_add_u32 s4, s4, 1
    s_cmp_eq_u32 s4, s99
    s_cselect_b32 s94, -1, 0
    v_add_u32 v8, s96, v8
    s_mul_i32 s27, s3, 12288
    s_add_u32 s27, s27, s22
    s_add_u32 s27, s27, 159744
    s_mov_b32 s36, 196608
    s_sub_u32 s34, s34, 1048576
    s_xor_b32 s4, s96, 8192
    s_add_u32 s34, s34, s4
    s_cmp_lg_u32 s97, 0
    s_cbranch_scc1 Cs_go
Cf_go:
    s_lshl_b32 s4, s3, 12
    v_add_u32 v194, s4, v2
    s_lshl_b32 s4, s3, 11
    s_add_u32 s4, s4, 65536
    v_add_u32 v195, s4, v2
    s_lshr_b32 s4, s3, 1
    s_lshl_b32 s4, s4, 10
    s_and_b32 s5, s3, 1
    s_lshl_b32 s5, s5, 3
    s_add_u32 s4, s4, s5
    s_add_u32 s4, s4, 65536
    v_add_u32 v196, s4, v2
    s_lshl_b32 s4, s3, 10
    v_add_u32 v197, s4, v2
    v_mov_b32 v3, v197
    s_mul_i32 s4, s3, 3072
    s_min_u32 s4, s4, 7168
    s_add_u32 s92, s4, s22
    s_add_u32 s92, s92, 405504
    s_add_u32 s93, s4, 102400
    s_mov_b64 s[84:85], 0
    s_mov_b64 s[86:87], 0
    s_mov_b64 s[88:89], 0
    s_mov_b64 s[90:91], 0
    s_mul_i32 s4, s3, 3072
    s_add_u32 s29, s4, s22
    s_add_u32 s29, s29, 106496
    s_lshl_b32 s4, s3, 12
    s_add_u32 s32, s4, s22
    s_add_u32 s32, s32, 40960
    s_barrier
    s_mov_b32 s31, 0
Cfv1_l:
    buffer_load_dword v250, v247, s[8:11], s22 offen sc1
    s_waitcnt vmcnt(0)
Cfv1_c:
    v_cmp_gt_u32 vcc, 1, v250
    s_cbranch_vccz Cfv1_o
    s_sleep 1
    s_add_u32 s31, s31, 1
    s_cmp_lt_u32 s31, s30
    s_cbranch_scc1 Cfv1_l
    s_mov_b32 s30, 1
Cfv1_o:
    s_add_u32 s4, 1, 3
    s_and_b32 s4, s4, 3
    s_mul_i32 s4, s4, 49152
    s_add_u32 s40, s4, s27
    s_add_u32 s41, s40, 4096
    s_add_u32 s42, s40, 8192
    buffer_load_dwordx4 v[48:51], v2, s[8:11], s40 offen offset:0 sc1
    buffer_load_dwordx4 v[52:55], v2, s[8:11], s40 offen offset:1024 sc1
    buffer_load_dwordx4 v[56:59], v2, s[8:11], s40 offen offset:2048 sc1
    buffer_load_dwordx4 v[60:63], v2, s[8:11], s40 offen offset:3072 sc1
    buffer_load_dwordx4 v[64:67], v2, s[8:11], s41 offen offset:0 sc1
    buffer_load_dwordx4 v[68:71], v2, s[8:11], s41 offen offset:1024 sc1
    buffer_load_dwordx4 v[72:75], v2, s[8:11], s41 offen offset:2048 sc1
    buffer_load_dwordx4 v[76:79], v2, s[8:11], s41 offen offset:3072 sc1
    buffer_load_dwordx4 v[80:83], v2, s[8:11], s42 offen offset:0 sc1
    buffer_load_dwordx4 v[84:87], v2, s[8:11], s42 offen offset:1024 sc1
    buffer_load_dwordx4 v[88:91], v2, s[8:11], s42 offen offset:2048 sc1
    buffer_load_dwordx4 v[92:95], v2, s[8:11], s42 offen offset:3072 sc1
    s_waitcnt vmcnt(0)
    v_mfma_f32_16x16x32_bf16 v[136:139], v[48:51], a[0:3], 0
    v_mfma_f32_16x16x32_bf16 v[144:147], v[48:51], a[24:27], 0
    v_mfma_f32_16x16x32_bf16 v[152:155], v[48:51], a[48:51], 0
    v_mfma_f32_16x16x32_bf16 v[160:163], v[48:51], a[72:75], 0
    v_mfma_f32_16x16x32_bf16 v[140:143], v[72:75], a[0:3], 0
    v_mfma_f32_16x16x32_bf16 v[148:151], v[72:75], a[24:27], 0
    v_mfma_f32_16x16x32_bf16 v[156:159], v[72:75], a[48:51], 0
    v_mfma_f32_16x16x32_bf16 v[164:167], v[72:75], a[72:75], 0
    v_mfma_f32_16x16x32_bf16 v[136:139], v[52:55], a[4:7], v[136:139]
    v_mfma_f32_16x16x32_bf16 v[144:147], v[52:55], a[28:31], v[144:147]
    v_mfma_f32_16x16x32_bf16 v[152:155], v[52:55], a[52:55], v[152:155]
    v_mfma_f32_16x16x32_bf16 v[160:163], v[52:55], a[76:79], v[160:163]
    v_mfma_f32_16x16x32_bf16 v[140:143], v[76:79], a[4:7], v[140:143]
    v_mfma_f32_16x16x32_bf16 v[148:151], v[76:79], a[28:31], v[148:151]
    v_mfma_f32_16x16x32_bf16 v[156:159], v[76:79], a[52:55], v[156:159]
    v_mfma_f32_16x16x32_bf16 v[164:167], v[76:79], a[76:79], v[164:167]
    v_mfma_f32_16x16x32_bf16 v[136:139], v[56:59], a[8:11], v[136:139]
    v_mfma_f32_16x16x32_bf16 v[144:147], v[56:59], a[32:35], v[144:147]
    v_mfma_f32_16x16x32_bf16 v[152:155], v[56:59], a[56:59], v[152:155]
    v_mfma_f32_16x16x32_bf16 v[160:163], v[56:59], a[80:83], v[160:163]
    v_mfma_f32_16x16x32_bf16 v[140:143], v[80:83], a[8:11], v[140:143]
    v_mfma_f32_16x16x32_bf16 v[148:151], v[80:83], a[32:35], v[148:151]
    v_mfma_f32_16x16x32_bf16 v[156:159], v[80:83], a[56:59], v[156:159]
    v_mfma_f32_16x16x32_bf16 v[164:167], v[80:83], a[80:83], v[164:167]
    v_mfma_f32_16x16x32_bf16 v[136:139], v[60:63], a[12:15], v[136:139]
    v_mfma_f32_16x16x32_bf16 v[144:147], v[60:63], a[36:39], v[144:147]
    v_mfma_f32_16x16x32_bf16 v[152:155], v[60:63], a[60:63], v[152:155]
    v_mfma_f32_16x16x32_bf16 v[160:163], v[60:63], a[84:87], v[160:163]
    v_mfma_f32_16x16x32_bf16 v[140:143], v[84:87], a[12:15], v[140:143]
    v_mfma_f32_16x16x32_bf16 v[148:151], v[84:87], a[36:39], v[148:151]
    v_mfma_f32_16x16x32_bf16 v[156:159], v[84:87], a[60:63], v[156:159]
    v_mfma_f32_16x16x32_bf16 v[164:167], v[84:87], a[84:87], v[164:167]
    v_mfma_f32_16x16x32_bf16 v[136:139], v[64:67], a[16:19], v[136:139]
    v_mfma_f32_16x16x32_bf16 v[144:147], v[64:67], a[40:43], v[144:147]
    v_mfma_f32_16x16x32_bf16 v[152:155], v[64:67], a[64:67], v[152:155]
    v_mfma_f32_16x16x32_bf16 v[160:163], v[64:67], a[88:91], v[160:163]
    v_mfma_f32_16x16x32_bf16 v[140:143], v[88:91], a[16:19], v[140:143]
    v_mfma_f32_16x16x32_bf16 v[148:151], v[88:91], a[40:43], v[148:151]
    v_mfma_f32_16x16x32_bf16 v[156:159], v[88:91], a[64:67], v[156:159]
    v_mfma_f32_16x16x32_bf16 v[164:167], v[88:91], a[88:91], v[164:167]
    v_mfma_f32_16x16x32_bf16 v[136:139], v[68:71], a[20:23], v[136:139]
    v_mfma_f32_16x16x32_bf16 v[144:147], v[68:71], a[44:47], v[144:147]
    v_mfma_f32_16x16x32_bf16 v[152:155], v[68:71], a[68:71], v[152:155]
    v_mfma_f32_16x16x32_bf16 v[160:163], v[68:71], a[92:95], v[160:163]
    v_mfma_f32_16x16x32_bf16 v[140:143], v[92:95], a[20:23], v[140:143]
    v_mfma_f32_16x16x32_bf16 v[148:151], v[92:95], a[44:47], v[148:151]
    v_mfma_f32_16x16x32_bf16 v[156:159], v[92:95], a[68:71], v[156:159]
    v_mfma_f32_16x16x32_bf16 v[164:167], v[92:95], a[92:95], v[164:167]
    v_cvt_pk_bf16_f32 v168, v136, v137
    v_cvt_pk_bf16_f32 v169, v140, v141
    v_cvt_pk_bf16_f32 v170, v138, v139
    v_cvt_pk_bf16_f32 v171, v142, v143
    ds_write_b128 v3, v[168:171] offset:0
    v_cvt_pk_bf16_f32 v172, v144, v145
    v_cvt_pk_bf16_f32 v173, v148, v149
    v_cvt_pk_bf16_f32 v174, v146, v147
    v_cvt_pk_bf16_f32 v175, v150, v151
    ds_write_b128 v3, v[172:175] offset:4096
    v_cvt_pk_bf16_f32 v176, v152, v153
    v_cvt_pk_bf16_f32 v177, v156, v157
    v_cvt_pk_bf16_f32 v178, v154, v155
    v_cvt_pk_bf16_f32 v179, v158, v159
    ds_write_b128 v3, v[176:179] offset:8192
    v_cvt_pk_bf16_f32 v180, v160, v161
    v_cvt_pk_bf16_f32 v181, v164, v165
    v_cvt_pk_bf16_f32 v182, v162, v163
    v_cvt_pk_bf16_f32 v183, v166, v167
    ds_write_b128 v3, v[180:183] offset:12288
    s_and_b32 s28, s21, 3
    s_lshl_b32 s4, s28, 14
    v_add_u32 v192, s4, v194
    s_lshl_b32 s4, s28, 13
    v_add_u32 v13, s4, v195
    v_add_u32 v10, s4, v196
    v_xor_b32 v0, 32768, v192
    v_xor_b32 v193, 16384, v13
    s_mul_i32 s4, s28, 12288
    s_add_u32 s38, s4, s29
    s_mul_i32 s4, s28, 16384
    s_add_u32 s39, s4, s32
    s_mul_i32 s4, s28, 10240
    s_add_u32 s25, s4, s22
    s_xor_b32 s4, s28, 2
    s_mul_i32 s4, s4, 10240
    s_add_u32 s26, s4, s22
    s_add_u32 s4, s21, 1
    v_mov_b32 v228, s4
    v_mov_b32 v96, 0
    v_mov_b32 v97, 0
    v_mov_b32 v98, 0
    v_mov_b32 v99, 0
    v_mov_b32 v100, 0
    v_mov_b32 v101, 0
    v_mov_b32 v102, 0
    v_mov_b32 v103, 0
    v_mov_b32 v104, 0
    v_mov_b32 v105, 0
    v_mov_b32 v106, 0
    v_mov_b32 v107, 0
    v_mov_b32 v108, 0
    v_mov_b32 v109, 0
    v_mov_b32 v110, 0
    v_mov_b32 v111, 0
    s_waitcnt lgkmcnt(0)
    s_barrier
    s_mul_i32 s4, s28, 163840
    s_add_u32 s35, s4, 2097152
    s_add_u32 s4, s28, 1
    s_and_b32 s4, s4, 3
    s_lshl_b32 s4, s4, 14
    v_add_u32 v3, s4, v197
    s_add_u32 s46, s21, 3
    s_min_u32 s46, s46, 64
    s_mov_b32 s47, s21
    s_add_u32 s4, s46, 3
    s_and_b32 s4, s4, 3
    s_mul_i32 s4, s4, 49152
    s_add_u32 s40, s4, s27
    s_add_u32 s41, s40, 4096
    s_add_u32 s42, s40, 8192
    s_add_u32 s23, s36, s92
    s_mov_b32 m0, s93
    s_add_u32 s36, s36, 65536
    s_and_b32 s36, s36, 262143
    ds_read_b128 v[120:123], v192 offset:0
    ds_read_b128 v[124:127], v192 offset:1024
    ds_read_b128 v[128:131], v192 offset:2048
    ds_read_b128 v[132:135], v192 offset:3072
Cf_loop:
    s_add_u32 s21, s21, 1
    buffer_load_dword v45, v247, s[8:11], s22 offen offset:0 sc1
    buffer_load_dword v46, v248, s[8:11], s22 offen offset:0 sc1
    s_cmp_lg_u32 s3, 0
    s_cbranch_scc1 Cfl_o
    buffer_load_dword v47, v4, s[8:11], s22 offen offset:0 sc1
    s_nop 12
    buffer_load_dword v47, v4, s[8:11], s22 offen offset:0 sc1
    s_nop 12
    s_mov_b32 s31, -1
Cfl_l:
    buffer_load_dword v47, v4, s[8:11], s22 offen offset:0 sc1
    s_add_u32 s31, s31, 1
    s_cmp_lt_u32 s31, s30
    s_cselect_b32 s30, s30, 1
    s_cbranch_scc0 Cfl_o
    s_waitcnt vmcnt(2)
    v_cmp_gt_u32 vcc, s21, v47
    s_cbranch_vccnz Cfl_l
Cfl_o:
    s_barrier
    buffer_load_dwordx4 v[16:19], v2, s[8:11], s38 offen offset:0 sc1
    buffer_load_dwordx4 v[20:23], v2, s[8:11], s38 offen offset:1024 sc1
    buffer_load_dwordx4 v[24:27], v2, s[8:11], s38 offen offset:2048 sc1
    s_waitcnt vmcnt(3)
    v_cmp_gt_u32 vcc, s46, v45
    v_cmp_gt_u32 s[6:7], s47, v46
    s_or_b64 s[88:89], vcc, s[6:7]
Cfm_b:
    s_waitcnt vmcnt(2)
    v_smfmac_f32_16x16x64_bf16 v[96:99], v[16:19], a[0:7], v5
    buffer_load_dwordx4 v[28:31], v2, s[8:11], s39 offen offset:0 sc1
    v_smfmac_f32_16x16x64_bf16 v[100:103], v[16:19], a[24:31], v5
    buffer_load_dwordx4 v[32:35], v2, s[8:11], s39 offen offset:1024 sc1
    v_smfmac_f32_16x16x64_bf16 v[104:107], v[16:19], a[48:55], v5
    buffer_load_dwordx4 v[36:39], v2, s[8:11], s39 offen offset:2048 sc1
    v_smfmac_f32_16x16x64_bf16 v[108:111], v[16:19], a[72:79], v5
    buffer_load_dwordx3 v[40:42], v2, s[8:11], s39 offen offset:3072 sc1
    s_waitcnt vmcnt(5)
    v_smfmac_f32_16x16x64_bf16 v[96:99], v[20:23], a[8:15], v5
    v_smfmac_f32_16x16x64_bf16 v[100:103], v[20:23], a[32:39], v5
    v_smfmac_f32_16x16x64_bf16 v[104:107], v[20:23], a[56:63], v5
    v_smfmac_f32_16x16x64_bf16 v[108:111], v[20:23], a[80:87], v5
    s_waitcnt vmcnt(4)
    v_smfmac_f32_16x16x64_bf16 v[96:99], v[24:27], a[16:23], v5
    v_max3_u32 v251, v16, v18, v20
    v_smfmac_f32_16x16x64_bf16 v[100:103], v[24:27], a[40:47], v5
    v_max3_u32 v251, v251, v22, v24
    v_smfmac_f32_16x16x64_bf16 v[104:107], v[24:27], a[64:71], v5
    v_max_u32 v251, v251, v26
    v_smfmac_f32_16x16x64_bf16 v[108:111], v[24:27], a[88:95], v5
    v_cmp_eq_u32 vcc, -1, v251
    v_cvt_pk_bf16_f32 v112, v96, v97
    v_cvt_pk_bf16_f32 v113, v98, v99
    s_cbranch_vccnz Cfm_s
    ds_write_b64 v10, v[112:113] offset:0
    v_cvt_pk_bf16_f32 v114, v100, v101
    v_cvt_pk_bf16_f32 v115, v102, v103
    ds_write_b64 v10, v[114:115] offset:2048
    v_cvt_pk_bf16_f32 v116, v104, v105
    v_cvt_pk_bf16_f32 v117, v106, v107
    ds_write_b64 v10, v[116:117] offset:4096
    v_cvt_pk_bf16_f32 v118, v108, v109
    v_cvt_pk_bf16_f32 v119, v110, v111
    ds_write_b64 v10, v[118:119] offset:6144
    s_cmp_eq_u32 s21, 64
    s_cbranch_scc1 Cf_end
    s_cmp_lg_u64 s[88:89], 0
    s_cbranch_scc1 Cf_fw
Cf_fo:
    buffer_load_dwordx4 v2, s[8:11], s23 offen offset:0 sc1 lds
    buffer_load_dwordx4 v2, s[8:11], s23 offen offset:1024 sc1 lds
    buffer_load_dwordx4 v2, s[8:11], s23 offen offset:2048 sc1 lds
    s_waitcnt vmcnt(3)
Cfs_b:
    v_max3_u32 v250, v28, v32, v36
    v_pk_add_f32 v[28:29], v[28:29], v[32:33]
    v_pk_add_f32 v[30:31], v[30:31], v[34:35]
    v_max3_u32 v251, v40, v41, v42
    v_add_f32 v40, v40, v41
    v_pk_add_f32 v[28:29], v[28:29], v[36:37]
    v_pk_add_f32 v[30:31], v[30:31], v[38:39]
    v_add_f32 v40, v40, v42
    v_max3_f32 v43, v28, v29, v30
    v_max3_f32 v43, v43, v31, v40
    v_max_u32 v250, v250, v251
    v_cmp_eq_u32 vcc, -1, v250
    v_max_f32 v43, v43, v43 quad_perm:[1,0,3,2] row_mask:0xf bank_mask:0xf
    v_mul_f32 v28, s49, v28
    v_mul_f32 v29, s49, v29
    v_max_f32 v43, v43, v43 quad_perm:[2,3,0,1] row_mask:0xf bank_mask:0xf
    v_mul_f32 v30, s49, v30
    v_mul_f32 v31, s49, v31
    v_max_f32 v43, v43, v43 row_half_mirror row_mask:0xf bank_mask:0xf
    v_mul_f32 v40, s49, v40
    s_cbranch_vccnz Cfs_s
    v_mul_f32 v43, s49, v43
    v_sub_f32 v28, v28, v43
    v_sub_f32 v29, v29, v43
    v_sub_f32 v30, v30, v43
    v_sub_f32 v31, v31, v43
    v_sub_f32 v40, v40, v43
    v_exp_f32 v28, v28
    v_exp_f32 v29, v29
    v_exp_f32 v30, v30
    v_exp_f32 v31, v31
    v_exp_f32 v40, v40
    v_add_f32 v43, v28, v29
    v_add_f32 v44, v30, v31
    v_add_f32 v43, v43, v44
    v_add_f32 v43, v43, v40
    s_nop 1
    v_add_f32 v43, v43, v43 quad_perm:[1,0,3,2] row_mask:0xf bank_mask:0xf
    s_nop 1
    v_add_f32 v43, v43, v43 quad_perm:[2,3,0,1] row_mask:0xf bank_mask:0xf
    s_nop 1
    v_add_f32 v43, v43, v43 row_half_mirror row_mask:0xf bank_mask:0xf
    v_rcp_f32 v43, v43
    s_mov_b64 exec, s[44:45]
    buffer_store_dword v228, v198, s[8:11], s24 offen offset:0 sc1
    s_mov_b64 exec, -1
    v_mul_f32 v28, v28, v43
    v_mul_f32 v29, v29, v43
    v_mul_f32 v30, v30, v43
    v_mul_f32 v31, v31, v43
    v_mul_f32 v40, v40, v43
    v_cvt_pk_bf16_f32 v28, v28, v29
    v_cvt_pk_bf16_f32 v29, v30, v31
    v_cvt_pk_bf16_f32 v30, v40, v40
    ds_write2_b32 v11, v28, v29 offset0:0 offset1:2
    ds_write_b16 v244, v30
    s_waitcnt lgkmcnt(0)
    s_barrier
    ds_read_b128 v[168:171], v14 offset:0
    ds_read_b128 v[172:175], v14 offset:768
    ds_read_b128 v[176:179], v14 offset:1536
    ds_read_b128 v[180:183], v14 offset:2304
    ds_read_b128 v[184:187], v15 offset:0
    ds_read_b128 v[112:115], v13 offset:0
    ds_read_b128 v[188:191], v15 offset:256
    ds_read_b128 v[116:119], v13 offset:1024
    s_waitcnt lgkmcnt(7)
    v_mfma_f32_16x16x32_bf16 v[200:203], v[120:123], v[168:171], 0
    s_waitcnt lgkmcnt(6)
    v_mfma_f32_16x16x32_bf16 v[200:203], v[124:127], v[172:175], v[200:203]
    s_waitcnt lgkmcnt(5)
    v_mfma_f32_16x16x32_bf16 v[200:203], v[128:131], v[176:179], v[200:203]
    s_waitcnt lgkmcnt(4)
    v_mfma_f32_16x16x32_bf16 v[200:203], v[132:135], v[180:183], v[200:203]
    s_waitcnt lgkmcnt(2)
    v_mfma_f32_16x16x32_bf16 v[200:203], v[112:115], v[184:187], v[200:203]
    s_waitcnt lgkmcnt(0)
    v_mfma_f32_16x16x32_bf16 v[200:203], v[116:119], v[188:191], v[200:203]
    s_load_dword s84, s[8:9], s37 glc
    s_load_dword s85, s[8:9], s43 glc
    s_nop 5
    v_cvt_pk_bf16_f32 v200, v200, v201
    v_cvt_pk_bf16_f32 v201, v202, v203
    buffer_store_dwordx2 v[200:201], v7, s[8:11], s35 offen offset:0 sc1
    s_cmp_eq_u32 s21, 1
    s_cbranch_scc1 Cf_v1
Cf_v1r:
    v_mfma_f32_16x16x32_bf16 v[136:139], v[48:51], a[0:3], 0
    v_mfma_f32_16x16x32_bf16 v[144:147], v[48:51], a[24:27], 0
    v_mfma_f32_16x16x32_bf16 v[152:155], v[48:51], a[48:51], 0
    s_and_b32 s28, s21, 3
    s_lshl_b32 s4, s28, 14
    v_mfma_f32_16x16x32_bf16 v[160:163], v[48:51], a[72:75], 0
    v_add_u32 v192, s4, v194
    s_lshl_b32 s4, s28, 13
    v_mfma_f32_16x16x32_bf16 v[140:143], v[72:75], a[0:3], 0
    v_add_u32 v13, s4, v195
    v_add_u32 v10, s4, v196
    v_mfma_f32_16x16x32_bf16 v[148:151], v[72:75], a[24:27], 0
    v_xor_b32 v0, 32768, v192
    v_xor_b32 v193, 16384, v13
    v_mfma_f32_16x16x32_bf16 v[156:159], v[72:75], a[48:51], 0
    s_load_dword s84, s[8:9], s37 glc
    s_load_dword s85, s[8:9], s43 glc
    v_mfma_f32_16x16x32_bf16 v[164:167], v[72:75], a[72:75], 0
    s_mul_i32 s4, s28, 12288
    s_add_u32 s38, s4, s29
    v_mfma_f32_16x16x32_bf16 v[136:139], v[52:55], a[4:7], v[136:139]
    s_mul_i32 s4, s28, 16384
    s_add_u32 s39, s4, s32
    v_mfma_f32_16x16x32_bf16 v[144:147], v[52:55], a[28:31], v[144:147]
    s_mul_i32 s4, s28, 10240
    s_add_u32 s25, s4, s22
    v_mfma_f32_16x16x32_bf16 v[152:155], v[52:55], a[52:55], v[152:155]
    s_xor_b32 s4, s28, 2
    s_mul_i32 s4, s4, 10240
    v_mfma_f32_16x16x32_bf16 v[160:163], v[52:55], a[76:79], v[160:163]
    s_add_u32 s26, s4, s22
    s_add_u32 s4, s21, 1
    v_mfma_f32_16x16x32_bf16 v[140:143], v[76:79], a[4:7], v[140:143]
    v_mov_b32 v228, s4
    v_mov_b32 v96, 0
    v_mfma_f32_16x16x32_bf16 v[148:151], v[76:79], a[28:31], v[148:151]
    v_mov_b32 v97, 0
    v_mov_b32 v98, 0
    v_mfma_f32_16x16x32_bf16 v[156:159], v[76:79], a[52:55], v[156:159]
    s_or_b64 s[6:7], s[84:85], s[94:95]
    s_min_u32 s6, s6, s7
    s_cmp_ge_u32 s6, s21
    s_cbranch_scc0 Cfg_s
Cfg_o:
    s_barrier
    buffer_load_dwordx4 v[204:207], v8, s[8:11], s35 offen offset:0 sc1
    buffer_load_dwordx4 v[208:211], v8, s[8:11], s35 offen offset:1024 sc1
    v_mfma_f32_16x16x32_bf16 v[164:167], v[76:79], a[76:79], v[164:167]
    v_mov_b32 v99, 0
    v_mov_b32 v100, 0
    v_mfma_f32_16x16x32_bf16 v[136:139], v[56:59], a[8:11], v[136:139]
    buffer_store_dwordx2 v[232:233], v12, s[8:11], s34 offen offset:0 sc1
    buffer_store_dwordx2 v[234:235], v12, s[8:11], s34 offen offset:512 sc1
    s_add_u32 s34, s34, 524288
    s_and_b32 s6, s34, 1572864
    s_cselect_b32 s6, 0, 8192
    s_xor_b32 s34, s34, s6
    v_mfma_f32_16x16x32_bf16 v[144:147], v[56:59], a[32:35], v[144:147]
    v_mov_b32 v101, 0
    v_mov_b32 v102, 0
    v_mfma_f32_16x16x32_bf16 v[152:155], v[56:59], a[56:59], v[152:155]
    v_mov_b32 v103, 0
    v_mov_b32 v104, 0
    v_mfma_f32_16x16x32_bf16 v[160:163], v[56:59], a[80:83], v[160:163]
    v_mov_b32 v105, 0
    v_mov_b32 v106, 0
    v_mfma_f32_16x16x32_bf16 v[140:143], v[80:83], a[8:11], v[140:143]
    v_mov_b32 v107, 0
    v_mov_b32 v108, 0
    v_mfma_f32_16x16x32_bf16 v[148:151], v[80:83], a[32:35], v[148:151]
    v_mov_b32 v109, 0
    v_mov_b32 v110, 0
    v_mfma_f32_16x16x32_bf16 v[156:159], v[80:83], a[56:59], v[156:159]
    v_mov_b32 v111, 0
    v_mfma_f32_16x16x32_bf16 v[164:167], v[80:83], a[80:83], v[164:167]
    v_mfma_f32_16x16x32_bf16 v[136:139], v[60:63], a[12:15], v[136:139]
    v_mfma_f32_16x16x32_bf16 v[144:147], v[60:63], a[36:39], v[144:147]
    v_mfma_f32_16x16x32_bf16 v[152:155], v[60:63], a[60:63], v[152:155]
    v_mfma_f32_16x16x32_bf16 v[160:163], v[60:63], a[84:87], v[160:163]
    v_mfma_f32_16x16x32_bf16 v[140:143], v[84:87], a[12:15], v[140:143]
    v_mfma_f32_16x16x32_bf16 v[148:151], v[84:87], a[36:39], v[148:151]
    v_mfma_f32_16x16x32_bf16 v[156:159], v[84:87], a[60:63], v[156:159]
    v_mfma_f32_16x16x32_bf16 v[164:167], v[84:87], a[84:87], v[164:167]
    v_mfma_f32_16x16x32_bf16 v[136:139], v[64:67], a[16:19], v[136:139]
    v_mfma_f32_16x16x32_bf16 v[144:147], v[64:67], a[40:43], v[144:147]
    v_mfma_f32_16x16x32_bf16 v[152:155], v[64:67], a[64:67], v[152:155]
    v_mfma_f32_16x16x32_bf16 v[160:163], v[64:67], a[88:91], v[160:163]
    v_mfma_f32_16x16x32_bf16 v[140:143], v[88:91], a[16:19], v[140:143]
    v_mfma_f32_16x16x32_bf16 v[148:151], v[88:91], a[40:43], v[148:151]
    v_mfma_f32_16x16x32_bf16 v[156:159], v[88:91], a[64:67], v[156:159]
    v_mfma_f32_16x16x32_bf16 v[164:167], v[88:91], a[88:91], v[164:167]
    s_waitcnt vmcnt(2)
    v_mfma_f32_16x16x32_bf16 v[32:35], v[224:227], v[204:207], 0
    v_max3_u32 v36, v204, v206, v208
    v_mfma_f32_16x16x32_bf16 v[32:35], v[224:227], v[208:211], v[32:35]
    v_max_u32 v36, v36, v210
    v_cmp_eq_u32 vcc, -1, v36
    s_cbranch_vccnz Cf4_s
Cf4_o:
    s_nop 4
    v_cvt_pk_bf16_f32 v38, v32, v33
    v_cvt_pk_bf16_f32 v39, v34, v35
Cf4_z:
    buffer_store_dwordx2 v[38:39], v222, s[8:11], s25 offen offset:0
    v_mfma_f32_16x16x32_bf16 v[136:139], v[68:71], a[20:23], v[136:139]
    v_mfma_f32_16x16x32_bf16 v[144:147], v[68:71], a[44:47], v[144:147]
    v_mfma_f32_16x16x32_bf16 v[152:155], v[68:71], a[68:71], v[152:155]
    v_mfma_f32_16x16x32_bf16 v[160:163], v[68:71], a[92:95], v[160:163]
    v_mfma_f32_16x16x32_bf16 v[140:143], v[92:95], a[20:23], v[140:143]
    v_mfma_f32_16x16x32_bf16 v[148:151], v[92:95], a[44:47], v[148:151]
    v_mfma_f32_16x16x32_bf16 v[156:159], v[92:95], a[68:71], v[156:159]
    v_mfma_f32_16x16x32_bf16 v[164:167], v[92:95], a[92:95], v[164:167]
    v_cvt_pk_bf16_f32 v168, v136, v137
    v_cvt_pk_bf16_f32 v169, v140, v141
    v_cvt_pk_bf16_f32 v170, v138, v139
    v_cvt_pk_bf16_f32 v171, v142, v143
    ds_write_b128 v3, v[168:171] offset:0
    v_cvt_pk_bf16_f32 v172, v144, v145
    v_cvt_pk_bf16_f32 v173, v148, v149
    v_cvt_pk_bf16_f32 v174, v146, v147
    v_cvt_pk_bf16_f32 v175, v150, v151
    ds_write_b128 v3, v[172:175] offset:4096
    buffer_load_dwordx4 v[48:51], v2, s[8:11], s40 offen offset:0 sc1
    v_cvt_pk_bf16_f32 v176, v152, v153
    v_cvt_pk_bf16_f32 v177, v156, v157
    buffer_load_dwordx4 v[72:75], v2, s[8:11], s41 offen offset:2048 sc1
    v_cvt_pk_bf16_f32 v178, v154, v155
    v_cvt_pk_bf16_f32 v179, v158, v159
    buffer_load_dwordx4 v[52:55], v2, s[8:11], s40 offen offset:1024 sc1
    ds_write_b128 v3, v[176:179] offset:8192
    v_cvt_pk_bf16_f32 v180, v160, v161
    buffer_load_dwordx4 v[76:79], v2, s[8:11], s41 offen offset:3072 sc1
    v_cvt_pk_bf16_f32 v181, v164, v165
    v_cvt_pk_bf16_f32 v182, v162, v163
    buffer_load_dwordx4 v[56:59], v2, s[8:11], s40 offen offset:2048 sc1
    v_cvt_pk_bf16_f32 v183, v166, v167
    ds_write_b128 v3, v[180:183] offset:12288
    buffer_load_dwordx4 v[80:83], v2, s[8:11], s42 offen offset:0 sc1
    s_waitcnt lgkmcnt(0)
    s_barrier
    ds_read_b128 v[168:171], v0 offset:0
    ds_read_b128 v[136:139], v246 offset:0
    ds_read_b128 v[140:143], v246 offset:1024
    ds_read_b128 v[172:175], v0 offset:1024
    ds_read_b128 v[144:147], v246 offset:2048
    ds_read_b128 v[148:151], v246 offset:3072
    ds_read_b128 v[176:179], v0 offset:2048
    ds_read_b128 v[152:155], v246 offset:4096
    ds_read_b128 v[156:159], v246 offset:5120
    ds_read_b128 v[180:183], v0 offset:3072
    ds_read_b128 v[160:163], v246 offset:6144
    ds_read_b128 v[164:167], v246 offset:7168
    s_waitcnt lgkmcnt(10)
    v_mfma_f32_16x16x32_bf16 v[236:239], v[168:171], v[136:139], 0
    ds_read_b128 v[184:187], v193 offset:0
    buffer_load_dwordx4 v[60:63], v2, s[8:11], s40 offen offset:3072 sc1
    s_waitcnt lgkmcnt(10)
    v_mfma_f32_16x16x32_bf16 v[252:255], v[168:171], v[140:143], 0
    ds_read_b128 v[16:19], v245 offset:0
    buffer_load_dwordx4 v[84:87], v2, s[8:11], s42 offen offset:1024 sc1
    s_waitcnt lgkmcnt(9)
    v_mfma_f32_16x16x32_bf16 v[236:239], v[172:175], v[144:147], v[236:239]
    ds_read_b128 v[20:23], v245 offset:512
    buffer_load_dwordx4 v[64:67], v2, s[8:11], s41 offen offset:0 sc1
    s_waitcnt lgkmcnt(9)
    v_mfma_f32_16x16x32_bf16 v[252:255], v[172:175], v[148:151], v[252:255]
    ds_read_b128 v[188:191], v193 offset:1024
    buffer_load_dwordx4 v[88:91], v2, s[8:11], s42 offen offset:2048 sc1
    s_waitcnt lgkmcnt(8)
    v_mfma_f32_16x16x32_bf16 v[236:239], v[176:179], v[152:155], v[236:239]
    ds_read_b128 v[24:27], v245 offset:1024
    buffer_load_dwordx4 v[68:71], v2, s[8:11], s41 offen offset:1024 sc1
    s_waitcnt lgkmcnt(8)
    v_mfma_f32_16x16x32_bf16 v[252:255], v[176:179], v[156:159], v[252:255]
    ds_read_b128 v[28:31], v245 offset:1536
    buffer_load_dwordx4 v[92:95], v2, s[8:11], s42 offen offset:3072 sc1
    s_waitcnt lgkmcnt(7)
    v_mfma_f32_16x16x32_bf16 v[236:239], v[180:183], v[160:163], v[236:239]
    s_waitcnt lgkmcnt(6)
    v_mfma_f32_16x16x32_bf16 v[252:255], v[180:183], v[164:167], v[252:255]
    s_waitcnt lgkmcnt(4)
    v_mfma_f32_16x16x32_bf16 v[236:239], v[184:187], v[16:19], v[236:239]
    s_waitcnt lgkmcnt(3)
    v_mfma_f32_16x16x32_bf16 v[252:255], v[184:187], v[20:23], v[252:255]
    s_waitcnt lgkmcnt(1)
    v_mfma_f32_16x16x32_bf16 v[236:239], v[188:191], v[24:27], v[236:239]
    s_waitcnt lgkmcnt(0)
    v_mfma_f32_16x16x32_bf16 v[252:255], v[188:191], v[28:31], v[252:255]
    s_nop 3
    v_cvt_pk_bf16_f32 v232, v236, v237
    v_cvt_pk_bf16_f32 v233, v238, v239
    s_nop 1
    v_cvt_pk_bf16_f32 v234, v252, v253
    v_cvt_pk_bf16_f32 v235, v254, v255
    buffer_store_dwordx2 v[240:241], v6, s[8:11], s26 offen offset:0
    s_mul_i32 s4, s28, 163840
    s_add_u32 s35, s4, 2097152
    s_add_u32 s4, s28, 1
    s_and_b32 s4, s4, 3
    s_lshl_b32 s4, s4, 14
    v_add_u32 v3, s4, v197
    s_add_u32 s46, s21, 3
    s_min_u32 s46, s46, 64
    s_mov_b32 s47, s21
    s_add_u32 s4, s46, 3
    s_and_b32 s4, s4, 3
    s_mul_i32 s4, s4, 49152
    s_add_u32 s40, s4, s27
    s_add_u32 s41, s40, 4096
    s_add_u32 s42, s40, 8192
    s_add_u32 s23, s36, s92
    s_mov_b32 m0, s93
    s_add_u32 s36, s36, 65536
    s_and_b32 s36, s36, 262143
    ds_read_b128 v[120:123], v192 offset:0
    ds_read_b128 v[124:127], v192 offset:1024
    ds_read_b128 v[128:131], v192 offset:2048
    ds_read_b128 v[132:135], v192 offset:3072
    s_branch Cf_loop
Cf_end:
    buffer_store_dwordx2 v[232:233], v12, s[8:11], s34 offen offset:0 sc1
    buffer_store_dwordx2 v[234:235], v12, s[8:11], s34 offen offset:512 sc1
    s_add_u32 s34, s34, 524288
    s_and_b32 s6, s34, 1572864
    s_cselect_b32 s6, 0, 8192
    s_xor_b32 s34, s34, s6
    v_mov_b32 v10, 61
    s_mov_b64 exec, 1
    buffer_store_dword v10, v9, s[8:11], s33 offen
    s_mov_b64 exec, -1
    s_barrier
    s_mov_b32 s31, 0
Cfx1_l:
    buffer_load_dword v250, v248, s[8:11], s22 offen sc1
    s_waitcnt vmcnt(0)
Cfx1_c:
    v_cmp_gt_u32 vcc, 63, v250
    s_cbranch_vccz Cfx1_o
    s_sleep 1
    s_add_u32 s31, s31, 1
    s_cmp_lt_u32 s31, s30
    s_cbranch_scc1 Cfx1_l
    s_mov_b32 s30, 1
Cfx1_o:
    buffer_load_dwordx4 v2, s[8:11], s23 offen offset:0 sc1 lds
    buffer_load_dwordx4 v2, s[8:11], s23 offen offset:1024 sc1 lds
    buffer_load_dwordx4 v2, s[8:11], s23 offen offset:2048 sc1 lds
    v_add_u32 v0, 32768, v194
    v_add_u32 v193, 16384, v195
    s_waitcnt vmcnt(0) lgkmcnt(0)
    s_barrier
    ds_read_b128 v[168:171], v0 offset:0
    ds_read_b128 v[136:139], v246 offset:0
    ds_read_b128 v[140:143], v246 offset:1024
    ds_read_b128 v[172:175], v0 offset:1024
    ds_read_b128 v[144:147], v246 offset:2048
    ds_read_b128 v[148:151], v246 offset:3072
    ds_read_b128 v[176:179], v0 offset:2048
    ds_read_b128 v[152:155], v246 offset:4096
    ds_read_b128 v[156:159], v246 offset:5120
    ds_read_b128 v[180:183], v0 offset:3072
    ds_read_b128 v[160:163], v246 offset:6144
    ds_read_b128 v[164:167], v246 offset:7168
    s_waitcnt lgkmcnt(10)
    v_mfma_f32_16x16x32_bf16 v[236:239], v[168:171], v[136:139], 0
    ds_read_b128 v[184:187], v193 offset:0
    s_waitcnt lgkmcnt(10)
    v_mfma_f32_16x16x32_bf16 v[252:255], v[168:171], v[140:143], 0
    ds_read_b128 v[16:19], v245 offset:0
    s_waitcnt lgkmcnt(9)
    v_mfma_f32_16x16x32_bf16 v[236:239], v[172:175], v[144:147], v[236:239]
    ds_read_b128 v[20:23], v245 offset:512
    s_waitcnt lgkmcnt(9)
    v_mfma_f32_16x16x32_bf16 v[252:255], v[172:175], v[148:151], v[252:255]
    ds_read_b128 v[188:191], v193 offset:1024
    s_waitcnt lgkmcnt(8)
    v_mfma_f32_16x16x32_bf16 v[236:239], v[176:179], v[152:155], v[236:239]
    ds_read_b128 v[24:27], v245 offset:1024
    s_waitcnt lgkmcnt(8)
    v_mfma_f32_16x16x32_bf16 v[252:255], v[176:179], v[156:159], v[252:255]
    ds_read_b128 v[28:31], v245 offset:1536
    s_waitcnt lgkmcnt(7)
    v_mfma_f32_16x16x32_bf16 v[236:239], v[180:183], v[160:163], v[236:239]
    s_waitcnt lgkmcnt(6)
    v_mfma_f32_16x16x32_bf16 v[252:255], v[180:183], v[164:167], v[252:255]
    s_waitcnt lgkmcnt(4)
    v_mfma_f32_16x16x32_bf16 v[236:239], v[184:187], v[16:19], v[236:239]
    s_waitcnt lgkmcnt(3)
    v_mfma_f32_16x16x32_bf16 v[252:255], v[184:187], v[20:23], v[252:255]
    s_waitcnt lgkmcnt(1)
    v_mfma_f32_16x16x32_bf16 v[236:239], v[188:191], v[24:27], v[236:239]
    s_waitcnt lgkmcnt(0)
    v_mfma_f32_16x16x32_bf16 v[252:255], v[188:191], v[28:31], v[252:255]
    s_nop 3
    v_cvt_pk_bf16_f32 v232, v236, v237
    v_cvt_pk_bf16_f32 v233, v238, v239
    s_nop 1
    v_cvt_pk_bf16_f32 v234, v252, v253
    v_cvt_pk_bf16_f32 v235, v254, v255
    buffer_store_dwordx2 v[232:233], v12, s[8:11], s34 offen offset:0 sc1
    buffer_store_dwordx2 v[234:235], v12, s[8:11], s34 offen offset:512 sc1
    s_add_u32 s34, s34, 524288
    s_and_b32 s6, s34, 1572864
    s_cselect_b32 s6, 0, 8192
    s_xor_b32 s34, s34, s6
    v_mov_b32 v10, 62
    s_mov_b64 exec, 1
    buffer_store_dword v10, v9, s[8:11], s33 offen
    s_mov_b64 exec, -1
    s_barrier
    s_mov_b32 s31, 0
Cfx2_l:
    buffer_load_dword v250, v248, s[8:11], s22 offen sc1
    s_waitcnt vmcnt(0)
Cfx2_c:
    v_cmp_gt_u32 vcc, 64, v250
    s_cbranch_vccz Cfx2_o
    s_sleep 1
    s_add_u32 s31, s31, 1
    s_cmp_lt_u32 s31, s30
    s_cbranch_scc1 Cfx2_l
    s_mov_b32 s30, 1
Cfx2_o:
    s_add_u32 s23, s36, s92
    s_mov_b32 m0, s93
    s_add_u32 s36, s36, 65536
    s_and_b32 s36, s36, 262143
    buffer_load_dwordx4 v2, s[8:11], s23 offen offset:0 sc1 lds
    buffer_load_dwordx4 v2, s[8:11], s23 offen offset:1024 sc1 lds
    buffer_load_dwordx4 v2, s[8:11], s23 offen offset:2048 sc1 lds
    v_add_u32 v0, 49152, v194
    v_add_u32 v193, 24576, v195
    s_waitcnt vmcnt(0)
    s_barrier
    ds_read_b128 v[168:171], v0 offset:0
    ds_read_b128 v[136:139], v246 offset:0
    ds_read_b128 v[140:143], v246 offset:1024
    ds_read_b128 v[172:175], v0 offset:1024
    ds_read_b128 v[144:147], v246 offset:2048
    ds_read_b128 v[148:151], v246 offset:3072
    ds_read_b128 v[176:179], v0 offset:2048
    ds_read_b128 v[152:155], v246 offset:4096
    ds_read_b128 v[156:159], v246 offset:5120
    ds_read_b128 v[180:183], v0 offset:3072
    ds_read_b128 v[160:163], v246 offset:6144
    ds_read_b128 v[164:167], v246 offset:7168
    s_waitcnt lgkmcnt(10)
    v_mfma_f32_16x16x32_bf16 v[236:239], v[168:171], v[136:139], 0
    ds_read_b128 v[184:187], v193 offset:0
    s_waitcnt lgkmcnt(10)
    v_mfma_f32_16x16x32_bf16 v[252:255], v[168:171], v[140:143], 0
    ds_read_b128 v[16:19], v245 offset:0
    s_waitcnt lgkmcnt(9)
    v_mfma_f32_16x16x32_bf16 v[236:239], v[172:175], v[144:147], v[236:239]
    ds_read_b128 v[20:23], v245 offset:512
    s_waitcnt lgkmcnt(9)
    v_mfma_f32_16x16x32_bf16 v[252:255], v[172:175], v[148:151], v[252:255]
    ds_read_b128 v[188:191], v193 offset:1024
    s_waitcnt lgkmcnt(8)
    v_mfma_f32_16x16x32_bf16 v[236:239], v[176:179], v[152:155], v[236:239]
    ds_read_b128 v[24:27], v245 offset:1024
    s_waitcnt lgkmcnt(8)
    v_mfma_f32_16x16x32_bf16 v[252:255], v[176:179], v[156:159], v[252:255]
    ds_read_b128 v[28:31], v245 offset:1536
    s_waitcnt lgkmcnt(7)
    v_mfma_f32_16x16x32_bf16 v[236:239], v[180:183], v[160:163], v[236:239]
    s_waitcnt lgkmcnt(6)
    v_mfma_f32_16x16x32_bf16 v[252:255], v[180:183], v[164:167], v[252:255]
    s_waitcnt lgkmcnt(4)
    v_mfma_f32_16x16x32_bf16 v[236:239], v[184:187], v[16:19], v[236:239]
    s_waitcnt lgkmcnt(3)
    v_mfma_f32_16x16x32_bf16 v[252:255], v[184:187], v[20:23], v[252:255]
    s_waitcnt lgkmcnt(1)
    v_mfma_f32_16x16x32_bf16 v[236:239], v[188:191], v[24:27], v[236:239]
    s_waitcnt lgkmcnt(0)
    v_mfma_f32_16x16x32_bf16 v[252:255], v[188:191], v[28:31], v[252:255]
    s_nop 3
    v_cvt_pk_bf16_f32 v232, v236, v237
    v_cvt_pk_bf16_f32 v233, v238, v239
    s_nop 1
    v_cvt_pk_bf16_f32 v234, v252, v253
    v_cvt_pk_bf16_f32 v235, v254, v255
    buffer_store_dwordx2 v[232:233], v12, s[8:11], s34 offen offset:0 sc1
    buffer_store_dwordx2 v[234:235], v12, s[8:11], s34 offen offset:512 sc1
    s_add_u32 s34, s34, 524288
    s_and_b32 s6, s34, 1572864
    s_cselect_b32 s6, 0, 8192
    s_xor_b32 s34, s34, s6
    v_mov_b32 v10, 63
    s_mov_b64 exec, 1
    buffer_store_dword v10, v9, s[8:11], s33 offen
    s_mov_b64 exec, -1
    s_branch R_done
Cf_fw:
    s_mov_b32 s31, 0
Cffv_l:
    buffer_load_dword v250, v247, s[8:11], s22 offen sc1
    s_waitcnt vmcnt(0)
Cffv_c:
    v_cmp_gt_u32 vcc, s46, v250
    s_cbranch_vccz Cffv_o
    s_sleep 1
    s_add_u32 s31, s31, 1
    s_cmp_lt_u32 s31, s30
    s_cbranch_scc1 Cffv_l
    s_mov_b32 s30, 1
Cffv_o:
    s_mov_b32 s31, 0
Cffx_l:
    buffer_load_dword v250, v248, s[8:11], s22 offen sc1
    s_waitcnt vmcnt(0)
Cffx_c:
    v_cmp_gt_u32 vcc, s47, v250
    s_cbranch_vccz Cffx_o
    s_sleep 1
    s_add_u32 s31, s31, 1
    s_cmp_lt_u32 s31, s30
    s_cbranch_scc1 Cffx_l
    s_mov_b32 s30, 1
Cffx_o:
    s_branch Cf_fo
Cf_v1:
    s_mov_b32 s31, 0
Cfv3_l:
    buffer_load_dword v250, v247, s[8:11], s22 offen sc1
    s_waitcnt vmcnt(0)
Cfv3_c:
    v_cmp_gt_u32 vcc, 2, v250
    s_cbranch_vccz Cfv3_o
    s_sleep 1
    s_add_u32 s31, s31, 1
    s_cmp_lt_u32 s31, s30
    s_cbranch_scc1 Cfv3_l
    s_mov_b32 s30, 1
Cfv3_o:
    s_add_u32 s4, 2, 3
    s_and_b32 s4, s4, 3
    s_mul_i32 s4, s4, 49152
    s_add_u32 s40, s4, s27
    s_add_u32 s41, s40, 4096
    s_add_u32 s42, s40, 8192
    buffer_load_dwordx4 v[48:51], v2, s[8:11], s40 offen offset:0 sc1
    buffer_load_dwordx4 v[52:55], v2, s[8:11], s40 offen offset:1024 sc1
    buffer_load_dwordx4 v[56:59], v2, s[8:11], s40 offen offset:2048 sc1
    buffer_load_dwordx4 v[60:63], v2, s[8:11], s40 offen offset:3072 sc1
    buffer_load_dwordx4 v[64:67], v2, s[8:11], s41 offen offset:0 sc1
    buffer_load_dwordx4 v[68:71], v2, s[8:11], s41 offen offset:1024 sc1
    buffer_load_dwordx4 v[72:75], v2, s[8:11], s41 offen offset:2048 sc1
    buffer_load_dwordx4 v[76:79], v2, s[8:11], s41 offen offset:3072 sc1
    buffer_load_dwordx4 v[80:83], v2, s[8:11], s42 offen offset:0 sc1
    buffer_load_dwordx4 v[84:87], v2, s[8:11], s42 offen offset:1024 sc1
    buffer_load_dwordx4 v[88:91], v2, s[8:11], s42 offen offset:2048 sc1
    buffer_load_dwordx4 v[92:95], v2, s[8:11], s42 offen offset:3072 sc1
    s_add_u32 s4, s46, 3
    s_and_b32 s4, s4, 3
    s_mul_i32 s4, s4, 49152
    s_add_u32 s40, s4, s27
    s_add_u32 s41, s40, 4096
    s_add_u32 s42, s40, 8192
    s_waitcnt vmcnt(0)
    s_branch Cf_v1r
Cfm_s:
    s_mov_b32 s31, 0
Cfm_l:
    buffer_load_dwordx4 v[16:19], v2, s[8:11], s38 offen offset:0 sc1
    buffer_load_dwordx4 v[20:23], v2, s[8:11], s38 offen offset:1024 sc1
    buffer_load_dwordx4 v[24:27], v2, s[8:11], s38 offen offset:2048 sc1
    s_nop 7
    v_mov_b32 v96, 0
    v_mov_b32 v97, 0
    v_mov_b32 v98, 0
    v_mov_b32 v99, 0
    v_mov_b32 v100, 0
    v_mov_b32 v101, 0
    v_mov_b32 v102, 0
    v_mov_b32 v103, 0
    v_mov_b32 v104, 0
    v_mov_b32 v105, 0
    v_mov_b32 v106, 0
    v_mov_b32 v107, 0
    v_mov_b32 v108, 0
    v_mov_b32 v109, 0
    v_mov_b32 v110, 0
    v_mov_b32 v111, 0
    s_waitcnt vmcnt(0)
    v_max3_u32 v251, v16, v18, v20
    v_max3_u32 v251, v251, v22, v24
    v_max_u32 v251, v251, v26
    v_cmp_eq_u32 vcc, -1, v251
    s_cbranch_vccz Cfm_b
    s_add_u32 s31, s31, 1
    s_cmp_lt_u32 s31, s30
    s_cbranch_scc1 Cfm_l
    s_mov_b32 s30, 1
    v_min_u32 v16, s48, v16
    v_min_u32 v18, s48, v18
    v_min_u32 v20, s48, v20
    v_min_u32 v22, s48, v22
    v_min_u32 v24, s48, v24
    v_min_u32 v26, s48, v26
    s_branch Cfm_b
Cfg_s:
    s_mov_b32 s31, 0
Cfg_l:
    s_load_dword s84, s[8:9], s37 glc
    s_load_dword s85, s[8:9], s43 glc
    s_or_b64 s[6:7], s[84:85], s[94:95]
    s_min_u32 s6, s6, s7
    s_cmp_ge_u32 s6, s21
    s_cbranch_scc1 Cfg_o
    s_or_b64 s[6:7], s[84:85], s[94:95]
    s_min_u32 s6, s6, s7
    s_cmp_ge_u32 s6, s21
    s_cbranch_scc1 Cfg_o
    s_or_b64 s[6:7], s[84:85], s[94:95]
    s_min_u32 s6, s6, s7
    s_cmp_ge_u32 s6, s21
    s_cbranch_scc1 Cfg_o
    s_or_b64 s[6:7], s[84:85], s[94:95]
    s_min_u32 s6, s6, s7
    s_cmp_ge_u32 s6, s21
    s_cbranch_scc1 Cfg_o
    s_or_b64 s[6:7], s[84:85], s[94:95]
    s_min_u32 s6, s6, s7
    s_cmp_ge_u32 s6, s21
    s_cbranch_scc1 Cfg_o
    s_or_b64 s[6:7], s[84:85], s[94:95]
    s_min_u32 s6, s6, s7
    s_cmp_ge_u32 s6, s21
    s_cbranch_scc1 Cfg_o
    s_add_u32 s31, s31, 1
    s_cmp_lt_u32 s31, s30
    s_cbranch_scc1 Cfg_l
    s_mov_b32 s30, 1
    s_branch Cfg_o
Cf4_s:
    s_mov_b32 s31, 0
Cf4_l:
    buffer_load_dwordx4 v[204:207], v8, s[8:11], s35 offen offset:0 sc1
    buffer_load_dwordx4 v[208:211], v8, s[8:11], s35 offen offset:1024 sc1
    s_waitcnt vmcnt(0)
    v_mfma_f32_16x16x32_bf16 v[32:35], v[224:227], v[204:207], 0
    v_max3_u32 v36, v204, v206, v208
    v_mfma_f32_16x16x32_bf16 v[32:35], v[224:227], v[208:211], v[32:35]
    v_max_u32 v36, v36, v210
    v_cmp_eq_u32 vcc, -1, v36
    s_nop 7
    s_cbranch_vccz Cf4_o
    s_add_u32 s31, s31, 1
    s_cmp_lt_u32 s31, s30
    s_cbranch_scc1 Cf4_l
    s_mov_b32 s30, 1
    v_cvt_pk_bf16_f32 v38, v32, v33
    v_cvt_pk_bf16_f32 v39, v34, v35
    v_min_u32 v38, s48, v38
    v_min_u32 v39, s48, v39
    s_branch Cf4_z
Cfs_s:
    s_mov_b32 s31, 0
Cfs_l:
    buffer_load_dwordx4 v[28:31], v2, s[8:11], s39 offen offset:0 sc1
    buffer_load_dwordx4 v[32:35], v2, s[8:11], s39 offen offset:1024 sc1
    buffer_load_dwordx4 v[36:39], v2, s[8:11], s39 offen offset:2048 sc1
    buffer_load_dwordx3 v[40:42], v2, s[8:11], s39 offen offset:3072 sc1
    s_waitcnt vmcnt(0)
    v_max3_u32 v250, v28, v32, v36
    v_max3_u32 v250, v250, v40, v41
    v_max_u32 v250, v250, v42
    v_cmp_eq_u32 vcc, -1, v250
    s_cbranch_vccz Cfs_b
    s_add_u32 s31, s31, 1
    s_cmp_lt_u32 s31, s30
    s_cbranch_scc1 Cfs_l
    s_mov_b32 s30, 1
    v_min_u32 v28, s48, v28
    v_min_u32 v29, s48, v29
    v_min_u32 v30, s48, v30
    v_min_u32 v31, s48, v31
    v_min_u32 v32, s48, v32
    v_min_u32 v33, s48, v33
    v_min_u32 v34, s48, v34
    v_min_u32 v35, s48, v35
    v_min_u32 v36, s48, v36
    v_min_u32 v37, s48, v37
    v_min_u32 v38, s48, v38
    v_min_u32 v39, s48, v39
    v_min_u32 v40, s48, v40
    v_min_u32 v41, s48, v41
    v_min_u32 v42, s48, v42
    s_branch Cfs_b
Cs_go:
    s_lshl_b32 s4, s3, 12
    v_add_u32 v194, s4, v2
    s_lshl_b32 s4, s3, 11
    s_add_u32 s4, s4, 65536
    v_add_u32 v195, s4, v2
    s_lshr_b32 s4, s3, 1
    s_lshl_b32 s4, s4, 10
    s_and_b32 s5, s3, 1
    s_lshl_b32 s5, s5, 3
    s_add_u32 s4, s4, s5
    s_add_u32 s4, s4, 65536
    v_add_u32 v196, s4, v2
    s_lshl_b32 s4, s3, 10
    v_add_u32 v197, s4, v2
    v_mov_b32 v3, v197
    s_mul_i32 s4, s3, 3072
    s_min_u32 s4, s4, 7168
    s_add_u32 s92, s4, s22
    s_add_u32 s92, s92, 405504
    s_add_u32 s93, s4, 102400
    s_mov_b64 s[84:85], 0
    s_mov_b64 s[86:87], 0
    s_mov_b64 s[88:89], 0
    s_mov_b64 s[90:91], 0
    s_mul_i32 s4, s3, 3072
    s_add_u32 s29, s4, s22
    s_add_u32 s29, s29, 106496
    s_lshl_b32 s4, s3, 12
    s_add_u32 s32, s4, s22
    s_add_u32 s32, s32, 40960
    s_barrier
    s_mov_b32 s31, 0
Csv1_l:
    buffer_load_dword v250, v247, s[8:11], s22 offen sc1
    s_waitcnt vmcnt(0)
Csv1_c:
    v_cmp_gt_u32 vcc, 1, v250
    s_cbranch_vccz Csv1_o
    s_sleep 1
    s_add_u32 s31, s31, 1
    s_cmp_lt_u32 s31, s30
    s_cbranch_scc1 Csv1_l
    s_mov_b32 s30, 1
Csv1_o:
    s_add_u32 s4, 1, 3
    s_and_b32 s4, s4, 3
    s_mul_i32 s4, s4, 49152
    s_add_u32 s40, s4, s27
    s_add_u32 s41, s40, 4096
    s_add_u32 s42, s40, 8192
    buffer_load_dwordx4 v[48:51], v2, s[8:11], s40 offen offset:0 sc1
    buffer_load_dwordx4 v[52:55], v2, s[8:11], s40 offen offset:1024 sc1
    buffer_load_dwordx4 v[56:59], v2, s[8:11], s40 offen offset:2048 sc1
    buffer_load_dwordx4 v[60:63], v2, s[8:11], s40 offen offset:3072 sc1
    buffer_load_dwordx4 v[64:67], v2, s[8:11], s41 offen offset:0 sc1
    buffer_load_dwordx4 v[68:71], v2, s[8:11], s41 offen offset:1024 sc1
    buffer_load_dwordx4 v[72:75], v2, s[8:11], s41 offen offset:2048 sc1
    buffer_load_dwordx4 v[76:79], v2, s[8:11], s41 offen offset:3072 sc1
    buffer_load_dwordx4 v[80:83], v2, s[8:11], s42 offen offset:0 sc1
    buffer_load_dwordx4 v[84:87], v2, s[8:11], s42 offen offset:1024 sc1
    buffer_load_dwordx4 v[88:91], v2, s[8:11], s42 offen offset:2048 sc1
    buffer_load_dwordx4 v[92:95], v2, s[8:11], s42 offen offset:3072 sc1
    s_waitcnt vmcnt(0)
    v_mfma_f32_16x16x32_bf16 v[136:139], v[48:51], a[0:3], 0
    v_mfma_f32_16x16x32_bf16 v[144:147], v[48:51], a[24:27], 0
    v_mfma_f32_16x16x32_bf16 v[152:155], v[48:51], a[48:51], 0
    v_mfma_f32_16x16x32_bf16 v[160:163], v[48:51], a[72:75], 0
    v_mfma_f32_16x16x32_bf16 v[140:143], v[72:75], a[0:3], 0
    v_mfma_f32_16x16x32_bf16 v[148:151], v[72:75], a[24:27], 0
    v_mfma_f32_16x16x32_bf16 v[156:159], v[72:75], a[48:51], 0
    v_mfma_f32_16x16x32_bf16 v[164:167], v[72:75], a[72:75], 0
    v_mfma_f32_16x16x32_bf16 v[136:139], v[52:55], a[4:7], v[136:139]
    v_mfma_f32_16x16x32_bf16 v[144:147], v[52:55], a[28:31], v[144:147]
    v_mfma_f32_16x16x32_bf16 v[152:155], v[52:55], a[52:55], v[152:155]
    v_mfma_f32_16x16x32_bf16 v[160:163], v[52:55], a[76:79], v[160:163]
    v_mfma_f32_16x16x32_bf16 v[140:143], v[76:79], a[4:7], v[140:143]
    v_mfma_f32_16x16x32_bf16 v[148:151], v[76:79], a[28:31], v[148:151]
    v_mfma_f32_16x16x32_bf16 v[156:159], v[76:79], a[52:55], v[156:159]
    v_mfma_f32_16x16x32_bf16 v[164:167], v[76:79], a[76:79], v[164:167]
    v_mfma_f32_16x16x32_bf16 v[136:139], v[56:59], a[8:11], v[136:139]
    v_mfma_f32_16x16x32_bf16 v[144:147], v[56:59], a[32:35], v[144:147]
    v_mfma_f32_16x16x32_bf16 v[152:155], v[56:59], a[56:59], v[152:155]
    v_mfma_f32_16x16x32_bf16 v[160:163], v[56:59], a[80:83], v[160:163]
    v_mfma_f32_16x16x32_bf16 v[140:143], v[80:83], a[8:11], v[140:143]
    v_mfma_f32_16x16x32_bf16 v[148:151], v[80:83], a[32:35], v[148:151]
    v_mfma_f32_16x16x32_bf16 v[156:159], v[80:83], a[56:59], v[156:159]
    v_mfma_f32_16x16x32_bf16 v[164:167], v[80:83], a[80:83], v[164:167]
    v_mfma_f32_16x16x32_bf16 v[136:139], v[60:63], a[12:15], v[136:139]
    v_mfma_f32_16x16x32_bf16 v[144:147], v[60:63], a[36:39], v[144:147]
    v_mfma_f32_16x16x32_bf16 v[152:155], v[60:63], a[60:63], v[152:155]
    v_mfma_f32_16x16x32_bf16 v[160:163], v[60:63], a[84:87], v[160:163]
    v_mfma_f32_16x16x32_bf16 v[140:143], v[84:87], a[12:15], v[140:143]
    v_mfma_f32_16x16x32_bf16 v[148:151], v[84:87], a[36:39], v[148:151]
    v_mfma_f32_16x16x32_bf16 v[156:159], v[84:87], a[60:63], v[156:159]
    v_mfma_f32_16x16x32_bf16 v[164:167], v[84:87], a[84:87], v[164:167]
    v_mfma_f32_16x16x32_bf16 v[136:139], v[64:67], a[16:19], v[136:139]
    v_mfma_f32_16x16x32_bf16 v[144:147], v[64:67], a[40:43], v[144:147]
    v_mfma_f32_16x16x32_bf16 v[152:155], v[64:67], a[64:67], v[152:155]
    v_mfma_f32_16x16x32_bf16 v[160:163], v[64:67], a[88:91], v[160:163]
    v_mfma_f32_16x16x32_bf16 v[140:143], v[88:91], a[16:19], v[140:143]
    v_mfma_f32_16x16x32_bf16 v[148:151], v[88:91], a[40:43], v[148:151]
    v_mfma_f32_16x16x32_bf16 v[156:159], v[88:91], a[64:67], v[156:159]
    v_mfma_f32_16x16x32_bf16 v[164:167], v[88:91], a[88:91], v[164:167]
    v_mfma_f32_16x16x32_bf16 v[136:139], v[68:71], a[20:23], v[136:139]
    v_mfma_f32_16x16x32_bf16 v[144:147], v[68:71], a[44:47], v[144:147]
    v_mfma_f32_16x16x32_bf16 v[152:155], v[68:71], a[68:71], v[152:155]
    v_mfma_f32_16x16x32_bf16 v[160:163], v[68:71], a[92:95], v[160:163]
    v_mfma_f32_16x16x32_bf16 v[140:143], v[92:95], a[20:23], v[140:143]
    v_mfma_f32_16x16x32_bf16 v[148:151], v[92:95], a[44:47], v[148:151]
    v_mfma_f32_16x16x32_bf16 v[156:159], v[92:95], a[68:71], v[156:159]
    v_mfma_f32_16x16x32_bf16 v[164:167], v[92:95], a[92:95], v[164:167]
    v_cvt_pk_bf16_f32 v168, v136, v137
    v_cvt_pk_bf16_f32 v169, v140, v141
    v_cvt_pk_bf16_f32 v170, v138, v139
    v_cvt_pk_bf16_f32 v171, v142, v143
    ds_write_b128 v3, v[168:171] offset:0
    v_cvt_pk_bf16_f32 v172, v144, v145
    v_cvt_pk_bf16_f32 v173, v148, v149
    v_cvt_pk_bf16_f32 v174, v146, v147
    v_cvt_pk_bf16_f32 v175, v150, v151
    ds_write_b128 v3, v[172:175] offset:4096
    v_cvt_pk_bf16_f32 v176, v152, v153
    v_cvt_pk_bf16_f32 v177, v156, v157
    v_cvt_pk_bf16_f32 v178, v154, v155
    v_cvt_pk_bf16_f32 v179, v158, v159
    ds_write_b128 v3, v[176:179] offset:8192
    v_cvt_pk_bf16_f32 v180, v160, v161
    v_cvt_pk_bf16_f32 v181, v164, v165
    v_cvt_pk_bf16_f32 v182, v162, v163
    v_cvt_pk_bf16_f32 v183, v166, v167
    ds_write_b128 v3, v[180:183] offset:12288
    s_and_b32 s28, s21, 3
    s_lshl_b32 s4, s28, 14
    v_add_u32 v192, s4, v194
    s_lshl_b32 s4, s28, 13
    v_add_u32 v13, s4, v195
    v_add_u32 v10, s4, v196
    v_xor_b32 v0, 32768, v192
    v_xor_b32 v193, 16384, v13
    s_mul_i32 s4, s28, 12288
    s_add_u32 s38, s4, s29
    s_mul_i32 s4, s28, 16384
    s_add_u32 s39, s4, s32
    s_mul_i32 s4, s28, 10240
    s_add_u32 s25, s4, s22
    s_xor_b32 s4, s28, 2
    s_mul_i32 s4, s4, 10240
    s_add_u32 s26, s4, s22
    s_add_u32 s4, s21, 1
    v_mov_b32 v228, s4
    v_mov_b32 v96, 0
    v_mov_b32 v97, 0
    v_mov_b32 v98, 0
    v_mov_b32 v99, 0
    v_mov_b32 v100, 0
    v_mov_b32 v101, 0
    v_mov_b32 v102, 0
    v_mov_b32 v103, 0
    v_mov_b32 v104, 0
    v_mov_b32 v105, 0
    v_mov_b32 v106, 0
    v_mov_b32 v107, 0
    v_mov_b32 v108, 0
    v_mov_b32 v109, 0
    v_mov_b32 v110, 0
    v_mov_b32 v111, 0
    s_waitcnt lgkmcnt(0)
    s_barrier
    s_mul_i32 s4, s28, 163840
    s_add_u32 s35, s4, 2097152
    s_add_u32 s4, s28, 1
    s_and_b32 s4, s4, 3
    s_lshl_b32 s4, s4, 14
    v_add_u32 v3, s4, v197
    s_add_u32 s46, s21, 3
    s_min_u32 s46, s46, 64
    s_mov_b32 s47, s21
    s_add_u32 s4, s46, 3
    s_and_b32 s4, s4, 3
    s_mul_i32 s4, s4, 49152
    s_add_u32 s40, s4, s27
    s_add_u32 s41, s40, 4096
    s_add_u32 s42, s40, 8192
    s_add_u32 s23, s36, s92
    s_mov_b32 m0, s93
    s_add_u32 s36, s36, 65536
    s_and_b32 s36, s36, 262143
    ds_read_b128 v[120:123], v192 offset:0
    ds_read_b128 v[124:127], v192 offset:1024
    ds_read_b128 v[128:131], v192 offset:2048
    ds_read_b128 v[132:135], v192 offset:3072
Cs_loop:
    s_add_u32 s21, s21, 1
    buffer_load_dword v45, v247, s[8:11], s22 offen offset:0 sc1
    buffer_load_dword v46, v248, s[8:11], s22 offen offset:0 sc1
    s_cmp_lg_u32 s3, 0
    s_cbranch_scc1 Csl_o
    buffer_load_dword v47, v4, s[8:11], s22 offen offset:0 sc1
    s_nop 12
    buffer_load_dword v47, v4, s[8:11], s22 offen offset:0 sc1
    s_nop 12
    s_mov_b32 s31, -1
Csl_l:
    buffer_load_dword v47, v4, s[8:11], s22 offen offset:0 sc1
    s_add_u32 s31, s31, 1
    s_cmp_lt_u32 s31, s30
    s_cselect_b32 s30, s30, 1
    s_cbranch_scc0 Csl_o
    s_waitcnt vmcnt(2)
    v_cmp_gt_u32 vcc, s21, v47
    s_cbranch_vccnz Csl_l
Csl_o:
    s_barrier
    buffer_load_dwordx4 v[16:19], v2, s[8:11], s38 offen offset:0 sc1
    buffer_load_dwordx4 v[20:23], v2, s[8:11], s38 offen offset:1024 sc1
    buffer_load_dwordx4 v[24:27], v2, s[8:11], s38 offen offset:2048 sc1
    s_waitcnt vmcnt(3)
    v_cmp_gt_u32 vcc, s46, v45
    v_cmp_gt_u32 s[6:7], s47, v46
    s_or_b64 s[88:89], vcc, s[6:7]
Csm_b:
    s_waitcnt vmcnt(2)
    v_smfmac_f32_16x16x64_bf16 v[96:99], v[16:19], a[0:7], v5
    buffer_load_dwordx4 v[28:31], v2, s[8:11], s39 offen offset:0 sc1
    v_smfmac_f32_16x16x64_bf16 v[100:103], v[16:19], a[24:31], v5
    buffer_load_dwordx4 v[32:35], v2, s[8:11], s39 offen offset:1024 sc1
    v_smfmac_f32_16x16x64_bf16 v[104:107], v[16:19], a[48:55], v5
    buffer_load_dwordx4 v[36:39], v2, s[8:11], s39 offen offset:2048 sc1
    v_smfmac_f32_16x16x64_bf16 v[108:111], v[16:19], a[72:79], v5
    buffer_load_dwordx3 v[40:42], v2, s[8:11], s39 offen offset:3072 sc1
    s_waitcnt vmcnt(5)
    v_smfmac_f32_16x16x64_bf16 v[96:99], v[20:23], a[8:15], v5
    v_smfmac_f32_16x16x64_bf16 v[100:103], v[20:23], a[32:39], v5
    v_smfmac_f32_16x16x64_bf16 v[104:107], v[20:23], a[56:63], v5
    v_smfmac_f32_16x16x64_bf16 v[108:111], v[20:23], a[80:87], v5
    s_waitcnt vmcnt(4)
    v_smfmac_f32_16x16x64_bf16 v[96:99], v[24:27], a[16:23], v5
    v_max3_u32 v251, v16, v18, v20
    v_smfmac_f32_16x16x64_bf16 v[100:103], v[24:27], a[40:47], v5
    v_max3_u32 v251, v251, v22, v24
    v_smfmac_f32_16x16x64_bf16 v[104:107], v[24:27], a[64:71], v5
    v_max_u32 v251, v251, v26
    v_smfmac_f32_16x16x64_bf16 v[108:111], v[24:27], a[88:95], v5
    v_cmp_eq_u32 vcc, -1, v251
    v_cvt_pk_bf16_f32 v112, v96, v97
    v_cvt_pk_bf16_f32 v113, v98, v99
    s_cbranch_vccnz Csm_s
    ds_write_b64 v10, v[112:113] offset:0
    v_cvt_pk_bf16_f32 v114, v100, v101
    v_cvt_pk_bf16_f32 v115, v102, v103
    ds_write_b64 v10, v[114:115] offset:2048
    v_cvt_pk_bf16_f32 v116, v104, v105
    v_cvt_pk_bf16_f32 v117, v106, v107
    ds_write_b64 v10, v[116:117] offset:4096
    v_cvt_pk_bf16_f32 v118, v108, v109
    v_cvt_pk_bf16_f32 v119, v110, v111
    ds_write_b64 v10, v[118:119] offset:6144
    s_cmp_eq_u32 s21, 64
    s_cbranch_scc1 Cs_end
    s_cmp_lg_u64 s[88:89], 0
    s_cbranch_scc1 Cs_fw
Cs_fo:
    buffer_load_dwordx4 v2, s[8:11], s23 offen offset:0 sc1 lds
    buffer_load_dwordx4 v2, s[8:11], s23 offen offset:1024 sc1 lds
    buffer_load_dwordx4 v2, s[8:11], s23 offen offset:2048 sc1 lds
    s_waitcnt vmcnt(3)
Css_b:
    v_max3_u32 v250, v28, v32, v36
    v_pk_add_f32 v[28:29], v[28:29], v[32:33]
    v_pk_add_f32 v[30:31], v[30:31], v[34:35]
    v_max3_u32 v251, v40, v41, v42
    v_add_f32 v40, v40, v41
    v_pk_add_f32 v[28:29], v[28:29], v[36:37]
    v_pk_add_f32 v[30:31], v[30:31], v[38:39]
    v_add_f32 v40, v40, v42
    v_max3_f32 v43, v28, v29, v30
    v_max3_f32 v43, v43, v31, v40
    v_max_u32 v250, v250, v251
    v_cmp_eq_u32 vcc, -1, v250
    v_max_f32 v43, v43, v43 quad_perm:[1,0,3,2] row_mask:0xf bank_mask:0xf
    v_mul_f32 v28, s49, v28
    v_mul_f32 v29, s49, v29
    v_max_f32 v43, v43, v43 quad_perm:[2,3,0,1] row_mask:0xf bank_mask:0xf
    v_mul_f32 v30, s49, v30
    v_mul_f32 v31, s49, v31
    v_max_f32 v43, v43, v43 row_half_mirror row_mask:0xf bank_mask:0xf
    v_mul_f32 v40, s49, v40
    s_cbranch_vccnz Css_s
    v_mul_f32 v43, s49, v43
    v_sub_f32 v28, v28, v43
    v_sub_f32 v29, v29, v43
    v_sub_f32 v30, v30, v43
    v_sub_f32 v31, v31, v43
    v_sub_f32 v40, v40, v43
    v_exp_f32 v28, v28
    v_exp_f32 v29, v29
    v_exp_f32 v30, v30
    v_exp_f32 v31, v31
    v_exp_f32 v40, v40
    v_add_f32 v43, v28, v29
    v_add_f32 v44, v30, v31
    v_add_f32 v43, v43, v44
    v_add_f32 v43, v43, v40
    s_nop 1
    v_add_f32 v43, v43, v43 quad_perm:[1,0,3,2] row_mask:0xf bank_mask:0xf
    s_nop 1
    v_add_f32 v43, v43, v43 quad_perm:[2,3,0,1] row_mask:0xf bank_mask:0xf
    s_nop 1
    v_add_f32 v43, v43, v43 row_half_mirror row_mask:0xf bank_mask:0xf
    v_rcp_f32 v43, v43
    s_mov_b64 exec, s[44:45]
    buffer_store_dword v228, v198, s[8:11], s24 offen offset:0 sc1
    s_mov_b64 exec, -1
    v_mul_f32 v28, v28, v43
    v_mul_f32 v29, v29, v43
    v_mul_f32 v30, v30, v43
    v_mul_f32 v31, v31, v43
    v_mul_f32 v40, v40, v43
    v_cvt_pk_bf16_f32 v28, v28, v29
    v_cvt_pk_bf16_f32 v29, v30, v31
    v_cvt_pk_bf16_f32 v30, v40, v40
    ds_write2_b32 v11, v28, v29 offset0:0 offset1:2
    ds_write_b16 v244, v30
    s_waitcnt lgkmcnt(0)
    s_barrier
    ds_read_b128 v[168:171], v14 offset:0
    ds_read_b128 v[172:175], v14 offset:768
    ds_read_b128 v[176:179], v14 offset:1536
    ds_read_b128 v[180:183], v14 offset:2304
    ds_read_b128 v[184:187], v15 offset:0
    ds_read_b128 v[112:115], v13 offset:0
    ds_read_b128 v[188:191], v15 offset:256
    ds_read_b128 v[116:119], v13 offset:1024
    s_waitcnt lgkmcnt(7)
    v_mfma_f32_16x16x32_bf16 v[200:203], v[120:123], v[168:171], 0
    s_waitcnt lgkmcnt(6)
    v_mfma_f32_16x16x32_bf16 v[200:203], v[124:127], v[172:175], v[200:203]
    s_waitcnt lgkmcnt(5)
    v_mfma_f32_16x16x32_bf16 v[200:203], v[128:131], v[176:179], v[200:203]
    s_waitcnt lgkmcnt(4)
    v_mfma_f32_16x16x32_bf16 v[200:203], v[132:135], v[180:183], v[200:203]
    s_waitcnt lgkmcnt(2)
    v_mfma_f32_16x16x32_bf16 v[200:203], v[112:115], v[184:187], v[200:203]
    s_waitcnt lgkmcnt(0)
    v_mfma_f32_16x16x32_bf16 v[200:203], v[116:119], v[188:191], v[200:203]
    s_load_dword s84, s[8:9], s37 glc
    s_load_dword s85, s[8:9], s43 glc
    s_nop 5
    v_cvt_pk_bf16_f32 v200, v200, v201
    v_cvt_pk_bf16_f32 v201, v202, v203
    buffer_store_dwordx2 v[200:201], v7, s[8:11], s35 offen offset:0 sc1
    s_cmp_eq_u32 s21, 1
    s_cbranch_scc1 Cs_v1
Cs_v1r:
    v_mfma_f32_16x16x32_bf16 v[136:139], v[48:51], a[0:3], 0
    v_mfma_f32_16x16x32_bf16 v[144:147], v[48:51], a[24:27], 0
    v_mfma_f32_16x16x32_bf16 v[152:155], v[48:51], a[48:51], 0
    s_and_b32 s28, s21, 3
    s_lshl_b32 s4, s28, 14
    v_mfma_f32_16x16x32_bf16 v[160:163], v[48:51], a[72:75], 0
    v_add_u32 v192, s4, v194
    s_lshl_b32 s4, s28, 13
    v_mfma_f32_16x16x32_bf16 v[140:143], v[72:75], a[0:3], 0
    v_add_u32 v13, s4, v195
    v_add_u32 v10, s4, v196
    v_mfma_f32_16x16x32_bf16 v[148:151], v[72:75], a[24:27], 0
    v_xor_b32 v0, 32768, v192
    v_xor_b32 v193, 16384, v13
    v_mfma_f32_16x16x32_bf16 v[156:159], v[72:75], a[48:51], 0
    s_load_dword s84, s[8:9], s37 glc
    s_load_dword s85, s[8:9], s43 glc
    v_mfma_f32_16x16x32_bf16 v[164:167], v[72:75], a[72:75], 0
    s_mul_i32 s4, s28, 12288
    s_add_u32 s38, s4, s29
    v_mfma_f32_16x16x32_bf16 v[136:139], v[52:55], a[4:7], v[136:139]
    s_mul_i32 s4, s28, 16384
    s_add_u32 s39, s4, s32
    v_mfma_f32_16x16x32_bf16 v[144:147], v[52:55], a[28:31], v[144:147]
    s_mul_i32 s4, s28, 10240
    s_add_u32 s25, s4, s22
    v_mfma_f32_16x16x32_bf16 v[152:155], v[52:55], a[52:55], v[152:155]
    s_xor_b32 s4, s28, 2
    s_mul_i32 s4, s4, 10240
    v_mfma_f32_16x16x32_bf16 v[160:163], v[52:55], a[76:79], v[160:163]
    s_add_u32 s26, s4, s22
    s_add_u32 s4, s21, 1
    v_mfma_f32_16x16x32_bf16 v[140:143], v[76:79], a[4:7], v[140:143]
    v_mov_b32 v228, s4
    v_mov_b32 v96, 0
    v_mfma_f32_16x16x32_bf16 v[148:151], v[76:79], a[28:31], v[148:151]
    v_mov_b32 v97, 0
    v_mov_b32 v98, 0
    v_mfma_f32_16x16x32_bf16 v[156:159], v[76:79], a[52:55], v[156:159]
    s_or_b64 s[6:7], s[84:85], s[94:95]
    s_min_u32 s6, s6, s7
    s_cmp_ge_u32 s6, s21
    s_cbranch_scc0 Csg_s
Csg_o:
    s_barrier
    buffer_load_dwordx4 v[204:207], v8, s[8:11], s35 offen offset:0 sc1
    buffer_load_dwordx4 v[208:211], v8, s[8:11], s35 offen offset:1024 sc1
    v_mfma_f32_16x16x32_bf16 v[164:167], v[76:79], a[76:79], v[164:167]
    v_mov_b32 v99, 0
    v_mov_b32 v100, 0
    v_mfma_f32_16x16x32_bf16 v[136:139], v[56:59], a[8:11], v[136:139]
    buffer_store_dwordx2 v[232:233], v12, s[8:11], s34 offen offset:0 sc1
    buffer_store_dwordx2 v[234:235], v12, s[8:11], s34 offen offset:512 sc1
    s_add_u32 s34, s34, 524288
    s_and_b32 s6, s34, 1572864
    s_cselect_b32 s6, 0, 8192
    s_xor_b32 s34, s34, s6
    v_mfma_f32_16x16x32_bf16 v[144:147], v[56:59], a[32:35], v[144:147]
    v_mov_b32 v101, 0
    v_mov_b32 v102, 0
    v_mfma_f32_16x16x32_bf16 v[152:155], v[56:59], a[56:59], v[152:155]
    v_mov_b32 v103, 0
    v_mov_b32 v104, 0
    v_mfma_f32_16x16x32_bf16 v[160:163], v[56:59], a[80:83], v[160:163]
    v_mov_b32 v105, 0
    v_mov_b32 v106, 0
    v_mfma_f32_16x16x32_bf16 v[140:143], v[80:83], a[8:11], v[140:143]
    v_mov_b32 v107, 0
    v_mov_b32 v108, 0
    v_mfma_f32_16x16x32_bf16 v[148:151], v[80:83], a[32:35], v[148:151]
    v_mov_b32 v109, 0
    v_mov_b32 v110, 0
    v_mfma_f32_16x16x32_bf16 v[156:159], v[80:83], a[56:59], v[156:159]
    v_mov_b32 v111, 0
    v_mfma_f32_16x16x32_bf16 v[164:167], v[80:83], a[80:83], v[164:167]
    v_mfma_f32_16x16x32_bf16 v[136:139], v[60:63], a[12:15], v[136:139]
    v_mfma_f32_16x16x32_bf16 v[144:147], v[60:63], a[36:39], v[144:147]
    v_mfma_f32_16x16x32_bf16 v[152:155], v[60:63], a[60:63], v[152:155]
    v_mfma_f32_16x16x32_bf16 v[160:163], v[60:63], a[84:87], v[160:163]
    v_mfma_f32_16x16x32_bf16 v[140:143], v[84:87], a[12:15], v[140:143]
    v_mfma_f32_16x16x32_bf16 v[148:151], v[84:87], a[36:39], v[148:151]
    v_mfma_f32_16x16x32_bf16 v[156:159], v[84:87], a[60:63], v[156:159]
    v_mfma_f32_16x16x32_bf16 v[164:167], v[84:87], a[84:87], v[164:167]
    v_mfma_f32_16x16x32_bf16 v[136:139], v[64:67], a[16:19], v[136:139]
    v_mfma_f32_16x16x32_bf16 v[144:147], v[64:67], a[40:43], v[144:147]
    v_mfma_f32_16x16x32_bf16 v[152:155], v[64:67], a[64:67], v[152:155]
    v_mfma_f32_16x16x32_bf16 v[160:163], v[64:67], a[88:91], v[160:163]
    v_mfma_f32_16x16x32_bf16 v[140:143], v[88:91], a[16:19], v[140:143]
    v_mfma_f32_16x16x32_bf16 v[148:151], v[88:91], a[40:43], v[148:151]
    v_mfma_f32_16x16x32_bf16 v[156:159], v[88:91], a[64:67], v[156:159]
    v_mfma_f32_16x16x32_bf16 v[164:167], v[88:91], a[88:91], v[164:167]
    s_waitcnt vmcnt(2)
    v_mfma_f32_16x16x32_bf16 v[32:35], v[224:227], v[204:207], 0
    v_max3_u32 v36, v204, v206, v208
    v_mfma_f32_16x16x32_bf16 v[32:35], v[224:227], v[208:211], v[32:35]
    v_max_u32 v36, v36, v210
    v_cmp_eq_u32 vcc, -1, v36
    s_cbranch_vccnz Cs4_s
Cs4_o:
    s_nop 4
    v_cvt_pk_bf16_f32 v38, v32, v33
    v_cvt_pk_bf16_f32 v39, v34, v35
Cs4_z:
    buffer_store_dwordx2 v[38:39], v222, s[8:11], s25 offen offset:0 sc1
    v_mfma_f32_16x16x32_bf16 v[136:139], v[68:71], a[20:23], v[136:139]
    v_mfma_f32_16x16x32_bf16 v[144:147], v[68:71], a[44:47], v[144:147]
    v_mfma_f32_16x16x32_bf16 v[152:155], v[68:71], a[68:71], v[152:155]
    v_mfma_f32_16x16x32_bf16 v[160:163], v[68:71], a[92:95], v[160:163]
    v_mfma_f32_16x16x32_bf16 v[140:143], v[92:95], a[20:23], v[140:143]
    v_mfma_f32_16x16x32_bf16 v[148:151], v[92:95], a[44:47], v[148:151]
    v_mfma_f32_16x16x32_bf16 v[156:159], v[92:95], a[68:71], v[156:159]
    v_mfma_f32_16x16x32_bf16 v[164:167], v[92:95], a[92:95], v[164:167]
    v_cvt_pk_bf16_f32 v168, v136, v137
    v_cvt_pk_bf16_f32 v169, v140, v141
    v_cvt_pk_bf16_f32 v170, v138, v139
    v_cvt_pk_bf16_f32 v171, v142, v143
    ds_write_b128 v3, v[168:171] offset:0
    v_cvt_pk_bf16_f32 v172, v144, v145
    v_cvt_pk_bf16_f32 v173, v148, v149
    v_cvt_pk_bf16_f32 v174, v146, v147
    v_cvt_pk_bf16_f32 v175, v150, v151
    ds_write_b128 v3, v[172:175] offset:4096
    buffer_load_dwordx4 v[48:51], v2, s[8:11], s40 offen offset:0 sc1
    v_cvt_pk_bf16_f32 v176, v152, v153
    v_cvt_pk_bf16_f32 v177, v156, v157
    buffer_load_dwordx4 v[72:75], v2, s[8:11], s41 offen offset:2048 sc1
    v_cvt_pk_bf16_f32 v178, v154, v155
    v_cvt_pk_bf16_f32 v179, v158, v159
    buffer_load_dwordx4 v[52:55], v2, s[8:11], s40 offen offset:1024 sc1
    ds_write_b128 v3, v[176:179] offset:8192
    v_cvt_pk_bf16_f32 v180, v160, v161
    buffer_load_dwordx4 v[76:79], v2, s[8:11], s41 offen offset:3072 sc1
    v_cvt_pk_bf16_f32 v181, v164, v165
    v_cvt_pk_bf16_f32 v182, v162, v163
    buffer_load_dwordx4 v[56:59], v2, s[8:11], s40 offen offset:2048 sc1
    v_cvt_pk_bf16_f32 v183, v166, v167
    ds_write_b128 v3, v[180:183] offset:12288
    buffer_load_dwordx4 v[80:83], v2, s[8:11], s42 offen offset:0 sc1
    s_waitcnt lgkmcnt(0)
    s_barrier
    ds_read_b128 v[168:171], v0 offset:0
    ds_read_b128 v[136:139], v246 offset:0
    ds_read_b128 v[140:143], v246 offset:1024
    ds_read_b128 v[172:175], v0 offset:1024
    ds_read_b128 v[144:147], v246 offset:2048
    ds_read_b128 v[148:151], v246 offset:3072
    ds_read_b128 v[176:179], v0 offset:2048
    ds_read_b128 v[152:155], v246 offset:4096
    ds_read_b128 v[156:159], v246 offset:5120
    ds_read_b128 v[180:183], v0 offset:3072
    ds_read_b128 v[160:163], v246 offset:6144
    ds_read_b128 v[164:167], v246 offset:7168
    s_waitcnt lgkmcnt(10)
    v_mfma_f32_16x16x32_bf16 v[236:239], v[168:171], v[136:139], 0
    ds_read_b128 v[184:187], v193 offset:0
    buffer_load_dwordx4 v[60:63], v2, s[8:11], s40 offen offset:3072 sc1
    s_waitcnt lgkmcnt(10)
    v_mfma_f32_16x16x32_bf16 v[252:255], v[168:171], v[140:143], 0
    ds_read_b128 v[16:19], v245 offset:0
    buffer_load_dwordx4 v[84:87], v2, s[8:11], s42 offen offset:1024 sc1
    s_waitcnt lgkmcnt(9)
    v_mfma_f32_16x16x32_bf16 v[236:239], v[172:175], v[144:147], v[236:239]
    ds_read_b128 v[20:23], v245 offset:512
    buffer_load_dwordx4 v[64:67], v2, s[8:11], s41 offen offset:0 sc1
    s_waitcnt lgkmcnt(9)
    v_mfma_f32_16x16x32_bf16 v[252:255], v[172:175], v[148:151], v[252:255]
    ds_read_b128 v[188:191], v193 offset:1024
    buffer_load_dwordx4 v[88:91], v2, s[8:11], s42 offen offset:2048 sc1
    s_waitcnt lgkmcnt(8)
    v_mfma_f32_16x16x32_bf16 v[236:239], v[176:179], v[152:155], v[236:239]
    ds_read_b128 v[24:27], v245 offset:1024
    buffer_load_dwordx4 v[68:71], v2, s[8:11], s41 offen offset:1024 sc1
    s_waitcnt lgkmcnt(8)
    v_mfma_f32_16x16x32_bf16 v[252:255], v[176:179], v[156:159], v[252:255]
    ds_read_b128 v[28:31], v245 offset:1536
    buffer_load_dwordx4 v[92:95], v2, s[8:11], s42 offen offset:3072 sc1
    s_waitcnt lgkmcnt(7)
    v_mfma_f32_16x16x32_bf16 v[236:239], v[180:183], v[160:163], v[236:239]
    s_waitcnt lgkmcnt(6)
    v_mfma_f32_16x16x32_bf16 v[252:255], v[180:183], v[164:167], v[252:255]
    s_waitcnt lgkmcnt(4)
    v_mfma_f32_16x16x32_bf16 v[236:239], v[184:187], v[16:19], v[236:239]
    s_waitcnt lgkmcnt(3)
    v_mfma_f32_16x16x32_bf16 v[252:255], v[184:187], v[20:23], v[252:255]
    s_waitcnt lgkmcnt(1)
    v_mfma_f32_16x16x32_bf16 v[236:239], v[188:191], v[24:27], v[236:239]
    s_waitcnt lgkmcnt(0)
    v_mfma_f32_16x16x32_bf16 v[252:255], v[188:191], v[28:31], v[252:255]
    s_nop 3
    v_cvt_pk_bf16_f32 v232, v236, v237
    v_cvt_pk_bf16_f32 v233, v238, v239
    s_nop 1
    v_cvt_pk_bf16_f32 v234, v252, v253
    v_cvt_pk_bf16_f32 v235, v254, v255
    buffer_store_dwordx2 v[240:241], v6, s[8:11], s26 offen offset:0 sc1
    s_mul_i32 s4, s28, 163840
    s_add_u32 s35, s4, 2097152
    s_add_u32 s4, s28, 1
    s_and_b32 s4, s4, 3
    s_lshl_b32 s4, s4, 14
    v_add_u32 v3, s4, v197
    s_add_u32 s46, s21, 3
    s_min_u32 s46, s46, 64
    s_mov_b32 s47, s21
    s_add_u32 s4, s46, 3
    s_and_b32 s4, s4, 3
    s_mul_i32 s4, s4, 49152
    s_add_u32 s40, s4, s27
    s_add_u32 s41, s40, 4096
    s_add_u32 s42, s40, 8192
    s_add_u32 s23, s36, s92
    s_mov_b32 m0, s93
    s_add_u32 s36, s36, 65536
    s_and_b32 s36, s36, 262143
    ds_read_b128 v[120:123], v192 offset:0
    ds_read_b128 v[124:127], v192 offset:1024
    ds_read_b128 v[128:131], v192 offset:2048
    ds_read_b128 v[132:135], v192 offset:3072
    s_branch Cs_loop
Cs_end:
    buffer_store_dwordx2 v[232:233], v12, s[8:11], s34 offen offset:0 sc1
    buffer_store_dwordx2 v[234:235], v12, s[8:11], s34 offen offset:512 sc1
    s_add_u32 s34, s34, 524288
    s_and_b32 s6, s34, 1572864
    s_cselect_b32 s6, 0, 8192
    s_xor_b32 s34, s34, s6
    v_mov_b32 v10, 61
    s_mov_b64 exec, 1
    buffer_store_dword v10, v9, s[8:11], s33 offen sc1
    s_mov_b64 exec, -1
    s_barrier
    s_mov_b32 s31, 0
Csx1_l:
    buffer_load_dword v250, v248, s[8:11], s22 offen sc1
    s_waitcnt vmcnt(0)
Csx1_c:
    v_cmp_gt_u32 vcc, 63, v250
    s_cbranch_vccz Csx1_o
    s_sleep 1
    s_add_u32 s31, s31, 1
    s_cmp_lt_u32 s31, s30
    s_cbranch_scc1 Csx1_l
    s_mov_b32 s30, 1
Csx1_o:
    buffer_load_dwordx4 v2, s[8:11], s23 offen offset:0 sc1 lds
    buffer_load_dwordx4 v2, s[8:11], s23 offen offset:1024 sc1 lds
    buffer_load_dwordx4 v2, s[8:11], s23 offen offset:2048 sc1 lds
    v_add_u32 v0, 32768, v194
    v_add_u32 v193, 16384, v195
    s_waitcnt vmcnt(0) lgkmcnt(0)
    s_barrier
    ds_read_b128 v[168:171], v0 offset:0
    ds_read_b128 v[136:139], v246 offset:0
    ds_read_b128 v[140:143], v246 offset:1024
    ds_read_b128 v[172:175], v0 offset:1024
    ds_read_b128 v[144:147], v246 offset:2048
    ds_read_b128 v[148:151], v246 offset:3072
    ds_read_b128 v[176:179], v0 offset:2048
    ds_read_b128 v[152:155], v246 offset:4096
    ds_read_b128 v[156:159], v246 offset:5120
    ds_read_b128 v[180:183], v0 offset:3072
    ds_read_b128 v[160:163], v246 offset:6144
    ds_read_b128 v[164:167], v246 offset:7168
    s_waitcnt lgkmcnt(10)
    v_mfma_f32_16x16x32_bf16 v[236:239], v[168:171], v[136:139], 0
    ds_read_b128 v[184:187], v193 offset:0
    s_waitcnt lgkmcnt(10)
    v_mfma_f32_16x16x32_bf16 v[252:255], v[168:171], v[140:143], 0
    ds_read_b128 v[16:19], v245 offset:0
    s_waitcnt lgkmcnt(9)
    v_mfma_f32_16x16x32_bf16 v[236:239], v[172:175], v[144:147], v[236:239]
    ds_read_b128 v[20:23], v245 offset:512
    s_waitcnt lgkmcnt(9)
    v_mfma_f32_16x16x32_bf16 v[252:255], v[172:175], v[148:151], v[252:255]
    ds_read_b128 v[188:191], v193 offset:1024
    s_waitcnt lgkmcnt(8)
    v_mfma_f32_16x16x32_bf16 v[236:239], v[176:179], v[152:155], v[236:239]
    ds_read_b128 v[24:27], v245 offset:1024
    s_waitcnt lgkmcnt(8)
    v_mfma_f32_16x16x32_bf16 v[252:255], v[176:179], v[156:159], v[252:255]
    ds_read_b128 v[28:31], v245 offset:1536
    s_waitcnt lgkmcnt(7)
    v_mfma_f32_16x16x32_bf16 v[236:239], v[180:183], v[160:163], v[236:239]
    s_waitcnt lgkmcnt(6)
    v_mfma_f32_16x16x32_bf16 v[252:255], v[180:183], v[164:167], v[252:255]
    s_waitcnt lgkmcnt(4)
    v_mfma_f32_16x16x32_bf16 v[236:239], v[184:187], v[16:19], v[236:239]
    s_waitcnt lgkmcnt(3)
    v_mfma_f32_16x16x32_bf16 v[252:255], v[184:187], v[20:23], v[252:255]
    s_waitcnt lgkmcnt(1)
    v_mfma_f32_16x16x32_bf16 v[236:239], v[188:191], v[24:27], v[236:239]
    s_waitcnt lgkmcnt(0)
    v_mfma_f32_16x16x32_bf16 v[252:255], v[188:191], v[28:31], v[252:255]
    s_nop 3
    v_cvt_pk_bf16_f32 v232, v236, v237
    v_cvt_pk_bf16_f32 v233, v238, v239
    s_nop 1
    v_cvt_pk_bf16_f32 v234, v252, v253
    v_cvt_pk_bf16_f32 v235, v254, v255
    buffer_store_dwordx2 v[232:233], v12, s[8:11], s34 offen offset:0 sc1
    buffer_store_dwordx2 v[234:235], v12, s[8:11], s34 offen offset:512 sc1
    s_add_u32 s34, s34, 524288
    s_and_b32 s6, s34, 1572864
    s_cselect_b32 s6, 0, 8192
    s_xor_b32 s34, s34, s6
    v_mov_b32 v10, 62
    s_mov_b64 exec, 1
    buffer_store_dword v10, v9, s[8:11], s33 offen sc1
    s_mov_b64 exec, -1
    s_barrier
    s_mov_b32 s31, 0
Csx2_l:
    buffer_load_dword v250, v248, s[8:11], s22 offen sc1
    s_waitcnt vmcnt(0)
Csx2_c:
    v_cmp_gt_u32 vcc, 64, v250
    s_cbranch_vccz Csx2_o
    s_sleep 1
    s_add_u32 s31, s31, 1
    s_cmp_lt_u32 s31, s30
    s_cbranch_scc1 Csx2_l
    s_mov_b32 s30, 1
Csx2_o:
    s_add_u32 s23, s36, s92
    s_mov_b32 m0, s93
    s_add_u32 s36, s36, 65536
    s_and_b32 s36, s36, 262143
    buffer_load_dwordx4 v2, s[8:11], s23 offen offset:0 sc1 lds
    buffer_load_dwordx4 v2, s[8:11], s23 offen offset:1024 sc1 lds
    buffer_load_dwordx4 v2, s[8:11], s23 offen offset:2048 sc1 lds
    v_add_u32 v0, 49152, v194
    v_add_u32 v193, 24576, v195
    s_waitcnt vmcnt(0)
    s_barrier
    ds_read_b128 v[168:171], v0 offset:0
    ds_read_b128 v[136:139], v246 offset:0
    ds_read_b128 v[140:143], v246 offset:1024
    ds_read_b128 v[172:175], v0 offset:1024
    ds_read_b128 v[144:147], v246 offset:2048
    ds_read_b128 v[148:151], v246 offset:3072
    ds_read_b128 v[176:179], v0 offset:2048
    ds_read_b128 v[152:155], v246 offset:4096
    ds_read_b128 v[156:159], v246 offset:5120
    ds_read_b128 v[180:183], v0 offset:3072
    ds_read_b128 v[160:163], v246 offset:6144
    ds_read_b128 v[164:167], v246 offset:7168
    s_waitcnt lgkmcnt(10)
    v_mfma_f32_16x16x32_bf16 v[236:239], v[168:171], v[136:139], 0
    ds_read_b128 v[184:187], v193 offset:0
    s_waitcnt lgkmcnt(10)
    v_mfma_f32_16x16x32_bf16 v[252:255], v[168:171], v[140:143], 0
    ds_read_b128 v[16:19], v245 offset:0
    s_waitcnt lgkmcnt(9)
    v_mfma_f32_16x16x32_bf16 v[236:239], v[172:175], v[144:147], v[236:239]
    ds_read_b128 v[20:23], v245 offset:512
    s_waitcnt lgkmcnt(9)
    v_mfma_f32_16x16x32_bf16 v[252:255], v[172:175], v[148:151], v[252:255]
    ds_read_b128 v[188:191], v193 offset:1024
    s_waitcnt lgkmcnt(8)
    v_mfma_f32_16x16x32_bf16 v[236:239], v[176:179], v[152:155], v[236:239]
    ds_read_b128 v[24:27], v245 offset:1024
    s_waitcnt lgkmcnt(8)
    v_mfma_f32_16x16x32_bf16 v[252:255], v[176:179], v[156:159], v[252:255]
    ds_read_b128 v[28:31], v245 offset:1536
    s_waitcnt lgkmcnt(7)
    v_mfma_f32_16x16x32_bf16 v[236:239], v[180:183], v[160:163], v[236:239]
    s_waitcnt lgkmcnt(6)
    v_mfma_f32_16x16x32_bf16 v[252:255], v[180:183], v[164:167], v[252:255]
    s_waitcnt lgkmcnt(4)
    v_mfma_f32_16x16x32_bf16 v[236:239], v[184:187], v[16:19], v[236:239]
    s_waitcnt lgkmcnt(3)
    v_mfma_f32_16x16x32_bf16 v[252:255], v[184:187], v[20:23], v[252:255]
    s_waitcnt lgkmcnt(1)
    v_mfma_f32_16x16x32_bf16 v[236:239], v[188:191], v[24:27], v[236:239]
    s_waitcnt lgkmcnt(0)
    v_mfma_f32_16x16x32_bf16 v[252:255], v[188:191], v[28:31], v[252:255]
    s_nop 3
    v_cvt_pk_bf16_f32 v232, v236, v237
    v_cvt_pk_bf16_f32 v233, v238, v239
    s_nop 1
    v_cvt_pk_bf16_f32 v234, v252, v253
    v_cvt_pk_bf16_f32 v235, v254, v255
    buffer_store_dwordx2 v[232:233], v12, s[8:11], s34 offen offset:0 sc1
    buffer_store_dwordx2 v[234:235], v12, s[8:11], s34 offen offset:512 sc1
    s_add_u32 s34, s34, 524288
    s_and_b32 s6, s34, 1572864
    s_cselect_b32 s6, 0, 8192
    s_xor_b32 s34, s34, s6
    v_mov_b32 v10, 63
    s_mov_b64 exec, 1
    buffer_store_dword v10, v9, s[8:11], s33 offen sc1
    s_mov_b64 exec, -1
    s_branch R_done
Cs_fw:
    s_mov_b32 s31, 0
Csfv_l:
    buffer_load_dword v250, v247, s[8:11], s22 offen sc1
    s_waitcnt vmcnt(0)
Csfv_c:
    v_cmp_gt_u32 vcc, s46, v250
    s_cbranch_vccz Csfv_o
    s_sleep 1
    s_add_u32 s31, s31, 1
    s_cmp_lt_u32 s31, s30
    s_cbranch_scc1 Csfv_l
    s_mov_b32 s30, 1
Csfv_o:
    s_mov_b32 s31, 0
Csfx_l:
    buffer_load_dword v250, v248, s[8:11], s22 offen sc1
    s_waitcnt vmcnt(0)
Csfx_c:
    v_cmp_gt_u32 vcc, s47, v250
    s_cbranch_vccz Csfx_o
    s_sleep 1
    s_add_u32 s31, s31, 1
    s_cmp_lt_u32 s31, s30
    s_cbranch_scc1 Csfx_l
    s_mov_b32 s30, 1
Csfx_o:
    s_branch Cs_fo
Cs_v1:
    s_mov_b32 s31, 0
Csv3_l:
    buffer_load_dword v250, v247, s[8:11], s22 offen sc1
    s_waitcnt vmcnt(0)
Csv3_c:
    v_cmp_gt_u32 vcc, 2, v250
    s_cbranch_vccz Csv3_o
    s_sleep 1
    s_add_u32 s31, s31, 1
    s_cmp_lt_u32 s31, s30
    s_cbranch_scc1 Csv3_l
    s_mov_b32 s30, 1
Csv3_o:
    s_add_u32 s4, 2, 3
    s_and_b32 s4, s4, 3
    s_mul_i32 s4, s4, 49152
    s_add_u32 s40, s4, s27
    s_add_u32 s41, s40, 4096
    s_add_u32 s42, s40, 8192
    buffer_load_dwordx4 v[48:51], v2, s[8:11], s40 offen offset:0 sc1
    buffer_load_dwordx4 v[52:55], v2, s[8:11], s40 offen offset:1024 sc1
    buffer_load_dwordx4 v[56:59], v2, s[8:11], s40 offen offset:2048 sc1
    buffer_load_dwordx4 v[60:63], v2, s[8:11], s40 offen offset:3072 sc1
    buffer_load_dwordx4 v[64:67], v2, s[8:11], s41 offen offset:0 sc1
    buffer_load_dwordx4 v[68:71], v2, s[8:11], s41 offen offset:1024 sc1
    buffer_load_dwordx4 v[72:75], v2, s[8:11], s41 offen offset:2048 sc1
    buffer_load_dwordx4 v[76:79], v2, s[8:11], s41 offen offset:3072 sc1
    buffer_load_dwordx4 v[80:83], v2, s[8:11], s42 offen offset:0 sc1
    buffer_load_dwordx4 v[84:87], v2, s[8:11], s42 offen offset:1024 sc1
    buffer_load_dwordx4 v[88:91], v2, s[8:11], s42 offen offset:2048 sc1
    buffer_load_dwordx4 v[92:95], v2, s[8:11], s42 offen offset:3072 sc1
    s_add_u32 s4, s46, 3
    s_and_b32 s4, s4, 3
    s_mul_i32 s4, s4, 49152
    s_add_u32 s40, s4, s27
    s_add_u32 s41, s40, 4096
    s_add_u32 s42, s40, 8192
    s_waitcnt vmcnt(0)
    s_branch Cs_v1r
Csm_s:
    s_mov_b32 s31, 0
Csm_l:
    buffer_load_dwordx4 v[16:19], v2, s[8:11], s38 offen offset:0 sc1
    buffer_load_dwordx4 v[20:23], v2, s[8:11], s38 offen offset:1024 sc1
    buffer_load_dwordx4 v[24:27], v2, s[8:11], s38 offen offset:2048 sc1
    s_nop 7
    v_mov_b32 v96, 0
    v_mov_b32 v97, 0
    v_mov_b32 v98, 0
    v_mov_b32 v99, 0
    v_mov_b32 v100, 0
    v_mov_b32 v101, 0
    v_mov_b32 v102, 0
    v_mov_b32 v103, 0
    v_mov_b32 v104, 0
    v_mov_b32 v105, 0
    v_mov_b32 v106, 0
    v_mov_b32 v107, 0
    v_mov_b32 v108, 0
    v_mov_b32 v109, 0
    v_mov_b32 v110, 0
    v_mov_b32 v111, 0
    s_waitcnt vmcnt(0)
    v_max3_u32 v251, v16, v18, v20
    v_max3_u32 v251, v251, v22, v24
    v_max_u32 v251, v251, v26
    v_cmp_eq_u32 vcc, -1, v251
    s_cbranch_vccz Csm_b
    s_add_u32 s31, s31, 1
    s_cmp_lt_u32 s31, s30
    s_cbranch_scc1 Csm_l
    s_mov_b32 s30, 1
    v_min_u32 v16, s48, v16
    v_min_u32 v18, s48, v18
    v_min_u32 v20, s48, v20
    v_min_u32 v22, s48, v22
    v_min_u32 v24, s48, v24
    v_min_u32 v26, s48, v26
    s_branch Csm_b
Csg_s:
    s_mov_b32 s31, 0
Csg_l:
    s_load_dword s84, s[8:9], s37 glc
    s_load_dword s85, s[8:9], s43 glc
    s_or_b64 s[6:7], s[84:85], s[94:95]
    s_min_u32 s6, s6, s7
    s_cmp_ge_u32 s6, s21
    s_cbranch_scc1 Csg_o
    s_or_b64 s[6:7], s[84:85], s[94:95]
    s_min_u32 s6, s6, s7
    s_cmp_ge_u32 s6, s21
    s_cbranch_scc1 Csg_o
    s_or_b64 s[6:7], s[84:85], s[94:95]
    s_min_u32 s6, s6, s7
    s_cmp_ge_u32 s6, s21
    s_cbranch_scc1 Csg_o
    s_or_b64 s[6:7], s[84:85], s[94:95]
    s_min_u32 s6, s6, s7
    s_cmp_ge_u32 s6, s21
    s_cbranch_scc1 Csg_o
    s_or_b64 s[6:7], s[84:85], s[94:95]
    s_min_u32 s6, s6, s7
    s_cmp_ge_u32 s6, s21
    s_cbranch_scc1 Csg_o
    s_or_b64 s[6:7], s[84:85], s[94:95]
    s_min_u32 s6, s6, s7
    s_cmp_ge_u32 s6, s21
    s_cbranch_scc1 Csg_o
    s_add_u32 s31, s31, 1
    s_cmp_lt_u32 s31, s30
    s_cbranch_scc1 Csg_l
    s_mov_b32 s30, 1
    s_branch Csg_o
Cs4_s:
    s_mov_b32 s31, 0
Cs4_l:
    buffer_load_dwordx4 v[204:207], v8, s[8:11], s35 offen offset:0 sc1
    buffer_load_dwordx4 v[208:211], v8, s[8:11], s35 offen offset:1024 sc1
    s_waitcnt vmcnt(0)
    v_mfma_f32_16x16x32_bf16 v[32:35], v[224:227], v[204:207], 0
    v_max3_u32 v36, v204, v206, v208
    v_mfma_f32_16x16x32_bf16 v[32:35], v[224:227], v[208:211], v[32:35]
    v_max_u32 v36, v36, v210
    v_cmp_eq_u32 vcc, -1, v36
    s_nop 7
    s_cbranch_vccz Cs4_o
    s_add_u32 s31, s31, 1
    s_cmp_lt_u32 s31, s30
    s_cbranch_scc1 Cs4_l
    s_mov_b32 s30, 1
    v_cvt_pk_bf16_f32 v38, v32, v33
    v_cvt_pk_bf16_f32 v39, v34, v35
    v_min_u32 v38, s48, v38
    v_min_u32 v39, s48, v39
    s_branch Cs4_z
Css_s:
    s_mov_b32 s31, 0
Css_l:
    buffer_load_dwordx4 v[28:31], v2, s[8:11], s39 offen offset:0 sc1
    buffer_load_dwordx4 v[32:35], v2, s[8:11], s39 offen offset:1024 sc1
    buffer_load_dwordx4 v[36:39], v2, s[8:11], s39 offen offset:2048 sc1
    buffer_load_dwordx3 v[40:42], v2, s[8:11], s39 offen offset:3072 sc1
    s_waitcnt vmcnt(0)
    v_max3_u32 v250, v28, v32, v36
    v_max3_u32 v250, v250, v40, v41
    v_max_u32 v250, v250, v42
    v_cmp_eq_u32 vcc, -1, v250
    s_cbranch_vccz Css_b
    s_add_u32 s31, s31, 1
    s_cmp_lt_u32 s31, s30
    s_cbranch_scc1 Css_l
    s_mov_b32 s30, 1
    v_min_u32 v28, s48, v28
    v_min_u32 v29, s48, v29
    v_min_u32 v30, s48, v30
    v_min_u32 v31, s48, v31
    v_min_u32 v32, s48, v32
    v_min_u32 v33, s48, v33
    v_min_u32 v34, s48, v34
    v_min_u32 v35, s48, v35
    v_min_u32 v36, s48, v36
    v_min_u32 v37, s48, v37
    v_min_u32 v38, s48, v38
    v_min_u32 v39, s48, v39
    v_min_u32 v40, s48, v40
    v_min_u32 v41, s48, v41
    v_min_u32 v42, s48, v42
    s_branch Css_b
R_x:
    s_load_dwordx2 s[12:13], s[0:1], 96
    s_load_dwordx2 s[16:17], s[0:1], 104
    s_load_dwordx2 s[84:85], s[0:1], 120
    s_load_dwordx2 s[88:89], s[0:1], 0
    s_mov_b32 s14, 1280
    s_mov_b32 s15, 0x20000
    s_mov_b32 s18, 4915200
    s_mov_b32 s19, 0x20000
    s_mov_b32 s86, 256
    s_mov_b32 s87, 0x20000
    s_mov_b32 s90, 2621440
    s_mov_b32 s91, 0x20000
    s_waitcnt lgkmcnt(0)
    v_lshlrev_b32 v2, 4, v1
    s_lshl_b32 s21, s99, 2
    s_add_u32 s21, s21, s20
    s_sub_u32 s21, s21, 28
    s_mul_i32 s4, s3, 5120
    s_add_u32 s23, s4, 81920
    s_mul_i32 s26, s21, 20480
    s_add_u32 s26, s26, s4
    v_lshlrev_b32 v4, 2, v1
    s_mul_i32 s4, s3, 320
    buffer_load_dword v244, v4, s[12:15], s4 offen
    buffer_load_dword v245, v4, s[12:15], s4 offen offset:256
    s_add_u32 s4, s26, 0
    s_add_u32 m0, s23, 0
    s_nop 0
    buffer_load_dwordx4 v2, s[88:91], s4 offen offset:0 nt lds
    buffer_load_dwordx4 v2, s[88:91], s4 offen offset:1024 nt lds
    buffer_load_dwordx4 v2, s[88:91], s4 offen offset:2048 nt lds
    buffer_load_dwordx4 v2, s[88:91], s4 offen offset:3072 nt lds
    s_add_u32 s4, s26, 4096
    s_add_u32 m0, s23, 4096
    s_nop 0
    buffer_load_dwordx4 v2, s[88:91], s4 offen offset:0 nt lds
    v_lshrrev_b32 v4, 3, v1
    v_and_b32 v5, 1, v4
    v_mul_u32_u24 v14, 7680, v4
    v_bfe_u32 v4, v1, 1, 2
    v_xor_b32 v4, v4, v5
    v_lshlrev_b32 v4, 5, v4
    v_and_b32 v5, 1, v1
    v_lshlrev_b32 v5, 4, v5
    v_add3_u32 v14, v14, v4, v5
    v_xor_b32 v15, 64, v14
    s_mul_i32 s22, s3, 20480
    v_lshrrev_b32 v4, 4, v1
    v_lshlrev_b32 v4, 2, v4
    v_bfe_u32 v5, v1, 2, 1
    v_add_u32 v4, v4, v5
    v_bfe_u32 v5, v1, 3, 1
    v_lshl_add_u32 v4, v5, 4, v4
    v_lshlrev_b32 v32, 7, v4
    v_bfe_u32 v4, v1, 2, 2
    v_lshlrev_b32 v4, 5, v4
    v_and_b32 v5, 3, v1
    v_lshlrev_b32 v5, 3, v5
    v_add3_u32 v32, v32, v4, v5
    v_add_u32 v32, s22, v32
    v_xor_b32 v33, 32, v32
    v_xor_b32 v34, 64, v32
    v_xor_b32 v35, 96, v32
    v_lshrrev_b32 v4, 5, v1
    v_lshlrev_b32 v36, 6, v4
    v_bfe_u32 v4, v1, 2, 2
    v_lshl_add_u32 v36, v4, 4, v36
    v_bfe_u32 v4, v1, 1, 1
    v_lshl_add_u32 v36, v4, 3, v36
    v_bfe_u32 v4, v1, 4, 1
    v_lshl_add_u32 v36, v4, 2, v36
    v_and_b32 v37, 0x30, v1
    v_add_u32 v37, s22, v37
    v_lshlrev_b32 v38, 2, v1
    v_and_b32 v4, 3, v1
    v_mul_u32_u24 v39, 1280, v4
    v_lshrrev_b32 v5, 4, v1
    v_lshl_add_u32 v39, v5, 6, v39
    v_bfe_u32 v5, v1, 2, 2
    v_lshl_add_u32 v39, v5, 3, v39
    v_add_u32 v39, s23, v39
    v_lshrrev_b32 v5, 2, v1
    v_lshlrev_b32 v3, 8, v5
    v_lshl_add_u32 v3, v4, 4, v3
    s_lshl_b32 s4, s3, 6
    s_add_u32 s4, s4, 81920
    v_add_u32 v3, s4, v3
    s_mul_i32 s27, s21, 20480
    s_mul_i32 s4, s3, 5120
    s_add_u32 s27, s27, s4
    s_add_u32 s27, s27, 16777216
    v_mov_b32 v134, 163776
    s_cmp_lg_u32 s3, 0
    s_cbranch_scc1 XC_c
    s_waitcnt vmcnt(7)
    v_readfirstlane_b32 s4, v135
    s_and_b32 s4, s4, s33
    s_nop 0
    v_mov_b32 v135, s4
    ds_write_b32 v134, v135
    s_waitcnt lgkmcnt(0)
XC_c:
    s_barrier
    ds_read_b32 v135, v134
    s_waitcnt lgkmcnt(0)
    v_readfirstlane_b32 s4, v135
    s_cmp_lg_u32 s4, 0
    s_cbranch_scc1 R_ovf
    s_mul_i32 s4, s99, 1048576
    s_lshl_b32 s33, s20, 4
    s_add_u32 s33, s33, s4
    s_lshl_b32 s4, s3, 2
    s_add_u32 s33, s33, s4
    s_add_u32 s33, s33, 8544256
    v_mov_b32 v4, 0
    s_mov_b64 exec, 1
    buffer_store_dword v4, v4, s[8:11], s33 offen sc1
    s_mov_b64 exec, -1
    s_lshl_b32 s4, s21, 7
    s_add_u32 s4, s4, 65536
    v_mov_b32 v16, 0
    v_lshlrev_b32 v17, 2, v1
    s_cmp_eq_u32 s3, 0
    s_cselect_b64 exec, 3, 0
    buffer_store_dword v16, v17, s[8:11], s4 offen sc1
    s_mov_b64 exec, -1
    s_mul_i32 s4, s99, 1048576
    s_add_u32 s4, s4, 8544768
    s_cmp_eq_u32 s20, 30
    s_cselect_b64 exec, 0xff, 0
    buffer_store_dword v16, v17, s[8:11], s4 offen sc1
    s_mov_b64 exec, -1
    v_mov_b32 v16, -1
    v_mov_b32 v17, -1
    v_mov_b32 v18, -1
    v_mov_b32 v19, -1
    s_lshl_b32 s4, s3, 10
    s_add_u32 s4, s4, 32768
    s_cmp_eq_u32 s21, 0
    s_cselect_b64 exec, -1, 0
    buffer_store_dwordx4 v[16:19], v2, s[8:11], s4 offen sc1
    s_mov_b64 exec, -1
    s_waitcnt vmcnt(0)
    s_barrier
    s_cmp_lg_u32 s3, 0
    s_cbranch_scc1 XA_n
    s_lshl_b32 s4, s99, 5
    s_add_u32 s4, s4, 4
    v_mov_b32 v16, 0
    v_mov_b32 v17, 1
    s_mov_b64 exec, 1
    buffer_atomic_add v17, v16, s[84:87], s4 offen sc1
    s_mov_b64 exec, -1
XA_n:
    s_cmp_lt_u32 s21, 20
    s_cbranch_scc1 XD_nv
    s_lshr_b32 s6, s21, 2
    s_lshl_b32 s6, s6, 14
    s_and_b32 s5, s21, 3
    s_lshl_b32 s5, s5, 11
    s_add_u32 s6, s6, s5
    s_lshl_b32 s5, s3, 9
    s_add_u32 s40, s5, s6
    s_add_u32 s40, s40, 2670592
    s_add_u32 s41, s40, 384
    s_load_dword s36, s[8:9], s41
    s_mov_b32 s38, -1
    s_mov_b32 s39, -1
    s_waitcnt lgkmcnt(0)
    s_add_u32 s41, s40, 0
    s_memtime s[4:5]
    s_waitcnt lgkmcnt(0)
    s_load_dword s36, s[8:9], s41
    s_waitcnt lgkmcnt(0)
    s_memtime s[6:7]
    s_waitcnt lgkmcnt(0)
    s_sub_u32 s4, s6, s4
    s_min_u32 s38, s38, s4
    s_add_u32 s41, s40, 8192
    s_memtime s[4:5]
    s_waitcnt lgkmcnt(0)
    s_load_dword s36, s[8:9], s41
    s_waitcnt lgkmcnt(0)
    s_memtime s[6:7]
    s_waitcnt lgkmcnt(0)
    s_sub_u32 s4, s6, s4
    s_min_u32 s39, s39, s4
    s_add_u32 s41, s40, 128
    s_memtime s[4:5]
    s_waitcnt lgkmcnt(0)
    s_load_dword s36, s[8:9], s41
    s_waitcnt lgkmcnt(0)
    s_memtime s[6:7]
    s_waitcnt lgkmcnt(0)
    s_sub_u32 s4, s6, s4
    s_min_u32 s38, s38, s4
    s_add_u32 s41, s40, 8320
    s_memtime s[4:5]
    s_waitcnt lgkmcnt(0)
    s_load_dword s36, s[8:9], s41
    s_waitcnt lgkmcnt(0)
    s_memtime s[6:7]
    s_waitcnt lgkmcnt(0)
    s_sub_u32 s4, s6, s4
    s_min_u32 s39, s39, s4
    s_cmp_lt_u32 s39, s38
    s_cselect_b32 s4, 0, 0x10000
    s_lshl_b32 s5, s3, 2
    s_add_u32 s5, s5, 163792
    v_mov_b32 v4, s5
    v_mov_b32 v5, s4
    ds_write_b32 v4, v5
XD_nv:
    v_lshrrev_b32 v10, 4, v1
    v_lshlrev_b32 v10, 6, v10
    v_bfe_u32 v11, v1, 1, 2
    v_lshl_add_u32 v10, v11, 4, v10
    v_and_b32 v11, 1, v1
    v_lshl_add_u32 v10, v11, 3, v10
    v_bfe_u32 v11, v1, 3, 1
    v_lshl_add_u32 v10, v11, 2, v10
    v_add_u32 v10, s23, v10
    v_lshlrev_b32 v6, 16, v244
    v_and_b32 v7, 0xffff0000, v244
    v_lshlrev_b32 v8, 16, v245
    v_and_b32 v9, 0xffff0000, v245
    v_mul_f32 v16, 0xbfb8aa3b, v6
    v_mul_f32 v17, 0xbfb8aa3b, v7
    v_mul_f32 v18, 0xbfb8aa3b, v8
    v_mul_f32 v19, 0xbfb8aa3b, v9
    v_exp_f32 v16, v16
    v_exp_f32 v17, v17
    v_exp_f32 v18, v18
    v_exp_f32 v19, v19
    v_add_f32 v16, 1.0, v16
    v_add_f32 v17, 1.0, v17
    v_add_f32 v18, 1.0, v18
    v_add_f32 v19, 1.0, v19
    v_rcp_f32 v16, v16
    v_rcp_f32 v17, v17
    v_rcp_f32 v18, v18
    v_rcp_f32 v19, v19
    v_mul_f32 v6, v6, v16
    v_mul_f32 v7, v7, v17
    v_mul_f32 v8, v8, v18
    v_mul_f32 v9, v9, v19
    v_cvt_pk_bf16_f32 v4, v6, v7
    v_cvt_pk_bf16_f32 v5, v8, v9
    v_and_b32 v11, 0x30, v1
    v_add_u32 v11, s23, v11
    v_add_u32 v12, 0, v39
    s_call_b64 s[100:101], XN_sub
    v_cvt_pk_bf16_f32 v180, v60, v61
    v_cvt_pk_bf16_f32 v181, v62, v63
    v_cvt_pk_bf16_f32 v182, v64, v65
    v_cvt_pk_bf16_f32 v183, v66, v67
    v_cvt_pk_bf16_f32 v184, v68, v69
    v_cvt_pk_bf16_f32 v185, v70, v71
    v_cvt_pk_bf16_f32 v186, v72, v73
    v_cvt_pk_bf16_f32 v187, v74, v75
    v_cvt_pk_bf16_f32 v188, v76, v77
    v_cvt_pk_bf16_f32 v189, v78, v79
    v_cvt_pk_bf16_f32 v190, v80, v81
    v_cvt_pk_bf16_f32 v191, v82, v83
    v_cvt_pk_bf16_f32 v192, v84, v85
    v_cvt_pk_bf16_f32 v193, v86, v87
    v_cvt_pk_bf16_f32 v194, v88, v89
    v_cvt_pk_bf16_f32 v195, v90, v91
    v_cvt_pk_bf16_f32 v196, v92, v93
    v_cvt_pk_bf16_f32 v197, v94, v95
    v_cvt_pk_bf16_f32 v198, v96, v97
    v_cvt_pk_bf16_f32 v199, v98, v99
    ds_write_b32 v10, v4
    ds_write_b32 v10, v5 offset:256
    s_waitcnt lgkmcnt(0)
    ds_read_b128 v[220:223], v11 offset:0
    ds_read_b128 v[224:227], v11 offset:64
    ds_read_b128 v[228:231], v11 offset:128
    ds_read_b128 v[232:235], v11 offset:192
    ds_read_b128 v[236:239], v11 offset:256
    v_and_b32 v16, 7, v1
    v_lshlrev_b32 v16, 5, v16
    buffer_load_dwordx4 v[20:23], v16, s[84:87], 0 offen sc1
    s_mov_b32 s31, 0
    s_waitcnt vmcnt(0)
    s_branch XI_c
XI_l:
    buffer_load_dwordx4 v[20:23], v16, s[84:87], 0 offen sc1
    s_waitcnt vmcnt(0)
XI_c:
    v_bcnt_u32_b32 v17, v20, v23
    v_cmp_lt_u32 s[4:5], 32, v17
    s_and_b32 s6, s4, 0xff
    v_cmp_ne_u32 s[4:5], 32, v17
    s_cmp_eq_u32 s6, 0
    s_cselect_b32 s5, 0xff, 0
    s_and_b32 s4, s4, s5
    v_cmp_gt_u32 vcc, 22, v21
    s_and_b32 vcc_lo, vcc_lo, 0xff
    s_or_b32 vcc_lo, vcc_lo, s4
    s_mov_b32 vcc_hi, 0
    s_cbranch_vccz XI_o
    s_sleep 16
    s_add_u32 s31, s31, 1
    s_cmp_lt_u32 s31, s30
    s_cbranch_scc1 XI_l
    s_mov_b32 s30, 1
XI_o:
    s_mov_b32 s97, s6
    s_waitcnt lgkmcnt(0)
    s_cmp_lg_u32 s3, 0
    s_cbranch_scc1 XW_o
    s_mov_b32 s5, 32768
    s_mov_b32 s31, 0
XW_l:
    buffer_load_dwordx4 v[40:43], v2, s[8:11], s5 offen offset:0 sc1
    buffer_load_dwordx4 v[44:47], v2, s[8:11], s5 offen offset:1024 sc1
    buffer_load_dwordx4 v[48:51], v2, s[8:11], s5 offen offset:1536 sc1
    s_waitcnt vmcnt(0)
    v_max3_u32 v4, v40, v41, v42
    v_max3_u32 v4, v4, v43, v44
    v_max3_u32 v4, v4, v45, v46
    v_max3_u32 v4, v4, v47, v48
    v_max3_u32 v4, v4, v49, v50
    v_max_u32 v4, v4, v51
    v_cmp_eq_u32 vcc, -1, v4
    s_cbranch_vccz XW_o
    s_sleep 4
    s_add_u32 s31, s31, 1
    s_cmp_lt_u32 s31, s30
    s_cbranch_scc1 XW_l
    s_mov_b32 s30, 1
XW_o:
    s_barrier
    v_lshrrev_b32 v10, 2, v1
    v_lshlrev_b32 v10, 4, v10
    s_mov_b64 s[24:25], -1
    s_mov_b32 s5, 32768
    buffer_load_dwordx4 v[160:163], v10, s[8:11], s5 offen offset:0 sc1
    buffer_load_dwordx4 v[164:167], v10, s[8:11], s5 offen offset:256 sc1
    buffer_load_dwordx4 v[168:171], v10, s[8:11], s5 offen offset:512 sc1
    buffer_load_dwordx4 v[172:175], v10, s[8:11], s5 offen offset:768 sc1
    buffer_load_dwordx4 v[176:179], v10, s[8:11], s5 offen offset:1024 sc1
    buffer_load_dwordx4 v[120:123], v10, s[8:11], s5 offen offset:1280 sc1
    buffer_load_dwordx4 v[124:127], v10, s[8:11], s5 offen offset:1536 sc1
    buffer_load_dwordx4 v[128:131], v10, s[8:11], s5 offen offset:1792 sc1
    buffer_load_dwordx4 v[132:135], v10, s[8:11], s5 offen offset:2048 sc1
    buffer_load_dwordx4 v[136:139], v10, s[8:11], s5 offen offset:2304 sc1
    s_mov_b32 s36, 1
    s_cmp_lt_u32 s21, 20
    s_cbranch_scc1 XD_nw
    v_mov_b32 v4, 163792
    ds_read_b128 v[16:19], v4
    s_waitcnt lgkmcnt(0)
    v_add3_u32 v16, v16, v17, v18
    v_add_u32 v16, v16, v19
    s_nop 0
    v_readfirstlane_b32 s36, v16
    s_and_b32 s36, s36, 0x70000
    s_add_u32 s36, s36, 1
XD_nw:
    s_waitcnt vmcnt(0)
    v_lshlrev_b32 v100, 16, v120
    v_and_b32 v101, 0xffff0000, v120
    v_lshlrev_b32 v102, 16, v121
    v_and_b32 v103, 0xffff0000, v121
    v_lshlrev_b32 v104, 16, v122
    v_and_b32 v105, 0xffff0000, v122
    v_lshlrev_b32 v106, 16, v123
    v_and_b32 v107, 0xffff0000, v123
    v_lshlrev_b32 v108, 16, v124
    v_and_b32 v109, 0xffff0000, v124
    v_lshlrev_b32 v110, 16, v125
    v_and_b32 v111, 0xffff0000, v125
    v_lshlrev_b32 v112, 16, v126
    v_and_b32 v113, 0xffff0000, v126
    v_lshlrev_b32 v114, 16, v127
    v_and_b32 v115, 0xffff0000, v127
    v_lshlrev_b32 v116, 16, v128
    v_and_b32 v117, 0xffff0000, v128
    v_lshlrev_b32 v118, 16, v129
    v_and_b32 v119, 0xffff0000, v129
    v_lshlrev_b32 v120, 16, v130
    v_and_b32 v121, 0xffff0000, v130
    v_lshlrev_b32 v122, 16, v131
    v_and_b32 v123, 0xffff0000, v131
    v_lshlrev_b32 v124, 16, v132
    v_and_b32 v125, 0xffff0000, v132
    v_lshlrev_b32 v126, 16, v133
    v_and_b32 v127, 0xffff0000, v133
    v_lshlrev_b32 v128, 16, v134
    v_and_b32 v129, 0xffff0000, v134
    v_lshlrev_b32 v130, 16, v135
    v_and_b32 v131, 0xffff0000, v135
    v_lshlrev_b32 v132, 16, v136
    v_and_b32 v133, 0xffff0000, v136
    v_lshlrev_b32 v134, 16, v137
    v_and_b32 v135, 0xffff0000, v137
    v_lshlrev_b32 v136, 16, v138
    v_and_b32 v137, 0xffff0000, v138
    v_lshlrev_b32 v138, 16, v139
    v_and_b32 v139, 0xffff0000, v139
    v_lshlrev_b32 v140, 16, v160
    v_and_b32 v141, 0xffff0000, v160
    v_lshlrev_b32 v142, 16, v161
    v_and_b32 v143, 0xffff0000, v161
    v_lshlrev_b32 v144, 16, v162
    v_and_b32 v145, 0xffff0000, v162
    v_lshlrev_b32 v146, 16, v163
    v_and_b32 v147, 0xffff0000, v163
    v_lshlrev_b32 v148, 16, v164
    v_and_b32 v149, 0xffff0000, v164
    v_lshlrev_b32 v150, 16, v165
    v_and_b32 v151, 0xffff0000, v165
    v_lshlrev_b32 v152, 16, v166
    v_and_b32 v153, 0xffff0000, v166
    v_lshlrev_b32 v154, 16, v167
    v_and_b32 v155, 0xffff0000, v167
    v_lshlrev_b32 v156, 16, v168
    v_and_b32 v157, 0xffff0000, v168
    v_lshlrev_b32 v158, 16, v169
    v_and_b32 v159, 0xffff0000, v169
    v_lshlrev_b32 v160, 16, v170
    v_and_b32 v161, 0xffff0000, v170
    v_lshlrev_b32 v162, 16, v171
    v_and_b32 v163, 0xffff0000, v171
    v_lshlrev_b32 v164, 16, v172
    v_and_b32 v165, 0xffff0000, v172
    v_lshlrev_b32 v166, 16, v173
    v_and_b32 v167, 0xffff0000, v173
    v_lshlrev_b32 v168, 16, v174
    v_and_b32 v169, 0xffff0000, v174
    v_lshlrev_b32 v170, 16, v175
    v_and_b32 v171, 0xffff0000, v175
    v_lshlrev_b32 v172, 16, v176
    v_and_b32 v173, 0xffff0000, v176
    v_lshlrev_b32 v174, 16, v177
    v_and_b32 v175, 0xffff0000, v177
    v_lshlrev_b32 v176, 16, v178
    v_and_b32 v177, 0xffff0000, v178
    v_lshlrev_b32 v178, 16, v179
    v_and_b32 v179, 0xffff0000, v179
    v_lshlrev_b32 v60, 16, v180
    v_and_b32 v61, 0xffff0000, v180
    v_lshlrev_b32 v62, 16, v181
    v_and_b32 v63, 0xffff0000, v181
    v_lshlrev_b32 v64, 16, v182
    v_and_b32 v65, 0xffff0000, v182
    v_lshlrev_b32 v66, 16, v183
    v_and_b32 v67, 0xffff0000, v183
    v_lshlrev_b32 v68, 16, v184
    v_and_b32 v69, 0xffff0000, v184
    v_lshlrev_b32 v70, 16, v185
    v_and_b32 v71, 0xffff0000, v185
    v_lshlrev_b32 v72, 16, v186
    v_and_b32 v73, 0xffff0000, v186
    v_lshlrev_b32 v74, 16, v187
    v_and_b32 v75, 0xffff0000, v187
    v_lshlrev_b32 v76, 16, v188
    v_and_b32 v77, 0xffff0000, v188
    v_lshlrev_b32 v78, 16, v189
    v_and_b32 v79, 0xffff0000, v189
    v_lshlrev_b32 v80, 16, v190
    v_and_b32 v81, 0xffff0000, v190
    v_lshlrev_b32 v82, 16, v191
    v_and_b32 v83, 0xffff0000, v191
    v_lshlrev_b32 v84, 16, v192
    v_and_b32 v85, 0xffff0000, v192
    v_lshlrev_b32 v86, 16, v193
    v_and_b32 v87, 0xffff0000, v193
    v_lshlrev_b32 v88, 16, v194
    v_and_b32 v89, 0xffff0000, v194
    v_lshlrev_b32 v90, 16, v195
    v_and_b32 v91, 0xffff0000, v195
    v_lshlrev_b32 v92, 16, v196
    v_and_b32 v93, 0xffff0000, v196
    v_lshlrev_b32 v94, 16, v197
    v_and_b32 v95, 0xffff0000, v197
    v_lshlrev_b32 v96, 16, v198
    v_and_b32 v97, 0xffff0000, v198
    v_lshlrev_b32 v98, 16, v199
    v_and_b32 v99, 0xffff0000, v199
    v_add_u32 v12, 0, v3
    s_add_u32 s4, s23, 0
    v_add_u32 v11, s4, v2
    s_call_b64 s[100:101], XS_sub
    s_add_u32 s27, s27, 655360
    s_waitcnt vmcnt(0)
    s_barrier
    s_lshl_b32 s4, s21, 7
    s_add_u32 s4, s4, 65536
    v_mov_b32 v16, s36
    v_lshlrev_b32 v17, 2, v1
    s_cmp_eq_u32 s3, 0
    s_cselect_b64 exec, 1, 0
    buffer_store_dword v16, v17, s[8:11], s4 offen sc1
    s_mov_b64 exec, -1
    s_mov_b32 s28, s21
    s_add_u32 s21, s21, 20
XD_ml:
    s_mul_i32 s4, s3, 1228800
    s_lshl_b32 s5, s21, 7
    s_add_u32 s4, s4, s5
    s_add_u32 m0, s22, 0
    s_nop 0
    buffer_load_dwordx4 v14, s[16:19], s4 offen nt lds
    s_add_u32 s4, s4, 61440
    s_add_u32 m0, s22, 1024
    s_nop 0
    buffer_load_dwordx4 v14, s[16:19], s4 offen nt lds
    s_add_u32 s4, s4, 61440
    s_add_u32 m0, s22, 2048
    s_nop 0
    buffer_load_dwordx4 v15, s[16:19], s4 offen nt lds
    s_add_u32 s4, s4, 61440
    s_add_u32 m0, s22, 3072
    s_nop 0
    buffer_load_dwordx4 v15, s[16:19], s4 offen nt lds
    s_add_u32 s4, s4, 61440
    s_add_u32 m0, s22, 4096
    s_nop 0
    buffer_load_dwordx4 v14, s[16:19], s4 offen nt lds
    s_add_u32 s4, s4, 61440
    s_add_u32 m0, s22, 5120
    s_nop 0
    buffer_load_dwordx4 v14, s[16:19], s4 offen nt lds
    s_add_u32 s4, s4, 61440
    s_add_u32 m0, s22, 6144
    s_nop 0
    buffer_load_dwordx4 v15, s[16:19], s4 offen nt lds
    s_add_u32 s4, s4, 61440
    s_add_u32 m0, s22, 7168
    s_nop 0
    buffer_load_dwordx4 v15, s[16:19], s4 offen nt lds
    s_add_u32 s4, s4, 61440
    s_add_u32 m0, s22, 8192
    s_nop 0
    buffer_load_dwordx4 v14, s[16:19], s4 offen nt lds
    s_add_u32 s4, s4, 61440
    s_add_u32 m0, s22, 9216
    s_nop 0
    buffer_load_dwordx4 v14, s[16:19], s4 offen nt lds
    s_add_u32 s4, s4, 61440
    s_add_u32 m0, s22, 10240
    s_nop 0
    buffer_load_dwordx4 v15, s[16:19], s4 offen nt lds
    s_add_u32 s4, s4, 61440
    s_add_u32 m0, s22, 11264
    s_nop 0
    buffer_load_dwordx4 v15, s[16:19], s4 offen nt lds
    s_add_u32 s4, s4, 61440
    s_add_u32 m0, s22, 12288
    s_nop 0
    buffer_load_dwordx4 v14, s[16:19], s4 offen nt lds
    s_add_u32 s4, s4, 61440
    s_add_u32 m0, s22, 13312
    s_nop 0
    buffer_load_dwordx4 v14, s[16:19], s4 offen nt lds
    s_add_u32 s4, s4, 61440
    s_add_u32 m0, s22, 14336
    s_nop 0
    buffer_load_dwordx4 v15, s[16:19], s4 offen nt lds
    s_add_u32 s4, s4, 61440
    s_add_u32 m0, s22, 15360
    s_nop 0
    buffer_load_dwordx4 v15, s[16:19], s4 offen nt lds
    s_add_u32 s4, s4, 61440
    s_add_u32 m0, s22, 16384
    s_nop 0
    buffer_load_dwordx4 v14, s[16:19], s4 offen nt lds
    s_add_u32 s4, s4, 61440
    s_add_u32 m0, s22, 17408
    s_nop 0
    buffer_load_dwordx4 v14, s[16:19], s4 offen nt lds
    s_add_u32 s4, s4, 61440
    s_add_u32 m0, s22, 18432
    s_nop 0
    buffer_load_dwordx4 v15, s[16:19], s4 offen nt lds
    s_add_u32 s4, s4, 61440
    s_add_u32 m0, s22, 19456
    s_nop 0
    buffer_load_dwordx4 v15, s[16:19], s4 offen nt lds
    s_add_u32 s4, s4, 61440
    s_waitcnt vmcnt(0)
    ds_read_b64_tr_b16 a[0:1], v32 offset:0
    ds_read_b64_tr_b16 a[2:3], v32 offset:256
    ds_read_b64_tr_b16 a[4:5], v33 offset:0
    ds_read_b64_tr_b16 a[6:7], v33 offset:256
    ds_read_b64_tr_b16 a[8:9], v34 offset:0
    ds_read_b64_tr_b16 a[10:11], v34 offset:256
    ds_read_b64_tr_b16 a[12:13], v35 offset:0
    ds_read_b64_tr_b16 a[14:15], v35 offset:256
    ds_read_b64_tr_b16 a[16:17], v32 offset:4096
    ds_read_b64_tr_b16 a[18:19], v32 offset:4352
    ds_read_b64_tr_b16 a[20:21], v33 offset:4096
    ds_read_b64_tr_b16 a[22:23], v33 offset:4352
    ds_read_b64_tr_b16 a[24:25], v34 offset:4096
    ds_read_b64_tr_b16 a[26:27], v34 offset:4352
    s_waitcnt lgkmcnt(12)
    v_mfma_f32_16x16x32_bf16 v[16:19], a[0:3], v[220:223], 0
    ds_read_b64_tr_b16 a[28:29], v35 offset:4096
    ds_read_b64_tr_b16 a[30:31], v35 offset:4352
    s_waitcnt lgkmcnt(12)
    v_mfma_f32_16x16x32_bf16 v[20:23], a[4:7], v[220:223], 0
    ds_read_b64_tr_b16 a[32:33], v32 offset:8192
    ds_read_b64_tr_b16 a[34:35], v32 offset:8448
    s_waitcnt lgkmcnt(12)
    v_mfma_f32_16x16x32_bf16 v[24:27], a[8:11], v[220:223], 0
    ds_read_b64_tr_b16 a[36:37], v33 offset:8192
    ds_read_b64_tr_b16 a[38:39], v33 offset:8448
    s_waitcnt lgkmcnt(12)
    v_mfma_f32_16x16x32_bf16 v[28:31], a[12:15], v[220:223], 0
    ds_read_b64_tr_b16 a[40:41], v34 offset:8192
    ds_read_b64_tr_b16 a[42:43], v34 offset:8448
    s_waitcnt lgkmcnt(12)
    v_mfma_f32_16x16x32_bf16 v[16:19], a[16:19], v[224:227], v[16:19]
    ds_read_b64_tr_b16 a[44:45], v35 offset:8192
    ds_read_b64_tr_b16 a[46:47], v35 offset:8448
    s_waitcnt lgkmcnt(12)
    v_mfma_f32_16x16x32_bf16 v[20:23], a[20:23], v[224:227], v[20:23]
    ds_read_b64_tr_b16 a[48:49], v32 offset:12288
    ds_read_b64_tr_b16 a[50:51], v32 offset:12544
    s_waitcnt lgkmcnt(12)
    v_mfma_f32_16x16x32_bf16 v[24:27], a[24:27], v[224:227], v[24:27]
    ds_read_b64_tr_b16 a[52:53], v33 offset:12288
    ds_read_b64_tr_b16 a[54:55], v33 offset:12544
    s_waitcnt lgkmcnt(12)
    v_mfma_f32_16x16x32_bf16 v[28:31], a[28:31], v[224:227], v[28:31]
    ds_read_b64_tr_b16 a[56:57], v34 offset:12288
    ds_read_b64_tr_b16 a[58:59], v34 offset:12544
    s_waitcnt lgkmcnt(12)
    v_mfma_f32_16x16x32_bf16 v[16:19], a[32:35], v[228:231], v[16:19]
    ds_read_b64_tr_b16 a[60:61], v35 offset:12288
    ds_read_b64_tr_b16 a[62:63], v35 offset:12544
    s_waitcnt lgkmcnt(12)
    v_mfma_f32_16x16x32_bf16 v[20:23], a[36:39], v[228:231], v[20:23]
    ds_read_b64_tr_b16 a[64:65], v32 offset:16384
    ds_read_b64_tr_b16 a[66:67], v32 offset:16640
    s_waitcnt lgkmcnt(12)
    v_mfma_f32_16x16x32_bf16 v[24:27], a[40:43], v[228:231], v[24:27]
    ds_read_b64_tr_b16 a[68:69], v33 offset:16384
    ds_read_b64_tr_b16 a[70:71], v33 offset:16640
    s_waitcnt lgkmcnt(12)
    v_mfma_f32_16x16x32_bf16 v[28:31], a[44:47], v[228:231], v[28:31]
    ds_read_b64_tr_b16 a[72:73], v34 offset:16384
    ds_read_b64_tr_b16 a[74:75], v34 offset:16640
    s_waitcnt lgkmcnt(12)
    v_mfma_f32_16x16x32_bf16 v[16:19], a[48:51], v[232:235], v[16:19]
    ds_read_b64_tr_b16 a[76:77], v35 offset:16384
    ds_read_b64_tr_b16 a[78:79], v35 offset:16640
    s_waitcnt lgkmcnt(12)
    v_mfma_f32_16x16x32_bf16 v[20:23], a[52:55], v[232:235], v[20:23]
    s_waitcnt lgkmcnt(10)
    v_mfma_f32_16x16x32_bf16 v[24:27], a[56:59], v[232:235], v[24:27]
    s_waitcnt lgkmcnt(8)
    v_mfma_f32_16x16x32_bf16 v[28:31], a[60:63], v[232:235], v[28:31]
    s_waitcnt lgkmcnt(6)
    v_mfma_f32_16x16x32_bf16 v[16:19], a[64:67], v[236:239], v[16:19]
    s_waitcnt lgkmcnt(4)
    v_mfma_f32_16x16x32_bf16 v[20:23], a[68:71], v[236:239], v[20:23]
    s_waitcnt lgkmcnt(2)
    v_mfma_f32_16x16x32_bf16 v[24:27], a[72:75], v[236:239], v[24:27]
    s_waitcnt lgkmcnt(0)
    v_mfma_f32_16x16x32_bf16 v[28:31], a[76:79], v[236:239], v[28:31]
    s_mov_b32 exec_lo, 0x00010001
    s_mov_b32 exec_hi, 0x00010001
    ds_write_b128 v37, v[16:19] offset:0
    ds_write_b128 v37, v[20:23] offset:64
    ds_write_b128 v37, v[24:27] offset:128
    s_nop 2
    ds_write_b128 v37, v[28:31] offset:192
    s_mov_b64 exec, -1
    s_waitcnt lgkmcnt(0)
    s_barrier
    s_cmp_lg_u32 s3, 0
    s_cbranch_scc1 XD_r2
    ds_read_b32 v16, v38 offset:0
    ds_read_b32 v17, v38 offset:20480
    ds_read_b32 v18, v38 offset:40960
    ds_read_b32 v19, v38 offset:61440
    s_lshl_b32 s4, s21, 8
    s_add_u32 s4, s4, 0
    s_lshl_b32 s5, s21, 7
    s_add_u32 s5, s5, 32768
    s_mov_b32 s6, 0x55555555
    s_cmp_ge_u32 s21, 10
    s_cselect_b32 s7, 1.0, 0
    s_waitcnt lgkmcnt(0)
    v_add_f32 v16, v16, v17
    v_add_f32 v18, v18, v19
    v_add_f32 v16, v16, v18
    v_cvt_pk_bf16_f32 v16, v16, v16
    v_and_b32 v16, 0xffff0000, v16
    v_add_f32 v18, s7, v16
    s_nop 1
    v_mov_b32 v17, v18 quad_perm:[1,1,3,3] row_mask:0xf bank_mask:0xf
    v_cvt_pk_bf16_f32 v17, v18, v17
    s_mov_b32 exec_lo, s6
    s_mov_b32 exec_hi, s6
    buffer_store_dword v17, v36, s[8:11], s5 offen sc1
    s_mov_b64 exec, -1
    buffer_store_dword v16, v38, s[8:11], s4 offen sc1
XD_r2:
    s_barrier
    s_add_u32 s21, s21, 32
    s_cmp_lt_u32 s21, 60
    s_cbranch_scc1 XD_ml
    s_waitcnt vmcnt(0)
    s_lshl_b32 s4, s28, 7
    s_add_u32 s4, s4, 65540
    v_mov_b32 v16, 1
    v_lshlrev_b32 v17, 2, v1
    s_cmp_eq_u32 s3, 0
    s_cselect_b64 exec, 1, 0
    buffer_store_dword v16, v17, s[8:11], s4 offen sc1
    s_mov_b64 exec, -1
    v_and_b32 v16, 7, v1
    v_lshlrev_b32 v16, 5, v16
    buffer_load_dwordx4 v[20:23], v16, s[84:87], 0 offen sc1
    s_mov_b32 s31, 0
    s_waitcnt vmcnt(0)
    s_branch XJ_c
XJ_l:
    buffer_load_dwordx4 v[20:23], v16, s[84:87], 0 offen sc1
    s_waitcnt vmcnt(0)
XJ_c:
    v_bcnt_u32_b32 v17, v20, v23
    v_cmp_lt_u32 s[4:5], 32, v17
    s_and_b32 s6, s4, 0xff
    v_cmp_ne_u32 s[4:5], 32, v17
    s_cmp_eq_u32 s6, 0
    s_cselect_b32 s5, 0xff, 0
    s_and_b32 s4, s4, s5
    v_add_u32 v21, v21, v22
    v_cmp_gt_u32 vcc, 32, v21
    s_and_b32 vcc_lo, vcc_lo, 0xff
    s_or_b32 vcc_lo, vcc_lo, s4
    s_mov_b32 vcc_hi, 0
    s_cbranch_vccz XJ_o
    s_sleep 16
    s_add_u32 s31, s31, 1
    s_cmp_lt_u32 s31, s30
    s_cbranch_scc1 XJ_l
    s_mov_b32 s30, 1
XJ_o:
    s_mov_b32 s97, s6
    s_mul_i32 s22, s99, 1048576
    s_add_u32 s22, s22, 8388608
    s_sub_u32 s34, s20, 28
    s_lshl_b32 s20, s99, 2
    s_add_u32 s20, s20, s34
    s_mov_b32 s28, s34
    s_lshl_b32 s96, s99, 2
    s_add_u32 s96, s96, s3
    s_and_b32 s34, s34, 1
    s_lshl_b32 s34, s34, 1
    s_lshr_b32 s4, s3, 1
    s_add_u32 s34, s34, s4
    s_and_b32 s32, s3, 1
    s_mul_i32 s4, s34, 48
    s_add_u32 s4, s4, 155648
    v_min_u32 v15, 11, v1
    v_lshl_add_u32 v15, v15, 2, s4
    s_mov_b32 s43, 0
    s_barrier
    v_mov_b32 v9, 0
    s_cmp_lt_u32 s28, 2
    s_cbranch_scc1 XM2_o
    v_and_b32 v16, 31, v1
    v_lshlrev_b32 v16, 7, v16
    s_mov_b32 s23, 65540
    s_mov_b32 s31, 0
XM2_l:
    buffer_load_dword v17, v16, s[8:11], s23 offen sc1
    s_waitcnt vmcnt(0)
XM2_c:
    v_cmp_gt_u32 vcc, 1, v17
    s_cbranch_vccz XM2_o
    s_sleep 8
    s_add_u32 s31, s31, 1
    s_cmp_lt_u32 s31, s30
    s_cbranch_scc1 XM2_l
    s_mov_b32 s30, 1
XM2_o:
    s_load_dwordx2 s[12:13], s[0:1], 0
    s_load_dwordx2 s[16:17], s[0:1], 112
    s_mov_b32 s14, 2621440
    s_mov_b32 s15, 0x20000
    s_mov_b32 s18, 2621440
    s_mov_b32 s19, 0x20000
    s_waitcnt lgkmcnt(0)
    s_load_dwordx2 s[84:85], s[0:1], 72
    s_load_dwordx2 s[88:89], s[0:1], 80
    s_load_dwordx2 s[92:93], s[0:1], 88
    s_mov_b32 s86, 1966080
    s_mov_b32 s87, 0x20000
    s_mov_b32 s90, 1966080
    s_mov_b32 s91, 0x20000
    s_mov_b32 s94, 1966080
    s_mov_b32 s95, 0x20000
    s_waitcnt lgkmcnt(0)
    v_mul_u32_u24 v4, 43, v1
    v_lshrrev_b32 v4, 8, v4
    v_mul_u32_u24 v5, 6, v4
    v_sub_u32 v5, v1, v5
    v_mul_u32_u24 v0, 3072, v4
    v_lshl_add_u32 v0, v5, 4, v0
    s_mul_i32 s98, s3, 491520
    s_mul_i32 s5, s20, 96
    s_add_u32 s98, s98, s5
    s_mul_i32 s99, s3, 30720
    s_add_u32 s99, s99, 40960
    s_lshl_b32 s23, s20, 2
    s_add_u32 s23, s23, s3
    s_mul_i32 s23, s23, 15360
    s_mov_b32 s44, 0
    s_mov_b32 s45, 0
    s_mov_b32 s46, 0
    s_mov_b32 s47, 0
    s_mov_b32 s38, 0
    s_mov_b32 s39, 0
    s_mov_b32 s48, 0
    s_mov_b32 s49, 0
    s_cmp_ge_u32 s28, 2
    s_cbranch_scc1 X3_go
    s_cmp_lg_u32 s97, 0
    s_cbranch_scc1 Xs_go
Xf_go:
    s_mul_i32 s26, s34, 12288
    s_add_u32 s26, s26, 356352
    s_lshl_b32 s4, s32, 9
    s_add_u32 s4, s4, 3072
    v_and_b32 v16, 0x1f0, v2
    v_add_u32 v16, s4, v16
    s_lshl_b32 s4, s32, 10
    v_add_u32 v17, s4, v2
    v_lshrrev_b32 v56, 4, v1
    v_lshlrev_b32 v57, 2, v56
    v_and_b32 v58, 15, v1
    v_sub_u32 v57, v57, v58
    s_lshl_b32 s4, s32, 4
    v_subrev_u32 v57, s4, v57
    v_and_b32 v56, 0x1f0, v2
    v_mov_b32 v58, 0xff800000
    s_lshl_b32 s37, s34, 1
    s_add_u32 s37, s37, s32
    s_lshl_b32 s37, s37, 10
    s_and_b32 s40, s34, 2
    s_add_u32 s40, s40, s32
    s_lshl_b32 s40, s40, 9
    s_and_b32 s4, s34, 1
    s_lshl_b32 s4, s4, 3
    s_add_u32 s40, s40, s4
    s_add_u32 s40, s40, 413696
    s_add_u32 s37, s37, 405504
    s_mov_b32 s41, 0x3dd53b95
    s_mov_b32 s21, 0
Xf_loop:
    s_and_b32 s36, s21, 3
    s_lshl_b32 s36, s36, 16
    s_add_u32 s36, s36, s22
    s_add_u32 s35, s36, s26
    s_add_u32 s21, s21, 1
    s_mov_b32 s31, 0
Xfw_l:
    buffer_load_dword v18, v15, s[8:11], s22 offen sc1
    s_waitcnt vmcnt(0)
Xfw_c:
    v_cmp_gt_u32 vcc, s21, v18
    s_cbranch_vccz Xfw_o
    s_sleep 1
    s_add_u32 s31, s31, 1
    s_cmp_lt_u32 s31, s30
    s_cbranch_scc1 Xfw_l
    s_mov_b32 s30, 1
Xfw_o:
    s_add_u32 s4, s35, 0
    buffer_load_dwordx4 v[60:63], v16, s[8:11], s4 offen offset:0 sc1
    buffer_load_dwordx4 v[64:67], v17, s[8:11], s4 offen offset:0 sc1
    buffer_load_dwordx4 v[68:71], v17, s[8:11], s4 offen offset:1024 sc1
    s_add_u32 s4, s35, 4096
    buffer_load_dwordx4 v[72:75], v16, s[8:11], s4 offen offset:0 sc1
    buffer_load_dwordx4 v[76:79], v17, s[8:11], s4 offen offset:0 sc1
    buffer_load_dwordx4 v[80:83], v17, s[8:11], s4 offen offset:1024 sc1
    s_add_u32 s4, s35, 8192
    buffer_load_dwordx4 v[84:87], v16, s[8:11], s4 offen offset:0 sc1
    buffer_load_dwordx4 v[88:91], v17, s[8:11], s4 offen offset:0 sc1
    buffer_load_dwordx4 v[92:95], v17, s[8:11], s4 offen offset:1024 sc1
    s_add_u32 s5, s36, s37
    s_add_u32 s6, s36, s40
    s_waitcnt vmcnt(3)
    v_pk_add_f32 v[60:61], v[60:61], v[72:73]
    v_pk_add_f32 v[62:63], v[62:63], v[74:75]
    v_pk_add_f32 v[64:65], v[64:65], v[76:77]
    v_pk_add_f32 v[66:67], v[66:67], v[78:79]
    v_pk_add_f32 v[68:69], v[68:69], v[80:81]
    v_pk_add_f32 v[70:71], v[70:71], v[82:83]
    s_waitcnt vmcnt(0)
    v_pk_add_f32 v[60:61], v[60:61], v[84:85]
    v_pk_add_f32 v[62:63], v[62:63], v[86:87]
    v_pk_add_f32 v[64:65], v[64:65], v[88:89]
    v_pk_add_f32 v[66:67], v[66:67], v[90:91]
    v_pk_add_f32 v[68:69], v[68:69], v[92:93]
    v_pk_add_f32 v[70:71], v[70:71], v[94:95]
    v_cmp_lt_u32 vcc, 31, v1
    s_nop 1
    v_cndmask_b32 v60, v58, v60, vcc
    v_cndmask_b32 v61, v58, v61, vcc
    v_cndmask_b32 v62, v58, v62, vcc
    v_cndmask_b32 v63, v58, v63, vcc
    v_cmp_ge_i32 vcc, 0, v57
    s_nop 1
    v_cndmask_b32 v64, v58, v64, vcc
    v_cmp_ge_i32 vcc, -1, v57
    s_nop 1
    v_cndmask_b32 v65, v58, v65, vcc
    v_cmp_ge_i32 vcc, -2, v57
    s_nop 1
    v_cndmask_b32 v66, v58, v66, vcc
    v_cmp_ge_i32 vcc, -3, v57
    s_nop 1
    v_cndmask_b32 v67, v58, v67, vcc
    v_cmp_ge_i32 vcc, -16, v57
    s_nop 1
    v_cndmask_b32 v68, v58, v68, vcc
    v_cmp_ge_i32 vcc, -17, v57
    s_nop 1
    v_cndmask_b32 v69, v58, v69, vcc
    v_cmp_ge_i32 vcc, -18, v57
    s_nop 1
    v_cndmask_b32 v70, v58, v70, vcc
    v_cmp_ge_i32 vcc, -19, v57
    s_nop 1
    v_cndmask_b32 v71, v58, v71, vcc
    v_max_f32 v44, v60, v61
    v_max3_f32 v44, v44, v62, v63
    v_max3_f32 v44, v44, v64, v65
    v_max3_f32 v44, v44, v66, v67
    v_max3_f32 v44, v44, v68, v69
    v_max3_f32 v44, v44, v70, v71
    v_mov_b32 v45, v44
    s_nop 1
    v_permlane16_swap_b32 v44, v45
    v_max_f32 v44, v44, v45
    v_mov_b32 v45, v44
    s_nop 1
    v_permlane32_swap_b32 v44, v45
    v_max_f32 v44, v44, v45
    v_mul_f32 v44, s41, v44
    v_fma_f32 v60, v60, s41, -v44
    v_fma_f32 v61, v61, s41, -v44
    v_fma_f32 v62, v62, s41, -v44
    v_fma_f32 v63, v63, s41, -v44
    v_fma_f32 v64, v64, s41, -v44
    v_fma_f32 v65, v65, s41, -v44
    v_fma_f32 v66, v66, s41, -v44
    v_fma_f32 v67, v67, s41, -v44
    v_fma_f32 v68, v68, s41, -v44
    v_fma_f32 v69, v69, s41, -v44
    v_fma_f32 v70, v70, s41, -v44
    v_fma_f32 v71, v71, s41, -v44
    v_exp_f32 v60, v60
    v_exp_f32 v61, v61
    v_exp_f32 v62, v62
    v_exp_f32 v63, v63
    v_exp_f32 v64, v64
    v_exp_f32 v65, v65
    v_exp_f32 v66, v66
    v_exp_f32 v67, v67
    v_exp_f32 v68, v68
    v_exp_f32 v69, v69
    v_exp_f32 v70, v70
    v_exp_f32 v71, v71
    v_add_f32 v44, v60, v61
    v_add_f32 v44, v44, v62
    v_add_f32 v44, v44, v63
    v_add_f32 v44, v44, v64
    v_add_f32 v44, v44, v65
    v_add_f32 v44, v44, v66
    v_add_f32 v44, v44, v67
    v_add_f32 v44, v44, v68
    v_add_f32 v44, v44, v69
    v_add_f32 v44, v44, v70
    v_add_f32 v44, v44, v71
    v_mov_b32 v45, v44
    s_nop 1
    v_permlane16_swap_b32 v44, v45
    v_add_f32 v44, v44, v45
    v_mov_b32 v45, v44
    s_nop 1
    v_permlane32_swap_b32 v44, v45
    v_add_f32 v44, v44, v45
    v_rcp_f32 v44, v44
    s_nop 0
    v_mul_f32 v60, v60, v44
    v_mul_f32 v61, v61, v44
    v_mul_f32 v62, v62, v44
    v_mul_f32 v63, v63, v44
    v_mul_f32 v64, v64, v44
    v_mul_f32 v65, v65, v44
    v_mul_f32 v66, v66, v44
    v_mul_f32 v67, v67, v44
    v_mul_f32 v68, v68, v44
    v_mul_f32 v69, v69, v44
    v_mul_f32 v70, v70, v44
    v_mul_f32 v71, v71, v44
    v_cvt_pk_bf16_f32 v48, v64, v65
    v_cvt_pk_bf16_f32 v49, v68, v69
    v_cvt_pk_bf16_f32 v50, v66, v67
    v_cvt_pk_bf16_f32 v51, v70, v71
    v_cvt_pk_bf16_f32 v52, v60, v61
    v_cvt_pk_bf16_f32 v53, v62, v63
    buffer_store_dwordx4 v[48:51], v2, s[8:11], s5 offen offset:0
    s_mov_b32 exec_lo, 0
    buffer_store_dwordx2 v[52:53], v56, s[8:11], s6 offen offset:0
    s_mov_b64 exec, -1
    s_waitcnt vmcnt(0)
    v_mov_b32 v10, s21
    s_mov_b64 exec, 1
    buffer_store_dword v10, v9, s[8:11], s33 offen
    s_mov_b64 exec, -1
    s_cmp_eq_u32 s21, 64
    s_cbranch_scc1 X_join
    s_bitcmp1_b32 s21, 0
    s_cbranch_scc1 Xf_loop
    s_lshr_b32 s29, s21, 1
    s_sub_u32 s29, s29, 2
    s_cbranch_scc1 Xf_loop
    s_cmp_lt_u32 s29, 2
    s_cbranch_scc1 Xfb_e
    s_cmp_lt_u32 s29, 10
    s_cbranch_scc0 Xfb_a
    s_mov_b32 exec_hi, 0x0fffffff
    s_add_u32 m0, s99, 0
    s_nop 0
    buffer_load_dwordx4 v0, s[84:87], s98 offen nt lds
    s_add_u32 m0, s99, 15360
    s_nop 0
    buffer_load_dwordx4 v0, s[88:91], s98 offen nt lds
    s_add_u32 s98, s98, 30720
    s_add_u32 s99, s99, 960
    s_add_u32 m0, s99, 0
    s_nop 0
    buffer_load_dwordx4 v0, s[84:87], s98 offen nt lds
    s_add_u32 m0, s99, 15360
    s_nop 0
    buffer_load_dwordx4 v0, s[88:91], s98 offen nt lds
    s_add_u32 s98, s98, 30720
    s_add_u32 s99, s99, 960
    s_mov_b64 exec, -1
Xfb_a:
    s_cmp_eq_u32 s29, 11
    s_cbranch_scc0 Xfb_b
    s_waitcnt vmcnt(0)
    v_lshrrev_b32 v12, 4, v1
    v_lshlrev_b32 v12, 3, v12
    v_bfe_u32 v13, v1, 2, 2
    v_add_u32 v12, v12, v13
    v_mul_u32_u24 v12, 96, v12
    v_and_b32 v13, 3, v1
    v_lshlrev_b32 v13, 3, v13
    v_add_u32 v12, v12, v13
    s_mul_i32 s4, s3, 30720
    s_add_u32 s4, s4, 40960
    v_add_u32 v12, s4, v12
    ds_read_b64_tr_b16 a[0:1], v12 offset:0
    ds_read_b64_tr_b16 a[2:3], v12 offset:384
    ds_read_b64_tr_b16 a[4:5], v12 offset:3072
    ds_read_b64_tr_b16 a[6:7], v12 offset:3456
    ds_read_b64_tr_b16 a[8:9], v12 offset:6144
    ds_read_b64_tr_b16 a[10:11], v12 offset:6528
    ds_read_b64_tr_b16 a[12:13], v12 offset:9216
    ds_read_b64_tr_b16 a[14:15], v12 offset:9600
    ds_read_b64_tr_b16 a[16:17], v12 offset:12288
    ds_read_b64_tr_b16 a[18:19], v12 offset:12672
    ds_read_b64_tr_b16 a[20:21], v12 offset:15360
    ds_read_b64_tr_b16 a[22:23], v12 offset:15744
    ds_read_b64_tr_b16 a[24:25], v12 offset:18432
    ds_read_b64_tr_b16 a[26:27], v12 offset:18816
    ds_read_b64_tr_b16 a[28:29], v12 offset:21504
    ds_read_b64_tr_b16 a[30:31], v12 offset:21888
    ds_read_b64_tr_b16 a[32:33], v12 offset:24576
    ds_read_b64_tr_b16 a[34:35], v12 offset:24960
    ds_read_b64_tr_b16 a[36:37], v12 offset:27648
    ds_read_b64_tr_b16 a[38:39], v12 offset:28032
    ds_read_b64_tr_b16 a[40:41], v12 offset:32
    ds_read_b64_tr_b16 a[42:43], v12 offset:416
    ds_read_b64_tr_b16 a[44:45], v12 offset:3104
    ds_read_b64_tr_b16 a[46:47], v12 offset:3488
    ds_read_b64_tr_b16 a[48:49], v12 offset:6176
    ds_read_b64_tr_b16 a[50:51], v12 offset:6560
    ds_read_b64_tr_b16 a[52:53], v12 offset:9248
    ds_read_b64_tr_b16 a[54:55], v12 offset:9632
    ds_read_b64_tr_b16 a[56:57], v12 offset:12320
    ds_read_b64_tr_b16 a[58:59], v12 offset:12704
    ds_read_b64_tr_b16 a[60:61], v12 offset:15392
    ds_read_b64_tr_b16 a[62:63], v12 offset:15776
    ds_read_b64_tr_b16 a[64:65], v12 offset:18464
    ds_read_b64_tr_b16 a[66:67], v12 offset:18848
    ds_read_b64_tr_b16 a[68:69], v12 offset:21536
    ds_read_b64_tr_b16 a[70:71], v12 offset:21920
    ds_read_b64_tr_b16 a[72:73], v12 offset:24608
    ds_read_b64_tr_b16 a[74:75], v12 offset:24992
    ds_read_b64_tr_b16 a[76:77], v12 offset:27680
    ds_read_b64_tr_b16 a[78:79], v12 offset:28064
    ds_read_b64_tr_b16 a[80:81], v12 offset:64
    ds_read_b64_tr_b16 a[82:83], v12 offset:448
    ds_read_b64_tr_b16 a[84:85], v12 offset:3136
    ds_read_b64_tr_b16 a[86:87], v12 offset:3520
    ds_read_b64_tr_b16 a[88:89], v12 offset:6208
    ds_read_b64_tr_b16 a[90:91], v12 offset:6592
    ds_read_b64_tr_b16 a[92:93], v12 offset:9280
    ds_read_b64_tr_b16 a[94:95], v12 offset:9664
    ds_read_b64_tr_b16 a[96:97], v12 offset:12352
    ds_read_b64_tr_b16 a[98:99], v12 offset:12736
    ds_read_b64_tr_b16 a[100:101], v12 offset:15424
    ds_read_b64_tr_b16 a[102:103], v12 offset:15808
    ds_read_b64_tr_b16 a[104:105], v12 offset:18496
    ds_read_b64_tr_b16 a[106:107], v12 offset:18880
    ds_read_b64_tr_b16 a[108:109], v12 offset:21568
    ds_read_b64_tr_b16 a[110:111], v12 offset:21952
    ds_read_b64_tr_b16 a[112:113], v12 offset:24640
    ds_read_b64_tr_b16 a[114:115], v12 offset:25024
    ds_read_b64_tr_b16 a[116:117], v12 offset:27712
    ds_read_b64_tr_b16 a[118:119], v12 offset:28096
    v_lshrrev_b32 v4, 2, v1
    v_mul_u32_u24 v4, 1280, v4
    v_and_b32 v5, 3, v1
    v_lshl_add_u32 v0, v5, 4, v4
    s_mul_i32 s4, s3, 491520
    s_lshl_b32 s5, s20, 6
    s_add_u32 s98, s4, s5
    s_mul_i32 s99, s3, 30720
    s_add_u32 s99, s99, 40960
    s_waitcnt lgkmcnt(0)
Xfb_b:
    s_sub_u32 s4, s29, 12
    s_cmp_lt_u32 s4, 8
    s_cbranch_scc0 Xfb_d
    s_cmp_ge_u32 s20, 20
    s_cbranch_scc1 Xfb_d
    s_mov_b32 m0, s99
    s_add_u32 s99, s99, 1024
    buffer_load_dwordx4 v0, s[92:95], s98 offen nt lds
    s_add_u32 s98, s98, 20480
    s_mov_b32 m0, s99
    s_add_u32 s99, s99, 1024
    buffer_load_dwordx4 v0, s[92:95], s98 offen nt lds
    s_add_u32 s98, s98, 20480
    s_mov_b32 m0, s99
    s_add_u32 s99, s99, 1024
    buffer_load_dwordx4 v0, s[92:95], s98 offen nt lds
    s_add_u32 s98, s98, 20480
Xfb_d:
    s_cmp_eq_u32 s29, 21
    s_cbranch_scc0 Xfb_c
    s_waitcnt vmcnt(0)
    v_lshrrev_b32 v12, 4, v1
    v_lshlrev_b32 v12, 3, v12
    v_bfe_u32 v13, v1, 2, 2
    v_add_u32 v12, v12, v13
    v_mul_u32_u24 v12, 64, v12
    v_and_b32 v13, 3, v1
    v_lshlrev_b32 v13, 3, v13
    v_add_u32 v12, v12, v13
    s_mul_i32 s4, s3, 30720
    s_add_u32 s4, s4, 40960
    v_add_u32 v12, s4, v12
    ds_read_b64_tr_b16 a[120:121], v12 offset:0
    ds_read_b64_tr_b16 a[122:123], v12 offset:256
    ds_read_b64_tr_b16 a[124:125], v12 offset:2048
    ds_read_b64_tr_b16 a[126:127], v12 offset:2304
    ds_read_b64_tr_b16 a[128:129], v12 offset:4096
    ds_read_b64_tr_b16 a[130:131], v12 offset:4352
    ds_read_b64_tr_b16 a[132:133], v12 offset:6144
    ds_read_b64_tr_b16 a[134:135], v12 offset:6400
    ds_read_b64_tr_b16 a[136:137], v12 offset:8192
    ds_read_b64_tr_b16 a[138:139], v12 offset:8448
    ds_read_b64_tr_b16 a[140:141], v12 offset:10240
    ds_read_b64_tr_b16 a[142:143], v12 offset:10496
    ds_read_b64_tr_b16 a[144:145], v12 offset:12288
    ds_read_b64_tr_b16 a[146:147], v12 offset:12544
    ds_read_b64_tr_b16 a[148:149], v12 offset:14336
    ds_read_b64_tr_b16 a[150:151], v12 offset:14592
    ds_read_b64_tr_b16 a[152:153], v12 offset:16384
    ds_read_b64_tr_b16 a[154:155], v12 offset:16640
    ds_read_b64_tr_b16 a[156:157], v12 offset:18432
    ds_read_b64_tr_b16 a[158:159], v12 offset:18688
    ds_read_b64_tr_b16 a[160:161], v12 offset:20480
    ds_read_b64_tr_b16 a[162:163], v12 offset:20736
    ds_read_b64_tr_b16 a[164:165], v12 offset:22528
    ds_read_b64_tr_b16 a[166:167], v12 offset:22784
    ds_read_b64_tr_b16 a[168:169], v12 offset:32
    ds_read_b64_tr_b16 a[170:171], v12 offset:288
    ds_read_b64_tr_b16 a[172:173], v12 offset:2080
    ds_read_b64_tr_b16 a[174:175], v12 offset:2336
    ds_read_b64_tr_b16 a[176:177], v12 offset:4128
    ds_read_b64_tr_b16 a[178:179], v12 offset:4384
    ds_read_b64_tr_b16 a[180:181], v12 offset:6176
    ds_read_b64_tr_b16 a[182:183], v12 offset:6432
    ds_read_b64_tr_b16 a[184:185], v12 offset:8224
    ds_read_b64_tr_b16 a[186:187], v12 offset:8480
    ds_read_b64_tr_b16 a[188:189], v12 offset:10272
    ds_read_b64_tr_b16 a[190:191], v12 offset:10528
    ds_read_b64_tr_b16 a[192:193], v12 offset:12320
    ds_read_b64_tr_b16 a[194:195], v12 offset:12576
    ds_read_b64_tr_b16 a[196:197], v12 offset:14368
    ds_read_b64_tr_b16 a[198:199], v12 offset:14624
    ds_read_b64_tr_b16 a[200:201], v12 offset:16416
    ds_read_b64_tr_b16 a[202:203], v12 offset:16672
    ds_read_b64_tr_b16 a[204:205], v12 offset:18464
    ds_read_b64_tr_b16 a[206:207], v12 offset:18720
    ds_read_b64_tr_b16 a[208:209], v12 offset:20512
    ds_read_b64_tr_b16 a[210:211], v12 offset:20768
    ds_read_b64_tr_b16 a[212:213], v12 offset:22560
    ds_read_b64_tr_b16 a[214:215], v12 offset:22816
    s_waitcnt lgkmcnt(0)
Xfb_c:
Xfb_e:
    s_branch Xf_loop
Xs_go:
    s_mul_i32 s26, s34, 12288
    s_add_u32 s26, s26, 356352
    s_lshl_b32 s4, s32, 9
    s_add_u32 s4, s4, 3072
    v_and_b32 v16, 0x1f0, v2
    v_add_u32 v16, s4, v16
    s_lshl_b32 s4, s32, 10
    v_add_u32 v17, s4, v2
    v_lshrrev_b32 v56, 4, v1
    v_lshlrev_b32 v57, 2, v56
    v_and_b32 v58, 15, v1
    v_sub_u32 v57, v57, v58
    s_lshl_b32 s4, s32, 4
    v_subrev_u32 v57, s4, v57
    v_and_b32 v56, 0x1f0, v2
    v_mov_b32 v58, 0xff800000
    s_lshl_b32 s37, s34, 1
    s_add_u32 s37, s37, s32
    s_lshl_b32 s37, s37, 10
    s_and_b32 s40, s34, 2
    s_add_u32 s40, s40, s32
    s_lshl_b32 s40, s40, 9
    s_and_b32 s4, s34, 1
    s_lshl_b32 s4, s4, 3
    s_add_u32 s40, s40, s4
    s_add_u32 s40, s40, 413696
    s_add_u32 s37, s37, 405504
    s_mov_b32 s41, 0x3dd53b95
    s_mov_b32 s21, 0
Xs_loop:
    s_and_b32 s36, s21, 3
    s_lshl_b32 s36, s36, 16
    s_add_u32 s36, s36, s22
    s_add_u32 s35, s36, s26
    s_add_u32 s21, s21, 1
    s_mov_b32 s31, 0
Xsw_l:
    buffer_load_dword v18, v15, s[8:11], s22 offen sc1
    s_waitcnt vmcnt(0)
Xsw_c:
    v_cmp_gt_u32 vcc, s21, v18
    s_cbranch_vccz Xsw_o
    s_sleep 1
    s_add_u32 s31, s31, 1
    s_cmp_lt_u32 s31, s30
    s_cbranch_scc1 Xsw_l
    s_mov_b32 s30, 1
Xsw_o:
    s_add_u32 s4, s35, 0
    buffer_load_dwordx4 v[60:63], v16, s[8:11], s4 offen offset:0 sc1
    buffer_load_dwordx4 v[64:67], v17, s[8:11], s4 offen offset:0 sc1
    buffer_load_dwordx4 v[68:71], v17, s[8:11], s4 offen offset:1024 sc1
    s_add_u32 s4, s35, 4096
    buffer_load_dwordx4 v[72:75], v16, s[8:11], s4 offen offset:0 sc1
    buffer_load_dwordx4 v[76:79], v17, s[8:11], s4 offen offset:0 sc1
    buffer_load_dwordx4 v[80:83], v17, s[8:11], s4 offen offset:1024 sc1
    s_add_u32 s4, s35, 8192
    buffer_load_dwordx4 v[84:87], v16, s[8:11], s4 offen offset:0 sc1
    buffer_load_dwordx4 v[88:91], v17, s[8:11], s4 offen offset:0 sc1
    buffer_load_dwordx4 v[92:95], v17, s[8:11], s4 offen offset:1024 sc1
    s_add_u32 s5, s36, s37
    s_add_u32 s6, s36, s40
    s_waitcnt vmcnt(3)
    v_pk_add_f32 v[60:61], v[60:61], v[72:73]
    v_pk_add_f32 v[62:63], v[62:63], v[74:75]
    v_pk_add_f32 v[64:65], v[64:65], v[76:77]
    v_pk_add_f32 v[66:67], v[66:67], v[78:79]
    v_pk_add_f32 v[68:69], v[68:69], v[80:81]
    v_pk_add_f32 v[70:71], v[70:71], v[82:83]
    s_waitcnt vmcnt(0)
    v_pk_add_f32 v[60:61], v[60:61], v[84:85]
    v_pk_add_f32 v[62:63], v[62:63], v[86:87]
    v_pk_add_f32 v[64:65], v[64:65], v[88:89]
    v_pk_add_f32 v[66:67], v[66:67], v[90:91]
    v_pk_add_f32 v[68:69], v[68:69], v[92:93]
    v_pk_add_f32 v[70:71], v[70:71], v[94:95]
    v_cmp_lt_u32 vcc, 31, v1
    s_nop 1
    v_cndmask_b32 v60, v58, v60, vcc
    v_cndmask_b32 v61, v58, v61, vcc
    v_cndmask_b32 v62, v58, v62, vcc
    v_cndmask_b32 v63, v58, v63, vcc
    v_cmp_ge_i32 vcc, 0, v57
    s_nop 1
    v_cndmask_b32 v64, v58, v64, vcc
    v_cmp_ge_i32 vcc, -1, v57
    s_nop 1
    v_cndmask_b32 v65, v58, v65, vcc
    v_cmp_ge_i32 vcc, -2, v57
    s_nop 1
    v_cndmask_b32 v66, v58, v66, vcc
    v_cmp_ge_i32 vcc, -3, v57
    s_nop 1
    v_cndmask_b32 v67, v58, v67, vcc
    v_cmp_ge_i32 vcc, -16, v57
    s_nop 1
    v_cndmask_b32 v68, v58, v68, vcc
    v_cmp_ge_i32 vcc, -17, v57
    s_nop 1
    v_cndmask_b32 v69, v58, v69, vcc
    v_cmp_ge_i32 vcc, -18, v57
    s_nop 1
    v_cndmask_b32 v70, v58, v70, vcc
    v_cmp_ge_i32 vcc, -19, v57
    s_nop 1
    v_cndmask_b32 v71, v58, v71, vcc
    v_max_f32 v44, v60, v61
    v_max3_f32 v44, v44, v62, v63
    v_max3_f32 v44, v44, v64, v65
    v_max3_f32 v44, v44, v66, v67
    v_max3_f32 v44, v44, v68, v69
    v_max3_f32 v44, v44, v70, v71
    v_mov_b32 v45, v44
    s_nop 1
    v_permlane16_swap_b32 v44, v45
    v_max_f32 v44, v44, v45
    v_mov_b32 v45, v44
    s_nop 1
    v_permlane32_swap_b32 v44, v45
    v_max_f32 v44, v44, v45
    v_mul_f32 v44, s41, v44
    v_fma_f32 v60, v60, s41, -v44
    v_fma_f32 v61, v61, s41, -v44
    v_fma_f32 v62, v62, s41, -v44
    v_fma_f32 v63, v63, s41, -v44
    v_fma_f32 v64, v64, s41, -v44
    v_fma_f32 v65, v65, s41, -v44
    v_fma_f32 v66, v66, s41, -v44
    v_fma_f32 v67, v67, s41, -v44
    v_fma_f32 v68, v68, s41, -v44
    v_fma_f32 v69, v69, s41, -v44
    v_fma_f32 v70, v70, s41, -v44
    v_fma_f32 v71, v71, s41, -v44
    v_exp_f32 v60, v60
    v_exp_f32 v61, v61
    v_exp_f32 v62, v62
    v_exp_f32 v63, v63
    v_exp_f32 v64, v64
    v_exp_f32 v65, v65
    v_exp_f32 v66, v66
    v_exp_f32 v67, v67
    v_exp_f32 v68, v68
    v_exp_f32 v69, v69
    v_exp_f32 v70, v70
    v_exp_f32 v71, v71
    v_add_f32 v44, v60, v61
    v_add_f32 v44, v44, v62
    v_add_f32 v44, v44, v63
    v_add_f32 v44, v44, v64
    v_add_f32 v44, v44, v65
    v_add_f32 v44, v44, v66
    v_add_f32 v44, v44, v67
    v_add_f32 v44, v44, v68
    v_add_f32 v44, v44, v69
    v_add_f32 v44, v44, v70
    v_add_f32 v44, v44, v71
    v_mov_b32 v45, v44
    s_nop 1
    v_permlane16_swap_b32 v44, v45
    v_add_f32 v44, v44, v45
    v_mov_b32 v45, v44
    s_nop 1
    v_permlane32_swap_b32 v44, v45
    v_add_f32 v44, v44, v45
    v_rcp_f32 v44, v44
    s_nop 0
    v_mul_f32 v60, v60, v44
    v_mul_f32 v61, v61, v44
    v_mul_f32 v62, v62, v44
    v_mul_f32 v63, v63, v44
    v_mul_f32 v64, v64, v44
    v_mul_f32 v65, v65, v44
    v_mul_f32 v66, v66, v44
    v_mul_f32 v67, v67, v44
    v_mul_f32 v68, v68, v44
    v_mul_f32 v69, v69, v44
    v_mul_f32 v70, v70, v44
    v_mul_f32 v71, v71, v44
    v_cvt_pk_bf16_f32 v48, v64, v65
    v_cvt_pk_bf16_f32 v49, v68, v69
    v_cvt_pk_bf16_f32 v50, v66, v67
    v_cvt_pk_bf16_f32 v51, v70, v71
    v_cvt_pk_bf16_f32 v52, v60, v61
    v_cvt_pk_bf16_f32 v53, v62, v63
    buffer_store_dwordx4 v[48:51], v2, s[8:11], s5 offen offset:0 sc1
    s_mov_b32 exec_lo, 0
    buffer_store_dwordx2 v[52:53], v56, s[8:11], s6 offen offset:0 sc1
    s_mov_b64 exec, -1
    s_waitcnt vmcnt(0)
    v_mov_b32 v10, s21
    s_mov_b64 exec, 1
    buffer_store_dword v10, v9, s[8:11], s33 offen sc1
    s_mov_b64 exec, -1
    s_cmp_eq_u32 s21, 64
    s_cbranch_scc1 X_join
    s_bitcmp1_b32 s21, 0
    s_cbranch_scc1 Xs_loop
    s_lshr_b32 s29, s21, 1
    s_sub_u32 s29, s29, 2
    s_cbranch_scc1 Xs_loop
    s_cmp_lt_u32 s29, 2
    s_cbranch_scc1 Xsb_e
    s_cmp_lt_u32 s29, 10
    s_cbranch_scc0 Xsb_a
    s_mov_b32 exec_hi, 0x0fffffff
    s_add_u32 m0, s99, 0
    s_nop 0
    buffer_load_dwordx4 v0, s[84:87], s98 offen nt lds
    s_add_u32 m0, s99, 15360
    s_nop 0
    buffer_load_dwordx4 v0, s[88:91], s98 offen nt lds
    s_add_u32 s98, s98, 30720
    s_add_u32 s99, s99, 960
    s_add_u32 m0, s99, 0
    s_nop 0
    buffer_load_dwordx4 v0, s[84:87], s98 offen nt lds
    s_add_u32 m0, s99, 15360
    s_nop 0
    buffer_load_dwordx4 v0, s[88:91], s98 offen nt lds
    s_add_u32 s98, s98, 30720
    s_add_u32 s99, s99, 960
    s_mov_b64 exec, -1
Xsb_a:
    s_cmp_eq_u32 s29, 11
    s_cbranch_scc0 Xsb_b
    s_waitcnt vmcnt(0)
    v_lshrrev_b32 v12, 4, v1
    v_lshlrev_b32 v12, 3, v12
    v_bfe_u32 v13, v1, 2, 2
    v_add_u32 v12, v12, v13
    v_mul_u32_u24 v12, 96, v12
    v_and_b32 v13, 3, v1
    v_lshlrev_b32 v13, 3, v13
    v_add_u32 v12, v12, v13
    s_mul_i32 s4, s3, 30720
    s_add_u32 s4, s4, 40960
    v_add_u32 v12, s4, v12
    ds_read_b64_tr_b16 a[0:1], v12 offset:0
    ds_read_b64_tr_b16 a[2:3], v12 offset:384
    ds_read_b64_tr_b16 a[4:5], v12 offset:3072
    ds_read_b64_tr_b16 a[6:7], v12 offset:3456
    ds_read_b64_tr_b16 a[8:9], v12 offset:6144
    ds_read_b64_tr_b16 a[10:11], v12 offset:6528
    ds_read_b64_tr_b16 a[12:13], v12 offset:9216
    ds_read_b64_tr_b16 a[14:15], v12 offset:9600
    ds_read_b64_tr_b16 a[16:17], v12 offset:12288
    ds_read_b64_tr_b16 a[18:19], v12 offset:12672
    ds_read_b64_tr_b16 a[20:21], v12 offset:15360
    ds_read_b64_tr_b16 a[22:23], v12 offset:15744
    ds_read_b64_tr_b16 a[24:25], v12 offset:18432
    ds_read_b64_tr_b16 a[26:27], v12 offset:18816
    ds_read_b64_tr_b16 a[28:29], v12 offset:21504
    ds_read_b64_tr_b16 a[30:31], v12 offset:21888
    ds_read_b64_tr_b16 a[32:33], v12 offset:24576
    ds_read_b64_tr_b16 a[34:35], v12 offset:24960
    ds_read_b64_tr_b16 a[36:37], v12 offset:27648
    ds_read_b64_tr_b16 a[38:39], v12 offset:28032
    ds_read_b64_tr_b16 a[40:41], v12 offset:32
    ds_read_b64_tr_b16 a[42:43], v12 offset:416
    ds_read_b64_tr_b16 a[44:45], v12 offset:3104
    ds_read_b64_tr_b16 a[46:47], v12 offset:3488
    ds_read_b64_tr_b16 a[48:49], v12 offset:6176
    ds_read_b64_tr_b16 a[50:51], v12 offset:6560
    ds_read_b64_tr_b16 a[52:53], v12 offset:9248
    ds_read_b64_tr_b16 a[54:55], v12 offset:9632
    ds_read_b64_tr_b16 a[56:57], v12 offset:12320
    ds_read_b64_tr_b16 a[58:59], v12 offset:12704
    ds_read_b64_tr_b16 a[60:61], v12 offset:15392
    ds_read_b64_tr_b16 a[62:63], v12 offset:15776
    ds_read_b64_tr_b16 a[64:65], v12 offset:18464
    ds_read_b64_tr_b16 a[66:67], v12 offset:18848
    ds_read_b64_tr_b16 a[68:69], v12 offset:21536
    ds_read_b64_tr_b16 a[70:71], v12 offset:21920
    ds_read_b64_tr_b16 a[72:73], v12 offset:24608
    ds_read_b64_tr_b16 a[74:75], v12 offset:24992
    ds_read_b64_tr_b16 a[76:77], v12 offset:27680
    ds_read_b64_tr_b16 a[78:79], v12 offset:28064
    ds_read_b64_tr_b16 a[80:81], v12 offset:64
    ds_read_b64_tr_b16 a[82:83], v12 offset:448
    ds_read_b64_tr_b16 a[84:85], v12 offset:3136
    ds_read_b64_tr_b16 a[86:87], v12 offset:3520
    ds_read_b64_tr_b16 a[88:89], v12 offset:6208
    ds_read_b64_tr_b16 a[90:91], v12 offset:6592
    ds_read_b64_tr_b16 a[92:93], v12 offset:9280
    ds_read_b64_tr_b16 a[94:95], v12 offset:9664
    ds_read_b64_tr_b16 a[96:97], v12 offset:12352
    ds_read_b64_tr_b16 a[98:99], v12 offset:12736
    ds_read_b64_tr_b16 a[100:101], v12 offset:15424
    ds_read_b64_tr_b16 a[102:103], v12 offset:15808
    ds_read_b64_tr_b16 a[104:105], v12 offset:18496
    ds_read_b64_tr_b16 a[106:107], v12 offset:18880
    ds_read_b64_tr_b16 a[108:109], v12 offset:21568
    ds_read_b64_tr_b16 a[110:111], v12 offset:21952
    ds_read_b64_tr_b16 a[112:113], v12 offset:24640
    ds_read_b64_tr_b16 a[114:115], v12 offset:25024
    ds_read_b64_tr_b16 a[116:117], v12 offset:27712
    ds_read_b64_tr_b16 a[118:119], v12 offset:28096
    v_lshrrev_b32 v4, 2, v1
    v_mul_u32_u24 v4, 1280, v4
    v_and_b32 v5, 3, v1
    v_lshl_add_u32 v0, v5, 4, v4
    s_mul_i32 s4, s3, 491520
    s_lshl_b32 s5, s20, 6
    s_add_u32 s98, s4, s5
    s_mul_i32 s99, s3, 30720
    s_add_u32 s99, s99, 40960
    s_waitcnt lgkmcnt(0)
Xsb_b:
    s_sub_u32 s4, s29, 12
    s_cmp_lt_u32 s4, 8
    s_cbranch_scc0 Xsb_d
    s_cmp_ge_u32 s20, 20
    s_cbranch_scc1 Xsb_d
    s_mov_b32 m0, s99
    s_add_u32 s99, s99, 1024
    buffer_load_dwordx4 v0, s[92:95], s98 offen nt lds
    s_add_u32 s98, s98, 20480
    s_mov_b32 m0, s99
    s_add_u32 s99, s99, 1024
    buffer_load_dwordx4 v0, s[92:95], s98 offen nt lds
    s_add_u32 s98, s98, 20480
    s_mov_b32 m0, s99
    s_add_u32 s99, s99, 1024
    buffer_load_dwordx4 v0, s[92:95], s98 offen nt lds
    s_add_u32 s98, s98, 20480
Xsb_d:
    s_cmp_eq_u32 s29, 21
    s_cbranch_scc0 Xsb_c
    s_waitcnt vmcnt(0)
    v_lshrrev_b32 v12, 4, v1
    v_lshlrev_b32 v12, 3, v12
    v_bfe_u32 v13, v1, 2, 2
    v_add_u32 v12, v12, v13
    v_mul_u32_u24 v12, 64, v12
    v_and_b32 v13, 3, v1
    v_lshlrev_b32 v13, 3, v13
    v_add_u32 v12, v12, v13
    s_mul_i32 s4, s3, 30720
    s_add_u32 s4, s4, 40960
    v_add_u32 v12, s4, v12
    ds_read_b64_tr_b16 a[120:121], v12 offset:0
    ds_read_b64_tr_b16 a[122:123], v12 offset:256
    ds_read_b64_tr_b16 a[124:125], v12 offset:2048
    ds_read_b64_tr_b16 a[126:127], v12 offset:2304
    ds_read_b64_tr_b16 a[128:129], v12 offset:4096
    ds_read_b64_tr_b16 a[130:131], v12 offset:4352
    ds_read_b64_tr_b16 a[132:133], v12 offset:6144
    ds_read_b64_tr_b16 a[134:135], v12 offset:6400
    ds_read_b64_tr_b16 a[136:137], v12 offset:8192
    ds_read_b64_tr_b16 a[138:139], v12 offset:8448
    ds_read_b64_tr_b16 a[140:141], v12 offset:10240
    ds_read_b64_tr_b16 a[142:143], v12 offset:10496
    ds_read_b64_tr_b16 a[144:145], v12 offset:12288
    ds_read_b64_tr_b16 a[146:147], v12 offset:12544
    ds_read_b64_tr_b16 a[148:149], v12 offset:14336
    ds_read_b64_tr_b16 a[150:151], v12 offset:14592
    ds_read_b64_tr_b16 a[152:153], v12 offset:16384
    ds_read_b64_tr_b16 a[154:155], v12 offset:16640
    ds_read_b64_tr_b16 a[156:157], v12 offset:18432
    ds_read_b64_tr_b16 a[158:159], v12 offset:18688
    ds_read_b64_tr_b16 a[160:161], v12 offset:20480
    ds_read_b64_tr_b16 a[162:163], v12 offset:20736
    ds_read_b64_tr_b16 a[164:165], v12 offset:22528
    ds_read_b64_tr_b16 a[166:167], v12 offset:22784
    ds_read_b64_tr_b16 a[168:169], v12 offset:32
    ds_read_b64_tr_b16 a[170:171], v12 offset:288
    ds_read_b64_tr_b16 a[172:173], v12 offset:2080
    ds_read_b64_tr_b16 a[174:175], v12 offset:2336
    ds_read_b64_tr_b16 a[176:177], v12 offset:4128
    ds_read_b64_tr_b16 a[178:179], v12 offset:4384
    ds_read_b64_tr_b16 a[180:181], v12 offset:6176
    ds_read_b64_tr_b16 a[182:183], v12 offset:6432
    ds_read_b64_tr_b16 a[184:185], v12 offset:8224
    ds_read_b64_tr_b16 a[186:187], v12 offset:8480
    ds_read_b64_tr_b16 a[188:189], v12 offset:10272
    ds_read_b64_tr_b16 a[190:191], v12 offset:10528
    ds_read_b64_tr_b16 a[192:193], v12 offset:12320
    ds_read_b64_tr_b16 a[194:195], v12 offset:12576
    ds_read_b64_tr_b16 a[196:197], v12 offset:14368
    ds_read_b64_tr_b16 a[198:199], v12 offset:14624
    ds_read_b64_tr_b16 a[200:201], v12 offset:16416
    ds_read_b64_tr_b16 a[202:203], v12 offset:16672
    ds_read_b64_tr_b16 a[204:205], v12 offset:18464
    ds_read_b64_tr_b16 a[206:207], v12 offset:18720
    ds_read_b64_tr_b16 a[208:209], v12 offset:20512
    ds_read_b64_tr_b16 a[210:211], v12 offset:20768
    ds_read_b64_tr_b16 a[212:213], v12 offset:22560
    ds_read_b64_tr_b16 a[214:215], v12 offset:22816
    s_waitcnt lgkmcnt(0)
Xsb_c:
Xsb_e:
    s_branch Xs_loop
X3_go:
    s_load_dwordx2 s[24:25], s[0:1], 64
    s_mov_b32 s26, 1280
    s_mov_b32 s27, 0x20000
    s_waitcnt lgkmcnt(0)
    v_lshlrev_b32 v3, 2, v1
    v_lshlrev_b32 v11, 3, v1
    s_mov_b32 s4, 5120
    buffer_load_dwordx2 v[146:147], v11, s[8:11], s4 offen offset:0 sc1
    buffer_load_dwordx2 v[148:149], v11, s[8:11], s4 offen offset:512 sc1
    buffer_load_dwordx2 v[150:151], v11, s[8:11], s4 offen offset:1024 sc1
    buffer_load_dwordx2 v[152:153], v11, s[8:11], s4 offen offset:1536 sc1
    buffer_load_dwordx2 v[154:155], v11, s[8:11], s4 offen offset:2048 sc1
    s_mov_b32 s5, 7680
    s_mov_b32 s6, 10240
    s_mov_b32 s7, 12800
    buffer_load_dwordx2 v[100:101], v11, s[8:11], s5 offen offset:0 sc1
    buffer_load_dwordx2 v[110:111], v11, s[8:11], s6 offen offset:0 sc1
    buffer_load_dwordx2 v[120:121], v11, s[8:11], s7 offen offset:0 sc1
    buffer_load_dword v140, v3, s[24:27], 0 offen offset:0
    buffer_load_dwordx2 v[102:103], v11, s[8:11], s5 offen offset:512 sc1
    buffer_load_dwordx2 v[112:113], v11, s[8:11], s6 offen offset:512 sc1
    buffer_load_dwordx2 v[122:123], v11, s[8:11], s7 offen offset:512 sc1
    buffer_load_dword v141, v3, s[24:27], 0 offen offset:256
    buffer_load_dwordx2 v[104:105], v11, s[8:11], s5 offen offset:1024 sc1
    buffer_load_dwordx2 v[114:115], v11, s[8:11], s6 offen offset:1024 sc1
    buffer_load_dwordx2 v[124:125], v11, s[8:11], s7 offen offset:1024 sc1
    buffer_load_dword v142, v3, s[24:27], 0 offen offset:512
    buffer_load_dwordx2 v[106:107], v11, s[8:11], s5 offen offset:1536 sc1
    buffer_load_dwordx2 v[116:117], v11, s[8:11], s6 offen offset:1536 sc1
    buffer_load_dwordx2 v[126:127], v11, s[8:11], s7 offen offset:1536 sc1
    buffer_load_dword v143, v3, s[24:27], 0 offen offset:768
    buffer_load_dwordx2 v[108:109], v11, s[8:11], s5 offen offset:2048 sc1
    buffer_load_dwordx2 v[118:119], v11, s[8:11], s6 offen offset:2048 sc1
    buffer_load_dwordx2 v[128:129], v11, s[8:11], s7 offen offset:2048 sc1
    buffer_load_dword v144, v3, s[24:27], 0 offen offset:1024
    s_waitcnt vmcnt(0)
    v_add_f32 v110, 1.0, v110
    v_cvt_pk_bf16_f32 v110, v110, v110
    v_and_b32 v110, 0xffff0000, v110
    v_add_f32 v111, 1.0, v111
    v_cvt_pk_bf16_f32 v111, v111, v111
    v_and_b32 v111, 0xffff0000, v111
    v_add_f32 v112, 1.0, v112
    v_cvt_pk_bf16_f32 v112, v112, v112
    v_and_b32 v112, 0xffff0000, v112
    v_add_f32 v113, 1.0, v113
    v_cvt_pk_bf16_f32 v113, v113, v113
    v_and_b32 v113, 0xffff0000, v113
    v_add_f32 v114, 1.0, v114
    v_cvt_pk_bf16_f32 v114, v114, v114
    v_and_b32 v114, 0xffff0000, v114
    v_add_f32 v115, 1.0, v115
    v_cvt_pk_bf16_f32 v115, v115, v115
    v_and_b32 v115, 0xffff0000, v115
    v_add_f32 v116, 1.0, v116
    v_cvt_pk_bf16_f32 v116, v116, v116
    v_and_b32 v116, 0xffff0000, v116
    v_add_f32 v117, 1.0, v117
    v_cvt_pk_bf16_f32 v117, v117, v117
    v_and_b32 v117, 0xffff0000, v117
    v_add_f32 v118, 1.0, v118
    v_cvt_pk_bf16_f32 v118, v118, v118
    v_and_b32 v118, 0xffff0000, v118
    v_add_f32 v119, 1.0, v119
    v_cvt_pk_bf16_f32 v119, v119, v119
    v_and_b32 v119, 0xffff0000, v119
    v_lshlrev_b32 v130, 16, v140
    v_and_b32 v131, 0xffff0000, v140
    v_lshlrev_b32 v132, 16, v141
    v_and_b32 v133, 0xffff0000, v141
    v_lshlrev_b32 v134, 16, v142
    v_and_b32 v135, 0xffff0000, v142
    v_lshlrev_b32 v136, 16, v143
    v_and_b32 v137, 0xffff0000, v143
    v_lshlrev_b32 v138, 16, v144
    v_and_b32 v139, 0xffff0000, v144
    s_sub_u32 s21, s28, 2
    s_lshl_b32 s28, s28, 2
    s_add_u32 s28, s28, s3
    s_lshl_b32 s4, s21, 5
    s_add_u32 s4, s4, s96
    s_mul_i32 s4, s4, 1280
    s_mov_b32 s42, 61964288
    buffer_load_dword v224, v3, s[12:15], s4 offen offset:0
    buffer_load_dword v225, v3, s[12:15], s4 offen offset:256
    buffer_load_dword v226, v3, s[12:15], s4 offen offset:512
    buffer_load_dword v227, v3, s[12:15], s4 offen offset:768
    buffer_load_dword v228, v3, s[12:15], s4 offen offset:1024
X3_loop:
    s_cmp_lt_u32 s21, 57
    s_cselect_b32 s4, 5, 4
    s_add_u32 s35, s21, s4
    buffer_load_dword v18, v15, s[8:11], s22 offen offset:0 sc1
    s_waitcnt vmcnt(0)
    s_mov_b64 exec, 1
    buffer_store_dword v9, v3, s[8:11], s42 offen sc1
    s_mov_b64 exec, -1
    s_cmp_ge_u32 s21, 60
    s_cbranch_scc1 X_join
    s_mov_b32 s31, 0
    s_waitcnt vmcnt(1)
    s_branch X3w_c
X3w_l:
    buffer_load_dword v18, v15, s[8:11], s22 offen sc1
    s_waitcnt vmcnt(0)
X3w_c:
    v_cmp_gt_u32 vcc, s35, v18
    s_cbranch_vccz X3w_o
    s_sleep 4
    s_add_u32 s31, s31, 1
    s_cmp_lt_u32 s31, s30
    s_cbranch_scc1 X3w_l
    s_mov_b32 s30, 1
X3w_o:
    v_lshrrev_b32 v16, 3, v1
    v_lshlrev_b32 v16, 10, v16
    v_and_b32 v17, 7, v1
    v_lshl_add_u32 v16, v17, 2, v16
    s_lshl_b32 s4, s96, 5
    v_add_u32 v16, s4, v16
    s_lshl_b32 s4, s21, 5
    s_add_u32 s4, s4, s96
    s_mul_i32 s24, s4, 1280
    s_add_u32 s25, s24, 59244544
    s_lshl_b32 s5, s4, 2
    s_add_u32 s5, s5, 16384
    s_lshl_b32 s6, s4, 7
    s_add_u32 s6, s6, 61636608
    s_cmp_lt_u32 s4, 1792
    s_cselect_b32 s42, s5, s6
    s_mul_i32 s35, s21, 524288
    s_add_u32 s35, s35, 23068672
    s_call_b64 s[100:101], T3_sub
    s_add_u32 s4, s24, 56623104
    buffer_store_dword v140, v3, s[8:11], s4 offen offset:0 sc1
    buffer_store_dword v141, v3, s[8:11], s4 offen offset:256 sc1
    buffer_store_dword v142, v3, s[8:11], s4 offen offset:512 sc1
    buffer_store_dword v143, v3, s[8:11], s4 offen offset:768 sc1
    buffer_store_dword v144, v3, s[8:11], s4 offen offset:1024 sc1
    s_add_u32 s21, s21, 2
    s_cmp_ge_u32 s21, 60
    s_cbranch_scc1 X3_loop
    s_lshr_b32 s29, s21, 1
    s_cmp_lt_u32 s29, 2
    s_cbranch_scc1 X3b_e
    s_cmp_lt_u32 s29, 10
    s_cbranch_scc0 X3b_a
    s_mov_b32 exec_hi, 0x0fffffff
    s_add_u32 m0, s99, 0
    s_nop 0
    buffer_load_dwordx4 v0, s[84:87], s98 offen nt lds
    s_add_u32 m0, s99, 15360
    s_nop 0
    buffer_load_dwordx4 v0, s[88:91], s98 offen nt lds
    s_add_u32 s98, s98, 30720
    s_add_u32 s99, s99, 960
    s_add_u32 m0, s99, 0
    s_nop 0
    buffer_load_dwordx4 v0, s[84:87], s98 offen nt lds
    s_add_u32 m0, s99, 15360
    s_nop 0
    buffer_load_dwordx4 v0, s[88:91], s98 offen nt lds
    s_add_u32 s98, s98, 30720
    s_add_u32 s99, s99, 960
    s_mov_b64 exec, -1
X3b_a:
    s_cmp_eq_u32 s29, 11
    s_cbranch_scc0 X3b_b
    s_waitcnt vmcnt(0)
    v_lshrrev_b32 v12, 4, v1
    v_lshlrev_b32 v12, 3, v12
    v_bfe_u32 v13, v1, 2, 2
    v_add_u32 v12, v12, v13
    v_mul_u32_u24 v12, 96, v12
    v_and_b32 v13, 3, v1
    v_lshlrev_b32 v13, 3, v13
    v_add_u32 v12, v12, v13
    s_mul_i32 s4, s3, 30720
    s_add_u32 s4, s4, 40960
    v_add_u32 v12, s4, v12
    ds_read_b64_tr_b16 a[0:1], v12 offset:0
    ds_read_b64_tr_b16 a[2:3], v12 offset:384
    ds_read_b64_tr_b16 a[4:5], v12 offset:3072
    ds_read_b64_tr_b16 a[6:7], v12 offset:3456
    ds_read_b64_tr_b16 a[8:9], v12 offset:6144
    ds_read_b64_tr_b16 a[10:11], v12 offset:6528
    ds_read_b64_tr_b16 a[12:13], v12 offset:9216
    ds_read_b64_tr_b16 a[14:15], v12 offset:9600
    ds_read_b64_tr_b16 a[16:17], v12 offset:12288
    ds_read_b64_tr_b16 a[18:19], v12 offset:12672
    ds_read_b64_tr_b16 a[20:21], v12 offset:15360
    ds_read_b64_tr_b16 a[22:23], v12 offset:15744
    ds_read_b64_tr_b16 a[24:25], v12 offset:18432
    ds_read_b64_tr_b16 a[26:27], v12 offset:18816
    ds_read_b64_tr_b16 a[28:29], v12 offset:21504
    ds_read_b64_tr_b16 a[30:31], v12 offset:21888
    ds_read_b64_tr_b16 a[32:33], v12 offset:24576
    ds_read_b64_tr_b16 a[34:35], v12 offset:24960
    ds_read_b64_tr_b16 a[36:37], v12 offset:27648
    ds_read_b64_tr_b16 a[38:39], v12 offset:28032
    ds_read_b64_tr_b16 a[40:41], v12 offset:32
    ds_read_b64_tr_b16 a[42:43], v12 offset:416
    ds_read_b64_tr_b16 a[44:45], v12 offset:3104
    ds_read_b64_tr_b16 a[46:47], v12 offset:3488
    ds_read_b64_tr_b16 a[48:49], v12 offset:6176
    ds_read_b64_tr_b16 a[50:51], v12 offset:6560
    ds_read_b64_tr_b16 a[52:53], v12 offset:9248
    ds_read_b64_tr_b16 a[54:55], v12 offset:9632
    ds_read_b64_tr_b16 a[56:57], v12 offset:12320
    ds_read_b64_tr_b16 a[58:59], v12 offset:12704
    ds_read_b64_tr_b16 a[60:61], v12 offset:15392
    ds_read_b64_tr_b16 a[62:63], v12 offset:15776
    ds_read_b64_tr_b16 a[64:65], v12 offset:18464
    ds_read_b64_tr_b16 a[66:67], v12 offset:18848
    ds_read_b64_tr_b16 a[68:69], v12 offset:21536
    ds_read_b64_tr_b16 a[70:71], v12 offset:21920
    ds_read_b64_tr_b16 a[72:73], v12 offset:24608
    ds_read_b64_tr_b16 a[74:75], v12 offset:24992
    ds_read_b64_tr_b16 a[76:77], v12 offset:27680
    ds_read_b64_tr_b16 a[78:79], v12 offset:28064
    ds_read_b64_tr_b16 a[80:81], v12 offset:64
    ds_read_b64_tr_b16 a[82:83], v12 offset:448
    ds_read_b64_tr_b16 a[84:85], v12 offset:3136
    ds_read_b64_tr_b16 a[86:87], v12 offset:3520
    ds_read_b64_tr_b16 a[88:89], v12 offset:6208
    ds_read_b64_tr_b16 a[90:91], v12 offset:6592
    ds_read_b64_tr_b16 a[92:93], v12 offset:9280
    ds_read_b64_tr_b16 a[94:95], v12 offset:9664
    ds_read_b64_tr_b16 a[96:97], v12 offset:12352
    ds_read_b64_tr_b16 a[98:99], v12 offset:12736
    ds_read_b64_tr_b16 a[100:101], v12 offset:15424
    ds_read_b64_tr_b16 a[102:103], v12 offset:15808
    ds_read_b64_tr_b16 a[104:105], v12 offset:18496
    ds_read_b64_tr_b16 a[106:107], v12 offset:18880
    ds_read_b64_tr_b16 a[108:109], v12 offset:21568
    ds_read_b64_tr_b16 a[110:111], v12 offset:21952
    ds_read_b64_tr_b16 a[112:113], v12 offset:24640
    ds_read_b64_tr_b16 a[114:115], v12 offset:25024
    ds_read_b64_tr_b16 a[116:117], v12 offset:27712
    ds_read_b64_tr_b16 a[118:119], v12 offset:28096
    v_lshrrev_b32 v4, 2, v1
    v_mul_u32_u24 v4, 1280, v4
    v_and_b32 v5, 3, v1
    v_lshl_add_u32 v0, v5, 4, v4
    s_mul_i32 s4, s3, 491520
    s_lshl_b32 s5, s20, 6
    s_add_u32 s98, s4, s5
    s_mul_i32 s99, s3, 30720
    s_add_u32 s99, s99, 40960
    s_waitcnt lgkmcnt(0)
X3b_b:
    s_sub_u32 s4, s29, 12
    s_cmp_lt_u32 s4, 8
    s_cbranch_scc0 X3b_d
    s_cmp_ge_u32 s20, 20
    s_cbranch_scc1 X3b_d
    s_mov_b32 m0, s99
    s_add_u32 s99, s99, 1024
    buffer_load_dwordx4 v0, s[92:95], s98 offen nt lds
    s_add_u32 s98, s98, 20480
    s_mov_b32 m0, s99
    s_add_u32 s99, s99, 1024
    buffer_load_dwordx4 v0, s[92:95], s98 offen nt lds
    s_add_u32 s98, s98, 20480
    s_mov_b32 m0, s99
    s_add_u32 s99, s99, 1024
    buffer_load_dwordx4 v0, s[92:95], s98 offen nt lds
    s_add_u32 s98, s98, 20480
X3b_d:
    s_cmp_eq_u32 s29, 21
    s_cbranch_scc0 X3b_c
    s_waitcnt vmcnt(0)
    v_lshrrev_b32 v12, 4, v1
    v_lshlrev_b32 v12, 3, v12
    v_bfe_u32 v13, v1, 2, 2
    v_add_u32 v12, v12, v13
    v_mul_u32_u24 v12, 64, v12
    v_and_b32 v13, 3, v1
    v_lshlrev_b32 v13, 3, v13
    v_add_u32 v12, v12, v13
    s_mul_i32 s4, s3, 30720
    s_add_u32 s4, s4, 40960
    v_add_u32 v12, s4, v12
    ds_read_b64_tr_b16 a[120:121], v12 offset:0
    ds_read_b64_tr_b16 a[122:123], v12 offset:256
    ds_read_b64_tr_b16 a[124:125], v12 offset:2048
    ds_read_b64_tr_b16 a[126:127], v12 offset:2304
    ds_read_b64_tr_b16 a[128:129], v12 offset:4096
    ds_read_b64_tr_b16 a[130:131], v12 offset:4352
    ds_read_b64_tr_b16 a[132:133], v12 offset:6144
    ds_read_b64_tr_b16 a[134:135], v12 offset:6400
    ds_read_b64_tr_b16 a[136:137], v12 offset:8192
    ds_read_b64_tr_b16 a[138:139], v12 offset:8448
    ds_read_b64_tr_b16 a[140:141], v12 offset:10240
    ds_read_b64_tr_b16 a[142:143], v12 offset:10496
    ds_read_b64_tr_b16 a[144:145], v12 offset:12288
    ds_read_b64_tr_b16 a[146:147], v12 offset:12544
    ds_read_b64_tr_b16 a[148:149], v12 offset:14336
    ds_read_b64_tr_b16 a[150:151], v12 offset:14592
    ds_read_b64_tr_b16 a[152:153], v12 offset:16384
    ds_read_b64_tr_b16 a[154:155], v12 offset:16640
    ds_read_b64_tr_b16 a[156:157], v12 offset:18432
    ds_read_b64_tr_b16 a[158:159], v12 offset:18688
    ds_read_b64_tr_b16 a[160:161], v12 offset:20480
    ds_read_b64_tr_b16 a[162:163], v12 offset:20736
    ds_read_b64_tr_b16 a[164:165], v12 offset:22528
    ds_read_b64_tr_b16 a[166:167], v12 offset:22784
    ds_read_b64_tr_b16 a[168:169], v12 offset:32
    ds_read_b64_tr_b16 a[170:171], v12 offset:288
    ds_read_b64_tr_b16 a[172:173], v12 offset:2080
    ds_read_b64_tr_b16 a[174:175], v12 offset:2336
    ds_read_b64_tr_b16 a[176:177], v12 offset:4128
    ds_read_b64_tr_b16 a[178:179], v12 offset:4384
    ds_read_b64_tr_b16 a[180:181], v12 offset:6176
    ds_read_b64_tr_b16 a[182:183], v12 offset:6432
    ds_read_b64_tr_b16 a[184:185], v12 offset:8224
    ds_read_b64_tr_b16 a[186:187], v12 offset:8480
    ds_read_b64_tr_b16 a[188:189], v12 offset:10272
    ds_read_b64_tr_b16 a[190:191], v12 offset:10528
    ds_read_b64_tr_b16 a[192:193], v12 offset:12320
    ds_read_b64_tr_b16 a[194:195], v12 offset:12576
    ds_read_b64_tr_b16 a[196:197], v12 offset:14368
    ds_read_b64_tr_b16 a[198:199], v12 offset:14624
    ds_read_b64_tr_b16 a[200:201], v12 offset:16416
    ds_read_b64_tr_b16 a[202:203], v12 offset:16672
    ds_read_b64_tr_b16 a[204:205], v12 offset:18464
    ds_read_b64_tr_b16 a[206:207], v12 offset:18720
    ds_read_b64_tr_b16 a[208:209], v12 offset:20512
    ds_read_b64_tr_b16 a[210:211], v12 offset:20768
    ds_read_b64_tr_b16 a[212:213], v12 offset:22560
    ds_read_b64_tr_b16 a[214:215], v12 offset:22816
    s_waitcnt lgkmcnt(0)
X3b_c:
X3b_e:
    s_cmp_lg_u32 s28, 8
    s_cbranch_scc1 X3_loop
    s_cmp_lt_u32 s29, 4
    s_cbranch_scc1 X3_loop
    s_call_b64 s[100:101], XG_sub
    s_branch X3_loop
X_join:
    s_add_u32 s26, s22, 156160
    v_and_b32 v4, 7, v1
    v_lshlrev_b32 v4, 5, v4
    v_lshrrev_b32 v5, 4, v1
    v_lshl_add_u32 v16, v5, 3, v4
    s_mul_i32 s4, s20, 768
    s_lshl_b32 s5, s3, 8
    s_add_u32 s4, s4, s5
    v_add_u32 v16, s4, v16
    v_lshlrev_b32 v18, 4, v5
    v_and_b32 v17, 16, v18
    v_add_u32 v17, v17, v4
    v_lshrrev_b32 v4, 5, v1
    v_lshl_add_u32 v17, v4, 8, v17
    s_mul_i32 s4, s3, 6144
    v_add_u32 v17, s4, v17
    v_add_u32 v32, 3072, v17
    s_mul_i32 s4, s3, 6144
    v_add_u32 v19, s4, v2
    s_lshl_b32 s4, s3, 11
    v_add_u32 v20, s4, v2
    s_lshl_b32 s4, s3, 10
    v_add_u32 v21, s4, v2
    s_lshl_b32 s22, s20, 6
    s_and_b32 s4, s3, 1
    s_lshl_b32 s4, s4, 5
    s_add_u32 s22, s22, s4
    s_min_u32 s22, s22, 1248
    s_lshl_b32 s4, s22, 1
    s_add_u32 s4, s4, 12800
    buffer_load_dwordx4 v[22:25], v18, s[8:11], s4 offen sc1
    v_and_b32 v27, 7, v1
    v_lshlrev_b32 v27, 2, v27
    s_cmp_lg_u32 s28, 8
    s_cbranch_scc1 XE_b
XE_m:
    s_call_b64 s[100:101], XG_sub
    s_cmp_lt_u32 s43, 1920
    s_cbranch_scc1 XE_m
    v_writelane_b32 v26, s44, 0
    v_writelane_b32 v26, s45, 1
    v_writelane_b32 v26, s46, 2
    v_writelane_b32 v26, s47, 3
    v_writelane_b32 v26, s38, 4
    v_writelane_b32 v26, s39, 5
    v_writelane_b32 v26, s48, 6
    v_writelane_b32 v26, s49, 7
    s_mov_b64 exec, 0xff
    buffer_store_dword v26, v27, s[8:11], s26 offen sc1
    s_mov_b64 exec, -1
XE_b:
    s_mov_b32 s31, 0
XL_l:
    buffer_load_dword v26, v27, s[8:11], s26 offen sc1
    s_waitcnt vmcnt(0)
XL_c:
    v_cmp_gt_u32 vcc, 1, v26
    s_cbranch_vccz XL_o
    s_sleep 1
    s_add_u32 s31, s31, 1
    s_cmp_lt_u32 s31, s30
    s_cbranch_scc1 XL_l
    s_mov_b32 s30, 1
XL_o:
    s_mov_b32 s43, 1920
    v_readlane_b32 s44, v26, 0
    v_readlane_b32 s45, v26, 1
    v_readlane_b32 s46, v26, 2
    v_readlane_b32 s47, v26, 3
    v_readlane_b32 s38, v26, 4
    v_readlane_b32 s39, v26, 5
    v_readlane_b32 s48, v26, 6
    v_readlane_b32 s49, v26, 7
    s_mov_b32 s97, 1
    s_mov_b32 s23, 61898752
    s_call_b64 s[100:101], XM_sub
    s_mov_b32 s27, 0
    s_call_b64 s[100:101], XG_sub
    s_call_b64 s[100:101], XG_sub
    s_cmp_eq_u32 s27, 0
    s_cbranch_scc1 XE_st
    s_mov_b32 s23, 61923328
    s_call_b64 s[100:101], XM_sub
XE_st:
    s_cmp_ge_u32 s20, 20
    s_cbranch_scc1 XE_e
    s_cmp_ge_u32 s3, 2
    s_cbranch_scc1 XE_e
    s_mov_b32 exec_lo, 0x00ff00ff
    s_mov_b32 exec_hi, 0x00ff00ff
    buffer_store_dwordx2 v[28:29], v27, s[16:19], 0 offen sc1
    s_mov_b64 exec, -1
XE_e:
    s_branch R_done
XM_sub:
    s_barrier
    s_mov_b32 exec_lo, 0x01010101
    s_mov_b32 exec_hi, 0x01010101
    v_mov_b32 v26, s44
    s_lshl_b64 exec, exec, 1
    v_mov_b32 v26, s45
    s_lshl_b64 exec, exec, 1
    v_mov_b32 v26, s46
    s_lshl_b64 exec, exec, 1
    v_mov_b32 v26, s47
    s_lshl_b64 exec, exec, 1
    v_mov_b32 v26, s38
    s_lshl_b64 exec, exec, 1
    v_mov_b32 v26, s39
    s_lshl_b64 exec, exec, 1
    v_mov_b32 v26, s48
    s_lshl_b64 exec, exec, 1
    v_mov_b32 v26, s49
    s_mov_b64 exec, -1
    v_and_b32 v27, 0x7ff, v26
    v_sub_u32 v27, 0x7ff, v27
    v_mul_u32_u24 v27, 1280, v27
    v_add_u32 v30, v27, v18
    s_mul_i32 s5, s3, 320
    s_add_u32 s5, s5, 59244544
    s_mov_b32 s31, 0
XH_l:
    buffer_load_dwordx4 v[96:99], v30, s[8:11], s5 offen offset:0 sc1
    buffer_load_dwordx4 v[100:103], v30, s[8:11], s5 offen offset:64 sc1
    buffer_load_dwordx4 v[104:107], v30, s[8:11], s5 offen offset:128 sc1
    buffer_load_dwordx4 v[108:111], v30, s[8:11], s5 offen offset:192 sc1
    buffer_load_dwordx4 v[112:115], v30, s[8:11], s5 offen offset:256 sc1
    s_waitcnt vmcnt(0)
    v_max3_u32 v31, v96, v97, v98
    v_max3_u32 v31, v31, v99, v100
    v_max3_u32 v31, v31, v101, v102
    v_max3_u32 v31, v31, v103, v104
    v_max3_u32 v31, v31, v105, v106
    v_max3_u32 v31, v31, v107, v108
    v_max3_u32 v31, v31, v109, v110
    v_max3_u32 v31, v31, v111, v112
    v_max3_u32 v31, v31, v113, v114
    v_max_u32 v31, v31, v115
    v_cmp_eq_u32 vcc, -1, v31
    s_cbranch_vccz XH_o
    s_sleep 1
    s_add_u32 s31, s31, 1
    s_cmp_lt_u32 s31, s30
    s_cbranch_scc1 XH_l
    s_mov_b32 s30, 1
XH_o:
    v_mfma_f32_16x16x32_bf16 v[116:119], a[0:3], v[96:99], 0
    v_mfma_f32_16x16x32_bf16 v[120:123], a[20:23], v[96:99], 0
    v_mfma_f32_16x16x32_bf16 v[124:127], a[40:43], v[96:99], 0
    v_mfma_f32_16x16x32_bf16 v[128:131], a[60:63], v[96:99], 0
    v_mfma_f32_16x16x32_bf16 v[132:135], a[80:83], v[96:99], 0
    v_mfma_f32_16x16x32_bf16 v[136:139], a[100:103], v[96:99], 0
    v_mfma_f32_16x16x32_bf16 v[116:119], a[4:7], v[100:103], v[116:119]
    v_mfma_f32_16x16x32_bf16 v[120:123], a[24:27], v[100:103], v[120:123]
    v_mfma_f32_16x16x32_bf16 v[124:127], a[44:47], v[100:103], v[124:127]
    v_mfma_f32_16x16x32_bf16 v[128:131], a[64:67], v[100:103], v[128:131]
    v_mfma_f32_16x16x32_bf16 v[132:135], a[84:87], v[100:103], v[132:135]
    v_mfma_f32_16x16x32_bf16 v[136:139], a[104:107], v[100:103], v[136:139]
    v_mfma_f32_16x16x32_bf16 v[116:119], a[8:11], v[104:107], v[116:119]
    v_mfma_f32_16x16x32_bf16 v[120:123], a[28:31], v[104:107], v[120:123]
    v_mfma_f32_16x16x32_bf16 v[124:127], a[48:51], v[104:107], v[124:127]
    v_mfma_f32_16x16x32_bf16 v[128:131], a[68:71], v[104:107], v[128:131]
    v_mfma_f32_16x16x32_bf16 v[132:135], a[88:91], v[104:107], v[132:135]
    v_mfma_f32_16x16x32_bf16 v[136:139], a[108:111], v[104:107], v[136:139]
    v_mfma_f32_16x16x32_bf16 v[116:119], a[12:15], v[108:111], v[116:119]
    v_mfma_f32_16x16x32_bf16 v[120:123], a[32:35], v[108:111], v[120:123]
    v_mfma_f32_16x16x32_bf16 v[124:127], a[52:55], v[108:111], v[124:127]
    v_mfma_f32_16x16x32_bf16 v[128:131], a[72:75], v[108:111], v[128:131]
    v_mfma_f32_16x16x32_bf16 v[132:135], a[92:95], v[108:111], v[132:135]
    v_mfma_f32_16x16x32_bf16 v[136:139], a[112:115], v[108:111], v[136:139]
    v_mfma_f32_16x16x32_bf16 v[116:119], a[16:19], v[112:115], v[116:119]
    v_mfma_f32_16x16x32_bf16 v[120:123], a[36:39], v[112:115], v[120:123]
    v_mfma_f32_16x16x32_bf16 v[124:127], a[56:59], v[112:115], v[124:127]
    v_mfma_f32_16x16x32_bf16 v[128:131], a[76:79], v[112:115], v[128:131]
    v_mfma_f32_16x16x32_bf16 v[132:135], a[96:99], v[112:115], v[132:135]
    v_mfma_f32_16x16x32_bf16 v[136:139], a[116:119], v[112:115], v[136:139]
    ds_write_b128 v19, v[116:119] offset:0
    ds_write_b128 v19, v[120:123] offset:1024
    ds_write_b128 v19, v[124:127] offset:2048
    ds_write_b128 v19, v[128:131] offset:3072
    ds_write_b128 v19, v[132:135] offset:4096
    s_nop 2
    ds_write_b128 v19, v[136:139] offset:5120
    v_lshrrev_b32 v30, 1, v18
    v_add3_u32 v27, v27, v30, s22
    s_waitcnt lgkmcnt(0)
    s_barrier
    s_cmp_eq_u32 s3, 3
    s_cbranch_scc1 XM_ng
    ds_read_b128 v[96:99], v20 offset:0
    ds_read_b128 v[100:103], v20 offset:1024
    ds_read_b128 v[104:107], v20 offset:6144
    ds_read_b128 v[108:111], v20 offset:7168
    ds_read_b128 v[112:115], v20 offset:12288
    ds_read_b128 v[116:119], v20 offset:13312
    ds_read_b128 v[120:123], v20 offset:18432
    ds_read_b128 v[124:127], v20 offset:19456
    s_waitcnt lgkmcnt(4)
    v_pk_add_f32 v[96:97], v[96:97], v[104:105]
    v_pk_add_f32 v[98:99], v[98:99], v[106:107]
    v_pk_add_f32 v[100:101], v[100:101], v[108:109]
    v_pk_add_f32 v[102:103], v[102:103], v[110:111]
    s_waitcnt lgkmcnt(2)
    v_pk_add_f32 v[96:97], v[96:97], v[112:113]
    v_pk_add_f32 v[98:99], v[98:99], v[114:115]
    v_pk_add_f32 v[100:101], v[100:101], v[116:117]
    v_pk_add_f32 v[102:103], v[102:103], v[118:119]
    s_waitcnt lgkmcnt(0)
    v_pk_add_f32 v[96:97], v[96:97], v[120:121]
    v_pk_add_f32 v[98:99], v[98:99], v[122:123]
    v_pk_add_f32 v[100:101], v[100:101], v[124:125]
    v_pk_add_f32 v[102:103], v[102:103], v[126:127]
    v_cvt_pk_bf16_f32 v100, v96, v100
    v_lshlrev_b32 v96, 16, v100
    v_and_b32 v100, 0xffff0000, v100
    v_mul_f32 v108, 0xbfb8aa3b, v96
    v_exp_f32 v108, v108
    s_nop 0
    v_add_f32 v108, 1.0, v108
    v_rcp_f32 v104, v108
    v_cvt_pk_bf16_f32 v101, v97, v101
    v_lshlrev_b32 v97, 16, v101
    v_and_b32 v101, 0xffff0000, v101
    v_mul_f32 v109, 0xbfb8aa3b, v97
    v_exp_f32 v109, v109
    s_nop 0
    v_add_f32 v109, 1.0, v109
    v_rcp_f32 v105, v109
    v_cvt_pk_bf16_f32 v102, v98, v102
    v_lshlrev_b32 v98, 16, v102
    v_and_b32 v102, 0xffff0000, v102
    v_mul_f32 v110, 0xbfb8aa3b, v98
    v_exp_f32 v110, v110
    s_nop 0
    v_add_f32 v110, 1.0, v110
    v_rcp_f32 v106, v110
    v_cvt_pk_bf16_f32 v103, v99, v103
    v_lshlrev_b32 v99, 16, v103
    v_and_b32 v103, 0xffff0000, v103
    v_mul_f32 v111, 0xbfb8aa3b, v99
    v_exp_f32 v111, v111
    s_nop 0
    v_add_f32 v111, 1.0, v111
    v_rcp_f32 v107, v111
    v_mul_f32 v96, v96, v104
    v_mul_f32 v97, v97, v105
    v_mul_f32 v98, v98, v106
    v_mul_f32 v99, v99, v107
    v_cvt_pk_bf16_f32 v97, v96, v97
    v_lshlrev_b32 v96, 16, v97
    v_and_b32 v97, 0xffff0000, v97
    v_cvt_pk_bf16_f32 v99, v98, v99
    v_lshlrev_b32 v98, 16, v99
    v_and_b32 v99, 0xffff0000, v99
    v_mul_f32 v96, v96, v100
    v_mul_f32 v97, v97, v101
    v_mul_f32 v98, v98, v102
    v_mul_f32 v99, v99, v103
    v_cvt_pk_bf16_f32 v96, v96, v97
    v_cvt_pk_bf16_f32 v97, v98, v99
    s_mov_b32 exec_lo, 0x00ff00ff
    s_mov_b32 exec_hi, 0x00ff00ff
    buffer_store_dwordx2 v[96:97], v16, s[8:11], s23 offen sc1
    s_mov_b64 exec, -1
XM_ng:
    s_cmp_ge_u32 s20, 20
    s_cbranch_scc1 XM_r
    s_mov_b32 s6, 59244544
    s_mov_b32 s7, 56623104
    buffer_load_dwordx2 v[144:145], v27, s[8:11], s6 offen sc1
    buffer_load_dwordx2 v[146:147], v27, s[8:11], s7 offen sc1
    s_waitcnt vmcnt(0)
    s_barrier
    buffer_load_dwordx4 v[96:99], v17, s[8:11], s23 offen offset:0 sc1
    buffer_load_dwordx4 v[100:103], v17, s[8:11], s23 offen offset:512 sc1
    buffer_load_dwordx4 v[104:107], v17, s[8:11], s23 offen offset:1024 sc1
    buffer_load_dwordx4 v[108:111], v17, s[8:11], s23 offen offset:1536 sc1
    buffer_load_dwordx4 v[112:115], v17, s[8:11], s23 offen offset:2048 sc1
    buffer_load_dwordx4 v[116:119], v17, s[8:11], s23 offen offset:2560 sc1
    buffer_load_dwordx4 v[120:123], v32, s[8:11], s23 offen offset:0 sc1
    buffer_load_dwordx4 v[124:127], v32, s[8:11], s23 offen offset:512 sc1
    buffer_load_dwordx4 v[128:131], v32, s[8:11], s23 offen offset:1024 sc1
    buffer_load_dwordx4 v[132:135], v32, s[8:11], s23 offen offset:1536 sc1
    buffer_load_dwordx4 v[136:139], v32, s[8:11], s23 offen offset:2048 sc1
    buffer_load_dwordx4 v[140:143], v32, s[8:11], s23 offen offset:2560 sc1
    v_and_b32 v30, 0xffff0000, v26
    v_ashrrev_i32 v31, 31, v30
    v_not_b32 v31, v31
    v_or_b32 v31, 0x80000000, v31
    v_xor_b32 v30, v30, v31
    v_and_b32 v30, 0xffff0000, v30
    v_mul_f32 v31, 0xbfb8aa3b, v30
    v_exp_f32 v31, v31
    s_nop 0
    v_add_f32 v31, 1.0, v31
    v_rcp_f32 v30, v31
    s_nop 0
    v_cvt_pk_bf16_f32 v30, v30, v30
    v_and_b32 v30, 0xffff0000, v30
    s_mov_b32 s31, 0
    s_waitcnt vmcnt(0)
    v_max3_u32 v31, v144, v145, v146
    v_max3_u32 v31, v31, v147, v96
    v_max3_u32 v31, v31, v97, v98
    v_max3_u32 v31, v31, v99, v100
    v_max3_u32 v31, v31, v101, v102
    v_max3_u32 v31, v31, v103, v104
    v_max3_u32 v31, v31, v105, v106
    v_max3_u32 v31, v31, v107, v108
    v_max3_u32 v31, v31, v109, v110
    v_max3_u32 v31, v31, v111, v112
    v_max3_u32 v31, v31, v113, v114
    v_max3_u32 v31, v31, v115, v116
    v_max3_u32 v31, v31, v117, v118
    v_max3_u32 v31, v31, v119, v120
    v_max3_u32 v31, v31, v121, v122
    v_max3_u32 v31, v31, v123, v124
    v_max3_u32 v31, v31, v125, v126
    v_max3_u32 v31, v31, v127, v128
    v_max3_u32 v31, v31, v129, v130
    v_max3_u32 v31, v31, v131, v132
    v_max3_u32 v31, v31, v133, v134
    v_max3_u32 v31, v31, v135, v136
    v_max3_u32 v31, v31, v137, v138
    v_max3_u32 v31, v31, v139, v140
    v_max3_u32 v31, v31, v141, v142
    v_max_u32 v31, v31, v143
    v_cmp_eq_u32 vcc, -1, v31
    s_cbranch_vccz XA_o
XA_l:
    s_mov_b32 s4, 0
    s_sleep 1
    v_max3_u32 v31, v144, v145, v146
    v_max_u32 v31, v31, v147
    v_cmp_eq_u32 vcc, -1, v31
    s_cbranch_vccz XA_k0
    buffer_load_dwordx2 v[144:145], v27, s[8:11], s6 offen sc1
    buffer_load_dwordx2 v[146:147], v27, s[8:11], s7 offen sc1
    s_mov_b32 s4, 1
XA_k0:
    v_max3_u32 v31, v96, v97, v98
    v_max3_u32 v31, v31, v99, v100
    v_max3_u32 v31, v31, v101, v102
    v_max3_u32 v31, v31, v103, v104
    v_max3_u32 v31, v31, v105, v106
    v_max_u32 v31, v31, v107
    v_cmp_eq_u32 vcc, -1, v31
    s_cbranch_vccz XA_k1
    buffer_load_dwordx4 v[96:99], v17, s[8:11], s23 offen offset:0 sc1
    buffer_load_dwordx4 v[100:103], v17, s[8:11], s23 offen offset:512 sc1
    buffer_load_dwordx4 v[104:107], v17, s[8:11], s23 offen offset:1024 sc1
    s_mov_b32 s4, 1
XA_k1:
    v_max3_u32 v31, v108, v109, v110
    v_max3_u32 v31, v31, v111, v112
    v_max3_u32 v31, v31, v113, v114
    v_max3_u32 v31, v31, v115, v116
    v_max3_u32 v31, v31, v117, v118
    v_max_u32 v31, v31, v119
    v_cmp_eq_u32 vcc, -1, v31
    s_cbranch_vccz XA_k2
    buffer_load_dwordx4 v[108:111], v17, s[8:11], s23 offen offset:1536 sc1
    buffer_load_dwordx4 v[112:115], v17, s[8:11], s23 offen offset:2048 sc1
    buffer_load_dwordx4 v[116:119], v17, s[8:11], s23 offen offset:2560 sc1
    s_mov_b32 s4, 1
XA_k2:
    v_max3_u32 v31, v120, v121, v122
    v_max3_u32 v31, v31, v123, v124
    v_max3_u32 v31, v31, v125, v126
    v_max3_u32 v31, v31, v127, v128
    v_max3_u32 v31, v31, v129, v130
    v_max_u32 v31, v31, v131
    v_cmp_eq_u32 vcc, -1, v31
    s_cbranch_vccz XA_k3
    buffer_load_dwordx4 v[120:123], v32, s[8:11], s23 offen offset:0 sc1
    buffer_load_dwordx4 v[124:127], v32, s[8:11], s23 offen offset:512 sc1
    buffer_load_dwordx4 v[128:131], v32, s[8:11], s23 offen offset:1024 sc1
    s_mov_b32 s4, 1
XA_k3:
    v_max3_u32 v31, v132, v133, v134
    v_max3_u32 v31, v31, v135, v136
    v_max3_u32 v31, v31, v137, v138
    v_max3_u32 v31, v31, v139, v140
    v_max3_u32 v31, v31, v141, v142
    v_max_u32 v31, v31, v143
    v_cmp_eq_u32 vcc, -1, v31
    s_cbranch_vccz XA_k4
    buffer_load_dwordx4 v[132:135], v32, s[8:11], s23 offen offset:1536 sc1
    buffer_load_dwordx4 v[136:139], v32, s[8:11], s23 offen offset:2048 sc1
    buffer_load_dwordx4 v[140:143], v32, s[8:11], s23 offen offset:2560 sc1
    s_mov_b32 s4, 1
XA_k4:
    s_cmp_eq_u32 s4, 0
    s_cbranch_scc1 XA_o
    s_waitcnt vmcnt(0)
    s_add_u32 s31, s31, 1
    s_cmp_lt_u32 s31, s30
    s_cbranch_scc1 XA_l
    s_mov_b32 s30, 1
XA_o:
    v_mfma_f32_16x16x32_bf16 v[148:151], a[120:123], v[96:99], 0
    v_mfma_f32_16x16x32_bf16 v[152:155], a[168:171], v[96:99], 0
    v_mfma_f32_16x16x32_bf16 v[148:151], a[124:127], v[100:103], v[148:151]
    v_mfma_f32_16x16x32_bf16 v[152:155], a[172:175], v[100:103], v[152:155]
    v_mfma_f32_16x16x32_bf16 v[148:151], a[128:131], v[104:107], v[148:151]
    v_mfma_f32_16x16x32_bf16 v[152:155], a[176:179], v[104:107], v[152:155]
    v_mfma_f32_16x16x32_bf16 v[148:151], a[132:135], v[108:111], v[148:151]
    v_mfma_f32_16x16x32_bf16 v[152:155], a[180:183], v[108:111], v[152:155]
    v_mfma_f32_16x16x32_bf16 v[148:151], a[136:139], v[112:115], v[148:151]
    v_mfma_f32_16x16x32_bf16 v[152:155], a[184:187], v[112:115], v[152:155]
    v_mfma_f32_16x16x32_bf16 v[148:151], a[140:143], v[116:119], v[148:151]
    v_mfma_f32_16x16x32_bf16 v[152:155], a[188:191], v[116:119], v[152:155]
    v_mfma_f32_16x16x32_bf16 v[148:151], a[144:147], v[120:123], v[148:151]
    v_mfma_f32_16x16x32_bf16 v[152:155], a[192:195], v[120:123], v[152:155]
    v_mfma_f32_16x16x32_bf16 v[148:151], a[148:151], v[124:127], v[148:151]
    v_mfma_f32_16x16x32_bf16 v[152:155], a[196:199], v[124:127], v[152:155]
    v_mfma_f32_16x16x32_bf16 v[148:151], a[152:155], v[128:131], v[148:151]
    v_mfma_f32_16x16x32_bf16 v[152:155], a[200:203], v[128:131], v[152:155]
    v_mfma_f32_16x16x32_bf16 v[148:151], a[156:159], v[132:135], v[148:151]
    v_mfma_f32_16x16x32_bf16 v[152:155], a[204:207], v[132:135], v[152:155]
    v_mfma_f32_16x16x32_bf16 v[148:151], a[160:163], v[136:139], v[148:151]
    v_mfma_f32_16x16x32_bf16 v[152:155], a[208:211], v[136:139], v[152:155]
    v_mfma_f32_16x16x32_bf16 v[148:151], a[164:167], v[140:143], v[148:151]
    v_mfma_f32_16x16x32_bf16 v[152:155], a[212:215], v[140:143], v[152:155]
    s_nop 3
    ds_write_b128 v20, v[148:151] offset:24576
    s_nop 2
    ds_write_b128 v20, v[152:155] offset:25600
    s_waitcnt lgkmcnt(0)
    s_barrier
    s_cmp_ge_u32 s3, 2
    s_cbranch_scc1 XM_r
    ds_read_b128 v[96:99], v21 offset:24576
    ds_read_b128 v[100:103], v21 offset:26624
    ds_read_b128 v[104:107], v21 offset:28672
    ds_read_b128 v[108:111], v21 offset:30720
    s_waitcnt lgkmcnt(0)
    v_pk_add_f32 v[96:97], v[96:97], v[100:101]
    v_pk_add_f32 v[98:99], v[98:99], v[102:103]
    v_pk_add_f32 v[96:97], v[96:97], v[104:105]
    v_pk_add_f32 v[98:99], v[98:99], v[106:107]
    v_pk_add_f32 v[96:97], v[96:97], v[108:109]
    v_pk_add_f32 v[98:99], v[98:99], v[110:111]
    v_cvt_pk_bf16_f32 v97, v96, v97
    v_lshlrev_b32 v96, 16, v97
    v_and_b32 v97, 0xffff0000, v97
    v_mul_f32 v96, v96, v30
    v_mul_f32 v97, v97, v30
    v_cvt_pk_bf16_f32 v97, v96, v97
    v_lshlrev_b32 v96, 16, v97
    v_and_b32 v97, 0xffff0000, v97
    v_lshlrev_b32 v104, 16, v144
    v_and_b32 v105, 0xffff0000, v144
    v_add_f32 v96, v96, v104
    v_add_f32 v97, v97, v105
    v_cvt_pk_bf16_f32 v97, v96, v97
    v_lshlrev_b32 v96, 16, v97
    v_and_b32 v97, 0xffff0000, v97
    v_mul_f32 v96, v96, v22
    v_mul_f32 v97, v97, v23
    v_cvt_pk_bf16_f32 v97, v96, v97
    v_lshlrev_b32 v96, 16, v97
    v_and_b32 v97, 0xffff0000, v97
    v_lshlrev_b32 v104, 16, v146
    v_and_b32 v105, 0xffff0000, v146
    v_add_f32 v96, v96, v104
    v_add_f32 v97, v97, v105
    v_cvt_pk_bf16_f32 v28, v96, v97
    v_cvt_pk_bf16_f32 v99, v98, v99
    v_lshlrev_b32 v98, 16, v99
    v_and_b32 v99, 0xffff0000, v99
    v_mul_f32 v98, v98, v30
    v_mul_f32 v99, v99, v30
    v_cvt_pk_bf16_f32 v99, v98, v99
    v_lshlrev_b32 v98, 16, v99
    v_and_b32 v99, 0xffff0000, v99
    v_lshlrev_b32 v104, 16, v145
    v_and_b32 v105, 0xffff0000, v145
    v_add_f32 v98, v98, v104
    v_add_f32 v99, v99, v105
    v_cvt_pk_bf16_f32 v99, v98, v99
    v_lshlrev_b32 v98, 16, v99
    v_and_b32 v99, 0xffff0000, v99
    v_mul_f32 v98, v98, v24
    v_mul_f32 v99, v99, v25
    v_cvt_pk_bf16_f32 v99, v98, v99
    v_lshlrev_b32 v98, 16, v99
    v_and_b32 v99, 0xffff0000, v99
    v_lshlrev_b32 v104, 16, v147
    v_and_b32 v105, 0xffff0000, v147
    v_add_f32 v98, v98, v104
    v_add_f32 v99, v99, v105
    v_cvt_pk_bf16_f32 v29, v98, v99
XM_r:
    s_setpc_b64 s[100:101]
XG_sub:
    s_lshl_b32 s4, s43, 2
    s_add_u32 s4, s4, 16384
    s_lshl_b32 s5, s43, 7
    s_add_u32 s5, s5, 61636608
    s_cmp_lt_u32 s43, 1792
    s_cselect_b32 s5, s4, s5
    s_cselect_b32 s4, 2, 7
    v_lshlrev_b32 v93, s4, v1
    s_sub_u32 s4, 0x7ff, s43
    v_sub_u32 v94, s4, v1
    s_add_u32 s43, s43, 64
    s_mov_b32 s31, 0
XG_l:
    buffer_load_dword v92, v93, s[8:11], s5 offen sc1
    s_waitcnt vmcnt(0)
    v_max_u32 v95, v92, v92
    v_cmp_eq_u32 vcc, -1, v95
    s_cbranch_vccz XG_o
    s_sleep 1
    s_add_u32 s31, s31, 1
    s_cmp_lt_u32 s31, s30
    s_cbranch_scc1 XG_l
    s_mov_b32 s30, 1
XG_o:
    v_ashrrev_i32 v95, 31, v92
    v_or_b32 v95, 0x80000000, v95
    v_xor_b32 v92, v92, v95
    v_and_b32 v92, 0xffff0000, v92
    v_or_b32 v92, v92, v94
    s_mov_b64 s[6:7], -1
XG_i:
    v_cmp_lt_u32 vcc, s49, v92
    s_and_b64 s[6:7], s[6:7], vcc
    s_cbranch_scc0 XG_d
    s_mov_b32 s27, 1
    s_ff1_i32_b64 s4, s[6:7]
    v_readlane_b32 s5, v92, s4
    s_bitset0_b64 s[6:7], s4
    s_min_u32 s4, s5, s44
    s_max_u32 s44, s5, s44
    s_min_u32 s5, s4, s45
    s_max_u32 s45, s4, s45
    s_min_u32 s4, s5, s46
    s_max_u32 s46, s5, s46
    s_min_u32 s5, s4, s47
    s_max_u32 s47, s4, s47
    s_min_u32 s4, s5, s38
    s_max_u32 s38, s5, s38
    s_min_u32 s5, s4, s39
    s_max_u32 s39, s4, s39
    s_min_u32 s4, s5, s48
    s_max_u32 s48, s5, s48
    s_min_u32 s5, s4, s49
    s_max_u32 s49, s4, s49
    s_branch XG_i
XG_d:
    s_setpc_b64 s[100:101]
T3_sub:
    v_lshrrev_b32 v18, 3, v1
    v_lshlrev_b32 v19, 10, v18
    v_lshl_add_u32 v19, v17, 4, v19
    v_lshlrev_b32 v18, 7, v18
    v_lshl_add_u32 v18, v17, 2, v18
    s_lshl_b32 s4, s3, 5
    v_add_u32 v18, s4, v18
    s_andn2_b32 s4, s96, 3
    s_lshl_b32 s4, s4, 5
    s_add_u32 s4, s4, s35
    s_mul_i32 s5, s3, 81920
    s_add_u32 s4, s4, s5
    s_mul_i32 s5, s3, 10240
    s_barrier
    s_add_u32 m0, s5, 0
    s_nop 0
    buffer_load_dwordx4 v19, s[8:11], s4 offen sc1 lds
    s_add_u32 s4, s4, 8192
    s_add_u32 m0, s5, 1024
    s_nop 0
    buffer_load_dwordx4 v19, s[8:11], s4 offen sc1 lds
    s_add_u32 s4, s4, 8192
    s_add_u32 m0, s5, 2048
    s_nop 0
    buffer_load_dwordx4 v19, s[8:11], s4 offen sc1 lds
    s_add_u32 s4, s4, 8192
    s_add_u32 m0, s5, 3072
    s_nop 0
    buffer_load_dwordx4 v19, s[8:11], s4 offen sc1 lds
    s_add_u32 s4, s4, 8192
    s_add_u32 m0, s5, 4096
    s_nop 0
    buffer_load_dwordx4 v19, s[8:11], s4 offen sc1 lds
    s_add_u32 s4, s4, 8192
    s_add_u32 m0, s5, 5120
    s_nop 0
    buffer_load_dwordx4 v19, s[8:11], s4 offen sc1 lds
    s_add_u32 s4, s4, 8192
    s_add_u32 m0, s5, 6144
    s_nop 0
    buffer_load_dwordx4 v19, s[8:11], s4 offen sc1 lds
    s_add_u32 s4, s4, 8192
    s_add_u32 m0, s5, 7168
    s_nop 0
    buffer_load_dwordx4 v19, s[8:11], s4 offen sc1 lds
    s_add_u32 s4, s4, 8192
    s_add_u32 m0, s5, 8192
    s_nop 0
    buffer_load_dwordx4 v19, s[8:11], s4 offen sc1 lds
    s_add_u32 s4, s4, 8192
    s_add_u32 m0, s5, 9216
    s_nop 0
    buffer_load_dwordx4 v19, s[8:11], s4 offen sc1 lds
    s_add_u32 s4, s4, 8192
    v_mov_b32 v140, v224
    v_mov_b32 v141, v225
    v_mov_b32 v142, v226
    v_mov_b32 v143, v227
    v_mov_b32 v144, v228
    s_waitcnt vmcnt(0)
    s_barrier
    s_add_u32 s4, s24, 81920
    buffer_load_dword v224, v3, s[12:15], s4 offen offset:0
    buffer_load_dword v225, v3, s[12:15], s4 offen offset:256
    buffer_load_dword v226, v3, s[12:15], s4 offen offset:512
    buffer_load_dword v227, v3, s[12:15], s4 offen offset:768
    buffer_load_dword v228, v3, s[12:15], s4 offen offset:1024
    ds_read2st64_b32 v[184:185], v18 offset0:0 offset1:4
    ds_read2st64_b32 v[186:187], v18 offset0:8 offset1:12
    ds_read2st64_b32 v[188:189], v18 offset0:16 offset1:20
    ds_read2st64_b32 v[190:191], v18 offset0:24 offset1:28
    ds_read2st64_b32 v[192:193], v18 offset0:32 offset1:36
    ds_read2st64_b32 v[194:195], v18 offset0:40 offset1:44
    ds_read2st64_b32 v[196:197], v18 offset0:48 offset1:52
    ds_read2st64_b32 v[198:199], v18 offset0:56 offset1:60
    ds_read2st64_b32 v[200:201], v18 offset0:64 offset1:68
    ds_read2st64_b32 v[202:203], v18 offset0:72 offset1:76
    ds_read2st64_b32 v[204:205], v18 offset0:80 offset1:84
    ds_read2st64_b32 v[206:207], v18 offset0:88 offset1:92
    ds_read2st64_b32 v[208:209], v18 offset0:96 offset1:100
    ds_read2st64_b32 v[210:211], v18 offset0:104 offset1:108
    ds_read2st64_b32 v[212:213], v18 offset0:112 offset1:116
    ds_read2st64_b32 v[214:215], v18 offset0:120 offset1:124
    ds_read2st64_b32 v[216:217], v18 offset0:128 offset1:132
    ds_read2st64_b32 v[218:219], v18 offset0:136 offset1:140
    ds_read2st64_b32 v[220:221], v18 offset0:144 offset1:148
    ds_read2st64_b32 v[222:223], v18 offset0:152 offset1:156
    s_waitcnt lgkmcnt(0)
    v_max3_u32 v6, v184, v185, v186
    v_max3_u32 v6, v6, v187, v188
    v_max3_u32 v6, v6, v189, v190
    v_max3_u32 v6, v6, v191, v192
    v_max3_u32 v6, v6, v193, v194
    v_max3_u32 v6, v6, v195, v196
    v_max3_u32 v6, v6, v197, v198
    v_max3_u32 v6, v6, v199, v200
    v_max3_u32 v6, v6, v201, v202
    v_max3_u32 v6, v6, v203, v204
    v_max3_u32 v6, v6, v205, v206
    v_max3_u32 v6, v6, v207, v208
    v_max3_u32 v6, v6, v209, v210
    v_max3_u32 v6, v6, v211, v212
    v_max3_u32 v6, v6, v213, v214
    v_max3_u32 v6, v6, v215, v216
    v_max3_u32 v6, v6, v217, v218
    v_max3_u32 v6, v6, v219, v220
    v_max3_u32 v6, v6, v221, v222
    v_max_u32 v6, v6, v223
    v_cmp_eq_u32 vcc, -1, v6
    s_cbranch_vccz T3p_o
    s_mov_b32 s31, 0
T3p_l:
    s_add_u32 s4, s35, 0
    buffer_load_dword v184, v16, s[8:11], s4 offen offset:0 sc1
    s_add_u32 s4, s35, 8192
    buffer_load_dword v185, v16, s[8:11], s4 offen offset:0 sc1
    s_add_u32 s4, s35, 16384
    buffer_load_dword v186, v16, s[8:11], s4 offen offset:0 sc1
    s_add_u32 s4, s35, 24576
    buffer_load_dword v187, v16, s[8:11], s4 offen offset:0 sc1
    s_add_u32 s4, s35, 32768
    buffer_load_dword v188, v16, s[8:11], s4 offen offset:0 sc1
    s_add_u32 s4, s35, 40960
    buffer_load_dword v189, v16, s[8:11], s4 offen offset:0 sc1
    s_add_u32 s4, s35, 49152
    buffer_load_dword v190, v16, s[8:11], s4 offen offset:0 sc1
    s_add_u32 s4, s35, 57344
    buffer_load_dword v191, v16, s[8:11], s4 offen offset:0 sc1
    s_add_u32 s4, s35, 65536
    buffer_load_dword v192, v16, s[8:11], s4 offen offset:0 sc1
    s_add_u32 s4, s35, 73728
    buffer_load_dword v193, v16, s[8:11], s4 offen offset:0 sc1
    s_add_u32 s4, s35, 81920
    buffer_load_dword v194, v16, s[8:11], s4 offen offset:0 sc1
    s_add_u32 s4, s35, 90112
    buffer_load_dword v195, v16, s[8:11], s4 offen offset:0 sc1
    s_add_u32 s4, s35, 98304
    buffer_load_dword v196, v16, s[8:11], s4 offen offset:0 sc1
    s_add_u32 s4, s35, 106496
    buffer_load_dword v197, v16, s[8:11], s4 offen offset:0 sc1
    s_add_u32 s4, s35, 114688
    buffer_load_dword v198, v16, s[8:11], s4 offen offset:0 sc1
    s_add_u32 s4, s35, 122880
    buffer_load_dword v199, v16, s[8:11], s4 offen offset:0 sc1
    s_add_u32 s4, s35, 131072
    buffer_load_dword v200, v16, s[8:11], s4 offen offset:0 sc1
    s_add_u32 s4, s35, 139264
    buffer_load_dword v201, v16, s[8:11], s4 offen offset:0 sc1
    s_add_u32 s4, s35, 147456
    buffer_load_dword v202, v16, s[8:11], s4 offen offset:0 sc1
    s_add_u32 s4, s35, 155648
    buffer_load_dword v203, v16, s[8:11], s4 offen offset:0 sc1
    s_add_u32 s4, s35, 163840
    buffer_load_dword v204, v16, s[8:11], s4 offen offset:0 sc1
    s_add_u32 s4, s35, 172032
    buffer_load_dword v205, v16, s[8:11], s4 offen offset:0 sc1
    s_add_u32 s4, s35, 180224
    buffer_load_dword v206, v16, s[8:11], s4 offen offset:0 sc1
    s_add_u32 s4, s35, 188416
    buffer_load_dword v207, v16, s[8:11], s4 offen offset:0 sc1
    s_add_u32 s4, s35, 196608
    buffer_load_dword v208, v16, s[8:11], s4 offen offset:0 sc1
    s_add_u32 s4, s35, 204800
    buffer_load_dword v209, v16, s[8:11], s4 offen offset:0 sc1
    s_add_u32 s4, s35, 212992
    buffer_load_dword v210, v16, s[8:11], s4 offen offset:0 sc1
    s_add_u32 s4, s35, 221184
    buffer_load_dword v211, v16, s[8:11], s4 offen offset:0 sc1
    s_add_u32 s4, s35, 229376
    buffer_load_dword v212, v16, s[8:11], s4 offen offset:0 sc1
    s_add_u32 s4, s35, 237568
    buffer_load_dword v213, v16, s[8:11], s4 offen offset:0 sc1
    s_add_u32 s4, s35, 245760
    buffer_load_dword v214, v16, s[8:11], s4 offen offset:0 sc1
    s_add_u32 s4, s35, 253952
    buffer_load_dword v215, v16, s[8:11], s4 offen offset:0 sc1
    s_add_u32 s4, s35, 262144
    buffer_load_dword v216, v16, s[8:11], s4 offen offset:0 sc1
    s_add_u32 s4, s35, 270336
    buffer_load_dword v217, v16, s[8:11], s4 offen offset:0 sc1
    s_add_u32 s4, s35, 278528
    buffer_load_dword v218, v16, s[8:11], s4 offen offset:0 sc1
    s_add_u32 s4, s35, 286720
    buffer_load_dword v219, v16, s[8:11], s4 offen offset:0 sc1
    s_add_u32 s4, s35, 294912
    buffer_load_dword v220, v16, s[8:11], s4 offen offset:0 sc1
    s_add_u32 s4, s35, 303104
    buffer_load_dword v221, v16, s[8:11], s4 offen offset:0 sc1
    s_add_u32 s4, s35, 311296
    buffer_load_dword v222, v16, s[8:11], s4 offen offset:0 sc1
    s_add_u32 s4, s35, 319488
    buffer_load_dword v223, v16, s[8:11], s4 offen offset:0 sc1
    s_waitcnt vmcnt(0)
    v_max3_u32 v6, v184, v185, v186
    v_max3_u32 v6, v6, v187, v188
    v_max3_u32 v6, v6, v189, v190
    v_max3_u32 v6, v6, v191, v192
    v_max3_u32 v6, v6, v193, v194
    v_max3_u32 v6, v6, v195, v196
    v_max3_u32 v6, v6, v197, v198
    v_max3_u32 v6, v6, v199, v200
    v_max3_u32 v6, v6, v201, v202
    v_max3_u32 v6, v6, v203, v204
    v_max3_u32 v6, v6, v205, v206
    v_max3_u32 v6, v6, v207, v208
    v_max3_u32 v6, v6, v209, v210
    v_max3_u32 v6, v6, v211, v212
    v_max3_u32 v6, v6, v213, v214
    v_max3_u32 v6, v6, v215, v216
    v_max3_u32 v6, v6, v217, v218
    v_max3_u32 v6, v6, v219, v220
    v_max3_u32 v6, v6, v221, v222
    v_max_u32 v6, v6, v223
    v_cmp_eq_u32 vcc, -1, v6
    s_cbranch_vccz T3p_o
    s_sleep 1
    s_add_u32 s31, s31, 1
    s_cmp_lt_u32 s31, s30
    s_cbranch_scc1 T3p_l
    s_mov_b32 s30, 1
T3p_o:
    v_lshlrev_b32 v160, 16, v184
    v_and_b32 v161, 0xffff0000, v184
    v_lshlrev_b32 v162, 16, v186
    v_and_b32 v163, 0xffff0000, v186
    v_lshlrev_b32 v164, 16, v188
    v_and_b32 v165, 0xffff0000, v188
    v_lshlrev_b32 v166, 16, v190
    v_and_b32 v167, 0xffff0000, v190
    v_lshlrev_b32 v168, 16, v192
    v_and_b32 v169, 0xffff0000, v192
    v_lshlrev_b32 v6, 16, v185
    v_and_b32 v7, 0xffff0000, v185
    v_pk_add_f32 v[160:161], v[160:161], v[6:7]
    v_lshlrev_b32 v6, 16, v187
    v_and_b32 v7, 0xffff0000, v187
    v_pk_add_f32 v[162:163], v[162:163], v[6:7]
    v_lshlrev_b32 v6, 16, v189
    v_and_b32 v7, 0xffff0000, v189
    v_pk_add_f32 v[164:165], v[164:165], v[6:7]
    v_lshlrev_b32 v6, 16, v191
    v_and_b32 v7, 0xffff0000, v191
    v_pk_add_f32 v[166:167], v[166:167], v[6:7]
    v_lshlrev_b32 v6, 16, v193
    v_and_b32 v7, 0xffff0000, v193
    v_pk_add_f32 v[168:169], v[168:169], v[6:7]
    v_lshlrev_b32 v6, 16, v194
    v_and_b32 v7, 0xffff0000, v194
    v_pk_add_f32 v[160:161], v[160:161], v[6:7]
    v_lshlrev_b32 v6, 16, v196
    v_and_b32 v7, 0xffff0000, v196
    v_pk_add_f32 v[162:163], v[162:163], v[6:7]
    v_lshlrev_b32 v6, 16, v198
    v_and_b32 v7, 0xffff0000, v198
    v_pk_add_f32 v[164:165], v[164:165], v[6:7]
    v_lshlrev_b32 v6, 16, v200
    v_and_b32 v7, 0xffff0000, v200
    v_pk_add_f32 v[166:167], v[166:167], v[6:7]
    v_lshlrev_b32 v6, 16, v202
    v_and_b32 v7, 0xffff0000, v202
    v_pk_add_f32 v[168:169], v[168:169], v[6:7]
    v_lshlrev_b32 v6, 16, v195
    v_and_b32 v7, 0xffff0000, v195
    v_pk_add_f32 v[160:161], v[160:161], v[6:7]
    v_lshlrev_b32 v6, 16, v197
    v_and_b32 v7, 0xffff0000, v197
    v_pk_add_f32 v[162:163], v[162:163], v[6:7]
    v_lshlrev_b32 v6, 16, v199
    v_and_b32 v7, 0xffff0000, v199
    v_pk_add_f32 v[164:165], v[164:165], v[6:7]
    v_lshlrev_b32 v6, 16, v201
    v_and_b32 v7, 0xffff0000, v201
    v_pk_add_f32 v[166:167], v[166:167], v[6:7]
    v_lshlrev_b32 v6, 16, v203
    v_and_b32 v7, 0xffff0000, v203
    v_pk_add_f32 v[168:169], v[168:169], v[6:7]
    v_lshlrev_b32 v6, 16, v204
    v_and_b32 v7, 0xffff0000, v204
    v_pk_add_f32 v[160:161], v[160:161], v[6:7]
    v_lshlrev_b32 v6, 16, v206
    v_and_b32 v7, 0xffff0000, v206
    v_pk_add_f32 v[162:163], v[162:163], v[6:7]
    v_lshlrev_b32 v6, 16, v208
    v_and_b32 v7, 0xffff0000, v208
    v_pk_add_f32 v[164:165], v[164:165], v[6:7]
    v_lshlrev_b32 v6, 16, v210
    v_and_b32 v7, 0xffff0000, v210
    v_pk_add_f32 v[166:167], v[166:167], v[6:7]
    v_lshlrev_b32 v6, 16, v212
    v_and_b32 v7, 0xffff0000, v212
    v_pk_add_f32 v[168:169], v[168:169], v[6:7]
    v_lshlrev_b32 v6, 16, v205
    v_and_b32 v7, 0xffff0000, v205
    v_pk_add_f32 v[160:161], v[160:161], v[6:7]
    v_lshlrev_b32 v6, 16, v207
    v_and_b32 v7, 0xffff0000, v207
    v_pk_add_f32 v[162:163], v[162:163], v[6:7]
    v_lshlrev_b32 v6, 16, v209
    v_and_b32 v7, 0xffff0000, v209
    v_pk_add_f32 v[164:165], v[164:165], v[6:7]
    v_lshlrev_b32 v6, 16, v211
    v_and_b32 v7, 0xffff0000, v211
    v_pk_add_f32 v[166:167], v[166:167], v[6:7]
    v_lshlrev_b32 v6, 16, v213
    v_and_b32 v7, 0xffff0000, v213
    v_pk_add_f32 v[168:169], v[168:169], v[6:7]
    v_lshlrev_b32 v6, 16, v214
    v_and_b32 v7, 0xffff0000, v214
    v_pk_add_f32 v[160:161], v[160:161], v[6:7]
    v_lshlrev_b32 v6, 16, v216
    v_and_b32 v7, 0xffff0000, v216
    v_pk_add_f32 v[162:163], v[162:163], v[6:7]
    v_lshlrev_b32 v6, 16, v218
    v_and_b32 v7, 0xffff0000, v218
    v_pk_add_f32 v[164:165], v[164:165], v[6:7]
    v_lshlrev_b32 v6, 16, v220
    v_and_b32 v7, 0xffff0000, v220
    v_pk_add_f32 v[166:167], v[166:167], v[6:7]
    v_lshlrev_b32 v6, 16, v222
    v_and_b32 v7, 0xffff0000, v222
    v_pk_add_f32 v[168:169], v[168:169], v[6:7]
    v_lshlrev_b32 v6, 16, v215
    v_and_b32 v7, 0xffff0000, v215
    v_pk_add_f32 v[160:161], v[160:161], v[6:7]
    v_lshlrev_b32 v6, 16, v217
    v_and_b32 v7, 0xffff0000, v217
    v_pk_add_f32 v[162:163], v[162:163], v[6:7]
    v_lshlrev_b32 v6, 16, v219
    v_and_b32 v7, 0xffff0000, v219
    v_pk_add_f32 v[164:165], v[164:165], v[6:7]
    v_lshlrev_b32 v6, 16, v221
    v_and_b32 v7, 0xffff0000, v221
    v_pk_add_f32 v[166:167], v[166:167], v[6:7]
    v_lshlrev_b32 v6, 16, v223
    v_and_b32 v7, 0xffff0000, v223
    v_pk_add_f32 v[168:169], v[168:169], v[6:7]
    v_cvt_pk_bf16_f32 v161, v160, v161
    v_lshlrev_b32 v160, 16, v161
    v_and_b32 v161, 0xffff0000, v161
    v_mul_f32 v160, v160, v146
    v_mul_f32 v161, v161, v147
    v_cvt_pk_bf16_f32 v161, v160, v161
    v_lshlrev_b32 v160, 16, v161
    v_and_b32 v161, 0xffff0000, v161
    v_lshlrev_b32 v6, 16, v140
    v_and_b32 v7, 0xffff0000, v140
    v_add_f32 v160, v160, v6
    v_add_f32 v161, v161, v7
    v_cvt_pk_bf16_f32 v140, v160, v161
    v_cvt_pk_bf16_f32 v163, v162, v163
    v_lshlrev_b32 v162, 16, v163
    v_and_b32 v163, 0xffff0000, v163
    v_mul_f32 v162, v162, v148
    v_mul_f32 v163, v163, v149
    v_cvt_pk_bf16_f32 v163, v162, v163
    v_lshlrev_b32 v162, 16, v163
    v_and_b32 v163, 0xffff0000, v163
    v_lshlrev_b32 v6, 16, v141
    v_and_b32 v7, 0xffff0000, v141
    v_add_f32 v162, v162, v6
    v_add_f32 v163, v163, v7
    v_cvt_pk_bf16_f32 v141, v162, v163
    v_cvt_pk_bf16_f32 v165, v164, v165
    v_lshlrev_b32 v164, 16, v165
    v_and_b32 v165, 0xffff0000, v165
    v_mul_f32 v164, v164, v150
    v_mul_f32 v165, v165, v151
    v_cvt_pk_bf16_f32 v165, v164, v165
    v_lshlrev_b32 v164, 16, v165
    v_and_b32 v165, 0xffff0000, v165
    v_lshlrev_b32 v6, 16, v142
    v_and_b32 v7, 0xffff0000, v142
    v_add_f32 v164, v164, v6
    v_add_f32 v165, v165, v7
    v_cvt_pk_bf16_f32 v142, v164, v165
    v_cvt_pk_bf16_f32 v167, v166, v167
    v_lshlrev_b32 v166, 16, v167
    v_and_b32 v167, 0xffff0000, v167
    v_mul_f32 v166, v166, v152
    v_mul_f32 v167, v167, v153
    v_cvt_pk_bf16_f32 v167, v166, v167
    v_lshlrev_b32 v166, 16, v167
    v_and_b32 v167, 0xffff0000, v167
    v_lshlrev_b32 v6, 16, v143
    v_and_b32 v7, 0xffff0000, v143
    v_add_f32 v166, v166, v6
    v_add_f32 v167, v167, v7
    v_cvt_pk_bf16_f32 v143, v166, v167
    v_cvt_pk_bf16_f32 v169, v168, v169
    v_lshlrev_b32 v168, 16, v169
    v_and_b32 v169, 0xffff0000, v169
    v_mul_f32 v168, v168, v154
    v_mul_f32 v169, v169, v155
    v_cvt_pk_bf16_f32 v169, v168, v169
    v_lshlrev_b32 v168, 16, v169
    v_and_b32 v169, 0xffff0000, v169
    v_lshlrev_b32 v6, 16, v144
    v_and_b32 v7, 0xffff0000, v144
    v_add_f32 v168, v168, v6
    v_add_f32 v169, v169, v7
    v_cvt_pk_bf16_f32 v144, v168, v169
    v_lshlrev_b32 v160, 16, v140
    v_and_b32 v161, 0xffff0000, v140
    v_lshlrev_b32 v162, 16, v141
    v_and_b32 v163, 0xffff0000, v141
    v_lshlrev_b32 v164, 16, v142
    v_and_b32 v165, 0xffff0000, v142
    v_lshlrev_b32 v166, 16, v143
    v_and_b32 v167, 0xffff0000, v143
    v_lshlrev_b32 v168, 16, v144
    v_and_b32 v169, 0xffff0000, v144
    v_add_f32 v6, v160, v161
    v_add_f32 v6, v6, v162
    v_add_f32 v6, v6, v163
    v_add_f32 v6, v6, v164
    v_add_f32 v6, v6, v165
    v_add_f32 v6, v6, v166
    v_add_f32 v6, v6, v167
    v_add_f32 v6, v6, v168
    v_add_f32 v6, v6, v169
    s_nop 1
    v_add_f32 v6, v6, v6 row_ror:8 row_mask:0xf bank_mask:0xf
    s_nop 1
    v_add_f32 v6, v6, v6 row_ror:4 row_mask:0xf bank_mask:0xf
    s_nop 1
    v_add_f32 v6, v6, v6 row_ror:2 row_mask:0xf bank_mask:0xf
    s_nop 1
    v_add_f32 v6, v6, v6 row_ror:1 row_mask:0xf bank_mask:0xf
    v_mov_b32 v7, v6
    s_nop 1
    v_permlane16_swap_b32 v6, v7
    v_add_f32 v6, v6, v7
    v_mov_b32 v7, v6
    s_nop 1
    v_permlane32_swap_b32 v6, v7
    v_add_f32 v6, v6, v7
    v_mul_f32 v6, 0x3acccccd, v6
    v_sub_f32 v7, v160, v6
    v_mul_f32 v8, v7, v7
    v_sub_f32 v7, v161, v6
    v_fmac_f32 v8, v7, v7
    v_sub_f32 v7, v162, v6
    v_fmac_f32 v8, v7, v7
    v_sub_f32 v7, v163, v6
    v_fmac_f32 v8, v7, v7
    v_sub_f32 v7, v164, v6
    v_fmac_f32 v8, v7, v7
    v_sub_f32 v7, v165, v6
    v_fmac_f32 v8, v7, v7
    v_sub_f32 v7, v166, v6
    v_fmac_f32 v8, v7, v7
    v_sub_f32 v7, v167, v6
    v_fmac_f32 v8, v7, v7
    v_sub_f32 v7, v168, v6
    v_fmac_f32 v8, v7, v7
    v_sub_f32 v7, v169, v6
    v_fmac_f32 v8, v7, v7
    s_nop 1
    v_add_f32 v8, v8, v8 row_ror:8 row_mask:0xf bank_mask:0xf
    s_nop 1
    v_add_f32 v8, v8, v8 row_ror:4 row_mask:0xf bank_mask:0xf
    s_nop 1
    v_add_f32 v8, v8, v8 row_ror:2 row_mask:0xf bank_mask:0xf
    s_nop 1
    v_add_f32 v8, v8, v8 row_ror:1 row_mask:0xf bank_mask:0xf
    v_mov_b32 v7, v8
    s_nop 1
    v_permlane16_swap_b32 v8, v7
    v_add_f32 v8, v8, v7
    v_mov_b32 v7, v8
    s_nop 1
    v_permlane32_swap_b32 v8, v7
    v_add_f32 v8, v8, v7
    v_mul_f32 v8, 0x3acccccd, v8
    v_cvt_pk_bf16_f32 v8, v8, v8
    v_and_b32 v8, 0xffff0000, v8
    v_add_f32 v8, 0x3727c5ac, v8
    v_cvt_pk_bf16_f32 v8, v8, v8
    v_and_b32 v8, 0xffff0000, v8
    v_sqrt_f32 v8, v8
    s_nop 0
    v_cvt_pk_bf16_f32 v8, v8, v8
    v_and_b32 v8, 0xffff0000, v8
    v_rcp_f32 v8, v8
    v_cvt_pk_bf16_f32 v6, v6, v6
    v_and_b32 v6, 0xffff0000, v6
    v_sub_f32 v160, v160, v6
    v_sub_f32 v161, v161, v6
    v_cvt_pk_bf16_f32 v161, v160, v161
    v_lshlrev_b32 v160, 16, v161
    v_and_b32 v161, 0xffff0000, v161
    v_mul_f32 v160, v160, v8
    v_mul_f32 v161, v161, v8
    v_cvt_pk_bf16_f32 v161, v160, v161
    v_lshlrev_b32 v160, 16, v161
    v_and_b32 v161, 0xffff0000, v161
    v_sub_f32 v162, v162, v6
    v_sub_f32 v163, v163, v6
    v_cvt_pk_bf16_f32 v163, v162, v163
    v_lshlrev_b32 v162, 16, v163
    v_and_b32 v163, 0xffff0000, v163
    v_mul_f32 v162, v162, v8
    v_mul_f32 v163, v163, v8
    v_cvt_pk_bf16_f32 v163, v162, v163
    v_lshlrev_b32 v162, 16, v163
    v_and_b32 v163, 0xffff0000, v163
    v_sub_f32 v164, v164, v6
    v_sub_f32 v165, v165, v6
    v_cvt_pk_bf16_f32 v165, v164, v165
    v_lshlrev_b32 v164, 16, v165
    v_and_b32 v165, 0xffff0000, v165
    v_mul_f32 v164, v164, v8
    v_mul_f32 v165, v165, v8
    v_cvt_pk_bf16_f32 v165, v164, v165
    v_lshlrev_b32 v164, 16, v165
    v_and_b32 v165, 0xffff0000, v165
    v_sub_f32 v166, v166, v6
    v_sub_f32 v167, v167, v6
    v_cvt_pk_bf16_f32 v167, v166, v167
    v_lshlrev_b32 v166, 16, v167
    v_and_b32 v167, 0xffff0000, v167
    v_mul_f32 v166, v166, v8
    v_mul_f32 v167, v167, v8
    v_cvt_pk_bf16_f32 v167, v166, v167
    v_lshlrev_b32 v166, 16, v167
    v_and_b32 v167, 0xffff0000, v167
    v_sub_f32 v168, v168, v6
    v_sub_f32 v169, v169, v6
    v_cvt_pk_bf16_f32 v169, v168, v169
    v_lshlrev_b32 v168, 16, v169
    v_and_b32 v169, 0xffff0000, v169
    v_mul_f32 v168, v168, v8
    v_mul_f32 v169, v169, v8
    v_cvt_pk_bf16_f32 v169, v168, v169
    v_lshlrev_b32 v168, 16, v169
    v_and_b32 v169, 0xffff0000, v169
    v_mov_b32 v9, 0
    v_mul_f32 v160, v160, v110
    v_mul_f32 v161, v161, v111
    v_cvt_pk_bf16_f32 v161, v160, v161
    v_lshlrev_b32 v160, 16, v161
    v_and_b32 v161, 0xffff0000, v161
    v_add_f32 v160, v160, v100
    v_add_f32 v161, v161, v101
    v_cvt_pk_bf16_f32 v170, v160, v161
    buffer_store_dword v170, v3, s[8:11], s25 offen offset:0 sc1
    v_lshlrev_b32 v160, 16, v170
    v_and_b32 v161, 0xffff0000, v170
    v_fmac_f32 v9, v160, v130
    v_fmac_f32 v9, v161, v131
    v_mul_f32 v160, v160, v120
    v_mul_f32 v161, v161, v121
    v_cvt_pk_bf16_f32 v161, v160, v161
    v_lshlrev_b32 v160, 16, v161
    v_and_b32 v161, 0xffff0000, v161
    v_lshlrev_b32 v6, 16, v140
    v_and_b32 v7, 0xffff0000, v140
    v_add_f32 v160, v160, v6
    v_add_f32 v161, v161, v7
    v_cvt_pk_bf16_f32 v175, v160, v161
    buffer_store_dword v175, v3, s[16:19], s24 offen offset:0 sc1
    v_mul_f32 v162, v162, v112
    v_mul_f32 v163, v163, v113
    v_cvt_pk_bf16_f32 v163, v162, v163
    v_lshlrev_b32 v162, 16, v163
    v_and_b32 v163, 0xffff0000, v163
    v_add_f32 v162, v162, v102
    v_add_f32 v163, v163, v103
    v_cvt_pk_bf16_f32 v171, v162, v163
    buffer_store_dword v171, v3, s[8:11], s25 offen offset:256 sc1
    v_lshlrev_b32 v162, 16, v171
    v_and_b32 v163, 0xffff0000, v171
    v_fmac_f32 v9, v162, v132
    v_fmac_f32 v9, v163, v133
    v_mul_f32 v162, v162, v122
    v_mul_f32 v163, v163, v123
    v_cvt_pk_bf16_f32 v163, v162, v163
    v_lshlrev_b32 v162, 16, v163
    v_and_b32 v163, 0xffff0000, v163
    v_lshlrev_b32 v6, 16, v141
    v_and_b32 v7, 0xffff0000, v141
    v_add_f32 v162, v162, v6
    v_add_f32 v163, v163, v7
    v_cvt_pk_bf16_f32 v176, v162, v163
    buffer_store_dword v176, v3, s[16:19], s24 offen offset:256 sc1
    v_mul_f32 v164, v164, v114
    v_mul_f32 v165, v165, v115
    v_cvt_pk_bf16_f32 v165, v164, v165
    v_lshlrev_b32 v164, 16, v165
    v_and_b32 v165, 0xffff0000, v165
    v_add_f32 v164, v164, v104
    v_add_f32 v165, v165, v105
    v_cvt_pk_bf16_f32 v172, v164, v165
    buffer_store_dword v172, v3, s[8:11], s25 offen offset:512 sc1
    v_lshlrev_b32 v164, 16, v172
    v_and_b32 v165, 0xffff0000, v172
    v_fmac_f32 v9, v164, v134
    v_fmac_f32 v9, v165, v135
    v_mul_f32 v164, v164, v124
    v_mul_f32 v165, v165, v125
    v_cvt_pk_bf16_f32 v165, v164, v165
    v_lshlrev_b32 v164, 16, v165
    v_and_b32 v165, 0xffff0000, v165
    v_lshlrev_b32 v6, 16, v142
    v_and_b32 v7, 0xffff0000, v142
    v_add_f32 v164, v164, v6
    v_add_f32 v165, v165, v7
    v_cvt_pk_bf16_f32 v177, v164, v165
    buffer_store_dword v177, v3, s[16:19], s24 offen offset:512 sc1
    v_mul_f32 v166, v166, v116
    v_mul_f32 v167, v167, v117
    v_cvt_pk_bf16_f32 v167, v166, v167
    v_lshlrev_b32 v166, 16, v167
    v_and_b32 v167, 0xffff0000, v167
    v_add_f32 v166, v166, v106
    v_add_f32 v167, v167, v107
    v_cvt_pk_bf16_f32 v173, v166, v167
    buffer_store_dword v173, v3, s[8:11], s25 offen offset:768 sc1
    v_lshlrev_b32 v166, 16, v173
    v_and_b32 v167, 0xffff0000, v173
    v_fmac_f32 v9, v166, v136
    v_fmac_f32 v9, v167, v137
    v_mul_f32 v166, v166, v126
    v_mul_f32 v167, v167, v127
    v_cvt_pk_bf16_f32 v167, v166, v167
    v_lshlrev_b32 v166, 16, v167
    v_and_b32 v167, 0xffff0000, v167
    v_lshlrev_b32 v6, 16, v143
    v_and_b32 v7, 0xffff0000, v143
    v_add_f32 v166, v166, v6
    v_add_f32 v167, v167, v7
    v_cvt_pk_bf16_f32 v178, v166, v167
    buffer_store_dword v178, v3, s[16:19], s24 offen offset:768 sc1
    v_mul_f32 v168, v168, v118
    v_mul_f32 v169, v169, v119
    v_cvt_pk_bf16_f32 v169, v168, v169
    v_lshlrev_b32 v168, 16, v169
    v_and_b32 v169, 0xffff0000, v169
    v_add_f32 v168, v168, v108
    v_add_f32 v169, v169, v109
    v_cvt_pk_bf16_f32 v174, v168, v169
    buffer_store_dword v174, v3, s[8:11], s25 offen offset:1024 sc1
    v_lshlrev_b32 v168, 16, v174
    v_and_b32 v169, 0xffff0000, v174
    v_fmac_f32 v9, v168, v138
    v_fmac_f32 v9, v169, v139
    v_mul_f32 v168, v168, v128
    v_mul_f32 v169, v169, v129
    v_cvt_pk_bf16_f32 v169, v168, v169
    v_lshlrev_b32 v168, 16, v169
    v_and_b32 v169, 0xffff0000, v169
    v_lshlrev_b32 v6, 16, v144
    v_and_b32 v7, 0xffff0000, v144
    v_add_f32 v168, v168, v6
    v_add_f32 v169, v169, v7
    v_cvt_pk_bf16_f32 v179, v168, v169
    buffer_store_dword v179, v3, s[16:19], s24 offen offset:1024 sc1
    v_add_f32 v9, v9, v9 row_ror:8 row_mask:0xf bank_mask:0xf
    s_nop 1
    v_add_f32 v9, v9, v9 row_ror:4 row_mask:0xf bank_mask:0xf
    s_nop 1
    v_add_f32 v9, v9, v9 row_ror:2 row_mask:0xf bank_mask:0xf
    s_nop 1
    v_add_f32 v9, v9, v9 row_ror:1 row_mask:0xf bank_mask:0xf
    v_mov_b32 v6, v9
    s_nop 1
    v_permlane16_swap_b32 v9, v6
    v_add_f32 v9, v9, v6
    v_mov_b32 v6, v9
    s_nop 1
    v_permlane32_swap_b32 v9, v6
    v_add_f32 v9, v9, v6
    v_cvt_pk_bf16_f32 v9, v9, v9
    v_and_b32 v9, 0xffff0000, v9
    s_setpc_b64 s[100:101]
XN_sub:
    ds_read2_b64 v[40:43], v12 offset0:0 offset1:4
    ds_read2_b64 v[44:47], v12 offset0:32 offset1:36
    ds_read2_b64 v[48:51], v12 offset0:64 offset1:68
    ds_read2_b64 v[52:55], v12 offset0:96 offset1:100
    ds_read2_b64 v[56:59], v12 offset0:128 offset1:132
    s_waitcnt lgkmcnt(4)
    v_lshlrev_b32 v60, 16, v40
    v_and_b32 v61, 0xffff0000, v40
    v_lshlrev_b32 v62, 16, v42
    v_and_b32 v63, 0xffff0000, v42
    v_lshlrev_b32 v64, 16, v41
    v_and_b32 v65, 0xffff0000, v41
    v_lshlrev_b32 v66, 16, v43
    v_and_b32 v67, 0xffff0000, v43
    s_waitcnt lgkmcnt(3)
    v_lshlrev_b32 v68, 16, v44
    v_and_b32 v69, 0xffff0000, v44
    v_lshlrev_b32 v70, 16, v46
    v_and_b32 v71, 0xffff0000, v46
    v_lshlrev_b32 v72, 16, v45
    v_and_b32 v73, 0xffff0000, v45
    v_lshlrev_b32 v74, 16, v47
    v_and_b32 v75, 0xffff0000, v47
    s_waitcnt lgkmcnt(2)
    v_lshlrev_b32 v76, 16, v48
    v_and_b32 v77, 0xffff0000, v48
    v_lshlrev_b32 v78, 16, v50
    v_and_b32 v79, 0xffff0000, v50
    v_lshlrev_b32 v80, 16, v49
    v_and_b32 v81, 0xffff0000, v49
    v_lshlrev_b32 v82, 16, v51
    v_and_b32 v83, 0xffff0000, v51
    s_waitcnt lgkmcnt(1)
    v_lshlrev_b32 v84, 16, v52
    v_and_b32 v85, 0xffff0000, v52
    v_lshlrev_b32 v86, 16, v54
    v_and_b32 v87, 0xffff0000, v54
    v_lshlrev_b32 v88, 16, v53
    v_and_b32 v89, 0xffff0000, v53
    v_lshlrev_b32 v90, 16, v55
    v_and_b32 v91, 0xffff0000, v55
    s_waitcnt lgkmcnt(0)
    v_lshlrev_b32 v92, 16, v56
    v_and_b32 v93, 0xffff0000, v56
    v_lshlrev_b32 v94, 16, v58
    v_and_b32 v95, 0xffff0000, v58
    v_lshlrev_b32 v96, 16, v57
    v_and_b32 v97, 0xffff0000, v57
    v_lshlrev_b32 v98, 16, v59
    v_and_b32 v99, 0xffff0000, v59
    v_pk_add_f32 v[16:17], v[60:61], v[68:69]
    v_pk_add_f32 v[18:19], v[62:63], v[70:71]
    v_pk_add_f32 v[20:21], v[64:65], v[72:73]
    v_pk_add_f32 v[22:23], v[66:67], v[74:75]
    v_pk_add_f32 v[16:17], v[16:17], v[76:77]
    v_pk_add_f32 v[18:19], v[18:19], v[78:79]
    v_pk_add_f32 v[20:21], v[20:21], v[80:81]
    v_pk_add_f32 v[22:23], v[22:23], v[82:83]
    v_pk_add_f32 v[16:17], v[16:17], v[84:85]
    v_pk_add_f32 v[18:19], v[18:19], v[86:87]
    v_pk_add_f32 v[20:21], v[20:21], v[88:89]
    v_pk_add_f32 v[22:23], v[22:23], v[90:91]
    v_pk_add_f32 v[16:17], v[16:17], v[92:93]
    v_pk_add_f32 v[18:19], v[18:19], v[94:95]
    v_pk_add_f32 v[20:21], v[20:21], v[96:97]
    v_pk_add_f32 v[22:23], v[22:23], v[98:99]
    v_pk_add_f32 v[16:17], v[16:17], v[18:19]
    v_pk_add_f32 v[20:21], v[20:21], v[22:23]
    v_pk_add_f32 v[16:17], v[16:17], v[20:21]
    v_add_f32 v16, v16, v17
    s_nop 1
    v_add_f32 v16, v16, v16 row_ror:4 row_mask:0xf bank_mask:0xf
    s_nop 1
    v_add_f32 v16, v16, v16 row_ror:8 row_mask:0xf bank_mask:0xf
    v_mov_b32 v17, v16
    s_nop 1
    v_permlane16_swap_b32 v16, v17
    v_add_f32 v16, v16, v17
    v_mov_b32 v17, v16
    s_nop 1
    v_permlane32_swap_b32 v16, v17
    v_add_f32 v16, v16, v17
    v_mul_f32 v6, 0xbacccccd, v16
    v_mov_b32 v7, v6
    v_pk_add_f32 v[40:41], v[60:61], v[6:7]
    v_pk_add_f32 v[42:43], v[62:63], v[6:7]
    v_pk_add_f32 v[44:45], v[64:65], v[6:7]
    v_pk_add_f32 v[46:47], v[66:67], v[6:7]
    v_pk_mul_f32 v[16:17], v[40:41], v[40:41]
    v_pk_mul_f32 v[18:19], v[42:43], v[42:43]
    v_pk_mul_f32 v[20:21], v[44:45], v[44:45]
    v_pk_mul_f32 v[22:23], v[46:47], v[46:47]
    v_pk_add_f32 v[48:49], v[68:69], v[6:7]
    v_pk_add_f32 v[50:51], v[70:71], v[6:7]
    v_pk_add_f32 v[52:53], v[72:73], v[6:7]
    v_pk_add_f32 v[54:55], v[74:75], v[6:7]
    v_pk_fma_f32 v[16:17], v[48:49], v[48:49], v[16:17]
    v_pk_fma_f32 v[18:19], v[50:51], v[50:51], v[18:19]
    v_pk_fma_f32 v[20:21], v[52:53], v[52:53], v[20:21]
    v_pk_fma_f32 v[22:23], v[54:55], v[54:55], v[22:23]
    v_pk_add_f32 v[40:41], v[76:77], v[6:7]
    v_pk_add_f32 v[42:43], v[78:79], v[6:7]
    v_pk_add_f32 v[44:45], v[80:81], v[6:7]
    v_pk_add_f32 v[46:47], v[82:83], v[6:7]
    v_pk_fma_f32 v[16:17], v[40:41], v[40:41], v[16:17]
    v_pk_fma_f32 v[18:19], v[42:43], v[42:43], v[18:19]
    v_pk_fma_f32 v[20:21], v[44:45], v[44:45], v[20:21]
    v_pk_fma_f32 v[22:23], v[46:47], v[46:47], v[22:23]
    v_pk_add_f32 v[48:49], v[84:85], v[6:7]
    v_pk_add_f32 v[50:51], v[86:87], v[6:7]
    v_pk_add_f32 v[52:53], v[88:89], v[6:7]
    v_pk_add_f32 v[54:55], v[90:91], v[6:7]
    v_pk_fma_f32 v[16:17], v[48:49], v[48:49], v[16:17]
    v_pk_fma_f32 v[18:19], v[50:51], v[50:51], v[18:19]
    v_pk_fma_f32 v[20:21], v[52:53], v[52:53], v[20:21]
    v_pk_fma_f32 v[22:23], v[54:55], v[54:55], v[22:23]
    v_pk_add_f32 v[40:41], v[92:93], v[6:7]
    v_pk_add_f32 v[42:43], v[94:95], v[6:7]
    v_pk_add_f32 v[44:45], v[96:97], v[6:7]
    v_pk_add_f32 v[46:47], v[98:99], v[6:7]
    v_pk_fma_f32 v[16:17], v[40:41], v[40:41], v[16:17]
    v_pk_fma_f32 v[18:19], v[42:43], v[42:43], v[18:19]
    v_pk_fma_f32 v[20:21], v[44:45], v[44:45], v[20:21]
    v_pk_fma_f32 v[22:23], v[46:47], v[46:47], v[22:23]
    v_cvt_pk_bf16_f32 v6, v6, v6
    v_and_b32 v6, 0xffff0000, v6
    v_mov_b32 v7, v6
    v_pk_add_f32 v[16:17], v[16:17], v[18:19]
    v_pk_add_f32 v[20:21], v[20:21], v[22:23]
    v_pk_add_f32 v[16:17], v[16:17], v[20:21]
    v_add_f32 v16, v16, v17
    s_nop 1
    v_add_f32 v16, v16, v16 row_ror:4 row_mask:0xf bank_mask:0xf
    s_nop 1
    v_add_f32 v16, v16, v16 row_ror:8 row_mask:0xf bank_mask:0xf
    v_mov_b32 v17, v16
    s_nop 1
    v_permlane16_swap_b32 v16, v17
    v_add_f32 v16, v16, v17
    v_mov_b32 v17, v16
    s_nop 1
    v_permlane32_swap_b32 v16, v17
    v_add_f32 v16, v16, v17
    v_mul_f32 v8, 0x3acccccd, v16
    v_pk_add_f32 v[60:61], v[60:61], v[6:7]
    v_pk_add_f32 v[62:63], v[62:63], v[6:7]
    v_cvt_pk_bf16_f32 v8, v8, v8
    v_pk_add_f32 v[64:65], v[64:65], v[6:7]
    v_pk_add_f32 v[66:67], v[66:67], v[6:7]
    v_and_b32 v8, 0xffff0000, v8
    v_pk_add_f32 v[68:69], v[68:69], v[6:7]
    v_pk_add_f32 v[70:71], v[70:71], v[6:7]
    v_add_f32 v8, 0x3727c5ac, v8
    v_pk_add_f32 v[72:73], v[72:73], v[6:7]
    v_pk_add_f32 v[74:75], v[74:75], v[6:7]
    v_cvt_pk_bf16_f32 v8, v8, v8
    v_pk_add_f32 v[76:77], v[76:77], v[6:7]
    v_pk_add_f32 v[78:79], v[78:79], v[6:7]
    v_and_b32 v8, 0xffff0000, v8
    v_pk_add_f32 v[80:81], v[80:81], v[6:7]
    v_pk_add_f32 v[82:83], v[82:83], v[6:7]
    v_sqrt_f32 v8, v8
    v_pk_add_f32 v[84:85], v[84:85], v[6:7]
    v_pk_add_f32 v[86:87], v[86:87], v[6:7]
    v_cvt_pk_bf16_f32 v8, v8, v8
    v_pk_add_f32 v[88:89], v[88:89], v[6:7]
    v_pk_add_f32 v[90:91], v[90:91], v[6:7]
    v_and_b32 v8, 0xffff0000, v8
    v_pk_add_f32 v[92:93], v[92:93], v[6:7]
    v_pk_add_f32 v[94:95], v[94:95], v[6:7]
    v_rcp_f32 v8, v8
    v_pk_add_f32 v[96:97], v[96:97], v[6:7]
    v_pk_add_f32 v[98:99], v[98:99], v[6:7]
    v_mov_b32 v9, v8
    v_cvt_pk_bf16_f32 v40, v60, v61
    v_cvt_pk_bf16_f32 v41, v62, v63
    v_cvt_pk_bf16_f32 v42, v64, v65
    v_cvt_pk_bf16_f32 v43, v66, v67
    v_cvt_pk_bf16_f32 v44, v68, v69
    v_cvt_pk_bf16_f32 v45, v70, v71
    v_cvt_pk_bf16_f32 v46, v72, v73
    v_cvt_pk_bf16_f32 v47, v74, v75
    v_cvt_pk_bf16_f32 v48, v76, v77
    v_cvt_pk_bf16_f32 v49, v78, v79
    v_cvt_pk_bf16_f32 v50, v80, v81
    v_cvt_pk_bf16_f32 v51, v82, v83
    v_cvt_pk_bf16_f32 v52, v84, v85
    v_cvt_pk_bf16_f32 v53, v86, v87
    v_cvt_pk_bf16_f32 v54, v88, v89
    v_cvt_pk_bf16_f32 v55, v90, v91
    v_cvt_pk_bf16_f32 v56, v92, v93
    v_cvt_pk_bf16_f32 v57, v94, v95
    v_cvt_pk_bf16_f32 v58, v96, v97
    v_cvt_pk_bf16_f32 v59, v98, v99
    v_lshlrev_b32 v60, 16, v40
    v_and_b32 v61, 0xffff0000, v40
    v_lshlrev_b32 v62, 16, v41
    v_and_b32 v63, 0xffff0000, v41
    v_lshlrev_b32 v64, 16, v42
    v_and_b32 v65, 0xffff0000, v42
    v_lshlrev_b32 v66, 16, v43
    v_and_b32 v67, 0xffff0000, v43
    v_lshlrev_b32 v68, 16, v44
    v_and_b32 v69, 0xffff0000, v44
    v_lshlrev_b32 v70, 16, v45
    v_and_b32 v71, 0xffff0000, v45
    v_lshlrev_b32 v72, 16, v46
    v_and_b32 v73, 0xffff0000, v46
    v_lshlrev_b32 v74, 16, v47
    v_and_b32 v75, 0xffff0000, v47
    v_lshlrev_b32 v76, 16, v48
    v_and_b32 v77, 0xffff0000, v48
    v_lshlrev_b32 v78, 16, v49
    v_and_b32 v79, 0xffff0000, v49
    v_lshlrev_b32 v80, 16, v50
    v_and_b32 v81, 0xffff0000, v50
    v_lshlrev_b32 v82, 16, v51
    v_and_b32 v83, 0xffff0000, v51
    v_lshlrev_b32 v84, 16, v52
    v_and_b32 v85, 0xffff0000, v52
    v_lshlrev_b32 v86, 16, v53
    v_and_b32 v87, 0xffff0000, v53
    v_lshlrev_b32 v88, 16, v54
    v_and_b32 v89, 0xffff0000, v54
    v_lshlrev_b32 v90, 16, v55
    v_and_b32 v91, 0xffff0000, v55
    v_lshlrev_b32 v92, 16, v56
    v_and_b32 v93, 0xffff0000, v56
    v_lshlrev_b32 v94, 16, v57
    v_and_b32 v95, 0xffff0000, v57
    v_lshlrev_b32 v96, 16, v58
    v_and_b32 v97, 0xffff0000, v58
    v_lshlrev_b32 v98, 16, v59
    v_and_b32 v99, 0xffff0000, v59
    v_pk_mul_f32 v[60:61], v[60:61], v[8:9]
    v_pk_mul_f32 v[62:63], v[62:63], v[8:9]
    v_pk_mul_f32 v[64:65], v[64:65], v[8:9]
    v_pk_mul_f32 v[66:67], v[66:67], v[8:9]
    v_pk_mul_f32 v[68:69], v[68:69], v[8:9]
    v_pk_mul_f32 v[70:71], v[70:71], v[8:9]
    v_pk_mul_f32 v[72:73], v[72:73], v[8:9]
    v_pk_mul_f32 v[74:75], v[74:75], v[8:9]
    v_pk_mul_f32 v[76:77], v[76:77], v[8:9]
    v_pk_mul_f32 v[78:79], v[78:79], v[8:9]
    v_pk_mul_f32 v[80:81], v[80:81], v[8:9]
    v_pk_mul_f32 v[82:83], v[82:83], v[8:9]
    v_pk_mul_f32 v[84:85], v[84:85], v[8:9]
    v_pk_mul_f32 v[86:87], v[86:87], v[8:9]
    v_pk_mul_f32 v[88:89], v[88:89], v[8:9]
    v_pk_mul_f32 v[90:91], v[90:91], v[8:9]
    v_pk_mul_f32 v[92:93], v[92:93], v[8:9]
    v_pk_mul_f32 v[94:95], v[94:95], v[8:9]
    v_pk_mul_f32 v[96:97], v[96:97], v[8:9]
    v_pk_mul_f32 v[98:99], v[98:99], v[8:9]
    s_setpc_b64 s[100:101]
XS_sub:
    v_pk_mul_f32 v[60:61], v[60:61], v[100:101]
    v_pk_mul_f32 v[62:63], v[62:63], v[102:103]
    v_pk_mul_f32 v[64:65], v[64:65], v[104:105]
    v_pk_mul_f32 v[66:67], v[66:67], v[106:107]
    v_pk_mul_f32 v[68:69], v[68:69], v[108:109]
    v_pk_mul_f32 v[70:71], v[70:71], v[110:111]
    v_pk_mul_f32 v[72:73], v[72:73], v[112:113]
    v_pk_mul_f32 v[74:75], v[74:75], v[114:115]
    v_pk_mul_f32 v[76:77], v[76:77], v[116:117]
    v_pk_mul_f32 v[78:79], v[78:79], v[118:119]
    v_pk_mul_f32 v[80:81], v[80:81], v[120:121]
    v_pk_mul_f32 v[82:83], v[82:83], v[122:123]
    v_pk_mul_f32 v[84:85], v[84:85], v[124:125]
    v_pk_mul_f32 v[86:87], v[86:87], v[126:127]
    v_pk_mul_f32 v[88:89], v[88:89], v[128:129]
    v_pk_mul_f32 v[90:91], v[90:91], v[130:131]
    v_pk_mul_f32 v[92:93], v[92:93], v[132:133]
    v_pk_mul_f32 v[94:95], v[94:95], v[134:135]
    v_pk_mul_f32 v[96:97], v[96:97], v[136:137]
    v_pk_mul_f32 v[98:99], v[98:99], v[138:139]
    v_cvt_pk_bf16_f32 v40, v60, v61
    v_cvt_pk_bf16_f32 v41, v62, v63
    v_cvt_pk_bf16_f32 v42, v64, v65
    v_cvt_pk_bf16_f32 v43, v66, v67
    v_cvt_pk_bf16_f32 v44, v68, v69
    v_cvt_pk_bf16_f32 v45, v70, v71
    v_cvt_pk_bf16_f32 v46, v72, v73
    v_cvt_pk_bf16_f32 v47, v74, v75
    v_cvt_pk_bf16_f32 v48, v76, v77
    v_cvt_pk_bf16_f32 v49, v78, v79
    v_cvt_pk_bf16_f32 v50, v80, v81
    v_cvt_pk_bf16_f32 v51, v82, v83
    v_cvt_pk_bf16_f32 v52, v84, v85
    v_cvt_pk_bf16_f32 v53, v86, v87
    v_cvt_pk_bf16_f32 v54, v88, v89
    v_cvt_pk_bf16_f32 v55, v90, v91
    v_cvt_pk_bf16_f32 v56, v92, v93
    v_cvt_pk_bf16_f32 v57, v94, v95
    v_cvt_pk_bf16_f32 v58, v96, v97
    v_cvt_pk_bf16_f32 v59, v98, v99
    v_lshlrev_b32 v60, 16, v40
    v_and_b32 v61, 0xffff0000, v40
    v_lshlrev_b32 v62, 16, v41
    v_and_b32 v63, 0xffff0000, v41
    v_lshlrev_b32 v64, 16, v42
    v_and_b32 v65, 0xffff0000, v42
    v_lshlrev_b32 v66, 16, v43
    v_and_b32 v67, 0xffff0000, v43
    v_lshlrev_b32 v68, 16, v44
    v_and_b32 v69, 0xffff0000, v44
    v_lshlrev_b32 v70, 16, v45
    v_and_b32 v71, 0xffff0000, v45
    v_lshlrev_b32 v72, 16, v46
    v_and_b32 v73, 0xffff0000, v46
    v_lshlrev_b32 v74, 16, v47
    v_and_b32 v75, 0xffff0000, v47
    v_lshlrev_b32 v76, 16, v48
    v_and_b32 v77, 0xffff0000, v48
    v_lshlrev_b32 v78, 16, v49
    v_and_b32 v79, 0xffff0000, v49
    v_lshlrev_b32 v80, 16, v50
    v_and_b32 v81, 0xffff0000, v50
    v_lshlrev_b32 v82, 16, v51
    v_and_b32 v83, 0xffff0000, v51
    v_lshlrev_b32 v84, 16, v52
    v_and_b32 v85, 0xffff0000, v52
    v_lshlrev_b32 v86, 16, v53
    v_and_b32 v87, 0xffff0000, v53
    v_lshlrev_b32 v88, 16, v54
    v_and_b32 v89, 0xffff0000, v54
    v_lshlrev_b32 v90, 16, v55
    v_and_b32 v91, 0xffff0000, v55
    v_lshlrev_b32 v92, 16, v56
    v_and_b32 v93, 0xffff0000, v56
    v_lshlrev_b32 v94, 16, v57
    v_and_b32 v95, 0xffff0000, v57
    v_lshlrev_b32 v96, 16, v58
    v_and_b32 v97, 0xffff0000, v58
    v_lshlrev_b32 v98, 16, v59
    v_and_b32 v99, 0xffff0000, v59
    v_pk_add_f32 v[60:61], v[60:61], v[140:141]
    v_pk_add_f32 v[62:63], v[62:63], v[142:143]
    v_pk_add_f32 v[64:65], v[64:65], v[144:145]
    v_pk_add_f32 v[66:67], v[66:67], v[146:147]
    v_pk_add_f32 v[68:69], v[68:69], v[148:149]
    v_pk_add_f32 v[70:71], v[70:71], v[150:151]
    v_pk_add_f32 v[72:73], v[72:73], v[152:153]
    v_pk_add_f32 v[74:75], v[74:75], v[154:155]
    v_pk_add_f32 v[76:77], v[76:77], v[156:157]
    v_pk_add_f32 v[78:79], v[78:79], v[158:159]
    v_pk_add_f32 v[80:81], v[80:81], v[160:161]
    v_pk_add_f32 v[82:83], v[82:83], v[162:163]
    v_pk_add_f32 v[84:85], v[84:85], v[164:165]
    v_pk_add_f32 v[86:87], v[86:87], v[166:167]
    v_pk_add_f32 v[88:89], v[88:89], v[168:169]
    v_pk_add_f32 v[90:91], v[90:91], v[170:171]
    v_pk_add_f32 v[92:93], v[92:93], v[172:173]
    v_pk_add_f32 v[94:95], v[94:95], v[174:175]
    v_pk_add_f32 v[96:97], v[96:97], v[176:177]
    v_pk_add_f32 v[98:99], v[98:99], v[178:179]
    v_cvt_pk_bf16_f32 v40, v60, v61
    v_cvt_pk_bf16_f32 v41, v62, v63
    v_cvt_pk_bf16_f32 v42, v64, v65
    v_cvt_pk_bf16_f32 v43, v66, v67
    v_cvt_pk_bf16_f32 v44, v68, v69
    v_cvt_pk_bf16_f32 v45, v70, v71
    v_cvt_pk_bf16_f32 v46, v72, v73
    v_cvt_pk_bf16_f32 v47, v74, v75
    v_cvt_pk_bf16_f32 v48, v76, v77
    v_cvt_pk_bf16_f32 v49, v78, v79
    v_cvt_pk_bf16_f32 v50, v80, v81
    v_cvt_pk_bf16_f32 v51, v82, v83
    v_cvt_pk_bf16_f32 v52, v84, v85
    v_cvt_pk_bf16_f32 v53, v86, v87
    v_cvt_pk_bf16_f32 v54, v88, v89
    v_cvt_pk_bf16_f32 v55, v90, v91
    v_cvt_pk_bf16_f32 v56, v92, v93
    v_cvt_pk_bf16_f32 v57, v94, v95
    v_cvt_pk_bf16_f32 v58, v96, v97
    v_cvt_pk_bf16_f32 v59, v98, v99
    s_mov_b64 exec, s[24:25]
    ds_write_b128 v12, v[40:43] offset:0
    ds_write_b128 v12, v[44:47] offset:4096
    ds_write_b128 v12, v[48:51] offset:8192
    ds_write_b128 v12, v[52:55] offset:12288
    ds_write_b128 v12, v[56:59] offset:16384
    s_waitcnt lgkmcnt(0)
    s_barrier
    s_cbranch_execz XS_r
    ds_read_b128 v[40:43], v11 offset:0
    ds_read_b128 v[44:47], v11 offset:1024
    ds_read_b128 v[48:51], v11 offset:2048
    ds_read_b128 v[52:55], v11 offset:3072
    ds_read_b128 v[56:59], v11 offset:4096
    s_add_u32 s4, s27, 4096
    s_waitcnt lgkmcnt(4)
    buffer_store_dwordx4 v[40:43], v2, s[8:11], s27 offen offset:0 sc1
    s_waitcnt lgkmcnt(3)
    buffer_store_dwordx4 v[44:47], v2, s[8:11], s27 offen offset:1024 sc1
    s_waitcnt lgkmcnt(2)
    buffer_store_dwordx4 v[48:51], v2, s[8:11], s27 offen offset:2048 sc1
    s_waitcnt lgkmcnt(1)
    buffer_store_dwordx4 v[52:55], v2, s[8:11], s27 offen offset:3072 sc1
    s_waitcnt lgkmcnt(0)
    buffer_store_dwordx4 v[56:59], v2, s[8:11], s4 offen offset:0 sc1
XS_r:
    s_mov_b64 exec, -1
    s_setpc_b64 s[100:101]
R_ovf:
    s_waitcnt vmcnt(0) lgkmcnt(0)
    s_barrier
    s_load_dwordx2 s[12:13], s[0:1], 120
    s_mov_b32 s14, 256
    s_mov_b32 s15, 0x20000
    s_waitcnt lgkmcnt(0)
    v_mov_b32 v4, 0
    s_cmp_lg_u32 s3, 0
    s_cbranch_scc1 RO_b
    s_getreg_b32 s22, hwreg(HW_REG_XCC_ID)
    s_and_b32 s22, s22, 7
    s_lshl_b32 s21, s22, 5
    v_mov_b32 v5, 1
    s_mov_b64 exec, 1
    buffer_atomic_add v5, v4, s[12:15], s21 offen offset:12 sc0 sc1
    s_mov_b64 exec, -1
    v_and_b32 v6, 7, v1
    v_lshlrev_b32 v6, 5, v6
    s_waitcnt vmcnt(0)
    v_readfirstlane_b32 s20, v5
    s_mov_b32 s31, 0
RO_l:
    buffer_load_dwordx4 v[8:11], v6, s[12:15], 0 offen sc1
    s_waitcnt vmcnt(0)
    v_bcnt_u32_b32 v7, v8, v11
    v_cmp_lt_u32 s[4:5], 32, v7
    s_and_b32 s23, s4, 0xff
    v_cmp_ne_u32 s[4:5], 32, v7
    s_cmp_eq_u32 s23, 0
    s_cselect_b32 s5, 0xff, 0
    s_and_b32 s4, s4, s5
    s_mov_b32 s5, 0
    s_mov_b32 s24, s20
    v_readlane_b32 s4, v7, 0
    s_add_u32 s5, s5, s4
    v_readlane_b32 s4, v11, 0
    s_cmp_gt_u32 s22, 0
    s_cselect_b32 s4, s4, 0
    s_add_u32 s24, s24, s4
    v_readlane_b32 s4, v7, 1
    s_add_u32 s5, s5, s4
    v_readlane_b32 s4, v11, 1
    s_cmp_gt_u32 s22, 1
    s_cselect_b32 s4, s4, 0
    s_add_u32 s24, s24, s4
    v_readlane_b32 s4, v7, 2
    s_add_u32 s5, s5, s4
    v_readlane_b32 s4, v11, 2
    s_cmp_gt_u32 s22, 2
    s_cselect_b32 s4, s4, 0
    s_add_u32 s24, s24, s4
    v_readlane_b32 s4, v7, 3
    s_add_u32 s5, s5, s4
    v_readlane_b32 s4, v11, 3
    s_cmp_gt_u32 s22, 3
    s_cselect_b32 s4, s4, 0
    s_add_u32 s24, s24, s4
    v_readlane_b32 s4, v7, 4
    s_add_u32 s5, s5, s4
    v_readlane_b32 s4, v11, 4
    s_cmp_gt_u32 s22, 4
    s_cselect_b32 s4, s4, 0
    s_add_u32 s24, s24, s4
    v_readlane_b32 s4, v7, 5
    s_add_u32 s5, s5, s4
    v_readlane_b32 s4, v11, 5
    s_cmp_gt_u32 s22, 5
    s_cselect_b32 s4, s4, 0
    s_add_u32 s24, s24, s4
    v_readlane_b32 s4, v7, 6
    s_add_u32 s5, s5, s4
    v_readlane_b32 s4, v11, 6
    s_cmp_gt_u32 s22, 6
    s_cselect_b32 s4, s4, 0
    s_add_u32 s24, s24, s4
    v_readlane_b32 s4, v7, 7
    s_add_u32 s5, s5, s4
    v_readlane_b32 s4, v11, 7
    s_cmp_gt_u32 s22, 7
    s_cselect_b32 s4, s4, 0
    s_add_u32 s24, s24, s4
    s_cmp_ge_u32 s5, 256
    s_cbranch_scc1 RO_o
    s_sleep 4
    s_add_u32 s31, s31, 1
    s_cmp_lt_u32 s31, 0x80000
    s_cbranch_scc1 RO_l
    s_mov_b32 s21, 256
    s_branch RO_w
RO_o:
    v_mov_b32 v7, v8
    s_cmp_eq_u32 s23, 0
    s_cselect_b32 s21, s21, 0
    s_cselect_b32 s20, s20, s24
RO_x:
    s_lshr_b32 s6, s21, 5
    s_nop 4
    v_readlane_b32 s4, v7, s6
    s_bcnt0_i32_b32 s5, s4
    s_cmp_lt_u32 s20, s5
    s_cbranch_scc1 RO_f
    s_sub_u32 s20, s20, s5
    s_add_u32 s21, s21, 32
    s_cmp_lt_u32 s21, 256
    s_cbranch_scc1 RO_x
    s_branch RO_w
RO_f:
    s_ff0_i32_b32 s5, s4
    s_bitset1_b32 s4, s5
    s_sub_u32 s20, s20, 1
    s_cbranch_scc0 RO_f
    s_add_u32 s21, s21, s5
RO_w:
    v_mov_b32 v5, s21
    ds_write_b32 v4, v5
    s_waitcnt lgkmcnt(0)
RO_b:
    s_barrier
    ds_read_b32 v5, v4
    s_waitcnt lgkmcnt(0)
    v_readfirstlane_b32 s20, v5
    s_barrier
    s_cmp_ge_u32 s20, 256
    s_cbranch_scc1 R_exit
    s_lshr_b32 s4, s20, 5
    s_and_b32 s20, s20, 31
    s_mov_b32 s33, 0
    s_branch R_disp
R_c8:
    v_mov_b32 v133, 163776
    s_cmp_lg_u32 s3, 0
    s_cbranch_scc1 R_c8b
    s_mov_b32 s31, 0
    s_sleep 8
R_c8l:
    v_mov_b32 v135, 0
    s_mov_b64 exec, 1
    buffer_atomic_or v135, v134, s[12:15], s5 offen sc0 sc1
    s_mov_b64 exec, -1
    s_waitcnt vmcnt(0)
    v_readfirstlane_b32 s6, v135
    s_lshr_b32 s6, s6, s7
    s_and_b32 s6, s6, 0xff
    s_bcnt1_i32_b32 s21, s6
    s_add_u32 s31, s31, 1
    s_cmp_ge_u32 s31, 40
    s_cselect_b32 s21, 8, s21
    s_cmp_lt_u32 s21, 7
    s_cbranch_scc1 R_c8l
    s_ff0_i32_b32 s6, s6
    s_add_u32 s6, s6, s7
    s_cmp_eq_u32 s21, 7
    s_cselect_b32 s20, s6, s20
    v_mov_b32 v135, s20
    ds_write_b32 v133, v135
    s_waitcnt lgkmcnt(0)
R_c8b:
    s_barrier
    ds_read_b32 v135, v133
    s_waitcnt lgkmcnt(0)
    v_readfirstlane_b32 s20, v135
    s_barrier
    s_branch R_clm
R_done:
    s_waitcnt vmcnt(0)
R_exit:
    s_endpgm
.section .rodata,"a"
.p2align 6
.amdhsa_kernel rec_kernel
  .amdhsa_next_free_vgpr 512
  .amdhsa_next_free_sgpr 102
  .amdhsa_accum_offset 256
  .amdhsa_group_segment_fixed_size 0
  .amdhsa_kernarg_size 136
  .amdhsa_user_sgpr_count 2
  .amdhsa_user_sgpr_kernarg_segment_ptr 1
  .amdhsa_system_sgpr_workgroup_id_x 1
.end_amdhsa_kernel
```

```asm
; @launch kernel=rec_kernel grid=(256,1,1) block=(256,1,1) lds=163840
.amdgcn_target "amdgcn-amd-amdhsa--gfx950"
.text
.globl rec_kernel
.p2align 8
.type rec_kernel,@function
rec_kernel:
    s_cmp_ge_u32 s2, 256
    s_cbranch_scc1 R_exit
    s_load_dwordx2 s[8:9], s[0:1], 128
    s_load_dwordx2 s[12:13], s[0:1], 120
    s_mov_b32 s10, 268435456
    s_mov_b32 s11, 0x20000
    s_mov_b32 s14, 256
    s_mov_b32 s15, 0x20000
    s_waitcnt lgkmcnt(0)
    s_getreg_b32 s4, hwreg(HW_REG_XCC_ID)
    s_getreg_b32 s5, hwreg(HW_REG_HW_ID)
    s_and_b32 s4, s4, 7
    s_bfe_u32 s20, s5, 0x30008
    s_bfe_u32 s6, s5, 0x1000b
    s_bfe_u32 s5, s5, 131085
    s_lshl_b32 s7, s5, 3
    s_add_u32 s20, s20, s7
    v_and_b32 v1, 63, v0
    v_lshrrev_b32 v2, 6, v0
    s_nop 0
    v_readfirstlane_b32 s3, v2
    s_mov_b32 s30, 65536
    s_lshl_b32 s5, s4, 5
    v_mov_b32 v134, 0
    s_cmp_lg_u32 s6, 0
    s_cbranch_scc1 R_c8
R_clm:
    s_lshl_b32 s33, 1, s20
    s_cmp_lg_u32 s3, 0
    s_cbranch_scc1 R_disp
    v_mov_b32 v135, s33
    s_mov_b64 exec, 1
    buffer_atomic_or v135, v134, s[12:15], s5 offen sc0 sc1
    s_mov_b64 exec, -1
R_disp:
    s_mov_b32 s99, s4
    s_lshl_b32 s51, s4, 5
    s_add_u32 s51, s51, s20
    s_mov_b32 s82, 0
    s_cmp_ge_u32 s20, 28
    s_cbranch_scc1 R_x
    s_cmp_ge_u32 s20, 18
    s_cbranch_scc1 R_c
    s_cmp_ge_u32 s20, 12
    s_cbranch_scc1 R_v
    v_lshlrev_b32 v2, 4, v1
    s_load_dwordx2 s[12:13], s[0:1], 16
    s_load_dwordx2 s[16:17], s[0:1], 24
    s_mov_b32 s14, 7864320
    s_mov_b32 s15, 0x20000
    s_mov_b32 s18, 7864320
    s_mov_b32 s19, 0x20000
    s_waitcnt lgkmcnt(0)
    s_mul_i32 s42, s99, 12
    s_add_u32 s42, s42, s20
    s_lshl_b32 s42, s42, 7
    s_mov_b32 s47, s42
    s_lshl_b32 s37, s3, 11
    s_lshl_b32 s4, s3, 4
    s_and_b32 s5, s3, 1
    s_lshl_b32 s5, s5, 1
    v_lshrrev_b32 v60, 3, v1
    v_and_b32 v61, 1, v60
    v_or_b32 v61, s5, v61
    v_add_u32 v60, s4, v60
    v_mul_u32_u24 v13, 12288, v60
    v_bfe_u32 v60, v1, 1, 2
    v_xor_b32 v60, v60, v61
    v_lshlrev_b32 v60, 5, v60
    v_and_b32 v61, 1, v1
    v_lshlrev_b32 v61, 4, v61
    v_add3_u32 v13, v13, v60, v61
    v_lshrrev_b32 v60, 4, v1
    v_lshlrev_b32 v60, 2, v60
    v_bfe_u32 v61, v1, 2, 1
    v_add_u32 v60, v60, v61
    v_bfe_u32 v61, v1, 3, 1
    v_lshlrev_b32 v61, 4, v61
    v_add_u32 v60, v60, v61
    v_lshlrev_b32 v0, 7, v60
    v_bfe_u32 v60, v1, 2, 2
    v_lshlrev_b32 v60, 5, v60
    v_and_b32 v61, 3, v1
    v_lshlrev_b32 v61, 3, v61
    v_add3_u32 v0, v0, v60, v61
    v_mov_b32 v134, 163776
    s_cmp_lg_u32 s3, 0
    s_cbranch_scc1 SC_c
    s_waitcnt vmcnt(0)
    v_readfirstlane_b32 s4, v135
    s_and_b32 s4, s4, s33
    s_nop 0
    v_mov_b32 v135, s4
    ds_write_b32 v134, v135
    s_waitcnt lgkmcnt(0)
SC_c:
    s_barrier
    ds_read_b32 v135, v134
    s_waitcnt lgkmcnt(0)
    v_readfirstlane_b32 s4, v135
    s_cmp_lg_u32 s4, 0
    s_cbranch_scc1 R_ovf
    s_load_dwordx2 s[84:85], s[0:1], 120
    s_mov_b32 s86, 256
    s_mov_b32 s87, 0x20000
    s_waitcnt lgkmcnt(0)
    s_mul_i32 s22, s99, 1048576
    s_add_u32 s22, s22, 8388608
    s_lshl_b32 s33, s20, 4
    s_lshl_b32 s4, s3, 2
    s_add_u32 s33, s33, s4
    s_add_u32 s33, s33, s22
    s_add_u32 s33, s33, 155648
    s_mov_b32 s48, 0xfffffffe
    v_mov_b32 v9, 0
    v_mov_b32 v240, -1
    v_mov_b32 v241, -1
    v_mov_b32 v242, -1
    v_mov_b32 v243, -1
    v_and_b32 v16, 8, v1
    v_mov_b32 v5, 0x4444
    v_mov_b32 v17, 0xeeee
    v_cmp_ne_u32 vcc, 0, v16
    s_nop 1
    v_cndmask_b32 v5, v5, v17, vcc
    s_mul_i32 s4, s20, 43
    s_lshr_b32 s4, s4, 7
    s_mul_i32 s5, s4, 3
    s_sub_u32 s5, s20, s5
    s_lshl_b32 s4, s4, 12
    s_lshl_b32 s6, s5, 10
    s_add_u32 s6, s6, s4
    s_lshl_b32 s7, s3, 6
    s_add_u32 s6, s6, s7
    s_lshl_b32 s5, s5, 2
    s_add_u32 s5, s5, s4
    s_add_u32 s5, s5, 3072
    v_and_b32 v16, 7, v1
    v_lshrrev_b32 v17, 4, v1
    v_bfe_u32 v18, v1, 3, 1
    v_lshlrev_b32 v19, 7, v16
    v_mov_b32 v64, 0x80000000
    v_mov_b32 v65, 0x80000000
    v_mov_b32 v14, 0x80000000
    s_cmp_lt_u32 s3, 2
    s_cselect_b32 exec_lo, 0x00ff00ff, 0
    s_mov_b32 exec_hi, exec_lo
    v_lshl_add_u32 v64, v17, 4, v19
    v_add_u32 v64, s6, v64
    s_cmp_eq_u32 s3, 2
    s_cselect_b64 exec, -1, 0
    v_lshl_add_u32 v65, v17, 5, v19
    v_lshl_add_u32 v65, v18, 4, v65
    v_add_u32 v65, s5, v65
    s_cmp_eq_u32 s3, 3
    s_cselect_b64 exec, 1, 0
    v_mov_b32 v14, 0
    s_mov_b64 exec, -1
    s_add_u32 s24, s22, 40960
    s_add_u32 s5, s24, 16384
    s_mul_i32 s4, s20, 43
    s_lshr_b32 s4, s4, 7
    s_mul_i32 s4, s4, 61
    s_add_u32 s4, s4, s20
    s_lshl_b32 s4, s4, 2
    s_add_u32 s44, s4, s22
    s_add_u32 s44, s44, 156800
    buffer_store_dwordx4 v[240:243], v64, s[8:11], s24 offen offset:0 sc1
    buffer_store_dword v240, v65, s[8:11], s24 offen offset:0 sc1
    buffer_store_dwordx4 v[240:243], v64, s[8:11], s5 offen offset:0 sc1
    buffer_store_dword v240, v65, s[8:11], s5 offen offset:0 sc1
    buffer_store_dword v9, v14, s[8:11], s44 offen offset:0 sc1
    v_mov_b32 v10, 0
    s_mov_b64 exec, 1
    buffer_store_dword v10, v9, s[8:11], s33 offen sc1
    s_mov_b64 exec, -1
    v_and_b32 v16, 15, v1
    v_lshrrev_b32 v17, 4, v1
    v_and_b32 v18, 1, v17
    v_lshlrev_b32 v18, 2, v18
    v_sub_u32 v18, v16, v18
    v_mov_b32 v19, 0x3f80
    v_mov_b32 v20, 0x3f800000
    v_cmp_eq_u32 vcc, 0, v18
    s_nop 1
    v_cndmask_b32 v84, 0, v19, vcc
    v_cmp_eq_u32 vcc, 1, v18
    s_nop 1
    v_cndmask_b32 v84, v84, v20, vcc
    v_cmp_eq_u32 vcc, 2, v18
    s_nop 1
    v_cndmask_b32 v85, 0, v19, vcc
    v_cmp_eq_u32 vcc, 3, v18
    s_nop 1
    v_cndmask_b32 v85, v85, v20, vcc
    v_cmp_eq_u32 vcc, 8, v18
    s_nop 1
    v_cndmask_b32 v86, 0, v19, vcc
    v_cmp_eq_u32 vcc, 9, v18
    s_nop 1
    v_cndmask_b32 v86, v86, v20, vcc
    v_cmp_eq_u32 vcc, 10, v18
    s_nop 1
    v_cndmask_b32 v87, 0, v19, vcc
    v_cmp_eq_u32 vcc, 11, v18
    s_nop 1
    v_cndmask_b32 v87, v87, v20, vcc
    s_lshl_b32 s4, s3, 11
    s_add_u32 s4, s4, 73728
    v_add_u32 v3, s4, v2
    s_lshl_b32 s4, s3, 9
    s_add_u32 s4, s4, 90112
    v_lshl_add_u32 v4, v1, 3, s4
    s_mul_i32 s4, s3, 640
    s_add_u32 s4, s4, 92160
    v_mul_u32_u24 v7, 40, v16
    v_lshl_add_u32 v7, v17, 3, v7
    v_add_u32 v7, s4, v7
    v_lshrrev_b32 v18, 2, v1
    v_mul_u32_u24 v18, 40, v18
    v_add_u32 v18, 92160, v18
    v_and_b32 v19, 1, v1
    v_lshl_add_u32 v8, v19, 3, v18
    s_cmp_eq_u32 s3, 2
    s_cselect_b32 s4, 1, 0
    v_bfe_u32 v19, v1, s4, 1
    v_lshl_add_u32 v6, v19, 3, v18
    s_lshr_b32 s4, s3, 1
    s_lshl_b32 s4, s4, 10
    s_and_b32 s5, s3, 1
    s_lshl_b32 s5, s5, 3
    s_add_u32 s4, s4, s5
    s_add_u32 s4, s4, 96256
    v_add_u32 v12, s4, v2
    s_lshl_b32 s4, s3, 2
    s_lshr_b32 s5, 0x0232, s4
    s_and_b32 s5, s5, 3
    s_lshl_b32 s5, s5, 11
    s_add_u32 s5, s5, 96256
    v_add_u32 v15, s5, v2
    s_min_u32 s5, s3, 1
    s_lshl_b32 s5, s5, 11
    s_add_u32 s5, s5, 96256
    v_add_u32 v62, s5, v2
    s_lshr_b32 s5, 0x3120, s4
    s_and_b32 s5, s5, 3
    s_lshl_b32 s5, s5, 10
    s_lshl_b32 s36, s20, 12
    s_add_u32 s36, s36, s5
    s_add_u32 s36, s36, s22
    s_add_u32 s36, s36, 356352
    s_cmp_eq_u32 s3, 3
    s_cselect_b32 s5, 0x80000000, 0
    v_add_u32 v63, s5, v2
    s_lshl_b32 s4, s20, 2
    s_add_u32 s4, s4, s3
    s_lshl_b32 s5, s4, 10
    s_mul_i32 s6, s99, 49152
    s_add_u32 s5, s5, s6
    s_add_u32 s46, s5, 48758784
    s_mov_b32 s45, 7
    s_cmp_lt_u32 s4, 40
    s_cselect_b32 s88, 20, 99
    s_mul_i32 s5, s99, 40
    s_add_u32 s5, s5, s4
    s_lshl_b32 s5, s5, 10
    s_cmp_lt_u32 s5, 163840
    s_cselect_b32 s6, 0, 2457600
    s_add_u32 s5, s5, s6
    s_add_u32 s89, s5, 59080704
    s_mov_b32 s40, 0xff00ff00
    s_mov_b32 s41, 0xff00ff00
    s_mov_b32 s90, 0xffff0000
    s_mov_b32 s91, 0xffff0000
    s_waitcnt vmcnt(0)
    s_barrier
    s_cmp_lg_u32 s3, 0
    s_cbranch_scc1 SA_n
    s_lshl_b32 s4, s99, 5
    s_add_u32 s4, s4, 4
    v_mov_b32 v16, 0
    v_mov_b32 v17, 1
    s_mov_b64 exec, 1
    buffer_atomic_add v17, v16, s[84:87], s4 offen sc1
    s_mov_b64 exec, -1
SA_n:
    s_add_u32 s4, s42, 0
    s_add_u32 m0, s37, 0
    s_nop 0
    buffer_load_dwordx4 v13, s[12:15], s4 offen nt lds
    s_add_u32 s4, s42, 98304
    s_add_u32 m0, s37, 1024
    s_nop 0
    buffer_load_dwordx4 v13, s[12:15], s4 offen nt lds
    s_waitcnt vmcnt(2)
    s_add_u32 s4, s47, 0
    s_add_u32 m0, s37, 81920
    s_nop 0
    buffer_load_dwordx4 v13, s[16:19], s4 offen nt lds
    s_add_u32 s4, s47, 98304
    s_add_u32 m0, s37, 82944
    s_nop 0
    buffer_load_dwordx4 v13, s[16:19], s4 offen nt lds
    s_waitcnt vmcnt(2)
    s_add_u32 s4, s42, 786432
    s_add_u32 m0, s37, 8192
    s_nop 0
    buffer_load_dwordx4 v13, s[12:15], s4 offen nt lds
    s_add_u32 s4, s42, 884736
    s_add_u32 m0, s37, 9216
    s_nop 0
    buffer_load_dwordx4 v13, s[12:15], s4 offen nt lds
    s_waitcnt vmcnt(2)
    s_add_u32 s4, s47, 786432
    s_add_u32 m0, s37, 90112
    s_nop 0
    buffer_load_dwordx4 v13, s[16:19], s4 offen nt lds
    s_add_u32 s4, s47, 884736
    s_add_u32 m0, s37, 91136
    s_nop 0
    buffer_load_dwordx4 v13, s[16:19], s4 offen nt lds
    s_waitcnt vmcnt(2)
    s_add_u32 s4, s42, 1572864
    s_add_u32 m0, s37, 16384
    s_nop 0
    buffer_load_dwordx4 v13, s[12:15], s4 offen nt lds
    s_add_u32 s4, s42, 1671168
    s_add_u32 m0, s37, 17408
    s_nop 0
    buffer_load_dwordx4 v13, s[12:15], s4 offen nt lds
    s_waitcnt vmcnt(2)
    s_add_u32 s4, s47, 1572864
    s_add_u32 m0, s37, 98304
    s_nop 0
    buffer_load_dwordx4 v13, s[16:19], s4 offen nt lds
    s_add_u32 s4, s47, 1671168
    s_add_u32 m0, s37, 99328
    s_nop 0
    buffer_load_dwordx4 v13, s[16:19], s4 offen nt lds
    s_waitcnt vmcnt(2)
    s_add_u32 s4, s42, 2359296
    s_add_u32 m0, s37, 24576
    s_nop 0
    buffer_load_dwordx4 v13, s[12:15], s4 offen nt lds
    s_add_u32 s4, s42, 2457600
    s_add_u32 m0, s37, 25600
    s_nop 0
    buffer_load_dwordx4 v13, s[12:15], s4 offen nt lds
    s_waitcnt vmcnt(2)
    s_add_u32 s4, s47, 2359296
    s_add_u32 m0, s37, 106496
    s_nop 0
    buffer_load_dwordx4 v13, s[16:19], s4 offen nt lds
    s_add_u32 s4, s47, 2457600
    s_add_u32 m0, s37, 107520
    s_nop 0
    buffer_load_dwordx4 v13, s[16:19], s4 offen nt lds
    s_waitcnt vmcnt(2)
    s_add_u32 s4, s42, 3145728
    s_add_u32 m0, s37, 32768
    s_nop 0
    buffer_load_dwordx4 v13, s[12:15], s4 offen nt lds
    s_add_u32 s4, s42, 3244032
    s_add_u32 m0, s37, 33792
    s_nop 0
    buffer_load_dwordx4 v13, s[12:15], s4 offen nt lds
    s_waitcnt vmcnt(2)
    s_add_u32 s4, s47, 3145728
    s_add_u32 m0, s37, 114688
    s_nop 0
    buffer_load_dwordx4 v13, s[16:19], s4 offen nt lds
    s_add_u32 s4, s47, 3244032
    s_add_u32 m0, s37, 115712
    s_nop 0
    buffer_load_dwordx4 v13, s[16:19], s4 offen nt lds
    s_waitcnt vmcnt(2)
    v_and_b32 v16, 7, v1
    v_lshlrev_b32 v16, 5, v16
    buffer_load_dwordx4 v[20:23], v16, s[84:87], 0 offen sc1
    s_add_u32 s4, s42, 3932160
    s_add_u32 m0, s37, 40960
    s_nop 0
    buffer_load_dwordx4 v13, s[12:15], s4 offen nt lds
    s_add_u32 s4, s42, 4030464
    s_add_u32 m0, s37, 41984
    s_nop 0
    buffer_load_dwordx4 v13, s[12:15], s4 offen nt lds
    s_add_u32 s4, s47, 3932160
    s_add_u32 m0, s37, 122880
    s_nop 0
    buffer_load_dwordx4 v13, s[16:19], s4 offen nt lds
    s_add_u32 s4, s47, 4030464
    s_add_u32 m0, s37, 123904
    s_nop 0
    buffer_load_dwordx4 v13, s[16:19], s4 offen nt lds
    s_add_u32 s4, s42, 4718592
    s_add_u32 m0, s37, 49152
    s_nop 0
    buffer_load_dwordx4 v13, s[12:15], s4 offen nt lds
    s_add_u32 s4, s42, 4816896
    s_add_u32 m0, s37, 50176
    s_nop 0
    buffer_load_dwordx4 v13, s[12:15], s4 offen nt lds
    s_add_u32 s4, s47, 4718592
    s_add_u32 m0, s37, 131072
    s_nop 0
    buffer_load_dwordx4 v13, s[16:19], s4 offen nt lds
    s_add_u32 s4, s47, 4816896
    s_add_u32 m0, s37, 132096
    s_nop 0
    buffer_load_dwordx4 v13, s[16:19], s4 offen nt lds
    s_mov_b32 s31, 0
    s_waitcnt vmcnt(8)
    s_branch SI_c
SI_l:
    buffer_load_dwordx4 v[20:23], v16, s[84:87], 0 offen sc1
    s_waitcnt vmcnt(0)
SI_c:
    v_bcnt_u32_b32 v17, v20, v23
    v_cmp_lt_u32 s[4:5], 32, v17
    s_and_b32 s6, s4, 0xff
    v_cmp_ne_u32 s[4:5], 32, v17
    s_cmp_eq_u32 s6, 0
    s_cselect_b32 s5, 0xff, 0
    s_and_b32 s4, s4, s5
    v_cmp_gt_u32 vcc, 22, v21
    s_and_b32 vcc_lo, vcc_lo, 0xff
    s_or_b32 vcc_lo, vcc_lo, s4
    s_mov_b32 vcc_hi, 0
    s_cbranch_vccz SI_o
    s_sleep 16
    s_add_u32 s31, s31, 1
    s_cmp_lt_u32 s31, s30
    s_cbranch_scc1 SI_l
    s_mov_b32 s30, 1
SI_o:
    s_mov_b32 s97, s6
    s_add_u32 s4, s42, 5505024
    s_add_u32 m0, s37, 57344
    s_nop 0
    buffer_load_dwordx4 v13, s[12:15], s4 offen nt lds
    s_add_u32 s4, s42, 5603328
    s_add_u32 m0, s37, 58368
    s_nop 0
    buffer_load_dwordx4 v13, s[12:15], s4 offen nt lds
    s_add_u32 s4, s47, 5505024
    s_add_u32 m0, s37, 139264
    s_nop 0
    buffer_load_dwordx4 v13, s[16:19], s4 offen nt lds
    s_add_u32 s4, s47, 5603328
    s_add_u32 m0, s37, 140288
    s_nop 0
    buffer_load_dwordx4 v13, s[16:19], s4 offen nt lds
    s_add_u32 s4, s42, 6291456
    s_add_u32 m0, s37, 65536
    s_nop 0
    buffer_load_dwordx4 v13, s[12:15], s4 offen nt lds
    s_add_u32 s4, s42, 6389760
    s_add_u32 m0, s37, 66560
    s_nop 0
    buffer_load_dwordx4 v13, s[12:15], s4 offen nt lds
    s_add_u32 s4, s47, 6291456
    s_add_u32 m0, s37, 147456
    s_nop 0
    buffer_load_dwordx4 v13, s[16:19], s4 offen nt lds
    s_add_u32 s4, s47, 6389760
    s_add_u32 m0, s37, 148480
    s_nop 0
    buffer_load_dwordx4 v13, s[16:19], s4 offen nt lds
    s_add_u32 s4, s42, 7077888
    s_add_u32 m0, s37, 73728
    s_nop 0
    buffer_load_dwordx4 v13, s[12:15], s4 offen nt lds
    s_add_u32 s4, s42, 7176192
    s_add_u32 m0, s37, 74752
    s_nop 0
    buffer_load_dwordx4 v13, s[12:15], s4 offen nt lds
    s_add_u32 s4, s47, 7077888
    s_add_u32 m0, s37, 155648
    s_nop 0
    buffer_load_dwordx4 v13, s[16:19], s4 offen nt lds
    s_add_u32 s4, s47, 7176192
    s_add_u32 m0, s37, 156672
    s_nop 0
    buffer_load_dwordx4 v13, s[16:19], s4 offen nt lds
    s_barrier
    s_lshl_b32 s4, s3, 5
    v_xor_b32 v60, s4, v0
    v_add_u32 v61, 81920, v60
    ds_read_b64_tr_b16 a[0:1], v60 offset:0
    ds_read_b64_tr_b16 a[2:3], v60 offset:256
    ds_read_b64_tr_b16 a[4:5], v60 offset:4096
    ds_read_b64_tr_b16 a[6:7], v60 offset:4352
    ds_read_b64_tr_b16 a[8:9], v60 offset:8192
    ds_read_b64_tr_b16 a[10:11], v60 offset:8448
    ds_read_b64_tr_b16 a[12:13], v60 offset:12288
    ds_read_b64_tr_b16 a[14:15], v60 offset:12544
    ds_read_b64_tr_b16 a[16:17], v60 offset:16384
    ds_read_b64_tr_b16 a[18:19], v60 offset:16640
    ds_read_b64_tr_b16 a[20:21], v60 offset:20480
    ds_read_b64_tr_b16 a[22:23], v60 offset:20736
    ds_read_b64_tr_b16 a[24:25], v60 offset:24576
    ds_read_b64_tr_b16 a[26:27], v60 offset:24832
    ds_read_b64_tr_b16 a[28:29], v60 offset:28672
    ds_read_b64_tr_b16 a[30:31], v60 offset:28928
    ds_read_b64_tr_b16 a[32:33], v60 offset:32768
    ds_read_b64_tr_b16 a[34:35], v60 offset:33024
    ds_read_b64_tr_b16 a[36:37], v60 offset:36864
    ds_read_b64_tr_b16 a[38:39], v60 offset:37120
    ds_read_b64_tr_b16 a[80:81], v61 offset:0
    ds_read_b64_tr_b16 a[82:83], v61 offset:256
    ds_read_b64_tr_b16 a[84:85], v61 offset:4096
    ds_read_b64_tr_b16 a[86:87], v61 offset:4352
    ds_read_b64_tr_b16 a[88:89], v61 offset:8192
    ds_read_b64_tr_b16 a[90:91], v61 offset:8448
    ds_read_b64_tr_b16 a[92:93], v61 offset:12288
    ds_read_b64_tr_b16 a[94:95], v61 offset:12544
    ds_read_b64_tr_b16 a[96:97], v61 offset:16384
    ds_read_b64_tr_b16 a[98:99], v61 offset:16640
    ds_read_b64_tr_b16 a[100:101], v61 offset:20480
    ds_read_b64_tr_b16 a[102:103], v61 offset:20736
    ds_read_b64_tr_b16 a[104:105], v61 offset:24576
    ds_read_b64_tr_b16 a[106:107], v61 offset:24832
    ds_read_b64_tr_b16 a[108:109], v61 offset:28672
    ds_read_b64_tr_b16 a[110:111], v61 offset:28928
    ds_read_b64_tr_b16 a[112:113], v61 offset:32768
    ds_read_b64_tr_b16 a[114:115], v61 offset:33024
    ds_read_b64_tr_b16 a[116:117], v61 offset:36864
    ds_read_b64_tr_b16 a[118:119], v61 offset:37120
    s_mul_i32 s27, s3, 10240
    s_add_u32 s28, s27, 16777216
    s_mov_b32 s29, 0
    s_mov_b32 s21, 0
    s_mov_b32 s32, 0
    s_cmp_lg_u32 s3, 0
    s_cbranch_scc1 SH_o
    s_lshl_b32 s23, s99, 7
    s_add_u32 s23, s23, 81920
    s_mov_b32 s31, 0
SH_l:
    s_load_dwordx4 s[4:7], s[8:9], s23 glc
    s_waitcnt lgkmcnt(0)
    s_and_b64 s[4:5], s[4:5], s[6:7]
    s_and_b32 s4, s4, s5
    s_cbranch_scc1 SH_o
    s_sleep 8
    s_add_u32 s31, s31, 1
    s_cmp_lt_u32 s31, s30
    s_cbranch_scc1 SH_l
    s_mov_b32 s30, 1
SH_o:
    s_waitcnt lgkmcnt(0)
    s_barrier
    v_and_b32 v16, 7, v1
    v_lshlrev_b32 v16, 5, v16
    buffer_load_dwordx4 v[20:23], v16, s[84:87], 0 offen sc1
    s_add_u32 s35, s28, 0
    s_add_u32 m0, s27, 0
    s_nop 0
    buffer_load_dwordx4 v2, s[8:11], s35 offen offset:0 sc1 lds
    buffer_load_dwordx4 v2, s[8:11], s35 offen offset:1024 sc1 lds
    buffer_load_dwordx4 v2, s[8:11], s35 offen offset:2048 sc1 lds
    buffer_load_dwordx4 v2, s[8:11], s35 offen offset:3072 sc1 lds
    s_add_u32 s35, s28, 4096
    s_add_u32 m0, s27, 4096
    s_nop 0
    buffer_load_dwordx4 v2, s[8:11], s35 offen offset:0 sc1 lds
    buffer_load_dwordx4 v2, s[8:11], s35 offen offset:1024 sc1 lds
    buffer_load_dwordx4 v2, s[8:11], s35 offen offset:2048 sc1 lds
    buffer_load_dwordx4 v2, s[8:11], s35 offen offset:3072 sc1 lds
    s_add_u32 s35, s28, 8192
    s_add_u32 m0, s27, 8192
    s_nop 0
    buffer_load_dwordx4 v2, s[8:11], s35 offen offset:0 sc1 lds
    buffer_load_dwordx4 v2, s[8:11], s35 offen offset:1024 sc1 lds
    s_waitcnt vmcnt(11)
    s_barrier
    ds_read_b64_tr_b16 a[40:41], v60 offset:40960
    ds_read_b64_tr_b16 a[42:43], v60 offset:41216
    ds_read_b64_tr_b16 a[44:45], v60 offset:45056
    ds_read_b64_tr_b16 a[46:47], v60 offset:45312
    ds_read_b64_tr_b16 a[48:49], v60 offset:49152
    ds_read_b64_tr_b16 a[50:51], v60 offset:49408
    ds_read_b64_tr_b16 a[52:53], v60 offset:53248
    ds_read_b64_tr_b16 a[54:55], v60 offset:53504
    ds_read_b64_tr_b16 a[56:57], v60 offset:57344
    ds_read_b64_tr_b16 a[58:59], v60 offset:57600
    ds_read_b64_tr_b16 a[60:61], v60 offset:61440
    ds_read_b64_tr_b16 a[62:63], v60 offset:61696
    v_add_u32 v60, 65536, v60
    ds_read_b64_tr_b16 a[64:65], v60 offset:0
    ds_read_b64_tr_b16 a[66:67], v60 offset:256
    ds_read_b64_tr_b16 a[68:69], v60 offset:4096
    ds_read_b64_tr_b16 a[70:71], v60 offset:4352
    ds_read_b64_tr_b16 a[72:73], v60 offset:8192
    ds_read_b64_tr_b16 a[74:75], v60 offset:8448
    ds_read_b64_tr_b16 a[76:77], v60 offset:12288
    ds_read_b64_tr_b16 a[78:79], v60 offset:12544
    ds_read_b64_tr_b16 a[120:121], v61 offset:40960
    ds_read_b64_tr_b16 a[122:123], v61 offset:41216
    ds_read_b64_tr_b16 a[124:125], v61 offset:45056
    ds_read_b64_tr_b16 a[126:127], v61 offset:45312
    ds_read_b64_tr_b16 a[128:129], v61 offset:49152
    ds_read_b64_tr_b16 a[130:131], v61 offset:49408
    ds_read_b64_tr_b16 a[132:133], v61 offset:53248
    ds_read_b64_tr_b16 a[134:135], v61 offset:53504
    ds_read_b64_tr_b16 a[136:137], v61 offset:57344
    ds_read_b64_tr_b16 a[138:139], v61 offset:57600
    ds_read_b64_tr_b16 a[140:141], v61 offset:61440
    ds_read_b64_tr_b16 a[142:143], v61 offset:61696
    v_add_u32 v61, 65536, v61
    ds_read_b64_tr_b16 a[144:145], v61 offset:0
    ds_read_b64_tr_b16 a[146:147], v61 offset:256
    ds_read_b64_tr_b16 a[148:149], v61 offset:4096
    ds_read_b64_tr_b16 a[150:151], v61 offset:4352
    ds_read_b64_tr_b16 a[152:153], v61 offset:8192
    ds_read_b64_tr_b16 a[154:155], v61 offset:8448
    ds_read_b64_tr_b16 a[156:157], v61 offset:12288
    ds_read_b64_tr_b16 a[158:159], v61 offset:12544
    s_mov_b32 s31, 0
    s_waitcnt vmcnt(10)
    s_branch SJ_c
SJ_l:
    buffer_load_dwordx4 v[20:23], v16, s[84:87], 0 offen sc1
    s_waitcnt vmcnt(0)
SJ_c:
    v_bcnt_u32_b32 v17, v20, v23
    v_cmp_lt_u32 s[4:5], 32, v17
    s_and_b32 s6, s4, 0xff
    v_cmp_ne_u32 s[4:5], 32, v17
    s_cmp_eq_u32 s6, 0
    s_cselect_b32 s5, 0xff, 0
    s_and_b32 s4, s4, s5
    v_add_u32 v21, v21, v22
    v_cmp_gt_u32 vcc, 32, v21
    s_and_b32 vcc_lo, vcc_lo, 0xff
    s_or_b32 vcc_lo, vcc_lo, s4
    s_mov_b32 vcc_hi, 0
    s_cbranch_vccz SJ_o
    s_sleep 16
    s_add_u32 s31, s31, 1
    s_cmp_lt_u32 s31, s30
    s_cbranch_scc1 SJ_l
    s_mov_b32 s30, 1
SJ_o:
    s_mov_b32 s97, s6
    v_min_u32 v67, 55, v1
    v_lshlrev_b32 v67, 7, v67
    v_min_u32 v70, 3968, v67
    v_min_u32 v71, 896, v67
    s_mov_b32 s49, 65536
    s_mov_b32 s23, 65540
    s_mov_b32 s47, 72708
    s_waitcnt lgkmcnt(0)
    s_barrier
    s_add_u32 s28, s28, 40960
    s_cmp_lg_u32 s97, 0
    s_cbranch_scc1 Ss_go
Sf_go:
    s_waitcnt vmcnt(0)
    s_barrier
    v_add_u32 v11, s29, v2
    s_xor_b32 s29, s29, 40960
    s_add_u32 s42, s29, s27
    ds_read_b128 a[160:163], v11 offset:0
    ds_read_b128 a[164:167], v11 offset:20480
    ds_read_b128 a[168:171], v11 offset:1024
    ds_read_b128 a[172:175], v11 offset:21504
    ds_read_b128 a[176:179], v11 offset:2048
    ds_read_b128 a[180:183], v11 offset:22528
    s_waitcnt lgkmcnt(5)
    v_mfma_f32_16x16x32_bf16 v[144:147], a[0:3], a[160:163], 0
    ds_read_b128 a[184:187], v11 offset:3072
    v_mfma_f32_16x16x32_bf16 v[152:155], a[80:83], a[160:163], 0
    s_waitcnt lgkmcnt(5)
    v_mfma_f32_16x16x32_bf16 v[148:151], a[0:3], a[164:167], 0
    ds_read_b128 a[188:191], v11 offset:23552
    v_mfma_f32_16x16x32_bf16 v[156:159], a[80:83], a[164:167], 0
    s_waitcnt lgkmcnt(5)
    v_mfma_f32_16x16x32_bf16 v[144:147], a[4:7], a[168:171], v[144:147]
    ds_read_b128 a[160:163], v11 offset:4096
    s_add_u32 s35, s28, 0
    s_add_u32 m0, s42, 0
    v_mfma_f32_16x16x32_bf16 v[152:155], a[84:87], a[168:171], v[152:155]
    buffer_load_dwordx4 v2, s[8:11], s35 offen offset:0 sc1 lds
    s_waitcnt lgkmcnt(5)
    v_mfma_f32_16x16x32_bf16 v[148:151], a[4:7], a[172:175], v[148:151]
    ds_read_b128 a[164:167], v11 offset:24576
    v_mfma_f32_16x16x32_bf16 v[156:159], a[84:87], a[172:175], v[156:159]
    s_waitcnt lgkmcnt(5)
    v_mfma_f32_16x16x32_bf16 v[144:147], a[8:11], a[176:179], v[144:147]
    ds_read_b128 a[168:171], v11 offset:5120
    v_mfma_f32_16x16x32_bf16 v[152:155], a[88:91], a[176:179], v[152:155]
    s_waitcnt lgkmcnt(5)
    v_mfma_f32_16x16x32_bf16 v[148:151], a[8:11], a[180:183], v[148:151]
    ds_read_b128 a[172:175], v11 offset:25600
    v_mfma_f32_16x16x32_bf16 v[156:159], a[88:91], a[180:183], v[156:159]
    buffer_load_dwordx4 v2, s[8:11], s35 offen offset:1024 sc1 lds
    s_waitcnt lgkmcnt(5)
    v_mfma_f32_16x16x32_bf16 v[144:147], a[12:15], a[184:187], v[144:147]
    ds_read_b128 a[176:179], v11 offset:6144
    v_mfma_f32_16x16x32_bf16 v[152:155], a[92:95], a[184:187], v[152:155]
    s_waitcnt lgkmcnt(5)
    v_mfma_f32_16x16x32_bf16 v[148:151], a[12:15], a[188:191], v[148:151]
    ds_read_b128 a[180:183], v11 offset:26624
    v_mfma_f32_16x16x32_bf16 v[156:159], a[92:95], a[188:191], v[156:159]
    s_waitcnt lgkmcnt(5)
    v_mfma_f32_16x16x32_bf16 v[144:147], a[16:19], a[160:163], v[144:147]
    ds_read_b128 a[184:187], v11 offset:7168
    v_mfma_f32_16x16x32_bf16 v[152:155], a[96:99], a[160:163], v[152:155]
    buffer_load_dwordx4 v2, s[8:11], s35 offen offset:2048 sc1 lds
    s_waitcnt lgkmcnt(5)
    v_mfma_f32_16x16x32_bf16 v[148:151], a[16:19], a[164:167], v[148:151]
    ds_read_b128 a[188:191], v11 offset:27648
    v_mfma_f32_16x16x32_bf16 v[156:159], a[96:99], a[164:167], v[156:159]
    s_waitcnt lgkmcnt(5)
    v_mfma_f32_16x16x32_bf16 v[144:147], a[20:23], a[168:171], v[144:147]
    ds_read_b128 a[160:163], v11 offset:8192
    v_mfma_f32_16x16x32_bf16 v[152:155], a[100:103], a[168:171], v[152:155]
    s_waitcnt lgkmcnt(5)
    v_mfma_f32_16x16x32_bf16 v[148:151], a[20:23], a[172:175], v[148:151]
    ds_read_b128 a[164:167], v11 offset:28672
    v_mfma_f32_16x16x32_bf16 v[156:159], a[100:103], a[172:175], v[156:159]
    buffer_load_dwordx4 v2, s[8:11], s35 offen offset:3072 sc1 lds
    s_waitcnt lgkmcnt(5)
    v_mfma_f32_16x16x32_bf16 v[144:147], a[24:27], a[176:179], v[144:147]
    ds_read_b128 a[168:171], v11 offset:9216
    v_mfma_f32_16x16x32_bf16 v[152:155], a[104:107], a[176:179], v[152:155]
    s_waitcnt lgkmcnt(5)
    v_mfma_f32_16x16x32_bf16 v[148:151], a[24:27], a[180:183], v[148:151]
    ds_read_b128 a[172:175], v11 offset:29696
    v_mfma_f32_16x16x32_bf16 v[156:159], a[104:107], a[180:183], v[156:159]
    s_waitcnt lgkmcnt(5)
    v_mfma_f32_16x16x32_bf16 v[144:147], a[28:31], a[184:187], v[144:147]
    ds_read_b128 a[176:179], v11 offset:10240
    s_add_u32 s35, s28, 4096
    s_add_u32 m0, s42, 4096
    v_mfma_f32_16x16x32_bf16 v[152:155], a[108:111], a[184:187], v[152:155]
    buffer_load_dwordx4 v2, s[8:11], s35 offen offset:0 sc1 lds
    s_waitcnt lgkmcnt(5)
    v_mfma_f32_16x16x32_bf16 v[148:151], a[28:31], a[188:191], v[148:151]
    ds_read_b128 a[180:183], v11 offset:30720
    v_mfma_f32_16x16x32_bf16 v[156:159], a[108:111], a[188:191], v[156:159]
    s_waitcnt lgkmcnt(5)
    v_mfma_f32_16x16x32_bf16 v[144:147], a[32:35], a[160:163], v[144:147]
    ds_read_b128 a[184:187], v11 offset:11264
    v_mfma_f32_16x16x32_bf16 v[152:155], a[112:115], a[160:163], v[152:155]
    s_waitcnt lgkmcnt(5)
    v_mfma_f32_16x16x32_bf16 v[148:151], a[32:35], a[164:167], v[148:151]
    ds_read_b128 a[188:191], v11 offset:31744
    v_mfma_f32_16x16x32_bf16 v[156:159], a[112:115], a[164:167], v[156:159]
    buffer_load_dwordx4 v2, s[8:11], s35 offen offset:1024 sc1 lds
    s_waitcnt lgkmcnt(5)
    v_mfma_f32_16x16x32_bf16 v[144:147], a[36:39], a[168:171], v[144:147]
    ds_read_b128 a[160:163], v11 offset:12288
    v_mfma_f32_16x16x32_bf16 v[152:155], a[116:119], a[168:171], v[152:155]
    s_waitcnt lgkmcnt(5)
    v_mfma_f32_16x16x32_bf16 v[148:151], a[36:39], a[172:175], v[148:151]
    ds_read_b128 a[164:167], v11 offset:32768
    v_mfma_f32_16x16x32_bf16 v[156:159], a[116:119], a[172:175], v[156:159]
    s_waitcnt lgkmcnt(5)
    v_mfma_f32_16x16x32_bf16 v[144:147], a[40:43], a[176:179], v[144:147]
    ds_read_b128 a[168:171], v11 offset:13312
    v_mfma_f32_16x16x32_bf16 v[152:155], a[120:123], a[176:179], v[152:155]
    buffer_load_dwordx4 v2, s[8:11], s35 offen offset:2048 sc1 lds
    s_waitcnt lgkmcnt(5)
    v_mfma_f32_16x16x32_bf16 v[148:151], a[40:43], a[180:183], v[148:151]
    ds_read_b128 a[172:175], v11 offset:33792
    v_mfma_f32_16x16x32_bf16 v[156:159], a[120:123], a[180:183], v[156:159]
    s_waitcnt lgkmcnt(5)
    v_mfma_f32_16x16x32_bf16 v[144:147], a[44:47], a[184:187], v[144:147]
    ds_read_b128 a[176:179], v11 offset:14336
    v_mfma_f32_16x16x32_bf16 v[152:155], a[124:127], a[184:187], v[152:155]
    s_waitcnt lgkmcnt(5)
    v_mfma_f32_16x16x32_bf16 v[148:151], a[44:47], a[188:191], v[148:151]
    ds_read_b128 a[180:183], v11 offset:34816
    v_mfma_f32_16x16x32_bf16 v[156:159], a[124:127], a[188:191], v[156:159]
    buffer_load_dwordx4 v2, s[8:11], s35 offen offset:3072 sc1 lds
    s_waitcnt lgkmcnt(5)
    v_mfma_f32_16x16x32_bf16 v[144:147], a[48:51], a[160:163], v[144:147]
    ds_read_b128 a[184:187], v11 offset:15360
    v_mfma_f32_16x16x32_bf16 v[152:155], a[128:131], a[160:163], v[152:155]
    s_waitcnt lgkmcnt(5)
    v_mfma_f32_16x16x32_bf16 v[148:151], a[48:51], a[164:167], v[148:151]
    ds_read_b128 a[188:191], v11 offset:35840
    v_mfma_f32_16x16x32_bf16 v[156:159], a[128:131], a[164:167], v[156:159]
    s_waitcnt lgkmcnt(5)
    v_mfma_f32_16x16x32_bf16 v[144:147], a[52:55], a[168:171], v[144:147]
    ds_read_b128 a[160:163], v11 offset:16384
    s_add_u32 s35, s28, 8192
    s_add_u32 m0, s42, 8192
    v_mfma_f32_16x16x32_bf16 v[152:155], a[132:135], a[168:171], v[152:155]
    buffer_load_dwordx4 v2, s[8:11], s35 offen offset:0 sc1 lds
    s_waitcnt lgkmcnt(5)
    v_mfma_f32_16x16x32_bf16 v[148:151], a[52:55], a[172:175], v[148:151]
    ds_read_b128 a[164:167], v11 offset:36864
    v_mfma_f32_16x16x32_bf16 v[156:159], a[132:135], a[172:175], v[156:159]
    s_waitcnt lgkmcnt(5)
    v_mfma_f32_16x16x32_bf16 v[144:147], a[56:59], a[176:179], v[144:147]
    ds_read_b128 a[168:171], v11 offset:17408
    v_mfma_f32_16x16x32_bf16 v[152:155], a[136:139], a[176:179], v[152:155]
    s_waitcnt lgkmcnt(5)
    v_mfma_f32_16x16x32_bf16 v[148:151], a[56:59], a[180:183], v[148:151]
    ds_read_b128 a[172:175], v11 offset:37888
    v_mfma_f32_16x16x32_bf16 v[156:159], a[136:139], a[180:183], v[156:159]
    buffer_load_dwordx4 v2, s[8:11], s35 offen offset:1024 sc1 lds
    s_waitcnt lgkmcnt(5)
    v_mfma_f32_16x16x32_bf16 v[144:147], a[60:63], a[184:187], v[144:147]
    ds_read_b128 a[176:179], v11 offset:18432
    v_mfma_f32_16x16x32_bf16 v[152:155], a[140:143], a[184:187], v[152:155]
    s_waitcnt lgkmcnt(5)
    v_mfma_f32_16x16x32_bf16 v[148:151], a[60:63], a[188:191], v[148:151]
    ds_read_b128 a[180:183], v11 offset:38912
    v_mfma_f32_16x16x32_bf16 v[156:159], a[140:143], a[188:191], v[156:159]
    s_waitcnt lgkmcnt(5)
    v_mfma_f32_16x16x32_bf16 v[144:147], a[64:67], a[160:163], v[144:147]
    ds_read_b128 a[184:187], v11 offset:19456
    v_mfma_f32_16x16x32_bf16 v[152:155], a[144:147], a[160:163], v[152:155]
    s_waitcnt lgkmcnt(5)
    v_mfma_f32_16x16x32_bf16 v[148:151], a[64:67], a[164:167], v[148:151]
    ds_read_b128 a[188:191], v11 offset:39936
    v_mfma_f32_16x16x32_bf16 v[156:159], a[144:147], a[164:167], v[156:159]
    s_waitcnt lgkmcnt(5)
    v_mfma_f32_16x16x32_bf16 v[144:147], a[68:71], a[168:171], v[144:147]
    v_mfma_f32_16x16x32_bf16 v[152:155], a[148:151], a[168:171], v[152:155]
    s_waitcnt lgkmcnt(4)
    v_mfma_f32_16x16x32_bf16 v[148:151], a[68:71], a[172:175], v[148:151]
    v_mfma_f32_16x16x32_bf16 v[156:159], a[148:151], a[172:175], v[156:159]
    s_waitcnt lgkmcnt(3)
    v_mfma_f32_16x16x32_bf16 v[144:147], a[72:75], a[176:179], v[144:147]
    v_mfma_f32_16x16x32_bf16 v[152:155], a[152:155], a[176:179], v[152:155]
    s_waitcnt lgkmcnt(2)
    v_mfma_f32_16x16x32_bf16 v[148:151], a[72:75], a[180:183], v[148:151]
    v_mfma_f32_16x16x32_bf16 v[156:159], a[152:155], a[180:183], v[156:159]
    s_waitcnt lgkmcnt(1)
    v_mfma_f32_16x16x32_bf16 v[144:147], a[76:79], a[184:187], v[144:147]
    v_mfma_f32_16x16x32_bf16 v[152:155], a[156:159], a[184:187], v[152:155]
    s_waitcnt lgkmcnt(0)
    v_mfma_f32_16x16x32_bf16 v[148:151], a[76:79], a[188:191], v[148:151]
    v_mfma_f32_16x16x32_bf16 v[156:159], a[156:159], a[188:191], v[156:159]
    s_add_u32 s28, s28, 40960
    s_add_u32 s32, s32, 1
    buffer_load_dword v68, v71, s[8:11], s49 offen offset:0 sc1
    v_cvt_pk_bf16_f32 v160, v144, v145
    v_cvt_pk_bf16_f32 v161, v146, v147
    ds_write_b64 v12, v[160:161] offset:0
    v_cvt_pk_bf16_f32 v162, v148, v149
    v_cvt_pk_bf16_f32 v163, v150, v151
    ds_write_b64 v12, v[162:163] offset:2048
    v_cvt_pk_bf16_f32 v164, v152, v153
    v_cvt_pk_bf16_f32 v165, v154, v155
    ds_write_b64 v12, v[164:165] offset:4096
    v_cvt_pk_bf16_f32 v166, v156, v157
    v_cvt_pk_bf16_f32 v167, v158, v159
    ds_write_b64 v12, v[166:167] offset:6144
    s_and_b32 s4, s21, 3
    s_lshl_b32 s4, s4, 16
    s_add_u32 s34, s36, s4
    s_waitcnt lgkmcnt(0)
    s_barrier
    ds_read_b128 v[96:99], v15 offset:0
    ds_read_b128 v[104:107], v62 offset:0
    ds_read_b128 v[100:103], v15 offset:1024
    ds_read_b128 v[108:111], v62 offset:1024
    s_waitcnt lgkmcnt(2)
    v_mfma_f32_16x16x32_bf16 v[128:131], v[96:99], v[104:107], 0
    s_waitcnt lgkmcnt(0)
    v_mfma_f32_16x16x32_bf16 v[128:131], v[100:103], v[108:111], v[128:131]
    s_nop 7
    buffer_store_dwordx4 v[128:131], v63, s[8:11], s34 offen offset:0
Sf_loop:
    s_and_b32 s4, s21, 3
    s_mul_i32 s5, s4, 10240
    s_add_u32 s5, s5, s22
    s_sub_u32 s38, s5, 73728
    s_sub_u32 s39, s5, 81920
    s_mul_i32 s5, s4, 16384
    s_add_u32 s25, s24, s5
    s_xor_b32 s4, s4, 2
    s_mul_i32 s5, s4, 163840
    s_mul_i32 s5, s4, 16384
    s_add_u32 s26, s24, s5
    s_add_u32 s21, s21, 1
    v_mov_b32 v72, 0
    v_mov_b32 v73, 0
    v_mov_b32 v74, 0
    v_mov_b32 v75, 0
    v_mov_b32 v76, 0
    v_mov_b32 v77, 0
    v_mov_b32 v78, 0
    v_mov_b32 v79, 0
    v_mov_b32 v59, s21
    s_cmp_eq_u32 s3, 1
    s_cbranch_scc1 Sf_q1
    s_cmp_eq_u32 s3, 2
    s_cbranch_scc1 Sf_q2
    s_cmp_eq_u32 s3, 3
    s_cbranch_scc1 Sf_q3
Sf_q0:
    s_mov_b64 s[4:5], -1
    s_mov_b64 s[6:7], -1
    s_mov_b64 s[92:93], -1
    s_mov_b32 s31, -1
Sf0m_l:
    s_mov_b64 exec, s[4:5]
    buffer_load_dwordx4 v[16:19], v3, s[8:11], s38 offen offset:0 sc1
    s_mov_b64 exec, s[6:7]
    buffer_load_dwordx4 v[20:23], v3, s[8:11], s38 offen offset:1024 sc1
    s_mov_b64 exec, s[92:93]
    buffer_load_dwordx2 v[56:57], v4, s[8:11], s39 offen offset:0 sc1
    s_mov_b64 exec, -1
    s_add_u32 s31, s31, 1
    s_cmp_lt_u32 s31, s30
    s_cselect_b32 s30, s30, 1
    s_cbranch_scc0 Sf0m_o
    s_waitcnt vmcnt(0)
    v_max3_u32 v58, v16, v17, v18
    v_max3_u32 v60, v20, v21, v22
    v_max_u32 v61, v56, v57
    v_max_u32 v58, v58, v19
    v_max_u32 v60, v60, v23
    v_cmp_eq_u32 s[92:93], -1, v61
    v_cmp_eq_u32 s[4:5], -1, v58
    v_cmp_eq_u32 s[6:7], -1, v60
    s_or_b64 s[94:95], s[92:93], s[4:5]
    s_or_b64 s[94:95], s[94:95], s[6:7]
    s_cbranch_scc1 Sf0m_l
Sf0m_o:
    ds_write_b128 v3, v[16:19] offset:8192
    ds_write_b128 v3, v[20:23] offset:9216
    ds_write_b64 v4, v[56:57]
    v_smfmac_f32_16x16x64_bf16 v[72:75], v[16:19], a[0:7], v5
    v_smfmac_f32_16x16x64_bf16 v[76:79], v[16:19], a[80:87], v5
    s_waitcnt lgkmcnt(0)
    s_barrier
    ds_read_b128 v[24:27], v3 offset:10240
    ds_read_b128 v[28:31], v3 offset:11264
    ds_read_b128 v[32:35], v3 offset:12288
    v_smfmac_f32_16x16x64_bf16 v[72:75], v[20:23], a[8:15], v5
    ds_read_b128 v[36:39], v3 offset:13312
    ds_read_b128 v[40:43], v3 offset:14336
    v_smfmac_f32_16x16x64_bf16 v[76:79], v[20:23], a[88:95], v5
    ds_read_b128 v[44:47], v3 offset:15360
    ds_read_b128 v[48:51], v3 offset:16384
    ds_read_b128 v[52:55], v3 offset:17408
    s_waitcnt lgkmcnt(7)
    v_smfmac_f32_16x16x64_bf16 v[72:75], v[24:27], a[16:23], v5
    v_smfmac_f32_16x16x64_bf16 v[76:79], v[24:27], a[96:103], v5
    s_waitcnt lgkmcnt(6)
    v_smfmac_f32_16x16x64_bf16 v[72:75], v[28:31], a[24:31], v5
    v_smfmac_f32_16x16x64_bf16 v[76:79], v[28:31], a[104:111], v5
    s_waitcnt lgkmcnt(5)
    v_smfmac_f32_16x16x64_bf16 v[72:75], v[32:35], a[32:39], v5
    v_smfmac_f32_16x16x64_bf16 v[76:79], v[32:35], a[112:119], v5
    s_waitcnt lgkmcnt(4)
    v_smfmac_f32_16x16x64_bf16 v[72:75], v[36:39], a[40:47], v5
    v_smfmac_f32_16x16x64_bf16 v[76:79], v[36:39], a[120:127], v5
    s_waitcnt lgkmcnt(3)
    v_smfmac_f32_16x16x64_bf16 v[72:75], v[40:43], a[48:55], v5
    v_smfmac_f32_16x16x64_bf16 v[76:79], v[40:43], a[128:135], v5
    s_waitcnt lgkmcnt(2)
    v_smfmac_f32_16x16x64_bf16 v[72:75], v[44:47], a[56:63], v5
    v_smfmac_f32_16x16x64_bf16 v[76:79], v[44:47], a[136:143], v5
    s_waitcnt lgkmcnt(1)
    v_smfmac_f32_16x16x64_bf16 v[72:75], v[48:51], a[64:71], v5
    v_smfmac_f32_16x16x64_bf16 v[76:79], v[48:51], a[144:151], v5
    s_waitcnt lgkmcnt(0)
    v_smfmac_f32_16x16x64_bf16 v[72:75], v[52:55], a[72:79], v5
    v_smfmac_f32_16x16x64_bf16 v[76:79], v[52:55], a[152:159], v5
    s_nop 7
    v_permlane32_swap_b32 v72, v76
    v_permlane32_swap_b32 v73, v77
    v_permlane32_swap_b32 v74, v78
    v_permlane32_swap_b32 v75, v79
    v_pk_add_f32 v[72:73], v[72:73], v[76:77]
    v_pk_add_f32 v[74:75], v[74:75], v[78:79]
    v_cvt_pk_bf16_f32 v94, v72, v73
    v_cvt_pk_bf16_f32 v95, v74, v75
    ds_write_b64 v7, v[94:95]
    s_waitcnt lgkmcnt(0)
    s_barrier
    ds_read_b64_tr_b16 v[120:121], v8 offset:0
    ds_read_b64_tr_b16 v[122:123], v8 offset:640
    ds_read_b64_tr_b16 v[124:125], v8 offset:1280
    ds_read_b64_tr_b16 v[126:127], v8 offset:1920
    s_waitcnt lgkmcnt(2)
    v_mfma_f32_16x16x32_bf16 v[128:131], v[96:99], v[120:123], 0
    s_waitcnt lgkmcnt(0)
    v_mfma_f32_16x16x32_bf16 v[128:131], v[100:103], v[124:127], v[128:131]
    s_nop 7
    buffer_store_dwordx4 v[128:131], v64, s[8:11], s25 offen offset:0
    s_branch Sf_qj
Sf_q1:
    s_mov_b64 s[4:5], -1
    s_mov_b64 s[6:7], -1
    s_mov_b64 s[92:93], -1
    s_mov_b32 s31, -1
Sf1m_l:
    s_mov_b64 exec, s[4:5]
    buffer_load_dwordx4 v[16:19], v3, s[8:11], s38 offen offset:0 sc1
    s_mov_b64 exec, s[6:7]
    buffer_load_dwordx4 v[20:23], v3, s[8:11], s38 offen offset:1024 sc1
    s_mov_b64 exec, s[92:93]
    buffer_load_dwordx2 v[56:57], v4, s[8:11], s39 offen offset:0 sc1
    s_mov_b64 exec, -1
    s_add_u32 s31, s31, 1
    s_cmp_lt_u32 s31, s30
    s_cselect_b32 s30, s30, 1
    s_cbranch_scc0 Sf1m_o
    s_waitcnt vmcnt(0)
    v_max3_u32 v58, v16, v17, v18
    v_max3_u32 v60, v20, v21, v22
    v_max_u32 v61, v56, v57
    v_max_u32 v58, v58, v19
    v_max_u32 v60, v60, v23
    v_cmp_eq_u32 s[92:93], -1, v61
    v_cmp_eq_u32 s[4:5], -1, v58
    v_cmp_eq_u32 s[6:7], -1, v60
    s_or_b64 s[94:95], s[92:93], s[4:5]
    s_or_b64 s[94:95], s[94:95], s[6:7]
    s_cbranch_scc1 Sf1m_l
Sf1m_o:
    ds_write_b128 v3, v[16:19] offset:8192
    ds_write_b128 v3, v[20:23] offset:9216
    ds_write_b64 v4, v[56:57]
    v_smfmac_f32_16x16x64_bf16 v[72:75], v[16:19], a[16:23], v5
    v_smfmac_f32_16x16x64_bf16 v[76:79], v[16:19], a[96:103], v5
    s_waitcnt lgkmcnt(0)
    s_barrier
    ds_read_b128 v[24:27], v3 offset:10240
    ds_read_b128 v[28:31], v3 offset:11264
    ds_read_b128 v[32:35], v3 offset:12288
    v_smfmac_f32_16x16x64_bf16 v[72:75], v[20:23], a[24:31], v5
    ds_read_b128 v[36:39], v3 offset:13312
    ds_read_b128 v[40:43], v3 offset:6144
    v_smfmac_f32_16x16x64_bf16 v[76:79], v[20:23], a[104:111], v5
    ds_read_b128 v[44:47], v3 offset:7168
    ds_read_b128 v[48:51], v3 offset:14336
    ds_read_b128 v[52:55], v3 offset:15360
    s_waitcnt lgkmcnt(7)
    v_smfmac_f32_16x16x64_bf16 v[72:75], v[24:27], a[32:39], v5
    v_smfmac_f32_16x16x64_bf16 v[76:79], v[24:27], a[112:119], v5
    s_waitcnt lgkmcnt(6)
    v_smfmac_f32_16x16x64_bf16 v[72:75], v[28:31], a[40:47], v5
    v_smfmac_f32_16x16x64_bf16 v[76:79], v[28:31], a[120:127], v5
    s_waitcnt lgkmcnt(5)
    v_smfmac_f32_16x16x64_bf16 v[72:75], v[32:35], a[48:55], v5
    v_smfmac_f32_16x16x64_bf16 v[76:79], v[32:35], a[128:135], v5
    s_waitcnt lgkmcnt(4)
    v_smfmac_f32_16x16x64_bf16 v[72:75], v[36:39], a[56:63], v5
    v_smfmac_f32_16x16x64_bf16 v[76:79], v[36:39], a[136:143], v5
    s_waitcnt lgkmcnt(3)
    v_smfmac_f32_16x16x64_bf16 v[72:75], v[40:43], a[0:7], v5
    v_smfmac_f32_16x16x64_bf16 v[76:79], v[40:43], a[80:87], v5
    s_waitcnt lgkmcnt(2)
    v_smfmac_f32_16x16x64_bf16 v[72:75], v[44:47], a[8:15], v5
    v_smfmac_f32_16x16x64_bf16 v[76:79], v[44:47], a[88:95], v5
    s_waitcnt lgkmcnt(1)
    v_smfmac_f32_16x16x64_bf16 v[72:75], v[48:51], a[64:71], v5
    v_smfmac_f32_16x16x64_bf16 v[76:79], v[48:51], a[144:151], v5
    s_waitcnt lgkmcnt(0)
    v_smfmac_f32_16x16x64_bf16 v[72:75], v[52:55], a[72:79], v5
    v_smfmac_f32_16x16x64_bf16 v[76:79], v[52:55], a[152:159], v5
    s_nop 7
    v_permlane32_swap_b32 v72, v76
    v_permlane32_swap_b32 v73, v77
    v_permlane32_swap_b32 v74, v78
    v_permlane32_swap_b32 v75, v79
    v_pk_add_f32 v[72:73], v[72:73], v[76:77]
    v_pk_add_f32 v[74:75], v[74:75], v[78:79]
    v_cvt_pk_bf16_f32 v94, v72, v73
    v_cvt_pk_bf16_f32 v95, v74, v75
    ds_write_b64 v7, v[94:95]
    s_waitcnt lgkmcnt(0)
    s_barrier
    ds_read_b64_tr_b16 v[120:121], v8 offset:0
    ds_read_b64_tr_b16 v[122:123], v8 offset:640
    ds_read_b64_tr_b16 v[124:125], v8 offset:1280
    ds_read_b64_tr_b16 v[126:127], v8 offset:1920
    s_waitcnt lgkmcnt(2)
    v_mfma_f32_16x16x32_bf16 v[128:131], v[96:99], v[120:123], 0
    s_waitcnt lgkmcnt(0)
    v_mfma_f32_16x16x32_bf16 v[128:131], v[100:103], v[124:127], v[128:131]
    s_nop 7
    buffer_store_dwordx4 v[128:131], v64, s[8:11], s25 offen offset:0
    s_branch Sf_qj
Sf_q2:
    s_mov_b64 s[4:5], -1
    s_mov_b64 s[6:7], -1
    s_mov_b64 s[92:93], -1
    s_mov_b32 s31, -1
Sf2m_l:
    s_mov_b64 exec, s[4:5]
    buffer_load_dwordx4 v[16:19], v3, s[8:11], s38 offen offset:0 sc1
    s_mov_b64 exec, s[6:7]
    buffer_load_dwordx4 v[20:23], v3, s[8:11], s38 offen offset:1024 sc1
    s_mov_b64 exec, s[92:93]
    buffer_load_dwordx2 v[56:57], v4, s[8:11], s39 offen offset:0 sc1
    s_mov_b64 exec, -1
    s_add_u32 s31, s31, 1
    s_cmp_lt_u32 s31, s30
    s_cselect_b32 s30, s30, 1
    s_cbranch_scc0 Sf2m_o
    s_waitcnt vmcnt(0)
    v_max3_u32 v58, v16, v17, v18
    v_max3_u32 v60, v20, v21, v22
    v_max_u32 v61, v56, v57
    v_max_u32 v58, v58, v19
    v_max_u32 v60, v60, v23
    v_cmp_eq_u32 s[92:93], -1, v61
    v_cmp_eq_u32 s[4:5], -1, v58
    v_cmp_eq_u32 s[6:7], -1, v60
    s_or_b64 s[94:95], s[92:93], s[4:5]
    s_or_b64 s[94:95], s[94:95], s[6:7]
    s_cbranch_scc1 Sf2m_l
Sf2m_o:
    ds_write_b128 v3, v[16:19] offset:8192
    ds_write_b128 v3, v[20:23] offset:9216
    ds_write_b64 v4, v[56:57]
    v_smfmac_f32_16x16x64_bf16 v[72:75], v[16:19], a[32:39], v5
    v_smfmac_f32_16x16x64_bf16 v[76:79], v[16:19], a[112:119], v5
    s_waitcnt lgkmcnt(0)
    s_barrier
    ds_read_b128 v[24:27], v3 offset:10240
    ds_read_b128 v[28:31], v3 offset:11264
    ds_read_b128 v[32:35], v3 offset:4096
    v_smfmac_f32_16x16x64_bf16 v[72:75], v[20:23], a[40:47], v5
    ds_read_b128 v[36:39], v3 offset:5120
    ds_read_b128 v[40:43], v3 offset:6144
    v_smfmac_f32_16x16x64_bf16 v[76:79], v[20:23], a[120:127], v5
    ds_read_b128 v[44:47], v3 offset:7168
    ds_read_b128 v[48:51], v3 offset:12288
    ds_read_b128 v[52:55], v3 offset:13312
    s_waitcnt lgkmcnt(7)
    v_smfmac_f32_16x16x64_bf16 v[72:75], v[24:27], a[48:55], v5
    v_smfmac_f32_16x16x64_bf16 v[76:79], v[24:27], a[128:135], v5
    s_waitcnt lgkmcnt(6)
    v_smfmac_f32_16x16x64_bf16 v[72:75], v[28:31], a[56:63], v5
    v_smfmac_f32_16x16x64_bf16 v[76:79], v[28:31], a[136:143], v5
    s_waitcnt lgkmcnt(5)
    v_smfmac_f32_16x16x64_bf16 v[72:75], v[32:35], a[0:7], v5
    v_smfmac_f32_16x16x64_bf16 v[76:79], v[32:35], a[80:87], v5
    s_waitcnt lgkmcnt(4)
    v_smfmac_f32_16x16x64_bf16 v[72:75], v[36:39], a[8:15], v5
    v_smfmac_f32_16x16x64_bf16 v[76:79], v[36:39], a[88:95], v5
    s_waitcnt lgkmcnt(3)
    v_smfmac_f32_16x16x64_bf16 v[72:75], v[40:43], a[16:23], v5
    v_smfmac_f32_16x16x64_bf16 v[76:79], v[40:43], a[96:103], v5
    s_waitcnt lgkmcnt(2)
    v_smfmac_f32_16x16x64_bf16 v[72:75], v[44:47], a[24:31], v5
    v_smfmac_f32_16x16x64_bf16 v[76:79], v[44:47], a[104:111], v5
    s_waitcnt lgkmcnt(1)
    v_smfmac_f32_16x16x64_bf16 v[72:75], v[48:51], a[64:71], v5
    v_smfmac_f32_16x16x64_bf16 v[76:79], v[48:51], a[144:151], v5
    s_waitcnt lgkmcnt(0)
    v_smfmac_f32_16x16x64_bf16 v[72:75], v[52:55], a[72:79], v5
    v_smfmac_f32_16x16x64_bf16 v[76:79], v[52:55], a[152:159], v5
    s_nop 7
    v_permlane32_swap_b32 v72, v76
    v_permlane32_swap_b32 v73, v77
    v_permlane32_swap_b32 v74, v78
    v_permlane32_swap_b32 v75, v79
    v_pk_add_f32 v[72:73], v[72:73], v[76:77]
    v_pk_add_f32 v[74:75], v[74:75], v[78:79]
    v_cvt_pk_bf16_f32 v94, v72, v73
    v_cvt_pk_bf16_f32 v95, v74, v75
    ds_write_b64 v7, v[94:95]
    s_waitcnt lgkmcnt(0)
    s_barrier
    ds_read_b64_tr_b16 v[120:121], v8 offset:0
    ds_read_b64_tr_b16 v[112:113], v6 offset:16
    ds_read_b64_tr_b16 v[122:123], v8 offset:640
    ds_read_b64_tr_b16 v[114:115], v6 offset:656
    ds_read_b64_tr_b16 v[124:125], v8 offset:1280
    ds_read_b64_tr_b16 v[116:117], v6 offset:1296
    ds_read_b64_tr_b16 v[126:127], v8 offset:1920
    ds_read_b64_tr_b16 v[118:119], v6 offset:1936
    s_waitcnt lgkmcnt(4)
    v_mfma_f32_16x16x32_bf16 v[128:131], v[112:115], v[120:123], 0
    s_waitcnt lgkmcnt(0)
    v_mfma_f32_16x16x32_bf16 v[128:131], v[116:119], v[124:127], v[128:131]
    s_nop 7
    v_cndmask_b32 v128, v128, v129, s[40:41]
    v_cndmask_b32 v130, v130, v131, s[40:41]
    v_cndmask_b32 v128, v128, v130, s[90:91]
    buffer_store_dword v128, v65, s[8:11], s25 offen offset:0
    s_branch Sf_qj
Sf_q3:
    s_mov_b64 s[4:5], -1
    s_mov_b64 s[6:7], -1
    s_mov_b64 s[92:93], -1
    s_mov_b32 s31, -1
Sf3m_l:
    s_mov_b64 exec, s[4:5]
    buffer_load_dwordx4 v[16:19], v3, s[8:11], s38 offen offset:0 sc1
    s_mov_b64 exec, s[6:7]
    buffer_load_dwordx4 v[20:23], v3, s[8:11], s38 offen offset:1024 sc1
    s_mov_b64 exec, s[92:93]
    buffer_load_dwordx2 v[56:57], v4, s[8:11], s39 offen offset:0 sc1
    s_mov_b64 exec, -1
    s_add_u32 s31, s31, 1
    s_cmp_lt_u32 s31, s30
    s_cselect_b32 s30, s30, 1
    s_cbranch_scc0 Sf3m_o
    s_waitcnt vmcnt(0)
    v_max3_u32 v58, v16, v17, v18
    v_max3_u32 v60, v20, v21, v22
    v_max_u32 v61, v56, v57
    v_max_u32 v58, v58, v19
    v_max_u32 v60, v60, v23
    v_cmp_eq_u32 s[92:93], -1, v61
    v_cmp_eq_u32 s[4:5], -1, v58
    v_cmp_eq_u32 s[6:7], -1, v60
    s_or_b64 s[94:95], s[92:93], s[4:5]
    s_or_b64 s[94:95], s[94:95], s[6:7]
    s_cbranch_scc1 Sf3m_l
Sf3m_o:
    ds_write_b128 v3, v[16:19] offset:8192
    ds_write_b128 v3, v[20:23] offset:9216
    ds_write_b64 v4, v[56:57]
    v_smfmac_f32_16x16x64_bf16 v[72:75], v[16:19], a[48:55], v5
    v_smfmac_f32_16x16x64_bf16 v[76:79], v[16:19], a[128:135], v5
    s_waitcnt lgkmcnt(0)
    s_barrier
    ds_read_b128 v[24:27], v3 offset:2048
    ds_read_b128 v[28:31], v3 offset:3072
    ds_read_b128 v[32:35], v3 offset:4096
    v_smfmac_f32_16x16x64_bf16 v[72:75], v[20:23], a[56:63], v5
    ds_read_b128 v[36:39], v3 offset:5120
    ds_read_b128 v[40:43], v3 offset:6144
    v_smfmac_f32_16x16x64_bf16 v[76:79], v[20:23], a[136:143], v5
    ds_read_b128 v[44:47], v3 offset:7168
    ds_read_b128 v[48:51], v3 offset:10240
    ds_read_b128 v[52:55], v3 offset:11264
    s_waitcnt lgkmcnt(7)
    v_smfmac_f32_16x16x64_bf16 v[72:75], v[24:27], a[0:7], v5
    v_smfmac_f32_16x16x64_bf16 v[76:79], v[24:27], a[80:87], v5
    s_waitcnt lgkmcnt(6)
    v_smfmac_f32_16x16x64_bf16 v[72:75], v[28:31], a[8:15], v5
    v_smfmac_f32_16x16x64_bf16 v[76:79], v[28:31], a[88:95], v5
    s_waitcnt lgkmcnt(5)
    v_smfmac_f32_16x16x64_bf16 v[72:75], v[32:35], a[16:23], v5
    v_smfmac_f32_16x16x64_bf16 v[76:79], v[32:35], a[96:103], v5
    s_waitcnt lgkmcnt(4)
    v_smfmac_f32_16x16x64_bf16 v[72:75], v[36:39], a[24:31], v5
    v_smfmac_f32_16x16x64_bf16 v[76:79], v[36:39], a[104:111], v5
    s_waitcnt lgkmcnt(3)
    v_smfmac_f32_16x16x64_bf16 v[72:75], v[40:43], a[32:39], v5
    v_smfmac_f32_16x16x64_bf16 v[76:79], v[40:43], a[112:119], v5
    s_waitcnt lgkmcnt(2)
    v_smfmac_f32_16x16x64_bf16 v[72:75], v[44:47], a[40:47], v5
    v_smfmac_f32_16x16x64_bf16 v[76:79], v[44:47], a[120:127], v5
    s_waitcnt lgkmcnt(1)
    v_smfmac_f32_16x16x64_bf16 v[72:75], v[48:51], a[64:71], v5
    buffer_store_dword v59, v14, s[8:11], s44 offen offset:0
    v_smfmac_f32_16x16x64_bf16 v[76:79], v[48:51], a[144:151], v5
    s_waitcnt lgkmcnt(0)
    v_smfmac_f32_16x16x64_bf16 v[72:75], v[52:55], a[72:79], v5
    v_smfmac_f32_16x16x64_bf16 v[76:79], v[52:55], a[152:159], v5
    s_nop 7
    v_permlane32_swap_b32 v72, v76
    v_permlane32_swap_b32 v73, v77
    v_permlane32_swap_b32 v74, v78
    v_permlane32_swap_b32 v75, v79
    v_pk_add_f32 v[72:73], v[72:73], v[76:77]
    v_pk_add_f32 v[74:75], v[74:75], v[78:79]
    v_cvt_pk_bf16_f32 v94, v72, v73
    v_cvt_pk_bf16_f32 v95, v74, v75
    ds_write_b64 v7, v[94:95]
    s_waitcnt lgkmcnt(0)
    s_barrier
    ds_read_b64_tr_b16 v[112:113], v6 offset:16
    ds_read_b64_tr_b16 v[114:115], v6 offset:656
    ds_read_b64_tr_b16 v[116:117], v6 offset:1296
    ds_read_b64_tr_b16 v[118:119], v6 offset:1936
    s_waitcnt lgkmcnt(2)
    v_mfma_f32_16x16x32_bf16 v[128:131], v[112:115], v[96:99], 0
    v_mfma_f32_16x16x32_bf16 v[132:135], v[112:115], v[104:107], 0
    s_waitcnt lgkmcnt(0)
    v_mfma_f32_16x16x32_bf16 v[128:131], v[116:119], v[100:103], v[128:131]
    v_mfma_f32_16x16x32_bf16 v[132:135], v[116:119], v[108:111], v[132:135]
    s_nop 7
    s_mov_b32 exec_lo, 0
    v_mov_b32 v128, v132
    v_mov_b32 v129, v133
    v_mov_b32 v130, v134
    v_mov_b32 v131, v135
    s_mov_b32 exec_lo, -1
    buffer_store_dwordx4 v[128:131], v2, s[8:11], s34 offen offset:0
Sf_qj:
    s_cmp_lt_u32 s21, 64
    s_cbranch_scc0 Sf_end
    s_cmp_eq_u32 s32, 14
    s_cbranch_scc0 Sf_h
    s_mov_b32 s31, 0
    s_waitcnt vmcnt(63)
    s_branch SfB1_c
SfB1_l:
    buffer_load_dword v68, v70, s[8:11], s23 offen sc1
    s_waitcnt vmcnt(0)
SfB1_c:
    v_cmp_gt_u32 vcc, 1, v68
    s_cbranch_vccz SfB1_o
    s_sleep 4
    s_add_u32 s31, s31, 1
    s_cmp_lt_u32 s31, s30
    s_cbranch_scc1 SfB1_l
    s_mov_b32 s30, 1
SfB1_o:
Sf_h:
    s_cmp_gt_u32 s32, 3
    s_cbranch_scc1 SfB0_o
    s_cmp_eq_u32 s32, 1
    s_cbranch_scc0 SfBA_o
    s_mov_b32 s31, 0
    s_waitcnt vmcnt(63)
    s_branch SfBA_c
SfBA_l:
    buffer_load_dword v68, v71, s[8:11], s49 offen sc1
    s_waitcnt vmcnt(0)
SfBA_c:
    v_cmp_gt_u32 vcc, 1, v68
    s_cbranch_vccz SfBA_o
    s_sleep 2
    s_add_u32 s31, s31, 1
    s_cmp_lt_u32 s31, s30
    s_cbranch_scc1 SfBA_l
    s_mov_b32 s30, 1
SfBA_o:
    s_cmp_eq_u32 s32, 3
    s_cbranch_scc0 SfB0_o
    s_mov_b32 s31, 0
    s_waitcnt vmcnt(63)
    s_branch SfB0_c
SfB0_l:
    buffer_load_dword v68, v70, s[8:11], s49 offen sc1
    s_waitcnt vmcnt(0)
SfB0_c:
    v_cmp_gt_u32 vcc, 1, v68
    s_cbranch_vccz SfB0_o
    s_sleep 2
    s_add_u32 s31, s31, 1
    s_cmp_lt_u32 s31, s30
    s_cbranch_scc1 SfB0_l
    s_mov_b32 s30, 1
SfB0_o:
    v_add_u32 v11, s29, v2
    s_xor_b32 s29, s29, 40960
    s_add_u32 s42, s29, s27
    ds_read_b128 a[160:163], v11 offset:0
    ds_read_b128 a[164:167], v11 offset:20480
    ds_read_b128 a[168:171], v11 offset:1024
    ds_read_b128 a[172:175], v11 offset:21504
    ds_read_b128 a[176:179], v11 offset:2048
    ds_read_b128 a[180:183], v11 offset:22528
    s_waitcnt lgkmcnt(5)
    v_mfma_f32_16x16x32_bf16 v[144:147], a[0:3], a[160:163], 0
    ds_read_b128 a[184:187], v11 offset:3072
    v_mfma_f32_16x16x32_bf16 v[152:155], a[80:83], a[160:163], 0
    s_waitcnt lgkmcnt(5)
    v_mfma_f32_16x16x32_bf16 v[148:151], a[0:3], a[164:167], 0
    ds_read_b128 a[188:191], v11 offset:23552
    v_mfma_f32_16x16x32_bf16 v[156:159], a[80:83], a[164:167], 0
    s_waitcnt lgkmcnt(5)
    v_mfma_f32_16x16x32_bf16 v[144:147], a[4:7], a[168:171], v[144:147]
    ds_read_b128 a[160:163], v11 offset:4096
    s_add_u32 s35, s28, 0
    s_add_u32 m0, s42, 0
    v_mfma_f32_16x16x32_bf16 v[152:155], a[84:87], a[168:171], v[152:155]
    buffer_load_dwordx4 v2, s[8:11], s35 offen offset:0 sc1 lds
    s_waitcnt lgkmcnt(5)
    v_mfma_f32_16x16x32_bf16 v[148:151], a[4:7], a[172:175], v[148:151]
    ds_read_b128 a[164:167], v11 offset:24576
    v_mfma_f32_16x16x32_bf16 v[156:159], a[84:87], a[172:175], v[156:159]
    s_waitcnt lgkmcnt(5)
    v_mfma_f32_16x16x32_bf16 v[144:147], a[8:11], a[176:179], v[144:147]
    ds_read_b128 a[168:171], v11 offset:5120
    v_mfma_f32_16x16x32_bf16 v[152:155], a[88:91], a[176:179], v[152:155]
    s_waitcnt lgkmcnt(5)
    v_mfma_f32_16x16x32_bf16 v[148:151], a[8:11], a[180:183], v[148:151]
    ds_read_b128 a[172:175], v11 offset:25600
    v_mfma_f32_16x16x32_bf16 v[156:159], a[88:91], a[180:183], v[156:159]
    buffer_load_dwordx4 v2, s[8:11], s35 offen offset:1024 sc1 lds
    s_waitcnt lgkmcnt(5)
    v_mfma_f32_16x16x32_bf16 v[144:147], a[12:15], a[184:187], v[144:147]
    ds_read_b128 a[176:179], v11 offset:6144
    v_mfma_f32_16x16x32_bf16 v[152:155], a[92:95], a[184:187], v[152:155]
    s_waitcnt lgkmcnt(5)
    v_mfma_f32_16x16x32_bf16 v[148:151], a[12:15], a[188:191], v[148:151]
    ds_read_b128 a[180:183], v11 offset:26624
    v_mfma_f32_16x16x32_bf16 v[156:159], a[92:95], a[188:191], v[156:159]
    s_waitcnt vmcnt(2)
    v_mov_b32 v10, s21
    s_mov_b64 exec, 1
    buffer_store_dword v10, v9, s[8:11], s33 offen
    s_mov_b64 exec, -1
    s_waitcnt lgkmcnt(5)
    v_mfma_f32_16x16x32_bf16 v[144:147], a[16:19], a[160:163], v[144:147]
    ds_read_b128 a[184:187], v11 offset:7168
    v_mfma_f32_16x16x32_bf16 v[152:155], a[96:99], a[160:163], v[152:155]
    buffer_load_dwordx4 v2, s[8:11], s35 offen offset:2048 sc1 lds
    s_waitcnt lgkmcnt(5)
    v_mfma_f32_16x16x32_bf16 v[148:151], a[16:19], a[164:167], v[148:151]
    ds_read_b128 a[188:191], v11 offset:27648
    v_mfma_f32_16x16x32_bf16 v[156:159], a[96:99], a[164:167], v[156:159]
    buffer_store_dwordx4 v[240:243], v64, s[8:11], s26 offen offset:0
    s_waitcnt lgkmcnt(5)
    v_mfma_f32_16x16x32_bf16 v[144:147], a[20:23], a[168:171], v[144:147]
    ds_read_b128 a[160:163], v11 offset:8192
    v_mfma_f32_16x16x32_bf16 v[152:155], a[100:103], a[168:171], v[152:155]
    buffer_store_dword v240, v65, s[8:11], s26 offen offset:0
    s_waitcnt lgkmcnt(5)
    v_mfma_f32_16x16x32_bf16 v[148:151], a[20:23], a[172:175], v[148:151]
    ds_read_b128 a[164:167], v11 offset:28672
    v_mfma_f32_16x16x32_bf16 v[156:159], a[100:103], a[172:175], v[156:159]
    buffer_load_dwordx4 v2, s[8:11], s35 offen offset:3072 sc1 lds
    s_waitcnt lgkmcnt(5)
    v_mfma_f32_16x16x32_bf16 v[144:147], a[24:27], a[176:179], v[144:147]
    ds_read_b128 a[168:171], v11 offset:9216
    v_mfma_f32_16x16x32_bf16 v[152:155], a[104:107], a[176:179], v[152:155]
    s_waitcnt lgkmcnt(5)
    v_mfma_f32_16x16x32_bf16 v[148:151], a[24:27], a[180:183], v[148:151]
    ds_read_b128 a[172:175], v11 offset:29696
    v_mfma_f32_16x16x32_bf16 v[156:159], a[104:107], a[180:183], v[156:159]
    s_waitcnt lgkmcnt(5)
    v_mfma_f32_16x16x32_bf16 v[144:147], a[28:31], a[184:187], v[144:147]
    ds_read_b128 a[176:179], v11 offset:10240
    s_add_u32 s35, s28, 4096
    s_add_u32 m0, s42, 4096
    v_mfma_f32_16x16x32_bf16 v[152:155], a[108:111], a[184:187], v[152:155]
    buffer_load_dwordx4 v2, s[8:11], s35 offen offset:0 sc1 lds
    s_waitcnt lgkmcnt(5)
    v_mfma_f32_16x16x32_bf16 v[148:151], a[28:31], a[188:191], v[148:151]
    ds_read_b128 a[180:183], v11 offset:30720
    v_mfma_f32_16x16x32_bf16 v[156:159], a[108:111], a[188:191], v[156:159]
    s_waitcnt lgkmcnt(5)
    v_mfma_f32_16x16x32_bf16 v[144:147], a[32:35], a[160:163], v[144:147]
    ds_read_b128 a[184:187], v11 offset:11264
    v_mfma_f32_16x16x32_bf16 v[152:155], a[112:115], a[160:163], v[152:155]
    s_waitcnt lgkmcnt(5)
    v_mfma_f32_16x16x32_bf16 v[148:151], a[32:35], a[164:167], v[148:151]
    ds_read_b128 a[188:191], v11 offset:31744
    v_mfma_f32_16x16x32_bf16 v[156:159], a[112:115], a[164:167], v[156:159]
    buffer_load_dwordx4 v2, s[8:11], s35 offen offset:1024 sc1 lds
    s_waitcnt lgkmcnt(5)
    v_mfma_f32_16x16x32_bf16 v[144:147], a[36:39], a[168:171], v[144:147]
    ds_read_b128 a[160:163], v11 offset:12288
    v_mfma_f32_16x16x32_bf16 v[152:155], a[116:119], a[168:171], v[152:155]
    s_sub_u32 s4, s21, 8
    s_cmp_lt_u32 s4, s45
    s_cselect_b64 exec, -1, 0
    s_lshl_b32 s4, s21, 19
    s_add_u32 s4, s4, s46
    buffer_store_dwordx4 v[240:243], v2, s[8:11], s4 offen offset:0 sc1
    s_mov_b64 exec, -1
    s_waitcnt lgkmcnt(5)
    v_mfma_f32_16x16x32_bf16 v[148:151], a[36:39], a[172:175], v[148:151]
    ds_read_b128 a[164:167], v11 offset:32768
    v_mfma_f32_16x16x32_bf16 v[156:159], a[116:119], a[172:175], v[156:159]
    s_cmp_eq_u32 s21, s88
    s_cselect_b64 exec, -1, 0
    buffer_store_dwordx4 v[240:243], v2, s[8:11], s89 offen offset:0 sc1
    s_mov_b64 exec, -1
    s_waitcnt lgkmcnt(5)
    v_mfma_f32_16x16x32_bf16 v[144:147], a[40:43], a[176:179], v[144:147]
    ds_read_b128 a[168:171], v11 offset:13312
    v_mfma_f32_16x16x32_bf16 v[152:155], a[120:123], a[176:179], v[152:155]
    buffer_load_dwordx4 v2, s[8:11], s35 offen offset:2048 sc1 lds
    s_waitcnt lgkmcnt(5)
    v_mfma_f32_16x16x32_bf16 v[148:151], a[40:43], a[180:183], v[148:151]
    ds_read_b128 a[172:175], v11 offset:33792
    v_mfma_f32_16x16x32_bf16 v[156:159], a[120:123], a[180:183], v[156:159]
    s_waitcnt lgkmcnt(5)
    v_mfma_f32_16x16x32_bf16 v[144:147], a[44:47], a[184:187], v[144:147]
    ds_read_b128 a[176:179], v11 offset:14336
    v_mfma_f32_16x16x32_bf16 v[152:155], a[124:127], a[184:187], v[152:155]
    s_waitcnt lgkmcnt(5)
    v_mfma_f32_16x16x32_bf16 v[148:151], a[44:47], a[188:191], v[148:151]
    ds_read_b128 a[180:183], v11 offset:34816
    v_mfma_f32_16x16x32_bf16 v[156:159], a[124:127], a[188:191], v[156:159]
    buffer_load_dwordx4 v2, s[8:11], s35 offen offset:3072 sc1 lds
    s_waitcnt lgkmcnt(5)
    v_mfma_f32_16x16x32_bf16 v[144:147], a[48:51], a[160:163], v[144:147]
    ds_read_b128 a[184:187], v11 offset:15360
    v_mfma_f32_16x16x32_bf16 v[152:155], a[128:131], a[160:163], v[152:155]
    s_waitcnt lgkmcnt(5)
    v_mfma_f32_16x16x32_bf16 v[148:151], a[48:51], a[164:167], v[148:151]
    ds_read_b128 a[188:191], v11 offset:35840
    v_mfma_f32_16x16x32_bf16 v[156:159], a[128:131], a[164:167], v[156:159]
    s_waitcnt lgkmcnt(5)
    v_mfma_f32_16x16x32_bf16 v[144:147], a[52:55], a[168:171], v[144:147]
    ds_read_b128 a[160:163], v11 offset:16384
    s_add_u32 s35, s28, 8192
    s_add_u32 m0, s42, 8192
    v_mfma_f32_16x16x32_bf16 v[152:155], a[132:135], a[168:171], v[152:155]
    buffer_load_dwordx4 v2, s[8:11], s35 offen offset:0 sc1 lds
    s_waitcnt lgkmcnt(5)
    v_mfma_f32_16x16x32_bf16 v[148:151], a[52:55], a[172:175], v[148:151]
    ds_read_b128 a[164:167], v11 offset:36864
    v_mfma_f32_16x16x32_bf16 v[156:159], a[132:135], a[172:175], v[156:159]
    s_waitcnt lgkmcnt(5)
    v_mfma_f32_16x16x32_bf16 v[144:147], a[56:59], a[176:179], v[144:147]
    ds_read_b128 a[168:171], v11 offset:17408
    v_mfma_f32_16x16x32_bf16 v[152:155], a[136:139], a[176:179], v[152:155]
    s_waitcnt lgkmcnt(5)
    v_mfma_f32_16x16x32_bf16 v[148:151], a[56:59], a[180:183], v[148:151]
    ds_read_b128 a[172:175], v11 offset:37888
    v_mfma_f32_16x16x32_bf16 v[156:159], a[136:139], a[180:183], v[156:159]
    buffer_load_dwordx4 v2, s[8:11], s35 offen offset:1024 sc1 lds
    s_waitcnt lgkmcnt(5)
    v_mfma_f32_16x16x32_bf16 v[144:147], a[60:63], a[184:187], v[144:147]
    ds_read_b128 a[176:179], v11 offset:18432
    v_mfma_f32_16x16x32_bf16 v[152:155], a[140:143], a[184:187], v[152:155]
    s_waitcnt lgkmcnt(5)
    v_mfma_f32_16x16x32_bf16 v[148:151], a[60:63], a[188:191], v[148:151]
    ds_read_b128 a[180:183], v11 offset:38912
    v_mfma_f32_16x16x32_bf16 v[156:159], a[140:143], a[188:191], v[156:159]
    s_waitcnt lgkmcnt(5)
    v_mfma_f32_16x16x32_bf16 v[144:147], a[64:67], a[160:163], v[144:147]
    ds_read_b128 a[184:187], v11 offset:19456
    v_mfma_f32_16x16x32_bf16 v[152:155], a[144:147], a[160:163], v[152:155]
    s_waitcnt lgkmcnt(5)
    v_mfma_f32_16x16x32_bf16 v[148:151], a[64:67], a[164:167], v[148:151]
    ds_read_b128 a[188:191], v11 offset:39936
    v_mfma_f32_16x16x32_bf16 v[156:159], a[144:147], a[164:167], v[156:159]
    s_waitcnt lgkmcnt(5)
    v_mfma_f32_16x16x32_bf16 v[144:147], a[68:71], a[168:171], v[144:147]
    v_mfma_f32_16x16x32_bf16 v[152:155], a[148:151], a[168:171], v[152:155]
    s_waitcnt lgkmcnt(4)
    v_mfma_f32_16x16x32_bf16 v[148:151], a[68:71], a[172:175], v[148:151]
    v_mfma_f32_16x16x32_bf16 v[156:159], a[148:151], a[172:175], v[156:159]
    s_waitcnt lgkmcnt(3)
    v_mfma_f32_16x16x32_bf16 v[144:147], a[72:75], a[176:179], v[144:147]
    v_mfma_f32_16x16x32_bf16 v[152:155], a[152:155], a[176:179], v[152:155]
    s_waitcnt lgkmcnt(2)
    v_mfma_f32_16x16x32_bf16 v[148:151], a[72:75], a[180:183], v[148:151]
    v_mfma_f32_16x16x32_bf16 v[156:159], a[152:155], a[180:183], v[156:159]
    s_waitcnt lgkmcnt(1)
    v_mfma_f32_16x16x32_bf16 v[144:147], a[76:79], a[184:187], v[144:147]
    v_mfma_f32_16x16x32_bf16 v[152:155], a[156:159], a[184:187], v[152:155]
    s_waitcnt lgkmcnt(0)
    v_mfma_f32_16x16x32_bf16 v[148:151], a[76:79], a[188:191], v[148:151]
    v_mfma_f32_16x16x32_bf16 v[156:159], a[156:159], a[188:191], v[156:159]
    s_add_u32 s28, s28, 40960
    s_add_u32 s32, s32, 1
    s_cmp_eq_u32 s32, 3
    s_cbranch_scc0 Sf_n3
    buffer_load_dword v68, v70, s[8:11], s49 offen offset:0 sc1
Sf_n3:
    s_cmp_eq_u32 s32, 12
    s_cbranch_scc0 Sf_n12
    buffer_load_dword v68, v70, s[8:11], s23 offen offset:0 sc1
Sf_n12:
    v_cvt_pk_bf16_f32 v160, v144, v145
    v_cvt_pk_bf16_f32 v161, v146, v147
    ds_write_b64 v12, v[160:161] offset:0
    v_cvt_pk_bf16_f32 v162, v148, v149
    v_cvt_pk_bf16_f32 v163, v150, v151
    ds_write_b64 v12, v[162:163] offset:2048
    v_cvt_pk_bf16_f32 v164, v152, v153
    v_cvt_pk_bf16_f32 v165, v154, v155
    ds_write_b64 v12, v[164:165] offset:4096
    v_cvt_pk_bf16_f32 v166, v156, v157
    v_cvt_pk_bf16_f32 v167, v158, v159
    ds_write_b64 v12, v[166:167] offset:6144
    s_and_b32 s4, s21, 3
    s_lshl_b32 s4, s4, 16
    s_add_u32 s34, s36, s4
    s_waitcnt lgkmcnt(0)
    s_barrier
    ds_read_b128 v[96:99], v15 offset:0
    ds_read_b128 v[104:107], v62 offset:0
    ds_read_b128 v[100:103], v15 offset:1024
    ds_read_b128 v[108:111], v62 offset:1024
    s_waitcnt lgkmcnt(2)
    v_mfma_f32_16x16x32_bf16 v[128:131], v[96:99], v[104:107], 0
    s_waitcnt lgkmcnt(0)
    v_mfma_f32_16x16x32_bf16 v[128:131], v[100:103], v[108:111], v[128:131]
    s_nop 7
    buffer_store_dwordx4 v[128:131], v63, s[8:11], s34 offen offset:0
    s_branch Sf_loop
Sf_end:
    s_waitcnt vmcnt(0)
    v_mov_b32 v10, s21
    s_mov_b64 exec, 1
    buffer_store_dword v10, v9, s[8:11], s33 offen
    s_mov_b64 exec, -1
    s_branch R_done
Ss_go:
    s_waitcnt vmcnt(0)
    s_barrier
    v_add_u32 v11, s29, v2
    s_xor_b32 s29, s29, 40960
    s_add_u32 s42, s29, s27
    ds_read_b128 a[160:163], v11 offset:0
    ds_read_b128 a[164:167], v11 offset:20480
    ds_read_b128 a[168:171], v11 offset:1024
    ds_read_b128 a[172:175], v11 offset:21504
    ds_read_b128 a[176:179], v11 offset:2048
    ds_read_b128 a[180:183], v11 offset:22528
    s_waitcnt lgkmcnt(5)
    v_mfma_f32_16x16x32_bf16 v[144:147], a[0:3], a[160:163], 0
    ds_read_b128 a[184:187], v11 offset:3072
    v_mfma_f32_16x16x32_bf16 v[152:155], a[80:83], a[160:163], 0
    s_waitcnt lgkmcnt(5)
    v_mfma_f32_16x16x32_bf16 v[148:151], a[0:3], a[164:167], 0
    ds_read_b128 a[188:191], v11 offset:23552
    v_mfma_f32_16x16x32_bf16 v[156:159], a[80:83], a[164:167], 0
    s_waitcnt lgkmcnt(5)
    v_mfma_f32_16x16x32_bf16 v[144:147], a[4:7], a[168:171], v[144:147]
    ds_read_b128 a[160:163], v11 offset:4096
    s_add_u32 s35, s28, 0
    s_add_u32 m0, s42, 0
    v_mfma_f32_16x16x32_bf16 v[152:155], a[84:87], a[168:171], v[152:155]
    buffer_load_dwordx4 v2, s[8:11], s35 offen offset:0 sc1 lds
    s_waitcnt lgkmcnt(5)
    v_mfma_f32_16x16x32_bf16 v[148:151], a[4:7], a[172:175], v[148:151]
    ds_read_b128 a[164:167], v11 offset:24576
    v_mfma_f32_16x16x32_bf16 v[156:159], a[84:87], a[172:175], v[156:159]
    s_waitcnt lgkmcnt(5)
    v_mfma_f32_16x16x32_bf16 v[144:147], a[8:11], a[176:179], v[144:147]
    ds_read_b128 a[168:171], v11 offset:5120
    v_mfma_f32_16x16x32_bf16 v[152:155], a[88:91], a[176:179], v[152:155]
    s_waitcnt lgkmcnt(5)
    v_mfma_f32_16x16x32_bf16 v[148:151], a[8:11], a[180:183], v[148:151]
    ds_read_b128 a[172:175], v11 offset:25600
    v_mfma_f32_16x16x32_bf16 v[156:159], a[88:91], a[180:183], v[156:159]
    buffer_load_dwordx4 v2, s[8:11], s35 offen offset:1024 sc1 lds
    s_waitcnt lgkmcnt(5)
    v_mfma_f32_16x16x32_bf16 v[144:147], a[12:15], a[184:187], v[144:147]
    ds_read_b128 a[176:179], v11 offset:6144
    v_mfma_f32_16x16x32_bf16 v[152:155], a[92:95], a[184:187], v[152:155]
    s_waitcnt lgkmcnt(5)
    v_mfma_f32_16x16x32_bf16 v[148:151], a[12:15], a[188:191], v[148:151]
    ds_read_b128 a[180:183], v11 offset:26624
    v_mfma_f32_16x16x32_bf16 v[156:159], a[92:95], a[188:191], v[156:159]
    s_waitcnt lgkmcnt(5)
    v_mfma_f32_16x16x32_bf16 v[144:147], a[16:19], a[160:163], v[144:147]
    ds_read_b128 a[184:187], v11 offset:7168
    v_mfma_f32_16x16x32_bf16 v[152:155], a[96:99], a[160:163], v[152:155]
    buffer_load_dwordx4 v2, s[8:11], s35 offen offset:2048 sc1 lds
    s_waitcnt lgkmcnt(5)
    v_mfma_f32_16x16x32_bf16 v[148:151], a[16:19], a[164:167], v[148:151]
    ds_read_b128 a[188:191], v11 offset:27648
    v_mfma_f32_16x16x32_bf16 v[156:159], a[96:99], a[164:167], v[156:159]
    s_waitcnt lgkmcnt(5)
    v_mfma_f32_16x16x32_bf16 v[144:147], a[20:23], a[168:171], v[144:147]
    ds_read_b128 a[160:163], v11 offset:8192
    v_mfma_f32_16x16x32_bf16 v[152:155], a[100:103], a[168:171], v[152:155]
    s_waitcnt lgkmcnt(5)
    v_mfma_f32_16x16x32_bf16 v[148:151], a[20:23], a[172:175], v[148:151]
    ds_read_b128 a[164:167], v11 offset:28672
    v_mfma_f32_16x16x32_bf16 v[156:159], a[100:103], a[172:175], v[156:159]
    buffer_load_dwordx4 v2, s[8:11], s35 offen offset:3072 sc1 lds
    s_waitcnt lgkmcnt(5)
    v_mfma_f32_16x16x32_bf16 v[144:147], a[24:27], a[176:179], v[144:147]
    ds_read_b128 a[168:171], v11 offset:9216
    v_mfma_f32_16x16x32_bf16 v[152:155], a[104:107], a[176:179], v[152:155]
    s_waitcnt lgkmcnt(5)
    v_mfma_f32_16x16x32_bf16 v[148:151], a[24:27], a[180:183], v[148:151]
    ds_read_b128 a[172:175], v11 offset:29696
    v_mfma_f32_16x16x32_bf16 v[156:159], a[104:107], a[180:183], v[156:159]
    s_waitcnt lgkmcnt(5)
    v_mfma_f32_16x16x32_bf16 v[144:147], a[28:31], a[184:187], v[144:147]
    ds_read_b128 a[176:179], v11 offset:10240
    s_add_u32 s35, s28, 4096
    s_add_u32 m0, s42, 4096
    v_mfma_f32_16x16x32_bf16 v[152:155], a[108:111], a[184:187], v[152:155]
    buffer_load_dwordx4 v2, s[8:11], s35 offen offset:0 sc1 lds
    s_waitcnt lgkmcnt(5)
    v_mfma_f32_16x16x32_bf16 v[148:151], a[28:31], a[188:191], v[148:151]
    ds_read_b128 a[180:183], v11 offset:30720
    v_mfma_f32_16x16x32_bf16 v[156:159], a[108:111], a[188:191], v[156:159]
    s_waitcnt lgkmcnt(5)
    v_mfma_f32_16x16x32_bf16 v[144:147], a[32:35], a[160:163], v[144:147]
    ds_read_b128 a[184:187], v11 offset:11264
    v_mfma_f32_16x16x32_bf16 v[152:155], a[112:115], a[160:163], v[152:155]
    s_waitcnt lgkmcnt(5)
    v_mfma_f32_16x16x32_bf16 v[148:151], a[32:35], a[164:167], v[148:151]
    ds_read_b128 a[188:191], v11 offset:31744
    v_mfma_f32_16x16x32_bf16 v[156:159], a[112:115], a[164:167], v[156:159]
    buffer_load_dwordx4 v2, s[8:11], s35 offen offset:1024 sc1 lds
    s_waitcnt lgkmcnt(5)
    v_mfma_f32_16x16x32_bf16 v[144:147], a[36:39], a[168:171], v[144:147]
    ds_read_b128 a[160:163], v11 offset:12288
    v_mfma_f32_16x16x32_bf16 v[152:155], a[116:119], a[168:171], v[152:155]
    s_waitcnt lgkmcnt(5)
    v_mfma_f32_16x16x32_bf16 v[148:151], a[36:39], a[172:175], v[148:151]
    ds_read_b128 a[164:167], v11 offset:32768
    v_mfma_f32_16x16x32_bf16 v[156:159], a[116:119], a[172:175], v[156:159]
    s_waitcnt lgkmcnt(5)
    v_mfma_f32_16x16x32_bf16 v[144:147], a[40:43], a[176:179], v[144:147]
    ds_read_b128 a[168:171], v11 offset:13312
    v_mfma_f32_16x16x32_bf16 v[152:155], a[120:123], a[176:179], v[152:155]
    buffer_load_dwordx4 v2, s[8:11], s35 offen offset:2048 sc1 lds
    s_waitcnt lgkmcnt(5)
    v_mfma_f32_16x16x32_bf16 v[148:151], a[40:43], a[180:183], v[148:151]
    ds_read_b128 a[172:175], v11 offset:33792
    v_mfma_f32_16x16x32_bf16 v[156:159], a[120:123], a[180:183], v[156:159]
    s_waitcnt lgkmcnt(5)
    v_mfma_f32_16x16x32_bf16 v[144:147], a[44:47], a[184:187], v[144:147]
    ds_read_b128 a[176:179], v11 offset:14336
    v_mfma_f32_16x16x32_bf16 v[152:155], a[124:127], a[184:187], v[152:155]
    s_waitcnt lgkmcnt(5)
    v_mfma_f32_16x16x32_bf16 v[148:151], a[44:47], a[188:191], v[148:151]
    ds_read_b128 a[180:183], v11 offset:34816
    v_mfma_f32_16x16x32_bf16 v[156:159], a[124:127], a[188:191], v[156:159]
    buffer_load_dwordx4 v2, s[8:11], s35 offen offset:3072 sc1 lds
    s_waitcnt lgkmcnt(5)
    v_mfma_f32_16x16x32_bf16 v[144:147], a[48:51], a[160:163], v[144:147]
    ds_read_b128 a[184:187], v11 offset:15360
    v_mfma_f32_16x16x32_bf16 v[152:155], a[128:131], a[160:163], v[152:155]
    s_waitcnt lgkmcnt(5)
    v_mfma_f32_16x16x32_bf16 v[148:151], a[48:51], a[164:167], v[148:151]
    ds_read_b128 a[188:191], v11 offset:35840
    v_mfma_f32_16x16x32_bf16 v[156:159], a[128:131], a[164:167], v[156:159]
    s_waitcnt lgkmcnt(5)
    v_mfma_f32_16x16x32_bf16 v[144:147], a[52:55], a[168:171], v[144:147]
    ds_read_b128 a[160:163], v11 offset:16384
    s_add_u32 s35, s28, 8192
    s_add_u32 m0, s42, 8192
    v_mfma_f32_16x16x32_bf16 v[152:155], a[132:135], a[168:171], v[152:155]
    buffer_load_dwordx4 v2, s[8:11], s35 offen offset:0 sc1 lds
    s_waitcnt lgkmcnt(5)
    v_mfma_f32_16x16x32_bf16 v[148:151], a[52:55], a[172:175], v[148:151]
    ds_read_b128 a[164:167], v11 offset:36864
    v_mfma_f32_16x16x32_bf16 v[156:159], a[132:135], a[172:175], v[156:159]
    s_waitcnt lgkmcnt(5)
    v_mfma_f32_16x16x32_bf16 v[144:147], a[56:59], a[176:179], v[144:147]
    ds_read_b128 a[168:171], v11 offset:17408
    v_mfma_f32_16x16x32_bf16 v[152:155], a[136:139], a[176:179], v[152:155]
    s_waitcnt lgkmcnt(5)
    v_mfma_f32_16x16x32_bf16 v[148:151], a[56:59], a[180:183], v[148:151]
    ds_read_b128 a[172:175], v11 offset:37888
    v_mfma_f32_16x16x32_bf16 v[156:159], a[136:139], a[180:183], v[156:159]
    buffer_load_dwordx4 v2, s[8:11], s35 offen offset:1024 sc1 lds
    s_waitcnt lgkmcnt(5)
    v_mfma_f32_16x16x32_bf16 v[144:147], a[60:63], a[184:187], v[144:147]
    ds_read_b128 a[176:179], v11 offset:18432
    v_mfma_f32_16x16x32_bf16 v[152:155], a[140:143], a[184:187], v[152:155]
    s_waitcnt lgkmcnt(5)
    v_mfma_f32_16x16x32_bf16 v[148:151], a[60:63], a[188:191], v[148:151]
    ds_read_b128 a[180:183], v11 offset:38912
    v_mfma_f32_16x16x32_bf16 v[156:159], a[140:143], a[188:191], v[156:159]
    s_waitcnt lgkmcnt(5)
    v_mfma_f32_16x16x32_bf16 v[144:147], a[64:67], a[160:163], v[144:147]
    ds_read_b128 a[184:187], v11 offset:19456
    v_mfma_f32_16x16x32_bf16 v[152:155], a[144:147], a[160:163], v[152:155]
    s_waitcnt lgkmcnt(5)
    v_mfma_f32_16x16x32_bf16 v[148:151], a[64:67], a[164:167], v[148:151]
    ds_read_b128 a[188:191], v11 offset:39936
    v_mfma_f32_16x16x32_bf16 v[156:159], a[144:147], a[164:167], v[156:159]
    s_waitcnt lgkmcnt(5)
    v_mfma_f32_16x16x32_bf16 v[144:147], a[68:71], a[168:171], v[144:147]
    v_mfma_f32_16x16x32_bf16 v[152:155], a[148:151], a[168:171], v[152:155]
    s_waitcnt lgkmcnt(4)
    v_mfma_f32_16x16x32_bf16 v[148:151], a[68:71], a[172:175], v[148:151]
    v_mfma_f32_16x16x32_bf16 v[156:159], a[148:151], a[172:175], v[156:159]
    s_waitcnt lgkmcnt(3)
    v_mfma_f32_16x16x32_bf16 v[144:147], a[72:75], a[176:179], v[144:147]
    v_mfma_f32_16x16x32_bf16 v[152:155], a[152:155], a[176:179], v[152:155]
    s_waitcnt lgkmcnt(2)
    v_mfma_f32_16x16x32_bf16 v[148:151], a[72:75], a[180:183], v[148:151]
    v_mfma_f32_16x16x32_bf16 v[156:159], a[152:155], a[180:183], v[156:159]
    s_waitcnt lgkmcnt(1)
    v_mfma_f32_16x16x32_bf16 v[144:147], a[76:79], a[184:187], v[144:147]
    v_mfma_f32_16x16x32_bf16 v[152:155], a[156:159], a[184:187], v[152:155]
    s_waitcnt lgkmcnt(0)
    v_mfma_f32_16x16x32_bf16 v[148:151], a[76:79], a[188:191], v[148:151]
    v_mfma_f32_16x16x32_bf16 v[156:159], a[156:159], a[188:191], v[156:159]
    s_add_u32 s28, s28, 40960
    s_add_u32 s32, s32, 1
    buffer_load_dword v68, v71, s[8:11], s49 offen offset:0 sc1
    v_cvt_pk_bf16_f32 v160, v144, v145
    v_cvt_pk_bf16_f32 v161, v146, v147
    ds_write_b64 v12, v[160:161] offset:0
    v_cvt_pk_bf16_f32 v162, v148, v149
    v_cvt_pk_bf16_f32 v163, v150, v151
    ds_write_b64 v12, v[162:163] offset:2048
    v_cvt_pk_bf16_f32 v164, v152, v153
    v_cvt_pk_bf16_f32 v165, v154, v155
    ds_write_b64 v12, v[164:165] offset:4096
    v_cvt_pk_bf16_f32 v166, v156, v157
    v_cvt_pk_bf16_f32 v167, v158, v159
    ds_write_b64 v12, v[166:167] offset:6144
    s_and_b32 s4, s21, 3
    s_lshl_b32 s4, s4, 16
    s_add_u32 s34, s36, s4
    s_waitcnt lgkmcnt(0)
    s_barrier
    ds_read_b128 v[96:99], v15 offset:0
    ds_read_b128 v[104:107], v62 offset:0
    ds_read_b128 v[100:103], v15 offset:1024
    ds_read_b128 v[108:111], v62 offset:1024
    s_waitcnt lgkmcnt(2)
    v_mfma_f32_16x16x32_bf16 v[128:131], v[96:99], v[104:107], 0
    s_waitcnt lgkmcnt(0)
    v_mfma_f32_16x16x32_bf16 v[128:131], v[100:103], v[108:111], v[128:131]
    s_nop 7
    buffer_store_dwordx4 v[128:131], v63, s[8:11], s34 offen offset:0 sc1
Ss_loop:
    s_and_b32 s4, s21, 3
    s_mul_i32 s5, s4, 10240
    s_add_u32 s5, s5, s22
    s_sub_u32 s38, s5, 73728
    s_sub_u32 s39, s5, 81920
    s_mul_i32 s5, s4, 16384
    s_add_u32 s25, s24, s5
    s_xor_b32 s4, s4, 2
    s_mul_i32 s5, s4, 163840
    s_mul_i32 s5, s4, 16384
    s_add_u32 s26, s24, s5
    s_add_u32 s21, s21, 1
    v_mov_b32 v72, 0
    v_mov_b32 v73, 0
    v_mov_b32 v74, 0
    v_mov_b32 v75, 0
    v_mov_b32 v76, 0
    v_mov_b32 v77, 0
    v_mov_b32 v78, 0
    v_mov_b32 v79, 0
    v_mov_b32 v59, s21
    s_cmp_eq_u32 s3, 1
    s_cbranch_scc1 Ss_q1
    s_cmp_eq_u32 s3, 2
    s_cbranch_scc1 Ss_q2
    s_cmp_eq_u32 s3, 3
    s_cbranch_scc1 Ss_q3
Ss_q0:
    s_mov_b64 s[4:5], -1
    s_mov_b64 s[6:7], -1
    s_mov_b64 s[92:93], -1
    s_mov_b32 s31, -1
Ss0m_l:
    s_mov_b64 exec, s[4:5]
    buffer_load_dwordx4 v[16:19], v3, s[8:11], s38 offen offset:0 sc1
    s_mov_b64 exec, s[6:7]
    buffer_load_dwordx4 v[20:23], v3, s[8:11], s38 offen offset:1024 sc1
    s_mov_b64 exec, s[92:93]
    buffer_load_dwordx2 v[56:57], v4, s[8:11], s39 offen offset:0 sc1
    s_mov_b64 exec, -1
    s_add_u32 s31, s31, 1
    s_cmp_lt_u32 s31, s30
    s_cselect_b32 s30, s30, 1
    s_cbranch_scc0 Ss0m_o
    s_waitcnt vmcnt(0)
    v_max3_u32 v58, v16, v17, v18
    v_max3_u32 v60, v20, v21, v22
    v_max_u32 v61, v56, v57
    v_max_u32 v58, v58, v19
    v_max_u32 v60, v60, v23
    v_cmp_eq_u32 s[92:93], -1, v61
    v_cmp_eq_u32 s[4:5], -1, v58
    v_cmp_eq_u32 s[6:7], -1, v60
    s_or_b64 s[94:95], s[92:93], s[4:5]
    s_or_b64 s[94:95], s[94:95], s[6:7]
    s_cbranch_scc1 Ss0m_l
Ss0m_o:
    ds_write_b128 v3, v[16:19] offset:8192
    ds_write_b128 v3, v[20:23] offset:9216
    ds_write_b64 v4, v[56:57]
    v_smfmac_f32_16x16x64_bf16 v[72:75], v[16:19], a[0:7], v5
    v_smfmac_f32_16x16x64_bf16 v[76:79], v[16:19], a[80:87], v5
    s_waitcnt lgkmcnt(0)
    s_barrier
    ds_read_b128 v[24:27], v3 offset:10240
    ds_read_b128 v[28:31], v3 offset:11264
    ds_read_b128 v[32:35], v3 offset:12288
    v_smfmac_f32_16x16x64_bf16 v[72:75], v[20:23], a[8:15], v5
    ds_read_b128 v[36:39], v3 offset:13312
    ds_read_b128 v[40:43], v3 offset:14336
    v_smfmac_f32_16x16x64_bf16 v[76:79], v[20:23], a[88:95], v5
    ds_read_b128 v[44:47], v3 offset:15360
    ds_read_b128 v[48:51], v3 offset:16384
    ds_read_b128 v[52:55], v3 offset:17408
    s_waitcnt lgkmcnt(7)
    v_smfmac_f32_16x16x64_bf16 v[72:75], v[24:27], a[16:23], v5
    v_smfmac_f32_16x16x64_bf16 v[76:79], v[24:27], a[96:103], v5
    s_waitcnt lgkmcnt(6)
    v_smfmac_f32_16x16x64_bf16 v[72:75], v[28:31], a[24:31], v5
    v_smfmac_f32_16x16x64_bf16 v[76:79], v[28:31], a[104:111], v5
    s_waitcnt lgkmcnt(5)
    v_smfmac_f32_16x16x64_bf16 v[72:75], v[32:35], a[32:39], v5
    v_smfmac_f32_16x16x64_bf16 v[76:79], v[32:35], a[112:119], v5
    s_waitcnt lgkmcnt(4)
    v_smfmac_f32_16x16x64_bf16 v[72:75], v[36:39], a[40:47], v5
    v_smfmac_f32_16x16x64_bf16 v[76:79], v[36:39], a[120:127], v5
    s_waitcnt lgkmcnt(3)
    v_smfmac_f32_16x16x64_bf16 v[72:75], v[40:43], a[48:55], v5
    v_smfmac_f32_16x16x64_bf16 v[76:79], v[40:43], a[128:135], v5
    s_waitcnt lgkmcnt(2)
    v_smfmac_f32_16x16x64_bf16 v[72:75], v[44:47], a[56:63], v5
    v_smfmac_f32_16x16x64_bf16 v[76:79], v[44:47], a[136:143], v5
    s_waitcnt lgkmcnt(1)
    v_smfmac_f32_16x16x64_bf16 v[72:75], v[48:51], a[64:71], v5
    v_smfmac_f32_16x16x64_bf16 v[76:79], v[48:51], a[144:151], v5
    s_waitcnt lgkmcnt(0)
    v_smfmac_f32_16x16x64_bf16 v[72:75], v[52:55], a[72:79], v5
    v_smfmac_f32_16x16x64_bf16 v[76:79], v[52:55], a[152:159], v5
    s_nop 7
    v_permlane32_swap_b32 v72, v76
    v_permlane32_swap_b32 v73, v77
    v_permlane32_swap_b32 v74, v78
    v_permlane32_swap_b32 v75, v79
    v_pk_add_f32 v[72:73], v[72:73], v[76:77]
    v_pk_add_f32 v[74:75], v[74:75], v[78:79]
    v_cvt_pk_bf16_f32 v94, v72, v73
    v_cvt_pk_bf16_f32 v95, v74, v75
    ds_write_b64 v7, v[94:95]
    s_waitcnt lgkmcnt(0)
    s_barrier
    ds_read_b64_tr_b16 v[120:121], v8 offset:0
    ds_read_b64_tr_b16 v[122:123], v8 offset:640
    ds_read_b64_tr_b16 v[124:125], v8 offset:1280
    ds_read_b64_tr_b16 v[126:127], v8 offset:1920
    s_waitcnt lgkmcnt(2)
    v_mfma_f32_16x16x32_bf16 v[128:131], v[96:99], v[120:123], 0
    s_waitcnt lgkmcnt(0)
    v_mfma_f32_16x16x32_bf16 v[128:131], v[100:103], v[124:127], v[128:131]
    s_nop 7
    buffer_store_dwordx4 v[128:131], v64, s[8:11], s25 offen offset:0 sc1
    s_branch Ss_qj
Ss_q1:
    s_mov_b64 s[4:5], -1
    s_mov_b64 s[6:7], -1
    s_mov_b64 s[92:93], -1
    s_mov_b32 s31, -1
Ss1m_l:
    s_mov_b64 exec, s[4:5]
    buffer_load_dwordx4 v[16:19], v3, s[8:11], s38 offen offset:0 sc1
    s_mov_b64 exec, s[6:7]
    buffer_load_dwordx4 v[20:23], v3, s[8:11], s38 offen offset:1024 sc1
    s_mov_b64 exec, s[92:93]
    buffer_load_dwordx2 v[56:57], v4, s[8:11], s39 offen offset:0 sc1
    s_mov_b64 exec, -1
    s_add_u32 s31, s31, 1
    s_cmp_lt_u32 s31, s30
    s_cselect_b32 s30, s30, 1
    s_cbranch_scc0 Ss1m_o
    s_waitcnt vmcnt(0)
    v_max3_u32 v58, v16, v17, v18
    v_max3_u32 v60, v20, v21, v22
    v_max_u32 v61, v56, v57
    v_max_u32 v58, v58, v19
    v_max_u32 v60, v60, v23
    v_cmp_eq_u32 s[92:93], -1, v61
    v_cmp_eq_u32 s[4:5], -1, v58
    v_cmp_eq_u32 s[6:7], -1, v60
    s_or_b64 s[94:95], s[92:93], s[4:5]
    s_or_b64 s[94:95], s[94:95], s[6:7]
    s_cbranch_scc1 Ss1m_l
Ss1m_o:
    ds_write_b128 v3, v[16:19] offset:8192
    ds_write_b128 v3, v[20:23] offset:9216
    ds_write_b64 v4, v[56:57]
    v_smfmac_f32_16x16x64_bf16 v[72:75], v[16:19], a[16:23], v5
    v_smfmac_f32_16x16x64_bf16 v[76:79], v[16:19], a[96:103], v5
    s_waitcnt lgkmcnt(0)
    s_barrier
    ds_read_b128 v[24:27], v3 offset:10240
    ds_read_b128 v[28:31], v3 offset:11264
    ds_read_b128 v[32:35], v3 offset:12288
    v_smfmac_f32_16x16x64_bf16 v[72:75], v[20:23], a[24:31], v5
    ds_read_b128 v[36:39], v3 offset:13312
    ds_read_b128 v[40:43], v3 offset:6144
    v_smfmac_f32_16x16x64_bf16 v[76:79], v[20:23], a[104:111], v5
    ds_read_b128 v[44:47], v3 offset:7168
    ds_read_b128 v[48:51], v3 offset:14336
    ds_read_b128 v[52:55], v3 offset:15360
    s_waitcnt lgkmcnt(7)
    v_smfmac_f32_16x16x64_bf16 v[72:75], v[24:27], a[32:39], v5
    v_smfmac_f32_16x16x64_bf16 v[76:79], v[24:27], a[112:119], v5
    s_waitcnt lgkmcnt(6)
    v_smfmac_f32_16x16x64_bf16 v[72:75], v[28:31], a[40:47], v5
    v_smfmac_f32_16x16x64_bf16 v[76:79], v[28:31], a[120:127], v5
    s_waitcnt lgkmcnt(5)
    v_smfmac_f32_16x16x64_bf16 v[72:75], v[32:35], a[48:55], v5
    v_smfmac_f32_16x16x64_bf16 v[76:79], v[32:35], a[128:135], v5
    s_waitcnt lgkmcnt(4)
    v_smfmac_f32_16x16x64_bf16 v[72:75], v[36:39], a[56:63], v5
    v_smfmac_f32_16x16x64_bf16 v[76:79], v[36:39], a[136:143], v5
    s_waitcnt lgkmcnt(3)
    v_smfmac_f32_16x16x64_bf16 v[72:75], v[40:43], a[0:7], v5
    v_smfmac_f32_16x16x64_bf16 v[76:79], v[40:43], a[80:87], v5
    s_waitcnt lgkmcnt(2)
    v_smfmac_f32_16x16x64_bf16 v[72:75], v[44:47], a[8:15], v5
    v_smfmac_f32_16x16x64_bf16 v[76:79], v[44:47], a[88:95], v5
    s_waitcnt lgkmcnt(1)
    v_smfmac_f32_16x16x64_bf16 v[72:75], v[48:51], a[64:71], v5
    v_smfmac_f32_16x16x64_bf16 v[76:79], v[48:51], a[144:151], v5
    s_waitcnt lgkmcnt(0)
    v_smfmac_f32_16x16x64_bf16 v[72:75], v[52:55], a[72:79], v5
    v_smfmac_f32_16x16x64_bf16 v[76:79], v[52:55], a[152:159], v5
    s_nop 7
    v_permlane32_swap_b32 v72, v76
    v_permlane32_swap_b32 v73, v77
    v_permlane32_swap_b32 v74, v78
    v_permlane32_swap_b32 v75, v79
    v_pk_add_f32 v[72:73], v[72:73], v[76:77]
    v_pk_add_f32 v[74:75], v[74:75], v[78:79]
    v_cvt_pk_bf16_f32 v94, v72, v73
    v_cvt_pk_bf16_f32 v95, v74, v75
    ds_write_b64 v7, v[94:95]
    s_waitcnt lgkmcnt(0)
    s_barrier
    ds_read_b64_tr_b16 v[120:121], v8 offset:0
    ds_read_b64_tr_b16 v[122:123], v8 offset:640
    ds_read_b64_tr_b16 v[124:125], v8 offset:1280
    ds_read_b64_tr_b16 v[126:127], v8 offset:1920
    s_waitcnt lgkmcnt(2)
    v_mfma_f32_16x16x32_bf16 v[128:131], v[96:99], v[120:123], 0
    s_waitcnt lgkmcnt(0)
    v_mfma_f32_16x16x32_bf16 v[128:131], v[100:103], v[124:127], v[128:131]
    s_nop 7
    buffer_store_dwordx4 v[128:131], v64, s[8:11], s25 offen offset:0 sc1
    s_branch Ss_qj
Ss_q2:
    s_mov_b64 s[4:5], -1
    s_mov_b64 s[6:7], -1
    s_mov_b64 s[92:93], -1
    s_mov_b32 s31, -1
Ss2m_l:
    s_mov_b64 exec, s[4:5]
    buffer_load_dwordx4 v[16:19], v3, s[8:11], s38 offen offset:0 sc1
    s_mov_b64 exec, s[6:7]
    buffer_load_dwordx4 v[20:23], v3, s[8:11], s38 offen offset:1024 sc1
    s_mov_b64 exec, s[92:93]
    buffer_load_dwordx2 v[56:57], v4, s[8:11], s39 offen offset:0 sc1
    s_mov_b64 exec, -1
    s_add_u32 s31, s31, 1
    s_cmp_lt_u32 s31, s30
    s_cselect_b32 s30, s30, 1
    s_cbranch_scc0 Ss2m_o
    s_waitcnt vmcnt(0)
    v_max3_u32 v58, v16, v17, v18
    v_max3_u32 v60, v20, v21, v22
    v_max_u32 v61, v56, v57
    v_max_u32 v58, v58, v19
    v_max_u32 v60, v60, v23
    v_cmp_eq_u32 s[92:93], -1, v61
    v_cmp_eq_u32 s[4:5], -1, v58
    v_cmp_eq_u32 s[6:7], -1, v60
    s_or_b64 s[94:95], s[92:93], s[4:5]
    s_or_b64 s[94:95], s[94:95], s[6:7]
    s_cbranch_scc1 Ss2m_l
Ss2m_o:
    ds_write_b128 v3, v[16:19] offset:8192
    ds_write_b128 v3, v[20:23] offset:9216
    ds_write_b64 v4, v[56:57]
    v_smfmac_f32_16x16x64_bf16 v[72:75], v[16:19], a[32:39], v5
    v_smfmac_f32_16x16x64_bf16 v[76:79], v[16:19], a[112:119], v5
    s_waitcnt lgkmcnt(0)
    s_barrier
    ds_read_b128 v[24:27], v3 offset:10240
    ds_read_b128 v[28:31], v3 offset:11264
    ds_read_b128 v[32:35], v3 offset:4096
    v_smfmac_f32_16x16x64_bf16 v[72:75], v[20:23], a[40:47], v5
    ds_read_b128 v[36:39], v3 offset:5120
    ds_read_b128 v[40:43], v3 offset:6144
    v_smfmac_f32_16x16x64_bf16 v[76:79], v[20:23], a[120:127], v5
    ds_read_b128 v[44:47], v3 offset:7168
    ds_read_b128 v[48:51], v3 offset:12288
    ds_read_b128 v[52:55], v3 offset:13312
    s_waitcnt lgkmcnt(7)
    v_smfmac_f32_16x16x64_bf16 v[72:75], v[24:27], a[48:55], v5
    v_smfmac_f32_16x16x64_bf16 v[76:79], v[24:27], a[128:135], v5
    s_waitcnt lgkmcnt(6)
    v_smfmac_f32_16x16x64_bf16 v[72:75], v[28:31], a[56:63], v5
    v_smfmac_f32_16x16x64_bf16 v[76:79], v[28:31], a[136:143], v5
    s_waitcnt lgkmcnt(5)
    v_smfmac_f32_16x16x64_bf16 v[72:75], v[32:35], a[0:7], v5
    v_smfmac_f32_16x16x64_bf16 v[76:79], v[32:35], a[80:87], v5
    s_waitcnt lgkmcnt(4)
    v_smfmac_f32_16x16x64_bf16 v[72:75], v[36:39], a[8:15], v5
    v_smfmac_f32_16x16x64_bf16 v[76:79], v[36:39], a[88:95], v5
    s_waitcnt lgkmcnt(3)
    v_smfmac_f32_16x16x64_bf16 v[72:75], v[40:43], a[16:23], v5
    v_smfmac_f32_16x16x64_bf16 v[76:79], v[40:43], a[96:103], v5
    s_waitcnt lgkmcnt(2)
    v_smfmac_f32_16x16x64_bf16 v[72:75], v[44:47], a[24:31], v5
    v_smfmac_f32_16x16x64_bf16 v[76:79], v[44:47], a[104:111], v5
    s_waitcnt lgkmcnt(1)
    v_smfmac_f32_16x16x64_bf16 v[72:75], v[48:51], a[64:71], v5
    v_smfmac_f32_16x16x64_bf16 v[76:79], v[48:51], a[144:151], v5
    s_waitcnt lgkmcnt(0)
    v_smfmac_f32_16x16x64_bf16 v[72:75], v[52:55], a[72:79], v5
    v_smfmac_f32_16x16x64_bf16 v[76:79], v[52:55], a[152:159], v5
    s_nop 7
    v_permlane32_swap_b32 v72, v76
    v_permlane32_swap_b32 v73, v77
    v_permlane32_swap_b32 v74, v78
    v_permlane32_swap_b32 v75, v79
    v_pk_add_f32 v[72:73], v[72:73], v[76:77]
    v_pk_add_f32 v[74:75], v[74:75], v[78:79]
    v_cvt_pk_bf16_f32 v94, v72, v73
    v_cvt_pk_bf16_f32 v95, v74, v75
    ds_write_b64 v7, v[94:95]
    s_waitcnt lgkmcnt(0)
    s_barrier
    ds_read_b64_tr_b16 v[120:121], v8 offset:0
    ds_read_b64_tr_b16 v[112:113], v6 offset:16
    ds_read_b64_tr_b16 v[122:123], v8 offset:640
    ds_read_b64_tr_b16 v[114:115], v6 offset:656
    ds_read_b64_tr_b16 v[124:125], v8 offset:1280
    ds_read_b64_tr_b16 v[116:117], v6 offset:1296
    ds_read_b64_tr_b16 v[126:127], v8 offset:1920
    ds_read_b64_tr_b16 v[118:119], v6 offset:1936
    s_waitcnt lgkmcnt(4)
    v_mfma_f32_16x16x32_bf16 v[128:131], v[112:115], v[120:123], 0
    s_waitcnt lgkmcnt(0)
    v_mfma_f32_16x16x32_bf16 v[128:131], v[116:119], v[124:127], v[128:131]
    s_nop 7
    v_cndmask_b32 v128, v128, v129, s[40:41]
    v_cndmask_b32 v130, v130, v131, s[40:41]
    v_cndmask_b32 v128, v128, v130, s[90:91]
    buffer_store_dword v128, v65, s[8:11], s25 offen offset:0 sc1
    s_branch Ss_qj
Ss_q3:
    s_mov_b64 s[4:5], -1
    s_mov_b64 s[6:7], -1
    s_mov_b64 s[92:93], -1
    s_mov_b32 s31, -1
Ss3m_l:
    s_mov_b64 exec, s[4:5]
    buffer_load_dwordx4 v[16:19], v3, s[8:11], s38 offen offset:0 sc1
    s_mov_b64 exec, s[6:7]
    buffer_load_dwordx4 v[20:23], v3, s[8:11], s38 offen offset:1024 sc1
    s_mov_b64 exec, s[92:93]
    buffer_load_dwordx2 v[56:57], v4, s[8:11], s39 offen offset:0 sc1
    s_mov_b64 exec, -1
    s_add_u32 s31, s31, 1
    s_cmp_lt_u32 s31, s30
    s_cselect_b32 s30, s30, 1
    s_cbranch_scc0 Ss3m_o
    s_waitcnt vmcnt(0)
    v_max3_u32 v58, v16, v17, v18
    v_max3_u32 v60, v20, v21, v22
    v_max_u32 v61, v56, v57
    v_max_u32 v58, v58, v19
    v_max_u32 v60, v60, v23
    v_cmp_eq_u32 s[92:93], -1, v61
    v_cmp_eq_u32 s[4:5], -1, v58
    v_cmp_eq_u32 s[6:7], -1, v60
    s_or_b64 s[94:95], s[92:93], s[4:5]
    s_or_b64 s[94:95], s[94:95], s[6:7]
    s_cbranch_scc1 Ss3m_l
Ss3m_o:
    ds_write_b128 v3, v[16:19] offset:8192
    ds_write_b128 v3, v[20:23] offset:9216
    ds_write_b64 v4, v[56:57]
    v_smfmac_f32_16x16x64_bf16 v[72:75], v[16:19], a[48:55], v5
    v_smfmac_f32_16x16x64_bf16 v[76:79], v[16:19], a[128:135], v5
    s_waitcnt lgkmcnt(0)
    s_barrier
    ds_read_b128 v[24:27], v3 offset:2048
    ds_read_b128 v[28:31], v3 offset:3072
    ds_read_b128 v[32:35], v3 offset:4096
    v_smfmac_f32_16x16x64_bf16 v[72:75], v[20:23], a[56:63], v5
    ds_read_b128 v[36:39], v3 offset:5120
    ds_read_b128 v[40:43], v3 offset:6144
    v_smfmac_f32_16x16x64_bf16 v[76:79], v[20:23], a[136:143], v5
    ds_read_b128 v[44:47], v3 offset:7168
    ds_read_b128 v[48:51], v3 offset:10240
    ds_read_b128 v[52:55], v3 offset:11264
    s_waitcnt lgkmcnt(7)
    v_smfmac_f32_16x16x64_bf16 v[72:75], v[24:27], a[0:7], v5
    v_smfmac_f32_16x16x64_bf16 v[76:79], v[24:27], a[80:87], v5
    s_waitcnt lgkmcnt(6)
    v_smfmac_f32_16x16x64_bf16 v[72:75], v[28:31], a[8:15], v5
    v_smfmac_f32_16x16x64_bf16 v[76:79], v[28:31], a[88:95], v5
    s_waitcnt lgkmcnt(5)
    v_smfmac_f32_16x16x64_bf16 v[72:75], v[32:35], a[16:23], v5
    v_smfmac_f32_16x16x64_bf16 v[76:79], v[32:35], a[96:103], v5
    s_waitcnt lgkmcnt(4)
    v_smfmac_f32_16x16x64_bf16 v[72:75], v[36:39], a[24:31], v5
    v_smfmac_f32_16x16x64_bf16 v[76:79], v[36:39], a[104:111], v5
    s_waitcnt lgkmcnt(3)
    v_smfmac_f32_16x16x64_bf16 v[72:75], v[40:43], a[32:39], v5
    v_smfmac_f32_16x16x64_bf16 v[76:79], v[40:43], a[112:119], v5
    s_waitcnt lgkmcnt(2)
    v_smfmac_f32_16x16x64_bf16 v[72:75], v[44:47], a[40:47], v5
    v_smfmac_f32_16x16x64_bf16 v[76:79], v[44:47], a[120:127], v5
    s_waitcnt lgkmcnt(1)
    v_smfmac_f32_16x16x64_bf16 v[72:75], v[48:51], a[64:71], v5
    buffer_store_dword v59, v14, s[8:11], s44 offen offset:0 sc1
    v_smfmac_f32_16x16x64_bf16 v[76:79], v[48:51], a[144:151], v5
    s_waitcnt lgkmcnt(0)
    v_smfmac_f32_16x16x64_bf16 v[72:75], v[52:55], a[72:79], v5
    v_smfmac_f32_16x16x64_bf16 v[76:79], v[52:55], a[152:159], v5
    s_nop 7
    v_permlane32_swap_b32 v72, v76
    v_permlane32_swap_b32 v73, v77
    v_permlane32_swap_b32 v74, v78
    v_permlane32_swap_b32 v75, v79
    v_pk_add_f32 v[72:73], v[72:73], v[76:77]
    v_pk_add_f32 v[74:75], v[74:75], v[78:79]
    v_cvt_pk_bf16_f32 v94, v72, v73
    v_cvt_pk_bf16_f32 v95, v74, v75
    ds_write_b64 v7, v[94:95]
    s_waitcnt lgkmcnt(0)
    s_barrier
    ds_read_b64_tr_b16 v[112:113], v6 offset:16
    ds_read_b64_tr_b16 v[114:115], v6 offset:656
    ds_read_b64_tr_b16 v[116:117], v6 offset:1296
    ds_read_b64_tr_b16 v[118:119], v6 offset:1936
    s_waitcnt lgkmcnt(2)
    v_mfma_f32_16x16x32_bf16 v[128:131], v[112:115], v[96:99], 0
    v_mfma_f32_16x16x32_bf16 v[132:135], v[112:115], v[104:107], 0
    s_waitcnt lgkmcnt(0)
    v_mfma_f32_16x16x32_bf16 v[128:131], v[116:119], v[100:103], v[128:131]
    v_mfma_f32_16x16x32_bf16 v[132:135], v[116:119], v[108:111], v[132:135]
    s_nop 7
    s_mov_b32 exec_lo, 0
    v_mov_b32 v128, v132
    v_mov_b32 v129, v133
    v_mov_b32 v130, v134
    v_mov_b32 v131, v135
    s_mov_b32 exec_lo, -1
    buffer_store_dwordx4 v[128:131], v2, s[8:11], s34 offen offset:0 sc1
Ss_qj:
    s_cmp_lt_u32 s21, 64
    s_cbranch_scc0 Ss_end
    s_cmp_eq_u32 s32, 14
    s_cbranch_scc0 Ss_h
    s_mov_b32 s31, 0
    s_waitcnt vmcnt(63)
    s_branch SsB1_c
SsB1_l:
    buffer_load_dword v68, v70, s[8:11], s23 offen sc1
    s_waitcnt vmcnt(0)
SsB1_c:
    v_cmp_gt_u32 vcc, 1, v68
    s_cbranch_vccz SsB1_o
    s_sleep 4
    s_add_u32 s31, s31, 1
    s_cmp_lt_u32 s31, s30
    s_cbranch_scc1 SsB1_l
    s_mov_b32 s30, 1
SsB1_o:
Ss_h:
    s_cmp_gt_u32 s32, 3
    s_cbranch_scc1 SsB0_o
    s_cmp_eq_u32 s32, 1
    s_cbranch_scc0 SsBA_o
    s_mov_b32 s31, 0
    s_waitcnt vmcnt(63)
    s_branch SsBA_c
SsBA_l:
    buffer_load_dword v68, v71, s[8:11], s49 offen sc1
    s_waitcnt vmcnt(0)
SsBA_c:
    v_cmp_gt_u32 vcc, 1, v68
    s_cbranch_vccz SsBA_o
    s_sleep 2
    s_add_u32 s31, s31, 1
    s_cmp_lt_u32 s31, s30
    s_cbranch_scc1 SsBA_l
    s_mov_b32 s30, 1
SsBA_o:
    s_cmp_eq_u32 s32, 3
    s_cbranch_scc0 SsB0_o
    s_mov_b32 s31, 0
    s_waitcnt vmcnt(63)
    s_branch SsB0_c
SsB0_l:
    buffer_load_dword v68, v70, s[8:11], s49 offen sc1
    s_waitcnt vmcnt(0)
SsB0_c:
    v_cmp_gt_u32 vcc, 1, v68
    s_cbranch_vccz SsB0_o
    s_sleep 2
    s_add_u32 s31, s31, 1
    s_cmp_lt_u32 s31, s30
    s_cbranch_scc1 SsB0_l
    s_mov_b32 s30, 1
SsB0_o:
    v_add_u32 v11, s29, v2
    s_xor_b32 s29, s29, 40960
    s_add_u32 s42, s29, s27
    ds_read_b128 a[160:163], v11 offset:0
    ds_read_b128 a[164:167], v11 offset:20480
    ds_read_b128 a[168:171], v11 offset:1024
    ds_read_b128 a[172:175], v11 offset:21504
    ds_read_b128 a[176:179], v11 offset:2048
    ds_read_b128 a[180:183], v11 offset:22528
    s_waitcnt lgkmcnt(5)
    v_mfma_f32_16x16x32_bf16 v[144:147], a[0:3], a[160:163], 0
    ds_read_b128 a[184:187], v11 offset:3072
    v_mfma_f32_16x16x32_bf16 v[152:155], a[80:83], a[160:163], 0
    s_waitcnt lgkmcnt(5)
    v_mfma_f32_16x16x32_bf16 v[148:151], a[0:3], a[164:167], 0
    ds_read_b128 a[188:191], v11 offset:23552
    v_mfma_f32_16x16x32_bf16 v[156:159], a[80:83], a[164:167], 0
    s_waitcnt lgkmcnt(5)
    v_mfma_f32_16x16x32_bf16 v[144:147], a[4:7], a[168:171], v[144:147]
    ds_read_b128 a[160:163], v11 offset:4096
    s_add_u32 s35, s28, 0
    s_add_u32 m0, s42, 0
    v_mfma_f32_16x16x32_bf16 v[152:155], a[84:87], a[168:171], v[152:155]
    buffer_load_dwordx4 v2, s[8:11], s35 offen offset:0 sc1 lds
    s_waitcnt lgkmcnt(5)
    v_mfma_f32_16x16x32_bf16 v[148:151], a[4:7], a[172:175], v[148:151]
    ds_read_b128 a[164:167], v11 offset:24576
    v_mfma_f32_16x16x32_bf16 v[156:159], a[84:87], a[172:175], v[156:159]
    s_waitcnt lgkmcnt(5)
    v_mfma_f32_16x16x32_bf16 v[144:147], a[8:11], a[176:179], v[144:147]
    ds_read_b128 a[168:171], v11 offset:5120
    v_mfma_f32_16x16x32_bf16 v[152:155], a[88:91], a[176:179], v[152:155]
    s_waitcnt lgkmcnt(5)
    v_mfma_f32_16x16x32_bf16 v[148:151], a[8:11], a[180:183], v[148:151]
    ds_read_b128 a[172:175], v11 offset:25600
    v_mfma_f32_16x16x32_bf16 v[156:159], a[88:91], a[180:183], v[156:159]
    buffer_load_dwordx4 v2, s[8:11], s35 offen offset:1024 sc1 lds
    s_waitcnt lgkmcnt(5)
    v_mfma_f32_16x16x32_bf16 v[144:147], a[12:15], a[184:187], v[144:147]
    ds_read_b128 a[176:179], v11 offset:6144
    v_mfma_f32_16x16x32_bf16 v[152:155], a[92:95], a[184:187], v[152:155]
    s_waitcnt lgkmcnt(5)
    v_mfma_f32_16x16x32_bf16 v[148:151], a[12:15], a[188:191], v[148:151]
    ds_read_b128 a[180:183], v11 offset:26624
    v_mfma_f32_16x16x32_bf16 v[156:159], a[92:95], a[188:191], v[156:159]
    s_waitcnt vmcnt(2)
    v_mov_b32 v10, s21
    s_mov_b64 exec, 1
    buffer_store_dword v10, v9, s[8:11], s33 offen sc1
    s_mov_b64 exec, -1
    s_waitcnt lgkmcnt(5)
    v_mfma_f32_16x16x32_bf16 v[144:147], a[16:19], a[160:163], v[144:147]
    ds_read_b128 a[184:187], v11 offset:7168
    v_mfma_f32_16x16x32_bf16 v[152:155], a[96:99], a[160:163], v[152:155]
    buffer_load_dwordx4 v2, s[8:11], s35 offen offset:2048 sc1 lds
    s_waitcnt lgkmcnt(5)
    v_mfma_f32_16x16x32_bf16 v[148:151], a[16:19], a[164:167], v[148:151]
    ds_read_b128 a[188:191], v11 offset:27648
    v_mfma_f32_16x16x32_bf16 v[156:159], a[96:99], a[164:167], v[156:159]
    buffer_store_dwordx4 v[240:243], v64, s[8:11], s26 offen offset:0 sc1
    s_waitcnt lgkmcnt(5)
    v_mfma_f32_16x16x32_bf16 v[144:147], a[20:23], a[168:171], v[144:147]
    ds_read_b128 a[160:163], v11 offset:8192
    v_mfma_f32_16x16x32_bf16 v[152:155], a[100:103], a[168:171], v[152:155]
    buffer_store_dword v240, v65, s[8:11], s26 offen offset:0 sc1
    s_waitcnt lgkmcnt(5)
    v_mfma_f32_16x16x32_bf16 v[148:151], a[20:23], a[172:175], v[148:151]
    ds_read_b128 a[164:167], v11 offset:28672
    v_mfma_f32_16x16x32_bf16 v[156:159], a[100:103], a[172:175], v[156:159]
    buffer_load_dwordx4 v2, s[8:11], s35 offen offset:3072 sc1 lds
    s_waitcnt lgkmcnt(5)
    v_mfma_f32_16x16x32_bf16 v[144:147], a[24:27], a[176:179], v[144:147]
    ds_read_b128 a[168:171], v11 offset:9216
    v_mfma_f32_16x16x32_bf16 v[152:155], a[104:107], a[176:179], v[152:155]
    s_waitcnt lgkmcnt(5)
    v_mfma_f32_16x16x32_bf16 v[148:151], a[24:27], a[180:183], v[148:151]
    ds_read_b128 a[172:175], v11 offset:29696
    v_mfma_f32_16x16x32_bf16 v[156:159], a[104:107], a[180:183], v[156:159]
    s_waitcnt lgkmcnt(5)
    v_mfma_f32_16x16x32_bf16 v[144:147], a[28:31], a[184:187], v[144:147]
    ds_read_b128 a[176:179], v11 offset:10240
    s_add_u32 s35, s28, 4096
    s_add_u32 m0, s42, 4096
    v_mfma_f32_16x16x32_bf16 v[152:155], a[108:111], a[184:187], v[152:155]
    buffer_load_dwordx4 v2, s[8:11], s35 offen offset:0 sc1 lds
    s_waitcnt lgkmcnt(5)
    v_mfma_f32_16x16x32_bf16 v[148:151], a[28:31], a[188:191], v[148:151]
    ds_read_b128 a[180:183], v11 offset:30720
    v_mfma_f32_16x16x32_bf16 v[156:159], a[108:111], a[188:191], v[156:159]
    s_waitcnt lgkmcnt(5)
    v_mfma_f32_16x16x32_bf16 v[144:147], a[32:35], a[160:163], v[144:147]
    ds_read_b128 a[184:187], v11 offset:11264
    v_mfma_f32_16x16x32_bf16 v[152:155], a[112:115], a[160:163], v[152:155]
    s_waitcnt lgkmcnt(5)
    v_mfma_f32_16x16x32_bf16 v[148:151], a[32:35], a[164:167], v[148:151]
    ds_read_b128 a[188:191], v11 offset:31744
    v_mfma_f32_16x16x32_bf16 v[156:159], a[112:115], a[164:167], v[156:159]
    buffer_load_dwordx4 v2, s[8:11], s35 offen offset:1024 sc1 lds
    s_waitcnt lgkmcnt(5)
    v_mfma_f32_16x16x32_bf16 v[144:147], a[36:39], a[168:171], v[144:147]
    ds_read_b128 a[160:163], v11 offset:12288
    v_mfma_f32_16x16x32_bf16 v[152:155], a[116:119], a[168:171], v[152:155]
    s_sub_u32 s4, s21, 8
    s_cmp_lt_u32 s4, s45
    s_cselect_b64 exec, -1, 0
    s_lshl_b32 s4, s21, 19
    s_add_u32 s4, s4, s46
    buffer_store_dwordx4 v[240:243], v2, s[8:11], s4 offen offset:0 sc1
    s_mov_b64 exec, -1
    s_waitcnt lgkmcnt(5)
    v_mfma_f32_16x16x32_bf16 v[148:151], a[36:39], a[172:175], v[148:151]
    ds_read_b128 a[164:167], v11 offset:32768
    v_mfma_f32_16x16x32_bf16 v[156:159], a[116:119], a[172:175], v[156:159]
    s_cmp_eq_u32 s21, s88
    s_cselect_b64 exec, -1, 0
    buffer_store_dwordx4 v[240:243], v2, s[8:11], s89 offen offset:0 sc1
    s_mov_b64 exec, -1
    s_waitcnt lgkmcnt(5)
    v_mfma_f32_16x16x32_bf16 v[144:147], a[40:43], a[176:179], v[144:147]
    ds_read_b128 a[168:171], v11 offset:13312
    v_mfma_f32_16x16x32_bf16 v[152:155], a[120:123], a[176:179], v[152:155]
    buffer_load_dwordx4 v2, s[8:11], s35 offen offset:2048 sc1 lds
    s_waitcnt lgkmcnt(5)
    v_mfma_f32_16x16x32_bf16 v[148:151], a[40:43], a[180:183], v[148:151]
    ds_read_b128 a[172:175], v11 offset:33792
    v_mfma_f32_16x16x32_bf16 v[156:159], a[120:123], a[180:183], v[156:159]
    s_waitcnt lgkmcnt(5)
    v_mfma_f32_16x16x32_bf16 v[144:147], a[44:47], a[184:187], v[144:147]
    ds_read_b128 a[176:179], v11 offset:14336
    v_mfma_f32_16x16x32_bf16 v[152:155], a[124:127], a[184:187], v[152:155]
    s_waitcnt lgkmcnt(5)
    v_mfma_f32_16x16x32_bf16 v[148:151], a[44:47], a[188:191], v[148:151]
    ds_read_b128 a[180:183], v11 offset:34816
    v_mfma_f32_16x16x32_bf16 v[156:159], a[124:127], a[188:191], v[156:159]
    buffer_load_dwordx4 v2, s[8:11], s35 offen offset:3072 sc1 lds
    s_waitcnt lgkmcnt(5)
    v_mfma_f32_16x16x32_bf16 v[144:147], a[48:51], a[160:163], v[144:147]
    ds_read_b128 a[184:187], v11 offset:15360
    v_mfma_f32_16x16x32_bf16 v[152:155], a[128:131], a[160:163], v[152:155]
    s_waitcnt lgkmcnt(5)
    v_mfma_f32_16x16x32_bf16 v[148:151], a[48:51], a[164:167], v[148:151]
    ds_read_b128 a[188:191], v11 offset:35840
    v_mfma_f32_16x16x32_bf16 v[156:159], a[128:131], a[164:167], v[156:159]
    s_waitcnt lgkmcnt(5)
    v_mfma_f32_16x16x32_bf16 v[144:147], a[52:55], a[168:171], v[144:147]
    ds_read_b128 a[160:163], v11 offset:16384
    s_add_u32 s35, s28, 8192
    s_add_u32 m0, s42, 8192
    v_mfma_f32_16x16x32_bf16 v[152:155], a[132:135], a[168:171], v[152:155]
    buffer_load_dwordx4 v2, s[8:11], s35 offen offset:0 sc1 lds
    s_waitcnt lgkmcnt(5)
    v_mfma_f32_16x16x32_bf16 v[148:151], a[52:55], a[172:175], v[148:151]
    ds_read_b128 a[164:167], v11 offset:36864
    v_mfma_f32_16x16x32_bf16 v[156:159], a[132:135], a[172:175], v[156:159]
    s_waitcnt lgkmcnt(5)
    v_mfma_f32_16x16x32_bf16 v[144:147], a[56:59], a[176:179], v[144:147]
    ds_read_b128 a[168:171], v11 offset:17408
    v_mfma_f32_16x16x32_bf16 v[152:155], a[136:139], a[176:179], v[152:155]
    s_waitcnt lgkmcnt(5)
    v_mfma_f32_16x16x32_bf16 v[148:151], a[56:59], a[180:183], v[148:151]
    ds_read_b128 a[172:175], v11 offset:37888
    v_mfma_f32_16x16x32_bf16 v[156:159], a[136:139], a[180:183], v[156:159]
    buffer_load_dwordx4 v2, s[8:11], s35 offen offset:1024 sc1 lds
    s_waitcnt lgkmcnt(5)
    v_mfma_f32_16x16x32_bf16 v[144:147], a[60:63], a[184:187], v[144:147]
    ds_read_b128 a[176:179], v11 offset:18432
    v_mfma_f32_16x16x32_bf16 v[152:155], a[140:143], a[184:187], v[152:155]
    s_waitcnt lgkmcnt(5)
    v_mfma_f32_16x16x32_bf16 v[148:151], a[60:63], a[188:191], v[148:151]
    ds_read_b128 a[180:183], v11 offset:38912
    v_mfma_f32_16x16x32_bf16 v[156:159], a[140:143], a[188:191], v[156:159]
    s_waitcnt lgkmcnt(5)
    v_mfma_f32_16x16x32_bf16 v[144:147], a[64:67], a[160:163], v[144:147]
    ds_read_b128 a[184:187], v11 offset:19456
    v_mfma_f32_16x16x32_bf16 v[152:155], a[144:147], a[160:163], v[152:155]
    s_waitcnt lgkmcnt(5)
    v_mfma_f32_16x16x32_bf16 v[148:151], a[64:67], a[164:167], v[148:151]
    ds_read_b128 a[188:191], v11 offset:39936
    v_mfma_f32_16x16x32_bf16 v[156:159], a[144:147], a[164:167], v[156:159]
    s_waitcnt lgkmcnt(5)
    v_mfma_f32_16x16x32_bf16 v[144:147], a[68:71], a[168:171], v[144:147]
    v_mfma_f32_16x16x32_bf16 v[152:155], a[148:151], a[168:171], v[152:155]
    s_waitcnt lgkmcnt(4)
    v_mfma_f32_16x16x32_bf16 v[148:151], a[68:71], a[172:175], v[148:151]
    v_mfma_f32_16x16x32_bf16 v[156:159], a[148:151], a[172:175], v[156:159]
    s_waitcnt lgkmcnt(3)
    v_mfma_f32_16x16x32_bf16 v[144:147], a[72:75], a[176:179], v[144:147]
    v_mfma_f32_16x16x32_bf16 v[152:155], a[152:155], a[176:179], v[152:155]
    s_waitcnt lgkmcnt(2)
    v_mfma_f32_16x16x32_bf16 v[148:151], a[72:75], a[180:183], v[148:151]
    v_mfma_f32_16x16x32_bf16 v[156:159], a[152:155], a[180:183], v[156:159]
    s_waitcnt lgkmcnt(1)
    v_mfma_f32_16x16x32_bf16 v[144:147], a[76:79], a[184:187], v[144:147]
    v_mfma_f32_16x16x32_bf16 v[152:155], a[156:159], a[184:187], v[152:155]
    s_waitcnt lgkmcnt(0)
    v_mfma_f32_16x16x32_bf16 v[148:151], a[76:79], a[188:191], v[148:151]
    v_mfma_f32_16x16x32_bf16 v[156:159], a[156:159], a[188:191], v[156:159]
    s_add_u32 s28, s28, 40960
    s_add_u32 s32, s32, 1
    s_cmp_eq_u32 s32, 3
    s_cbranch_scc0 Ss_n3
    buffer_load_dword v68, v70, s[8:11], s49 offen offset:0 sc1
Ss_n3:
    s_cmp_eq_u32 s32, 12
    s_cbranch_scc0 Ss_n12
    buffer_load_dword v68, v70, s[8:11], s23 offen offset:0 sc1
Ss_n12:
    v_cvt_pk_bf16_f32 v160, v144, v145
    v_cvt_pk_bf16_f32 v161, v146, v147
    ds_write_b64 v12, v[160:161] offset:0
    v_cvt_pk_bf16_f32 v162, v148, v149
    v_cvt_pk_bf16_f32 v163, v150, v151
    ds_write_b64 v12, v[162:163] offset:2048
    v_cvt_pk_bf16_f32 v164, v152, v153
    v_cvt_pk_bf16_f32 v165, v154, v155
    ds_write_b64 v12, v[164:165] offset:4096
    v_cvt_pk_bf16_f32 v166, v156, v157
    v_cvt_pk_bf16_f32 v167, v158, v159
    ds_write_b64 v12, v[166:167] offset:6144
    s_and_b32 s4, s21, 3
    s_lshl_b32 s4, s4, 16
    s_add_u32 s34, s36, s4
    s_waitcnt lgkmcnt(0)
    s_barrier
    ds_read_b128 v[96:99], v15 offset:0
    ds_read_b128 v[104:107], v62 offset:0
    ds_read_b128 v[100:103], v15 offset:1024
    ds_read_b128 v[108:111], v62 offset:1024
    s_waitcnt lgkmcnt(2)
    v_mfma_f32_16x16x32_bf16 v[128:131], v[96:99], v[104:107], 0
    s_waitcnt lgkmcnt(0)
    v_mfma_f32_16x16x32_bf16 v[128:131], v[100:103], v[108:111], v[128:131]
    s_nop 7
    buffer_store_dwordx4 v[128:131], v63, s[8:11], s34 offen offset:0 sc1
    s_branch Ss_loop
Ss_end:
    s_waitcnt vmcnt(0)
    v_mov_b32 v10, s21
    s_mov_b64 exec, 1
    buffer_store_dword v10, v9, s[8:11], s33 offen sc1
    s_mov_b64 exec, -1
    s_branch R_done
R_v:
    v_lshlrev_b32 v2, 4, v1
    s_load_dwordx2 s[12:13], s[0:1], 32
    s_load_dwordx2 s[16:17], s[0:1], 32
    s_mov_b32 s14, 7864320
    s_mov_b32 s15, 0x20000
    s_mov_b32 s18, 7864320
    s_mov_b32 s19, 0x20000
    s_waitcnt lgkmcnt(0)
    s_mul_i32 s42, s99, 6
    s_add_u32 s42, s42, s20
    s_sub_u32 s42, s42, 12
    s_lshl_b32 s42, s42, 8
    s_add_u32 s47, s42, 128
    s_lshl_b32 s37, s3, 11
    s_lshl_b32 s4, s3, 4
    s_and_b32 s5, s3, 1
    s_lshl_b32 s5, s5, 1
    v_lshrrev_b32 v60, 3, v1
    v_and_b32 v61, 1, v60
    v_or_b32 v61, s5, v61
    v_add_u32 v60, s4, v60
    v_mul_u32_u24 v13, 12288, v60
    v_bfe_u32 v60, v1, 1, 2
    v_xor_b32 v60, v60, v61
    v_lshlrev_b32 v60, 5, v60
    v_and_b32 v61, 1, v1
    v_lshlrev_b32 v61, 4, v61
    v_add3_u32 v13, v13, v60, v61
    v_lshrrev_b32 v60, 4, v1
    v_lshlrev_b32 v60, 2, v60
    v_bfe_u32 v61, v1, 2, 1
    v_add_u32 v60, v60, v61
    v_bfe_u32 v61, v1, 3, 1
    v_lshlrev_b32 v61, 4, v61
    v_add_u32 v60, v60, v61
    v_lshlrev_b32 v0, 7, v60
    v_bfe_u32 v60, v1, 2, 2
    v_lshlrev_b32 v60, 5, v60
    v_and_b32 v61, 3, v1
    v_lshlrev_b32 v61, 3, v61
    v_add3_u32 v0, v0, v60, v61
    v_mov_b32 v134, 163776
    s_cmp_lg_u32 s3, 0
    s_cbranch_scc1 VC_c
    s_waitcnt vmcnt(0)
    v_readfirstlane_b32 s4, v135
    s_and_b32 s4, s4, s33
    s_nop 0
    v_mov_b32 v135, s4
    ds_write_b32 v134, v135
    s_waitcnt lgkmcnt(0)
VC_c:
    s_barrier
    ds_read_b32 v135, v134
    s_waitcnt lgkmcnt(0)
    v_readfirstlane_b32 s4, v135
    s_cmp_lg_u32 s4, 0
    s_cbranch_scc1 R_ovf
    s_load_dwordx2 s[84:85], s[0:1], 120
    s_mov_b32 s86, 256
    s_mov_b32 s87, 0x20000
    s_waitcnt lgkmcnt(0)
    s_mul_i32 s22, s99, 1048576
    s_add_u32 s22, s22, 8388608
    s_lshl_b32 s33, s20, 4
    s_lshl_b32 s4, s3, 2
    s_add_u32 s33, s33, s4
    s_add_u32 s33, s33, s22
    s_add_u32 s33, s33, 155648
    s_mov_b32 s48, 0xfffffffe
    v_mov_b32 v9, 0
    v_mov_b32 v240, -1
    v_mov_b32 v241, -1
    v_mov_b32 v242, -1
    v_mov_b32 v243, -1
    v_and_b32 v16, 8, v1
    v_mov_b32 v5, 0x4444
    v_mov_b32 v17, 0xeeee
    v_cmp_ne_u32 vcc, 0, v16
    s_nop 1
    v_cndmask_b32 v5, v5, v17, vcc
    s_sub_u32 s4, s20, 12
    s_lshl_b32 s4, s4, 2
    s_add_u32 s4, s4, s3
    s_lshl_b32 s5, s4, 9
    v_lshrrev_b32 v16, 5, v1
    v_lshlrev_b32 v6, 8, v16
    v_and_b32 v16, 15, v1
    v_lshl_add_u32 v6, v16, 4, v6
    v_bfe_u32 v16, v1, 4, 1
    v_lshl_add_u32 v6, v16, 3, v6
    v_add_u32 v6, s5, v6
    s_mul_i32 s5, s4, 43
    s_lshr_b32 s5, s5, 8
    s_mul_i32 s5, s5, 6
    s_add_u32 s4, s4, s5
    s_lshl_b32 s43, s4, 10
    s_add_u32 s43, s43, s22
    s_add_u32 s43, s43, 159744
    s_add_u32 s24, s22, 106496
    s_add_u32 s5, s24, 12288
    buffer_store_dwordx2 v[240:241], v6, s[8:11], s24 offen offset:0 sc1
    buffer_store_dwordx2 v[240:241], v6, s[8:11], s5 offen offset:0 sc1
    s_sub_u32 s4, s20, 12
    s_lshl_b32 s4, s4, 2
    s_add_u32 s4, s4, s3
    s_mul_i32 s5, s4, 43
    s_lshr_b32 s5, s5, 8
    s_mul_i32 s5, s5, 58
    s_add_u32 s4, s4, s5
    s_lshl_b32 s4, s4, 2
    s_add_u32 s44, s4, s22
    s_add_u32 s44, s44, 156672
    v_mov_b32 v14, 0x80000000
    v_writelane_b32 v14, 0, 0
    buffer_store_dword v9, v14, s[8:11], s44 offen offset:0 sc1
    v_mov_b32 v10, 0
    s_mov_b64 exec, 1
    buffer_store_dword v10, v9, s[8:11], s33 offen sc1
    s_mov_b64 exec, -1
    v_and_b32 v16, 15, v1
    v_lshrrev_b32 v17, 4, v1
    v_and_b32 v18, 1, v17
    v_lshlrev_b32 v18, 2, v18
    v_sub_u32 v18, v16, v18
    v_mov_b32 v19, 0x3f80
    v_mov_b32 v20, 0x3f800000
    v_cmp_eq_u32 vcc, 0, v18
    s_nop 1
    v_cndmask_b32 v84, 0, v19, vcc
    v_cmp_eq_u32 vcc, 1, v18
    s_nop 1
    v_cndmask_b32 v84, v84, v20, vcc
    v_cmp_eq_u32 vcc, 2, v18
    s_nop 1
    v_cndmask_b32 v85, 0, v19, vcc
    v_cmp_eq_u32 vcc, 3, v18
    s_nop 1
    v_cndmask_b32 v85, v85, v20, vcc
    v_cmp_eq_u32 vcc, 8, v18
    s_nop 1
    v_cndmask_b32 v86, 0, v19, vcc
    v_cmp_eq_u32 vcc, 9, v18
    s_nop 1
    v_cndmask_b32 v86, v86, v20, vcc
    v_cmp_eq_u32 vcc, 10, v18
    s_nop 1
    v_cndmask_b32 v87, 0, v19, vcc
    v_cmp_eq_u32 vcc, 11, v18
    s_nop 1
    v_cndmask_b32 v87, v87, v20, vcc
    s_lshl_b32 s4, s3, 11
    s_add_u32 s4, s4, 73728
    v_add_u32 v3, s4, v2
    s_lshl_b32 s4, s3, 9
    s_add_u32 s4, s4, 90112
    v_lshl_add_u32 v4, v1, 3, s4
    s_waitcnt vmcnt(0)
    s_barrier
    s_cmp_lg_u32 s3, 0
    s_cbranch_scc1 VA_n
    s_lshl_b32 s4, s99, 5
    s_add_u32 s4, s4, 4
    v_mov_b32 v16, 0
    v_mov_b32 v17, 1
    s_mov_b64 exec, 1
    buffer_atomic_add v17, v16, s[84:87], s4 offen sc1
    s_mov_b64 exec, -1
VA_n:
    s_add_u32 s4, s42, 0
    s_add_u32 m0, s37, 0
    s_nop 0
    buffer_load_dwordx4 v13, s[12:15], s4 offen nt lds
    s_add_u32 s4, s42, 98304
    s_add_u32 m0, s37, 1024
    s_nop 0
    buffer_load_dwordx4 v13, s[12:15], s4 offen nt lds
    s_waitcnt vmcnt(2)
    s_add_u32 s4, s47, 0
    s_add_u32 m0, s37, 81920
    s_nop 0
    buffer_load_dwordx4 v13, s[16:19], s4 offen nt lds
    s_add_u32 s4, s47, 98304
    s_add_u32 m0, s37, 82944
    s_nop 0
    buffer_load_dwordx4 v13, s[16:19], s4 offen nt lds
    s_waitcnt vmcnt(2)
    s_add_u32 s4, s42, 786432
    s_add_u32 m0, s37, 8192
    s_nop 0
    buffer_load_dwordx4 v13, s[12:15], s4 offen nt lds
    s_add_u32 s4, s42, 884736
    s_add_u32 m0, s37, 9216
    s_nop 0
    buffer_load_dwordx4 v13, s[12:15], s4 offen nt lds
    s_waitcnt vmcnt(2)
    s_add_u32 s4, s47, 786432
    s_add_u32 m0, s37, 90112
    s_nop 0
    buffer_load_dwordx4 v13, s[16:19], s4 offen nt lds
    s_add_u32 s4, s47, 884736
    s_add_u32 m0, s37, 91136
    s_nop 0
    buffer_load_dwordx4 v13, s[16:19], s4 offen nt lds
    s_waitcnt vmcnt(2)
    s_add_u32 s4, s42, 1572864
    s_add_u32 m0, s37, 16384
    s_nop 0
    buffer_load_dwordx4 v13, s[12:15], s4 offen nt lds
    s_add_u32 s4, s42, 1671168
    s_add_u32 m0, s37, 17408
    s_nop 0
    buffer_load_dwordx4 v13, s[12:15], s4 offen nt lds
    s_waitcnt vmcnt(2)
    s_add_u32 s4, s47, 1572864
    s_add_u32 m0, s37, 98304
    s_nop 0
    buffer_load_dwordx4 v13, s[16:19], s4 offen nt lds
    s_add_u32 s4, s47, 1671168
    s_add_u32 m0, s37, 99328
    s_nop 0
    buffer_load_dwordx4 v13, s[16:19], s4 offen nt lds
    s_waitcnt vmcnt(2)
    s_add_u32 s4, s42, 2359296
    s_add_u32 m0, s37, 24576
    s_nop 0
    buffer_load_dwordx4 v13, s[12:15], s4 offen nt lds
    s_add_u32 s4, s42, 2457600
    s_add_u32 m0, s37, 25600
    s_nop 0
    buffer_load_dwordx4 v13, s[12:15], s4 offen nt lds
    s_waitcnt vmcnt(2)
    s_add_u32 s4, s47, 2359296
    s_add_u32 m0, s37, 106496
    s_nop 0
    buffer_load_dwordx4 v13, s[16:19], s4 offen nt lds
    s_add_u32 s4, s47, 2457600
    s_add_u32 m0, s37, 107520
    s_nop 0
    buffer_load_dwordx4 v13, s[16:19], s4 offen nt lds
    s_waitcnt vmcnt(2)
    s_add_u32 s4, s42, 3145728
    s_add_u32 m0, s37, 32768
    s_nop 0
    buffer_load_dwordx4 v13, s[12:15], s4 offen nt lds
    s_add_u32 s4, s42, 3244032
    s_add_u32 m0, s37, 33792
    s_nop 0
    buffer_load_dwordx4 v13, s[12:15], s4 offen nt lds
    s_waitcnt vmcnt(2)
    s_add_u32 s4, s47, 3145728
    s_add_u32 m0, s37, 114688
    s_nop 0
    buffer_load_dwordx4 v13, s[16:19], s4 offen nt lds
    s_add_u32 s4, s47, 3244032
    s_add_u32 m0, s37, 115712
    s_nop 0
    buffer_load_dwordx4 v13, s[16:19], s4 offen nt lds
    s_waitcnt vmcnt(2)
    v_and_b32 v16, 7, v1
    v_lshlrev_b32 v16, 5, v16
    buffer_load_dwordx4 v[20:23], v16, s[84:87], 0 offen sc1
    s_add_u32 s4, s42, 3932160
    s_add_u32 m0, s37, 40960
    s_nop 0
    buffer_load_dwordx4 v13, s[12:15], s4 offen nt lds
    s_add_u32 s4, s42, 4030464
    s_add_u32 m0, s37, 41984
    s_nop 0
    buffer_load_dwordx4 v13, s[12:15], s4 offen nt lds
    s_add_u32 s4, s47, 3932160
    s_add_u32 m0, s37, 122880
    s_nop 0
    buffer_load_dwordx4 v13, s[16:19], s4 offen nt lds
    s_add_u32 s4, s47, 4030464
    s_add_u32 m0, s37, 123904
    s_nop 0
    buffer_load_dwordx4 v13, s[16:19], s4 offen nt lds
    s_add_u32 s4, s42, 4718592
    s_add_u32 m0, s37, 49152
    s_nop 0
    buffer_load_dwordx4 v13, s[12:15], s4 offen nt lds
    s_add_u32 s4, s42, 4816896
    s_add_u32 m0, s37, 50176
    s_nop 0
    buffer_load_dwordx4 v13, s[12:15], s4 offen nt lds
    s_add_u32 s4, s47, 4718592
    s_add_u32 m0, s37, 131072
    s_nop 0
    buffer_load_dwordx4 v13, s[16:19], s4 offen nt lds
    s_add_u32 s4, s47, 4816896
    s_add_u32 m0, s37, 132096
    s_nop 0
    buffer_load_dwordx4 v13, s[16:19], s4 offen nt lds
    s_mov_b32 s31, 0
    s_waitcnt vmcnt(8)
    s_branch VI_c
VI_l:
    buffer_load_dwordx4 v[20:23], v16, s[84:87], 0 offen sc1
    s_waitcnt vmcnt(0)
VI_c:
    v_bcnt_u32_b32 v17, v20, v23
    v_cmp_lt_u32 s[4:5], 32, v17
    s_and_b32 s6, s4, 0xff
    v_cmp_ne_u32 s[4:5], 32, v17
    s_cmp_eq_u32 s6, 0
    s_cselect_b32 s5, 0xff, 0
    s_and_b32 s4, s4, s5
    v_cmp_gt_u32 vcc, 22, v21
    s_and_b32 vcc_lo, vcc_lo, 0xff
    s_or_b32 vcc_lo, vcc_lo, s4
    s_mov_b32 vcc_hi, 0
    s_cbranch_vccz VI_o
    s_sleep 16
    s_add_u32 s31, s31, 1
    s_cmp_lt_u32 s31, s30
    s_cbranch_scc1 VI_l
    s_mov_b32 s30, 1
VI_o:
    s_mov_b32 s97, s6
    s_add_u32 s4, s42, 5505024
    s_add_u32 m0, s37, 57344
    s_nop 0
    buffer_load_dwordx4 v13, s[12:15], s4 offen nt lds
    s_add_u32 s4, s42, 5603328
    s_add_u32 m0, s37, 58368
    s_nop 0
    buffer_load_dwordx4 v13, s[12:15], s4 offen nt lds
    s_add_u32 s4, s47, 5505024
    s_add_u32 m0, s37, 139264
    s_nop 0
    buffer_load_dwordx4 v13, s[16:19], s4 offen nt lds
    s_add_u32 s4, s47, 5603328
    s_add_u32 m0, s37, 140288
    s_nop 0
    buffer_load_dwordx4 v13, s[16:19], s4 offen nt lds
    s_add_u32 s4, s42, 6291456
    s_add_u32 m0, s37, 65536
    s_nop 0
    buffer_load_dwordx4 v13, s[12:15], s4 offen nt lds
    s_add_u32 s4, s42, 6389760
    s_add_u32 m0, s37, 66560
    s_nop 0
    buffer_load_dwordx4 v13, s[12:15], s4 offen nt lds
    s_add_u32 s4, s47, 6291456
    s_add_u32 m0, s37, 147456
    s_nop 0
    buffer_load_dwordx4 v13, s[16:19], s4 offen nt lds
    s_add_u32 s4, s47, 6389760
    s_add_u32 m0, s37, 148480
    s_nop 0
    buffer_load_dwordx4 v13, s[16:19], s4 offen nt lds
    s_add_u32 s4, s42, 7077888
    s_add_u32 m0, s37, 73728
    s_nop 0
    buffer_load_dwordx4 v13, s[12:15], s4 offen nt lds
    s_add_u32 s4, s42, 7176192
    s_add_u32 m0, s37, 74752
    s_nop 0
    buffer_load_dwordx4 v13, s[12:15], s4 offen nt lds
    s_add_u32 s4, s47, 7077888
    s_add_u32 m0, s37, 155648
    s_nop 0
    buffer_load_dwordx4 v13, s[16:19], s4 offen nt lds
    s_add_u32 s4, s47, 7176192
    s_add_u32 m0, s37, 156672
    s_nop 0
    buffer_load_dwordx4 v13, s[16:19], s4 offen nt lds
    s_barrier
    s_and_b32 s4, s3, 1
    s_lshl_b32 s4, s4, 6
    v_xor_b32 v60, s4, v0
    s_lshr_b32 s4, s3, 1
    s_mul_i32 s4, s4, 81920
    v_add_u32 v60, s4, v60
    v_xor_b32 v61, 32, v60
    ds_read_b64_tr_b16 a[0:1], v60 offset:0
    ds_read_b64_tr_b16 a[2:3], v60 offset:256
    ds_read_b64_tr_b16 a[4:5], v60 offset:4096
    ds_read_b64_tr_b16 a[6:7], v60 offset:4352
    ds_read_b64_tr_b16 a[8:9], v60 offset:8192
    ds_read_b64_tr_b16 a[10:11], v60 offset:8448
    ds_read_b64_tr_b16 a[12:13], v60 offset:12288
    ds_read_b64_tr_b16 a[14:15], v60 offset:12544
    ds_read_b64_tr_b16 a[16:17], v60 offset:16384
    ds_read_b64_tr_b16 a[18:19], v60 offset:16640
    ds_read_b64_tr_b16 a[20:21], v60 offset:20480
    ds_read_b64_tr_b16 a[22:23], v60 offset:20736
    ds_read_b64_tr_b16 a[24:25], v60 offset:24576
    ds_read_b64_tr_b16 a[26:27], v60 offset:24832
    ds_read_b64_tr_b16 a[28:29], v60 offset:28672
    ds_read_b64_tr_b16 a[30:31], v60 offset:28928
    ds_read_b64_tr_b16 a[32:33], v60 offset:32768
    ds_read_b64_tr_b16 a[34:35], v60 offset:33024
    ds_read_b64_tr_b16 a[36:37], v60 offset:36864
    ds_read_b64_tr_b16 a[38:39], v60 offset:37120
    ds_read_b64_tr_b16 a[80:81], v61 offset:0
    ds_read_b64_tr_b16 a[82:83], v61 offset:256
    ds_read_b64_tr_b16 a[84:85], v61 offset:4096
    ds_read_b64_tr_b16 a[86:87], v61 offset:4352
    ds_read_b64_tr_b16 a[88:89], v61 offset:8192
    ds_read_b64_tr_b16 a[90:91], v61 offset:8448
    ds_read_b64_tr_b16 a[92:93], v61 offset:12288
    ds_read_b64_tr_b16 a[94:95], v61 offset:12544
    ds_read_b64_tr_b16 a[96:97], v61 offset:16384
    ds_read_b64_tr_b16 a[98:99], v61 offset:16640
    ds_read_b64_tr_b16 a[100:101], v61 offset:20480
    ds_read_b64_tr_b16 a[102:103], v61 offset:20736
    ds_read_b64_tr_b16 a[104:105], v61 offset:24576
    ds_read_b64_tr_b16 a[106:107], v61 offset:24832
    ds_read_b64_tr_b16 a[108:109], v61 offset:28672
    ds_read_b64_tr_b16 a[110:111], v61 offset:28928
    ds_read_b64_tr_b16 a[112:113], v61 offset:32768
    ds_read_b64_tr_b16 a[114:115], v61 offset:33024
    ds_read_b64_tr_b16 a[116:117], v61 offset:36864
    ds_read_b64_tr_b16 a[118:119], v61 offset:37120
    v_and_b32 v7, 0xf0, v2
    v_lshrrev_b32 v16, 5, v1
    v_lshl_add_u32 v7, v16, 13, v7
    v_bfe_u32 v16, v1, 4, 1
    v_lshl_add_u32 v7, v16, 11, v7
    s_sub_u32 s4, s20, 12
    s_lshl_b32 s4, s4, 2
    s_add_u32 s4, s4, s3
    s_lshr_b32 s6, s4, 1
    s_lshl_b32 s6, s6, 14
    s_and_b32 s7, s4, 1
    s_lshl_b32 s7, s7, 12
    s_add_u32 s6, s6, s7
    s_lshl_b32 s7, s99, 8
    s_add_u32 s6, s6, s7
    s_add_u32 s36, s6, 2097152
    s_cmp_lt_u32 s4, 20
    s_cselect_b32 s4, 0, 0x80000000
    v_add_u32 v7, s4, v7
    s_mul_i32 s27, s3, 10240
    s_add_u32 s28, s27, 16777216
    s_mov_b32 s29, 0
    s_mov_b32 s21, 0
    s_mov_b32 s32, 0
    s_cmp_lg_u32 s3, 0
    s_cbranch_scc1 VH_o
    s_lshl_b32 s23, s99, 7
    s_add_u32 s23, s23, 81920
    s_mov_b32 s31, 0
VH_l:
    s_load_dwordx4 s[4:7], s[8:9], s23 glc
    s_waitcnt lgkmcnt(0)
    s_and_b64 s[4:5], s[4:5], s[6:7]
    s_and_b32 s4, s4, s5
    s_cbranch_scc1 VH_o
    s_sleep 8
    s_add_u32 s31, s31, 1
    s_cmp_lt_u32 s31, s30
    s_cbranch_scc1 VH_l
    s_mov_b32 s30, 1
VH_o:
    s_waitcnt lgkmcnt(0)
    s_barrier
    v_and_b32 v16, 7, v1
    v_lshlrev_b32 v16, 5, v16
    buffer_load_dwordx4 v[20:23], v16, s[84:87], 0 offen sc1
    s_add_u32 s35, s28, 0
    s_add_u32 m0, s27, 0
    s_nop 0
    buffer_load_dwordx4 v2, s[8:11], s35 offen offset:0 sc1 lds
    buffer_load_dwordx4 v2, s[8:11], s35 offen offset:1024 sc1 lds
    buffer_load_dwordx4 v2, s[8:11], s35 offen offset:2048 sc1 lds
    buffer_load_dwordx4 v2, s[8:11], s35 offen offset:3072 sc1 lds
    s_add_u32 s35, s28, 4096
    s_add_u32 m0, s27, 4096
    s_nop 0
    buffer_load_dwordx4 v2, s[8:11], s35 offen offset:0 sc1 lds
    buffer_load_dwordx4 v2, s[8:11], s35 offen offset:1024 sc1 lds
    buffer_load_dwordx4 v2, s[8:11], s35 offen offset:2048 sc1 lds
    buffer_load_dwordx4 v2, s[8:11], s35 offen offset:3072 sc1 lds
    s_add_u32 s35, s28, 8192
    s_add_u32 m0, s27, 8192
    s_nop 0
    buffer_load_dwordx4 v2, s[8:11], s35 offen offset:0 sc1 lds
    buffer_load_dwordx4 v2, s[8:11], s35 offen offset:1024 sc1 lds
    s_waitcnt vmcnt(11)
    s_barrier
    ds_read_b64_tr_b16 a[40:41], v60 offset:40960
    ds_read_b64_tr_b16 a[42:43], v60 offset:41216
    ds_read_b64_tr_b16 a[44:45], v60 offset:45056
    ds_read_b64_tr_b16 a[46:47], v60 offset:45312
    ds_read_b64_tr_b16 a[48:49], v60 offset:49152
    ds_read_b64_tr_b16 a[50:51], v60 offset:49408
    ds_read_b64_tr_b16 a[52:53], v60 offset:53248
    ds_read_b64_tr_b16 a[54:55], v60 offset:53504
    ds_read_b64_tr_b16 a[56:57], v60 offset:57344
    ds_read_b64_tr_b16 a[58:59], v60 offset:57600
    ds_read_b64_tr_b16 a[60:61], v60 offset:61440
    ds_read_b64_tr_b16 a[62:63], v60 offset:61696
    v_add_u32 v60, 65536, v60
    ds_read_b64_tr_b16 a[64:65], v60 offset:0
    ds_read_b64_tr_b16 a[66:67], v60 offset:256
    ds_read_b64_tr_b16 a[68:69], v60 offset:4096
    ds_read_b64_tr_b16 a[70:71], v60 offset:4352
    ds_read_b64_tr_b16 a[72:73], v60 offset:8192
    ds_read_b64_tr_b16 a[74:75], v60 offset:8448
    ds_read_b64_tr_b16 a[76:77], v60 offset:12288
    ds_read_b64_tr_b16 a[78:79], v60 offset:12544
    ds_read_b64_tr_b16 a[120:121], v61 offset:40960
    ds_read_b64_tr_b16 a[122:123], v61 offset:41216
    ds_read_b64_tr_b16 a[124:125], v61 offset:45056
    ds_read_b64_tr_b16 a[126:127], v61 offset:45312
    ds_read_b64_tr_b16 a[128:129], v61 offset:49152
    ds_read_b64_tr_b16 a[130:131], v61 offset:49408
    ds_read_b64_tr_b16 a[132:133], v61 offset:53248
    ds_read_b64_tr_b16 a[134:135], v61 offset:53504
    ds_read_b64_tr_b16 a[136:137], v61 offset:57344
    ds_read_b64_tr_b16 a[138:139], v61 offset:57600
    ds_read_b64_tr_b16 a[140:141], v61 offset:61440
    ds_read_b64_tr_b16 a[142:143], v61 offset:61696
    v_add_u32 v61, 65536, v61
    ds_read_b64_tr_b16 a[144:145], v61 offset:0
    ds_read_b64_tr_b16 a[146:147], v61 offset:256
    ds_read_b64_tr_b16 a[148:149], v61 offset:4096
    ds_read_b64_tr_b16 a[150:151], v61 offset:4352
    ds_read_b64_tr_b16 a[152:153], v61 offset:8192
    ds_read_b64_tr_b16 a[154:155], v61 offset:8448
    ds_read_b64_tr_b16 a[156:157], v61 offset:12288
    ds_read_b64_tr_b16 a[158:159], v61 offset:12544
    s_mov_b32 s31, 0
    s_waitcnt vmcnt(10)
    s_branch VJ_c
VJ_l:
    buffer_load_dwordx4 v[20:23], v16, s[84:87], 0 offen sc1
    s_waitcnt vmcnt(0)
VJ_c:
    v_bcnt_u32_b32 v17, v20, v23
    v_cmp_lt_u32 s[4:5], 32, v17
    s_and_b32 s6, s4, 0xff
    v_cmp_ne_u32 s[4:5], 32, v17
    s_cmp_eq_u32 s6, 0
    s_cselect_b32 s5, 0xff, 0
    s_and_b32 s4, s4, s5
    v_add_u32 v21, v21, v22
    v_cmp_gt_u32 vcc, 32, v21
    s_and_b32 vcc_lo, vcc_lo, 0xff
    s_or_b32 vcc_lo, vcc_lo, s4
    s_mov_b32 vcc_hi, 0
    s_cbranch_vccz VJ_o
    s_sleep 16
    s_add_u32 s31, s31, 1
    s_cmp_lt_u32 s31, s30
    s_cbranch_scc1 VJ_l
    s_mov_b32 s30, 1
VJ_o:
    s_mov_b32 s97, s6
    v_min_u32 v67, 55, v1
    v_lshlrev_b32 v67, 7, v67
    v_min_u32 v70, 3968, v67
    v_min_u32 v71, 896, v67
    s_mov_b32 s49, 65536
    s_mov_b32 s23, 65540
    s_mov_b32 s47, 72708
    s_waitcnt lgkmcnt(0)
    s_barrier
    s_add_u32 s28, s28, 40960
    s_cmp_lg_u32 s97, 0
    s_cbranch_scc1 Vs_go
Vf_go:
    s_waitcnt vmcnt(0)
    s_barrier
    v_add_u32 v11, s29, v2
    s_xor_b32 s29, s29, 40960
    s_add_u32 s42, s29, s27
    ds_read_b128 a[160:163], v11 offset:0
    ds_read_b128 a[164:167], v11 offset:20480
    ds_read_b128 a[168:171], v11 offset:1024
    ds_read_b128 a[172:175], v11 offset:21504
    ds_read_b128 a[176:179], v11 offset:2048
    ds_read_b128 a[180:183], v11 offset:22528
    s_waitcnt lgkmcnt(5)
    v_mfma_f32_16x16x32_bf16 v[144:147], a[0:3], a[160:163], 0
    ds_read_b128 a[184:187], v11 offset:3072
    v_mfma_f32_16x16x32_bf16 v[152:155], a[80:83], a[160:163], 0
    s_waitcnt lgkmcnt(5)
    v_mfma_f32_16x16x32_bf16 v[148:151], a[0:3], a[164:167], 0
    ds_read_b128 a[188:191], v11 offset:23552
    v_mfma_f32_16x16x32_bf16 v[156:159], a[80:83], a[164:167], 0
    s_waitcnt lgkmcnt(5)
    v_mfma_f32_16x16x32_bf16 v[144:147], a[4:7], a[168:171], v[144:147]
    ds_read_b128 a[160:163], v11 offset:4096
    s_add_u32 s35, s28, 0
    s_add_u32 m0, s42, 0
    v_mfma_f32_16x16x32_bf16 v[152:155], a[84:87], a[168:171], v[152:155]
    buffer_load_dwordx4 v2, s[8:11], s35 offen offset:0 sc1 lds
    s_waitcnt lgkmcnt(5)
    v_mfma_f32_16x16x32_bf16 v[148:151], a[4:7], a[172:175], v[148:151]
    ds_read_b128 a[164:167], v11 offset:24576
    v_mfma_f32_16x16x32_bf16 v[156:159], a[84:87], a[172:175], v[156:159]
    s_waitcnt lgkmcnt(5)
    v_mfma_f32_16x16x32_bf16 v[144:147], a[8:11], a[176:179], v[144:147]
    ds_read_b128 a[168:171], v11 offset:5120
    v_mfma_f32_16x16x32_bf16 v[152:155], a[88:91], a[176:179], v[152:155]
    s_waitcnt lgkmcnt(5)
    v_mfma_f32_16x16x32_bf16 v[148:151], a[8:11], a[180:183], v[148:151]
    ds_read_b128 a[172:175], v11 offset:25600
    v_mfma_f32_16x16x32_bf16 v[156:159], a[88:91], a[180:183], v[156:159]
    buffer_load_dwordx4 v2, s[8:11], s35 offen offset:1024 sc1 lds
    s_waitcnt lgkmcnt(5)
    v_mfma_f32_16x16x32_bf16 v[144:147], a[12:15], a[184:187], v[144:147]
    ds_read_b128 a[176:179], v11 offset:6144
    v_mfma_f32_16x16x32_bf16 v[152:155], a[92:95], a[184:187], v[152:155]
    s_waitcnt lgkmcnt(5)
    v_mfma_f32_16x16x32_bf16 v[148:151], a[12:15], a[188:191], v[148:151]
    ds_read_b128 a[180:183], v11 offset:26624
    v_mfma_f32_16x16x32_bf16 v[156:159], a[92:95], a[188:191], v[156:159]
    s_waitcnt lgkmcnt(5)
    v_mfma_f32_16x16x32_bf16 v[144:147], a[16:19], a[160:163], v[144:147]
    ds_read_b128 a[184:187], v11 offset:7168
    v_mfma_f32_16x16x32_bf16 v[152:155], a[96:99], a[160:163], v[152:155]
    buffer_load_dwordx4 v2, s[8:11], s35 offen offset:2048 sc1 lds
    s_waitcnt lgkmcnt(5)
    v_mfma_f32_16x16x32_bf16 v[148:151], a[16:19], a[164:167], v[148:151]
    ds_read_b128 a[188:191], v11 offset:27648
    v_mfma_f32_16x16x32_bf16 v[156:159], a[96:99], a[164:167], v[156:159]
    s_waitcnt lgkmcnt(5)
    v_mfma_f32_16x16x32_bf16 v[144:147], a[20:23], a[168:171], v[144:147]
    ds_read_b128 a[160:163], v11 offset:8192
    v_mfma_f32_16x16x32_bf16 v[152:155], a[100:103], a[168:171], v[152:155]
    s_waitcnt lgkmcnt(5)
    v_mfma_f32_16x16x32_bf16 v[148:151], a[20:23], a[172:175], v[148:151]
    ds_read_b128 a[164:167], v11 offset:28672
    v_mfma_f32_16x16x32_bf16 v[156:159], a[100:103], a[172:175], v[156:159]
    buffer_load_dwordx4 v2, s[8:11], s35 offen offset:3072 sc1 lds
    s_waitcnt lgkmcnt(5)
    v_mfma_f32_16x16x32_bf16 v[144:147], a[24:27], a[176:179], v[144:147]
    ds_read_b128 a[168:171], v11 offset:9216
    v_mfma_f32_16x16x32_bf16 v[152:155], a[104:107], a[176:179], v[152:155]
    s_waitcnt lgkmcnt(5)
    v_mfma_f32_16x16x32_bf16 v[148:151], a[24:27], a[180:183], v[148:151]
    ds_read_b128 a[172:175], v11 offset:29696
    v_mfma_f32_16x16x32_bf16 v[156:159], a[104:107], a[180:183], v[156:159]
    s_waitcnt lgkmcnt(5)
    v_mfma_f32_16x16x32_bf16 v[144:147], a[28:31], a[184:187], v[144:147]
    ds_read_b128 a[176:179], v11 offset:10240
    s_add_u32 s35, s28, 4096
    s_add_u32 m0, s42, 4096
    v_mfma_f32_16x16x32_bf16 v[152:155], a[108:111], a[184:187], v[152:155]
    buffer_load_dwordx4 v2, s[8:11], s35 offen offset:0 sc1 lds
    s_waitcnt lgkmcnt(5)
    v_mfma_f32_16x16x32_bf16 v[148:151], a[28:31], a[188:191], v[148:151]
    ds_read_b128 a[180:183], v11 offset:30720
    v_mfma_f32_16x16x32_bf16 v[156:159], a[108:111], a[188:191], v[156:159]
    s_waitcnt lgkmcnt(5)
    v_mfma_f32_16x16x32_bf16 v[144:147], a[32:35], a[160:163], v[144:147]
    ds_read_b128 a[184:187], v11 offset:11264
    v_mfma_f32_16x16x32_bf16 v[152:155], a[112:115], a[160:163], v[152:155]
    s_waitcnt lgkmcnt(5)
    v_mfma_f32_16x16x32_bf16 v[148:151], a[32:35], a[164:167], v[148:151]
    ds_read_b128 a[188:191], v11 offset:31744
    v_mfma_f32_16x16x32_bf16 v[156:159], a[112:115], a[164:167], v[156:159]
    buffer_load_dwordx4 v2, s[8:11], s35 offen offset:1024 sc1 lds
    s_waitcnt lgkmcnt(5)
    v_mfma_f32_16x16x32_bf16 v[144:147], a[36:39], a[168:171], v[144:147]
    ds_read_b128 a[160:163], v11 offset:12288
    v_mfma_f32_16x16x32_bf16 v[152:155], a[116:119], a[168:171], v[152:155]
    s_waitcnt lgkmcnt(5)
    v_mfma_f32_16x16x32_bf16 v[148:151], a[36:39], a[172:175], v[148:151]
    ds_read_b128 a[164:167], v11 offset:32768
    v_mfma_f32_16x16x32_bf16 v[156:159], a[116:119], a[172:175], v[156:159]
    s_waitcnt lgkmcnt(5)
    v_mfma_f32_16x16x32_bf16 v[144:147], a[40:43], a[176:179], v[144:147]
    ds_read_b128 a[168:171], v11 offset:13312
    v_mfma_f32_16x16x32_bf16 v[152:155], a[120:123], a[176:179], v[152:155]
    buffer_load_dwordx4 v2, s[8:11], s35 offen offset:2048 sc1 lds
    s_waitcnt lgkmcnt(5)
    v_mfma_f32_16x16x32_bf16 v[148:151], a[40:43], a[180:183], v[148:151]
    ds_read_b128 a[172:175], v11 offset:33792
    v_mfma_f32_16x16x32_bf16 v[156:159], a[120:123], a[180:183], v[156:159]
    s_waitcnt lgkmcnt(5)
    v_mfma_f32_16x16x32_bf16 v[144:147], a[44:47], a[184:187], v[144:147]
    ds_read_b128 a[176:179], v11 offset:14336
    v_mfma_f32_16x16x32_bf16 v[152:155], a[124:127], a[184:187], v[152:155]
    s_waitcnt lgkmcnt(5)
    v_mfma_f32_16x16x32_bf16 v[148:151], a[44:47], a[188:191], v[148:151]
    ds_read_b128 a[180:183], v11 offset:34816
    v_mfma_f32_16x16x32_bf16 v[156:159], a[124:127], a[188:191], v[156:159]
    buffer_load_dwordx4 v2, s[8:11], s35 offen offset:3072 sc1 lds
    s_waitcnt lgkmcnt(5)
    v_mfma_f32_16x16x32_bf16 v[144:147], a[48:51], a[160:163], v[144:147]
    ds_read_b128 a[184:187], v11 offset:15360
    v_mfma_f32_16x16x32_bf16 v[152:155], a[128:131], a[160:163], v[152:155]
    s_waitcnt lgkmcnt(5)
    v_mfma_f32_16x16x32_bf16 v[148:151], a[48:51], a[164:167], v[148:151]
    ds_read_b128 a[188:191], v11 offset:35840
    v_mfma_f32_16x16x32_bf16 v[156:159], a[128:131], a[164:167], v[156:159]
    s_waitcnt lgkmcnt(5)
    v_mfma_f32_16x16x32_bf16 v[144:147], a[52:55], a[168:171], v[144:147]
    ds_read_b128 a[160:163], v11 offset:16384
    s_add_u32 s35, s28, 8192
    s_add_u32 m0, s42, 8192
    v_mfma_f32_16x16x32_bf16 v[152:155], a[132:135], a[168:171], v[152:155]
    buffer_load_dwordx4 v2, s[8:11], s35 offen offset:0 sc1 lds
    s_waitcnt lgkmcnt(5)
    v_mfma_f32_16x16x32_bf16 v[148:151], a[52:55], a[172:175], v[148:151]
    ds_read_b128 a[164:167], v11 offset:36864
    v_mfma_f32_16x16x32_bf16 v[156:159], a[132:135], a[172:175], v[156:159]
    s_waitcnt lgkmcnt(5)
    v_mfma_f32_16x16x32_bf16 v[144:147], a[56:59], a[176:179], v[144:147]
    ds_read_b128 a[168:171], v11 offset:17408
    v_mfma_f32_16x16x32_bf16 v[152:155], a[136:139], a[176:179], v[152:155]
    s_waitcnt lgkmcnt(5)
    v_mfma_f32_16x16x32_bf16 v[148:151], a[56:59], a[180:183], v[148:151]
    ds_read_b128 a[172:175], v11 offset:37888
    v_mfma_f32_16x16x32_bf16 v[156:159], a[136:139], a[180:183], v[156:159]
    buffer_load_dwordx4 v2, s[8:11], s35 offen offset:1024 sc1 lds
    s_waitcnt lgkmcnt(5)
    v_mfma_f32_16x16x32_bf16 v[144:147], a[60:63], a[184:187], v[144:147]
    ds_read_b128 a[176:179], v11 offset:18432
    v_mfma_f32_16x16x32_bf16 v[152:155], a[140:143], a[184:187], v[152:155]
    s_waitcnt lgkmcnt(5)
    v_mfma_f32_16x16x32_bf16 v[148:151], a[60:63], a[188:191], v[148:151]
    ds_read_b128 a[180:183], v11 offset:38912
    v_mfma_f32_16x16x32_bf16 v[156:159], a[140:143], a[188:191], v[156:159]
    s_waitcnt lgkmcnt(5)
    v_mfma_f32_16x16x32_bf16 v[144:147], a[64:67], a[160:163], v[144:147]
    ds_read_b128 a[184:187], v11 offset:19456
    v_mfma_f32_16x16x32_bf16 v[152:155], a[144:147], a[160:163], v[152:155]
    s_waitcnt lgkmcnt(5)
    v_mfma_f32_16x16x32_bf16 v[148:151], a[64:67], a[164:167], v[148:151]
    ds_read_b128 a[188:191], v11 offset:39936
    v_mfma_f32_16x16x32_bf16 v[156:159], a[144:147], a[164:167], v[156:159]
    s_waitcnt lgkmcnt(5)
    v_mfma_f32_16x16x32_bf16 v[144:147], a[68:71], a[168:171], v[144:147]
    v_mfma_f32_16x16x32_bf16 v[152:155], a[148:151], a[168:171], v[152:155]
    s_waitcnt lgkmcnt(4)
    v_mfma_f32_16x16x32_bf16 v[148:151], a[68:71], a[172:175], v[148:151]
    v_mfma_f32_16x16x32_bf16 v[156:159], a[148:151], a[172:175], v[156:159]
    s_waitcnt lgkmcnt(3)
    v_mfma_f32_16x16x32_bf16 v[144:147], a[72:75], a[176:179], v[144:147]
    v_mfma_f32_16x16x32_bf16 v[152:155], a[152:155], a[176:179], v[152:155]
    s_waitcnt lgkmcnt(2)
    v_mfma_f32_16x16x32_bf16 v[148:151], a[72:75], a[180:183], v[148:151]
    v_mfma_f32_16x16x32_bf16 v[156:159], a[152:155], a[180:183], v[156:159]
    s_waitcnt lgkmcnt(1)
    v_mfma_f32_16x16x32_bf16 v[144:147], a[76:79], a[184:187], v[144:147]
    v_mfma_f32_16x16x32_bf16 v[152:155], a[156:159], a[184:187], v[152:155]
    s_waitcnt lgkmcnt(0)
    v_mfma_f32_16x16x32_bf16 v[148:151], a[76:79], a[188:191], v[148:151]
    v_mfma_f32_16x16x32_bf16 v[156:159], a[156:159], a[188:191], v[156:159]
    s_add_u32 s28, s28, 40960
    s_add_u32 s32, s32, 1
    buffer_load_dword v68, v71, s[8:11], s49 offen offset:0 sc1
    s_add_u32 s4, s32, 3
    s_and_b32 s4, s4, 3
    s_mul_i32 s4, s4, 49152
    s_add_u32 s4, s4, s43
    s_add_u32 s5, s4, 6144
    v_cvt_pk_bf16_f32 v160, v144, v145
    v_cvt_pk_bf16_f32 v161, v152, v153
    v_cvt_pk_bf16_f32 v162, v146, v147
    v_cvt_pk_bf16_f32 v163, v154, v155
    buffer_store_dwordx4 v[160:163], v2, s[8:11], s4 offen offset:0
    v_cvt_pk_bf16_f32 v164, v148, v149
    v_cvt_pk_bf16_f32 v165, v156, v157
    v_cvt_pk_bf16_f32 v166, v150, v151
    v_cvt_pk_bf16_f32 v167, v158, v159
    buffer_store_dwordx4 v[164:167], v2, s[8:11], s5 offen offset:0
    s_waitcnt vmcnt(0)
    v_mov_b32 v10, s32
    s_mov_b64 exec, 1
    buffer_store_dword v10, v9, s[8:11], s33 offen
    s_mov_b64 exec, -1
Vf_loop:
    s_and_b32 s4, s21, 3
    s_mul_i32 s5, s4, 10240
    s_add_u32 s5, s5, s22
    s_sub_u32 s38, s5, 73728
    s_sub_u32 s39, s5, 81920
    s_mul_i32 s5, s4, 12288
    s_add_u32 s25, s24, s5
    s_xor_b32 s4, s4, 2
    s_mul_i32 s5, s4, 163840
    s_add_u32 s34, s36, s5
    s_mul_i32 s5, s4, 12288
    s_add_u32 s26, s24, s5
    s_add_u32 s21, s21, 1
    v_mov_b32 v72, 0
    v_mov_b32 v73, 0
    v_mov_b32 v74, 0
    v_mov_b32 v75, 0
    v_mov_b32 v76, 0
    v_mov_b32 v77, 0
    v_mov_b32 v78, 0
    v_mov_b32 v79, 0
    v_mov_b32 v59, s21
    s_cmp_eq_u32 s3, 1
    s_cbranch_scc1 Vf_q1
    s_cmp_eq_u32 s3, 2
    s_cbranch_scc1 Vf_q2
    s_cmp_eq_u32 s3, 3
    s_cbranch_scc1 Vf_q3
Vf_q0:
    s_mov_b64 s[4:5], -1
    s_mov_b64 s[6:7], -1
    s_mov_b64 s[92:93], -1
    s_mov_b32 s31, -1
Vf0m_l:
    s_mov_b64 exec, s[4:5]
    buffer_load_dwordx4 v[16:19], v3, s[8:11], s38 offen offset:0 sc1
    s_mov_b64 exec, s[6:7]
    buffer_load_dwordx4 v[20:23], v3, s[8:11], s38 offen offset:1024 sc1
    s_mov_b64 exec, s[92:93]
    buffer_load_dwordx2 v[56:57], v4, s[8:11], s39 offen offset:0 sc1
    s_mov_b64 exec, -1
    s_add_u32 s31, s31, 1
    s_cmp_lt_u32 s31, s30
    s_cselect_b32 s30, s30, 1
    s_cbranch_scc0 Vf0m_o
    s_waitcnt vmcnt(0)
    v_max3_u32 v58, v16, v17, v18
    v_max3_u32 v60, v20, v21, v22
    v_max_u32 v61, v56, v57
    v_max_u32 v58, v58, v19
    v_max_u32 v60, v60, v23
    v_cmp_eq_u32 s[92:93], -1, v61
    v_cmp_eq_u32 s[4:5], -1, v58
    v_cmp_eq_u32 s[6:7], -1, v60
    s_or_b64 s[94:95], s[92:93], s[4:5]
    s_or_b64 s[94:95], s[94:95], s[6:7]
    s_cbranch_scc1 Vf0m_l
Vf0m_o:
    ds_write_b128 v3, v[16:19] offset:8192
    ds_write_b128 v3, v[20:23] offset:9216
    ds_write_b64 v4, v[56:57]
    v_smfmac_f32_16x16x64_bf16 v[72:75], v[16:19], a[0:7], v5
    v_smfmac_f32_16x16x64_bf16 v[76:79], v[16:19], a[80:87], v5
    s_waitcnt lgkmcnt(0)
    s_barrier
    ds_read_b128 v[24:27], v3 offset:10240
    ds_read_b128 v[28:31], v3 offset:11264
    ds_read_b128 v[32:35], v3 offset:12288
    v_smfmac_f32_16x16x64_bf16 v[72:75], v[20:23], a[8:15], v5
    ds_read_b128 v[36:39], v3 offset:13312
    ds_read_b128 v[40:43], v3 offset:14336
    v_smfmac_f32_16x16x64_bf16 v[76:79], v[20:23], a[88:95], v5
    ds_read_b128 v[44:47], v3 offset:15360
    ds_read_b128 v[48:51], v3 offset:16384
    ds_read_b128 v[52:55], v3 offset:17408
    s_waitcnt lgkmcnt(7)
    v_smfmac_f32_16x16x64_bf16 v[72:75], v[24:27], a[16:23], v5
    v_smfmac_f32_16x16x64_bf16 v[76:79], v[24:27], a[96:103], v5
    s_waitcnt lgkmcnt(6)
    v_smfmac_f32_16x16x64_bf16 v[72:75], v[28:31], a[24:31], v5
    v_smfmac_f32_16x16x64_bf16 v[76:79], v[28:31], a[104:111], v5
    s_waitcnt lgkmcnt(5)
    v_smfmac_f32_16x16x64_bf16 v[72:75], v[32:35], a[32:39], v5
    v_smfmac_f32_16x16x64_bf16 v[76:79], v[32:35], a[112:119], v5
    s_waitcnt lgkmcnt(4)
    v_smfmac_f32_16x16x64_bf16 v[72:75], v[36:39], a[40:47], v5
    v_smfmac_f32_16x16x64_bf16 v[76:79], v[36:39], a[120:127], v5
    s_waitcnt lgkmcnt(3)
    v_smfmac_f32_16x16x64_bf16 v[72:75], v[40:43], a[48:55], v5
    v_smfmac_f32_16x16x64_bf16 v[76:79], v[40:43], a[128:135], v5
    s_waitcnt lgkmcnt(2)
    v_smfmac_f32_16x16x64_bf16 v[72:75], v[44:47], a[56:63], v5
    v_smfmac_f32_16x16x64_bf16 v[76:79], v[44:47], a[136:143], v5
    s_waitcnt lgkmcnt(1)
    v_smfmac_f32_16x16x64_bf16 v[72:75], v[48:51], a[64:71], v5
    buffer_store_dword v59, v14, s[8:11], s44 offen offset:0
    v_smfmac_f32_16x16x64_bf16 v[76:79], v[48:51], a[144:151], v5
    s_waitcnt lgkmcnt(0)
    v_smfmac_f32_16x16x64_bf16 v[72:75], v[52:55], a[72:79], v5
    v_smfmac_f32_16x16x64_bf16 v[76:79], v[52:55], a[152:159], v5
    s_nop 3
    v_cvt_pk_bf16_f32 v80, v72, v73
    v_cvt_pk_bf16_f32 v81, v74, v75
    s_nop 1
    v_cvt_pk_bf16_f32 v82, v76, v77
    v_cvt_pk_bf16_f32 v83, v78, v79
    s_nop 1
    v_mfma_f32_16x16x32_bf16 v[88:91], v[80:83], v[84:87], 0
    s_branch Vf_qj
Vf_q1:
    s_mov_b64 s[4:5], -1
    s_mov_b64 s[6:7], -1
    s_mov_b64 s[92:93], -1
    s_mov_b32 s31, -1
Vf1m_l:
    s_mov_b64 exec, s[4:5]
    buffer_load_dwordx4 v[16:19], v3, s[8:11], s38 offen offset:0 sc1
    s_mov_b64 exec, s[6:7]
    buffer_load_dwordx4 v[20:23], v3, s[8:11], s38 offen offset:1024 sc1
    s_mov_b64 exec, s[92:93]
    buffer_load_dwordx2 v[56:57], v4, s[8:11], s39 offen offset:0 sc1
    s_mov_b64 exec, -1
    s_add_u32 s31, s31, 1
    s_cmp_lt_u32 s31, s30
    s_cselect_b32 s30, s30, 1
    s_cbranch_scc0 Vf1m_o
    s_waitcnt vmcnt(0)
    v_max3_u32 v58, v16, v17, v18
    v_max3_u32 v60, v20, v21, v22
    v_max_u32 v61, v56, v57
    v_max_u32 v58, v58, v19
    v_max_u32 v60, v60, v23
    v_cmp_eq_u32 s[92:93], -1, v61
    v_cmp_eq_u32 s[4:5], -1, v58
    v_cmp_eq_u32 s[6:7], -1, v60
    s_or_b64 s[94:95], s[92:93], s[4:5]
    s_or_b64 s[94:95], s[94:95], s[6:7]
    s_cbranch_scc1 Vf1m_l
Vf1m_o:
    ds_write_b128 v3, v[16:19] offset:8192
    ds_write_b128 v3, v[20:23] offset:9216
    ds_write_b64 v4, v[56:57]
    v_smfmac_f32_16x16x64_bf16 v[72:75], v[16:19], a[16:23], v5
    v_smfmac_f32_16x16x64_bf16 v[76:79], v[16:19], a[96:103], v5
    s_waitcnt lgkmcnt(0)
    s_barrier
    ds_read_b128 v[24:27], v3 offset:10240
    ds_read_b128 v[28:31], v3 offset:11264
    ds_read_b128 v[32:35], v3 offset:12288
    v_smfmac_f32_16x16x64_bf16 v[72:75], v[20:23], a[24:31], v5
    ds_read_b128 v[36:39], v3 offset:13312
    ds_read_b128 v[40:43], v3 offset:6144
    v_smfmac_f32_16x16x64_bf16 v[76:79], v[20:23], a[104:111], v5
    ds_read_b128 v[44:47], v3 offset:7168
    ds_read_b128 v[48:51], v3 offset:14336
    ds_read_b128 v[52:55], v3 offset:15360
    s_waitcnt lgkmcnt(7)
    v_smfmac_f32_16x16x64_bf16 v[72:75], v[24:27], a[32:39], v5
    v_smfmac_f32_16x16x64_bf16 v[76:79], v[24:27], a[112:119], v5
    s_waitcnt lgkmcnt(6)
    v_smfmac_f32_16x16x64_bf16 v[72:75], v[28:31], a[40:47], v5
    v_smfmac_f32_16x16x64_bf16 v[76:79], v[28:31], a[120:127], v5
    s_waitcnt lgkmcnt(5)
    v_smfmac_f32_16x16x64_bf16 v[72:75], v[32:35], a[48:55], v5
    v_smfmac_f32_16x16x64_bf16 v[76:79], v[32:35], a[128:135], v5
    s_waitcnt lgkmcnt(4)
    v_smfmac_f32_16x16x64_bf16 v[72:75], v[36:39], a[56:63], v5
    v_smfmac_f32_16x16x64_bf16 v[76:79], v[36:39], a[136:143], v5
    s_waitcnt lgkmcnt(3)
    v_smfmac_f32_16x16x64_bf16 v[72:75], v[40:43], a[0:7], v5
    v_smfmac_f32_16x16x64_bf16 v[76:79], v[40:43], a[80:87], v5
    s_waitcnt lgkmcnt(2)
    v_smfmac_f32_16x16x64_bf16 v[72:75], v[44:47], a[8:15], v5
    v_smfmac_f32_16x16x64_bf16 v[76:79], v[44:47], a[88:95], v5
    s_waitcnt lgkmcnt(1)
    v_smfmac_f32_16x16x64_bf16 v[72:75], v[48:51], a[64:71], v5
    buffer_store_dword v59, v14, s[8:11], s44 offen offset:0
    v_smfmac_f32_16x16x64_bf16 v[76:79], v[48:51], a[144:151], v5
    s_waitcnt lgkmcnt(0)
    v_smfmac_f32_16x16x64_bf16 v[72:75], v[52:55], a[72:79], v5
    v_smfmac_f32_16x16x64_bf16 v[76:79], v[52:55], a[152:159], v5
    s_nop 3
    v_cvt_pk_bf16_f32 v80, v72, v73
    v_cvt_pk_bf16_f32 v81, v74, v75
    s_nop 1
    v_cvt_pk_bf16_f32 v82, v76, v77
    v_cvt_pk_bf16_f32 v83, v78, v79
    s_nop 1
    v_mfma_f32_16x16x32_bf16 v[88:91], v[80:83], v[84:87], 0
    s_branch Vf_qj
Vf_q2:
    s_mov_b64 s[4:5], -1
    s_mov_b64 s[6:7], -1
    s_mov_b64 s[92:93], -1
    s_mov_b32 s31, -1
Vf2m_l:
    s_mov_b64 exec, s[4:5]
    buffer_load_dwordx4 v[16:19], v3, s[8:11], s38 offen offset:0 sc1
    s_mov_b64 exec, s[6:7]
    buffer_load_dwordx4 v[20:23], v3, s[8:11], s38 offen offset:1024 sc1
    s_mov_b64 exec, s[92:93]
    buffer_load_dwordx2 v[56:57], v4, s[8:11], s39 offen offset:0 sc1
    s_mov_b64 exec, -1
    s_add_u32 s31, s31, 1
    s_cmp_lt_u32 s31, s30
    s_cselect_b32 s30, s30, 1
    s_cbranch_scc0 Vf2m_o
    s_waitcnt vmcnt(0)
    v_max3_u32 v58, v16, v17, v18
    v_max3_u32 v60, v20, v21, v22
    v_max_u32 v61, v56, v57
    v_max_u32 v58, v58, v19
    v_max_u32 v60, v60, v23
    v_cmp_eq_u32 s[92:93], -1, v61
    v_cmp_eq_u32 s[4:5], -1, v58
    v_cmp_eq_u32 s[6:7], -1, v60
    s_or_b64 s[94:95], s[92:93], s[4:5]
    s_or_b64 s[94:95], s[94:95], s[6:7]
    s_cbranch_scc1 Vf2m_l
Vf2m_o:
    ds_write_b128 v3, v[16:19] offset:8192
    ds_write_b128 v3, v[20:23] offset:9216
    ds_write_b64 v4, v[56:57]
    v_smfmac_f32_16x16x64_bf16 v[72:75], v[16:19], a[32:39], v5
    v_smfmac_f32_16x16x64_bf16 v[76:79], v[16:19], a[112:119], v5
    s_waitcnt lgkmcnt(0)
    s_barrier
    ds_read_b128 v[24:27], v3 offset:10240
    ds_read_b128 v[28:31], v3 offset:11264
    ds_read_b128 v[32:35], v3 offset:4096
    v_smfmac_f32_16x16x64_bf16 v[72:75], v[20:23], a[40:47], v5
    ds_read_b128 v[36:39], v3 offset:5120
    ds_read_b128 v[40:43], v3 offset:6144
    v_smfmac_f32_16x16x64_bf16 v[76:79], v[20:23], a[120:127], v5
    ds_read_b128 v[44:47], v3 offset:7168
    ds_read_b128 v[48:51], v3 offset:12288
    ds_read_b128 v[52:55], v3 offset:13312
    s_waitcnt lgkmcnt(7)
    v_smfmac_f32_16x16x64_bf16 v[72:75], v[24:27], a[48:55], v5
    v_smfmac_f32_16x16x64_bf16 v[76:79], v[24:27], a[128:135], v5
    s_waitcnt lgkmcnt(6)
    v_smfmac_f32_16x16x64_bf16 v[72:75], v[28:31], a[56:63], v5
    v_smfmac_f32_16x16x64_bf16 v[76:79], v[28:31], a[136:143], v5
    s_waitcnt lgkmcnt(5)
    v_smfmac_f32_16x16x64_bf16 v[72:75], v[32:35], a[0:7], v5
    v_smfmac_f32_16x16x64_bf16 v[76:79], v[32:35], a[80:87], v5
    s_waitcnt lgkmcnt(4)
    v_smfmac_f32_16x16x64_bf16 v[72:75], v[36:39], a[8:15], v5
    v_smfmac_f32_16x16x64_bf16 v[76:79], v[36:39], a[88:95], v5
    s_waitcnt lgkmcnt(3)
    v_smfmac_f32_16x16x64_bf16 v[72:75], v[40:43], a[16:23], v5
    v_smfmac_f32_16x16x64_bf16 v[76:79], v[40:43], a[96:103], v5
    s_waitcnt lgkmcnt(2)
    v_smfmac_f32_16x16x64_bf16 v[72:75], v[44:47], a[24:31], v5
    v_smfmac_f32_16x16x64_bf16 v[76:79], v[44:47], a[104:111], v5
    s_waitcnt lgkmcnt(1)
    v_smfmac_f32_16x16x64_bf16 v[72:75], v[48:51], a[64:71], v5
    buffer_store_dword v59, v14, s[8:11], s44 offen offset:0
    v_smfmac_f32_16x16x64_bf16 v[76:79], v[48:51], a[144:151], v5
    s_waitcnt lgkmcnt(0)
    v_smfmac_f32_16x16x64_bf16 v[72:75], v[52:55], a[72:79], v5
    v_smfmac_f32_16x16x64_bf16 v[76:79], v[52:55], a[152:159], v5
    s_nop 3
    v_cvt_pk_bf16_f32 v80, v72, v73
    v_cvt_pk_bf16_f32 v81, v74, v75
    s_nop 1
    v_cvt_pk_bf16_f32 v82, v76, v77
    v_cvt_pk_bf16_f32 v83, v78, v79
    s_nop 1
    v_mfma_f32_16x16x32_bf16 v[88:91], v[80:83], v[84:87], 0
    s_branch Vf_qj
Vf_q3:
    s_mov_b64 s[4:5], -1
    s_mov_b64 s[6:7], -1
    s_mov_b64 s[92:93], -1
    s_mov_b32 s31, -1
Vf3m_l:
    s_mov_b64 exec, s[4:5]
    buffer_load_dwordx4 v[16:19], v3, s[8:11], s38 offen offset:0 sc1
    s_mov_b64 exec, s[6:7]
    buffer_load_dwordx4 v[20:23], v3, s[8:11], s38 offen offset:1024 sc1
    s_mov_b64 exec, s[92:93]
    buffer_load_dwordx2 v[56:57], v4, s[8:11], s39 offen offset:0 sc1
    s_mov_b64 exec, -1
    s_add_u32 s31, s31, 1
    s_cmp_lt_u32 s31, s30
    s_cselect_b32 s30, s30, 1
    s_cbranch_scc0 Vf3m_o
    s_waitcnt vmcnt(0)
    v_max3_u32 v58, v16, v17, v18
    v_max3_u32 v60, v20, v21, v22
    v_max_u32 v61, v56, v57
    v_max_u32 v58, v58, v19
    v_max_u32 v60, v60, v23
    v_cmp_eq_u32 s[92:93], -1, v61
    v_cmp_eq_u32 s[4:5], -1, v58
    v_cmp_eq_u32 s[6:7], -1, v60
    s_or_b64 s[94:95], s[92:93], s[4:5]
    s_or_b64 s[94:95], s[94:95], s[6:7]
    s_cbranch_scc1 Vf3m_l
Vf3m_o:
    ds_write_b128 v3, v[16:19] offset:8192
    ds_write_b128 v3, v[20:23] offset:9216
    ds_write_b64 v4, v[56:57]
    v_smfmac_f32_16x16x64_bf16 v[72:75], v[16:19], a[48:55], v5
    v_smfmac_f32_16x16x64_bf16 v[76:79], v[16:19], a[128:135], v5
    s_waitcnt lgkmcnt(0)
    s_barrier
    ds_read_b128 v[24:27], v3 offset:2048
    ds_read_b128 v[28:31], v3 offset:3072
    ds_read_b128 v[32:35], v3 offset:4096
    v_smfmac_f32_16x16x64_bf16 v[72:75], v[20:23], a[56:63], v5
    ds_read_b128 v[36:39], v3 offset:5120
    ds_read_b128 v[40:43], v3 offset:6144
    v_smfmac_f32_16x16x64_bf16 v[76:79], v[20:23], a[136:143], v5
    ds_read_b128 v[44:47], v3 offset:7168
    ds_read_b128 v[48:51], v3 offset:10240
    ds_read_b128 v[52:55], v3 offset:11264
    s_waitcnt lgkmcnt(7)
    v_smfmac_f32_16x16x64_bf16 v[72:75], v[24:27], a[0:7], v5
    v_smfmac_f32_16x16x64_bf16 v[76:79], v[24:27], a[80:87], v5
    s_waitcnt lgkmcnt(6)
    v_smfmac_f32_16x16x64_bf16 v[72:75], v[28:31], a[8:15], v5
    v_smfmac_f32_16x16x64_bf16 v[76:79], v[28:31], a[88:95], v5
    s_waitcnt lgkmcnt(5)
    v_smfmac_f32_16x16x64_bf16 v[72:75], v[32:35], a[16:23], v5
    v_smfmac_f32_16x16x64_bf16 v[76:79], v[32:35], a[96:103], v5
    s_waitcnt lgkmcnt(4)
    v_smfmac_f32_16x16x64_bf16 v[72:75], v[36:39], a[24:31], v5
    v_smfmac_f32_16x16x64_bf16 v[76:79], v[36:39], a[104:111], v5
    s_waitcnt lgkmcnt(3)
    v_smfmac_f32_16x16x64_bf16 v[72:75], v[40:43], a[32:39], v5
    v_smfmac_f32_16x16x64_bf16 v[76:79], v[40:43], a[112:119], v5
    s_waitcnt lgkmcnt(2)
    v_smfmac_f32_16x16x64_bf16 v[72:75], v[44:47], a[40:47], v5
    v_smfmac_f32_16x16x64_bf16 v[76:79], v[44:47], a[120:127], v5
    s_waitcnt lgkmcnt(1)
    v_smfmac_f32_16x16x64_bf16 v[72:75], v[48:51], a[64:71], v5
    buffer_store_dword v59, v14, s[8:11], s44 offen offset:0
    v_smfmac_f32_16x16x64_bf16 v[76:79], v[48:51], a[144:151], v5
    s_waitcnt lgkmcnt(0)
    v_smfmac_f32_16x16x64_bf16 v[72:75], v[52:55], a[72:79], v5
    v_smfmac_f32_16x16x64_bf16 v[76:79], v[52:55], a[152:159], v5
    s_nop 3
    v_cvt_pk_bf16_f32 v80, v72, v73
    v_cvt_pk_bf16_f32 v81, v74, v75
    s_nop 1
    v_cvt_pk_bf16_f32 v82, v76, v77
    v_cvt_pk_bf16_f32 v83, v78, v79
    s_nop 1
    v_mfma_f32_16x16x32_bf16 v[88:91], v[80:83], v[84:87], 0
Vf_qj:
    s_nop 7
    v_cvt_pk_bf16_f32 v94, v88, v89
    v_cvt_pk_bf16_f32 v95, v90, v91
    buffer_store_dwordx2 v[94:95], v6, s[8:11], s25 offen offset:0
    s_cmp_lt_u32 s32, 64
    s_cbranch_scc0 Vf_nb
    s_cmp_eq_u32 s32, 14
    s_cbranch_scc0 Vf_h
    s_mov_b32 s31, 0
    s_waitcnt vmcnt(63)
    s_branch VfB1_c
VfB1_l:
    buffer_load_dword v68, v70, s[8:11], s23 offen sc1
    s_waitcnt vmcnt(0)
VfB1_c:
    v_cmp_gt_u32 vcc, 1, v68
    s_cbranch_vccz VfB1_o
    s_sleep 4
    s_add_u32 s31, s31, 1
    s_cmp_lt_u32 s31, s30
    s_cbranch_scc1 VfB1_l
    s_mov_b32 s30, 1
VfB1_o:
Vf_h:
    s_cmp_gt_u32 s32, 3
    s_cbranch_scc1 VfB0_o
    s_cmp_eq_u32 s32, 1
    s_cbranch_scc0 VfBA_o
    s_mov_b32 s31, 0
    s_waitcnt vmcnt(63)
    s_branch VfBA_c
VfBA_l:
    buffer_load_dword v68, v71, s[8:11], s49 offen sc1
    s_waitcnt vmcnt(0)
VfBA_c:
    v_cmp_gt_u32 vcc, 1, v68
    s_cbranch_vccz VfBA_o
    s_sleep 2
    s_add_u32 s31, s31, 1
    s_cmp_lt_u32 s31, s30
    s_cbranch_scc1 VfBA_l
    s_mov_b32 s30, 1
VfBA_o:
    s_cmp_eq_u32 s32, 3
    s_cbranch_scc0 VfB0_o
    s_mov_b32 s31, 0
    s_waitcnt vmcnt(63)
    s_branch VfB0_c
VfB0_l:
    buffer_load_dword v68, v70, s[8:11], s49 offen sc1
    s_waitcnt vmcnt(0)
VfB0_c:
    v_cmp_gt_u32 vcc, 1, v68
    s_cbranch_vccz VfB0_o
    s_sleep 2
    s_add_u32 s31, s31, 1
    s_cmp_lt_u32 s31, s30
    s_cbranch_scc1 VfB0_l
    s_mov_b32 s30, 1
VfB0_o:
    v_add_u32 v11, s29, v2
    s_xor_b32 s29, s29, 40960
    s_add_u32 s42, s29, s27
    ds_read_b128 a[160:163], v11 offset:0
    ds_read_b128 a[164:167], v11 offset:20480
    ds_read_b128 a[168:171], v11 offset:1024
    ds_read_b128 a[172:175], v11 offset:21504
    ds_read_b128 a[176:179], v11 offset:2048
    ds_read_b128 a[180:183], v11 offset:22528
    s_waitcnt lgkmcnt(5)
    v_mfma_f32_16x16x32_bf16 v[144:147], a[0:3], a[160:163], 0
    ds_read_b128 a[184:187], v11 offset:3072
    v_mfma_f32_16x16x32_bf16 v[152:155], a[80:83], a[160:163], 0
    s_waitcnt lgkmcnt(5)
    v_mfma_f32_16x16x32_bf16 v[148:151], a[0:3], a[164:167], 0
    ds_read_b128 a[188:191], v11 offset:23552
    v_mfma_f32_16x16x32_bf16 v[156:159], a[80:83], a[164:167], 0
    s_waitcnt lgkmcnt(5)
    v_mfma_f32_16x16x32_bf16 v[144:147], a[4:7], a[168:171], v[144:147]
    ds_read_b128 a[160:163], v11 offset:4096
    s_add_u32 s35, s28, 0
    s_add_u32 m0, s42, 0
    v_mfma_f32_16x16x32_bf16 v[152:155], a[84:87], a[168:171], v[152:155]
    buffer_load_dwordx4 v2, s[8:11], s35 offen offset:0 sc1 lds
    s_waitcnt lgkmcnt(5)
    v_mfma_f32_16x16x32_bf16 v[148:151], a[4:7], a[172:175], v[148:151]
    ds_read_b128 a[164:167], v11 offset:24576
    v_mfma_f32_16x16x32_bf16 v[156:159], a[84:87], a[172:175], v[156:159]
    s_waitcnt lgkmcnt(5)
    v_mfma_f32_16x16x32_bf16 v[144:147], a[8:11], a[176:179], v[144:147]
    ds_read_b128 a[168:171], v11 offset:5120
    v_mfma_f32_16x16x32_bf16 v[152:155], a[88:91], a[176:179], v[152:155]
    s_waitcnt lgkmcnt(5)
    v_mfma_f32_16x16x32_bf16 v[148:151], a[8:11], a[180:183], v[148:151]
    ds_read_b128 a[172:175], v11 offset:25600
    v_mfma_f32_16x16x32_bf16 v[156:159], a[88:91], a[180:183], v[156:159]
    buffer_load_dwordx4 v2, s[8:11], s35 offen offset:1024 sc1 lds
    s_waitcnt lgkmcnt(5)
    v_mfma_f32_16x16x32_bf16 v[144:147], a[12:15], a[184:187], v[144:147]
    ds_read_b128 a[176:179], v11 offset:6144
    v_mfma_f32_16x16x32_bf16 v[152:155], a[92:95], a[184:187], v[152:155]
    s_waitcnt lgkmcnt(5)
    v_mfma_f32_16x16x32_bf16 v[148:151], a[12:15], a[188:191], v[148:151]
    ds_read_b128 a[180:183], v11 offset:26624
    v_mfma_f32_16x16x32_bf16 v[156:159], a[92:95], a[188:191], v[156:159]
    s_waitcnt lgkmcnt(5)
    v_mfma_f32_16x16x32_bf16 v[144:147], a[16:19], a[160:163], v[144:147]
    ds_read_b128 a[184:187], v11 offset:7168
    v_mfma_f32_16x16x32_bf16 v[152:155], a[96:99], a[160:163], v[152:155]
    buffer_load_dwordx4 v2, s[8:11], s35 offen offset:2048 sc1 lds
    s_waitcnt lgkmcnt(5)
    v_mfma_f32_16x16x32_bf16 v[148:151], a[16:19], a[164:167], v[148:151]
    ds_read_b128 a[188:191], v11 offset:27648
    v_mfma_f32_16x16x32_bf16 v[156:159], a[96:99], a[164:167], v[156:159]
    s_waitcnt lgkmcnt(5)
    v_mfma_f32_16x16x32_bf16 v[144:147], a[20:23], a[168:171], v[144:147]
    ds_read_b128 a[160:163], v11 offset:8192
    v_mfma_f32_16x16x32_bf16 v[152:155], a[100:103], a[168:171], v[152:155]
    s_waitcnt lgkmcnt(5)
    v_mfma_f32_16x16x32_bf16 v[148:151], a[20:23], a[172:175], v[148:151]
    ds_read_b128 a[164:167], v11 offset:28672
    v_mfma_f32_16x16x32_bf16 v[156:159], a[100:103], a[172:175], v[156:159]
    buffer_load_dwordx4 v2, s[8:11], s35 offen offset:3072 sc1 lds
    s_waitcnt lgkmcnt(5)
    v_mfma_f32_16x16x32_bf16 v[144:147], a[24:27], a[176:179], v[144:147]
    ds_read_b128 a[168:171], v11 offset:9216
    v_mfma_f32_16x16x32_bf16 v[152:155], a[104:107], a[176:179], v[152:155]
    s_waitcnt lgkmcnt(5)
    v_mfma_f32_16x16x32_bf16 v[148:151], a[24:27], a[180:183], v[148:151]
    ds_read_b128 a[172:175], v11 offset:29696
    v_mfma_f32_16x16x32_bf16 v[156:159], a[104:107], a[180:183], v[156:159]
    s_waitcnt lgkmcnt(5)
    v_mfma_f32_16x16x32_bf16 v[144:147], a[28:31], a[184:187], v[144:147]
    ds_read_b128 a[176:179], v11 offset:10240
    s_add_u32 s35, s28, 4096
    s_add_u32 m0, s42, 4096
    v_mfma_f32_16x16x32_bf16 v[152:155], a[108:111], a[184:187], v[152:155]
    buffer_load_dwordx4 v2, s[8:11], s35 offen offset:0 sc1 lds
    s_waitcnt lgkmcnt(5)
    v_mfma_f32_16x16x32_bf16 v[148:151], a[28:31], a[188:191], v[148:151]
    ds_read_b128 a[180:183], v11 offset:30720
    v_mfma_f32_16x16x32_bf16 v[156:159], a[108:111], a[188:191], v[156:159]
    s_waitcnt lgkmcnt(5)
    v_mfma_f32_16x16x32_bf16 v[144:147], a[32:35], a[160:163], v[144:147]
    ds_read_b128 a[184:187], v11 offset:11264
    v_mfma_f32_16x16x32_bf16 v[152:155], a[112:115], a[160:163], v[152:155]
    s_waitcnt lgkmcnt(5)
    v_mfma_f32_16x16x32_bf16 v[148:151], a[32:35], a[164:167], v[148:151]
    ds_read_b128 a[188:191], v11 offset:31744
    v_mfma_f32_16x16x32_bf16 v[156:159], a[112:115], a[164:167], v[156:159]
    buffer_load_dwordx4 v2, s[8:11], s35 offen offset:1024 sc1 lds
    s_waitcnt lgkmcnt(5)
    v_mfma_f32_16x16x32_bf16 v[144:147], a[36:39], a[168:171], v[144:147]
    ds_read_b128 a[160:163], v11 offset:12288
    v_mfma_f32_16x16x32_bf16 v[152:155], a[116:119], a[168:171], v[152:155]
    s_waitcnt lgkmcnt(5)
    v_mfma_f32_16x16x32_bf16 v[148:151], a[36:39], a[172:175], v[148:151]
    ds_read_b128 a[164:167], v11 offset:32768
    v_mfma_f32_16x16x32_bf16 v[156:159], a[116:119], a[172:175], v[156:159]
    s_waitcnt lgkmcnt(5)
    v_mfma_f32_16x16x32_bf16 v[144:147], a[40:43], a[176:179], v[144:147]
    ds_read_b128 a[168:171], v11 offset:13312
    v_mfma_f32_16x16x32_bf16 v[152:155], a[120:123], a[176:179], v[152:155]
    buffer_load_dwordx4 v2, s[8:11], s35 offen offset:2048 sc1 lds
    s_waitcnt lgkmcnt(5)
    v_mfma_f32_16x16x32_bf16 v[148:151], a[40:43], a[180:183], v[148:151]
    ds_read_b128 a[172:175], v11 offset:33792
    v_mfma_f32_16x16x32_bf16 v[156:159], a[120:123], a[180:183], v[156:159]
    buffer_store_dwordx2 v[240:241], v6, s[8:11], s26 offen offset:0
    buffer_store_dwordx4 v[240:243], v7, s[8:11], s34 offen offset:0 sc1
    s_waitcnt lgkmcnt(5)
    v_mfma_f32_16x16x32_bf16 v[144:147], a[44:47], a[184:187], v[144:147]
    ds_read_b128 a[176:179], v11 offset:14336
    v_mfma_f32_16x16x32_bf16 v[152:155], a[124:127], a[184:187], v[152:155]
    s_waitcnt lgkmcnt(5)
    v_mfma_f32_16x16x32_bf16 v[148:151], a[44:47], a[188:191], v[148:151]
    ds_read_b128 a[180:183], v11 offset:34816
    v_mfma_f32_16x16x32_bf16 v[156:159], a[124:127], a[188:191], v[156:159]
    buffer_load_dwordx4 v2, s[8:11], s35 offen offset:3072 sc1 lds
    s_waitcnt lgkmcnt(5)
    v_mfma_f32_16x16x32_bf16 v[144:147], a[48:51], a[160:163], v[144:147]
    ds_read_b128 a[184:187], v11 offset:15360
    v_mfma_f32_16x16x32_bf16 v[152:155], a[128:131], a[160:163], v[152:155]
    s_waitcnt lgkmcnt(5)
    v_mfma_f32_16x16x32_bf16 v[148:151], a[48:51], a[164:167], v[148:151]
    ds_read_b128 a[188:191], v11 offset:35840
    v_mfma_f32_16x16x32_bf16 v[156:159], a[128:131], a[164:167], v[156:159]
    s_waitcnt lgkmcnt(5)
    v_mfma_f32_16x16x32_bf16 v[144:147], a[52:55], a[168:171], v[144:147]
    ds_read_b128 a[160:163], v11 offset:16384
    s_add_u32 s35, s28, 8192
    s_add_u32 m0, s42, 8192
    v_mfma_f32_16x16x32_bf16 v[152:155], a[132:135], a[168:171], v[152:155]
    buffer_load_dwordx4 v2, s[8:11], s35 offen offset:0 sc1 lds
    s_waitcnt lgkmcnt(5)
    v_mfma_f32_16x16x32_bf16 v[148:151], a[52:55], a[172:175], v[148:151]
    ds_read_b128 a[164:167], v11 offset:36864
    v_mfma_f32_16x16x32_bf16 v[156:159], a[132:135], a[172:175], v[156:159]
    s_waitcnt lgkmcnt(5)
    v_mfma_f32_16x16x32_bf16 v[144:147], a[56:59], a[176:179], v[144:147]
    ds_read_b128 a[168:171], v11 offset:17408
    v_mfma_f32_16x16x32_bf16 v[152:155], a[136:139], a[176:179], v[152:155]
    s_waitcnt lgkmcnt(5)
    v_mfma_f32_16x16x32_bf16 v[148:151], a[56:59], a[180:183], v[148:151]
    ds_read_b128 a[172:175], v11 offset:37888
    v_mfma_f32_16x16x32_bf16 v[156:159], a[136:139], a[180:183], v[156:159]
    buffer_load_dwordx4 v2, s[8:11], s35 offen offset:1024 sc1 lds
    s_waitcnt lgkmcnt(5)
    v_mfma_f32_16x16x32_bf16 v[144:147], a[60:63], a[184:187], v[144:147]
    ds_read_b128 a[176:179], v11 offset:18432
    v_mfma_f32_16x16x32_bf16 v[152:155], a[140:143], a[184:187], v[152:155]
    s_waitcnt lgkmcnt(5)
    v_mfma_f32_16x16x32_bf16 v[148:151], a[60:63], a[188:191], v[148:151]
    ds_read_b128 a[180:183], v11 offset:38912
    v_mfma_f32_16x16x32_bf16 v[156:159], a[140:143], a[188:191], v[156:159]
    s_waitcnt lgkmcnt(5)
    v_mfma_f32_16x16x32_bf16 v[144:147], a[64:67], a[160:163], v[144:147]
    ds_read_b128 a[184:187], v11 offset:19456
    v_mfma_f32_16x16x32_bf16 v[152:155], a[144:147], a[160:163], v[152:155]
    s_waitcnt lgkmcnt(5)
    v_mfma_f32_16x16x32_bf16 v[148:151], a[64:67], a[164:167], v[148:151]
    ds_read_b128 a[188:191], v11 offset:39936
    v_mfma_f32_16x16x32_bf16 v[156:159], a[144:147], a[164:167], v[156:159]
    s_waitcnt lgkmcnt(5)
    v_mfma_f32_16x16x32_bf16 v[144:147], a[68:71], a[168:171], v[144:147]
    v_mfma_f32_16x16x32_bf16 v[152:155], a[148:151], a[168:171], v[152:155]
    s_waitcnt lgkmcnt(4)
    v_mfma_f32_16x16x32_bf16 v[148:151], a[68:71], a[172:175], v[148:151]
    v_mfma_f32_16x16x32_bf16 v[156:159], a[148:151], a[172:175], v[156:159]
    s_waitcnt lgkmcnt(3)
    v_mfma_f32_16x16x32_bf16 v[144:147], a[72:75], a[176:179], v[144:147]
    v_mfma_f32_16x16x32_bf16 v[152:155], a[152:155], a[176:179], v[152:155]
    s_waitcnt lgkmcnt(2)
    v_mfma_f32_16x16x32_bf16 v[148:151], a[72:75], a[180:183], v[148:151]
    v_mfma_f32_16x16x32_bf16 v[156:159], a[152:155], a[180:183], v[156:159]
    s_waitcnt lgkmcnt(1)
    v_mfma_f32_16x16x32_bf16 v[144:147], a[76:79], a[184:187], v[144:147]
    v_mfma_f32_16x16x32_bf16 v[152:155], a[156:159], a[184:187], v[152:155]
    s_waitcnt lgkmcnt(0)
    v_mfma_f32_16x16x32_bf16 v[148:151], a[76:79], a[188:191], v[148:151]
    v_mfma_f32_16x16x32_bf16 v[156:159], a[156:159], a[188:191], v[156:159]
    s_add_u32 s28, s28, 40960
    s_add_u32 s32, s32, 1
    s_cmp_eq_u32 s32, 3
    s_cbranch_scc0 Vf_n3
    buffer_load_dword v68, v70, s[8:11], s49 offen offset:0 sc1
Vf_n3:
    s_cmp_eq_u32 s32, 12
    s_cbranch_scc0 Vf_n12
    buffer_load_dword v68, v70, s[8:11], s23 offen offset:0 sc1
Vf_n12:
    s_add_u32 s4, s32, 3
    s_and_b32 s4, s4, 3
    s_mul_i32 s4, s4, 49152
    s_add_u32 s4, s4, s43
    s_add_u32 s5, s4, 6144
    v_cvt_pk_bf16_f32 v160, v144, v145
    v_cvt_pk_bf16_f32 v161, v152, v153
    v_cvt_pk_bf16_f32 v162, v146, v147
    v_cvt_pk_bf16_f32 v163, v154, v155
    buffer_store_dwordx4 v[160:163], v2, s[8:11], s4 offen offset:0
    v_cvt_pk_bf16_f32 v164, v148, v149
    v_cvt_pk_bf16_f32 v165, v156, v157
    v_cvt_pk_bf16_f32 v166, v150, v151
    v_cvt_pk_bf16_f32 v167, v158, v159
    buffer_store_dwordx4 v[164:167], v2, s[8:11], s5 offen offset:0
    s_waitcnt vmcnt(0)
    v_mov_b32 v10, s32
    s_mov_b64 exec, 1
    buffer_store_dword v10, v9, s[8:11], s33 offen
    s_mov_b64 exec, -1
    s_cmp_lt_u32 s32, 4
    s_cbranch_scc0 Vf_nb
    s_barrier
    s_branch Vf_h
Vf_nb:
    s_cmp_eq_u32 s21, 62
    s_cbranch_scc0 Vf_np
    s_barrier
    buffer_store_dwordx2 v[240:241], v6, s[8:11], s26 offen offset:0
    buffer_store_dwordx4 v[240:243], v7, s[8:11], s34 offen offset:0 sc1
Vf_np:
    s_cmp_lt_u32 s21, 63
    s_cbranch_scc1 Vf_loop
    s_cmp_eq_u32 s21, 64
    s_cbranch_scc1 V_t3
    s_load_dwordx2 s[12:13], s[0:1], 0
    s_load_dwordx2 s[16:17], s[0:1], 112
    s_mov_b32 s14, 2621440
    s_mov_b32 s15, 0x20000
    s_mov_b32 s18, 2621440
    s_mov_b32 s19, 0x20000
    s_waitcnt lgkmcnt(0)
    v_lshlrev_b32 v71, 2, v1
    s_add_u32 s4, s20, 48
    s_lshl_b32 s5, s4, 19
    s_add_u32 s5, s5, 23461888
    s_lshl_b32 s4, s4, 5
    s_lshl_b32 s6, s99, 2
    s_add_u32 s4, s4, s6
    s_add_u32 s4, s4, s3
    s_mul_i32 s4, s4, 1280
    buffer_load_dword v224, v71, s[12:15], s4 offen offset:0
    buffer_load_dword v225, v71, s[12:15], s4 offen offset:256
    buffer_load_dword v226, v71, s[12:15], s4 offen offset:512
    buffer_load_dword v227, v71, s[12:15], s4 offen offset:768
    buffer_load_dword v228, v71, s[12:15], s4 offen offset:1024
    buffer_load_dword v229, v9, s[8:11], s5 offen
    buffer_load_dword v229, v9, s[16:19], s4 offen
    s_mov_b32 s5, 61997056
    buffer_load_dword v229, v9, s[8:11], s5 offen
    s_mov_b32 s5, 59244544
    buffer_load_dword v229, v9, s[8:11], s5 offen
    s_load_dwordx2 s[88:89], s[0:1], 64
    s_mov_b32 s90, 1280
    s_mov_b32 s91, 0x20000
    s_waitcnt lgkmcnt(0)
    v_lshlrev_b32 v71, 2, v1
    v_lshlrev_b32 v70, 3, v1
    s_mov_b32 s4, 5120
    buffer_load_dwordx2 v[146:147], v70, s[8:11], s4 offen offset:0 sc1
    buffer_load_dwordx2 v[148:149], v70, s[8:11], s4 offen offset:512 sc1
    buffer_load_dwordx2 v[150:151], v70, s[8:11], s4 offen offset:1024 sc1
    buffer_load_dwordx2 v[152:153], v70, s[8:11], s4 offen offset:1536 sc1
    buffer_load_dwordx2 v[154:155], v70, s[8:11], s4 offen offset:2048 sc1
    s_mov_b32 s5, 7680
    s_mov_b32 s6, 10240
    s_mov_b32 s7, 12800
    buffer_load_dwordx2 v[100:101], v70, s[8:11], s5 offen offset:0 sc1
    buffer_load_dwordx2 v[110:111], v70, s[8:11], s6 offen offset:0 sc1
    buffer_load_dwordx2 v[120:121], v70, s[8:11], s7 offen offset:0 sc1
    buffer_load_dword v140, v71, s[88:91], 0 offen offset:0
    buffer_load_dwordx2 v[102:103], v70, s[8:11], s5 offen offset:512 sc1
    buffer_load_dwordx2 v[112:113], v70, s[8:11], s6 offen offset:512 sc1
    buffer_load_dwordx2 v[122:123], v70, s[8:11], s7 offen offset:512 sc1
    buffer_load_dword v141, v71, s[88:91], 0 offen offset:256
    buffer_load_dwordx2 v[104:105], v70, s[8:11], s5 offen offset:1024 sc1
    buffer_load_dwordx2 v[114:115], v70, s[8:11], s6 offen offset:1024 sc1
    buffer_load_dwordx2 v[124:125], v70, s[8:11], s7 offen offset:1024 sc1
    buffer_load_dword v142, v71, s[88:91], 0 offen offset:512
    buffer_load_dwordx2 v[106:107], v70, s[8:11], s5 offen offset:1536 sc1
    buffer_load_dwordx2 v[116:117], v70, s[8:11], s6 offen offset:1536 sc1
    buffer_load_dwordx2 v[126:127], v70, s[8:11], s7 offen offset:1536 sc1
    buffer_load_dword v143, v71, s[88:91], 0 offen offset:768
    buffer_load_dwordx2 v[108:109], v70, s[8:11], s5 offen offset:2048 sc1
    buffer_load_dwordx2 v[118:119], v70, s[8:11], s6 offen offset:2048 sc1
    buffer_load_dwordx2 v[128:129], v70, s[8:11], s7 offen offset:2048 sc1
    buffer_load_dword v144, v71, s[88:91], 0 offen offset:1024
    s_waitcnt vmcnt(0)
    v_add_f32 v110, 1.0, v110
    v_cvt_pk_bf16_f32 v110, v110, v110
    v_and_b32 v110, 0xffff0000, v110
    v_add_f32 v111, 1.0, v111
    v_cvt_pk_bf16_f32 v111, v111, v111
    v_and_b32 v111, 0xffff0000, v111
    v_add_f32 v112, 1.0, v112
    v_cvt_pk_bf16_f32 v112, v112, v112
    v_and_b32 v112, 0xffff0000, v112
    v_add_f32 v113, 1.0, v113
    v_cvt_pk_bf16_f32 v113, v113, v113
    v_and_b32 v113, 0xffff0000, v113
    v_add_f32 v114, 1.0, v114
    v_cvt_pk_bf16_f32 v114, v114, v114
    v_and_b32 v114, 0xffff0000, v114
    v_add_f32 v115, 1.0, v115
    v_cvt_pk_bf16_f32 v115, v115, v115
    v_and_b32 v115, 0xffff0000, v115
    v_add_f32 v116, 1.0, v116
    v_cvt_pk_bf16_f32 v116, v116, v116
    v_and_b32 v116, 0xffff0000, v116
    v_add_f32 v117, 1.0, v117
    v_cvt_pk_bf16_f32 v117, v117, v117
    v_and_b32 v117, 0xffff0000, v117
    v_add_f32 v118, 1.0, v118
    v_cvt_pk_bf16_f32 v118, v118, v118
    v_and_b32 v118, 0xffff0000, v118
    v_add_f32 v119, 1.0, v119
    v_cvt_pk_bf16_f32 v119, v119, v119
    v_and_b32 v119, 0xffff0000, v119
    v_lshlrev_b32 v130, 16, v140
    v_and_b32 v131, 0xffff0000, v140
    v_lshlrev_b32 v132, 16, v141
    v_and_b32 v133, 0xffff0000, v141
    v_lshlrev_b32 v134, 16, v142
    v_and_b32 v135, 0xffff0000, v142
    v_lshlrev_b32 v136, 16, v143
    v_and_b32 v137, 0xffff0000, v143
    v_lshlrev_b32 v138, 16, v144
    v_and_b32 v139, 0xffff0000, v144
    s_branch Vf_loop
Vs_go:
    s_waitcnt vmcnt(0)
    s_barrier
    v_add_u32 v11, s29, v2
    s_xor_b32 s29, s29, 40960
    s_add_u32 s42, s29, s27
    ds_read_b128 a[160:163], v11 offset:0
    ds_read_b128 a[164:167], v11 offset:20480
    ds_read_b128 a[168:171], v11 offset:1024
    ds_read_b128 a[172:175], v11 offset:21504
    ds_read_b128 a[176:179], v11 offset:2048
    ds_read_b128 a[180:183], v11 offset:22528
    s_waitcnt lgkmcnt(5)
    v_mfma_f32_16x16x32_bf16 v[144:147], a[0:3], a[160:163], 0
    ds_read_b128 a[184:187], v11 offset:3072
    v_mfma_f32_16x16x32_bf16 v[152:155], a[80:83], a[160:163], 0
    s_waitcnt lgkmcnt(5)
    v_mfma_f32_16x16x32_bf16 v[148:151], a[0:3], a[164:167], 0
    ds_read_b128 a[188:191], v11 offset:23552
    v_mfma_f32_16x16x32_bf16 v[156:159], a[80:83], a[164:167], 0
    s_waitcnt lgkmcnt(5)
    v_mfma_f32_16x16x32_bf16 v[144:147], a[4:7], a[168:171], v[144:147]
    ds_read_b128 a[160:163], v11 offset:4096
    s_add_u32 s35, s28, 0
    s_add_u32 m0, s42, 0
    v_mfma_f32_16x16x32_bf16 v[152:155], a[84:87], a[168:171], v[152:155]
    buffer_load_dwordx4 v2, s[8:11], s35 offen offset:0 sc1 lds
    s_waitcnt lgkmcnt(5)
    v_mfma_f32_16x16x32_bf16 v[148:151], a[4:7], a[172:175], v[148:151]
    ds_read_b128 a[164:167], v11 offset:24576
    v_mfma_f32_16x16x32_bf16 v[156:159], a[84:87], a[172:175], v[156:159]
    s_waitcnt lgkmcnt(5)
    v_mfma_f32_16x16x32_bf16 v[144:147], a[8:11], a[176:179], v[144:147]
    ds_read_b128 a[168:171], v11 offset:5120
    v_mfma_f32_16x16x32_bf16 v[152:155], a[88:91], a[176:179], v[152:155]
    s_waitcnt lgkmcnt(5)
    v_mfma_f32_16x16x32_bf16 v[148:151], a[8:11], a[180:183], v[148:151]
    ds_read_b128 a[172:175], v11 offset:25600
    v_mfma_f32_16x16x32_bf16 v[156:159], a[88:91], a[180:183], v[156:159]
    buffer_load_dwordx4 v2, s[8:11], s35 offen offset:1024 sc1 lds
    s_waitcnt lgkmcnt(5)
    v_mfma_f32_16x16x32_bf16 v[144:147], a[12:15], a[184:187], v[144:147]
    ds_read_b128 a[176:179], v11 offset:6144
    v_mfma_f32_16x16x32_bf16 v[152:155], a[92:95], a[184:187], v[152:155]
    s_waitcnt lgkmcnt(5)
    v_mfma_f32_16x16x32_bf16 v[148:151], a[12:15], a[188:191], v[148:151]
    ds_read_b128 a[180:183], v11 offset:26624
    v_mfma_f32_16x16x32_bf16 v[156:159], a[92:95], a[188:191], v[156:159]
    s_waitcnt lgkmcnt(5)
    v_mfma_f32_16x16x32_bf16 v[144:147], a[16:19], a[160:163], v[144:147]
    ds_read_b128 a[184:187], v11 offset:7168
    v_mfma_f32_16x16x32_bf16 v[152:155], a[96:99], a[160:163], v[152:155]
    buffer_load_dwordx4 v2, s[8:11], s35 offen offset:2048 sc1 lds
    s_waitcnt lgkmcnt(5)
    v_mfma_f32_16x16x32_bf16 v[148:151], a[16:19], a[164:167], v[148:151]
    ds_read_b128 a[188:191], v11 offset:27648
    v_mfma_f32_16x16x32_bf16 v[156:159], a[96:99], a[164:167], v[156:159]
    s_waitcnt lgkmcnt(5)
    v_mfma_f32_16x16x32_bf16 v[144:147], a[20:23], a[168:171], v[144:147]
    ds_read_b128 a[160:163], v11 offset:8192
    v_mfma_f32_16x16x32_bf16 v[152:155], a[100:103], a[168:171], v[152:155]
    s_waitcnt lgkmcnt(5)
    v_mfma_f32_16x16x32_bf16 v[148:151], a[20:23], a[172:175], v[148:151]
    ds_read_b128 a[164:167], v11 offset:28672
    v_mfma_f32_16x16x32_bf16 v[156:159], a[100:103], a[172:175], v[156:159]
    buffer_load_dwordx4 v2, s[8:11], s35 offen offset:3072 sc1 lds
    s_waitcnt lgkmcnt(5)
    v_mfma_f32_16x16x32_bf16 v[144:147], a[24:27], a[176:179], v[144:147]
    ds_read_b128 a[168:171], v11 offset:9216
    v_mfma_f32_16x16x32_bf16 v[152:155], a[104:107], a[176:179], v[152:155]
    s_waitcnt lgkmcnt(5)
    v_mfma_f32_16x16x32_bf16 v[148:151], a[24:27], a[180:183], v[148:151]
    ds_read_b128 a[172:175], v11 offset:29696
    v_mfma_f32_16x16x32_bf16 v[156:159], a[104:107], a[180:183], v[156:159]
    s_waitcnt lgkmcnt(5)
    v_mfma_f32_16x16x32_bf16 v[144:147], a[28:31], a[184:187], v[144:147]
    ds_read_b128 a[176:179], v11 offset:10240
    s_add_u32 s35, s28, 4096
    s_add_u32 m0, s42, 4096
    v_mfma_f32_16x16x32_bf16 v[152:155], a[108:111], a[184:187], v[152:155]
    buffer_load_dwordx4 v2, s[8:11], s35 offen offset:0 sc1 lds
    s_waitcnt lgkmcnt(5)
    v_mfma_f32_16x16x32_bf16 v[148:151], a[28:31], a[188:191], v[148:151]
    ds_read_b128 a[180:183], v11 offset:30720
    v_mfma_f32_16x16x32_bf16 v[156:159], a[108:111], a[188:191], v[156:159]
    s_waitcnt lgkmcnt(5)
    v_mfma_f32_16x16x32_bf16 v[144:147], a[32:35], a[160:163], v[144:147]
    ds_read_b128 a[184:187], v11 offset:11264
    v_mfma_f32_16x16x32_bf16 v[152:155], a[112:115], a[160:163], v[152:155]
    s_waitcnt lgkmcnt(5)
    v_mfma_f32_16x16x32_bf16 v[148:151], a[32:35], a[164:167], v[148:151]
    ds_read_b128 a[188:191], v11 offset:31744
    v_mfma_f32_16x16x32_bf16 v[156:159], a[112:115], a[164:167], v[156:159]
    buffer_load_dwordx4 v2, s[8:11], s35 offen offset:1024 sc1 lds
    s_waitcnt lgkmcnt(5)
    v_mfma_f32_16x16x32_bf16 v[144:147], a[36:39], a[168:171], v[144:147]
    ds_read_b128 a[160:163], v11 offset:12288
    v_mfma_f32_16x16x32_bf16 v[152:155], a[116:119], a[168:171], v[152:155]
    s_waitcnt lgkmcnt(5)
    v_mfma_f32_16x16x32_bf16 v[148:151], a[36:39], a[172:175], v[148:151]
    ds_read_b128 a[164:167], v11 offset:32768
    v_mfma_f32_16x16x32_bf16 v[156:159], a[116:119], a[172:175], v[156:159]
    s_waitcnt lgkmcnt(5)
    v_mfma_f32_16x16x32_bf16 v[144:147], a[40:43], a[176:179], v[144:147]
    ds_read_b128 a[168:171], v11 offset:13312
    v_mfma_f32_16x16x32_bf16 v[152:155], a[120:123], a[176:179], v[152:155]
    buffer_load_dwordx4 v2, s[8:11], s35 offen offset:2048 sc1 lds
    s_waitcnt lgkmcnt(5)
    v_mfma_f32_16x16x32_bf16 v[148:151], a[40:43], a[180:183], v[148:151]
    ds_read_b128 a[172:175], v11 offset:33792
    v_mfma_f32_16x16x32_bf16 v[156:159], a[120:123], a[180:183], v[156:159]
    s_waitcnt lgkmcnt(5)
    v_mfma_f32_16x16x32_bf16 v[144:147], a[44:47], a[184:187], v[144:147]
    ds_read_b128 a[176:179], v11 offset:14336
    v_mfma_f32_16x16x32_bf16 v[152:155], a[124:127], a[184:187], v[152:155]
    s_waitcnt lgkmcnt(5)
    v_mfma_f32_16x16x32_bf16 v[148:151], a[44:47], a[188:191], v[148:151]
    ds_read_b128 a[180:183], v11 offset:34816
    v_mfma_f32_16x16x32_bf16 v[156:159], a[124:127], a[188:191], v[156:159]
    buffer_load_dwordx4 v2, s[8:11], s35 offen offset:3072 sc1 lds
    s_waitcnt lgkmcnt(5)
    v_mfma_f32_16x16x32_bf16 v[144:147], a[48:51], a[160:163], v[144:147]
    ds_read_b128 a[184:187], v11 offset:15360
    v_mfma_f32_16x16x32_bf16 v[152:155], a[128:131], a[160:163], v[152:155]
    s_waitcnt lgkmcnt(5)
    v_mfma_f32_16x16x32_bf16 v[148:151], a[48:51], a[164:167], v[148:151]
    ds_read_b128 a[188:191], v11 offset:35840
    v_mfma_f32_16x16x32_bf16 v[156:159], a[128:131], a[164:167], v[156:159]
    s_waitcnt lgkmcnt(5)
    v_mfma_f32_16x16x32_bf16 v[144:147], a[52:55], a[168:171], v[144:147]
    ds_read_b128 a[160:163], v11 offset:16384
    s_add_u32 s35, s28, 8192
    s_add_u32 m0, s42, 8192
    v_mfma_f32_16x16x32_bf16 v[152:155], a[132:135], a[168:171], v[152:155]
    buffer_load_dwordx4 v2, s[8:11], s35 offen offset:0 sc1 lds
    s_waitcnt lgkmcnt(5)
    v_mfma_f32_16x16x32_bf16 v[148:151], a[52:55], a[172:175], v[148:151]
    ds_read_b128 a[164:167], v11 offset:36864
    v_mfma_f32_16x16x32_bf16 v[156:159], a[132:135], a[172:175], v[156:159]
    s_waitcnt lgkmcnt(5)
    v_mfma_f32_16x16x32_bf16 v[144:147], a[56:59], a[176:179], v[144:147]
    ds_read_b128 a[168:171], v11 offset:17408
    v_mfma_f32_16x16x32_bf16 v[152:155], a[136:139], a[176:179], v[152:155]
    s_waitcnt lgkmcnt(5)
    v_mfma_f32_16x16x32_bf16 v[148:151], a[56:59], a[180:183], v[148:151]
    ds_read_b128 a[172:175], v11 offset:37888
    v_mfma_f32_16x16x32_bf16 v[156:159], a[136:139], a[180:183], v[156:159]
    buffer_load_dwordx4 v2, s[8:11], s35 offen offset:1024 sc1 lds
    s_waitcnt lgkmcnt(5)
    v_mfma_f32_16x16x32_bf16 v[144:147], a[60:63], a[184:187], v[144:147]
    ds_read_b128 a[176:179], v11 offset:18432
    v_mfma_f32_16x16x32_bf16 v[152:155], a[140:143], a[184:187], v[152:155]
    s_waitcnt lgkmcnt(5)
    v_mfma_f32_16x16x32_bf16 v[148:151], a[60:63], a[188:191], v[148:151]
    ds_read_b128 a[180:183], v11 offset:38912
    v_mfma_f32_16x16x32_bf16 v[156:159], a[140:143], a[188:191], v[156:159]
    s_waitcnt lgkmcnt(5)
    v_mfma_f32_16x16x32_bf16 v[144:147], a[64:67], a[160:163], v[144:147]
    ds_read_b128 a[184:187], v11 offset:19456
    v_mfma_f32_16x16x32_bf16 v[152:155], a[144:147], a[160:163], v[152:155]
    s_waitcnt lgkmcnt(5)
    v_mfma_f32_16x16x32_bf16 v[148:151], a[64:67], a[164:167], v[148:151]
    ds_read_b128 a[188:191], v11 offset:39936
    v_mfma_f32_16x16x32_bf16 v[156:159], a[144:147], a[164:167], v[156:159]
    s_waitcnt lgkmcnt(5)
    v_mfma_f32_16x16x32_bf16 v[144:147], a[68:71], a[168:171], v[144:147]
    v_mfma_f32_16x16x32_bf16 v[152:155], a[148:151], a[168:171], v[152:155]
    s_waitcnt lgkmcnt(4)
    v_mfma_f32_16x16x32_bf16 v[148:151], a[68:71], a[172:175], v[148:151]
    v_mfma_f32_16x16x32_bf16 v[156:159], a[148:151], a[172:175], v[156:159]
    s_waitcnt lgkmcnt(3)
    v_mfma_f32_16x16x32_bf16 v[144:147], a[72:75], a[176:179], v[144:147]
    v_mfma_f32_16x16x32_bf16 v[152:155], a[152:155], a[176:179], v[152:155]
    s_waitcnt lgkmcnt(2)
    v_mfma_f32_16x16x32_bf16 v[148:151], a[72:75], a[180:183], v[148:151]
    v_mfma_f32_16x16x32_bf16 v[156:159], a[152:155], a[180:183], v[156:159]
    s_waitcnt lgkmcnt(1)
    v_mfma_f32_16x16x32_bf16 v[144:147], a[76:79], a[184:187], v[144:147]
    v_mfma_f32_16x16x32_bf16 v[152:155], a[156:159], a[184:187], v[152:155]
    s_waitcnt lgkmcnt(0)
    v_mfma_f32_16x16x32_bf16 v[148:151], a[76:79], a[188:191], v[148:151]
    v_mfma_f32_16x16x32_bf16 v[156:159], a[156:159], a[188:191], v[156:159]
    s_add_u32 s28, s28, 40960
    s_add_u32 s32, s32, 1
    buffer_load_dword v68, v71, s[8:11], s49 offen offset:0 sc1
    s_add_u32 s4, s32, 3
    s_and_b32 s4, s4, 3
    s_mul_i32 s4, s4, 49152
    s_add_u32 s4, s4, s43
    s_add_u32 s5, s4, 6144
    v_cvt_pk_bf16_f32 v160, v144, v145
    v_cvt_pk_bf16_f32 v161, v152, v153
    v_cvt_pk_bf16_f32 v162, v146, v147
    v_cvt_pk_bf16_f32 v163, v154, v155
    buffer_store_dwordx4 v[160:163], v2, s[8:11], s4 offen offset:0 sc1
    v_cvt_pk_bf16_f32 v164, v148, v149
    v_cvt_pk_bf16_f32 v165, v156, v157
    v_cvt_pk_bf16_f32 v166, v150, v151
    v_cvt_pk_bf16_f32 v167, v158, v159
    buffer_store_dwordx4 v[164:167], v2, s[8:11], s5 offen offset:0 sc1
    s_waitcnt vmcnt(0)
    v_mov_b32 v10, s32
    s_mov_b64 exec, 1
    buffer_store_dword v10, v9, s[8:11], s33 offen sc1
    s_mov_b64 exec, -1
Vs_loop:
    s_and_b32 s4, s21, 3
    s_mul_i32 s5, s4, 10240
    s_add_u32 s5, s5, s22
    s_sub_u32 s38, s5, 73728
    s_sub_u32 s39, s5, 81920
    s_mul_i32 s5, s4, 12288
    s_add_u32 s25, s24, s5
    s_xor_b32 s4, s4, 2
    s_mul_i32 s5, s4, 163840
    s_add_u32 s34, s36, s5
    s_mul_i32 s5, s4, 12288
    s_add_u32 s26, s24, s5
    s_add_u32 s21, s21, 1
    v_mov_b32 v72, 0
    v_mov_b32 v73, 0
    v_mov_b32 v74, 0
    v_mov_b32 v75, 0
    v_mov_b32 v76, 0
    v_mov_b32 v77, 0
    v_mov_b32 v78, 0
    v_mov_b32 v79, 0
    v_mov_b32 v59, s21
    s_cmp_eq_u32 s3, 1
    s_cbranch_scc1 Vs_q1
    s_cmp_eq_u32 s3, 2
    s_cbranch_scc1 Vs_q2
    s_cmp_eq_u32 s3, 3
    s_cbranch_scc1 Vs_q3
Vs_q0:
    s_mov_b64 s[4:5], -1
    s_mov_b64 s[6:7], -1
    s_mov_b64 s[92:93], -1
    s_mov_b32 s31, -1
Vs0m_l:
    s_mov_b64 exec, s[4:5]
    buffer_load_dwordx4 v[16:19], v3, s[8:11], s38 offen offset:0 sc1
    s_mov_b64 exec, s[6:7]
    buffer_load_dwordx4 v[20:23], v3, s[8:11], s38 offen offset:1024 sc1
    s_mov_b64 exec, s[92:93]
    buffer_load_dwordx2 v[56:57], v4, s[8:11], s39 offen offset:0 sc1
    s_mov_b64 exec, -1
    s_add_u32 s31, s31, 1
    s_cmp_lt_u32 s31, s30
    s_cselect_b32 s30, s30, 1
    s_cbranch_scc0 Vs0m_o
    s_waitcnt vmcnt(0)
    v_max3_u32 v58, v16, v17, v18
    v_max3_u32 v60, v20, v21, v22
    v_max_u32 v61, v56, v57
    v_max_u32 v58, v58, v19
    v_max_u32 v60, v60, v23
    v_cmp_eq_u32 s[92:93], -1, v61
    v_cmp_eq_u32 s[4:5], -1, v58
    v_cmp_eq_u32 s[6:7], -1, v60
    s_or_b64 s[94:95], s[92:93], s[4:5]
    s_or_b64 s[94:95], s[94:95], s[6:7]
    s_cbranch_scc1 Vs0m_l
Vs0m_o:
    ds_write_b128 v3, v[16:19] offset:8192
    ds_write_b128 v3, v[20:23] offset:9216
    ds_write_b64 v4, v[56:57]
    v_smfmac_f32_16x16x64_bf16 v[72:75], v[16:19], a[0:7], v5
    v_smfmac_f32_16x16x64_bf16 v[76:79], v[16:19], a[80:87], v5
    s_waitcnt lgkmcnt(0)
    s_barrier
    ds_read_b128 v[24:27], v3 offset:10240
    ds_read_b128 v[28:31], v3 offset:11264
    ds_read_b128 v[32:35], v3 offset:12288
    v_smfmac_f32_16x16x64_bf16 v[72:75], v[20:23], a[8:15], v5
    ds_read_b128 v[36:39], v3 offset:13312
    ds_read_b128 v[40:43], v3 offset:14336
    v_smfmac_f32_16x16x64_bf16 v[76:79], v[20:23], a[88:95], v5
    ds_read_b128 v[44:47], v3 offset:15360
    ds_read_b128 v[48:51], v3 offset:16384
    ds_read_b128 v[52:55], v3 offset:17408
    s_waitcnt lgkmcnt(7)
    v_smfmac_f32_16x16x64_bf16 v[72:75], v[24:27], a[16:23], v5
    v_smfmac_f32_16x16x64_bf16 v[76:79], v[24:27], a[96:103], v5
    s_waitcnt lgkmcnt(6)
    v_smfmac_f32_16x16x64_bf16 v[72:75], v[28:31], a[24:31], v5
    v_smfmac_f32_16x16x64_bf16 v[76:79], v[28:31], a[104:111], v5
    s_waitcnt lgkmcnt(5)
    v_smfmac_f32_16x16x64_bf16 v[72:75], v[32:35], a[32:39], v5
    v_smfmac_f32_16x16x64_bf16 v[76:79], v[32:35], a[112:119], v5
    s_waitcnt lgkmcnt(4)
    v_smfmac_f32_16x16x64_bf16 v[72:75], v[36:39], a[40:47], v5
    v_smfmac_f32_16x16x64_bf16 v[76:79], v[36:39], a[120:127], v5
    s_waitcnt lgkmcnt(3)
    v_smfmac_f32_16x16x64_bf16 v[72:75], v[40:43], a[48:55], v5
    v_smfmac_f32_16x16x64_bf16 v[76:79], v[40:43], a[128:135], v5
    s_waitcnt lgkmcnt(2)
    v_smfmac_f32_16x16x64_bf16 v[72:75], v[44:47], a[56:63], v5
    v_smfmac_f32_16x16x64_bf16 v[76:79], v[44:47], a[136:143], v5
    s_waitcnt lgkmcnt(1)
    v_smfmac_f32_16x16x64_bf16 v[72:75], v[48:51], a[64:71], v5
    buffer_store_dword v59, v14, s[8:11], s44 offen offset:0 sc1
    v_smfmac_f32_16x16x64_bf16 v[76:79], v[48:51], a[144:151], v5
    s_waitcnt lgkmcnt(0)
    v_smfmac_f32_16x16x64_bf16 v[72:75], v[52:55], a[72:79], v5
    v_smfmac_f32_16x16x64_bf16 v[76:79], v[52:55], a[152:159], v5
    s_nop 3
    v_cvt_pk_bf16_f32 v80, v72, v73
    v_cvt_pk_bf16_f32 v81, v74, v75
    s_nop 1
    v_cvt_pk_bf16_f32 v82, v76, v77
    v_cvt_pk_bf16_f32 v83, v78, v79
    s_nop 1
    v_mfma_f32_16x16x32_bf16 v[88:91], v[80:83], v[84:87], 0
    s_branch Vs_qj
Vs_q1:
    s_mov_b64 s[4:5], -1
    s_mov_b64 s[6:7], -1
    s_mov_b64 s[92:93], -1
    s_mov_b32 s31, -1
Vs1m_l:
    s_mov_b64 exec, s[4:5]
    buffer_load_dwordx4 v[16:19], v3, s[8:11], s38 offen offset:0 sc1
    s_mov_b64 exec, s[6:7]
    buffer_load_dwordx4 v[20:23], v3, s[8:11], s38 offen offset:1024 sc1
    s_mov_b64 exec, s[92:93]
    buffer_load_dwordx2 v[56:57], v4, s[8:11], s39 offen offset:0 sc1
    s_mov_b64 exec, -1
    s_add_u32 s31, s31, 1
    s_cmp_lt_u32 s31, s30
    s_cselect_b32 s30, s30, 1
    s_cbranch_scc0 Vs1m_o
    s_waitcnt vmcnt(0)
    v_max3_u32 v58, v16, v17, v18
    v_max3_u32 v60, v20, v21, v22
    v_max_u32 v61, v56, v57
    v_max_u32 v58, v58, v19
    v_max_u32 v60, v60, v23
    v_cmp_eq_u32 s[92:93], -1, v61
    v_cmp_eq_u32 s[4:5], -1, v58
    v_cmp_eq_u32 s[6:7], -1, v60
    s_or_b64 s[94:95], s[92:93], s[4:5]
    s_or_b64 s[94:95], s[94:95], s[6:7]
    s_cbranch_scc1 Vs1m_l
Vs1m_o:
    ds_write_b128 v3, v[16:19] offset:8192
    ds_write_b128 v3, v[20:23] offset:9216
    ds_write_b64 v4, v[56:57]
    v_smfmac_f32_16x16x64_bf16 v[72:75], v[16:19], a[16:23], v5
    v_smfmac_f32_16x16x64_bf16 v[76:79], v[16:19], a[96:103], v5
    s_waitcnt lgkmcnt(0)
    s_barrier
    ds_read_b128 v[24:27], v3 offset:10240
    ds_read_b128 v[28:31], v3 offset:11264
    ds_read_b128 v[32:35], v3 offset:12288
    v_smfmac_f32_16x16x64_bf16 v[72:75], v[20:23], a[24:31], v5
    ds_read_b128 v[36:39], v3 offset:13312
    ds_read_b128 v[40:43], v3 offset:6144
    v_smfmac_f32_16x16x64_bf16 v[76:79], v[20:23], a[104:111], v5
    ds_read_b128 v[44:47], v3 offset:7168
    ds_read_b128 v[48:51], v3 offset:14336
    ds_read_b128 v[52:55], v3 offset:15360
    s_waitcnt lgkmcnt(7)
    v_smfmac_f32_16x16x64_bf16 v[72:75], v[24:27], a[32:39], v5
    v_smfmac_f32_16x16x64_bf16 v[76:79], v[24:27], a[112:119], v5
    s_waitcnt lgkmcnt(6)
    v_smfmac_f32_16x16x64_bf16 v[72:75], v[28:31], a[40:47], v5
    v_smfmac_f32_16x16x64_bf16 v[76:79], v[28:31], a[120:127], v5
    s_waitcnt lgkmcnt(5)
    v_smfmac_f32_16x16x64_bf16 v[72:75], v[32:35], a[48:55], v5
    v_smfmac_f32_16x16x64_bf16 v[76:79], v[32:35], a[128:135], v5
    s_waitcnt lgkmcnt(4)
    v_smfmac_f32_16x16x64_bf16 v[72:75], v[36:39], a[56:63], v5
    v_smfmac_f32_16x16x64_bf16 v[76:79], v[36:39], a[136:143], v5
    s_waitcnt lgkmcnt(3)
    v_smfmac_f32_16x16x64_bf16 v[72:75], v[40:43], a[0:7], v5
    v_smfmac_f32_16x16x64_bf16 v[76:79], v[40:43], a[80:87], v5
    s_waitcnt lgkmcnt(2)
    v_smfmac_f32_16x16x64_bf16 v[72:75], v[44:47], a[8:15], v5
    v_smfmac_f32_16x16x64_bf16 v[76:79], v[44:47], a[88:95], v5
    s_waitcnt lgkmcnt(1)
    v_smfmac_f32_16x16x64_bf16 v[72:75], v[48:51], a[64:71], v5
    buffer_store_dword v59, v14, s[8:11], s44 offen offset:0 sc1
    v_smfmac_f32_16x16x64_bf16 v[76:79], v[48:51], a[144:151], v5
    s_waitcnt lgkmcnt(0)
    v_smfmac_f32_16x16x64_bf16 v[72:75], v[52:55], a[72:79], v5
    v_smfmac_f32_16x16x64_bf16 v[76:79], v[52:55], a[152:159], v5
    s_nop 3
    v_cvt_pk_bf16_f32 v80, v72, v73
    v_cvt_pk_bf16_f32 v81, v74, v75
    s_nop 1
    v_cvt_pk_bf16_f32 v82, v76, v77
    v_cvt_pk_bf16_f32 v83, v78, v79
    s_nop 1
    v_mfma_f32_16x16x32_bf16 v[88:91], v[80:83], v[84:87], 0
    s_branch Vs_qj
Vs_q2:
    s_mov_b64 s[4:5], -1
    s_mov_b64 s[6:7], -1
    s_mov_b64 s[92:93], -1
    s_mov_b32 s31, -1
Vs2m_l:
    s_mov_b64 exec, s[4:5]
    buffer_load_dwordx4 v[16:19], v3, s[8:11], s38 offen offset:0 sc1
    s_mov_b64 exec, s[6:7]
    buffer_load_dwordx4 v[20:23], v3, s[8:11], s38 offen offset:1024 sc1
    s_mov_b64 exec, s[92:93]
    buffer_load_dwordx2 v[56:57], v4, s[8:11], s39 offen offset:0 sc1
    s_mov_b64 exec, -1
    s_add_u32 s31, s31, 1
    s_cmp_lt_u32 s31, s30
    s_cselect_b32 s30, s30, 1
    s_cbranch_scc0 Vs2m_o
    s_waitcnt vmcnt(0)
    v_max3_u32 v58, v16, v17, v18
    v_max3_u32 v60, v20, v21, v22
    v_max_u32 v61, v56, v57
    v_max_u32 v58, v58, v19
    v_max_u32 v60, v60, v23
    v_cmp_eq_u32 s[92:93], -1, v61
    v_cmp_eq_u32 s[4:5], -1, v58
    v_cmp_eq_u32 s[6:7], -1, v60
    s_or_b64 s[94:95], s[92:93], s[4:5]
    s_or_b64 s[94:95], s[94:95], s[6:7]
    s_cbranch_scc1 Vs2m_l
Vs2m_o:
    ds_write_b128 v3, v[16:19] offset:8192
    ds_write_b128 v3, v[20:23] offset:9216
    ds_write_b64 v4, v[56:57]
    v_smfmac_f32_16x16x64_bf16 v[72:75], v[16:19], a[32:39], v5
    v_smfmac_f32_16x16x64_bf16 v[76:79], v[16:19], a[112:119], v5
    s_waitcnt lgkmcnt(0)
    s_barrier
    ds_read_b128 v[24:27], v3 offset:10240
    ds_read_b128 v[28:31], v3 offset:11264
    ds_read_b128 v[32:35], v3 offset:4096
    v_smfmac_f32_16x16x64_bf16 v[72:75], v[20:23], a[40:47], v5
    ds_read_b128 v[36:39], v3 offset:5120
    ds_read_b128 v[40:43], v3 offset:6144
    v_smfmac_f32_16x16x64_bf16 v[76:79], v[20:23], a[120:127], v5
    ds_read_b128 v[44:47], v3 offset:7168
    ds_read_b128 v[48:51], v3 offset:12288
    ds_read_b128 v[52:55], v3 offset:13312
    s_waitcnt lgkmcnt(7)
    v_smfmac_f32_16x16x64_bf16 v[72:75], v[24:27], a[48:55], v5
    v_smfmac_f32_16x16x64_bf16 v[76:79], v[24:27], a[128:135], v5
    s_waitcnt lgkmcnt(6)
    v_smfmac_f32_16x16x64_bf16 v[72:75], v[28:31], a[56:63], v5
    v_smfmac_f32_16x16x64_bf16 v[76:79], v[28:31], a[136:143], v5
    s_waitcnt lgkmcnt(5)
    v_smfmac_f32_16x16x64_bf16 v[72:75], v[32:35], a[0:7], v5
    v_smfmac_f32_16x16x64_bf16 v[76:79], v[32:35], a[80:87], v5
    s_waitcnt lgkmcnt(4)
    v_smfmac_f32_16x16x64_bf16 v[72:75], v[36:39], a[8:15], v5
    v_smfmac_f32_16x16x64_bf16 v[76:79], v[36:39], a[88:95], v5
    s_waitcnt lgkmcnt(3)
    v_smfmac_f32_16x16x64_bf16 v[72:75], v[40:43], a[16:23], v5
    v_smfmac_f32_16x16x64_bf16 v[76:79], v[40:43], a[96:103], v5
    s_waitcnt lgkmcnt(2)
    v_smfmac_f32_16x16x64_bf16 v[72:75], v[44:47], a[24:31], v5
    v_smfmac_f32_16x16x64_bf16 v[76:79], v[44:47], a[104:111], v5
    s_waitcnt lgkmcnt(1)
    v_smfmac_f32_16x16x64_bf16 v[72:75], v[48:51], a[64:71], v5
    buffer_store_dword v59, v14, s[8:11], s44 offen offset:0 sc1
    v_smfmac_f32_16x16x64_bf16 v[76:79], v[48:51], a[144:151], v5
    s_waitcnt lgkmcnt(0)
    v_smfmac_f32_16x16x64_bf16 v[72:75], v[52:55], a[72:79], v5
    v_smfmac_f32_16x16x64_bf16 v[76:79], v[52:55], a[152:159], v5
    s_nop 3
    v_cvt_pk_bf16_f32 v80, v72, v73
    v_cvt_pk_bf16_f32 v81, v74, v75
    s_nop 1
    v_cvt_pk_bf16_f32 v82, v76, v77
    v_cvt_pk_bf16_f32 v83, v78, v79
    s_nop 1
    v_mfma_f32_16x16x32_bf16 v[88:91], v[80:83], v[84:87], 0
    s_branch Vs_qj
Vs_q3:
    s_mov_b64 s[4:5], -1
    s_mov_b64 s[6:7], -1
    s_mov_b64 s[92:93], -1
    s_mov_b32 s31, -1
Vs3m_l:
    s_mov_b64 exec, s[4:5]
    buffer_load_dwordx4 v[16:19], v3, s[8:11], s38 offen offset:0 sc1
    s_mov_b64 exec, s[6:7]
    buffer_load_dwordx4 v[20:23], v3, s[8:11], s38 offen offset:1024 sc1
    s_mov_b64 exec, s[92:93]
    buffer_load_dwordx2 v[56:57], v4, s[8:11], s39 offen offset:0 sc1
    s_mov_b64 exec, -1
    s_add_u32 s31, s31, 1
    s_cmp_lt_u32 s31, s30
    s_cselect_b32 s30, s30, 1
    s_cbranch_scc0 Vs3m_o
    s_waitcnt vmcnt(0)
    v_max3_u32 v58, v16, v17, v18
    v_max3_u32 v60, v20, v21, v22
    v_max_u32 v61, v56, v57
    v_max_u32 v58, v58, v19
    v_max_u32 v60, v60, v23
    v_cmp_eq_u32 s[92:93], -1, v61
    v_cmp_eq_u32 s[4:5], -1, v58
    v_cmp_eq_u32 s[6:7], -1, v60
    s_or_b64 s[94:95], s[92:93], s[4:5]
    s_or_b64 s[94:95], s[94:95], s[6:7]
    s_cbranch_scc1 Vs3m_l
Vs3m_o:
    ds_write_b128 v3, v[16:19] offset:8192
    ds_write_b128 v3, v[20:23] offset:9216
    ds_write_b64 v4, v[56:57]
    v_smfmac_f32_16x16x64_bf16 v[72:75], v[16:19], a[48:55], v5
    v_smfmac_f32_16x16x64_bf16 v[76:79], v[16:19], a[128:135], v5
    s_waitcnt lgkmcnt(0)
    s_barrier
    ds_read_b128 v[24:27], v3 offset:2048
    ds_read_b128 v[28:31], v3 offset:3072
    ds_read_b128 v[32:35], v3 offset:4096
    v_smfmac_f32_16x16x64_bf16 v[72:75], v[20:23], a[56:63], v5
    ds_read_b128 v[36:39], v3 offset:5120
    ds_read_b128 v[40:43], v3 offset:6144
    v_smfmac_f32_16x16x64_bf16 v[76:79], v[20:23], a[136:143], v5
    ds_read_b128 v[44:47], v3 offset:7168
    ds_read_b128 v[48:51], v3 offset:10240
    ds_read_b128 v[52:55], v3 offset:11264
    s_waitcnt lgkmcnt(7)
    v_smfmac_f32_16x16x64_bf16 v[72:75], v[24:27], a[0:7], v5
    v_smfmac_f32_16x16x64_bf16 v[76:79], v[24:27], a[80:87], v5
    s_waitcnt lgkmcnt(6)
    v_smfmac_f32_16x16x64_bf16 v[72:75], v[28:31], a[8:15], v5
    v_smfmac_f32_16x16x64_bf16 v[76:79], v[28:31], a[88:95], v5
    s_waitcnt lgkmcnt(5)
    v_smfmac_f32_16x16x64_bf16 v[72:75], v[32:35], a[16:23], v5
    v_smfmac_f32_16x16x64_bf16 v[76:79], v[32:35], a[96:103], v5
    s_waitcnt lgkmcnt(4)
    v_smfmac_f32_16x16x64_bf16 v[72:75], v[36:39], a[24:31], v5
    v_smfmac_f32_16x16x64_bf16 v[76:79], v[36:39], a[104:111], v5
    s_waitcnt lgkmcnt(3)
    v_smfmac_f32_16x16x64_bf16 v[72:75], v[40:43], a[32:39], v5
    v_smfmac_f32_16x16x64_bf16 v[76:79], v[40:43], a[112:119], v5
    s_waitcnt lgkmcnt(2)
    v_smfmac_f32_16x16x64_bf16 v[72:75], v[44:47], a[40:47], v5
    v_smfmac_f32_16x16x64_bf16 v[76:79], v[44:47], a[120:127], v5
    s_waitcnt lgkmcnt(1)
    v_smfmac_f32_16x16x64_bf16 v[72:75], v[48:51], a[64:71], v5
    buffer_store_dword v59, v14, s[8:11], s44 offen offset:0 sc1
    v_smfmac_f32_16x16x64_bf16 v[76:79], v[48:51], a[144:151], v5
    s_waitcnt lgkmcnt(0)
    v_smfmac_f32_16x16x64_bf16 v[72:75], v[52:55], a[72:79], v5
    v_smfmac_f32_16x16x64_bf16 v[76:79], v[52:55], a[152:159], v5
    s_nop 3
    v_cvt_pk_bf16_f32 v80, v72, v73
    v_cvt_pk_bf16_f32 v81, v74, v75
    s_nop 1
    v_cvt_pk_bf16_f32 v82, v76, v77
    v_cvt_pk_bf16_f32 v83, v78, v79
    s_nop 1
    v_mfma_f32_16x16x32_bf16 v[88:91], v[80:83], v[84:87], 0
Vs_qj:
    s_nop 7
    v_cvt_pk_bf16_f32 v94, v88, v89
    v_cvt_pk_bf16_f32 v95, v90, v91
    buffer_store_dwordx2 v[94:95], v6, s[8:11], s25 offen offset:0 sc1
    s_cmp_lt_u32 s32, 64
    s_cbranch_scc0 Vs_nb
    s_cmp_eq_u32 s32, 14
    s_cbranch_scc0 Vs_h
    s_mov_b32 s31, 0
    s_waitcnt vmcnt(63)
    s_branch VsB1_c
VsB1_l:
    buffer_load_dword v68, v70, s[8:11], s23 offen sc1
    s_waitcnt vmcnt(0)
VsB1_c:
    v_cmp_gt_u32 vcc, 1, v68
    s_cbranch_vccz VsB1_o
    s_sleep 4
    s_add_u32 s31, s31, 1
    s_cmp_lt_u32 s31, s30
    s_cbranch_scc1 VsB1_l
    s_mov_b32 s30, 1
VsB1_o:
Vs_h:
    s_cmp_gt_u32 s32, 3
    s_cbranch_scc1 VsB0_o
    s_cmp_eq_u32 s32, 1
    s_cbranch_scc0 VsBA_o
    s_mov_b32 s31, 0
    s_waitcnt vmcnt(63)
    s_branch VsBA_c
VsBA_l:
    buffer_load_dword v68, v71, s[8:11], s49 offen sc1
    s_waitcnt vmcnt(0)
VsBA_c:
    v_cmp_gt_u32 vcc, 1, v68
    s_cbranch_vccz VsBA_o
    s_sleep 2
    s_add_u32 s31, s31, 1
    s_cmp_lt_u32 s31, s30
    s_cbranch_scc1 VsBA_l
    s_mov_b32 s30, 1
VsBA_o:
    s_cmp_eq_u32 s32, 3
    s_cbranch_scc0 VsB0_o
    s_mov_b32 s31, 0
    s_waitcnt vmcnt(63)
    s_branch VsB0_c
VsB0_l:
    buffer_load_dword v68, v70, s[8:11], s49 offen sc1
    s_waitcnt vmcnt(0)
VsB0_c:
    v_cmp_gt_u32 vcc, 1, v68
    s_cbranch_vccz VsB0_o
    s_sleep 2
    s_add_u32 s31, s31, 1
    s_cmp_lt_u32 s31, s30
    s_cbranch_scc1 VsB0_l
    s_mov_b32 s30, 1
VsB0_o:
    v_add_u32 v11, s29, v2
    s_xor_b32 s29, s29, 40960
    s_add_u32 s42, s29, s27
    ds_read_b128 a[160:163], v11 offset:0
    ds_read_b128 a[164:167], v11 offset:20480
    ds_read_b128 a[168:171], v11 offset:1024
    ds_read_b128 a[172:175], v11 offset:21504
    ds_read_b128 a[176:179], v11 offset:2048
    ds_read_b128 a[180:183], v11 offset:22528
    s_waitcnt lgkmcnt(5)
    v_mfma_f32_16x16x32_bf16 v[144:147], a[0:3], a[160:163], 0
    ds_read_b128 a[184:187], v11 offset:3072
    v_mfma_f32_16x16x32_bf16 v[152:155], a[80:83], a[160:163], 0
    s_waitcnt lgkmcnt(5)
    v_mfma_f32_16x16x32_bf16 v[148:151], a[0:3], a[164:167], 0
    ds_read_b128 a[188:191], v11 offset:23552
    v_mfma_f32_16x16x32_bf16 v[156:159], a[80:83], a[164:167], 0
    s_waitcnt lgkmcnt(5)
    v_mfma_f32_16x16x32_bf16 v[144:147], a[4:7], a[168:171], v[144:147]
    ds_read_b128 a[160:163], v11 offset:4096
    s_add_u32 s35, s28, 0
    s_add_u32 m0, s42, 0
    v_mfma_f32_16x16x32_bf16 v[152:155], a[84:87], a[168:171], v[152:155]
    buffer_load_dwordx4 v2, s[8:11], s35 offen offset:0 sc1 lds
    s_waitcnt lgkmcnt(5)
    v_mfma_f32_16x16x32_bf16 v[148:151], a[4:7], a[172:175], v[148:151]
    ds_read_b128 a[164:167], v11 offset:24576
    v_mfma_f32_16x16x32_bf16 v[156:159], a[84:87], a[172:175], v[156:159]
    s_waitcnt lgkmcnt(5)
    v_mfma_f32_16x16x32_bf16 v[144:147], a[8:11], a[176:179], v[144:147]
    ds_read_b128 a[168:171], v11 offset:5120
    v_mfma_f32_16x16x32_bf16 v[152:155], a[88:91], a[176:179], v[152:155]
    s_waitcnt lgkmcnt(5)
    v_mfma_f32_16x16x32_bf16 v[148:151], a[8:11], a[180:183], v[148:151]
    ds_read_b128 a[172:175], v11 offset:25600
    v_mfma_f32_16x16x32_bf16 v[156:159], a[88:91], a[180:183], v[156:159]
    buffer_load_dwordx4 v2, s[8:11], s35 offen offset:1024 sc1 lds
    s_waitcnt lgkmcnt(5)
    v_mfma_f32_16x16x32_bf16 v[144:147], a[12:15], a[184:187], v[144:147]
    ds_read_b128 a[176:179], v11 offset:6144
    v_mfma_f32_16x16x32_bf16 v[152:155], a[92:95], a[184:187], v[152:155]
    s_waitcnt lgkmcnt(5)
    v_mfma_f32_16x16x32_bf16 v[148:151], a[12:15], a[188:191], v[148:151]
    ds_read_b128 a[180:183], v11 offset:26624
    v_mfma_f32_16x16x32_bf16 v[156:159], a[92:95], a[188:191], v[156:159]
    s_waitcnt lgkmcnt(5)
    v_mfma_f32_16x16x32_bf16 v[144:147], a[16:19], a[160:163], v[144:147]
    ds_read_b128 a[184:187], v11 offset:7168
    v_mfma_f32_16x16x32_bf16 v[152:155], a[96:99], a[160:163], v[152:155]
    buffer_load_dwordx4 v2, s[8:11], s35 offen offset:2048 sc1 lds
    s_waitcnt lgkmcnt(5)
    v_mfma_f32_16x16x32_bf16 v[148:151], a[16:19], a[164:167], v[148:151]
    ds_read_b128 a[188:191], v11 offset:27648
    v_mfma_f32_16x16x32_bf16 v[156:159], a[96:99], a[164:167], v[156:159]
    s_waitcnt lgkmcnt(5)
    v_mfma_f32_16x16x32_bf16 v[144:147], a[20:23], a[168:171], v[144:147]
    ds_read_b128 a[160:163], v11 offset:8192
    v_mfma_f32_16x16x32_bf16 v[152:155], a[100:103], a[168:171], v[152:155]
    s_waitcnt lgkmcnt(5)
    v_mfma_f32_16x16x32_bf16 v[148:151], a[20:23], a[172:175], v[148:151]
    ds_read_b128 a[164:167], v11 offset:28672
    v_mfma_f32_16x16x32_bf16 v[156:159], a[100:103], a[172:175], v[156:159]
    buffer_load_dwordx4 v2, s[8:11], s35 offen offset:3072 sc1 lds
    s_waitcnt lgkmcnt(5)
    v_mfma_f32_16x16x32_bf16 v[144:147], a[24:27], a[176:179], v[144:147]
    ds_read_b128 a[168:171], v11 offset:9216
    v_mfma_f32_16x16x32_bf16 v[152:155], a[104:107], a[176:179], v[152:155]
    s_waitcnt lgkmcnt(5)
    v_mfma_f32_16x16x32_bf16 v[148:151], a[24:27], a[180:183], v[148:151]
    ds_read_b128 a[172:175], v11 offset:29696
    v_mfma_f32_16x16x32_bf16 v[156:159], a[104:107], a[180:183], v[156:159]
    s_waitcnt lgkmcnt(5)
    v_mfma_f32_16x16x32_bf16 v[144:147], a[28:31], a[184:187], v[144:147]
    ds_read_b128 a[176:179], v11 offset:10240
    s_add_u32 s35, s28, 4096
    s_add_u32 m0, s42, 4096
    v_mfma_f32_16x16x32_bf16 v[152:155], a[108:111], a[184:187], v[152:155]
    buffer_load_dwordx4 v2, s[8:11], s35 offen offset:0 sc1 lds
    s_waitcnt lgkmcnt(5)
    v_mfma_f32_16x16x32_bf16 v[148:151], a[28:31], a[188:191], v[148:151]
    ds_read_b128 a[180:183], v11 offset:30720
    v_mfma_f32_16x16x32_bf16 v[156:159], a[108:111], a[188:191], v[156:159]
    s_waitcnt lgkmcnt(5)
    v_mfma_f32_16x16x32_bf16 v[144:147], a[32:35], a[160:163], v[144:147]
    ds_read_b128 a[184:187], v11 offset:11264
    v_mfma_f32_16x16x32_bf16 v[152:155], a[112:115], a[160:163], v[152:155]
    s_waitcnt lgkmcnt(5)
    v_mfma_f32_16x16x32_bf16 v[148:151], a[32:35], a[164:167], v[148:151]
    ds_read_b128 a[188:191], v11 offset:31744
    v_mfma_f32_16x16x32_bf16 v[156:159], a[112:115], a[164:167], v[156:159]
    buffer_load_dwordx4 v2, s[8:11], s35 offen offset:1024 sc1 lds
    s_waitcnt lgkmcnt(5)
    v_mfma_f32_16x16x32_bf16 v[144:147], a[36:39], a[168:171], v[144:147]
    ds_read_b128 a[160:163], v11 offset:12288
    v_mfma_f32_16x16x32_bf16 v[152:155], a[116:119], a[168:171], v[152:155]
    s_waitcnt lgkmcnt(5)
    v_mfma_f32_16x16x32_bf16 v[148:151], a[36:39], a[172:175], v[148:151]
    ds_read_b128 a[164:167], v11 offset:32768
    v_mfma_f32_16x16x32_bf16 v[156:159], a[116:119], a[172:175], v[156:159]
    s_waitcnt lgkmcnt(5)
    v_mfma_f32_16x16x32_bf16 v[144:147], a[40:43], a[176:179], v[144:147]
    ds_read_b128 a[168:171], v11 offset:13312
    v_mfma_f32_16x16x32_bf16 v[152:155], a[120:123], a[176:179], v[152:155]
    buffer_load_dwordx4 v2, s[8:11], s35 offen offset:2048 sc1 lds
    s_waitcnt lgkmcnt(5)
    v_mfma_f32_16x16x32_bf16 v[148:151], a[40:43], a[180:183], v[148:151]
    ds_read_b128 a[172:175], v11 offset:33792
    v_mfma_f32_16x16x32_bf16 v[156:159], a[120:123], a[180:183], v[156:159]
    buffer_store_dwordx2 v[240:241], v6, s[8:11], s26 offen offset:0 sc1
    buffer_store_dwordx4 v[240:243], v7, s[8:11], s34 offen offset:0 sc1
    s_waitcnt lgkmcnt(5)
    v_mfma_f32_16x16x32_bf16 v[144:147], a[44:47], a[184:187], v[144:147]
    ds_read_b128 a[176:179], v11 offset:14336
    v_mfma_f32_16x16x32_bf16 v[152:155], a[124:127], a[184:187], v[152:155]
    s_waitcnt lgkmcnt(5)
    v_mfma_f32_16x16x32_bf16 v[148:151], a[44:47], a[188:191], v[148:151]
    ds_read_b128 a[180:183], v11 offset:34816
    v_mfma_f32_16x16x32_bf16 v[156:159], a[124:127], a[188:191], v[156:159]
    buffer_load_dwordx4 v2, s[8:11], s35 offen offset:3072 sc1 lds
    s_waitcnt lgkmcnt(5)
    v_mfma_f32_16x16x32_bf16 v[144:147], a[48:51], a[160:163], v[144:147]
    ds_read_b128 a[184:187], v11 offset:15360
    v_mfma_f32_16x16x32_bf16 v[152:155], a[128:131], a[160:163], v[152:155]
    s_waitcnt lgkmcnt(5)
    v_mfma_f32_16x16x32_bf16 v[148:151], a[48:51], a[164:167], v[148:151]
    ds_read_b128 a[188:191], v11 offset:35840
    v_mfma_f32_16x16x32_bf16 v[156:159], a[128:131], a[164:167], v[156:159]
    s_waitcnt lgkmcnt(5)
    v_mfma_f32_16x16x32_bf16 v[144:147], a[52:55], a[168:171], v[144:147]
    ds_read_b128 a[160:163], v11 offset:16384
    s_add_u32 s35, s28, 8192
    s_add_u32 m0, s42, 8192
    v_mfma_f32_16x16x32_bf16 v[152:155], a[132:135], a[168:171], v[152:155]
    buffer_load_dwordx4 v2, s[8:11], s35 offen offset:0 sc1 lds
    s_waitcnt lgkmcnt(5)
    v_mfma_f32_16x16x32_bf16 v[148:151], a[52:55], a[172:175], v[148:151]
    ds_read_b128 a[164:167], v11 offset:36864
    v_mfma_f32_16x16x32_bf16 v[156:159], a[132:135], a[172:175], v[156:159]
    s_waitcnt lgkmcnt(5)
    v_mfma_f32_16x16x32_bf16 v[144:147], a[56:59], a[176:179], v[144:147]
    ds_read_b128 a[168:171], v11 offset:17408
    v_mfma_f32_16x16x32_bf16 v[152:155], a[136:139], a[176:179], v[152:155]
    s_waitcnt lgkmcnt(5)
    v_mfma_f32_16x16x32_bf16 v[148:151], a[56:59], a[180:183], v[148:151]
    ds_read_b128 a[172:175], v11 offset:37888
    v_mfma_f32_16x16x32_bf16 v[156:159], a[136:139], a[180:183], v[156:159]
    buffer_load_dwordx4 v2, s[8:11], s35 offen offset:1024 sc1 lds
    s_waitcnt lgkmcnt(5)
    v_mfma_f32_16x16x32_bf16 v[144:147], a[60:63], a[184:187], v[144:147]
    ds_read_b128 a[176:179], v11 offset:18432
    v_mfma_f32_16x16x32_bf16 v[152:155], a[140:143], a[184:187], v[152:155]
    s_waitcnt lgkmcnt(5)
    v_mfma_f32_16x16x32_bf16 v[148:151], a[60:63], a[188:191], v[148:151]
    ds_read_b128 a[180:183], v11 offset:38912
    v_mfma_f32_16x16x32_bf16 v[156:159], a[140:143], a[188:191], v[156:159]
    s_waitcnt lgkmcnt(5)
    v_mfma_f32_16x16x32_bf16 v[144:147], a[64:67], a[160:163], v[144:147]
    ds_read_b128 a[184:187], v11 offset:19456
    v_mfma_f32_16x16x32_bf16 v[152:155], a[144:147], a[160:163], v[152:155]
    s_waitcnt lgkmcnt(5)
    v_mfma_f32_16x16x32_bf16 v[148:151], a[64:67], a[164:167], v[148:151]
    ds_read_b128 a[188:191], v11 offset:39936
    v_mfma_f32_16x16x32_bf16 v[156:159], a[144:147], a[164:167], v[156:159]
    s_waitcnt lgkmcnt(5)
    v_mfma_f32_16x16x32_bf16 v[144:147], a[68:71], a[168:171], v[144:147]
    v_mfma_f32_16x16x32_bf16 v[152:155], a[148:151], a[168:171], v[152:155]
    s_waitcnt lgkmcnt(4)
    v_mfma_f32_16x16x32_bf16 v[148:151], a[68:71], a[172:175], v[148:151]
    v_mfma_f32_16x16x32_bf16 v[156:159], a[148:151], a[172:175], v[156:159]
    s_waitcnt lgkmcnt(3)
    v_mfma_f32_16x16x32_bf16 v[144:147], a[72:75], a[176:179], v[144:147]
    v_mfma_f32_16x16x32_bf16 v[152:155], a[152:155], a[176:179], v[152:155]
    s_waitcnt lgkmcnt(2)
    v_mfma_f32_16x16x32_bf16 v[148:151], a[72:75], a[180:183], v[148:151]
    v_mfma_f32_16x16x32_bf16 v[156:159], a[152:155], a[180:183], v[156:159]
    s_waitcnt lgkmcnt(1)
    v_mfma_f32_16x16x32_bf16 v[144:147], a[76:79], a[184:187], v[144:147]
    v_mfma_f32_16x16x32_bf16 v[152:155], a[156:159], a[184:187], v[152:155]
    s_waitcnt lgkmcnt(0)
    v_mfma_f32_16x16x32_bf16 v[148:151], a[76:79], a[188:191], v[148:151]
    v_mfma_f32_16x16x32_bf16 v[156:159], a[156:159], a[188:191], v[156:159]
    s_add_u32 s28, s28, 40960
    s_add_u32 s32, s32, 1
    s_cmp_eq_u32 s32, 3
    s_cbranch_scc0 Vs_n3
    buffer_load_dword v68, v70, s[8:11], s49 offen offset:0 sc1
Vs_n3:
    s_cmp_eq_u32 s32, 12
    s_cbranch_scc0 Vs_n12
    buffer_load_dword v68, v70, s[8:11], s23 offen offset:0 sc1
Vs_n12:
    s_add_u32 s4, s32, 3
    s_and_b32 s4, s4, 3
    s_mul_i32 s4, s4, 49152
    s_add_u32 s4, s4, s43
    s_add_u32 s5, s4, 6144
    v_cvt_pk_bf16_f32 v160, v144, v145
    v_cvt_pk_bf16_f32 v161, v152, v153
    v_cvt_pk_bf16_f32 v162, v146, v147
    v_cvt_pk_bf16_f32 v163, v154, v155
    buffer_store_dwordx4 v[160:163], v2, s[8:11], s4 offen offset:0 sc1
    v_cvt_pk_bf16_f32 v164, v148, v149
    v_cvt_pk_bf16_f32 v165, v156, v157
    v_cvt_pk_bf16_f32 v166, v150, v151
    v_cvt_pk_bf16_f32 v167, v158, v159
    buffer_store_dwordx4 v[164:167], v2, s[8:11], s5 offen offset:0 sc1
    s_waitcnt vmcnt(0)
    v_mov_b32 v10, s32
    s_mov_b64 exec, 1
    buffer_store_dword v10, v9, s[8:11], s33 offen sc1
    s_mov_b64 exec, -1
    s_cmp_lt_u32 s32, 4
    s_cbranch_scc0 Vs_nb
    s_barrier
    s_branch Vs_h
Vs_nb:
    s_cmp_eq_u32 s21, 62
    s_cbranch_scc0 Vs_np
    s_barrier
    buffer_store_dwordx2 v[240:241], v6, s[8:11], s26 offen offset:0 sc1
    buffer_store_dwordx4 v[240:243], v7, s[8:11], s34 offen offset:0 sc1
Vs_np:
    s_cmp_lt_u32 s21, 63
    s_cbranch_scc1 Vs_loop
    s_cmp_eq_u32 s21, 64
    s_cbranch_scc1 V_t3
    s_load_dwordx2 s[12:13], s[0:1], 0
    s_load_dwordx2 s[16:17], s[0:1], 112
    s_mov_b32 s14, 2621440
    s_mov_b32 s15, 0x20000
    s_mov_b32 s18, 2621440
    s_mov_b32 s19, 0x20000
    s_waitcnt lgkmcnt(0)
    v_lshlrev_b32 v71, 2, v1
    s_add_u32 s4, s20, 48
    s_lshl_b32 s5, s4, 19
    s_add_u32 s5, s5, 23461888
    s_lshl_b32 s4, s4, 5
    s_lshl_b32 s6, s99, 2
    s_add_u32 s4, s4, s6
    s_add_u32 s4, s4, s3
    s_mul_i32 s4, s4, 1280
    buffer_load_dword v224, v71, s[12:15], s4 offen offset:0
    buffer_load_dword v225, v71, s[12:15], s4 offen offset:256
    buffer_load_dword v226, v71, s[12:15], s4 offen offset:512
    buffer_load_dword v227, v71, s[12:15], s4 offen offset:768
    buffer_load_dword v228, v71, s[12:15], s4 offen offset:1024
    buffer_load_dword v229, v9, s[8:11], s5 offen
    buffer_load_dword v229, v9, s[16:19], s4 offen
    s_mov_b32 s5, 61997056
    buffer_load_dword v229, v9, s[8:11], s5 offen
    s_mov_b32 s5, 59244544
    buffer_load_dword v229, v9, s[8:11], s5 offen
    s_load_dwordx2 s[88:89], s[0:1], 64
    s_mov_b32 s90, 1280
    s_mov_b32 s91, 0x20000
    s_waitcnt lgkmcnt(0)
    v_lshlrev_b32 v71, 2, v1
    v_lshlrev_b32 v70, 3, v1
    s_mov_b32 s4, 5120
    buffer_load_dwordx2 v[146:147], v70, s[8:11], s4 offen offset:0 sc1
    buffer_load_dwordx2 v[148:149], v70, s[8:11], s4 offen offset:512 sc1
    buffer_load_dwordx2 v[150:151], v70, s[8:11], s4 offen offset:1024 sc1
    buffer_load_dwordx2 v[152:153], v70, s[8:11], s4 offen offset:1536 sc1
    buffer_load_dwordx2 v[154:155], v70, s[8:11], s4 offen offset:2048 sc1
    s_mov_b32 s5, 7680
    s_mov_b32 s6, 10240
    s_mov_b32 s7, 12800
    buffer_load_dwordx2 v[100:101], v70, s[8:11], s5 offen offset:0 sc1
    buffer_load_dwordx2 v[110:111], v70, s[8:11], s6 offen offset:0 sc1
    buffer_load_dwordx2 v[120:121], v70, s[8:11], s7 offen offset:0 sc1
    buffer_load_dword v140, v71, s[88:91], 0 offen offset:0
    buffer_load_dwordx2 v[102:103], v70, s[8:11], s5 offen offset:512 sc1
    buffer_load_dwordx2 v[112:113], v70, s[8:11], s6 offen offset:512 sc1
    buffer_load_dwordx2 v[122:123], v70, s[8:11], s7 offen offset:512 sc1
    buffer_load_dword v141, v71, s[88:91], 0 offen offset:256
    buffer_load_dwordx2 v[104:105], v70, s[8:11], s5 offen offset:1024 sc1
    buffer_load_dwordx2 v[114:115], v70, s[8:11], s6 offen offset:1024 sc1
    buffer_load_dwordx2 v[124:125], v70, s[8:11], s7 offen offset:1024 sc1
    buffer_load_dword v142, v71, s[88:91], 0 offen offset:512
    buffer_load_dwordx2 v[106:107], v70, s[8:11], s5 offen offset:1536 sc1
    buffer_load_dwordx2 v[116:117], v70, s[8:11], s6 offen offset:1536 sc1
    buffer_load_dwordx2 v[126:127], v70, s[8:11], s7 offen offset:1536 sc1
    buffer_load_dword v143, v71, s[88:91], 0 offen offset:768
    buffer_load_dwordx2 v[108:109], v70, s[8:11], s5 offen offset:2048 sc1
    buffer_load_dwordx2 v[118:119], v70, s[8:11], s6 offen offset:2048 sc1
    buffer_load_dwordx2 v[128:129], v70, s[8:11], s7 offen offset:2048 sc1
    buffer_load_dword v144, v71, s[88:91], 0 offen offset:1024
    s_waitcnt vmcnt(0)
    v_add_f32 v110, 1.0, v110
    v_cvt_pk_bf16_f32 v110, v110, v110
    v_and_b32 v110, 0xffff0000, v110
    v_add_f32 v111, 1.0, v111
    v_cvt_pk_bf16_f32 v111, v111, v111
    v_and_b32 v111, 0xffff0000, v111
    v_add_f32 v112, 1.0, v112
    v_cvt_pk_bf16_f32 v112, v112, v112
    v_and_b32 v112, 0xffff0000, v112
    v_add_f32 v113, 1.0, v113
    v_cvt_pk_bf16_f32 v113, v113, v113
    v_and_b32 v113, 0xffff0000, v113
    v_add_f32 v114, 1.0, v114
    v_cvt_pk_bf16_f32 v114, v114, v114
    v_and_b32 v114, 0xffff0000, v114
    v_add_f32 v115, 1.0, v115
    v_cvt_pk_bf16_f32 v115, v115, v115
    v_and_b32 v115, 0xffff0000, v115
    v_add_f32 v116, 1.0, v116
    v_cvt_pk_bf16_f32 v116, v116, v116
    v_and_b32 v116, 0xffff0000, v116
    v_add_f32 v117, 1.0, v117
    v_cvt_pk_bf16_f32 v117, v117, v117
    v_and_b32 v117, 0xffff0000, v117
    v_add_f32 v118, 1.0, v118
    v_cvt_pk_bf16_f32 v118, v118, v118
    v_and_b32 v118, 0xffff0000, v118
    v_add_f32 v119, 1.0, v119
    v_cvt_pk_bf16_f32 v119, v119, v119
    v_and_b32 v119, 0xffff0000, v119
    v_lshlrev_b32 v130, 16, v140
    v_and_b32 v131, 0xffff0000, v140
    v_lshlrev_b32 v132, 16, v141
    v_and_b32 v133, 0xffff0000, v141
    v_lshlrev_b32 v134, 16, v142
    v_and_b32 v135, 0xffff0000, v142
    v_lshlrev_b32 v136, 16, v143
    v_and_b32 v137, 0xffff0000, v143
    v_lshlrev_b32 v138, 16, v144
    v_and_b32 v139, 0xffff0000, v144
    s_branch Vs_loop
V_t3:
    s_cmp_ge_u32 s20, 16
    s_cbranch_scc1 R_done
    s_waitcnt vmcnt(0)
    s_add_u32 s21, s20, 48
    s_lshl_b32 s96, s99, 2
    s_add_u32 s96, s96, s3
    v_lshlrev_b32 v3, 2, v1
    v_min_u32 v15, 39, v1
    v_lshlrev_b32 v15, 2, v15
    v_add_u32 v15, 155936, v15
    s_load_dwordx2 s[12:13], s[0:1], 0
    s_load_dwordx2 s[16:17], s[0:1], 112
    s_mov_b32 s14, 2621440
    s_mov_b32 s15, 0x20000
    s_mov_b32 s18, 2621440
    s_mov_b32 s19, 0x20000
    s_waitcnt lgkmcnt(0)
    v_lshrrev_b32 v16, 3, v1
    v_lshlrev_b32 v16, 7, v16
    v_and_b32 v17, 7, v1
    v_lshl_add_u32 v16, v17, 2, v16
    s_lshl_b32 s4, s3, 5
    v_add_u32 v16, s4, v16
    s_lshl_b32 s4, s21, 5
    s_add_u32 s4, s4, s96
    s_mul_i32 s24, s4, 1280
    s_add_u32 s25, s24, 59244544
    s_lshr_b32 s5, s4, 2
    s_lshl_b32 s5, s5, 7
    s_lshl_b32 s6, s3, 2
    s_add_u32 s5, s5, s6
    s_add_u32 s42, s5, 61865984
    s_mul_i32 s35, s21, 524288
    s_lshr_b32 s4, s96, 2
    s_mul_i32 s4, s4, 49152
    s_add_u32 s35, s35, s4
    s_add_u32 s35, s35, 23068672
    s_mov_b32 s40, 0
    s_mov_b32 s41, s42
    s_mov_b32 s31, 0
V3w_l:
    buffer_load_dword v18, v15, s[8:11], s22 offen sc1
    s_waitcnt vmcnt(0)
V3w_c:
    v_cmp_gt_u32 vcc, s21, v18
    s_cbranch_vccz V3w_o
    s_sleep 1
    s_add_u32 s31, s31, 1
    s_cmp_lt_u32 s31, s30
    s_cbranch_scc1 V3w_l
    s_mov_b32 s30, 1
V3w_o:
    s_call_b64 s[100:101], T3_sub
    s_mov_b64 exec, 1
    buffer_store_dword v9, v3, s[8:11], s42 offen sc1
    s_mov_b64 exec, -1
    s_waitcnt vmcnt(0)
    s_add_u32 s4, s24, 56623104
    buffer_store_dword v140, v3, s[8:11], s4 offen offset:0 sc1
    buffer_store_dword v141, v3, s[8:11], s4 offen offset:256 sc1
    buffer_store_dword v142, v3, s[8:11], s4 offen offset:512 sc1
    buffer_store_dword v143, v3, s[8:11], s4 offen offset:768 sc1
    buffer_store_dword v144, v3, s[8:11], s4 offen offset:1024 sc1
    s_branch R_done
R_c:
    s_load_dwordx2 s[12:13], s[0:1], 40
    s_load_dwordx2 s[16:17], s[0:1], 8
    s_load_dwordx2 s[84:85], s[0:1], 96
    s_load_dwordx2 s[92:93], s[0:1], 104
    s_mov_b32 s14, 7864320
    s_mov_b32 s15, 0x20000
    s_mov_b32 s18, 10240
    s_mov_b32 s19, 0x20000
    s_mov_b32 s86, 1280
    s_mov_b32 s87, 0x20000
    s_mov_b32 s94, 4915200
    s_mov_b32 s95, 0x20000
    s_waitcnt lgkmcnt(0)
    v_lshlrev_b32 v2, 4, v1
    v_lshlrev_b32 v4, 2, v1
    s_mul_i32 s4, s3, 320
    buffer_load_dword v244, v4, s[84:87], s4 offen
    buffer_load_dword v245, v4, s[84:87], s4 offen offset:256
    s_sub_u32 s98, s20, 18
    s_mul_i32 s28, s99, 10
    s_add_u32 s28, s28, s98
    v_lshrrev_b32 v14, 1, v1
    v_mul_u32_u24 v14, 7680, v14
    v_and_b32 v15, 1, v1
    v_lshl_add_u32 v14, v15, 4, v14
    s_mul_i32 s4, s3, 1228800
    s_lshl_b32 s5, s28, 5
    s_add_u32 s4, s4, s5
    s_mul_i32 s29, s3, 5120
    s_add_u32 s29, s29, 139264
    s_add_u32 m0, s29, 0
    s_nop 0
    buffer_load_dwordx4 v14, s[92:95], s4 offen  lds
    s_add_u32 s4, s4, 245760
    s_add_u32 m0, s29, 1024
    s_nop 0
    buffer_load_dwordx4 v14, s[92:95], s4 offen  lds
    s_add_u32 s4, s4, 245760
    s_add_u32 m0, s29, 2048
    s_nop 0
    buffer_load_dwordx4 v14, s[92:95], s4 offen  lds
    s_add_u32 s4, s4, 245760
    s_add_u32 m0, s29, 3072
    s_nop 0
    buffer_load_dwordx4 v14, s[92:95], s4 offen  lds
    s_add_u32 s4, s4, 245760
    s_add_u32 m0, s29, 4096
    s_nop 0
    buffer_load_dwordx4 v14, s[92:95], s4 offen  lds
    s_add_u32 s4, s4, 245760
    s_mul_i32 s42, s99, 983040
    s_lshl_b32 s4, s98, 7
    s_add_u32 s42, s42, s4
    s_lshl_b32 s98, s98, 2
    s_add_u32 s98, s98, s3
    v_and_b32 v16, 7, v1
    v_lshrrev_b32 v17, 4, v1
    v_mul_u32_u24 v19, 1280, v16
    v_lshl_add_u32 v19, v17, 3, v19
    s_lshl_b32 s4, s98, 5
    buffer_load_dwordx2 v[24:25], v19, s[16:19], s4 offen
    s_lshl_b32 s37, s3, 11
    s_lshl_b32 s4, s3, 4
    s_and_b32 s5, s3, 1
    s_lshl_b32 s5, s5, 1
    v_lshrrev_b32 v60, 3, v1
    v_and_b32 v61, 1, v60
    v_or_b32 v61, s5, v61
    v_add_u32 v60, s4, v60
    v_mul_u32_u24 v13, 1280, v60
    v_bfe_u32 v60, v1, 1, 2
    v_xor_b32 v60, v60, v61
    v_lshlrev_b32 v60, 5, v60
    v_and_b32 v61, 1, v1
    v_lshlrev_b32 v61, 4, v61
    v_add3_u32 v13, v13, v60, v61
    v_lshrrev_b32 v60, 4, v1
    v_lshlrev_b32 v60, 2, v60
    v_bfe_u32 v61, v1, 2, 1
    v_add_u32 v60, v60, v61
    v_bfe_u32 v61, v1, 3, 1
    v_lshlrev_b32 v61, 4, v61
    v_add_u32 v60, v60, v61
    v_lshlrev_b32 v0, 7, v60
    v_bfe_u32 v60, v1, 2, 2
    v_lshlrev_b32 v60, 5, v60
    v_and_b32 v61, 3, v1
    v_lshlrev_b32 v61, 3, v61
    v_add3_u32 v0, v0, v60, v61
    v_mov_b32 v134, 163776
    s_cmp_lg_u32 s3, 0
    s_cbranch_scc1 CC_c
    s_waitcnt vmcnt(8)
    v_readfirstlane_b32 s4, v135
    s_and_b32 s4, s4, s33
    s_nop 0
    v_mov_b32 v135, s4
    ds_write_b32 v134, v135
    s_waitcnt lgkmcnt(0)
CC_c:
    s_barrier
    ds_read_b32 v135, v134
    s_waitcnt lgkmcnt(0)
    v_readfirstlane_b32 s4, v135
    s_cmp_lg_u32 s4, 0
    s_cbranch_scc1 R_ovf
    s_load_dwordx2 s[16:17], s[0:1], 120
    s_mov_b32 s18, 256
    s_mov_b32 s19, 0x20000
    s_waitcnt lgkmcnt(0)
    s_mul_i32 s22, s99, 1048576
    s_add_u32 s22, s22, 8388608
    s_lshl_b32 s33, s20, 4
    s_lshl_b32 s4, s3, 2
    s_add_u32 s33, s33, s4
    s_add_u32 s33, s33, s22
    s_add_u32 s33, s33, 155648
    s_mov_b32 s48, 0xfffffffe
    v_mov_b32 v9, 0
    v_mov_b32 v240, -1
    v_mov_b32 v241, -1
    v_mov_b32 v242, -1
    v_mov_b32 v243, -1
    v_and_b32 v16, 7, v1
    v_lshrrev_b32 v17, 4, v1
    v_bfe_u32 v18, v1, 3, 1
    s_sub_u32 s4, s20, 18
    s_lshl_b32 s4, s4, 9
    s_add_u32 s43, s4, 2801664
    s_lshl_b32 s4, s99, 6
    s_add_u32 s24, s43, s4
    s_and_b32 s4, s99, 3
    s_lshl_b32 s4, s4, 14
    s_add_u32 s43, s43, s4
    s_lshl_b32 s4, s3, 7
    s_add_u32 s43, s43, s4
    s_cmp_eq_u32 s3, 0
    s_cselect_b32 s4, 8, 0
    s_cselect_b32 s44, 255, 0
    s_mov_b32 s45, 0
    v_lshrrev_b32 v198, 0, v1
    v_lshlrev_b32 v198, 13, v198
    v_and_b32 v19, 0, v2
    v_add_u32 v198, v198, v19
    v_mov_b32 v19, 0x80000000
    v_cmp_gt_u32 vcc, s4, v1
    s_nop 1
    v_cndmask_b32 v198, v19, v198, vcc
    s_lshr_b32 s4, s98, 1
    s_lshl_b32 s5, s4, 9
    s_and_b32 s6, s98, 1
    s_lshl_b32 s7, s6, 7
    s_add_u32 s5, s5, s7
    v_lshrrev_b32 v19, 1, v17
    v_lshlrev_b32 v6, 8, v19
    v_lshl_add_u32 v6, v16, 4, v6
    v_and_b32 v19, 1, v17
    v_lshl_add_u32 v6, v19, 3, v6
    v_add_u32 v6, s5, v6
    v_mov_b32 v19, 0x80000000
    v_cmp_ne_u32 vcc, 0, v18
    s_nop 1
    v_cndmask_b32 v6, v6, v19, vcc
    s_lshr_b32 s4, s98, 2
    s_lshl_b32 s4, s4, 14
    s_lshl_b32 s6, s3, 11
    s_add_u32 s4, s4, s6
    v_add_u32 v8, s4, v2
    v_lshrrev_b32 v19, 1, v17
    v_lshlrev_b32 v7, 7, v19
    v_lshl_add_u32 v7, v16, 4, v7
    v_and_b32 v19, 1, v17
    v_lshl_add_u32 v7, v19, 3, v7
    v_lshl_add_u32 v7, v18, 13, v7
    s_lshl_b32 s6, s99, 8
    s_add_u32 s4, s4, s6
    v_add_u32 v7, s4, v7
    v_and_b32 v19, 3, v1
    v_lshlrev_b32 v12, 5, v19
    v_lshl_add_u32 v12, v17, 3, v12
    v_bfe_u32 v19, v1, 2, 2
    v_mul_u32_u24 v19, 49152, v19
    v_add_u32 v12, v12, v19
    v_add_u32 v223, 196608, v12
    s_and_b32 s4, s99, 3
    s_mul_i32 s4, s4, 40
    s_add_u32 s4, s4, s98
    s_lshr_b32 s34, s4, 6
    s_lshl_b32 s34, s34, 14
    s_and_b32 s4, s4, 63
    s_lshl_b32 s4, s4, 7
    s_add_u32 s34, s34, s4
    s_add_u32 s34, s34, 23068672
    s_mov_b64 exec, -1
    s_add_u32 s4, s22, 10240
    s_add_u32 s5, s4, 10240
    buffer_store_dwordx2 v[240:241], v6, s[8:11], s4 offen offset:0 sc1
    buffer_store_dwordx2 v[240:241], v6, s[8:11], s5 offen offset:0 sc1
    s_mov_b32 s4, 2097152
    buffer_store_dwordx2 v[240:241], v7, s[8:11], s4 offen offset:0 sc1
    s_mov_b32 s4, 2260992
    buffer_store_dwordx2 v[240:241], v7, s[8:11], s4 offen offset:0 sc1
    s_mul_i32 s4, s99, 40
    s_add_u32 s4, s4, s98
    s_cmp_lt_u32 s4, 112
    s_cselect_b64 exec, -1, 0
    s_lshl_b32 s4, s4, 10
    s_add_u32 s4, s4, 61865984
    buffer_store_dwordx4 v[240:243], v2, s[8:11], s4 offen offset:0 sc1
    s_mov_b64 exec, -1
    v_mov_b32 v10, 0
    s_mov_b64 exec, 1
    buffer_store_dword v10, v9, s[8:11], s33 offen sc1
    s_mov_b64 exec, -1
    buffer_store_dword v9, v198, s[8:11], s24 offen offset:0 sc1
    v_mov_b32 v26, v6
    s_lshl_b32 s40, s3, 9
    s_add_u32 s40, s40, 159744
    s_waitcnt vmcnt(13)
    v_lshrrev_b32 v10, 4, v1
    v_lshlrev_b32 v10, 6, v10
    v_bfe_u32 v11, v1, 1, 2
    v_lshl_add_u32 v10, v11, 4, v10
    v_and_b32 v11, 1, v1
    v_lshl_add_u32 v10, v11, 3, v10
    v_bfe_u32 v11, v1, 3, 1
    v_lshl_add_u32 v10, v11, 2, v10
    v_add_u32 v10, s40, v10
    v_lshlrev_b32 v6, 16, v244
    v_and_b32 v7, 0xffff0000, v244
    v_lshlrev_b32 v8, 16, v245
    v_and_b32 v9, 0xffff0000, v245
    v_mul_f32 v16, 0xbfb8aa3b, v6
    v_mul_f32 v17, 0xbfb8aa3b, v7
    v_mul_f32 v18, 0xbfb8aa3b, v8
    v_mul_f32 v19, 0xbfb8aa3b, v9
    v_exp_f32 v16, v16
    v_exp_f32 v17, v17
    v_exp_f32 v18, v18
    v_exp_f32 v19, v19
    v_add_f32 v16, 1.0, v16
    v_add_f32 v17, 1.0, v17
    v_add_f32 v18, 1.0, v18
    v_add_f32 v19, 1.0, v19
    v_rcp_f32 v16, v16
    v_rcp_f32 v17, v17
    v_rcp_f32 v18, v18
    v_rcp_f32 v19, v19
    v_mul_f32 v6, v6, v16
    v_mul_f32 v7, v7, v17
    v_mul_f32 v8, v8, v18
    v_mul_f32 v9, v9, v19
    v_cvt_pk_bf16_f32 v4, v6, v7
    v_cvt_pk_bf16_f32 v5, v8, v9
    v_and_b32 v11, 0x30, v1
    v_add_u32 v11, s40, v11
    ds_write_b32 v10, v4
    ds_write_b32 v10, v5 offset:256
    s_waitcnt lgkmcnt(0)
    ds_read_b128 v[220:223], v11 offset:0
    ds_read_b128 v[224:227], v11 offset:64
    ds_read_b128 v[228:231], v11 offset:128
    ds_read_b128 v[232:235], v11 offset:192
    ds_read_b128 v[236:239], v11 offset:256
    s_waitcnt vmcnt(7)
    v_min_u32 v24, s48, v24
    v_min_u32 v25, s48, v25
    buffer_store_dwordx2 v[24:25], v26, s[8:11], s22 offen offset:0 sc1
    v_lshrrev_b32 v14, 4, v1
    v_lshlrev_b32 v14, 2, v14
    v_bfe_u32 v15, v1, 2, 1
    v_add_u32 v14, v14, v15
    v_bfe_u32 v15, v1, 3, 1
    v_lshl_add_u32 v14, v15, 4, v14
    v_lshlrev_b32 v14, 5, v14
    v_and_b32 v15, 3, v1
    v_lshl_add_u32 v14, v15, 3, v14
    v_add_u32 v14, s29, v14
    ds_read_b64_tr_b16 v[40:41], v14 offset:0
    ds_read_b64_tr_b16 v[42:43], v14 offset:64
    ds_read_b64_tr_b16 v[44:45], v14 offset:1024
    ds_read_b64_tr_b16 v[46:47], v14 offset:1088
    ds_read_b64_tr_b16 v[48:49], v14 offset:2048
    ds_read_b64_tr_b16 v[50:51], v14 offset:2112
    ds_read_b64_tr_b16 v[52:53], v14 offset:3072
    ds_read_b64_tr_b16 v[54:55], v14 offset:3136
    ds_read_b64_tr_b16 v[56:57], v14 offset:4096
    ds_read_b64_tr_b16 v[58:59], v14 offset:4160
    v_and_b32 v15, 0x30, v1
    v_add_u32 v15, s29, v15
    s_waitcnt lgkmcnt(0)
    v_mfma_f32_16x16x32_bf16 v[16:19], v[40:43], v[220:223], 0
    v_mfma_f32_16x16x32_bf16 v[16:19], v[44:47], v[224:227], v[16:19]
    v_mfma_f32_16x16x32_bf16 v[16:19], v[48:51], v[228:231], v[16:19]
    v_mfma_f32_16x16x32_bf16 v[16:19], v[52:55], v[232:235], v[16:19]
    v_mfma_f32_16x16x32_bf16 v[16:19], v[56:59], v[236:239], v[16:19]
    s_mov_b32 exec_lo, 0x00010001
    s_mov_b32 exec_hi, 0x00010001
    s_nop 5
    ds_write_b128 v15, v[16:19]
    s_mov_b64 exec, -1
    s_waitcnt lgkmcnt(0)
    s_barrier
    s_cmp_lg_u32 s3, 0
    s_cbranch_scc1 CD_r
    v_lshlrev_b32 v14, 2, v1
    v_add_u32 v15, 139264, v14
    ds_read_b32 v16, v15 offset:0
    ds_read_b32 v17, v15 offset:5120
    ds_read_b32 v18, v15 offset:10240
    ds_read_b32 v19, v15 offset:15360
    v_bfe_u32 v15, v1, 2, 2
    v_lshlrev_b32 v15, 4, v15
    v_bfe_u32 v20, v1, 1, 1
    v_lshl_add_u32 v15, v20, 3, v15
    s_lshr_b32 s5, s28, 1
    s_lshl_b32 s5, s5, 6
    s_and_b32 s6, s28, 1
    s_lshl_b32 s6, s6, 2
    s_add_u32 s5, s5, s6
    s_add_u32 s5, s5, 32768
    s_lshl_b32 s4, s28, 6
    s_add_u32 s4, s4, 0
    s_cmp_ge_u32 s28, 40
    s_cselect_b32 s7, 1.0, 0
    s_waitcnt lgkmcnt(0)
    v_add_f32 v16, v16, v17
    v_add_f32 v18, v18, v19
    v_add_f32 v16, v16, v18
    v_cvt_pk_bf16_f32 v16, v16, v16
    v_and_b32 v16, 0xffff0000, v16
    v_add_f32 v18, s7, v16
    s_nop 1
    v_mov_b32 v17, v18 quad_perm:[1,1,3,3] row_mask:0xf bank_mask:0xf
    v_cvt_pk_bf16_f32 v17, v18, v17
    s_mov_b64 exec, 0x5555
    buffer_store_dword v17, v15, s[8:11], s5 offen sc1
    s_mov_b64 exec, 0xffff
    buffer_store_dword v16, v14, s[8:11], s4 offen sc1
    s_mov_b64 exec, -1
CD_r:
    s_waitcnt vmcnt(0)
    s_barrier
    s_cmp_lg_u32 s3, 0
    s_cbranch_scc1 CA_n
    s_lshl_b32 s4, s99, 5
    s_add_u32 s4, s4, 8
    v_mov_b32 v16, 0
    v_mov_b32 v17, 1
    s_mov_b64 exec, 1
    buffer_atomic_add v17, v16, s[16:19], s4 offen sc1
    s_mov_b64 exec, -1
CA_n:
    s_add_u32 s4, s42, 0
    s_add_u32 m0, s37, 0
    s_nop 0
    buffer_load_dwordx4 v13, s[12:15], s4 offen nt lds
    s_add_u32 s4, s42, 10240
    s_add_u32 m0, s37, 1024
    s_nop 0
    buffer_load_dwordx4 v13, s[12:15], s4 offen nt lds
    s_add_u32 s4, s42, 81920
    s_add_u32 m0, s37, 8192
    s_nop 0
    buffer_load_dwordx4 v13, s[12:15], s4 offen nt lds
    s_add_u32 s4, s42, 92160
    s_add_u32 m0, s37, 9216
    s_nop 0
    buffer_load_dwordx4 v13, s[12:15], s4 offen nt lds
    s_add_u32 s4, s42, 163840
    s_add_u32 m0, s37, 16384
    s_nop 0
    buffer_load_dwordx4 v13, s[12:15], s4 offen nt lds
    s_add_u32 s4, s42, 174080
    s_add_u32 m0, s37, 17408
    s_nop 0
    buffer_load_dwordx4 v13, s[12:15], s4 offen nt lds
    s_add_u32 s4, s42, 245760
    s_add_u32 m0, s37, 24576
    s_nop 0
    buffer_load_dwordx4 v13, s[12:15], s4 offen nt lds
    s_add_u32 s4, s42, 256000
    s_add_u32 m0, s37, 25600
    s_nop 0
    buffer_load_dwordx4 v13, s[12:15], s4 offen nt lds
    s_add_u32 s4, s42, 327680
    s_add_u32 m0, s37, 32768
    s_nop 0
    buffer_load_dwordx4 v13, s[12:15], s4 offen nt lds
    s_add_u32 s4, s42, 337920
    s_add_u32 m0, s37, 33792
    s_nop 0
    buffer_load_dwordx4 v13, s[12:15], s4 offen nt lds
    s_add_u32 s4, s42, 409600
    s_add_u32 m0, s37, 40960
    s_nop 0
    buffer_load_dwordx4 v13, s[12:15], s4 offen nt lds
    s_add_u32 s4, s42, 419840
    s_add_u32 m0, s37, 41984
    s_nop 0
    buffer_load_dwordx4 v13, s[12:15], s4 offen nt lds
    s_add_u32 s4, s42, 491520
    s_add_u32 m0, s37, 49152
    s_nop 0
    buffer_load_dwordx4 v13, s[12:15], s4 offen nt lds
    s_add_u32 s4, s42, 501760
    s_add_u32 m0, s37, 50176
    s_nop 0
    buffer_load_dwordx4 v13, s[12:15], s4 offen nt lds
    s_add_u32 s4, s42, 573440
    s_add_u32 m0, s37, 57344
    s_nop 0
    buffer_load_dwordx4 v13, s[12:15], s4 offen nt lds
    s_add_u32 s4, s42, 583680
    s_add_u32 m0, s37, 58368
    s_nop 0
    buffer_load_dwordx4 v13, s[12:15], s4 offen nt lds
    s_add_u32 s4, s42, 655360
    s_add_u32 m0, s37, 65536
    s_nop 0
    buffer_load_dwordx4 v13, s[12:15], s4 offen nt lds
    s_add_u32 s4, s42, 665600
    s_add_u32 m0, s37, 66560
    s_nop 0
    buffer_load_dwordx4 v13, s[12:15], s4 offen nt lds
    s_add_u32 s4, s42, 737280
    s_add_u32 m0, s37, 73728
    s_nop 0
    buffer_load_dwordx4 v13, s[12:15], s4 offen nt lds
    s_add_u32 s4, s42, 747520
    s_add_u32 m0, s37, 74752
    s_nop 0
    buffer_load_dwordx4 v13, s[12:15], s4 offen nt lds
    s_add_u32 s4, s42, 819200
    s_add_u32 m0, s37, 81920
    s_nop 0
    buffer_load_dwordx4 v13, s[12:15], s4 offen nt lds
    s_add_u32 s4, s42, 829440
    s_add_u32 m0, s37, 82944
    s_nop 0
    buffer_load_dwordx4 v13, s[12:15], s4 offen nt lds
    s_add_u32 s4, s42, 901120
    s_add_u32 m0, s37, 90112
    s_nop 0
    buffer_load_dwordx4 v13, s[12:15], s4 offen nt lds
    s_add_u32 s4, s42, 911360
    s_add_u32 m0, s37, 91136
    s_nop 0
    buffer_load_dwordx4 v13, s[12:15], s4 offen nt lds
    v_and_b32 v26, 7, v1
    v_lshlrev_b32 v26, 5, v26
    buffer_load_dwordx4 v[28:31], v26, s[16:19], 0 offen sc1
    v_mov_b32 v9, 0
    v_and_b32 v16, 7, v1
    v_lshrrev_b32 v17, 4, v1
    v_bfe_u32 v18, v1, 3, 1
    s_sub_u32 s4, s20, 18
    s_lshl_b32 s4, s4, 9
    s_add_u32 s43, s4, 2801664
    s_lshl_b32 s4, s99, 6
    s_add_u32 s24, s43, s4
    s_and_b32 s4, s99, 3
    s_lshl_b32 s4, s4, 14
    s_add_u32 s43, s43, s4
    s_lshl_b32 s4, s3, 7
    s_add_u32 s43, s43, s4
    s_cmp_eq_u32 s3, 0
    s_cselect_b32 s4, 8, 0
    s_cselect_b32 s44, 255, 0
    s_mov_b32 s45, 0
    v_lshrrev_b32 v198, 0, v1
    v_lshlrev_b32 v198, 13, v198
    v_and_b32 v19, 0, v2
    v_add_u32 v198, v198, v19
    v_mov_b32 v19, 0x80000000
    v_cmp_gt_u32 vcc, s4, v1
    s_nop 1
    v_cndmask_b32 v198, v19, v198, vcc
    s_lshr_b32 s4, s98, 1
    s_lshl_b32 s5, s4, 9
    s_and_b32 s6, s98, 1
    s_lshl_b32 s7, s6, 7
    s_add_u32 s5, s5, s7
    v_lshrrev_b32 v19, 1, v17
    v_lshlrev_b32 v6, 8, v19
    v_lshl_add_u32 v6, v16, 4, v6
    v_and_b32 v19, 1, v17
    v_lshl_add_u32 v6, v19, 3, v6
    v_add_u32 v6, s5, v6
    v_mov_b32 v19, 0x80000000
    v_cmp_ne_u32 vcc, 0, v18
    s_nop 1
    v_cndmask_b32 v6, v6, v19, vcc
    s_lshr_b32 s4, s98, 2
    s_lshl_b32 s4, s4, 14
    s_lshl_b32 s6, s3, 11
    s_add_u32 s4, s4, s6
    v_add_u32 v8, s4, v2
    v_lshrrev_b32 v19, 1, v17
    v_lshlrev_b32 v7, 7, v19
    v_lshl_add_u32 v7, v16, 4, v7
    v_and_b32 v19, 1, v17
    v_lshl_add_u32 v7, v19, 3, v7
    v_lshl_add_u32 v7, v18, 13, v7
    s_lshl_b32 s6, s99, 8
    s_add_u32 s4, s4, s6
    v_add_u32 v7, s4, v7
    v_and_b32 v19, 3, v1
    v_lshlrev_b32 v12, 5, v19
    v_lshl_add_u32 v12, v17, 3, v12
    v_bfe_u32 v19, v1, 2, 2
    v_mul_u32_u24 v19, 49152, v19
    v_add_u32 v12, v12, v19
    v_add_u32 v223, 196608, v12
    s_and_b32 s4, s99, 3
    s_mul_i32 s4, s4, 40
    s_add_u32 s4, s4, s98
    s_lshr_b32 s34, s4, 6
    s_lshl_b32 s34, s34, 14
    s_and_b32 s4, s4, 63
    s_lshl_b32 s4, s4, 7
    s_add_u32 s34, s34, s4
    s_add_u32 s34, s34, 23068672
    v_lshrrev_b32 v19, 3, v1
    v_and_b32 v20, 1, v19
    v_mul_u32_u24 v20, 3, v20
    v_sub_u32 v20, 5, v20
    v_min_u32 v4, v16, v20
    v_lshlrev_b32 v4, 2, v4
    v_lshl_add_u32 v4, v19, 7, v4
    v_add_u32 v4, 156672, v4
    v_lshrrev_b32 v19, 3, v1
    v_and_b32 v20, 3, v1
    v_lshlrev_b32 v11, 7, v20
    v_lshrrev_b32 v20, 1, v20
    v_lshl_add_u32 v11, v20, 6, v11
    v_lshl_add_u32 v11, v19, 4, v11
    v_bfe_u32 v20, v1, 2, 1
    v_lshl_add_u32 v11, v20, 2, v11
    s_mul_i32 s4, s3, 768
    s_add_u32 s4, s4, 98304
    v_add_u32 v11, s4, v11
    v_bfe_u32 v20, v1, 2, 1
    v_lshlrev_b32 v244, 7, v20
    v_lshl_add_u32 v244, v19, 4, v244
    v_and_b32 v20, 3, v1
    v_lshl_add_u32 v244, v20, 1, v244
    s_lshr_b32 s4, s3, 1
    s_lshl_b32 s4, s4, 8
    s_and_b32 s5, s3, 1
    s_lshl_b32 s5, s5, 3
    s_add_u32 s4, s4, s5
    s_add_u32 s4, s4, 101376
    v_add_u32 v244, s4, v244
    v_lshlrev_b32 v14, 7, v17
    v_lshrrev_b32 v20, 1, v17
    v_lshl_add_u32 v14, v20, 6, v14
    v_lshl_add_u32 v14, v16, 4, v14
    v_add_u32 v14, 98304, v14
    v_and_b32 v20, 1, v17
    v_lshlrev_b32 v15, 7, v20
    v_lshl_add_u32 v15, v16, 4, v15
    v_add_u32 v15, 101376, v15
    v_and_b32 v245, 0x1f0, v2
    v_add_u32 v245, 110592, v245
    v_add_u32 v246, 102400, v2
    v_min_u32 v247, 5, v1
    s_mul_i32 s4, s3, 24
    s_add_u32 s4, s4, 155840
    v_lshl_add_u32 v247, v247, 2, s4
    v_and_b32 v248, 7, v1
    v_lshlrev_b32 v248, 2, v248
    v_add_u32 v248, 156096, v248
    s_mov_b32 s49, 0x3dd53b95
    s_lshr_b32 s4, s98, 1
    s_lshl_b32 s5, s4, 9
    s_and_b32 s6, s98, 1
    s_lshl_b32 s7, s6, 7
    s_add_u32 s5, s5, s7
    v_lshlrev_b32 v222, 8, v18
    v_lshl_add_u32 v222, v16, 4, v222
    v_lshl_add_u32 v222, v17, 3, v222
    v_add_u32 v222, s5, v222
    v_mov_b32 v19, 0x80000000
    v_cmp_lt_u32 vcc, 31, v1
    s_nop 1
    v_cndmask_b32 v222, v222, v19, vcc
    v_mov_b32 v19, 0x3f80
    v_mov_b32 v20, 0x3f800000
    v_cmp_eq_u32 vcc, 0, v16
    s_nop 1
    v_cndmask_b32 v224, 0, v19, vcc
    v_cmp_eq_u32 vcc, 1, v16
    s_nop 1
    v_cndmask_b32 v224, v224, v20, vcc
    v_cmp_eq_u32 vcc, 2, v16
    s_nop 1
    v_cndmask_b32 v225, 0, v19, vcc
    v_cmp_eq_u32 vcc, 3, v16
    s_nop 1
    v_cndmask_b32 v225, v225, v20, vcc
    v_cmp_eq_u32 vcc, 4, v16
    s_nop 1
    v_cndmask_b32 v226, 0, v19, vcc
    v_cmp_eq_u32 vcc, 5, v16
    s_nop 1
    v_cndmask_b32 v226, v226, v20, vcc
    v_cmp_eq_u32 vcc, 6, v16
    s_nop 1
    v_cndmask_b32 v227, 0, v19, vcc
    v_cmp_eq_u32 vcc, 7, v16
    s_nop 1
    v_cndmask_b32 v227, v227, v20, vcc
    v_and_b32 v16, 8, v1
    v_mov_b32 v5, 0x4444
    v_mov_b32 v17, 0xeeee
    v_cmp_ne_u32 vcc, 0, v16
    s_nop 1
    v_cndmask_b32 v5, v5, v17, vcc
    s_mov_b32 s31, 0
    s_waitcnt vmcnt(0)
    s_branch CI_c
CI_l:
    buffer_load_dwordx4 v[28:31], v26, s[16:19], 0 offen sc1
    s_waitcnt vmcnt(0)
CI_c:
    v_bcnt_u32_b32 v27, v28, v31
    v_cmp_lt_u32 s[4:5], 32, v27
    s_and_b32 s6, s4, 0xff
    v_cmp_ne_u32 s[4:5], 32, v27
    s_cmp_eq_u32 s6, 0
    s_cselect_b32 s5, 0xff, 0
    s_and_b32 s4, s4, s5
    v_add_u32 v29, v29, v30
    v_cmp_gt_u32 vcc, 32, v29
    s_and_b32 vcc_lo, vcc_lo, 0xff
    s_or_b32 vcc_lo, vcc_lo, s4
    s_mov_b32 vcc_hi, 0
    s_cbranch_vccz CI_o
    s_sleep 16
    s_add_u32 s31, s31, 1
    s_cmp_lt_u32 s31, s30
    s_cbranch_scc1 CI_l
    s_mov_b32 s30, 1
CI_o:
    s_mov_b32 s97, s6
    v_and_b32 v26, 31, v1
    v_max_u32 v26, 20, v26
    v_lshlrev_b32 v26, 7, v26
    s_mov_b32 s40, 65544
    buffer_load_dword v28, v26, s[8:11], s40 offen offset:0 sc1
    v_lshlrev_b32 v27, 7, v1
    s_lshl_b32 s4, s98, 13
    s_add_u32 s4, s4, s22
    buffer_load_dword v29, v27, s[8:11], s4 offen offset:0 sc1
    s_add_u32 s4, s4, 327680
    buffer_load_dword v29, v27, s[8:11], s4 offen offset:0 sc1
    s_barrier
    s_mul_i32 s4, s3, 24576
    v_add_u32 v0, s4, v0
    v_xor_b32 v30, 0, v0
    ds_read_b64_tr_b16 a[0:1], v30 offset:0
    ds_read_b64_tr_b16 a[2:3], v30 offset:256
    ds_read_b64_tr_b16 a[4:5], v30 offset:4096
    ds_read_b64_tr_b16 a[6:7], v30 offset:4352
    ds_read_b64_tr_b16 a[8:9], v30 offset:8192
    ds_read_b64_tr_b16 a[10:11], v30 offset:8448
    ds_read_b64_tr_b16 a[12:13], v30 offset:12288
    ds_read_b64_tr_b16 a[14:15], v30 offset:12544
    ds_read_b64_tr_b16 a[16:17], v30 offset:16384
    ds_read_b64_tr_b16 a[18:19], v30 offset:16640
    ds_read_b64_tr_b16 a[20:21], v30 offset:20480
    ds_read_b64_tr_b16 a[22:23], v30 offset:20736
    v_xor_b32 v30, 32, v0
    ds_read_b64_tr_b16 a[24:25], v30 offset:0
    ds_read_b64_tr_b16 a[26:27], v30 offset:256
    ds_read_b64_tr_b16 a[28:29], v30 offset:4096
    ds_read_b64_tr_b16 a[30:31], v30 offset:4352
    ds_read_b64_tr_b16 a[32:33], v30 offset:8192
    ds_read_b64_tr_b16 a[34:35], v30 offset:8448
    ds_read_b64_tr_b16 a[36:37], v30 offset:12288
    ds_read_b64_tr_b16 a[38:39], v30 offset:12544
    ds_read_b64_tr_b16 a[40:41], v30 offset:16384
    ds_read_b64_tr_b16 a[42:43], v30 offset:16640
    ds_read_b64_tr_b16 a[44:45], v30 offset:20480
    ds_read_b64_tr_b16 a[46:47], v30 offset:20736
    v_xor_b32 v30, 64, v0
    ds_read_b64_tr_b16 a[48:49], v30 offset:0
    ds_read_b64_tr_b16 a[50:51], v30 offset:256
    ds_read_b64_tr_b16 a[52:53], v30 offset:4096
    ds_read_b64_tr_b16 a[54:55], v30 offset:4352
    ds_read_b64_tr_b16 a[56:57], v30 offset:8192
    ds_read_b64_tr_b16 a[58:59], v30 offset:8448
    ds_read_b64_tr_b16 a[60:61], v30 offset:12288
    ds_read_b64_tr_b16 a[62:63], v30 offset:12544
    ds_read_b64_tr_b16 a[64:65], v30 offset:16384
    ds_read_b64_tr_b16 a[66:67], v30 offset:16640
    ds_read_b64_tr_b16 a[68:69], v30 offset:20480
    ds_read_b64_tr_b16 a[70:71], v30 offset:20736
    v_xor_b32 v30, 96, v0
    ds_read_b64_tr_b16 a[72:73], v30 offset:0
    ds_read_b64_tr_b16 a[74:75], v30 offset:256
    ds_read_b64_tr_b16 a[76:77], v30 offset:4096
    ds_read_b64_tr_b16 a[78:79], v30 offset:4352
    ds_read_b64_tr_b16 a[80:81], v30 offset:8192
    ds_read_b64_tr_b16 a[82:83], v30 offset:8448
    ds_read_b64_tr_b16 a[84:85], v30 offset:12288
    ds_read_b64_tr_b16 a[86:87], v30 offset:12544
    ds_read_b64_tr_b16 a[88:89], v30 offset:16384
    ds_read_b64_tr_b16 a[90:91], v30 offset:16640
    ds_read_b64_tr_b16 a[92:93], v30 offset:20480
    ds_read_b64_tr_b16 a[94:95], v30 offset:20736
    s_mov_b32 s31, 0
    s_waitcnt vmcnt(2)
    s_branch CH_c
CH_l:
    buffer_load_dword v28, v26, s[8:11], s40 offen sc1
    s_waitcnt vmcnt(0)
CH_c:
    v_cmp_gt_u32 vcc, 1, v28
    s_cbranch_vccz CH_o
    s_sleep 4
    s_add_u32 s31, s31, 1
    s_cmp_lt_u32 s31, s30
    s_cbranch_scc1 CH_l
    s_mov_b32 s30, 1
CH_o:
    s_mov_b32 s5, 0
    v_readlane_b32 s4, v28, 20
    s_add_u32 s5, s5, s4
    v_readlane_b32 s4, v28, 21
    s_add_u32 s5, s5, s4
    v_readlane_b32 s4, v28, 22
    s_add_u32 s5, s5, s4
    v_readlane_b32 s4, v28, 23
    s_add_u32 s5, s5, s4
    v_readlane_b32 s4, v28, 24
    s_add_u32 s5, s5, s4
    v_readlane_b32 s4, v28, 25
    s_add_u32 s5, s5, s4
    v_readlane_b32 s4, v28, 26
    s_add_u32 s5, s5, s4
    v_readlane_b32 s4, v28, 27
    s_add_u32 s5, s5, s4
    v_readlane_b32 s4, v28, 28
    s_add_u32 s5, s5, s4
    v_readlane_b32 s4, v28, 29
    s_add_u32 s5, s5, s4
    v_readlane_b32 s4, v28, 30
    s_add_u32 s5, s5, s4
    v_readlane_b32 s4, v28, 31
    s_add_u32 s5, s5, s4
    s_lshr_b32 s4, s5, 16
    s_cmp_gt_u32 s4, 24
    s_cselect_b32 s96, 8192, 0
    s_lshl_b32 s4, s99, 11
    s_xor_b32 s96, s96, s4
    s_and_b32 s96, s96, 8192
    s_waitcnt lgkmcnt(0)
    s_mov_b32 s21, 0
    s_add_u32 s43, s43, s96
    s_add_u32 s37, s43, 64
    s_lshl_b32 s4, s3, 1
    s_cmp_eq_u32 s4, s99
    s_cselect_b32 s95, -1, 0
    s_add_u32 s4, s4, 1
    s_cmp_eq_u32 s4, s99
    s_cselect_b32 s94, -1, 0
    v_add_u32 v8, s96, v8
    s_mul_i32 s27, s3, 12288
    s_add_u32 s27, s27, s22
    s_add_u32 s27, s27, 159744
    s_mov_b32 s36, 196608
    s_sub_u32 s34, s34, 1048576
    s_xor_b32 s4, s96, 8192
    s_add_u32 s34, s34, s4
    s_cmp_lg_u32 s97, 0
    s_cbranch_scc1 Cs_go
Cf_go:
    s_lshl_b32 s4, s3, 12
    v_add_u32 v194, s4, v2
    s_lshl_b32 s4, s3, 11
    s_add_u32 s4, s4, 65536
    v_add_u32 v195, s4, v2
    s_lshr_b32 s4, s3, 1
    s_lshl_b32 s4, s4, 10
    s_and_b32 s5, s3, 1
    s_lshl_b32 s5, s5, 3
    s_add_u32 s4, s4, s5
    s_add_u32 s4, s4, 65536
    v_add_u32 v196, s4, v2
    s_lshl_b32 s4, s3, 10
    v_add_u32 v197, s4, v2
    v_mov_b32 v3, v197
    s_mul_i32 s4, s3, 3072
    s_min_u32 s4, s4, 7168
    s_add_u32 s92, s4, s22
    s_add_u32 s92, s92, 405504
    s_add_u32 s93, s4, 102400
    s_mov_b64 s[84:85], 0
    s_mov_b64 s[86:87], 0
    s_mov_b64 s[88:89], 0
    s_mul_i32 s4, s3, 3072
    s_add_u32 s29, s4, s22
    s_add_u32 s29, s29, 106496
    s_lshl_b32 s4, s3, 12
    s_add_u32 s32, s4, s22
    s_add_u32 s32, s32, 40960
    s_barrier
    s_mov_b32 s31, 0
Cfv1_l:
    buffer_load_dword v250, v247, s[8:11], s22 offen sc1
    s_waitcnt vmcnt(0)
Cfv1_c:
    v_cmp_gt_u32 vcc, 1, v250
    s_cbranch_vccz Cfv1_o
    s_sleep 1
    s_add_u32 s31, s31, 1
    s_cmp_lt_u32 s31, s30
    s_cbranch_scc1 Cfv1_l
    s_mov_b32 s30, 1
Cfv1_o:
    s_add_u32 s4, 1, 3
    s_and_b32 s4, s4, 3
    s_mul_i32 s4, s4, 49152
    s_add_u32 s40, s4, s27
    s_add_u32 s41, s40, 4096
    s_add_u32 s42, s40, 8192
    buffer_load_dwordx4 v[48:51], v2, s[8:11], s40 offen offset:0 sc1
    buffer_load_dwordx4 v[52:55], v2, s[8:11], s40 offen offset:1024 sc1
    buffer_load_dwordx4 v[56:59], v2, s[8:11], s40 offen offset:2048 sc1
    buffer_load_dwordx4 v[60:63], v2, s[8:11], s40 offen offset:3072 sc1
    buffer_load_dwordx4 v[64:67], v2, s[8:11], s41 offen offset:0 sc1
    buffer_load_dwordx4 v[68:71], v2, s[8:11], s41 offen offset:1024 sc1
    buffer_load_dwordx4 v[72:75], v2, s[8:11], s41 offen offset:2048 sc1
    buffer_load_dwordx4 v[76:79], v2, s[8:11], s41 offen offset:3072 sc1
    buffer_load_dwordx4 v[80:83], v2, s[8:11], s42 offen offset:0 sc1
    buffer_load_dwordx4 v[84:87], v2, s[8:11], s42 offen offset:1024 sc1
    buffer_load_dwordx4 v[88:91], v2, s[8:11], s42 offen offset:2048 sc1
    buffer_load_dwordx4 v[92:95], v2, s[8:11], s42 offen offset:3072 sc1
    s_waitcnt vmcnt(0)
    v_mfma_f32_16x16x32_bf16 v[136:139], v[48:51], a[0:3], 0
    v_mfma_f32_16x16x32_bf16 v[144:147], v[48:51], a[24:27], 0
    v_mfma_f32_16x16x32_bf16 v[152:155], v[48:51], a[48:51], 0
    v_mfma_f32_16x16x32_bf16 v[160:163], v[48:51], a[72:75], 0
    v_mfma_f32_16x16x32_bf16 v[140:143], v[72:75], a[0:3], 0
    v_mfma_f32_16x16x32_bf16 v[148:151], v[72:75], a[24:27], 0
    v_mfma_f32_16x16x32_bf16 v[156:159], v[72:75], a[48:51], 0
    v_mfma_f32_16x16x32_bf16 v[164:167], v[72:75], a[72:75], 0
    v_mfma_f32_16x16x32_bf16 v[136:139], v[52:55], a[4:7], v[136:139]
    v_mfma_f32_16x16x32_bf16 v[144:147], v[52:55], a[28:31], v[144:147]
    v_mfma_f32_16x16x32_bf16 v[152:155], v[52:55], a[52:55], v[152:155]
    v_mfma_f32_16x16x32_bf16 v[160:163], v[52:55], a[76:79], v[160:163]
    v_mfma_f32_16x16x32_bf16 v[140:143], v[76:79], a[4:7], v[140:143]
    v_mfma_f32_16x16x32_bf16 v[148:151], v[76:79], a[28:31], v[148:151]
    v_mfma_f32_16x16x32_bf16 v[156:159], v[76:79], a[52:55], v[156:159]
    v_mfma_f32_16x16x32_bf16 v[164:167], v[76:79], a[76:79], v[164:167]
    v_mfma_f32_16x16x32_bf16 v[136:139], v[56:59], a[8:11], v[136:139]
    v_mfma_f32_16x16x32_bf16 v[144:147], v[56:59], a[32:35], v[144:147]
    v_mfma_f32_16x16x32_bf16 v[152:155], v[56:59], a[56:59], v[152:155]
    v_mfma_f32_16x16x32_bf16 v[160:163], v[56:59], a[80:83], v[160:163]
    v_mfma_f32_16x16x32_bf16 v[140:143], v[80:83], a[8:11], v[140:143]
    v_mfma_f32_16x16x32_bf16 v[148:151], v[80:83], a[32:35], v[148:151]
    v_mfma_f32_16x16x32_bf16 v[156:159], v[80:83], a[56:59], v[156:159]
    v_mfma_f32_16x16x32_bf16 v[164:167], v[80:83], a[80:83], v[164:167]
    v_mfma_f32_16x16x32_bf16 v[136:139], v[60:63], a[12:15], v[136:139]
    v_mfma_f32_16x16x32_bf16 v[144:147], v[60:63], a[36:39], v[144:147]
    v_mfma_f32_16x16x32_bf16 v[152:155], v[60:63], a[60:63], v[152:155]
    v_mfma_f32_16x16x32_bf16 v[160:163], v[60:63], a[84:87], v[160:163]
    v_mfma_f32_16x16x32_bf16 v[140:143], v[84:87], a[12:15], v[140:143]
    v_mfma_f32_16x16x32_bf16 v[148:151], v[84:87], a[36:39], v[148:151]
    v_mfma_f32_16x16x32_bf16 v[156:159], v[84:87], a[60:63], v[156:159]
    v_mfma_f32_16x16x32_bf16 v[164:167], v[84:87], a[84:87], v[164:167]
    v_mfma_f32_16x16x32_bf16 v[136:139], v[64:67], a[16:19], v[136:139]
    v_mfma_f32_16x16x32_bf16 v[144:147], v[64:67], a[40:43], v[144:147]
    v_mfma_f32_16x16x32_bf16 v[152:155], v[64:67], a[64:67], v[152:155]
    v_mfma_f32_16x16x32_bf16 v[160:163], v[64:67], a[88:91], v[160:163]
    v_mfma_f32_16x16x32_bf16 v[140:143], v[88:91], a[16:19], v[140:143]
    v_mfma_f32_16x16x32_bf16 v[148:151], v[88:91], a[40:43], v[148:151]
    v_mfma_f32_16x16x32_bf16 v[156:159], v[88:91], a[64:67], v[156:159]
    v_mfma_f32_16x16x32_bf16 v[164:167], v[88:91], a[88:91], v[164:167]
    v_mfma_f32_16x16x32_bf16 v[136:139], v[68:71], a[20:23], v[136:139]
    v_mfma_f32_16x16x32_bf16 v[144:147], v[68:71], a[44:47], v[144:147]
    v_mfma_f32_16x16x32_bf16 v[152:155], v[68:71], a[68:71], v[152:155]
    v_mfma_f32_16x16x32_bf16 v[160:163], v[68:71], a[92:95], v[160:163]
    v_mfma_f32_16x16x32_bf16 v[140:143], v[92:95], a[20:23], v[140:143]
    v_mfma_f32_16x16x32_bf16 v[148:151], v[92:95], a[44:47], v[148:151]
    v_mfma_f32_16x16x32_bf16 v[156:159], v[92:95], a[68:71], v[156:159]
    v_mfma_f32_16x16x32_bf16 v[164:167], v[92:95], a[92:95], v[164:167]
    v_cvt_pk_bf16_f32 v168, v136, v137
    v_cvt_pk_bf16_f32 v169, v140, v141
    v_cvt_pk_bf16_f32 v170, v138, v139
    v_cvt_pk_bf16_f32 v171, v142, v143
    ds_write_b128 v3, v[168:171] offset:0
    v_cvt_pk_bf16_f32 v172, v144, v145
    v_cvt_pk_bf16_f32 v173, v148, v149
    v_cvt_pk_bf16_f32 v174, v146, v147
    v_cvt_pk_bf16_f32 v175, v150, v151
    ds_write_b128 v3, v[172:175] offset:4096
    v_cvt_pk_bf16_f32 v176, v152, v153
    v_cvt_pk_bf16_f32 v177, v156, v157
    v_cvt_pk_bf16_f32 v178, v154, v155
    v_cvt_pk_bf16_f32 v179, v158, v159
    ds_write_b128 v3, v[176:179] offset:8192
    v_cvt_pk_bf16_f32 v180, v160, v161
    v_cvt_pk_bf16_f32 v181, v164, v165
    v_cvt_pk_bf16_f32 v182, v162, v163
    v_cvt_pk_bf16_f32 v183, v166, v167
    ds_write_b128 v3, v[180:183] offset:12288
    s_and_b32 s28, s21, 3
    s_lshl_b32 s4, s28, 14
    v_add_u32 v192, s4, v194
    s_lshl_b32 s4, s28, 13
    v_add_u32 v13, s4, v195
    v_add_u32 v10, s4, v196
    v_xor_b32 v0, 32768, v192
    v_xor_b32 v193, 16384, v13
    s_mul_i32 s4, s28, 12288
    s_add_u32 s38, s4, s29
    s_mul_i32 s4, s28, 16384
    s_add_u32 s39, s4, s32
    s_mul_i32 s4, s28, 10240
    s_add_u32 s25, s4, s22
    s_xor_b32 s4, s28, 2
    s_mul_i32 s4, s4, 10240
    s_add_u32 s26, s4, s22
    s_add_u32 s4, s21, 1
    v_mov_b32 v228, s4
    v_mov_b32 v96, 0
    v_mov_b32 v97, 0
    v_mov_b32 v98, 0
    v_mov_b32 v99, 0
    v_mov_b32 v100, 0
    v_mov_b32 v101, 0
    v_mov_b32 v102, 0
    v_mov_b32 v103, 0
    v_mov_b32 v104, 0
    v_mov_b32 v105, 0
    v_mov_b32 v106, 0
    v_mov_b32 v107, 0
    v_mov_b32 v108, 0
    v_mov_b32 v109, 0
    v_mov_b32 v110, 0
    v_mov_b32 v111, 0
    s_waitcnt lgkmcnt(0)
    s_barrier
    s_mul_i32 s4, s28, 163840
    s_add_u32 s35, s4, 2097152
    s_add_u32 s4, s28, 1
    s_and_b32 s4, s4, 3
    s_lshl_b32 s4, s4, 14
    v_add_u32 v3, s4, v197
    s_add_u32 s46, s21, 3
    s_min_u32 s46, s46, 64
    s_mov_b32 s47, s21
    s_add_u32 s4, s46, 3
    s_and_b32 s4, s4, 3
    s_mul_i32 s4, s4, 49152
    s_add_u32 s40, s4, s27
    s_add_u32 s41, s40, 4096
    s_add_u32 s42, s40, 8192
    s_add_u32 s23, s36, s92
    s_mov_b32 m0, s93
    s_add_u32 s36, s36, 65536
    s_and_b32 s36, s36, 262143
    ds_read_b128 v[120:123], v192 offset:0
    ds_read_b128 v[124:127], v192 offset:1024
    ds_read_b128 v[128:131], v192 offset:2048
    ds_read_b128 v[132:135], v192 offset:3072
Cf_loop:
    s_add_u32 s21, s21, 1
    buffer_load_dword v45, v247, s[8:11], s22 offen offset:0 sc1
    buffer_load_dword v46, v248, s[8:11], s22 offen offset:0 sc1
    s_cmp_lg_u32 s3, 0
    s_cbranch_scc1 Cfl_o
    buffer_load_dword v47, v4, s[8:11], s22 offen offset:0 sc1
    s_nop 12
    buffer_load_dword v47, v4, s[8:11], s22 offen offset:0 sc1
    s_nop 12
    s_mov_b32 s31, -1
Cfl_l:
    buffer_load_dword v47, v4, s[8:11], s22 offen offset:0 sc1
    s_add_u32 s31, s31, 1
    s_cmp_lt_u32 s31, s30
    s_cselect_b32 s30, s30, 1
    s_cbranch_scc0 Cfl_o
    s_waitcnt vmcnt(2)
    v_cmp_gt_u32 vcc, s21, v47
    s_cbranch_vccnz Cfl_l
Cfl_o:
    s_barrier
    buffer_load_dwordx4 v[16:19], v2, s[8:11], s38 offen offset:0 sc1
    buffer_load_dwordx4 v[20:23], v2, s[8:11], s38 offen offset:1024 sc1
    buffer_load_dwordx4 v[24:27], v2, s[8:11], s38 offen offset:2048 sc1
    s_waitcnt vmcnt(3)
    v_cmp_gt_u32 s[86:87], s46, v45
    v_cmp_gt_u32 s[88:89], s47, v46
Cfm_b:
    s_waitcnt vmcnt(2)
    v_smfmac_f32_16x16x64_bf16 v[96:99], v[16:19], a[0:7], v5
    buffer_load_dwordx4 v[28:31], v2, s[8:11], s39 offen offset:0 sc1
    v_smfmac_f32_16x16x64_bf16 v[100:103], v[16:19], a[24:31], v5
    buffer_load_dwordx4 v[32:35], v2, s[8:11], s39 offen offset:1024 sc1
    v_smfmac_f32_16x16x64_bf16 v[104:107], v[16:19], a[48:55], v5
    buffer_load_dwordx4 v[36:39], v2, s[8:11], s39 offen offset:2048 sc1
    v_smfmac_f32_16x16x64_bf16 v[108:111], v[16:19], a[72:79], v5
    buffer_load_dwordx3 v[40:42], v2, s[8:11], s39 offen offset:3072 sc1
    s_waitcnt vmcnt(5)
    v_smfmac_f32_16x16x64_bf16 v[96:99], v[20:23], a[8:15], v5
    v_smfmac_f32_16x16x64_bf16 v[100:103], v[20:23], a[32:39], v5
    v_smfmac_f32_16x16x64_bf16 v[104:107], v[20:23], a[56:63], v5
    v_smfmac_f32_16x16x64_bf16 v[108:111], v[20:23], a[80:87], v5
    s_waitcnt vmcnt(4)
    v_smfmac_f32_16x16x64_bf16 v[96:99], v[24:27], a[16:23], v5
    v_max3_u32 v251, v16, v18, v20
    v_smfmac_f32_16x16x64_bf16 v[100:103], v[24:27], a[40:47], v5
    v_max3_u32 v251, v251, v22, v24
    v_smfmac_f32_16x16x64_bf16 v[104:107], v[24:27], a[64:71], v5
    v_max_u32 v251, v251, v26
    v_smfmac_f32_16x16x64_bf16 v[108:111], v[24:27], a[88:95], v5
    v_cmp_eq_u32 vcc, -1, v251
    v_cvt_pk_bf16_f32 v112, v96, v97
    v_cvt_pk_bf16_f32 v113, v98, v99
    s_cbranch_vccnz Cfm_s
    ds_write_b64 v10, v[112:113] offset:0
    v_cvt_pk_bf16_f32 v114, v100, v101
    v_cvt_pk_bf16_f32 v115, v102, v103
    ds_write_b64 v10, v[114:115] offset:2048
    v_cvt_pk_bf16_f32 v116, v104, v105
    v_cvt_pk_bf16_f32 v117, v106, v107
    ds_write_b64 v10, v[116:117] offset:4096
    v_cvt_pk_bf16_f32 v118, v108, v109
    v_cvt_pk_bf16_f32 v119, v110, v111
    ds_write_b64 v10, v[118:119] offset:6144
    s_cmp_eq_u32 s21, 64
    s_cbranch_scc1 Cf_end
    s_cmp_lg_u64 s[88:89], 0
    s_cbranch_scc1 Cf_fw
Cf_fo:
    buffer_load_dwordx4 v2, s[8:11], s23 offen offset:0 sc1 lds
    buffer_load_dwordx4 v2, s[8:11], s23 offen offset:1024 sc1 lds
    buffer_load_dwordx4 v2, s[8:11], s23 offen offset:2048 sc1 lds
    s_waitcnt vmcnt(3)
Cfs_b:
    v_max3_u32 v250, v28, v32, v36
    v_pk_add_f32 v[28:29], v[28:29], v[32:33]
    v_pk_add_f32 v[30:31], v[30:31], v[34:35]
    v_max3_u32 v251, v40, v41, v42
    v_add_f32 v40, v40, v41
    v_pk_add_f32 v[28:29], v[28:29], v[36:37]
    v_pk_add_f32 v[30:31], v[30:31], v[38:39]
    v_add_f32 v40, v40, v42
    v_max3_f32 v43, v28, v29, v30
    v_max3_f32 v43, v43, v31, v40
    v_max_u32 v250, v250, v251
    v_cmp_eq_u32 vcc, -1, v250
    v_max_f32 v43, v43, v43 quad_perm:[1,0,3,2] row_mask:0xf bank_mask:0xf
    v_mul_f32 v28, s49, v28
    v_mul_f32 v29, s49, v29
    v_max_f32 v43, v43, v43 quad_perm:[2,3,0,1] row_mask:0xf bank_mask:0xf
    v_mul_f32 v30, s49, v30
    v_mul_f32 v31, s49, v31
    v_max_f32 v43, v43, v43 row_half_mirror row_mask:0xf bank_mask:0xf
    v_mul_f32 v40, s49, v40
    s_cbranch_vccnz Cfs_s
    v_mul_f32 v43, s49, v43
    v_sub_f32 v28, v28, v43
    v_sub_f32 v29, v29, v43
    v_sub_f32 v30, v30, v43
    v_sub_f32 v31, v31, v43
    v_sub_f32 v40, v40, v43
    v_exp_f32 v28, v28
    v_exp_f32 v29, v29
    v_exp_f32 v30, v30
    v_exp_f32 v31, v31
    v_exp_f32 v40, v40
    v_add_f32 v43, v28, v29
    v_add_f32 v44, v30, v31
    v_add_f32 v43, v43, v44
    v_add_f32 v43, v43, v40
    s_nop 1
    v_add_f32 v43, v43, v43 quad_perm:[1,0,3,2] row_mask:0xf bank_mask:0xf
    s_nop 1
    v_add_f32 v43, v43, v43 quad_perm:[2,3,0,1] row_mask:0xf bank_mask:0xf
    s_nop 1
    v_add_f32 v43, v43, v43 row_half_mirror row_mask:0xf bank_mask:0xf
    v_rcp_f32 v43, v43
    s_mov_b64 exec, s[44:45]
    buffer_store_dword v228, v198, s[8:11], s24 offen offset:0 sc1
    s_mov_b64 exec, -1
    v_mul_f32 v28, v28, v43
    v_mul_f32 v29, v29, v43
    v_mul_f32 v30, v30, v43
    v_mul_f32 v31, v31, v43
    v_mul_f32 v40, v40, v43
    v_cvt_pk_bf16_f32 v28, v28, v29
    v_cvt_pk_bf16_f32 v29, v30, v31
    v_cvt_pk_bf16_f32 v30, v40, v40
    ds_write2_b32 v11, v28, v29 offset0:0 offset1:2
    ds_write_b16 v244, v30
    s_waitcnt lgkmcnt(0)
    s_barrier
    ds_read_b128 v[168:171], v14 offset:0
    ds_read_b128 v[172:175], v14 offset:768
    ds_read_b128 v[176:179], v14 offset:1536
    ds_read_b128 v[180:183], v14 offset:2304
    ds_read_b128 v[184:187], v15 offset:0
    ds_read_b128 v[112:115], v13 offset:0
    ds_read_b128 v[188:191], v15 offset:256
    ds_read_b128 v[116:119], v13 offset:1024
    s_waitcnt lgkmcnt(7)
    v_mfma_f32_16x16x32_bf16 v[200:203], v[120:123], v[168:171], 0
    s_waitcnt lgkmcnt(6)
    v_mfma_f32_16x16x32_bf16 v[200:203], v[124:127], v[172:175], v[200:203]
    s_waitcnt lgkmcnt(5)
    v_mfma_f32_16x16x32_bf16 v[200:203], v[128:131], v[176:179], v[200:203]
    s_waitcnt lgkmcnt(4)
    v_mfma_f32_16x16x32_bf16 v[200:203], v[132:135], v[180:183], v[200:203]
    s_waitcnt lgkmcnt(2)
    v_mfma_f32_16x16x32_bf16 v[200:203], v[112:115], v[184:187], v[200:203]
    s_waitcnt lgkmcnt(0)
    v_mfma_f32_16x16x32_bf16 v[200:203], v[116:119], v[188:191], v[200:203]
    s_load_dword s84, s[8:9], s37 glc
    s_load_dword s85, s[8:9], s43 glc
    s_nop 5
    v_cvt_pk_bf16_f32 v200, v200, v201
    v_cvt_pk_bf16_f32 v201, v202, v203
    buffer_store_dwordx2 v[200:201], v7, s[8:11], s35 offen offset:0 sc1
    s_cmp_eq_u32 s21, 1
    s_cbranch_scc1 Cf_v1
Cf_v1r:
    v_mfma_f32_16x16x32_bf16 v[136:139], v[48:51], a[0:3], 0
    v_mfma_f32_16x16x32_bf16 v[144:147], v[48:51], a[24:27], 0
    v_mfma_f32_16x16x32_bf16 v[152:155], v[48:51], a[48:51], 0
    s_and_b32 s28, s21, 3
    s_lshl_b32 s4, s28, 14
    v_mfma_f32_16x16x32_bf16 v[160:163], v[48:51], a[72:75], 0
    v_add_u32 v192, s4, v194
    s_lshl_b32 s4, s28, 13
    v_mfma_f32_16x16x32_bf16 v[140:143], v[72:75], a[0:3], 0
    v_add_u32 v13, s4, v195
    v_add_u32 v10, s4, v196
    v_mfma_f32_16x16x32_bf16 v[148:151], v[72:75], a[24:27], 0
    v_xor_b32 v0, 32768, v192
    v_xor_b32 v193, 16384, v13
    v_mfma_f32_16x16x32_bf16 v[156:159], v[72:75], a[48:51], 0
    s_load_dword s84, s[8:9], s37 glc
    s_load_dword s85, s[8:9], s43 glc
    v_mfma_f32_16x16x32_bf16 v[164:167], v[72:75], a[72:75], 0
    s_mul_i32 s4, s28, 12288
    s_add_u32 s38, s4, s29
    v_mfma_f32_16x16x32_bf16 v[136:139], v[52:55], a[4:7], v[136:139]
    s_mul_i32 s4, s28, 16384
    s_add_u32 s39, s4, s32
    v_mfma_f32_16x16x32_bf16 v[144:147], v[52:55], a[28:31], v[144:147]
    s_mul_i32 s4, s28, 10240
    s_add_u32 s25, s4, s22
    v_mfma_f32_16x16x32_bf16 v[152:155], v[52:55], a[52:55], v[152:155]
    s_xor_b32 s4, s28, 2
    s_mul_i32 s4, s4, 10240
    v_mfma_f32_16x16x32_bf16 v[160:163], v[52:55], a[76:79], v[160:163]
    s_add_u32 s26, s4, s22
    s_add_u32 s4, s21, 1
    v_mfma_f32_16x16x32_bf16 v[140:143], v[76:79], a[4:7], v[140:143]
    v_mov_b32 v228, s4
    v_mov_b32 v96, 0
    v_mfma_f32_16x16x32_bf16 v[148:151], v[76:79], a[28:31], v[148:151]
    v_mov_b32 v97, 0
    v_mov_b32 v98, 0
    v_mfma_f32_16x16x32_bf16 v[156:159], v[76:79], a[52:55], v[156:159]
    s_or_b64 s[6:7], s[84:85], s[94:95]
    s_min_u32 s6, s6, s7
    s_cmp_ge_u32 s6, s21
    s_cbranch_scc0 Cfg_s
Cfg_o:
    s_barrier
    buffer_load_dwordx4 v[204:207], v8, s[8:11], s35 offen offset:0 sc1
    buffer_load_dwordx4 v[208:211], v8, s[8:11], s35 offen offset:1024 sc1
    v_mfma_f32_16x16x32_bf16 v[164:167], v[76:79], a[76:79], v[164:167]
    v_mov_b32 v99, 0
    v_mov_b32 v100, 0
    v_mfma_f32_16x16x32_bf16 v[136:139], v[56:59], a[8:11], v[136:139]
    buffer_store_dwordx2 v[232:233], v12, s[8:11], s34 offen offset:0 sc1
    buffer_store_dwordx2 v[234:235], v223, s[8:11], s34 offen offset:0 sc1
    s_add_u32 s34, s34, 524288
    s_and_b32 s6, s34, 1572864
    s_cselect_b32 s6, 0, 8192
    s_xor_b32 s34, s34, s6
    v_mfma_f32_16x16x32_bf16 v[144:147], v[56:59], a[32:35], v[144:147]
    v_mov_b32 v101, 0
    v_mov_b32 v102, 0
    v_mfma_f32_16x16x32_bf16 v[152:155], v[56:59], a[56:59], v[152:155]
    v_mov_b32 v103, 0
    v_mov_b32 v104, 0
    v_mfma_f32_16x16x32_bf16 v[160:163], v[56:59], a[80:83], v[160:163]
    v_mov_b32 v105, 0
    v_mov_b32 v106, 0
    v_mfma_f32_16x16x32_bf16 v[140:143], v[80:83], a[8:11], v[140:143]
    v_mov_b32 v107, 0
    v_mov_b32 v108, 0
    v_mfma_f32_16x16x32_bf16 v[148:151], v[80:83], a[32:35], v[148:151]
    v_mov_b32 v109, 0
    v_mov_b32 v110, 0
    v_mfma_f32_16x16x32_bf16 v[156:159], v[80:83], a[56:59], v[156:159]
    v_mov_b32 v111, 0
    v_mfma_f32_16x16x32_bf16 v[164:167], v[80:83], a[80:83], v[164:167]
    v_mfma_f32_16x16x32_bf16 v[136:139], v[60:63], a[12:15], v[136:139]
    v_mfma_f32_16x16x32_bf16 v[144:147], v[60:63], a[36:39], v[144:147]
    v_mfma_f32_16x16x32_bf16 v[152:155], v[60:63], a[60:63], v[152:155]
    v_mfma_f32_16x16x32_bf16 v[160:163], v[60:63], a[84:87], v[160:163]
    v_mfma_f32_16x16x32_bf16 v[140:143], v[84:87], a[12:15], v[140:143]
    v_mfma_f32_16x16x32_bf16 v[148:151], v[84:87], a[36:39], v[148:151]
    v_mfma_f32_16x16x32_bf16 v[156:159], v[84:87], a[60:63], v[156:159]
    v_mfma_f32_16x16x32_bf16 v[164:167], v[84:87], a[84:87], v[164:167]
    v_mfma_f32_16x16x32_bf16 v[136:139], v[64:67], a[16:19], v[136:139]
    v_mfma_f32_16x16x32_bf16 v[144:147], v[64:67], a[40:43], v[144:147]
    v_mfma_f32_16x16x32_bf16 v[152:155], v[64:67], a[64:67], v[152:155]
    v_mfma_f32_16x16x32_bf16 v[160:163], v[64:67], a[88:91], v[160:163]
    v_mfma_f32_16x16x32_bf16 v[140:143], v[88:91], a[16:19], v[140:143]
    v_mfma_f32_16x16x32_bf16 v[148:151], v[88:91], a[40:43], v[148:151]
    v_mfma_f32_16x16x32_bf16 v[156:159], v[88:91], a[64:67], v[156:159]
    v_mfma_f32_16x16x32_bf16 v[164:167], v[88:91], a[88:91], v[164:167]
    s_waitcnt vmcnt(2)
    v_mfma_f32_16x16x32_bf16 v[32:35], v[224:227], v[204:207], 0
    v_max3_u32 v36, v204, v206, v208
    v_mfma_f32_16x16x32_bf16 v[32:35], v[224:227], v[208:211], v[32:35]
    v_max_u32 v36, v36, v210
    v_cmp_eq_u32 vcc, -1, v36
    s_cbranch_vccnz Cf4_s
Cf4_o:
    s_nop 4
    v_cvt_pk_bf16_f32 v38, v32, v33
    v_cvt_pk_bf16_f32 v39, v34, v35
Cf4_z:
    buffer_store_dwordx2 v[38:39], v222, s[8:11], s25 offen offset:0
    v_mfma_f32_16x16x32_bf16 v[136:139], v[68:71], a[20:23], v[136:139]
    v_mfma_f32_16x16x32_bf16 v[144:147], v[68:71], a[44:47], v[144:147]
    v_mfma_f32_16x16x32_bf16 v[152:155], v[68:71], a[68:71], v[152:155]
    v_mfma_f32_16x16x32_bf16 v[160:163], v[68:71], a[92:95], v[160:163]
    v_mfma_f32_16x16x32_bf16 v[140:143], v[92:95], a[20:23], v[140:143]
    v_mfma_f32_16x16x32_bf16 v[148:151], v[92:95], a[44:47], v[148:151]
    v_mfma_f32_16x16x32_bf16 v[156:159], v[92:95], a[68:71], v[156:159]
    v_mfma_f32_16x16x32_bf16 v[164:167], v[92:95], a[92:95], v[164:167]
    s_cmp_lg_u64 s[86:87], 0
    s_cbranch_scc1 Cf_gw
Cf_go2:
    v_cvt_pk_bf16_f32 v168, v136, v137
    v_cvt_pk_bf16_f32 v169, v140, v141
    v_cvt_pk_bf16_f32 v170, v138, v139
    v_cvt_pk_bf16_f32 v171, v142, v143
    ds_write_b128 v3, v[168:171] offset:0
    v_cvt_pk_bf16_f32 v172, v144, v145
    v_cvt_pk_bf16_f32 v173, v148, v149
    v_cvt_pk_bf16_f32 v174, v146, v147
    v_cvt_pk_bf16_f32 v175, v150, v151
    ds_write_b128 v3, v[172:175] offset:4096
    buffer_load_dwordx4 v[48:51], v2, s[8:11], s40 offen offset:0 sc1
    v_cvt_pk_bf16_f32 v176, v152, v153
    v_cvt_pk_bf16_f32 v177, v156, v157
    buffer_load_dwordx4 v[72:75], v2, s[8:11], s41 offen offset:2048 sc1
    v_cvt_pk_bf16_f32 v178, v154, v155
    v_cvt_pk_bf16_f32 v179, v158, v159
    buffer_load_dwordx4 v[52:55], v2, s[8:11], s40 offen offset:1024 sc1
    ds_write_b128 v3, v[176:179] offset:8192
    v_cvt_pk_bf16_f32 v180, v160, v161
    buffer_load_dwordx4 v[76:79], v2, s[8:11], s41 offen offset:3072 sc1
    v_cvt_pk_bf16_f32 v181, v164, v165
    v_cvt_pk_bf16_f32 v182, v162, v163
    buffer_load_dwordx4 v[56:59], v2, s[8:11], s40 offen offset:2048 sc1
    v_cvt_pk_bf16_f32 v183, v166, v167
    ds_write_b128 v3, v[180:183] offset:12288
    buffer_load_dwordx4 v[80:83], v2, s[8:11], s42 offen offset:0 sc1
    s_waitcnt lgkmcnt(0)
    s_barrier
    ds_read_b128 v[168:171], v0 offset:0
    ds_read_b128 v[136:139], v246 offset:0
    ds_read_b128 v[140:143], v246 offset:1024
    ds_read_b128 v[172:175], v0 offset:1024
    ds_read_b128 v[144:147], v246 offset:2048
    ds_read_b128 v[148:151], v246 offset:3072
    ds_read_b128 v[176:179], v0 offset:2048
    ds_read_b128 v[152:155], v246 offset:4096
    ds_read_b128 v[156:159], v246 offset:5120
    ds_read_b128 v[180:183], v0 offset:3072
    ds_read_b128 v[160:163], v246 offset:6144
    ds_read_b128 v[164:167], v246 offset:7168
    s_waitcnt lgkmcnt(10)
    v_mfma_f32_16x16x32_bf16 v[236:239], v[168:171], v[136:139], 0
    ds_read_b128 v[184:187], v193 offset:0
    buffer_load_dwordx4 v[60:63], v2, s[8:11], s40 offen offset:3072 sc1
    s_waitcnt lgkmcnt(10)
    v_mfma_f32_16x16x32_bf16 v[252:255], v[168:171], v[140:143], 0
    ds_read_b128 v[16:19], v245 offset:0
    buffer_load_dwordx4 v[84:87], v2, s[8:11], s42 offen offset:1024 sc1
    s_waitcnt lgkmcnt(9)
    v_mfma_f32_16x16x32_bf16 v[236:239], v[172:175], v[144:147], v[236:239]
    ds_read_b128 v[20:23], v245 offset:512
    buffer_load_dwordx4 v[64:67], v2, s[8:11], s41 offen offset:0 sc1
    s_waitcnt lgkmcnt(9)
    v_mfma_f32_16x16x32_bf16 v[252:255], v[172:175], v[148:151], v[252:255]
    ds_read_b128 v[188:191], v193 offset:1024
    buffer_load_dwordx4 v[88:91], v2, s[8:11], s42 offen offset:2048 sc1
    s_waitcnt lgkmcnt(8)
    v_mfma_f32_16x16x32_bf16 v[236:239], v[176:179], v[152:155], v[236:239]
    ds_read_b128 v[24:27], v245 offset:1024
    buffer_load_dwordx4 v[68:71], v2, s[8:11], s41 offen offset:1024 sc1
    s_waitcnt lgkmcnt(8)
    v_mfma_f32_16x16x32_bf16 v[252:255], v[176:179], v[156:159], v[252:255]
    ds_read_b128 v[28:31], v245 offset:1536
    buffer_load_dwordx4 v[92:95], v2, s[8:11], s42 offen offset:3072 sc1
    s_waitcnt lgkmcnt(7)
    v_mfma_f32_16x16x32_bf16 v[236:239], v[180:183], v[160:163], v[236:239]
    s_waitcnt lgkmcnt(6)
    v_mfma_f32_16x16x32_bf16 v[252:255], v[180:183], v[164:167], v[252:255]
    s_waitcnt lgkmcnt(4)
    v_mfma_f32_16x16x32_bf16 v[236:239], v[184:187], v[16:19], v[236:239]
    s_waitcnt lgkmcnt(3)
    v_mfma_f32_16x16x32_bf16 v[252:255], v[184:187], v[20:23], v[252:255]
    s_waitcnt lgkmcnt(1)
    v_mfma_f32_16x16x32_bf16 v[236:239], v[188:191], v[24:27], v[236:239]
    s_waitcnt lgkmcnt(0)
    v_mfma_f32_16x16x32_bf16 v[252:255], v[188:191], v[28:31], v[252:255]
    s_nop 3
    v_cvt_pk_bf16_f32 v232, v236, v237
    v_cvt_pk_bf16_f32 v233, v238, v239
    s_nop 1
    v_cvt_pk_bf16_f32 v234, v252, v253
    v_cvt_pk_bf16_f32 v235, v254, v255
    buffer_store_dwordx2 v[240:241], v6, s[8:11], s26 offen offset:0
    s_mul_i32 s4, s28, 163840
    s_add_u32 s35, s4, 2097152
    s_add_u32 s4, s28, 1
    s_and_b32 s4, s4, 3
    s_lshl_b32 s4, s4, 14
    v_add_u32 v3, s4, v197
    s_add_u32 s46, s21, 3
    s_min_u32 s46, s46, 64
    s_mov_b32 s47, s21
    s_add_u32 s4, s46, 3
    s_and_b32 s4, s4, 3
    s_mul_i32 s4, s4, 49152
    s_add_u32 s40, s4, s27
    s_add_u32 s41, s40, 4096
    s_add_u32 s42, s40, 8192
    s_add_u32 s23, s36, s92
    s_mov_b32 m0, s93
    s_add_u32 s36, s36, 65536
    s_and_b32 s36, s36, 262143
    ds_read_b128 v[120:123], v192 offset:0
    ds_read_b128 v[124:127], v192 offset:1024
    ds_read_b128 v[128:131], v192 offset:2048
    ds_read_b128 v[132:135], v192 offset:3072
    s_branch Cf_loop
Cf_end:
    buffer_store_dwordx2 v[232:233], v12, s[8:11], s34 offen offset:0 sc1
    buffer_store_dwordx2 v[234:235], v223, s[8:11], s34 offen offset:0 sc1
    s_add_u32 s34, s34, 524288
    s_and_b32 s6, s34, 1572864
    s_cselect_b32 s6, 0, 8192
    s_xor_b32 s34, s34, s6
    v_mov_b32 v10, 61
    s_mov_b64 exec, 1
    buffer_store_dword v10, v9, s[8:11], s33 offen
    s_mov_b64 exec, -1
    s_barrier
    s_mov_b32 s31, 0
Cfx1_l:
    buffer_load_dword v250, v248, s[8:11], s22 offen sc1
    s_waitcnt vmcnt(0)
Cfx1_c:
    v_cmp_gt_u32 vcc, 63, v250
    s_cbranch_vccz Cfx1_o
    s_sleep 1
    s_add_u32 s31, s31, 1
    s_cmp_lt_u32 s31, s30
    s_cbranch_scc1 Cfx1_l
    s_mov_b32 s30, 1
Cfx1_o:
    buffer_load_dwordx4 v2, s[8:11], s23 offen offset:0 sc1 lds
    buffer_load_dwordx4 v2, s[8:11], s23 offen offset:1024 sc1 lds
    buffer_load_dwordx4 v2, s[8:11], s23 offen offset:2048 sc1 lds
    v_add_u32 v0, 32768, v194
    v_add_u32 v193, 16384, v195
    s_waitcnt vmcnt(0) lgkmcnt(0)
    s_barrier
    ds_read_b128 v[168:171], v0 offset:0
    ds_read_b128 v[136:139], v246 offset:0
    ds_read_b128 v[140:143], v246 offset:1024
    ds_read_b128 v[172:175], v0 offset:1024
    ds_read_b128 v[144:147], v246 offset:2048
    ds_read_b128 v[148:151], v246 offset:3072
    ds_read_b128 v[176:179], v0 offset:2048
    ds_read_b128 v[152:155], v246 offset:4096
    ds_read_b128 v[156:159], v246 offset:5120
    ds_read_b128 v[180:183], v0 offset:3072
    ds_read_b128 v[160:163], v246 offset:6144
    ds_read_b128 v[164:167], v246 offset:7168
    s_waitcnt lgkmcnt(10)
    v_mfma_f32_16x16x32_bf16 v[236:239], v[168:171], v[136:139], 0
    ds_read_b128 v[184:187], v193 offset:0
    s_waitcnt lgkmcnt(10)
    v_mfma_f32_16x16x32_bf16 v[252:255], v[168:171], v[140:143], 0
    ds_read_b128 v[16:19], v245 offset:0
    s_waitcnt lgkmcnt(9)
    v_mfma_f32_16x16x32_bf16 v[236:239], v[172:175], v[144:147], v[236:239]
    ds_read_b128 v[20:23], v245 offset:512
    s_waitcnt lgkmcnt(9)
    v_mfma_f32_16x16x32_bf16 v[252:255], v[172:175], v[148:151], v[252:255]
    ds_read_b128 v[188:191], v193 offset:1024
    s_waitcnt lgkmcnt(8)
    v_mfma_f32_16x16x32_bf16 v[236:239], v[176:179], v[152:155], v[236:239]
    ds_read_b128 v[24:27], v245 offset:1024
    s_waitcnt lgkmcnt(8)
    v_mfma_f32_16x16x32_bf16 v[252:255], v[176:179], v[156:159], v[252:255]
    ds_read_b128 v[28:31], v245 offset:1536
    s_waitcnt lgkmcnt(7)
    v_mfma_f32_16x16x32_bf16 v[236:239], v[180:183], v[160:163], v[236:239]
    s_waitcnt lgkmcnt(6)
    v_mfma_f32_16x16x32_bf16 v[252:255], v[180:183], v[164:167], v[252:255]
    s_waitcnt lgkmcnt(4)
    v_mfma_f32_16x16x32_bf16 v[236:239], v[184:187], v[16:19], v[236:239]
    s_waitcnt lgkmcnt(3)
    v_mfma_f32_16x16x32_bf16 v[252:255], v[184:187], v[20:23], v[252:255]
    s_waitcnt lgkmcnt(1)
    v_mfma_f32_16x16x32_bf16 v[236:239], v[188:191], v[24:27], v[236:239]
    s_waitcnt lgkmcnt(0)
    v_mfma_f32_16x16x32_bf16 v[252:255], v[188:191], v[28:31], v[252:255]
    s_nop 3
    v_cvt_pk_bf16_f32 v232, v236, v237
    v_cvt_pk_bf16_f32 v233, v238, v239
    s_nop 1
    v_cvt_pk_bf16_f32 v234, v252, v253
    v_cvt_pk_bf16_f32 v235, v254, v255
    buffer_store_dwordx2 v[232:233], v12, s[8:11], s34 offen offset:0 sc1
    buffer_store_dwordx2 v[234:235], v223, s[8:11], s34 offen offset:0 sc1
    s_add_u32 s34, s34, 524288
    s_and_b32 s6, s34, 1572864
    s_cselect_b32 s6, 0, 8192
    s_xor_b32 s34, s34, s6
    v_mov_b32 v10, 62
    s_mov_b64 exec, 1
    buffer_store_dword v10, v9, s[8:11], s33 offen
    s_mov_b64 exec, -1
    s_barrier
    s_mov_b32 s31, 0
Cfx2_l:
    buffer_load_dword v250, v248, s[8:11], s22 offen sc1
    s_waitcnt vmcnt(0)
Cfx2_c:
    v_cmp_gt_u32 vcc, 64, v250
    s_cbranch_vccz Cfx2_o
    s_sleep 1
    s_add_u32 s31, s31, 1
    s_cmp_lt_u32 s31, s30
    s_cbranch_scc1 Cfx2_l
    s_mov_b32 s30, 1
Cfx2_o:
    s_add_u32 s23, s36, s92
    s_mov_b32 m0, s93
    s_add_u32 s36, s36, 65536
    s_and_b32 s36, s36, 262143
    buffer_load_dwordx4 v2, s[8:11], s23 offen offset:0 sc1 lds
    buffer_load_dwordx4 v2, s[8:11], s23 offen offset:1024 sc1 lds
    buffer_load_dwordx4 v2, s[8:11], s23 offen offset:2048 sc1 lds
    v_add_u32 v0, 49152, v194
    v_add_u32 v193, 24576, v195
    s_waitcnt vmcnt(0)
    s_barrier
    ds_read_b128 v[168:171], v0 offset:0
    ds_read_b128 v[136:139], v246 offset:0
    ds_read_b128 v[140:143], v246 offset:1024
    ds_read_b128 v[172:175], v0 offset:1024
    ds_read_b128 v[144:147], v246 offset:2048
    ds_read_b128 v[148:151], v246 offset:3072
    ds_read_b128 v[176:179], v0 offset:2048
    ds_read_b128 v[152:155], v246 offset:4096
    ds_read_b128 v[156:159], v246 offset:5120
    ds_read_b128 v[180:183], v0 offset:3072
    ds_read_b128 v[160:163], v246 offset:6144
    ds_read_b128 v[164:167], v246 offset:7168
    s_waitcnt lgkmcnt(10)
    v_mfma_f32_16x16x32_bf16 v[236:239], v[168:171], v[136:139], 0
    ds_read_b128 v[184:187], v193 offset:0
    s_waitcnt lgkmcnt(10)
    v_mfma_f32_16x16x32_bf16 v[252:255], v[168:171], v[140:143], 0
    ds_read_b128 v[16:19], v245 offset:0
    s_waitcnt lgkmcnt(9)
    v_mfma_f32_16x16x32_bf16 v[236:239], v[172:175], v[144:147], v[236:239]
    ds_read_b128 v[20:23], v245 offset:512
    s_waitcnt lgkmcnt(9)
    v_mfma_f32_16x16x32_bf16 v[252:255], v[172:175], v[148:151], v[252:255]
    ds_read_b128 v[188:191], v193 offset:1024
    s_waitcnt lgkmcnt(8)
    v_mfma_f32_16x16x32_bf16 v[236:239], v[176:179], v[152:155], v[236:239]
    ds_read_b128 v[24:27], v245 offset:1024
    s_waitcnt lgkmcnt(8)
    v_mfma_f32_16x16x32_bf16 v[252:255], v[176:179], v[156:159], v[252:255]
    ds_read_b128 v[28:31], v245 offset:1536
    s_waitcnt lgkmcnt(7)
    v_mfma_f32_16x16x32_bf16 v[236:239], v[180:183], v[160:163], v[236:239]
    s_waitcnt lgkmcnt(6)
    v_mfma_f32_16x16x32_bf16 v[252:255], v[180:183], v[164:167], v[252:255]
    s_waitcnt lgkmcnt(4)
    v_mfma_f32_16x16x32_bf16 v[236:239], v[184:187], v[16:19], v[236:239]
    s_waitcnt lgkmcnt(3)
    v_mfma_f32_16x16x32_bf16 v[252:255], v[184:187], v[20:23], v[252:255]
    s_waitcnt lgkmcnt(1)
    v_mfma_f32_16x16x32_bf16 v[236:239], v[188:191], v[24:27], v[236:239]
    s_waitcnt lgkmcnt(0)
    v_mfma_f32_16x16x32_bf16 v[252:255], v[188:191], v[28:31], v[252:255]
    s_nop 3
    v_cvt_pk_bf16_f32 v232, v236, v237
    v_cvt_pk_bf16_f32 v233, v238, v239
    s_nop 1
    v_cvt_pk_bf16_f32 v234, v252, v253
    v_cvt_pk_bf16_f32 v235, v254, v255
    buffer_store_dwordx2 v[232:233], v12, s[8:11], s34 offen offset:0 sc1
    buffer_store_dwordx2 v[234:235], v223, s[8:11], s34 offen offset:0 sc1
    s_add_u32 s34, s34, 524288
    s_and_b32 s6, s34, 1572864
    s_cselect_b32 s6, 0, 8192
    s_xor_b32 s34, s34, s6
    v_mov_b32 v10, 63
    s_mov_b64 exec, 1
    buffer_store_dword v10, v9, s[8:11], s33 offen
    s_mov_b64 exec, -1
    s_branch R_done
Cf_fw:
    s_mov_b32 s31, 0
Cffx_l:
    buffer_load_dword v250, v248, s[8:11], s22 offen sc1
    s_waitcnt vmcnt(0)
Cffx_c:
    v_cmp_gt_u32 vcc, s47, v250
    s_cbranch_vccz Cffx_o
    s_sleep 1
    s_add_u32 s31, s31, 1
    s_cmp_lt_u32 s31, s30
    s_cbranch_scc1 Cffx_l
    s_mov_b32 s30, 1
Cffx_o:
    s_branch Cf_fo
Cf_gw:
    s_mov_b32 s31, 0
Cffv_l:
    buffer_load_dword v250, v247, s[8:11], s22 offen sc1
    s_waitcnt vmcnt(0)
Cffv_c:
    v_cmp_gt_u32 vcc, s46, v250
    s_cbranch_vccz Cffv_o
    s_sleep 1
    s_add_u32 s31, s31, 1
    s_cmp_lt_u32 s31, s30
    s_cbranch_scc1 Cffv_l
    s_mov_b32 s30, 1
Cffv_o:
    s_branch Cf_go2
Cf_v1:
    s_mov_b32 s31, 0
Cfv3_l:
    buffer_load_dword v250, v247, s[8:11], s22 offen sc1
    s_waitcnt vmcnt(0)
Cfv3_c:
    v_cmp_gt_u32 vcc, 2, v250
    s_cbranch_vccz Cfv3_o
    s_sleep 1
    s_add_u32 s31, s31, 1
    s_cmp_lt_u32 s31, s30
    s_cbranch_scc1 Cfv3_l
    s_mov_b32 s30, 1
Cfv3_o:
    s_add_u32 s4, 2, 3
    s_and_b32 s4, s4, 3
    s_mul_i32 s4, s4, 49152
    s_add_u32 s40, s4, s27
    s_add_u32 s41, s40, 4096
    s_add_u32 s42, s40, 8192
    buffer_load_dwordx4 v[48:51], v2, s[8:11], s40 offen offset:0 sc1
    buffer_load_dwordx4 v[52:55], v2, s[8:11], s40 offen offset:1024 sc1
    buffer_load_dwordx4 v[56:59], v2, s[8:11], s40 offen offset:2048 sc1
    buffer_load_dwordx4 v[60:63], v2, s[8:11], s40 offen offset:3072 sc1
    buffer_load_dwordx4 v[64:67], v2, s[8:11], s41 offen offset:0 sc1
    buffer_load_dwordx4 v[68:71], v2, s[8:11], s41 offen offset:1024 sc1
    buffer_load_dwordx4 v[72:75], v2, s[8:11], s41 offen offset:2048 sc1
    buffer_load_dwordx4 v[76:79], v2, s[8:11], s41 offen offset:3072 sc1
    buffer_load_dwordx4 v[80:83], v2, s[8:11], s42 offen offset:0 sc1
    buffer_load_dwordx4 v[84:87], v2, s[8:11], s42 offen offset:1024 sc1
    buffer_load_dwordx4 v[88:91], v2, s[8:11], s42 offen offset:2048 sc1
    buffer_load_dwordx4 v[92:95], v2, s[8:11], s42 offen offset:3072 sc1
    s_add_u32 s4, s46, 3
    s_and_b32 s4, s4, 3
    s_mul_i32 s4, s4, 49152
    s_add_u32 s40, s4, s27
    s_add_u32 s41, s40, 4096
    s_add_u32 s42, s40, 8192
    s_waitcnt vmcnt(0)
    s_branch Cf_v1r
Cfm_s:
    s_mov_b32 s31, 0
Cfm_l:
    buffer_load_dwordx4 v[16:19], v2, s[8:11], s38 offen offset:0 sc1
    buffer_load_dwordx4 v[20:23], v2, s[8:11], s38 offen offset:1024 sc1
    buffer_load_dwordx4 v[24:27], v2, s[8:11], s38 offen offset:2048 sc1
    s_nop 7
    v_mov_b32 v96, 0
    v_mov_b32 v97, 0
    v_mov_b32 v98, 0
    v_mov_b32 v99, 0
    v_mov_b32 v100, 0
    v_mov_b32 v101, 0
    v_mov_b32 v102, 0
    v_mov_b32 v103, 0
    v_mov_b32 v104, 0
    v_mov_b32 v105, 0
    v_mov_b32 v106, 0
    v_mov_b32 v107, 0
    v_mov_b32 v108, 0
    v_mov_b32 v109, 0
    v_mov_b32 v110, 0
    v_mov_b32 v111, 0
    s_waitcnt vmcnt(0)
    v_max3_u32 v251, v16, v18, v20
    v_max3_u32 v251, v251, v22, v24
    v_max_u32 v251, v251, v26
    v_cmp_eq_u32 vcc, -1, v251
    s_cbranch_vccz Cfm_b
    s_add_u32 s31, s31, 1
    s_cmp_lt_u32 s31, s30
    s_cbranch_scc1 Cfm_l
    s_mov_b32 s30, 1
    v_min_u32 v16, s48, v16
    v_min_u32 v18, s48, v18
    v_min_u32 v20, s48, v20
    v_min_u32 v22, s48, v22
    v_min_u32 v24, s48, v24
    v_min_u32 v26, s48, v26
    s_branch Cfm_b
Cfg_s:
    s_mov_b32 s31, 0
Cfg_l:
    s_load_dword s84, s[8:9], s37 glc
    s_load_dword s85, s[8:9], s43 glc
    s_or_b64 s[6:7], s[84:85], s[94:95]
    s_min_u32 s6, s6, s7
    s_cmp_ge_u32 s6, s21
    s_cbranch_scc1 Cfg_o
    s_or_b64 s[6:7], s[84:85], s[94:95]
    s_min_u32 s6, s6, s7
    s_cmp_ge_u32 s6, s21
    s_cbranch_scc1 Cfg_o
    s_or_b64 s[6:7], s[84:85], s[94:95]
    s_min_u32 s6, s6, s7
    s_cmp_ge_u32 s6, s21
    s_cbranch_scc1 Cfg_o
    s_or_b64 s[6:7], s[84:85], s[94:95]
    s_min_u32 s6, s6, s7
    s_cmp_ge_u32 s6, s21
    s_cbranch_scc1 Cfg_o
    s_or_b64 s[6:7], s[84:85], s[94:95]
    s_min_u32 s6, s6, s7
    s_cmp_ge_u32 s6, s21
    s_cbranch_scc1 Cfg_o
    s_or_b64 s[6:7], s[84:85], s[94:95]
    s_min_u32 s6, s6, s7
    s_cmp_ge_u32 s6, s21
    s_cbranch_scc1 Cfg_o
    s_add_u32 s31, s31, 1
    s_cmp_lt_u32 s31, s30
    s_cbranch_scc1 Cfg_l
    s_mov_b32 s30, 1
    s_branch Cfg_o
Cf4_s:
    s_mov_b32 s31, 0
Cf4_l:
    buffer_load_dwordx4 v[204:207], v8, s[8:11], s35 offen offset:0 sc1
    buffer_load_dwordx4 v[208:211], v8, s[8:11], s35 offen offset:1024 sc1
    s_waitcnt vmcnt(0)
    v_mfma_f32_16x16x32_bf16 v[32:35], v[224:227], v[204:207], 0
    v_max3_u32 v36, v204, v206, v208
    v_mfma_f32_16x16x32_bf16 v[32:35], v[224:227], v[208:211], v[32:35]
    v_max_u32 v36, v36, v210
    v_cmp_eq_u32 vcc, -1, v36
    s_nop 7
    s_cbranch_vccz Cf4_o
    s_add_u32 s31, s31, 1
    s_cmp_lt_u32 s31, s30
    s_cbranch_scc1 Cf4_l
    s_mov_b32 s30, 1
    v_cvt_pk_bf16_f32 v38, v32, v33
    v_cvt_pk_bf16_f32 v39, v34, v35
    v_min_u32 v38, s48, v38
    v_min_u32 v39, s48, v39
    s_branch Cf4_z
Cfs_s:
    s_mov_b32 s31, 0
Cfs_l:
    buffer_load_dwordx4 v[28:31], v2, s[8:11], s39 offen offset:0 sc1
    buffer_load_dwordx4 v[32:35], v2, s[8:11], s39 offen offset:1024 sc1
    buffer_load_dwordx4 v[36:39], v2, s[8:11], s39 offen offset:2048 sc1
    buffer_load_dwordx3 v[40:42], v2, s[8:11], s39 offen offset:3072 sc1
    s_waitcnt vmcnt(0)
    v_max3_u32 v250, v28, v32, v36
    v_max3_u32 v250, v250, v40, v41
    v_max_u32 v250, v250, v42
    v_cmp_eq_u32 vcc, -1, v250
    s_cbranch_vccz Cfs_b
    s_add_u32 s31, s31, 1
    s_cmp_lt_u32 s31, s30
    s_cbranch_scc1 Cfs_l
    s_mov_b32 s30, 1
    v_min_u32 v28, s48, v28
    v_min_u32 v29, s48, v29
    v_min_u32 v30, s48, v30
    v_min_u32 v31, s48, v31
    v_min_u32 v32, s48, v32
    v_min_u32 v33, s48, v33
    v_min_u32 v34, s48, v34
    v_min_u32 v35, s48, v35
    v_min_u32 v36, s48, v36
    v_min_u32 v37, s48, v37
    v_min_u32 v38, s48, v38
    v_min_u32 v39, s48, v39
    v_min_u32 v40, s48, v40
    v_min_u32 v41, s48, v41
    v_min_u32 v42, s48, v42
    s_branch Cfs_b
Cs_go:
    s_lshl_b32 s4, s3, 12
    v_add_u32 v194, s4, v2
    s_lshl_b32 s4, s3, 11
    s_add_u32 s4, s4, 65536
    v_add_u32 v195, s4, v2
    s_lshr_b32 s4, s3, 1
    s_lshl_b32 s4, s4, 10
    s_and_b32 s5, s3, 1
    s_lshl_b32 s5, s5, 3
    s_add_u32 s4, s4, s5
    s_add_u32 s4, s4, 65536
    v_add_u32 v196, s4, v2
    s_lshl_b32 s4, s3, 10
    v_add_u32 v197, s4, v2
    v_mov_b32 v3, v197
    s_mul_i32 s4, s3, 3072
    s_min_u32 s4, s4, 7168
    s_add_u32 s92, s4, s22
    s_add_u32 s92, s92, 405504
    s_add_u32 s93, s4, 102400
    s_mov_b64 s[84:85], 0
    s_mov_b64 s[86:87], 0
    s_mov_b64 s[88:89], 0
    s_mul_i32 s4, s3, 3072
    s_add_u32 s29, s4, s22
    s_add_u32 s29, s29, 106496
    s_lshl_b32 s4, s3, 12
    s_add_u32 s32, s4, s22
    s_add_u32 s32, s32, 40960
    s_barrier
    s_mov_b32 s31, 0
Csv1_l:
    buffer_load_dword v250, v247, s[8:11], s22 offen sc1
    s_waitcnt vmcnt(0)
Csv1_c:
    v_cmp_gt_u32 vcc, 1, v250
    s_cbranch_vccz Csv1_o
    s_sleep 1
    s_add_u32 s31, s31, 1
    s_cmp_lt_u32 s31, s30
    s_cbranch_scc1 Csv1_l
    s_mov_b32 s30, 1
Csv1_o:
    s_add_u32 s4, 1, 3
    s_and_b32 s4, s4, 3
    s_mul_i32 s4, s4, 49152
    s_add_u32 s40, s4, s27
    s_add_u32 s41, s40, 4096
    s_add_u32 s42, s40, 8192
    buffer_load_dwordx4 v[48:51], v2, s[8:11], s40 offen offset:0 sc1
    buffer_load_dwordx4 v[52:55], v2, s[8:11], s40 offen offset:1024 sc1
    buffer_load_dwordx4 v[56:59], v2, s[8:11], s40 offen offset:2048 sc1
    buffer_load_dwordx4 v[60:63], v2, s[8:11], s40 offen offset:3072 sc1
    buffer_load_dwordx4 v[64:67], v2, s[8:11], s41 offen offset:0 sc1
    buffer_load_dwordx4 v[68:71], v2, s[8:11], s41 offen offset:1024 sc1
    buffer_load_dwordx4 v[72:75], v2, s[8:11], s41 offen offset:2048 sc1
    buffer_load_dwordx4 v[76:79], v2, s[8:11], s41 offen offset:3072 sc1
    buffer_load_dwordx4 v[80:83], v2, s[8:11], s42 offen offset:0 sc1
    buffer_load_dwordx4 v[84:87], v2, s[8:11], s42 offen offset:1024 sc1
    buffer_load_dwordx4 v[88:91], v2, s[8:11], s42 offen offset:2048 sc1
    buffer_load_dwordx4 v[92:95], v2, s[8:11], s42 offen offset:3072 sc1
    s_waitcnt vmcnt(0)
    v_mfma_f32_16x16x32_bf16 v[136:139], v[48:51], a[0:3], 0
    v_mfma_f32_16x16x32_bf16 v[144:147], v[48:51], a[24:27], 0
    v_mfma_f32_16x16x32_bf16 v[152:155], v[48:51], a[48:51], 0
    v_mfma_f32_16x16x32_bf16 v[160:163], v[48:51], a[72:75], 0
    v_mfma_f32_16x16x32_bf16 v[140:143], v[72:75], a[0:3], 0
    v_mfma_f32_16x16x32_bf16 v[148:151], v[72:75], a[24:27], 0
    v_mfma_f32_16x16x32_bf16 v[156:159], v[72:75], a[48:51], 0
    v_mfma_f32_16x16x32_bf16 v[164:167], v[72:75], a[72:75], 0
    v_mfma_f32_16x16x32_bf16 v[136:139], v[52:55], a[4:7], v[136:139]
    v_mfma_f32_16x16x32_bf16 v[144:147], v[52:55], a[28:31], v[144:147]
    v_mfma_f32_16x16x32_bf16 v[152:155], v[52:55], a[52:55], v[152:155]
    v_mfma_f32_16x16x32_bf16 v[160:163], v[52:55], a[76:79], v[160:163]
    v_mfma_f32_16x16x32_bf16 v[140:143], v[76:79], a[4:7], v[140:143]
    v_mfma_f32_16x16x32_bf16 v[148:151], v[76:79], a[28:31], v[148:151]
    v_mfma_f32_16x16x32_bf16 v[156:159], v[76:79], a[52:55], v[156:159]
    v_mfma_f32_16x16x32_bf16 v[164:167], v[76:79], a[76:79], v[164:167]
    v_mfma_f32_16x16x32_bf16 v[136:139], v[56:59], a[8:11], v[136:139]
    v_mfma_f32_16x16x32_bf16 v[144:147], v[56:59], a[32:35], v[144:147]
    v_mfma_f32_16x16x32_bf16 v[152:155], v[56:59], a[56:59], v[152:155]
    v_mfma_f32_16x16x32_bf16 v[160:163], v[56:59], a[80:83], v[160:163]
    v_mfma_f32_16x16x32_bf16 v[140:143], v[80:83], a[8:11], v[140:143]
    v_mfma_f32_16x16x32_bf16 v[148:151], v[80:83], a[32:35], v[148:151]
    v_mfma_f32_16x16x32_bf16 v[156:159], v[80:83], a[56:59], v[156:159]
    v_mfma_f32_16x16x32_bf16 v[164:167], v[80:83], a[80:83], v[164:167]
    v_mfma_f32_16x16x32_bf16 v[136:139], v[60:63], a[12:15], v[136:139]
    v_mfma_f32_16x16x32_bf16 v[144:147], v[60:63], a[36:39], v[144:147]
    v_mfma_f32_16x16x32_bf16 v[152:155], v[60:63], a[60:63], v[152:155]
    v_mfma_f32_16x16x32_bf16 v[160:163], v[60:63], a[84:87], v[160:163]
    v_mfma_f32_16x16x32_bf16 v[140:143], v[84:87], a[12:15], v[140:143]
    v_mfma_f32_16x16x32_bf16 v[148:151], v[84:87], a[36:39], v[148:151]
    v_mfma_f32_16x16x32_bf16 v[156:159], v[84:87], a[60:63], v[156:159]
    v_mfma_f32_16x16x32_bf16 v[164:167], v[84:87], a[84:87], v[164:167]
    v_mfma_f32_16x16x32_bf16 v[136:139], v[64:67], a[16:19], v[136:139]
    v_mfma_f32_16x16x32_bf16 v[144:147], v[64:67], a[40:43], v[144:147]
    v_mfma_f32_16x16x32_bf16 v[152:155], v[64:67], a[64:67], v[152:155]
    v_mfma_f32_16x16x32_bf16 v[160:163], v[64:67], a[88:91], v[160:163]
    v_mfma_f32_16x16x32_bf16 v[140:143], v[88:91], a[16:19], v[140:143]
    v_mfma_f32_16x16x32_bf16 v[148:151], v[88:91], a[40:43], v[148:151]
    v_mfma_f32_16x16x32_bf16 v[156:159], v[88:91], a[64:67], v[156:159]
    v_mfma_f32_16x16x32_bf16 v[164:167], v[88:91], a[88:91], v[164:167]
    v_mfma_f32_16x16x32_bf16 v[136:139], v[68:71], a[20:23], v[136:139]
    v_mfma_f32_16x16x32_bf16 v[144:147], v[68:71], a[44:47], v[144:147]
    v_mfma_f32_16x16x32_bf16 v[152:155], v[68:71], a[68:71], v[152:155]
    v_mfma_f32_16x16x32_bf16 v[160:163], v[68:71], a[92:95], v[160:163]
    v_mfma_f32_16x16x32_bf16 v[140:143], v[92:95], a[20:23], v[140:143]
    v_mfma_f32_16x16x32_bf16 v[148:151], v[92:95], a[44:47], v[148:151]
    v_mfma_f32_16x16x32_bf16 v[156:159], v[92:95], a[68:71], v[156:159]
    v_mfma_f32_16x16x32_bf16 v[164:167], v[92:95], a[92:95], v[164:167]
    v_cvt_pk_bf16_f32 v168, v136, v137
    v_cvt_pk_bf16_f32 v169, v140, v141
    v_cvt_pk_bf16_f32 v170, v138, v139
    v_cvt_pk_bf16_f32 v171, v142, v143
    ds_write_b128 v3, v[168:171] offset:0
    v_cvt_pk_bf16_f32 v172, v144, v145
    v_cvt_pk_bf16_f32 v173, v148, v149
    v_cvt_pk_bf16_f32 v174, v146, v147
    v_cvt_pk_bf16_f32 v175, v150, v151
    ds_write_b128 v3, v[172:175] offset:4096
    v_cvt_pk_bf16_f32 v176, v152, v153
    v_cvt_pk_bf16_f32 v177, v156, v157
    v_cvt_pk_bf16_f32 v178, v154, v155
    v_cvt_pk_bf16_f32 v179, v158, v159
    ds_write_b128 v3, v[176:179] offset:8192
    v_cvt_pk_bf16_f32 v180, v160, v161
    v_cvt_pk_bf16_f32 v181, v164, v165
    v_cvt_pk_bf16_f32 v182, v162, v163
    v_cvt_pk_bf16_f32 v183, v166, v167
    ds_write_b128 v3, v[180:183] offset:12288
    s_and_b32 s28, s21, 3
    s_lshl_b32 s4, s28, 14
    v_add_u32 v192, s4, v194
    s_lshl_b32 s4, s28, 13
    v_add_u32 v13, s4, v195
    v_add_u32 v10, s4, v196
    v_xor_b32 v0, 32768, v192
    v_xor_b32 v193, 16384, v13
    s_mul_i32 s4, s28, 12288
    s_add_u32 s38, s4, s29
    s_mul_i32 s4, s28, 16384
    s_add_u32 s39, s4, s32
    s_mul_i32 s4, s28, 10240
    s_add_u32 s25, s4, s22
    s_xor_b32 s4, s28, 2
    s_mul_i32 s4, s4, 10240
    s_add_u32 s26, s4, s22
    s_add_u32 s4, s21, 1
    v_mov_b32 v228, s4
    v_mov_b32 v96, 0
    v_mov_b32 v97, 0
    v_mov_b32 v98, 0
    v_mov_b32 v99, 0
    v_mov_b32 v100, 0
    v_mov_b32 v101, 0
    v_mov_b32 v102, 0
    v_mov_b32 v103, 0
    v_mov_b32 v104, 0
    v_mov_b32 v105, 0
    v_mov_b32 v106, 0
    v_mov_b32 v107, 0
    v_mov_b32 v108, 0
    v_mov_b32 v109, 0
    v_mov_b32 v110, 0
    v_mov_b32 v111, 0
    s_waitcnt lgkmcnt(0)
    s_barrier
    s_mul_i32 s4, s28, 163840
    s_add_u32 s35, s4, 2097152
    s_add_u32 s4, s28, 1
    s_and_b32 s4, s4, 3
    s_lshl_b32 s4, s4, 14
    v_add_u32 v3, s4, v197
    s_add_u32 s46, s21, 3
    s_min_u32 s46, s46, 64
    s_mov_b32 s47, s21
    s_add_u32 s4, s46, 3
    s_and_b32 s4, s4, 3
    s_mul_i32 s4, s4, 49152
    s_add_u32 s40, s4, s27
    s_add_u32 s41, s40, 4096
    s_add_u32 s42, s40, 8192
    s_add_u32 s23, s36, s92
    s_mov_b32 m0, s93
    s_add_u32 s36, s36, 65536
    s_and_b32 s36, s36, 262143
    ds_read_b128 v[120:123], v192 offset:0
    ds_read_b128 v[124:127], v192 offset:1024
    ds_read_b128 v[128:131], v192 offset:2048
    ds_read_b128 v[132:135], v192 offset:3072
Cs_loop:
    s_add_u32 s21, s21, 1
    buffer_load_dword v45, v247, s[8:11], s22 offen offset:0 sc1
    buffer_load_dword v46, v248, s[8:11], s22 offen offset:0 sc1
    s_cmp_lg_u32 s3, 0
    s_cbranch_scc1 Csl_o
    buffer_load_dword v47, v4, s[8:11], s22 offen offset:0 sc1
    s_nop 12
    buffer_load_dword v47, v4, s[8:11], s22 offen offset:0 sc1
    s_nop 12
    s_mov_b32 s31, -1
Csl_l:
    buffer_load_dword v47, v4, s[8:11], s22 offen offset:0 sc1
    s_add_u32 s31, s31, 1
    s_cmp_lt_u32 s31, s30
    s_cselect_b32 s30, s30, 1
    s_cbranch_scc0 Csl_o
    s_waitcnt vmcnt(2)
    v_cmp_gt_u32 vcc, s21, v47
    s_cbranch_vccnz Csl_l
Csl_o:
    s_barrier
    buffer_load_dwordx4 v[16:19], v2, s[8:11], s38 offen offset:0 sc1
    buffer_load_dwordx4 v[20:23], v2, s[8:11], s38 offen offset:1024 sc1
    buffer_load_dwordx4 v[24:27], v2, s[8:11], s38 offen offset:2048 sc1
    s_waitcnt vmcnt(3)
    v_cmp_gt_u32 s[86:87], s46, v45
    v_cmp_gt_u32 s[88:89], s47, v46
Csm_b:
    s_waitcnt vmcnt(2)
    v_smfmac_f32_16x16x64_bf16 v[96:99], v[16:19], a[0:7], v5
    buffer_load_dwordx4 v[28:31], v2, s[8:11], s39 offen offset:0 sc1
    v_smfmac_f32_16x16x64_bf16 v[100:103], v[16:19], a[24:31], v5
    buffer_load_dwordx4 v[32:35], v2, s[8:11], s39 offen offset:1024 sc1
    v_smfmac_f32_16x16x64_bf16 v[104:107], v[16:19], a[48:55], v5
    buffer_load_dwordx4 v[36:39], v2, s[8:11], s39 offen offset:2048 sc1
    v_smfmac_f32_16x16x64_bf16 v[108:111], v[16:19], a[72:79], v5
    buffer_load_dwordx3 v[40:42], v2, s[8:11], s39 offen offset:3072 sc1
    s_waitcnt vmcnt(5)
    v_smfmac_f32_16x16x64_bf16 v[96:99], v[20:23], a[8:15], v5
    v_smfmac_f32_16x16x64_bf16 v[100:103], v[20:23], a[32:39], v5
    v_smfmac_f32_16x16x64_bf16 v[104:107], v[20:23], a[56:63], v5
    v_smfmac_f32_16x16x64_bf16 v[108:111], v[20:23], a[80:87], v5
    s_waitcnt vmcnt(4)
    v_smfmac_f32_16x16x64_bf16 v[96:99], v[24:27], a[16:23], v5
    v_max3_u32 v251, v16, v18, v20
    v_smfmac_f32_16x16x64_bf16 v[100:103], v[24:27], a[40:47], v5
    v_max3_u32 v251, v251, v22, v24
    v_smfmac_f32_16x16x64_bf16 v[104:107], v[24:27], a[64:71], v5
    v_max_u32 v251, v251, v26
    v_smfmac_f32_16x16x64_bf16 v[108:111], v[24:27], a[88:95], v5
    v_cmp_eq_u32 vcc, -1, v251
    v_cvt_pk_bf16_f32 v112, v96, v97
    v_cvt_pk_bf16_f32 v113, v98, v99
    s_cbranch_vccnz Csm_s
    ds_write_b64 v10, v[112:113] offset:0
    v_cvt_pk_bf16_f32 v114, v100, v101
    v_cvt_pk_bf16_f32 v115, v102, v103
    ds_write_b64 v10, v[114:115] offset:2048
    v_cvt_pk_bf16_f32 v116, v104, v105
    v_cvt_pk_bf16_f32 v117, v106, v107
    ds_write_b64 v10, v[116:117] offset:4096
    v_cvt_pk_bf16_f32 v118, v108, v109
    v_cvt_pk_bf16_f32 v119, v110, v111
    ds_write_b64 v10, v[118:119] offset:6144
    s_cmp_eq_u32 s21, 64
    s_cbranch_scc1 Cs_end
    s_cmp_lg_u64 s[88:89], 0
    s_cbranch_scc1 Cs_fw
Cs_fo:
    buffer_load_dwordx4 v2, s[8:11], s23 offen offset:0 sc1 lds
    buffer_load_dwordx4 v2, s[8:11], s23 offen offset:1024 sc1 lds
    buffer_load_dwordx4 v2, s[8:11], s23 offen offset:2048 sc1 lds
    s_waitcnt vmcnt(3)
Css_b:
    v_max3_u32 v250, v28, v32, v36
    v_pk_add_f32 v[28:29], v[28:29], v[32:33]
    v_pk_add_f32 v[30:31], v[30:31], v[34:35]
    v_max3_u32 v251, v40, v41, v42
    v_add_f32 v40, v40, v41
    v_pk_add_f32 v[28:29], v[28:29], v[36:37]
    v_pk_add_f32 v[30:31], v[30:31], v[38:39]
    v_add_f32 v40, v40, v42
    v_max3_f32 v43, v28, v29, v30
    v_max3_f32 v43, v43, v31, v40
    v_max_u32 v250, v250, v251
    v_cmp_eq_u32 vcc, -1, v250
    v_max_f32 v43, v43, v43 quad_perm:[1,0,3,2] row_mask:0xf bank_mask:0xf
    v_mul_f32 v28, s49, v28
    v_mul_f32 v29, s49, v29
    v_max_f32 v43, v43, v43 quad_perm:[2,3,0,1] row_mask:0xf bank_mask:0xf
    v_mul_f32 v30, s49, v30
    v_mul_f32 v31, s49, v31
    v_max_f32 v43, v43, v43 row_half_mirror row_mask:0xf bank_mask:0xf
    v_mul_f32 v40, s49, v40
    s_cbranch_vccnz Css_s
    v_mul_f32 v43, s49, v43
    v_sub_f32 v28, v28, v43
    v_sub_f32 v29, v29, v43
    v_sub_f32 v30, v30, v43
    v_sub_f32 v31, v31, v43
    v_sub_f32 v40, v40, v43
    v_exp_f32 v28, v28
    v_exp_f32 v29, v29
    v_exp_f32 v30, v30
    v_exp_f32 v31, v31
    v_exp_f32 v40, v40
    v_add_f32 v43, v28, v29
    v_add_f32 v44, v30, v31
    v_add_f32 v43, v43, v44
    v_add_f32 v43, v43, v40
    s_nop 1
    v_add_f32 v43, v43, v43 quad_perm:[1,0,3,2] row_mask:0xf bank_mask:0xf
    s_nop 1
    v_add_f32 v43, v43, v43 quad_perm:[2,3,0,1] row_mask:0xf bank_mask:0xf
    s_nop 1
    v_add_f32 v43, v43, v43 row_half_mirror row_mask:0xf bank_mask:0xf
    v_rcp_f32 v43, v43
    s_mov_b64 exec, s[44:45]
    buffer_store_dword v228, v198, s[8:11], s24 offen offset:0 sc1
    s_mov_b64 exec, -1
    v_mul_f32 v28, v28, v43
    v_mul_f32 v29, v29, v43
    v_mul_f32 v30, v30, v43
    v_mul_f32 v31, v31, v43
    v_mul_f32 v40, v40, v43
    v_cvt_pk_bf16_f32 v28, v28, v29
    v_cvt_pk_bf16_f32 v29, v30, v31
    v_cvt_pk_bf16_f32 v30, v40, v40
    ds_write2_b32 v11, v28, v29 offset0:0 offset1:2
    ds_write_b16 v244, v30
    s_waitcnt lgkmcnt(0)
    s_barrier
    ds_read_b128 v[168:171], v14 offset:0
    ds_read_b128 v[172:175], v14 offset:768
    ds_read_b128 v[176:179], v14 offset:1536
    ds_read_b128 v[180:183], v14 offset:2304
    ds_read_b128 v[184:187], v15 offset:0
    ds_read_b128 v[112:115], v13 offset:0
    ds_read_b128 v[188:191], v15 offset:256
    ds_read_b128 v[116:119], v13 offset:1024
    s_waitcnt lgkmcnt(7)
    v_mfma_f32_16x16x32_bf16 v[200:203], v[120:123], v[168:171], 0
    s_waitcnt lgkmcnt(6)
    v_mfma_f32_16x16x32_bf16 v[200:203], v[124:127], v[172:175], v[200:203]
    s_waitcnt lgkmcnt(5)
    v_mfma_f32_16x16x32_bf16 v[200:203], v[128:131], v[176:179], v[200:203]
    s_waitcnt lgkmcnt(4)
    v_mfma_f32_16x16x32_bf16 v[200:203], v[132:135], v[180:183], v[200:203]
    s_waitcnt lgkmcnt(2)
    v_mfma_f32_16x16x32_bf16 v[200:203], v[112:115], v[184:187], v[200:203]
    s_waitcnt lgkmcnt(0)
    v_mfma_f32_16x16x32_bf16 v[200:203], v[116:119], v[188:191], v[200:203]
    s_load_dword s84, s[8:9], s37 glc
    s_load_dword s85, s[8:9], s43 glc
    s_nop 5
    v_cvt_pk_bf16_f32 v200, v200, v201
    v_cvt_pk_bf16_f32 v201, v202, v203
    buffer_store_dwordx2 v[200:201], v7, s[8:11], s35 offen offset:0 sc1
    s_cmp_eq_u32 s21, 1
    s_cbranch_scc1 Cs_v1
Cs_v1r:
    v_mfma_f32_16x16x32_bf16 v[136:139], v[48:51], a[0:3], 0
    v_mfma_f32_16x16x32_bf16 v[144:147], v[48:51], a[24:27], 0
    v_mfma_f32_16x16x32_bf16 v[152:155], v[48:51], a[48:51], 0
    s_and_b32 s28, s21, 3
    s_lshl_b32 s4, s28, 14
    v_mfma_f32_16x16x32_bf16 v[160:163], v[48:51], a[72:75], 0
    v_add_u32 v192, s4, v194
    s_lshl_b32 s4, s28, 13
    v_mfma_f32_16x16x32_bf16 v[140:143], v[72:75], a[0:3], 0
    v_add_u32 v13, s4, v195
    v_add_u32 v10, s4, v196
    v_mfma_f32_16x16x32_bf16 v[148:151], v[72:75], a[24:27], 0
    v_xor_b32 v0, 32768, v192
    v_xor_b32 v193, 16384, v13
    v_mfma_f32_16x16x32_bf16 v[156:159], v[72:75], a[48:51], 0
    s_load_dword s84, s[8:9], s37 glc
    s_load_dword s85, s[8:9], s43 glc
    v_mfma_f32_16x16x32_bf16 v[164:167], v[72:75], a[72:75], 0
    s_mul_i32 s4, s28, 12288
    s_add_u32 s38, s4, s29
    v_mfma_f32_16x16x32_bf16 v[136:139], v[52:55], a[4:7], v[136:139]
    s_mul_i32 s4, s28, 16384
    s_add_u32 s39, s4, s32
    v_mfma_f32_16x16x32_bf16 v[144:147], v[52:55], a[28:31], v[144:147]
    s_mul_i32 s4, s28, 10240
    s_add_u32 s25, s4, s22
    v_mfma_f32_16x16x32_bf16 v[152:155], v[52:55], a[52:55], v[152:155]
    s_xor_b32 s4, s28, 2
    s_mul_i32 s4, s4, 10240
    v_mfma_f32_16x16x32_bf16 v[160:163], v[52:55], a[76:79], v[160:163]
    s_add_u32 s26, s4, s22
    s_add_u32 s4, s21, 1
    v_mfma_f32_16x16x32_bf16 v[140:143], v[76:79], a[4:7], v[140:143]
    v_mov_b32 v228, s4
    v_mov_b32 v96, 0
    v_mfma_f32_16x16x32_bf16 v[148:151], v[76:79], a[28:31], v[148:151]
    v_mov_b32 v97, 0
    v_mov_b32 v98, 0
    v_mfma_f32_16x16x32_bf16 v[156:159], v[76:79], a[52:55], v[156:159]
    s_or_b64 s[6:7], s[84:85], s[94:95]
    s_min_u32 s6, s6, s7
    s_cmp_ge_u32 s6, s21
    s_cbranch_scc0 Csg_s
Csg_o:
    s_barrier
    buffer_load_dwordx4 v[204:207], v8, s[8:11], s35 offen offset:0 sc1
    buffer_load_dwordx4 v[208:211], v8, s[8:11], s35 offen offset:1024 sc1
    v_mfma_f32_16x16x32_bf16 v[164:167], v[76:79], a[76:79], v[164:167]
    v_mov_b32 v99, 0
    v_mov_b32 v100, 0
    v_mfma_f32_16x16x32_bf16 v[136:139], v[56:59], a[8:11], v[136:139]
    buffer_store_dwordx2 v[232:233], v12, s[8:11], s34 offen offset:0 sc1
    buffer_store_dwordx2 v[234:235], v223, s[8:11], s34 offen offset:0 sc1
    s_add_u32 s34, s34, 524288
    s_and_b32 s6, s34, 1572864
    s_cselect_b32 s6, 0, 8192
    s_xor_b32 s34, s34, s6
    v_mfma_f32_16x16x32_bf16 v[144:147], v[56:59], a[32:35], v[144:147]
    v_mov_b32 v101, 0
    v_mov_b32 v102, 0
    v_mfma_f32_16x16x32_bf16 v[152:155], v[56:59], a[56:59], v[152:155]
    v_mov_b32 v103, 0
    v_mov_b32 v104, 0
    v_mfma_f32_16x16x32_bf16 v[160:163], v[56:59], a[80:83], v[160:163]
    v_mov_b32 v105, 0
    v_mov_b32 v106, 0
    v_mfma_f32_16x16x32_bf16 v[140:143], v[80:83], a[8:11], v[140:143]
    v_mov_b32 v107, 0
    v_mov_b32 v108, 0
    v_mfma_f32_16x16x32_bf16 v[148:151], v[80:83], a[32:35], v[148:151]
    v_mov_b32 v109, 0
    v_mov_b32 v110, 0
    v_mfma_f32_16x16x32_bf16 v[156:159], v[80:83], a[56:59], v[156:159]
    v_mov_b32 v111, 0
    v_mfma_f32_16x16x32_bf16 v[164:167], v[80:83], a[80:83], v[164:167]
    v_mfma_f32_16x16x32_bf16 v[136:139], v[60:63], a[12:15], v[136:139]
    v_mfma_f32_16x16x32_bf16 v[144:147], v[60:63], a[36:39], v[144:147]
    v_mfma_f32_16x16x32_bf16 v[152:155], v[60:63], a[60:63], v[152:155]
    v_mfma_f32_16x16x32_bf16 v[160:163], v[60:63], a[84:87], v[160:163]
    v_mfma_f32_16x16x32_bf16 v[140:143], v[84:87], a[12:15], v[140:143]
    v_mfma_f32_16x16x32_bf16 v[148:151], v[84:87], a[36:39], v[148:151]
    v_mfma_f32_16x16x32_bf16 v[156:159], v[84:87], a[60:63], v[156:159]
    v_mfma_f32_16x16x32_bf16 v[164:167], v[84:87], a[84:87], v[164:167]
    v_mfma_f32_16x16x32_bf16 v[136:139], v[64:67], a[16:19], v[136:139]
    v_mfma_f32_16x16x32_bf16 v[144:147], v[64:67], a[40:43], v[144:147]
    v_mfma_f32_16x16x32_bf16 v[152:155], v[64:67], a[64:67], v[152:155]
    v_mfma_f32_16x16x32_bf16 v[160:163], v[64:67], a[88:91], v[160:163]
    v_mfma_f32_16x16x32_bf16 v[140:143], v[88:91], a[16:19], v[140:143]
    v_mfma_f32_16x16x32_bf16 v[148:151], v[88:91], a[40:43], v[148:151]
    v_mfma_f32_16x16x32_bf16 v[156:159], v[88:91], a[64:67], v[156:159]
    v_mfma_f32_16x16x32_bf16 v[164:167], v[88:91], a[88:91], v[164:167]
    s_waitcnt vmcnt(2)
    v_mfma_f32_16x16x32_bf16 v[32:35], v[224:227], v[204:207], 0
    v_max3_u32 v36, v204, v206, v208
    v_mfma_f32_16x16x32_bf16 v[32:35], v[224:227], v[208:211], v[32:35]
    v_max_u32 v36, v36, v210
    v_cmp_eq_u32 vcc, -1, v36
    s_cbranch_vccnz Cs4_s
Cs4_o:
    s_nop 4
    v_cvt_pk_bf16_f32 v38, v32, v33
    v_cvt_pk_bf16_f32 v39, v34, v35
Cs4_z:
    buffer_store_dwordx2 v[38:39], v222, s[8:11], s25 offen offset:0 sc1
    v_mfma_f32_16x16x32_bf16 v[136:139], v[68:71], a[20:23], v[136:139]
    v_mfma_f32_16x16x32_bf16 v[144:147], v[68:71], a[44:47], v[144:147]
    v_mfma_f32_16x16x32_bf16 v[152:155], v[68:71], a[68:71], v[152:155]
    v_mfma_f32_16x16x32_bf16 v[160:163], v[68:71], a[92:95], v[160:163]
    v_mfma_f32_16x16x32_bf16 v[140:143], v[92:95], a[20:23], v[140:143]
    v_mfma_f32_16x16x32_bf16 v[148:151], v[92:95], a[44:47], v[148:151]
    v_mfma_f32_16x16x32_bf16 v[156:159], v[92:95], a[68:71], v[156:159]
    v_mfma_f32_16x16x32_bf16 v[164:167], v[92:95], a[92:95], v[164:167]
    s_cmp_lg_u64 s[86:87], 0
    s_cbranch_scc1 Cs_gw
Cs_go2:
    v_cvt_pk_bf16_f32 v168, v136, v137
    v_cvt_pk_bf16_f32 v169, v140, v141
    v_cvt_pk_bf16_f32 v170, v138, v139
    v_cvt_pk_bf16_f32 v171, v142, v143
    ds_write_b128 v3, v[168:171] offset:0
    v_cvt_pk_bf16_f32 v172, v144, v145
    v_cvt_pk_bf16_f32 v173, v148, v149
    v_cvt_pk_bf16_f32 v174, v146, v147
    v_cvt_pk_bf16_f32 v175, v150, v151
    ds_write_b128 v3, v[172:175] offset:4096
    buffer_load_dwordx4 v[48:51], v2, s[8:11], s40 offen offset:0 sc1
    v_cvt_pk_bf16_f32 v176, v152, v153
    v_cvt_pk_bf16_f32 v177, v156, v157
    buffer_load_dwordx4 v[72:75], v2, s[8:11], s41 offen offset:2048 sc1
    v_cvt_pk_bf16_f32 v178, v154, v155
    v_cvt_pk_bf16_f32 v179, v158, v159
    buffer_load_dwordx4 v[52:55], v2, s[8:11], s40 offen offset:1024 sc1
    ds_write_b128 v3, v[176:179] offset:8192
    v_cvt_pk_bf16_f32 v180, v160, v161
    buffer_load_dwordx4 v[76:79], v2, s[8:11], s41 offen offset:3072 sc1
    v_cvt_pk_bf16_f32 v181, v164, v165
    v_cvt_pk_bf16_f32 v182, v162, v163
    buffer_load_dwordx4 v[56:59], v2, s[8:11], s40 offen offset:2048 sc1
    v_cvt_pk_bf16_f32 v183, v166, v167
    ds_write_b128 v3, v[180:183] offset:12288
    buffer_load_dwordx4 v[80:83], v2, s[8:11], s42 offen offset:0 sc1
    s_waitcnt lgkmcnt(0)
    s_barrier
    ds_read_b128 v[168:171], v0 offset:0
    ds_read_b128 v[136:139], v246 offset:0
    ds_read_b128 v[140:143], v246 offset:1024
    ds_read_b128 v[172:175], v0 offset:1024
    ds_read_b128 v[144:147], v246 offset:2048
    ds_read_b128 v[148:151], v246 offset:3072
    ds_read_b128 v[176:179], v0 offset:2048
    ds_read_b128 v[152:155], v246 offset:4096
    ds_read_b128 v[156:159], v246 offset:5120
    ds_read_b128 v[180:183], v0 offset:3072
    ds_read_b128 v[160:163], v246 offset:6144
    ds_read_b128 v[164:167], v246 offset:7168
    s_waitcnt lgkmcnt(10)
    v_mfma_f32_16x16x32_bf16 v[236:239], v[168:171], v[136:139], 0
    ds_read_b128 v[184:187], v193 offset:0
    buffer_load_dwordx4 v[60:63], v2, s[8:11], s40 offen offset:3072 sc1
    s_waitcnt lgkmcnt(10)
    v_mfma_f32_16x16x32_bf16 v[252:255], v[168:171], v[140:143], 0
    ds_read_b128 v[16:19], v245 offset:0
    buffer_load_dwordx4 v[84:87], v2, s[8:11], s42 offen offset:1024 sc1
    s_waitcnt lgkmcnt(9)
    v_mfma_f32_16x16x32_bf16 v[236:239], v[172:175], v[144:147], v[236:239]
    ds_read_b128 v[20:23], v245 offset:512
    buffer_load_dwordx4 v[64:67], v2, s[8:11], s41 offen offset:0 sc1
    s_waitcnt lgkmcnt(9)
    v_mfma_f32_16x16x32_bf16 v[252:255], v[172:175], v[148:151], v[252:255]
    ds_read_b128 v[188:191], v193 offset:1024
    buffer_load_dwordx4 v[88:91], v2, s[8:11], s42 offen offset:2048 sc1
    s_waitcnt lgkmcnt(8)
    v_mfma_f32_16x16x32_bf16 v[236:239], v[176:179], v[152:155], v[236:239]
    ds_read_b128 v[24:27], v245 offset:1024
    buffer_load_dwordx4 v[68:71], v2, s[8:11], s41 offen offset:1024 sc1
    s_waitcnt lgkmcnt(8)
    v_mfma_f32_16x16x32_bf16 v[252:255], v[176:179], v[156:159], v[252:255]
    ds_read_b128 v[28:31], v245 offset:1536
    buffer_load_dwordx4 v[92:95], v2, s[8:11], s42 offen offset:3072 sc1
    s_waitcnt lgkmcnt(7)
    v_mfma_f32_16x16x32_bf16 v[236:239], v[180:183], v[160:163], v[236:239]
    s_waitcnt lgkmcnt(6)
    v_mfma_f32_16x16x32_bf16 v[252:255], v[180:183], v[164:167], v[252:255]
    s_waitcnt lgkmcnt(4)
    v_mfma_f32_16x16x32_bf16 v[236:239], v[184:187], v[16:19], v[236:239]
    s_waitcnt lgkmcnt(3)
    v_mfma_f32_16x16x32_bf16 v[252:255], v[184:187], v[20:23], v[252:255]
    s_waitcnt lgkmcnt(1)
    v_mfma_f32_16x16x32_bf16 v[236:239], v[188:191], v[24:27], v[236:239]
    s_waitcnt lgkmcnt(0)
    v_mfma_f32_16x16x32_bf16 v[252:255], v[188:191], v[28:31], v[252:255]
    s_nop 3
    v_cvt_pk_bf16_f32 v232, v236, v237
    v_cvt_pk_bf16_f32 v233, v238, v239
    s_nop 1
    v_cvt_pk_bf16_f32 v234, v252, v253
    v_cvt_pk_bf16_f32 v235, v254, v255
    buffer_store_dwordx2 v[240:241], v6, s[8:11], s26 offen offset:0 sc1
    s_mul_i32 s4, s28, 163840
    s_add_u32 s35, s4, 2097152
    s_add_u32 s4, s28, 1
    s_and_b32 s4, s4, 3
    s_lshl_b32 s4, s4, 14
    v_add_u32 v3, s4, v197
    s_add_u32 s46, s21, 3
    s_min_u32 s46, s46, 64
    s_mov_b32 s47, s21
    s_add_u32 s4, s46, 3
    s_and_b32 s4, s4, 3
    s_mul_i32 s4, s4, 49152
    s_add_u32 s40, s4, s27
    s_add_u32 s41, s40, 4096
    s_add_u32 s42, s40, 8192
    s_add_u32 s23, s36, s92
    s_mov_b32 m0, s93
    s_add_u32 s36, s36, 65536
    s_and_b32 s36, s36, 262143
    ds_read_b128 v[120:123], v192 offset:0
    ds_read_b128 v[124:127], v192 offset:1024
    ds_read_b128 v[128:131], v192 offset:2048
    ds_read_b128 v[132:135], v192 offset:3072
    s_branch Cs_loop
Cs_end:
    buffer_store_dwordx2 v[232:233], v12, s[8:11], s34 offen offset:0 sc1
    buffer_store_dwordx2 v[234:235], v223, s[8:11], s34 offen offset:0 sc1
    s_add_u32 s34, s34, 524288
    s_and_b32 s6, s34, 1572864
    s_cselect_b32 s6, 0, 8192
    s_xor_b32 s34, s34, s6
    v_mov_b32 v10, 61
    s_mov_b64 exec, 1
    buffer_store_dword v10, v9, s[8:11], s33 offen sc1
    s_mov_b64 exec, -1
    s_barrier
    s_mov_b32 s31, 0
Csx1_l:
    buffer_load_dword v250, v248, s[8:11], s22 offen sc1
    s_waitcnt vmcnt(0)
Csx1_c:
    v_cmp_gt_u32 vcc, 63, v250
    s_cbranch_vccz Csx1_o
    s_sleep 1
    s_add_u32 s31, s31, 1
    s_cmp_lt_u32 s31, s30
    s_cbranch_scc1 Csx1_l
    s_mov_b32 s30, 1
Csx1_o:
    buffer_load_dwordx4 v2, s[8:11], s23 offen offset:0 sc1 lds
    buffer_load_dwordx4 v2, s[8:11], s23 offen offset:1024 sc1 lds
    buffer_load_dwordx4 v2, s[8:11], s23 offen offset:2048 sc1 lds
    v_add_u32 v0, 32768, v194
    v_add_u32 v193, 16384, v195
    s_waitcnt vmcnt(0) lgkmcnt(0)
    s_barrier
    ds_read_b128 v[168:171], v0 offset:0
    ds_read_b128 v[136:139], v246 offset:0
    ds_read_b128 v[140:143], v246 offset:1024
    ds_read_b128 v[172:175], v0 offset:1024
    ds_read_b128 v[144:147], v246 offset:2048
    ds_read_b128 v[148:151], v246 offset:3072
    ds_read_b128 v[176:179], v0 offset:2048
    ds_read_b128 v[152:155], v246 offset:4096
    ds_read_b128 v[156:159], v246 offset:5120
    ds_read_b128 v[180:183], v0 offset:3072
    ds_read_b128 v[160:163], v246 offset:6144
    ds_read_b128 v[164:167], v246 offset:7168
    s_waitcnt lgkmcnt(10)
    v_mfma_f32_16x16x32_bf16 v[236:239], v[168:171], v[136:139], 0
    ds_read_b128 v[184:187], v193 offset:0
    s_waitcnt lgkmcnt(10)
    v_mfma_f32_16x16x32_bf16 v[252:255], v[168:171], v[140:143], 0
    ds_read_b128 v[16:19], v245 offset:0
    s_waitcnt lgkmcnt(9)
    v_mfma_f32_16x16x32_bf16 v[236:239], v[172:175], v[144:147], v[236:239]
    ds_read_b128 v[20:23], v245 offset:512
    s_waitcnt lgkmcnt(9)
    v_mfma_f32_16x16x32_bf16 v[252:255], v[172:175], v[148:151], v[252:255]
    ds_read_b128 v[188:191], v193 offset:1024
    s_waitcnt lgkmcnt(8)
    v_mfma_f32_16x16x32_bf16 v[236:239], v[176:179], v[152:155], v[236:239]
    ds_read_b128 v[24:27], v245 offset:1024
    s_waitcnt lgkmcnt(8)
    v_mfma_f32_16x16x32_bf16 v[252:255], v[176:179], v[156:159], v[252:255]
    ds_read_b128 v[28:31], v245 offset:1536
    s_waitcnt lgkmcnt(7)
    v_mfma_f32_16x16x32_bf16 v[236:239], v[180:183], v[160:163], v[236:239]
    s_waitcnt lgkmcnt(6)
    v_mfma_f32_16x16x32_bf16 v[252:255], v[180:183], v[164:167], v[252:255]
    s_waitcnt lgkmcnt(4)
    v_mfma_f32_16x16x32_bf16 v[236:239], v[184:187], v[16:19], v[236:239]
    s_waitcnt lgkmcnt(3)
    v_mfma_f32_16x16x32_bf16 v[252:255], v[184:187], v[20:23], v[252:255]
    s_waitcnt lgkmcnt(1)
    v_mfma_f32_16x16x32_bf16 v[236:239], v[188:191], v[24:27], v[236:239]
    s_waitcnt lgkmcnt(0)
    v_mfma_f32_16x16x32_bf16 v[252:255], v[188:191], v[28:31], v[252:255]
    s_nop 3
    v_cvt_pk_bf16_f32 v232, v236, v237
    v_cvt_pk_bf16_f32 v233, v238, v239
    s_nop 1
    v_cvt_pk_bf16_f32 v234, v252, v253
    v_cvt_pk_bf16_f32 v235, v254, v255
    buffer_store_dwordx2 v[232:233], v12, s[8:11], s34 offen offset:0 sc1
    buffer_store_dwordx2 v[234:235], v223, s[8:11], s34 offen offset:0 sc1
    s_add_u32 s34, s34, 524288
    s_and_b32 s6, s34, 1572864
    s_cselect_b32 s6, 0, 8192
    s_xor_b32 s34, s34, s6
    v_mov_b32 v10, 62
    s_mov_b64 exec, 1
    buffer_store_dword v10, v9, s[8:11], s33 offen sc1
    s_mov_b64 exec, -1
    s_barrier
    s_mov_b32 s31, 0
Csx2_l:
    buffer_load_dword v250, v248, s[8:11], s22 offen sc1
    s_waitcnt vmcnt(0)
Csx2_c:
    v_cmp_gt_u32 vcc, 64, v250
    s_cbranch_vccz Csx2_o
    s_sleep 1
    s_add_u32 s31, s31, 1
    s_cmp_lt_u32 s31, s30
    s_cbranch_scc1 Csx2_l
    s_mov_b32 s30, 1
Csx2_o:
    s_add_u32 s23, s36, s92
    s_mov_b32 m0, s93
    s_add_u32 s36, s36, 65536
    s_and_b32 s36, s36, 262143
    buffer_load_dwordx4 v2, s[8:11], s23 offen offset:0 sc1 lds
    buffer_load_dwordx4 v2, s[8:11], s23 offen offset:1024 sc1 lds
    buffer_load_dwordx4 v2, s[8:11], s23 offen offset:2048 sc1 lds
    v_add_u32 v0, 49152, v194
    v_add_u32 v193, 24576, v195
    s_waitcnt vmcnt(0)
    s_barrier
    ds_read_b128 v[168:171], v0 offset:0
    ds_read_b128 v[136:139], v246 offset:0
    ds_read_b128 v[140:143], v246 offset:1024
    ds_read_b128 v[172:175], v0 offset:1024
    ds_read_b128 v[144:147], v246 offset:2048
    ds_read_b128 v[148:151], v246 offset:3072
    ds_read_b128 v[176:179], v0 offset:2048
    ds_read_b128 v[152:155], v246 offset:4096
    ds_read_b128 v[156:159], v246 offset:5120
    ds_read_b128 v[180:183], v0 offset:3072
    ds_read_b128 v[160:163], v246 offset:6144
    ds_read_b128 v[164:167], v246 offset:7168
    s_waitcnt lgkmcnt(10)
    v_mfma_f32_16x16x32_bf16 v[236:239], v[168:171], v[136:139], 0
    ds_read_b128 v[184:187], v193 offset:0
    s_waitcnt lgkmcnt(10)
    v_mfma_f32_16x16x32_bf16 v[252:255], v[168:171], v[140:143], 0
    ds_read_b128 v[16:19], v245 offset:0
    s_waitcnt lgkmcnt(9)
    v_mfma_f32_16x16x32_bf16 v[236:239], v[172:175], v[144:147], v[236:239]
    ds_read_b128 v[20:23], v245 offset:512
    s_waitcnt lgkmcnt(9)
    v_mfma_f32_16x16x32_bf16 v[252:255], v[172:175], v[148:151], v[252:255]
    ds_read_b128 v[188:191], v193 offset:1024
    s_waitcnt lgkmcnt(8)
    v_mfma_f32_16x16x32_bf16 v[236:239], v[176:179], v[152:155], v[236:239]
    ds_read_b128 v[24:27], v245 offset:1024
    s_waitcnt lgkmcnt(8)
    v_mfma_f32_16x16x32_bf16 v[252:255], v[176:179], v[156:159], v[252:255]
    ds_read_b128 v[28:31], v245 offset:1536
    s_waitcnt lgkmcnt(7)
    v_mfma_f32_16x16x32_bf16 v[236:239], v[180:183], v[160:163], v[236:239]
    s_waitcnt lgkmcnt(6)
    v_mfma_f32_16x16x32_bf16 v[252:255], v[180:183], v[164:167], v[252:255]
    s_waitcnt lgkmcnt(4)
    v_mfma_f32_16x16x32_bf16 v[236:239], v[184:187], v[16:19], v[236:239]
    s_waitcnt lgkmcnt(3)
    v_mfma_f32_16x16x32_bf16 v[252:255], v[184:187], v[20:23], v[252:255]
    s_waitcnt lgkmcnt(1)
    v_mfma_f32_16x16x32_bf16 v[236:239], v[188:191], v[24:27], v[236:239]
    s_waitcnt lgkmcnt(0)
    v_mfma_f32_16x16x32_bf16 v[252:255], v[188:191], v[28:31], v[252:255]
    s_nop 3
    v_cvt_pk_bf16_f32 v232, v236, v237
    v_cvt_pk_bf16_f32 v233, v238, v239
    s_nop 1
    v_cvt_pk_bf16_f32 v234, v252, v253
    v_cvt_pk_bf16_f32 v235, v254, v255
    buffer_store_dwordx2 v[232:233], v12, s[8:11], s34 offen offset:0 sc1
    buffer_store_dwordx2 v[234:235], v223, s[8:11], s34 offen offset:0 sc1
    s_add_u32 s34, s34, 524288
    s_and_b32 s6, s34, 1572864
    s_cselect_b32 s6, 0, 8192
    s_xor_b32 s34, s34, s6
    v_mov_b32 v10, 63
    s_mov_b64 exec, 1
    buffer_store_dword v10, v9, s[8:11], s33 offen sc1
    s_mov_b64 exec, -1
    s_branch R_done
Cs_fw:
    s_mov_b32 s31, 0
Csfx_l:
    buffer_load_dword v250, v248, s[8:11], s22 offen sc1
    s_waitcnt vmcnt(0)
Csfx_c:
    v_cmp_gt_u32 vcc, s47, v250
    s_cbranch_vccz Csfx_o
    s_sleep 1
    s_add_u32 s31, s31, 1
    s_cmp_lt_u32 s31, s30
    s_cbranch_scc1 Csfx_l
    s_mov_b32 s30, 1
Csfx_o:
    s_branch Cs_fo
Cs_gw:
    s_mov_b32 s31, 0
Csfv_l:
    buffer_load_dword v250, v247, s[8:11], s22 offen sc1
    s_waitcnt vmcnt(0)
Csfv_c:
    v_cmp_gt_u32 vcc, s46, v250
    s_cbranch_vccz Csfv_o
    s_sleep 1
    s_add_u32 s31, s31, 1
    s_cmp_lt_u32 s31, s30
    s_cbranch_scc1 Csfv_l
    s_mov_b32 s30, 1
Csfv_o:
    s_branch Cs_go2
Cs_v1:
    s_mov_b32 s31, 0
Csv3_l:
    buffer_load_dword v250, v247, s[8:11], s22 offen sc1
    s_waitcnt vmcnt(0)
Csv3_c:
    v_cmp_gt_u32 vcc, 2, v250
    s_cbranch_vccz Csv3_o
    s_sleep 1
    s_add_u32 s31, s31, 1
    s_cmp_lt_u32 s31, s30
    s_cbranch_scc1 Csv3_l
    s_mov_b32 s30, 1
Csv3_o:
    s_add_u32 s4, 2, 3
    s_and_b32 s4, s4, 3
    s_mul_i32 s4, s4, 49152
    s_add_u32 s40, s4, s27
    s_add_u32 s41, s40, 4096
    s_add_u32 s42, s40, 8192
    buffer_load_dwordx4 v[48:51], v2, s[8:11], s40 offen offset:0 sc1
    buffer_load_dwordx4 v[52:55], v2, s[8:11], s40 offen offset:1024 sc1
    buffer_load_dwordx4 v[56:59], v2, s[8:11], s40 offen offset:2048 sc1
    buffer_load_dwordx4 v[60:63], v2, s[8:11], s40 offen offset:3072 sc1
    buffer_load_dwordx4 v[64:67], v2, s[8:11], s41 offen offset:0 sc1
    buffer_load_dwordx4 v[68:71], v2, s[8:11], s41 offen offset:1024 sc1
    buffer_load_dwordx4 v[72:75], v2, s[8:11], s41 offen offset:2048 sc1
    buffer_load_dwordx4 v[76:79], v2, s[8:11], s41 offen offset:3072 sc1
    buffer_load_dwordx4 v[80:83], v2, s[8:11], s42 offen offset:0 sc1
    buffer_load_dwordx4 v[84:87], v2, s[8:11], s42 offen offset:1024 sc1
    buffer_load_dwordx4 v[88:91], v2, s[8:11], s42 offen offset:2048 sc1
    buffer_load_dwordx4 v[92:95], v2, s[8:11], s42 offen offset:3072 sc1
    s_add_u32 s4, s46, 3
    s_and_b32 s4, s4, 3
    s_mul_i32 s4, s4, 49152
    s_add_u32 s40, s4, s27
    s_add_u32 s41, s40, 4096
    s_add_u32 s42, s40, 8192
    s_waitcnt vmcnt(0)
    s_branch Cs_v1r
Csm_s:
    s_mov_b32 s31, 0
Csm_l:
    buffer_load_dwordx4 v[16:19], v2, s[8:11], s38 offen offset:0 sc1
    buffer_load_dwordx4 v[20:23], v2, s[8:11], s38 offen offset:1024 sc1
    buffer_load_dwordx4 v[24:27], v2, s[8:11], s38 offen offset:2048 sc1
    s_nop 7
    v_mov_b32 v96, 0
    v_mov_b32 v97, 0
    v_mov_b32 v98, 0
    v_mov_b32 v99, 0
    v_mov_b32 v100, 0
    v_mov_b32 v101, 0
    v_mov_b32 v102, 0
    v_mov_b32 v103, 0
    v_mov_b32 v104, 0
    v_mov_b32 v105, 0
    v_mov_b32 v106, 0
    v_mov_b32 v107, 0
    v_mov_b32 v108, 0
    v_mov_b32 v109, 0
    v_mov_b32 v110, 0
    v_mov_b32 v111, 0
    s_waitcnt vmcnt(0)
    v_max3_u32 v251, v16, v18, v20
    v_max3_u32 v251, v251, v22, v24
    v_max_u32 v251, v251, v26
    v_cmp_eq_u32 vcc, -1, v251
    s_cbranch_vccz Csm_b
    s_add_u32 s31, s31, 1
    s_cmp_lt_u32 s31, s30
    s_cbranch_scc1 Csm_l
    s_mov_b32 s30, 1
    v_min_u32 v16, s48, v16
    v_min_u32 v18, s48, v18
    v_min_u32 v20, s48, v20
    v_min_u32 v22, s48, v22
    v_min_u32 v24, s48, v24
    v_min_u32 v26, s48, v26
    s_branch Csm_b
Csg_s:
    s_mov_b32 s31, 0
Csg_l:
    s_load_dword s84, s[8:9], s37 glc
    s_load_dword s85, s[8:9], s43 glc
    s_or_b64 s[6:7], s[84:85], s[94:95]
    s_min_u32 s6, s6, s7
    s_cmp_ge_u32 s6, s21
    s_cbranch_scc1 Csg_o
    s_or_b64 s[6:7], s[84:85], s[94:95]
    s_min_u32 s6, s6, s7
    s_cmp_ge_u32 s6, s21
    s_cbranch_scc1 Csg_o
    s_or_b64 s[6:7], s[84:85], s[94:95]
    s_min_u32 s6, s6, s7
    s_cmp_ge_u32 s6, s21
    s_cbranch_scc1 Csg_o
    s_or_b64 s[6:7], s[84:85], s[94:95]
    s_min_u32 s6, s6, s7
    s_cmp_ge_u32 s6, s21
    s_cbranch_scc1 Csg_o
    s_or_b64 s[6:7], s[84:85], s[94:95]
    s_min_u32 s6, s6, s7
    s_cmp_ge_u32 s6, s21
    s_cbranch_scc1 Csg_o
    s_or_b64 s[6:7], s[84:85], s[94:95]
    s_min_u32 s6, s6, s7
    s_cmp_ge_u32 s6, s21
    s_cbranch_scc1 Csg_o
    s_add_u32 s31, s31, 1
    s_cmp_lt_u32 s31, s30
    s_cbranch_scc1 Csg_l
    s_mov_b32 s30, 1
    s_branch Csg_o
Cs4_s:
    s_mov_b32 s31, 0
Cs4_l:
    buffer_load_dwordx4 v[204:207], v8, s[8:11], s35 offen offset:0 sc1
    buffer_load_dwordx4 v[208:211], v8, s[8:11], s35 offen offset:1024 sc1
    s_waitcnt vmcnt(0)
    v_mfma_f32_16x16x32_bf16 v[32:35], v[224:227], v[204:207], 0
    v_max3_u32 v36, v204, v206, v208
    v_mfma_f32_16x16x32_bf16 v[32:35], v[224:227], v[208:211], v[32:35]
    v_max_u32 v36, v36, v210
    v_cmp_eq_u32 vcc, -1, v36
    s_nop 7
    s_cbranch_vccz Cs4_o
    s_add_u32 s31, s31, 1
    s_cmp_lt_u32 s31, s30
    s_cbranch_scc1 Cs4_l
    s_mov_b32 s30, 1
    v_cvt_pk_bf16_f32 v38, v32, v33
    v_cvt_pk_bf16_f32 v39, v34, v35
    v_min_u32 v38, s48, v38
    v_min_u32 v39, s48, v39
    s_branch Cs4_z
Css_s:
    s_mov_b32 s31, 0
Css_l:
    buffer_load_dwordx4 v[28:31], v2, s[8:11], s39 offen offset:0 sc1
    buffer_load_dwordx4 v[32:35], v2, s[8:11], s39 offen offset:1024 sc1
    buffer_load_dwordx4 v[36:39], v2, s[8:11], s39 offen offset:2048 sc1
    buffer_load_dwordx3 v[40:42], v2, s[8:11], s39 offen offset:3072 sc1
    s_waitcnt vmcnt(0)
    v_max3_u32 v250, v28, v32, v36
    v_max3_u32 v250, v250, v40, v41
    v_max_u32 v250, v250, v42
    v_cmp_eq_u32 vcc, -1, v250
    s_cbranch_vccz Css_b
    s_add_u32 s31, s31, 1
    s_cmp_lt_u32 s31, s30
    s_cbranch_scc1 Css_l
    s_mov_b32 s30, 1
    v_min_u32 v28, s48, v28
    v_min_u32 v29, s48, v29
    v_min_u32 v30, s48, v30
    v_min_u32 v31, s48, v31
    v_min_u32 v32, s48, v32
    v_min_u32 v33, s48, v33
    v_min_u32 v34, s48, v34
    v_min_u32 v35, s48, v35
    v_min_u32 v36, s48, v36
    v_min_u32 v37, s48, v37
    v_min_u32 v38, s48, v38
    v_min_u32 v39, s48, v39
    v_min_u32 v40, s48, v40
    v_min_u32 v41, s48, v41
    v_min_u32 v42, s48, v42
    s_branch Css_b
R_x:
    s_load_dwordx2 s[12:13], s[0:1], 96
    s_load_dwordx2 s[16:17], s[0:1], 104
    s_load_dwordx2 s[84:85], s[0:1], 120
    s_load_dwordx2 s[88:89], s[0:1], 0
    s_mov_b32 s14, 1280
    s_mov_b32 s15, 0x20000
    s_mov_b32 s18, 4915200
    s_mov_b32 s19, 0x20000
    s_mov_b32 s86, 256
    s_mov_b32 s87, 0x20000
    s_mov_b32 s90, 2621440
    s_mov_b32 s91, 0x20000
    s_waitcnt lgkmcnt(0)
    v_lshlrev_b32 v2, 4, v1
    s_lshl_b32 s21, s99, 2
    s_add_u32 s21, s21, s20
    s_sub_u32 s21, s21, 28
    s_mul_i32 s4, s3, 5120
    s_add_u32 s23, s4, 81920
    s_mul_i32 s26, s21, 20480
    s_add_u32 s26, s26, s4
    v_lshlrev_b32 v4, 2, v1
    s_mul_i32 s4, s3, 320
    buffer_load_dword v244, v4, s[12:15], s4 offen
    buffer_load_dword v245, v4, s[12:15], s4 offen offset:256
    s_add_u32 s4, s26, 0
    s_add_u32 m0, s23, 0
    s_nop 0
    buffer_load_dwordx4 v2, s[88:91], s4 offen offset:0 nt lds
    buffer_load_dwordx4 v2, s[88:91], s4 offen offset:1024 nt lds
    buffer_load_dwordx4 v2, s[88:91], s4 offen offset:2048 nt lds
    buffer_load_dwordx4 v2, s[88:91], s4 offen offset:3072 nt lds
    s_add_u32 s4, s26, 4096
    s_add_u32 m0, s23, 4096
    s_nop 0
    buffer_load_dwordx4 v2, s[88:91], s4 offen offset:0 nt lds
    v_lshrrev_b32 v4, 3, v1
    v_and_b32 v5, 1, v4
    v_mul_u32_u24 v14, 7680, v4
    v_bfe_u32 v4, v1, 1, 2
    v_xor_b32 v4, v4, v5
    v_lshlrev_b32 v4, 5, v4
    v_and_b32 v5, 1, v1
    v_lshlrev_b32 v5, 4, v5
    v_add3_u32 v14, v14, v4, v5
    v_xor_b32 v15, 64, v14
    s_mul_i32 s22, s3, 20480
    v_lshrrev_b32 v4, 4, v1
    v_lshlrev_b32 v4, 2, v4
    v_bfe_u32 v5, v1, 2, 1
    v_add_u32 v4, v4, v5
    v_bfe_u32 v5, v1, 3, 1
    v_lshl_add_u32 v4, v5, 4, v4
    v_lshlrev_b32 v32, 7, v4
    v_bfe_u32 v4, v1, 2, 2
    v_lshlrev_b32 v4, 5, v4
    v_and_b32 v5, 3, v1
    v_lshlrev_b32 v5, 3, v5
    v_add3_u32 v32, v32, v4, v5
    v_add_u32 v32, s22, v32
    v_xor_b32 v33, 32, v32
    v_xor_b32 v34, 64, v32
    v_xor_b32 v35, 96, v32
    v_lshrrev_b32 v4, 5, v1
    v_lshlrev_b32 v36, 6, v4
    v_bfe_u32 v4, v1, 2, 2
    v_lshl_add_u32 v36, v4, 4, v36
    v_bfe_u32 v4, v1, 1, 1
    v_lshl_add_u32 v36, v4, 3, v36
    v_bfe_u32 v4, v1, 4, 1
    v_lshl_add_u32 v36, v4, 2, v36
    v_and_b32 v37, 0x30, v1
    v_add_u32 v37, s22, v37
    v_lshlrev_b32 v38, 2, v1
    v_and_b32 v4, 3, v1
    v_mul_u32_u24 v39, 1280, v4
    v_lshrrev_b32 v5, 4, v1
    v_lshl_add_u32 v39, v5, 6, v39
    v_bfe_u32 v5, v1, 2, 2
    v_lshl_add_u32 v39, v5, 3, v39
    v_add_u32 v39, s23, v39
    v_lshrrev_b32 v5, 2, v1
    v_lshlrev_b32 v3, 8, v5
    v_lshl_add_u32 v3, v4, 4, v3
    s_lshl_b32 s4, s3, 6
    s_add_u32 s4, s4, 81920
    v_add_u32 v3, s4, v3
    s_mul_i32 s27, s21, 20480
    s_mul_i32 s4, s3, 5120
    s_add_u32 s27, s27, s4
    s_add_u32 s27, s27, 16777216
    v_mov_b32 v134, 163776
    s_cmp_lg_u32 s3, 0
    s_cbranch_scc1 XC_c
    s_waitcnt vmcnt(7)
    v_readfirstlane_b32 s4, v135
    s_and_b32 s4, s4, s33
    s_nop 0
    v_mov_b32 v135, s4
    ds_write_b32 v134, v135
    s_waitcnt lgkmcnt(0)
XC_c:
    s_barrier
    ds_read_b32 v135, v134
    s_waitcnt lgkmcnt(0)
    v_readfirstlane_b32 s4, v135
    s_cmp_lg_u32 s4, 0
    s_cbranch_scc1 R_ovf
    s_mul_i32 s4, s99, 1048576
    s_lshl_b32 s33, s20, 4
    s_add_u32 s33, s33, s4
    s_lshl_b32 s4, s3, 2
    s_add_u32 s33, s33, s4
    s_add_u32 s33, s33, 8544256
    v_mov_b32 v4, 0
    s_mov_b64 exec, 1
    buffer_store_dword v4, v4, s[8:11], s33 offen sc1
    s_mov_b64 exec, -1
    s_lshl_b32 s4, s21, 7
    s_add_u32 s4, s4, 65536
    v_mov_b32 v16, 0
    v_lshlrev_b32 v17, 2, v1
    s_cmp_eq_u32 s3, 0
    s_cselect_b64 exec, 7, 0
    buffer_store_dword v16, v17, s[8:11], s4 offen sc1
    s_mov_b64 exec, -1
    s_mul_i32 s4, s99, 1048576
    s_add_u32 s4, s4, 8544768
    s_cmp_eq_u32 s20, 30
    s_cselect_b64 exec, 0xff, 0
    buffer_store_dword v16, v17, s[8:11], s4 offen sc1
    s_mov_b64 exec, -1
    s_lshl_b32 s4, s21, 2
    s_add_u32 s4, s4, 81920
    v_mov_b32 v16, 0
    v_lshlrev_b32 v17, 7, v1
    s_lshl_b32 s5, s3, 5
    s_add_u32 s5, s5, s21
    s_cmp_lt_u32 s5, 4
    s_cselect_b64 exec, 0xff, 0
    buffer_store_dword v16, v17, s[8:11], s4 offen sc1
    s_mov_b64 exec, -1
    s_waitcnt vmcnt(0)
    s_barrier
    s_cmp_lg_u32 s3, 0
    s_cbranch_scc1 XA_n
    s_lshl_b32 s4, s99, 5
    s_add_u32 s4, s4, 4
    v_mov_b32 v16, 0
    v_mov_b32 v17, 1
    s_mov_b64 exec, 1
    buffer_atomic_add v17, v16, s[84:87], s4 offen sc1
    s_mov_b64 exec, -1
XA_n:
    s_cmp_lt_u32 s21, 20
    s_cbranch_scc1 XD_nv
    s_lshr_b32 s6, s21, 2
    s_lshl_b32 s6, s6, 14
    s_and_b32 s5, s21, 3
    s_lshl_b32 s5, s5, 11
    s_add_u32 s6, s6, s5
    s_lshl_b32 s5, s3, 9
    s_add_u32 s40, s5, s6
    s_add_u32 s40, s40, 2670592
    s_add_u32 s41, s40, 384
    s_load_dword s36, s[8:9], s41
    s_mov_b32 s38, -1
    s_mov_b32 s39, -1
    s_waitcnt lgkmcnt(0)
    s_add_u32 s41, s40, 0
    s_memtime s[4:5]
    s_waitcnt lgkmcnt(0)
    s_load_dword s36, s[8:9], s41
    s_waitcnt lgkmcnt(0)
    s_memtime s[6:7]
    s_waitcnt lgkmcnt(0)
    s_sub_u32 s4, s6, s4
    s_min_u32 s38, s38, s4
    s_add_u32 s41, s40, 8192
    s_memtime s[4:5]
    s_waitcnt lgkmcnt(0)
    s_load_dword s36, s[8:9], s41
    s_waitcnt lgkmcnt(0)
    s_memtime s[6:7]
    s_waitcnt lgkmcnt(0)
    s_sub_u32 s4, s6, s4
    s_min_u32 s39, s39, s4
    s_add_u32 s41, s40, 128
    s_memtime s[4:5]
    s_waitcnt lgkmcnt(0)
    s_load_dword s36, s[8:9], s41
    s_waitcnt lgkmcnt(0)
    s_memtime s[6:7]
    s_waitcnt lgkmcnt(0)
    s_sub_u32 s4, s6, s4
    s_min_u32 s38, s38, s4
    s_add_u32 s41, s40, 8320
    s_memtime s[4:5]
    s_waitcnt lgkmcnt(0)
    s_load_dword s36, s[8:9], s41
    s_waitcnt lgkmcnt(0)
    s_memtime s[6:7]
    s_waitcnt lgkmcnt(0)
    s_sub_u32 s4, s6, s4
    s_min_u32 s39, s39, s4
    s_cmp_lt_u32 s39, s38
    s_cselect_b32 s4, 0, 0x10000
    s_lshl_b32 s5, s3, 2
    s_add_u32 s5, s5, 163792
    v_mov_b32 v4, s5
    v_mov_b32 v5, s4
    ds_write_b32 v4, v5
    s_waitcnt lgkmcnt(0)
    s_barrier
    v_mov_b32 v4, 163792
    ds_read_b128 v[16:19], v4
    s_waitcnt lgkmcnt(0)
    v_add3_u32 v16, v16, v17, v18
    v_add3_u32 v16, v16, v19, 1
    s_nop 0
    v_readfirstlane_b32 s36, v16
    s_lshl_b32 s4, s21, 7
    s_add_u32 s4, s4, 65544
    v_mov_b32 v16, s36
    v_lshlrev_b32 v17, 2, v1
    s_cmp_eq_u32 s3, 0
    s_cselect_b64 exec, 1, 0
    buffer_store_dword v16, v17, s[8:11], s4 offen sc1
    s_mov_b64 exec, -1
XD_nv:
    v_lshrrev_b32 v10, 4, v1
    v_lshlrev_b32 v10, 6, v10
    v_bfe_u32 v11, v1, 1, 2
    v_lshl_add_u32 v10, v11, 4, v10
    v_and_b32 v11, 1, v1
    v_lshl_add_u32 v10, v11, 3, v10
    v_bfe_u32 v11, v1, 3, 1
    v_lshl_add_u32 v10, v11, 2, v10
    v_add_u32 v10, s23, v10
    v_lshlrev_b32 v6, 16, v244
    v_and_b32 v7, 0xffff0000, v244
    v_lshlrev_b32 v8, 16, v245
    v_and_b32 v9, 0xffff0000, v245
    v_mul_f32 v16, 0xbfb8aa3b, v6
    v_mul_f32 v17, 0xbfb8aa3b, v7
    v_mul_f32 v18, 0xbfb8aa3b, v8
    v_mul_f32 v19, 0xbfb8aa3b, v9
    v_exp_f32 v16, v16
    v_exp_f32 v17, v17
    v_exp_f32 v18, v18
    v_exp_f32 v19, v19
    v_add_f32 v16, 1.0, v16
    v_add_f32 v17, 1.0, v17
    v_add_f32 v18, 1.0, v18
    v_add_f32 v19, 1.0, v19
    v_rcp_f32 v16, v16
    v_rcp_f32 v17, v17
    v_rcp_f32 v18, v18
    v_rcp_f32 v19, v19
    v_mul_f32 v6, v6, v16
    v_mul_f32 v7, v7, v17
    v_mul_f32 v8, v8, v18
    v_mul_f32 v9, v9, v19
    v_cvt_pk_bf16_f32 v4, v6, v7
    v_cvt_pk_bf16_f32 v5, v8, v9
    v_and_b32 v11, 0x30, v1
    v_add_u32 v11, s23, v11
    v_add_u32 v12, 0, v39
    s_call_b64 s[100:101], XN_sub
    v_cvt_pk_bf16_f32 v180, v60, v61
    v_cvt_pk_bf16_f32 v181, v62, v63
    v_cvt_pk_bf16_f32 v182, v64, v65
    v_cvt_pk_bf16_f32 v183, v66, v67
    v_cvt_pk_bf16_f32 v184, v68, v69
    v_cvt_pk_bf16_f32 v185, v70, v71
    v_cvt_pk_bf16_f32 v186, v72, v73
    v_cvt_pk_bf16_f32 v187, v74, v75
    v_cvt_pk_bf16_f32 v188, v76, v77
    v_cvt_pk_bf16_f32 v189, v78, v79
    v_cvt_pk_bf16_f32 v190, v80, v81
    v_cvt_pk_bf16_f32 v191, v82, v83
    v_cvt_pk_bf16_f32 v192, v84, v85
    v_cvt_pk_bf16_f32 v193, v86, v87
    v_cvt_pk_bf16_f32 v194, v88, v89
    v_cvt_pk_bf16_f32 v195, v90, v91
    v_cvt_pk_bf16_f32 v196, v92, v93
    v_cvt_pk_bf16_f32 v197, v94, v95
    v_cvt_pk_bf16_f32 v198, v96, v97
    v_cvt_pk_bf16_f32 v199, v98, v99
    ds_write_b32 v10, v4
    ds_write_b32 v10, v5 offset:256
    s_waitcnt lgkmcnt(0)
    ds_read_b128 v[220:223], v11 offset:0
    ds_read_b128 v[224:227], v11 offset:64
    ds_read_b128 v[228:231], v11 offset:128
    ds_read_b128 v[232:235], v11 offset:192
    ds_read_b128 v[236:239], v11 offset:256
    s_waitcnt lgkmcnt(0)
    s_cmp_lt_u32 s21, 4
    s_cbranch_scc1 XD_e
    s_cmp_lt_u32 s21, 8
    s_cbranch_scc1 XD_f
    s_add_u32 s21, s21, 12
    s_mul_i32 s4, s3, 1228800
    s_lshl_b32 s5, s21, 7
    s_add_u32 s4, s4, s5
    s_add_u32 m0, s22, 0
    s_nop 0
    buffer_load_dwordx4 v14, s[16:19], s4 offen nt lds
    s_add_u32 s4, s4, 61440
    s_add_u32 m0, s22, 1024
    s_nop 0
    buffer_load_dwordx4 v14, s[16:19], s4 offen nt lds
    s_add_u32 s4, s4, 61440
    s_add_u32 m0, s22, 2048
    s_nop 0
    buffer_load_dwordx4 v15, s[16:19], s4 offen nt lds
    s_add_u32 s4, s4, 61440
    s_add_u32 m0, s22, 3072
    s_nop 0
    buffer_load_dwordx4 v15, s[16:19], s4 offen nt lds
    s_add_u32 s4, s4, 61440
    s_add_u32 m0, s22, 4096
    s_nop 0
    buffer_load_dwordx4 v14, s[16:19], s4 offen nt lds
    s_add_u32 s4, s4, 61440
    s_add_u32 m0, s22, 5120
    s_nop 0
    buffer_load_dwordx4 v14, s[16:19], s4 offen nt lds
    s_add_u32 s4, s4, 61440
    s_add_u32 m0, s22, 6144
    s_nop 0
    buffer_load_dwordx4 v15, s[16:19], s4 offen nt lds
    s_add_u32 s4, s4, 61440
    s_add_u32 m0, s22, 7168
    s_nop 0
    buffer_load_dwordx4 v15, s[16:19], s4 offen nt lds
    s_add_u32 s4, s4, 61440
    s_add_u32 m0, s22, 8192
    s_nop 0
    buffer_load_dwordx4 v14, s[16:19], s4 offen nt lds
    s_add_u32 s4, s4, 61440
    s_add_u32 m0, s22, 9216
    s_nop 0
    buffer_load_dwordx4 v14, s[16:19], s4 offen nt lds
    s_add_u32 s4, s4, 61440
    s_add_u32 m0, s22, 10240
    s_nop 0
    buffer_load_dwordx4 v15, s[16:19], s4 offen nt lds
    s_add_u32 s4, s4, 61440
    s_add_u32 m0, s22, 11264
    s_nop 0
    buffer_load_dwordx4 v15, s[16:19], s4 offen nt lds
    s_add_u32 s4, s4, 61440
    s_add_u32 m0, s22, 12288
    s_nop 0
    buffer_load_dwordx4 v14, s[16:19], s4 offen nt lds
    s_add_u32 s4, s4, 61440
    s_add_u32 m0, s22, 13312
    s_nop 0
    buffer_load_dwordx4 v14, s[16:19], s4 offen nt lds
    s_add_u32 s4, s4, 61440
    s_add_u32 m0, s22, 14336
    s_nop 0
    buffer_load_dwordx4 v15, s[16:19], s4 offen nt lds
    s_add_u32 s4, s4, 61440
    s_add_u32 m0, s22, 15360
    s_nop 0
    buffer_load_dwordx4 v15, s[16:19], s4 offen nt lds
    s_add_u32 s4, s4, 61440
    s_add_u32 m0, s22, 16384
    s_nop 0
    buffer_load_dwordx4 v14, s[16:19], s4 offen nt lds
    s_add_u32 s4, s4, 61440
    s_add_u32 m0, s22, 17408
    s_nop 0
    buffer_load_dwordx4 v14, s[16:19], s4 offen nt lds
    s_add_u32 s4, s4, 61440
    s_add_u32 m0, s22, 18432
    s_nop 0
    buffer_load_dwordx4 v15, s[16:19], s4 offen nt lds
    s_add_u32 s4, s4, 61440
    s_add_u32 m0, s22, 19456
    s_nop 0
    buffer_load_dwordx4 v15, s[16:19], s4 offen nt lds
    s_add_u32 s4, s4, 61440
    v_and_b32 v16, 7, v1
    v_lshlrev_b32 v16, 5, v16
    buffer_load_dwordx4 v[20:23], v16, s[84:87], 0 offen sc1
    s_mov_b32 s31, 0
    s_waitcnt vmcnt(0)
    s_branch XI_c
XI_l:
    buffer_load_dwordx4 v[20:23], v16, s[84:87], 0 offen sc1
    s_waitcnt vmcnt(0)
XI_c:
    v_bcnt_u32_b32 v17, v20, v23
    v_cmp_lt_u32 s[4:5], 32, v17
    s_and_b32 s6, s4, 0xff
    v_cmp_ne_u32 s[4:5], 32, v17
    s_cmp_eq_u32 s6, 0
    s_cselect_b32 s5, 0xff, 0
    s_and_b32 s4, s4, s5
    v_add_u32 v21, v21, v22
    v_cmp_gt_u32 vcc, 32, v21
    s_and_b32 vcc_lo, vcc_lo, 0xff
    s_or_b32 vcc_lo, vcc_lo, s4
    s_mov_b32 vcc_hi, 0
    s_cbranch_vccz XI_o
    s_sleep 16
    s_add_u32 s31, s31, 1
    s_cmp_lt_u32 s31, s30
    s_cbranch_scc1 XI_l
    s_mov_b32 s30, 1
XI_o:
    s_mov_b32 s97, s6
    ds_read_b64_tr_b16 a[0:1], v32 offset:0
    ds_read_b64_tr_b16 a[2:3], v32 offset:256
    ds_read_b64_tr_b16 a[4:5], v33 offset:0
    ds_read_b64_tr_b16 a[6:7], v33 offset:256
    ds_read_b64_tr_b16 a[8:9], v34 offset:0
    ds_read_b64_tr_b16 a[10:11], v34 offset:256
    ds_read_b64_tr_b16 a[12:13], v35 offset:0
    ds_read_b64_tr_b16 a[14:15], v35 offset:256
    ds_read_b64_tr_b16 a[16:17], v32 offset:4096
    ds_read_b64_tr_b16 a[18:19], v32 offset:4352
    ds_read_b64_tr_b16 a[20:21], v33 offset:4096
    ds_read_b64_tr_b16 a[22:23], v33 offset:4352
    ds_read_b64_tr_b16 a[24:25], v34 offset:4096
    ds_read_b64_tr_b16 a[26:27], v34 offset:4352
    s_waitcnt lgkmcnt(12)
    v_mfma_f32_16x16x32_bf16 v[16:19], a[0:3], v[220:223], 0
    ds_read_b64_tr_b16 a[28:29], v35 offset:4096
    ds_read_b64_tr_b16 a[30:31], v35 offset:4352
    s_waitcnt lgkmcnt(12)
    v_mfma_f32_16x16x32_bf16 v[20:23], a[4:7], v[220:223], 0
    ds_read_b64_tr_b16 a[32:33], v32 offset:8192
    ds_read_b64_tr_b16 a[34:35], v32 offset:8448
    s_waitcnt lgkmcnt(12)
    v_mfma_f32_16x16x32_bf16 v[24:27], a[8:11], v[220:223], 0
    ds_read_b64_tr_b16 a[36:37], v33 offset:8192
    ds_read_b64_tr_b16 a[38:39], v33 offset:8448
    s_waitcnt lgkmcnt(12)
    v_mfma_f32_16x16x32_bf16 v[28:31], a[12:15], v[220:223], 0
    ds_read_b64_tr_b16 a[40:41], v34 offset:8192
    ds_read_b64_tr_b16 a[42:43], v34 offset:8448
    s_waitcnt lgkmcnt(12)
    v_mfma_f32_16x16x32_bf16 v[16:19], a[16:19], v[224:227], v[16:19]
    ds_read_b64_tr_b16 a[44:45], v35 offset:8192
    ds_read_b64_tr_b16 a[46:47], v35 offset:8448
    s_waitcnt lgkmcnt(12)
    v_mfma_f32_16x16x32_bf16 v[20:23], a[20:23], v[224:227], v[20:23]
    ds_read_b64_tr_b16 a[48:49], v32 offset:12288
    ds_read_b64_tr_b16 a[50:51], v32 offset:12544
    s_waitcnt lgkmcnt(12)
    v_mfma_f32_16x16x32_bf16 v[24:27], a[24:27], v[224:227], v[24:27]
    ds_read_b64_tr_b16 a[52:53], v33 offset:12288
    ds_read_b64_tr_b16 a[54:55], v33 offset:12544
    s_waitcnt lgkmcnt(12)
    v_mfma_f32_16x16x32_bf16 v[28:31], a[28:31], v[224:227], v[28:31]
    ds_read_b64_tr_b16 a[56:57], v34 offset:12288
    ds_read_b64_tr_b16 a[58:59], v34 offset:12544
    s_waitcnt lgkmcnt(12)
    v_mfma_f32_16x16x32_bf16 v[16:19], a[32:35], v[228:231], v[16:19]
    ds_read_b64_tr_b16 a[60:61], v35 offset:12288
    ds_read_b64_tr_b16 a[62:63], v35 offset:12544
    s_waitcnt lgkmcnt(12)
    v_mfma_f32_16x16x32_bf16 v[20:23], a[36:39], v[228:231], v[20:23]
    ds_read_b64_tr_b16 a[64:65], v32 offset:16384
    ds_read_b64_tr_b16 a[66:67], v32 offset:16640
    s_waitcnt lgkmcnt(12)
    v_mfma_f32_16x16x32_bf16 v[24:27], a[40:43], v[228:231], v[24:27]
    ds_read_b64_tr_b16 a[68:69], v33 offset:16384
    ds_read_b64_tr_b16 a[70:71], v33 offset:16640
    s_waitcnt lgkmcnt(12)
    v_mfma_f32_16x16x32_bf16 v[28:31], a[44:47], v[228:231], v[28:31]
    ds_read_b64_tr_b16 a[72:73], v34 offset:16384
    ds_read_b64_tr_b16 a[74:75], v34 offset:16640
    s_waitcnt lgkmcnt(12)
    v_mfma_f32_16x16x32_bf16 v[16:19], a[48:51], v[232:235], v[16:19]
    ds_read_b64_tr_b16 a[76:77], v35 offset:16384
    ds_read_b64_tr_b16 a[78:79], v35 offset:16640
    s_waitcnt lgkmcnt(12)
    v_mfma_f32_16x16x32_bf16 v[20:23], a[52:55], v[232:235], v[20:23]
    s_waitcnt lgkmcnt(10)
    v_mfma_f32_16x16x32_bf16 v[24:27], a[56:59], v[232:235], v[24:27]
    s_waitcnt lgkmcnt(8)
    v_mfma_f32_16x16x32_bf16 v[28:31], a[60:63], v[232:235], v[28:31]
    s_waitcnt lgkmcnt(6)
    v_mfma_f32_16x16x32_bf16 v[16:19], a[64:67], v[236:239], v[16:19]
    s_waitcnt lgkmcnt(4)
    v_mfma_f32_16x16x32_bf16 v[20:23], a[68:71], v[236:239], v[20:23]
    s_waitcnt lgkmcnt(2)
    v_mfma_f32_16x16x32_bf16 v[24:27], a[72:75], v[236:239], v[24:27]
    s_waitcnt lgkmcnt(0)
    v_mfma_f32_16x16x32_bf16 v[28:31], a[76:79], v[236:239], v[28:31]
    s_mov_b32 exec_lo, 0x00010001
    s_mov_b32 exec_hi, 0x00010001
    ds_write_b128 v37, v[16:19] offset:0
    ds_write_b128 v37, v[20:23] offset:64
    ds_write_b128 v37, v[24:27] offset:128
    s_nop 2
    ds_write_b128 v37, v[28:31] offset:192
    s_mov_b64 exec, -1
    s_waitcnt lgkmcnt(0)
    s_barrier
    s_cmp_lg_u32 s3, 0
    s_cbranch_scc1 XD_r1
    ds_read_b32 v16, v38 offset:0
    ds_read_b32 v17, v38 offset:20480
    ds_read_b32 v18, v38 offset:40960
    ds_read_b32 v19, v38 offset:61440
    s_lshl_b32 s4, s21, 8
    s_add_u32 s4, s4, 0
    s_lshl_b32 s5, s21, 7
    s_add_u32 s5, s5, 32768
    s_mov_b32 s6, 0x55555555
    s_cmp_ge_u32 s21, 10
    s_cselect_b32 s7, 1.0, 0
    s_waitcnt lgkmcnt(0)
    v_add_f32 v16, v16, v17
    v_add_f32 v18, v18, v19
    v_add_f32 v16, v16, v18
    v_cvt_pk_bf16_f32 v16, v16, v16
    v_and_b32 v16, 0xffff0000, v16
    v_add_f32 v18, s7, v16
    s_nop 1
    v_mov_b32 v17, v18 quad_perm:[1,1,3,3] row_mask:0xf bank_mask:0xf
    v_cvt_pk_bf16_f32 v17, v18, v17
    s_mov_b32 exec_lo, s6
    s_mov_b32 exec_hi, s6
    buffer_store_dword v17, v36, s[8:11], s5 offen sc1
    s_mov_b64 exec, -1
    buffer_store_dword v16, v38, s[8:11], s4 offen sc1
XD_r1:
    s_sub_u32 s21, s21, 12
    s_branch XD_g
XD_e:
    s_branch XD_e2
XD_f:
    s_sleep 48
XD_e2:
    s_mov_b32 s29, s51
    s_lshl_b32 s4, s3, 6
    s_mov_b32 s31, 0
XW_l:
    s_load_dwordx16 s[36:51], s[84:85], s4 glc
    s_waitcnt lgkmcnt(0)
    s_min_u32 s6, s38, s46
    s_cmp_ge_u32 s6, 10
    s_cbranch_scc1 XW_o
    s_sleep 2
    s_add_u32 s31, s31, 1
    s_cmp_lt_u32 s31, s30
    s_cbranch_scc1 XW_l
    s_mov_b32 s30, 1
XW_o:
    s_mov_b32 s51, s29
XD_g:
    s_barrier
    v_lshrrev_b32 v10, 2, v1
    v_lshlrev_b32 v10, 4, v10
    s_mov_b64 s[24:25], -1
    s_mov_b32 s5, 32768
    buffer_load_dwordx4 v[160:163], v10, s[8:11], s5 offen offset:0 sc1
    buffer_load_dwordx4 v[164:167], v10, s[8:11], s5 offen offset:256 sc1
    buffer_load_dwordx4 v[168:171], v10, s[8:11], s5 offen offset:512 sc1
    buffer_load_dwordx4 v[172:175], v10, s[8:11], s5 offen offset:768 sc1
    buffer_load_dwordx4 v[176:179], v10, s[8:11], s5 offen offset:1024 sc1
    buffer_load_dwordx4 v[120:123], v10, s[8:11], s5 offen offset:1280 sc1
    buffer_load_dwordx4 v[124:127], v10, s[8:11], s5 offen offset:1536 sc1
    buffer_load_dwordx4 v[128:131], v10, s[8:11], s5 offen offset:1792 sc1
    buffer_load_dwordx4 v[132:135], v10, s[8:11], s5 offen offset:2048 sc1
    buffer_load_dwordx4 v[136:139], v10, s[8:11], s5 offen offset:2304 sc1
    s_waitcnt vmcnt(0)
    v_lshlrev_b32 v100, 16, v120
    v_and_b32 v101, 0xffff0000, v120
    v_lshlrev_b32 v102, 16, v121
    v_and_b32 v103, 0xffff0000, v121
    v_lshlrev_b32 v104, 16, v122
    v_and_b32 v105, 0xffff0000, v122
    v_lshlrev_b32 v106, 16, v123
    v_and_b32 v107, 0xffff0000, v123
    v_lshlrev_b32 v108, 16, v124
    v_and_b32 v109, 0xffff0000, v124
    v_lshlrev_b32 v110, 16, v125
    v_and_b32 v111, 0xffff0000, v125
    v_lshlrev_b32 v112, 16, v126
    v_and_b32 v113, 0xffff0000, v126
    v_lshlrev_b32 v114, 16, v127
    v_and_b32 v115, 0xffff0000, v127
    v_lshlrev_b32 v116, 16, v128
    v_and_b32 v117, 0xffff0000, v128
    v_lshlrev_b32 v118, 16, v129
    v_and_b32 v119, 0xffff0000, v129
    v_lshlrev_b32 v120, 16, v130
    v_and_b32 v121, 0xffff0000, v130
    v_lshlrev_b32 v122, 16, v131
    v_and_b32 v123, 0xffff0000, v131
    v_lshlrev_b32 v124, 16, v132
    v_and_b32 v125, 0xffff0000, v132
    v_lshlrev_b32 v126, 16, v133
    v_and_b32 v127, 0xffff0000, v133
    v_lshlrev_b32 v128, 16, v134
    v_and_b32 v129, 0xffff0000, v134
    v_lshlrev_b32 v130, 16, v135
    v_and_b32 v131, 0xffff0000, v135
    v_lshlrev_b32 v132, 16, v136
    v_and_b32 v133, 0xffff0000, v136
    v_lshlrev_b32 v134, 16, v137
    v_and_b32 v135, 0xffff0000, v137
    v_lshlrev_b32 v136, 16, v138
    v_and_b32 v137, 0xffff0000, v138
    v_lshlrev_b32 v138, 16, v139
    v_and_b32 v139, 0xffff0000, v139
    v_lshlrev_b32 v140, 16, v160
    v_and_b32 v141, 0xffff0000, v160
    v_lshlrev_b32 v142, 16, v161
    v_and_b32 v143, 0xffff0000, v161
    v_lshlrev_b32 v144, 16, v162
    v_and_b32 v145, 0xffff0000, v162
    v_lshlrev_b32 v146, 16, v163
    v_and_b32 v147, 0xffff0000, v163
    v_lshlrev_b32 v148, 16, v164
    v_and_b32 v149, 0xffff0000, v164
    v_lshlrev_b32 v150, 16, v165
    v_and_b32 v151, 0xffff0000, v165
    v_lshlrev_b32 v152, 16, v166
    v_and_b32 v153, 0xffff0000, v166
    v_lshlrev_b32 v154, 16, v167
    v_and_b32 v155, 0xffff0000, v167
    v_lshlrev_b32 v156, 16, v168
    v_and_b32 v157, 0xffff0000, v168
    v_lshlrev_b32 v158, 16, v169
    v_and_b32 v159, 0xffff0000, v169
    v_lshlrev_b32 v160, 16, v170
    v_and_b32 v161, 0xffff0000, v170
    v_lshlrev_b32 v162, 16, v171
    v_and_b32 v163, 0xffff0000, v171
    v_lshlrev_b32 v164, 16, v172
    v_and_b32 v165, 0xffff0000, v172
    v_lshlrev_b32 v166, 16, v173
    v_and_b32 v167, 0xffff0000, v173
    v_lshlrev_b32 v168, 16, v174
    v_and_b32 v169, 0xffff0000, v174
    v_lshlrev_b32 v170, 16, v175
    v_and_b32 v171, 0xffff0000, v175
    v_lshlrev_b32 v172, 16, v176
    v_and_b32 v173, 0xffff0000, v176
    v_lshlrev_b32 v174, 16, v177
    v_and_b32 v175, 0xffff0000, v177
    v_lshlrev_b32 v176, 16, v178
    v_and_b32 v177, 0xffff0000, v178
    v_lshlrev_b32 v178, 16, v179
    v_and_b32 v179, 0xffff0000, v179
    v_lshlrev_b32 v60, 16, v180
    v_and_b32 v61, 0xffff0000, v180
    v_lshlrev_b32 v62, 16, v181
    v_and_b32 v63, 0xffff0000, v181
    v_lshlrev_b32 v64, 16, v182
    v_and_b32 v65, 0xffff0000, v182
    v_lshlrev_b32 v66, 16, v183
    v_and_b32 v67, 0xffff0000, v183
    v_lshlrev_b32 v68, 16, v184
    v_and_b32 v69, 0xffff0000, v184
    v_lshlrev_b32 v70, 16, v185
    v_and_b32 v71, 0xffff0000, v185
    v_lshlrev_b32 v72, 16, v186
    v_and_b32 v73, 0xffff0000, v186
    v_lshlrev_b32 v74, 16, v187
    v_and_b32 v75, 0xffff0000, v187
    v_lshlrev_b32 v76, 16, v188
    v_and_b32 v77, 0xffff0000, v188
    v_lshlrev_b32 v78, 16, v189
    v_and_b32 v79, 0xffff0000, v189
    v_lshlrev_b32 v80, 16, v190
    v_and_b32 v81, 0xffff0000, v190
    v_lshlrev_b32 v82, 16, v191
    v_and_b32 v83, 0xffff0000, v191
    v_lshlrev_b32 v84, 16, v192
    v_and_b32 v85, 0xffff0000, v192
    v_lshlrev_b32 v86, 16, v193
    v_and_b32 v87, 0xffff0000, v193
    v_lshlrev_b32 v88, 16, v194
    v_and_b32 v89, 0xffff0000, v194
    v_lshlrev_b32 v90, 16, v195
    v_and_b32 v91, 0xffff0000, v195
    v_lshlrev_b32 v92, 16, v196
    v_and_b32 v93, 0xffff0000, v196
    v_lshlrev_b32 v94, 16, v197
    v_and_b32 v95, 0xffff0000, v197
    v_lshlrev_b32 v96, 16, v198
    v_and_b32 v97, 0xffff0000, v198
    v_lshlrev_b32 v98, 16, v199
    v_and_b32 v99, 0xffff0000, v199
    v_add_u32 v12, 0, v3
    s_add_u32 s4, s23, 0
    v_add_u32 v11, s4, v2
    s_call_b64 s[100:101], XS_sub
    s_add_u32 s27, s27, 655360
    s_waitcnt vmcnt(0)
    s_barrier
    s_lshl_b32 s4, s21, 2
    s_add_u32 s4, s4, 81920
    v_mov_b32 v16, 1
    v_lshlrev_b32 v17, 7, v1
    s_lshl_b32 s5, s3, 5
    s_add_u32 s5, s5, s21
    s_cmp_lt_u32 s5, 4
    s_cselect_b64 exec, 0xff, 0
    buffer_store_dword v16, v17, s[8:11], s4 offen sc1
    s_mov_b64 exec, -1
    s_lshl_b32 s4, s21, 7
    s_add_u32 s4, s4, 65536
    v_mov_b32 v16, 1
    v_lshlrev_b32 v17, 2, v1
    s_cmp_eq_u32 s3, 0
    s_cselect_b64 exec, 1, 0
    buffer_store_dword v16, v17, s[8:11], s4 offen sc1
    s_mov_b64 exec, -1
    s_mov_b32 s28, s21
    s_bitcmp1_b32 s21, 1
    s_cbranch_scc0 XD_r2
    s_lshr_b32 s4, s21, 2
    s_lshl_b32 s4, s4, 1
    s_and_b32 s21, s21, 1
    s_add_u32 s21, s21, s4
    s_add_u32 s4, s21, 32
    s_mul_i32 s26, s4, 20480
    s_mul_i32 s5, s3, 5120
    s_add_u32 s26, s26, s5
    s_add_u32 s27, s26, 16777216
    s_add_u32 s21, s21, 44
    s_mul_i32 s4, s3, 1228800
    s_lshl_b32 s5, s21, 7
    s_add_u32 s4, s4, s5
    s_add_u32 m0, s22, 0
    s_nop 0
    buffer_load_dwordx4 v14, s[16:19], s4 offen nt lds
    s_add_u32 s4, s4, 61440
    s_add_u32 m0, s22, 1024
    s_nop 0
    buffer_load_dwordx4 v14, s[16:19], s4 offen nt lds
    s_add_u32 s4, s4, 61440
    s_add_u32 m0, s22, 2048
    s_nop 0
    buffer_load_dwordx4 v15, s[16:19], s4 offen nt lds
    s_add_u32 s4, s4, 61440
    s_add_u32 m0, s22, 3072
    s_nop 0
    buffer_load_dwordx4 v15, s[16:19], s4 offen nt lds
    s_add_u32 s4, s4, 61440
    s_add_u32 m0, s22, 4096
    s_nop 0
    buffer_load_dwordx4 v14, s[16:19], s4 offen nt lds
    s_add_u32 s4, s4, 61440
    s_add_u32 m0, s22, 5120
    s_nop 0
    buffer_load_dwordx4 v14, s[16:19], s4 offen nt lds
    s_add_u32 s4, s4, 61440
    s_add_u32 m0, s22, 6144
    s_nop 0
    buffer_load_dwordx4 v15, s[16:19], s4 offen nt lds
    s_add_u32 s4, s4, 61440
    s_add_u32 m0, s22, 7168
    s_nop 0
    buffer_load_dwordx4 v15, s[16:19], s4 offen nt lds
    s_add_u32 s4, s4, 61440
    s_add_u32 m0, s22, 8192
    s_nop 0
    buffer_load_dwordx4 v14, s[16:19], s4 offen nt lds
    s_add_u32 s4, s4, 61440
    s_add_u32 m0, s22, 9216
    s_nop 0
    buffer_load_dwordx4 v14, s[16:19], s4 offen nt lds
    s_add_u32 s4, s4, 61440
    s_add_u32 m0, s22, 10240
    s_nop 0
    buffer_load_dwordx4 v15, s[16:19], s4 offen nt lds
    s_add_u32 s4, s4, 61440
    s_add_u32 m0, s22, 11264
    s_nop 0
    buffer_load_dwordx4 v15, s[16:19], s4 offen nt lds
    s_add_u32 s4, s4, 61440
    s_add_u32 m0, s22, 12288
    s_nop 0
    buffer_load_dwordx4 v14, s[16:19], s4 offen nt lds
    s_add_u32 s4, s4, 61440
    s_add_u32 m0, s22, 13312
    s_nop 0
    buffer_load_dwordx4 v14, s[16:19], s4 offen nt lds
    s_add_u32 s4, s4, 61440
    s_add_u32 m0, s22, 14336
    s_nop 0
    buffer_load_dwordx4 v15, s[16:19], s4 offen nt lds
    s_add_u32 s4, s4, 61440
    s_add_u32 m0, s22, 15360
    s_nop 0
    buffer_load_dwordx4 v15, s[16:19], s4 offen nt lds
    s_add_u32 s4, s4, 61440
    s_add_u32 m0, s22, 16384
    s_nop 0
    buffer_load_dwordx4 v14, s[16:19], s4 offen nt lds
    s_add_u32 s4, s4, 61440
    s_add_u32 m0, s22, 17408
    s_nop 0
    buffer_load_dwordx4 v14, s[16:19], s4 offen nt lds
    s_add_u32 s4, s4, 61440
    s_add_u32 m0, s22, 18432
    s_nop 0
    buffer_load_dwordx4 v15, s[16:19], s4 offen nt lds
    s_add_u32 s4, s4, 61440
    s_add_u32 m0, s22, 19456
    s_nop 0
    buffer_load_dwordx4 v15, s[16:19], s4 offen nt lds
    s_add_u32 s4, s4, 61440
    s_add_u32 s4, s26, 0
    s_add_u32 m0, s23, 20480
    s_nop 0
    buffer_load_dwordx4 v2, s[88:91], s4 offen offset:0 nt lds
    buffer_load_dwordx4 v2, s[88:91], s4 offen offset:1024 nt lds
    buffer_load_dwordx4 v2, s[88:91], s4 offen offset:2048 nt lds
    buffer_load_dwordx4 v2, s[88:91], s4 offen offset:3072 nt lds
    s_add_u32 s4, s26, 4096
    s_add_u32 m0, s23, 24576
    s_nop 0
    buffer_load_dwordx4 v2, s[88:91], s4 offen offset:0 nt lds
    s_waitcnt vmcnt(5)
    ds_read_b64_tr_b16 a[0:1], v32 offset:0
    ds_read_b64_tr_b16 a[2:3], v32 offset:256
    ds_read_b64_tr_b16 a[4:5], v33 offset:0
    ds_read_b64_tr_b16 a[6:7], v33 offset:256
    ds_read_b64_tr_b16 a[8:9], v34 offset:0
    ds_read_b64_tr_b16 a[10:11], v34 offset:256
    ds_read_b64_tr_b16 a[12:13], v35 offset:0
    ds_read_b64_tr_b16 a[14:15], v35 offset:256
    ds_read_b64_tr_b16 a[16:17], v32 offset:4096
    ds_read_b64_tr_b16 a[18:19], v32 offset:4352
    ds_read_b64_tr_b16 a[20:21], v33 offset:4096
    ds_read_b64_tr_b16 a[22:23], v33 offset:4352
    ds_read_b64_tr_b16 a[24:25], v34 offset:4096
    ds_read_b64_tr_b16 a[26:27], v34 offset:4352
    s_waitcnt lgkmcnt(12)
    v_mfma_f32_16x16x32_bf16 v[16:19], a[0:3], v[220:223], 0
    ds_read_b64_tr_b16 a[28:29], v35 offset:4096
    ds_read_b64_tr_b16 a[30:31], v35 offset:4352
    s_waitcnt lgkmcnt(12)
    v_mfma_f32_16x16x32_bf16 v[20:23], a[4:7], v[220:223], 0
    ds_read_b64_tr_b16 a[32:33], v32 offset:8192
    ds_read_b64_tr_b16 a[34:35], v32 offset:8448
    s_waitcnt lgkmcnt(12)
    v_mfma_f32_16x16x32_bf16 v[24:27], a[8:11], v[220:223], 0
    ds_read_b64_tr_b16 a[36:37], v33 offset:8192
    ds_read_b64_tr_b16 a[38:39], v33 offset:8448
    s_waitcnt lgkmcnt(12)
    v_mfma_f32_16x16x32_bf16 v[28:31], a[12:15], v[220:223], 0
    ds_read_b64_tr_b16 a[40:41], v34 offset:8192
    ds_read_b64_tr_b16 a[42:43], v34 offset:8448
    s_waitcnt lgkmcnt(12)
    v_mfma_f32_16x16x32_bf16 v[16:19], a[16:19], v[224:227], v[16:19]
    ds_read_b64_tr_b16 a[44:45], v35 offset:8192
    ds_read_b64_tr_b16 a[46:47], v35 offset:8448
    s_waitcnt lgkmcnt(12)
    v_mfma_f32_16x16x32_bf16 v[20:23], a[20:23], v[224:227], v[20:23]
    ds_read_b64_tr_b16 a[48:49], v32 offset:12288
    ds_read_b64_tr_b16 a[50:51], v32 offset:12544
    s_waitcnt lgkmcnt(12)
    v_mfma_f32_16x16x32_bf16 v[24:27], a[24:27], v[224:227], v[24:27]
    ds_read_b64_tr_b16 a[52:53], v33 offset:12288
    ds_read_b64_tr_b16 a[54:55], v33 offset:12544
    s_waitcnt lgkmcnt(12)
    v_mfma_f32_16x16x32_bf16 v[28:31], a[28:31], v[224:227], v[28:31]
    ds_read_b64_tr_b16 a[56:57], v34 offset:12288
    ds_read_b64_tr_b16 a[58:59], v34 offset:12544
    s_waitcnt lgkmcnt(12)
    v_mfma_f32_16x16x32_bf16 v[16:19], a[32:35], v[228:231], v[16:19]
    ds_read_b64_tr_b16 a[60:61], v35 offset:12288
    ds_read_b64_tr_b16 a[62:63], v35 offset:12544
    s_waitcnt lgkmcnt(12)
    v_mfma_f32_16x16x32_bf16 v[20:23], a[36:39], v[228:231], v[20:23]
    ds_read_b64_tr_b16 a[64:65], v32 offset:16384
    ds_read_b64_tr_b16 a[66:67], v32 offset:16640
    s_waitcnt lgkmcnt(12)
    v_mfma_f32_16x16x32_bf16 v[24:27], a[40:43], v[228:231], v[24:27]
    ds_read_b64_tr_b16 a[68:69], v33 offset:16384
    ds_read_b64_tr_b16 a[70:71], v33 offset:16640
    s_waitcnt lgkmcnt(12)
    v_mfma_f32_16x16x32_bf16 v[28:31], a[44:47], v[228:231], v[28:31]
    ds_read_b64_tr_b16 a[72:73], v34 offset:16384
    ds_read_b64_tr_b16 a[74:75], v34 offset:16640
    s_waitcnt lgkmcnt(12)
    v_mfma_f32_16x16x32_bf16 v[16:19], a[48:51], v[232:235], v[16:19]
    ds_read_b64_tr_b16 a[76:77], v35 offset:16384
    ds_read_b64_tr_b16 a[78:79], v35 offset:16640
    s_waitcnt lgkmcnt(12)
    v_mfma_f32_16x16x32_bf16 v[20:23], a[52:55], v[232:235], v[20:23]
    s_waitcnt lgkmcnt(10)
    v_mfma_f32_16x16x32_bf16 v[24:27], a[56:59], v[232:235], v[24:27]
    s_waitcnt lgkmcnt(8)
    v_mfma_f32_16x16x32_bf16 v[28:31], a[60:63], v[232:235], v[28:31]
    s_waitcnt lgkmcnt(6)
    v_mfma_f32_16x16x32_bf16 v[16:19], a[64:67], v[236:239], v[16:19]
    s_waitcnt lgkmcnt(4)
    v_mfma_f32_16x16x32_bf16 v[20:23], a[68:71], v[236:239], v[20:23]
    s_waitcnt lgkmcnt(2)
    v_mfma_f32_16x16x32_bf16 v[24:27], a[72:75], v[236:239], v[24:27]
    s_waitcnt lgkmcnt(0)
    v_mfma_f32_16x16x32_bf16 v[28:31], a[76:79], v[236:239], v[28:31]
    s_mov_b32 exec_lo, 0x00010001
    s_mov_b32 exec_hi, 0x00010001
    ds_write_b128 v37, v[16:19] offset:0
    ds_write_b128 v37, v[20:23] offset:64
    ds_write_b128 v37, v[24:27] offset:128
    s_nop 2
    ds_write_b128 v37, v[28:31] offset:192
    s_mov_b64 exec, -1
    s_waitcnt lgkmcnt(0)
    s_barrier
    s_cmp_lg_u32 s3, 0
    s_cbranch_scc1 XD_r3
    ds_read_b32 v16, v38 offset:0
    ds_read_b32 v17, v38 offset:20480
    ds_read_b32 v18, v38 offset:40960
    ds_read_b32 v19, v38 offset:61440
    s_lshl_b32 s4, s21, 8
    s_add_u32 s4, s4, 0
    s_lshl_b32 s5, s21, 7
    s_add_u32 s5, s5, 32768
    s_mov_b32 s6, 0x55555555
    s_cmp_ge_u32 s21, 10
    s_cselect_b32 s7, 1.0, 0
    s_waitcnt lgkmcnt(0)
    v_add_f32 v16, v16, v17
    v_add_f32 v18, v18, v19
    v_add_f32 v16, v16, v18
    v_cvt_pk_bf16_f32 v16, v16, v16
    v_and_b32 v16, 0xffff0000, v16
    v_add_f32 v18, s7, v16
    s_nop 1
    v_mov_b32 v17, v18 quad_perm:[1,1,3,3] row_mask:0xf bank_mask:0xf
    v_cvt_pk_bf16_f32 v17, v18, v17
    s_mov_b32 exec_lo, s6
    s_mov_b32 exec_hi, s6
    buffer_store_dword v17, v36, s[8:11], s5 offen sc1
    s_mov_b64 exec, -1
    buffer_store_dword v16, v38, s[8:11], s4 offen sc1
XD_r3:
    s_mov_b32 s29, 0
XD_ll:
    s_add_u32 s26, s26, 327680
    s_waitcnt vmcnt(0)
    s_barrier
    s_add_u32 s4, s26, 0
    s_add_u32 m0, s23, 61440
    s_nop 0
    buffer_load_dwordx4 v2, s[88:91], s4 offen offset:0 nt lds
    buffer_load_dwordx4 v2, s[88:91], s4 offen offset:1024 nt lds
    buffer_load_dwordx4 v2, s[88:91], s4 offen offset:2048 nt lds
    buffer_load_dwordx4 v2, s[88:91], s4 offen offset:3072 nt lds
    s_add_u32 s4, s26, 4096
    s_add_u32 m0, s23, 65536
    s_nop 0
    buffer_load_dwordx4 v2, s[88:91], s4 offen offset:0 nt lds
    v_add_u32 v12, 20480, v39
    s_call_b64 s[100:101], XN_sub
    v_cvt_pk_bf16_f32 v200, v60, v61
    v_cvt_pk_bf16_f32 v201, v62, v63
    v_cvt_pk_bf16_f32 v202, v64, v65
    v_cvt_pk_bf16_f32 v203, v66, v67
    v_cvt_pk_bf16_f32 v204, v68, v69
    v_cvt_pk_bf16_f32 v205, v70, v71
    v_cvt_pk_bf16_f32 v206, v72, v73
    v_cvt_pk_bf16_f32 v207, v74, v75
    v_cvt_pk_bf16_f32 v208, v76, v77
    v_cvt_pk_bf16_f32 v209, v78, v79
    v_cvt_pk_bf16_f32 v210, v80, v81
    v_cvt_pk_bf16_f32 v211, v82, v83
    v_cvt_pk_bf16_f32 v212, v84, v85
    v_cvt_pk_bf16_f32 v213, v86, v87
    v_cvt_pk_bf16_f32 v214, v88, v89
    v_cvt_pk_bf16_f32 v215, v90, v91
    v_cvt_pk_bf16_f32 v216, v92, v93
    v_cvt_pk_bf16_f32 v217, v94, v95
    v_cvt_pk_bf16_f32 v218, v96, v97
    v_cvt_pk_bf16_f32 v219, v98, v99
    s_barrier
    v_lshlrev_b32 v60, 16, v200
    v_and_b32 v61, 0xffff0000, v200
    v_lshlrev_b32 v62, 16, v201
    v_and_b32 v63, 0xffff0000, v201
    v_lshlrev_b32 v64, 16, v202
    v_and_b32 v65, 0xffff0000, v202
    v_lshlrev_b32 v66, 16, v203
    v_and_b32 v67, 0xffff0000, v203
    v_lshlrev_b32 v68, 16, v204
    v_and_b32 v69, 0xffff0000, v204
    v_lshlrev_b32 v70, 16, v205
    v_and_b32 v71, 0xffff0000, v205
    v_lshlrev_b32 v72, 16, v206
    v_and_b32 v73, 0xffff0000, v206
    v_lshlrev_b32 v74, 16, v207
    v_and_b32 v75, 0xffff0000, v207
    v_lshlrev_b32 v76, 16, v208
    v_and_b32 v77, 0xffff0000, v208
    v_lshlrev_b32 v78, 16, v209
    v_and_b32 v79, 0xffff0000, v209
    v_lshlrev_b32 v80, 16, v210
    v_and_b32 v81, 0xffff0000, v210
    v_lshlrev_b32 v82, 16, v211
    v_and_b32 v83, 0xffff0000, v211
    v_lshlrev_b32 v84, 16, v212
    v_and_b32 v85, 0xffff0000, v212
    v_lshlrev_b32 v86, 16, v213
    v_and_b32 v87, 0xffff0000, v213
    v_lshlrev_b32 v88, 16, v214
    v_and_b32 v89, 0xffff0000, v214
    v_lshlrev_b32 v90, 16, v215
    v_and_b32 v91, 0xffff0000, v215
    v_lshlrev_b32 v92, 16, v216
    v_and_b32 v93, 0xffff0000, v216
    v_lshlrev_b32 v94, 16, v217
    v_and_b32 v95, 0xffff0000, v217
    v_lshlrev_b32 v96, 16, v218
    v_and_b32 v97, 0xffff0000, v218
    v_lshlrev_b32 v98, 16, v219
    v_and_b32 v99, 0xffff0000, v219
    v_add_u32 v12, 20480, v3
    s_add_u32 s4, s23, 20480
    v_add_u32 v11, s4, v2
    s_call_b64 s[100:101], XS_sub
    s_add_u32 s27, s27, 327680
    s_add_u32 s26, s26, 327680
    s_waitcnt vmcnt(0)
    s_barrier
    s_add_u32 s4, s26, 0
    s_add_u32 m0, s23, 20480
    s_nop 0
    buffer_load_dwordx4 v2, s[88:91], s4 offen offset:0 nt lds
    buffer_load_dwordx4 v2, s[88:91], s4 offen offset:1024 nt lds
    buffer_load_dwordx4 v2, s[88:91], s4 offen offset:2048 nt lds
    buffer_load_dwordx4 v2, s[88:91], s4 offen offset:3072 nt lds
    s_add_u32 s4, s26, 4096
    s_add_u32 m0, s23, 24576
    s_nop 0
    buffer_load_dwordx4 v2, s[88:91], s4 offen offset:0 nt lds
    v_add_u32 v12, 61440, v39
    s_call_b64 s[100:101], XN_sub
    v_cvt_pk_bf16_f32 v180, v60, v61
    v_cvt_pk_bf16_f32 v181, v62, v63
    v_cvt_pk_bf16_f32 v182, v64, v65
    v_cvt_pk_bf16_f32 v183, v66, v67
    v_cvt_pk_bf16_f32 v184, v68, v69
    v_cvt_pk_bf16_f32 v185, v70, v71
    v_cvt_pk_bf16_f32 v186, v72, v73
    v_cvt_pk_bf16_f32 v187, v74, v75
    v_cvt_pk_bf16_f32 v188, v76, v77
    v_cvt_pk_bf16_f32 v189, v78, v79
    v_cvt_pk_bf16_f32 v190, v80, v81
    v_cvt_pk_bf16_f32 v191, v82, v83
    v_cvt_pk_bf16_f32 v192, v84, v85
    v_cvt_pk_bf16_f32 v193, v86, v87
    v_cvt_pk_bf16_f32 v194, v88, v89
    v_cvt_pk_bf16_f32 v195, v90, v91
    v_cvt_pk_bf16_f32 v196, v92, v93
    v_cvt_pk_bf16_f32 v197, v94, v95
    v_cvt_pk_bf16_f32 v198, v96, v97
    v_cvt_pk_bf16_f32 v199, v98, v99
    s_barrier
    v_lshlrev_b32 v60, 16, v180
    v_and_b32 v61, 0xffff0000, v180
    v_lshlrev_b32 v62, 16, v181
    v_and_b32 v63, 0xffff0000, v181
    v_lshlrev_b32 v64, 16, v182
    v_and_b32 v65, 0xffff0000, v182
    v_lshlrev_b32 v66, 16, v183
    v_and_b32 v67, 0xffff0000, v183
    v_lshlrev_b32 v68, 16, v184
    v_and_b32 v69, 0xffff0000, v184
    v_lshlrev_b32 v70, 16, v185
    v_and_b32 v71, 0xffff0000, v185
    v_lshlrev_b32 v72, 16, v186
    v_and_b32 v73, 0xffff0000, v186
    v_lshlrev_b32 v74, 16, v187
    v_and_b32 v75, 0xffff0000, v187
    v_lshlrev_b32 v76, 16, v188
    v_and_b32 v77, 0xffff0000, v188
    v_lshlrev_b32 v78, 16, v189
    v_and_b32 v79, 0xffff0000, v189
    v_lshlrev_b32 v80, 16, v190
    v_and_b32 v81, 0xffff0000, v190
    v_lshlrev_b32 v82, 16, v191
    v_and_b32 v83, 0xffff0000, v191
    v_lshlrev_b32 v84, 16, v192
    v_and_b32 v85, 0xffff0000, v192
    v_lshlrev_b32 v86, 16, v193
    v_and_b32 v87, 0xffff0000, v193
    v_lshlrev_b32 v88, 16, v194
    v_and_b32 v89, 0xffff0000, v194
    v_lshlrev_b32 v90, 16, v195
    v_and_b32 v91, 0xffff0000, v195
    v_lshlrev_b32 v92, 16, v196
    v_and_b32 v93, 0xffff0000, v196
    v_lshlrev_b32 v94, 16, v197
    v_and_b32 v95, 0xffff0000, v197
    v_lshlrev_b32 v96, 16, v198
    v_and_b32 v97, 0xffff0000, v198
    v_lshlrev_b32 v98, 16, v199
    v_and_b32 v99, 0xffff0000, v199
    v_add_u32 v12, 61440, v3
    s_add_u32 s4, s23, 61440
    v_add_u32 v11, s4, v2
    s_call_b64 s[100:101], XS_sub
    s_add_u32 s27, s27, 327680
    s_add_u32 s29, s29, 1
    s_cmp_lt_u32 s29, 3
    s_cbranch_scc1 XD_ll
    s_waitcnt vmcnt(0)
    s_barrier
XD_r2:
    s_waitcnt vmcnt(0)
    s_lshl_b32 s4, s28, 7
    s_add_u32 s4, s4, 65540
    v_mov_b32 v16, 1
    v_lshlrev_b32 v17, 2, v1
    s_cmp_eq_u32 s3, 0
    s_cselect_b64 exec, 1, 0
    buffer_store_dword v16, v17, s[8:11], s4 offen sc1
    s_mov_b64 exec, -1
    v_and_b32 v16, 7, v1
    v_lshlrev_b32 v16, 5, v16
    buffer_load_dwordx4 v[20:23], v16, s[84:87], 0 offen sc1
    s_mov_b32 s31, 0
    s_waitcnt vmcnt(0)
    s_branch XJ_c
XJ_l:
    buffer_load_dwordx4 v[20:23], v16, s[84:87], 0 offen sc1
    s_waitcnt vmcnt(0)
XJ_c:
    v_bcnt_u32_b32 v17, v20, v23
    v_cmp_lt_u32 s[4:5], 32, v17
    s_and_b32 s6, s4, 0xff
    v_cmp_ne_u32 s[4:5], 32, v17
    s_cmp_eq_u32 s6, 0
    s_cselect_b32 s5, 0xff, 0
    s_and_b32 s4, s4, s5
    v_add_u32 v21, v21, v22
    v_cmp_gt_u32 vcc, 32, v21
    s_and_b32 vcc_lo, vcc_lo, 0xff
    s_or_b32 vcc_lo, vcc_lo, s4
    s_mov_b32 vcc_hi, 0
    s_cbranch_vccz XJ_o
    s_sleep 16
    s_add_u32 s31, s31, 1
    s_cmp_lt_u32 s31, s30
    s_cbranch_scc1 XJ_l
    s_mov_b32 s30, 1
XJ_o:
    s_mov_b32 s97, s6
    s_mul_i32 s22, s99, 1048576
    s_add_u32 s22, s22, 8388608
    s_sub_u32 s34, s20, 28
    s_lshl_b32 s20, s99, 2
    s_add_u32 s20, s20, s34
    s_mov_b32 s28, s34
    s_lshl_b32 s96, s99, 2
    s_add_u32 s96, s96, s3
    s_and_b32 s34, s34, 1
    s_lshl_b32 s34, s34, 1
    s_lshr_b32 s4, s3, 1
    s_add_u32 s34, s34, s4
    s_and_b32 s32, s3, 1
    s_mul_i32 s4, s34, 48
    s_add_u32 s4, s4, 155648
    v_min_u32 v15, 11, v1
    v_lshl_add_u32 v15, v15, 2, s4
    s_mov_b32 s43, 0
    s_barrier
    v_mov_b32 v9, 0
    s_cmp_lt_u32 s28, 2
    s_cbranch_scc1 XM2_o
    v_and_b32 v16, 31, v1
    v_lshlrev_b32 v16, 7, v16
    s_mov_b32 s23, 65540
    s_mov_b32 s31, 0
XM2_l:
    buffer_load_dword v17, v16, s[8:11], s23 offen sc1
    s_waitcnt vmcnt(0)
XM2_c:
    v_cmp_gt_u32 vcc, 1, v17
    s_cbranch_vccz XM2_o
    s_sleep 8
    s_add_u32 s31, s31, 1
    s_cmp_lt_u32 s31, s30
    s_cbranch_scc1 XM2_l
    s_mov_b32 s30, 1
XM2_o:
    s_load_dwordx2 s[12:13], s[0:1], 0
    s_load_dwordx2 s[16:17], s[0:1], 112
    s_mov_b32 s14, 2621440
    s_mov_b32 s15, 0x20000
    s_mov_b32 s18, 2621440
    s_mov_b32 s19, 0x20000
    s_waitcnt lgkmcnt(0)
    s_load_dwordx2 s[84:85], s[0:1], 72
    s_load_dwordx2 s[88:89], s[0:1], 80
    s_load_dwordx2 s[92:93], s[0:1], 88
    s_mov_b32 s86, 1966080
    s_mov_b32 s87, 0x20000
    s_mov_b32 s90, 1966080
    s_mov_b32 s91, 0x20000
    s_mov_b32 s94, 1966080
    s_mov_b32 s95, 0x20000
    s_waitcnt lgkmcnt(0)
    v_mul_u32_u24 v4, 43, v1
    v_lshrrev_b32 v4, 8, v4
    v_mul_u32_u24 v5, 6, v4
    v_sub_u32 v5, v1, v5
    v_mul_u32_u24 v0, 3072, v4
    v_lshl_add_u32 v0, v5, 4, v0
    s_mul_i32 s98, s3, 491520
    s_mul_i32 s5, s20, 96
    s_add_u32 s98, s98, s5
    s_mul_i32 s99, s3, 30720
    s_add_u32 s99, s99, 40960
    s_lshl_b32 s23, s20, 2
    s_add_u32 s23, s23, s3
    s_mul_i32 s23, s23, 15360
    s_mov_b32 s44, 0
    s_mov_b32 s45, 0
    s_mov_b32 s46, 0
    s_mov_b32 s47, 0
    s_mov_b32 s38, 0
    s_mov_b32 s39, 0
    s_mov_b32 s48, 0
    s_mov_b32 s49, 0
    s_cmp_ge_u32 s28, 2
    s_cbranch_scc1 X3_go
    s_cmp_lg_u32 s97, 0
    s_cbranch_scc1 Xs_go
Xf_go:
    s_mul_i32 s26, s34, 12288
    s_add_u32 s26, s26, 356352
    s_lshl_b32 s4, s32, 9
    s_add_u32 s4, s4, 3072
    v_and_b32 v16, 0x1f0, v2
    v_add_u32 v16, s4, v16
    s_lshl_b32 s4, s32, 10
    v_add_u32 v17, s4, v2
    v_lshrrev_b32 v56, 4, v1
    v_lshlrev_b32 v57, 2, v56
    v_and_b32 v58, 15, v1
    v_sub_u32 v57, v57, v58
    s_lshl_b32 s4, s32, 4
    v_subrev_u32 v57, s4, v57
    v_and_b32 v56, 0x1f0, v2
    v_mov_b32 v58, 0xff800000
    s_lshl_b32 s37, s34, 1
    s_add_u32 s37, s37, s32
    s_lshl_b32 s37, s37, 10
    s_and_b32 s40, s34, 2
    s_add_u32 s40, s40, s32
    s_lshl_b32 s40, s40, 9
    s_and_b32 s4, s34, 1
    s_lshl_b32 s4, s4, 3
    s_add_u32 s40, s40, s4
    s_add_u32 s40, s40, 413696
    s_add_u32 s37, s37, 405504
    s_mov_b32 s41, 0x3dd53b95
    s_mov_b32 s21, 0
Xf_loop:
    s_and_b32 s36, s21, 3
    s_lshl_b32 s36, s36, 16
    s_add_u32 s36, s36, s22
    s_add_u32 s35, s36, s26
    s_add_u32 s21, s21, 1
    s_mov_b32 s31, 0
Xfw_l:
    buffer_load_dword v18, v15, s[8:11], s22 offen sc1
    s_waitcnt vmcnt(0)
Xfw_c:
    v_cmp_gt_u32 vcc, s21, v18
    s_cbranch_vccz Xfw_o
    s_sleep 1
    s_add_u32 s31, s31, 1
    s_cmp_lt_u32 s31, s30
    s_cbranch_scc1 Xfw_l
    s_mov_b32 s30, 1
Xfw_o:
    s_add_u32 s4, s35, 0
    buffer_load_dwordx4 v[60:63], v16, s[8:11], s4 offen offset:0 sc1
    buffer_load_dwordx4 v[64:67], v17, s[8:11], s4 offen offset:0 sc1
    buffer_load_dwordx4 v[68:71], v17, s[8:11], s4 offen offset:1024 sc1
    s_add_u32 s4, s35, 4096
    buffer_load_dwordx4 v[72:75], v16, s[8:11], s4 offen offset:0 sc1
    buffer_load_dwordx4 v[76:79], v17, s[8:11], s4 offen offset:0 sc1
    buffer_load_dwordx4 v[80:83], v17, s[8:11], s4 offen offset:1024 sc1
    s_add_u32 s4, s35, 8192
    buffer_load_dwordx4 v[84:87], v16, s[8:11], s4 offen offset:0 sc1
    buffer_load_dwordx4 v[88:91], v17, s[8:11], s4 offen offset:0 sc1
    buffer_load_dwordx4 v[92:95], v17, s[8:11], s4 offen offset:1024 sc1
    s_add_u32 s5, s36, s37
    s_add_u32 s6, s36, s40
    s_waitcnt vmcnt(3)
    v_pk_add_f32 v[60:61], v[60:61], v[72:73]
    v_pk_add_f32 v[62:63], v[62:63], v[74:75]
    v_pk_add_f32 v[64:65], v[64:65], v[76:77]
    v_pk_add_f32 v[66:67], v[66:67], v[78:79]
    v_pk_add_f32 v[68:69], v[68:69], v[80:81]
    v_pk_add_f32 v[70:71], v[70:71], v[82:83]
    s_waitcnt vmcnt(0)
    v_pk_add_f32 v[60:61], v[60:61], v[84:85]
    v_pk_add_f32 v[62:63], v[62:63], v[86:87]
    v_pk_add_f32 v[64:65], v[64:65], v[88:89]
    v_pk_add_f32 v[66:67], v[66:67], v[90:91]
    v_pk_add_f32 v[68:69], v[68:69], v[92:93]
    v_pk_add_f32 v[70:71], v[70:71], v[94:95]
    v_cmp_lt_u32 vcc, 31, v1
    s_nop 1
    v_cndmask_b32 v60, v58, v60, vcc
    v_cndmask_b32 v61, v58, v61, vcc
    v_cndmask_b32 v62, v58, v62, vcc
    v_cndmask_b32 v63, v58, v63, vcc
    v_cmp_ge_i32 vcc, 0, v57
    s_nop 1
    v_cndmask_b32 v64, v58, v64, vcc
    v_cmp_ge_i32 vcc, -1, v57
    s_nop 1
    v_cndmask_b32 v65, v58, v65, vcc
    v_cmp_ge_i32 vcc, -2, v57
    s_nop 1
    v_cndmask_b32 v66, v58, v66, vcc
    v_cmp_ge_i32 vcc, -3, v57
    s_nop 1
    v_cndmask_b32 v67, v58, v67, vcc
    v_cmp_ge_i32 vcc, -16, v57
    s_nop 1
    v_cndmask_b32 v68, v58, v68, vcc
    v_cmp_ge_i32 vcc, -17, v57
    s_nop 1
    v_cndmask_b32 v69, v58, v69, vcc
    v_cmp_ge_i32 vcc, -18, v57
    s_nop 1
    v_cndmask_b32 v70, v58, v70, vcc
    v_cmp_ge_i32 vcc, -19, v57
    s_nop 1
    v_cndmask_b32 v71, v58, v71, vcc
    v_max_f32 v44, v60, v61
    v_max3_f32 v44, v44, v62, v63
    v_max3_f32 v44, v44, v64, v65
    v_max3_f32 v44, v44, v66, v67
    v_max3_f32 v44, v44, v68, v69
    v_max3_f32 v44, v44, v70, v71
    v_mov_b32 v45, v44
    s_nop 1
    v_permlane16_swap_b32 v44, v45
    v_max_f32 v44, v44, v45
    v_mov_b32 v45, v44
    s_nop 1
    v_permlane32_swap_b32 v44, v45
    v_max_f32 v44, v44, v45
    v_mul_f32 v44, s41, v44
    v_fma_f32 v60, v60, s41, -v44
    v_fma_f32 v61, v61, s41, -v44
    v_fma_f32 v62, v62, s41, -v44
    v_fma_f32 v63, v63, s41, -v44
    v_fma_f32 v64, v64, s41, -v44
    v_fma_f32 v65, v65, s41, -v44
    v_fma_f32 v66, v66, s41, -v44
    v_fma_f32 v67, v67, s41, -v44
    v_fma_f32 v68, v68, s41, -v44
    v_fma_f32 v69, v69, s41, -v44
    v_fma_f32 v70, v70, s41, -v44
    v_fma_f32 v71, v71, s41, -v44
    v_exp_f32 v60, v60
    v_exp_f32 v61, v61
    v_exp_f32 v62, v62
    v_exp_f32 v63, v63
    v_exp_f32 v64, v64
    v_exp_f32 v65, v65
    v_exp_f32 v66, v66
    v_exp_f32 v67, v67
    v_exp_f32 v68, v68
    v_exp_f32 v69, v69
    v_exp_f32 v70, v70
    v_exp_f32 v71, v71
    v_add_f32 v44, v60, v61
    v_add_f32 v44, v44, v62
    v_add_f32 v44, v44, v63
    v_add_f32 v44, v44, v64
    v_add_f32 v44, v44, v65
    v_add_f32 v44, v44, v66
    v_add_f32 v44, v44, v67
    v_add_f32 v44, v44, v68
    v_add_f32 v44, v44, v69
    v_add_f32 v44, v44, v70
    v_add_f32 v44, v44, v71
    v_mov_b32 v45, v44
    s_nop 1
    v_permlane16_swap_b32 v44, v45
    v_add_f32 v44, v44, v45
    v_mov_b32 v45, v44
    s_nop 1
    v_permlane32_swap_b32 v44, v45
    v_add_f32 v44, v44, v45
    v_rcp_f32 v44, v44
    s_nop 0
    v_mul_f32 v60, v60, v44
    v_mul_f32 v61, v61, v44
    v_mul_f32 v62, v62, v44
    v_mul_f32 v63, v63, v44
    v_mul_f32 v64, v64, v44
    v_mul_f32 v65, v65, v44
    v_mul_f32 v66, v66, v44
    v_mul_f32 v67, v67, v44
    v_mul_f32 v68, v68, v44
    v_mul_f32 v69, v69, v44
    v_mul_f32 v70, v70, v44
    v_mul_f32 v71, v71, v44
    v_cvt_pk_bf16_f32 v48, v64, v65
    v_cvt_pk_bf16_f32 v49, v68, v69
    v_cvt_pk_bf16_f32 v50, v66, v67
    v_cvt_pk_bf16_f32 v51, v70, v71
    v_cvt_pk_bf16_f32 v52, v60, v61
    v_cvt_pk_bf16_f32 v53, v62, v63
    buffer_store_dwordx4 v[48:51], v2, s[8:11], s5 offen offset:0
    s_mov_b32 exec_lo, 0
    buffer_store_dwordx2 v[52:53], v56, s[8:11], s6 offen offset:0
    s_mov_b64 exec, -1
    s_waitcnt vmcnt(0)
    v_mov_b32 v10, s21
    s_mov_b64 exec, 1
    buffer_store_dword v10, v9, s[8:11], s33 offen
    s_mov_b64 exec, -1
    s_cmp_eq_u32 s21, 64
    s_cbranch_scc1 X_join
    s_bitcmp1_b32 s21, 0
    s_cbranch_scc1 Xf_loop
    s_lshr_b32 s29, s21, 1
    s_sub_u32 s29, s29, 2
    s_cbranch_scc1 Xf_loop
    s_cmp_lt_u32 s29, 2
    s_cbranch_scc1 Xfb_e
    s_cmp_lt_u32 s29, 10
    s_cbranch_scc0 Xfb_a
    s_mov_b32 exec_hi, 0x0fffffff
    s_add_u32 m0, s99, 0
    s_nop 0
    buffer_load_dwordx4 v0, s[84:87], s98 offen nt lds
    s_add_u32 m0, s99, 15360
    s_nop 0
    buffer_load_dwordx4 v0, s[88:91], s98 offen nt lds
    s_add_u32 s98, s98, 30720
    s_add_u32 s99, s99, 960
    s_add_u32 m0, s99, 0
    s_nop 0
    buffer_load_dwordx4 v0, s[84:87], s98 offen nt lds
    s_add_u32 m0, s99, 15360
    s_nop 0
    buffer_load_dwordx4 v0, s[88:91], s98 offen nt lds
    s_add_u32 s98, s98, 30720
    s_add_u32 s99, s99, 960
    s_mov_b64 exec, -1
Xfb_a:
    s_cmp_eq_u32 s29, 11
    s_cbranch_scc0 Xfb_b
    s_waitcnt vmcnt(0)
    v_lshrrev_b32 v12, 4, v1
    v_lshlrev_b32 v12, 3, v12
    v_bfe_u32 v13, v1, 2, 2
    v_add_u32 v12, v12, v13
    v_mul_u32_u24 v12, 96, v12
    v_and_b32 v13, 3, v1
    v_lshlrev_b32 v13, 3, v13
    v_add_u32 v12, v12, v13
    s_mul_i32 s4, s3, 30720
    s_add_u32 s4, s4, 40960
    v_add_u32 v12, s4, v12
    ds_read_b64_tr_b16 a[0:1], v12 offset:0
    ds_read_b64_tr_b16 a[2:3], v12 offset:384
    ds_read_b64_tr_b16 a[4:5], v12 offset:3072
    ds_read_b64_tr_b16 a[6:7], v12 offset:3456
    ds_read_b64_tr_b16 a[8:9], v12 offset:6144
    ds_read_b64_tr_b16 a[10:11], v12 offset:6528
    ds_read_b64_tr_b16 a[12:13], v12 offset:9216
    ds_read_b64_tr_b16 a[14:15], v12 offset:9600
    ds_read_b64_tr_b16 a[16:17], v12 offset:12288
    ds_read_b64_tr_b16 a[18:19], v12 offset:12672
    ds_read_b64_tr_b16 a[20:21], v12 offset:15360
    ds_read_b64_tr_b16 a[22:23], v12 offset:15744
    ds_read_b64_tr_b16 a[24:25], v12 offset:18432
    ds_read_b64_tr_b16 a[26:27], v12 offset:18816
    ds_read_b64_tr_b16 a[28:29], v12 offset:21504
    ds_read_b64_tr_b16 a[30:31], v12 offset:21888
    ds_read_b64_tr_b16 a[32:33], v12 offset:24576
    ds_read_b64_tr_b16 a[34:35], v12 offset:24960
    ds_read_b64_tr_b16 a[36:37], v12 offset:27648
    ds_read_b64_tr_b16 a[38:39], v12 offset:28032
    ds_read_b64_tr_b16 a[40:41], v12 offset:32
    ds_read_b64_tr_b16 a[42:43], v12 offset:416
    ds_read_b64_tr_b16 a[44:45], v12 offset:3104
    ds_read_b64_tr_b16 a[46:47], v12 offset:3488
    ds_read_b64_tr_b16 a[48:49], v12 offset:6176
    ds_read_b64_tr_b16 a[50:51], v12 offset:6560
    ds_read_b64_tr_b16 a[52:53], v12 offset:9248
    ds_read_b64_tr_b16 a[54:55], v12 offset:9632
    ds_read_b64_tr_b16 a[56:57], v12 offset:12320
    ds_read_b64_tr_b16 a[58:59], v12 offset:12704
    ds_read_b64_tr_b16 a[60:61], v12 offset:15392
    ds_read_b64_tr_b16 a[62:63], v12 offset:15776
    ds_read_b64_tr_b16 a[64:65], v12 offset:18464
    ds_read_b64_tr_b16 a[66:67], v12 offset:18848
    ds_read_b64_tr_b16 a[68:69], v12 offset:21536
    ds_read_b64_tr_b16 a[70:71], v12 offset:21920
    ds_read_b64_tr_b16 a[72:73], v12 offset:24608
    ds_read_b64_tr_b16 a[74:75], v12 offset:24992
    ds_read_b64_tr_b16 a[76:77], v12 offset:27680
    ds_read_b64_tr_b16 a[78:79], v12 offset:28064
    ds_read_b64_tr_b16 a[80:81], v12 offset:64
    ds_read_b64_tr_b16 a[82:83], v12 offset:448
    ds_read_b64_tr_b16 a[84:85], v12 offset:3136
    ds_read_b64_tr_b16 a[86:87], v12 offset:3520
    ds_read_b64_tr_b16 a[88:89], v12 offset:6208
    ds_read_b64_tr_b16 a[90:91], v12 offset:6592
    ds_read_b64_tr_b16 a[92:93], v12 offset:9280
    ds_read_b64_tr_b16 a[94:95], v12 offset:9664
    ds_read_b64_tr_b16 a[96:97], v12 offset:12352
    ds_read_b64_tr_b16 a[98:99], v12 offset:12736
    ds_read_b64_tr_b16 a[100:101], v12 offset:15424
    ds_read_b64_tr_b16 a[102:103], v12 offset:15808
    ds_read_b64_tr_b16 a[104:105], v12 offset:18496
    ds_read_b64_tr_b16 a[106:107], v12 offset:18880
    ds_read_b64_tr_b16 a[108:109], v12 offset:21568
    ds_read_b64_tr_b16 a[110:111], v12 offset:21952
    ds_read_b64_tr_b16 a[112:113], v12 offset:24640
    ds_read_b64_tr_b16 a[114:115], v12 offset:25024
    ds_read_b64_tr_b16 a[116:117], v12 offset:27712
    ds_read_b64_tr_b16 a[118:119], v12 offset:28096
    v_lshrrev_b32 v4, 2, v1
    v_mul_u32_u24 v4, 1280, v4
    v_and_b32 v5, 3, v1
    v_lshl_add_u32 v0, v5, 4, v4
    s_mul_i32 s4, s3, 491520
    s_lshl_b32 s5, s20, 6
    s_add_u32 s98, s4, s5
    s_mul_i32 s99, s3, 30720
    s_add_u32 s99, s99, 40960
    s_waitcnt lgkmcnt(0)
Xfb_b:
    s_sub_u32 s4, s29, 12
    s_cmp_lt_u32 s4, 8
    s_cbranch_scc0 Xfb_d
    s_cmp_ge_u32 s20, 20
    s_cbranch_scc1 Xfb_d
    s_mov_b32 m0, s99
    s_add_u32 s99, s99, 1024
    buffer_load_dwordx4 v0, s[92:95], s98 offen nt lds
    s_add_u32 s98, s98, 20480
    s_mov_b32 m0, s99
    s_add_u32 s99, s99, 1024
    buffer_load_dwordx4 v0, s[92:95], s98 offen nt lds
    s_add_u32 s98, s98, 20480
    s_mov_b32 m0, s99
    s_add_u32 s99, s99, 1024
    buffer_load_dwordx4 v0, s[92:95], s98 offen nt lds
    s_add_u32 s98, s98, 20480
Xfb_d:
    s_cmp_eq_u32 s29, 21
    s_cbranch_scc0 Xfb_c
    s_waitcnt vmcnt(0)
    v_lshrrev_b32 v12, 4, v1
    v_lshlrev_b32 v12, 3, v12
    v_bfe_u32 v13, v1, 2, 2
    v_add_u32 v12, v12, v13
    v_mul_u32_u24 v12, 64, v12
    v_and_b32 v13, 3, v1
    v_lshlrev_b32 v13, 3, v13
    v_add_u32 v12, v12, v13
    s_mul_i32 s4, s3, 30720
    s_add_u32 s4, s4, 40960
    v_add_u32 v12, s4, v12
    ds_read_b64_tr_b16 a[120:121], v12 offset:0
    ds_read_b64_tr_b16 a[122:123], v12 offset:256
    ds_read_b64_tr_b16 a[124:125], v12 offset:2048
    ds_read_b64_tr_b16 a[126:127], v12 offset:2304
    ds_read_b64_tr_b16 a[128:129], v12 offset:4096
    ds_read_b64_tr_b16 a[130:131], v12 offset:4352
    ds_read_b64_tr_b16 a[132:133], v12 offset:6144
    ds_read_b64_tr_b16 a[134:135], v12 offset:6400
    ds_read_b64_tr_b16 a[136:137], v12 offset:8192
    ds_read_b64_tr_b16 a[138:139], v12 offset:8448
    ds_read_b64_tr_b16 a[140:141], v12 offset:10240
    ds_read_b64_tr_b16 a[142:143], v12 offset:10496
    ds_read_b64_tr_b16 a[144:145], v12 offset:12288
    ds_read_b64_tr_b16 a[146:147], v12 offset:12544
    ds_read_b64_tr_b16 a[148:149], v12 offset:14336
    ds_read_b64_tr_b16 a[150:151], v12 offset:14592
    ds_read_b64_tr_b16 a[152:153], v12 offset:16384
    ds_read_b64_tr_b16 a[154:155], v12 offset:16640
    ds_read_b64_tr_b16 a[156:157], v12 offset:18432
    ds_read_b64_tr_b16 a[158:159], v12 offset:18688
    ds_read_b64_tr_b16 a[160:161], v12 offset:20480
    ds_read_b64_tr_b16 a[162:163], v12 offset:20736
    ds_read_b64_tr_b16 a[164:165], v12 offset:22528
    ds_read_b64_tr_b16 a[166:167], v12 offset:22784
    ds_read_b64_tr_b16 a[168:169], v12 offset:32
    ds_read_b64_tr_b16 a[170:171], v12 offset:288
    ds_read_b64_tr_b16 a[172:173], v12 offset:2080
    ds_read_b64_tr_b16 a[174:175], v12 offset:2336
    ds_read_b64_tr_b16 a[176:177], v12 offset:4128
    ds_read_b64_tr_b16 a[178:179], v12 offset:4384
    ds_read_b64_tr_b16 a[180:181], v12 offset:6176
    ds_read_b64_tr_b16 a[182:183], v12 offset:6432
    ds_read_b64_tr_b16 a[184:185], v12 offset:8224
    ds_read_b64_tr_b16 a[186:187], v12 offset:8480
    ds_read_b64_tr_b16 a[188:189], v12 offset:10272
    ds_read_b64_tr_b16 a[190:191], v12 offset:10528
    ds_read_b64_tr_b16 a[192:193], v12 offset:12320
    ds_read_b64_tr_b16 a[194:195], v12 offset:12576
    ds_read_b64_tr_b16 a[196:197], v12 offset:14368
    ds_read_b64_tr_b16 a[198:199], v12 offset:14624
    ds_read_b64_tr_b16 a[200:201], v12 offset:16416
    ds_read_b64_tr_b16 a[202:203], v12 offset:16672
    ds_read_b64_tr_b16 a[204:205], v12 offset:18464
    ds_read_b64_tr_b16 a[206:207], v12 offset:18720
    ds_read_b64_tr_b16 a[208:209], v12 offset:20512
    ds_read_b64_tr_b16 a[210:211], v12 offset:20768
    ds_read_b64_tr_b16 a[212:213], v12 offset:22560
    ds_read_b64_tr_b16 a[214:215], v12 offset:22816
    s_waitcnt lgkmcnt(0)
Xfb_c:
Xfb_e:
    s_branch Xf_loop
Xs_go:
    s_mul_i32 s26, s34, 12288
    s_add_u32 s26, s26, 356352
    s_lshl_b32 s4, s32, 9
    s_add_u32 s4, s4, 3072
    v_and_b32 v16, 0x1f0, v2
    v_add_u32 v16, s4, v16
    s_lshl_b32 s4, s32, 10
    v_add_u32 v17, s4, v2
    v_lshrrev_b32 v56, 4, v1
    v_lshlrev_b32 v57, 2, v56
    v_and_b32 v58, 15, v1
    v_sub_u32 v57, v57, v58
    s_lshl_b32 s4, s32, 4
    v_subrev_u32 v57, s4, v57
    v_and_b32 v56, 0x1f0, v2
    v_mov_b32 v58, 0xff800000
    s_lshl_b32 s37, s34, 1
    s_add_u32 s37, s37, s32
    s_lshl_b32 s37, s37, 10
    s_and_b32 s40, s34, 2
    s_add_u32 s40, s40, s32
    s_lshl_b32 s40, s40, 9
    s_and_b32 s4, s34, 1
    s_lshl_b32 s4, s4, 3
    s_add_u32 s40, s40, s4
    s_add_u32 s40, s40, 413696
    s_add_u32 s37, s37, 405504
    s_mov_b32 s41, 0x3dd53b95
    s_mov_b32 s21, 0
Xs_loop:
    s_and_b32 s36, s21, 3
    s_lshl_b32 s36, s36, 16
    s_add_u32 s36, s36, s22
    s_add_u32 s35, s36, s26
    s_add_u32 s21, s21, 1
    s_mov_b32 s31, 0
Xsw_l:
    buffer_load_dword v18, v15, s[8:11], s22 offen sc1
    s_waitcnt vmcnt(0)
Xsw_c:
    v_cmp_gt_u32 vcc, s21, v18
    s_cbranch_vccz Xsw_o
    s_sleep 1
    s_add_u32 s31, s31, 1
    s_cmp_lt_u32 s31, s30
    s_cbranch_scc1 Xsw_l
    s_mov_b32 s30, 1
Xsw_o:
    s_add_u32 s4, s35, 0
    buffer_load_dwordx4 v[60:63], v16, s[8:11], s4 offen offset:0 sc1
    buffer_load_dwordx4 v[64:67], v17, s[8:11], s4 offen offset:0 sc1
    buffer_load_dwordx4 v[68:71], v17, s[8:11], s4 offen offset:1024 sc1
    s_add_u32 s4, s35, 4096
    buffer_load_dwordx4 v[72:75], v16, s[8:11], s4 offen offset:0 sc1
    buffer_load_dwordx4 v[76:79], v17, s[8:11], s4 offen offset:0 sc1
    buffer_load_dwordx4 v[80:83], v17, s[8:11], s4 offen offset:1024 sc1
    s_add_u32 s4, s35, 8192
    buffer_load_dwordx4 v[84:87], v16, s[8:11], s4 offen offset:0 sc1
    buffer_load_dwordx4 v[88:91], v17, s[8:11], s4 offen offset:0 sc1
    buffer_load_dwordx4 v[92:95], v17, s[8:11], s4 offen offset:1024 sc1
    s_add_u32 s5, s36, s37
    s_add_u32 s6, s36, s40
    s_waitcnt vmcnt(3)
    v_pk_add_f32 v[60:61], v[60:61], v[72:73]
    v_pk_add_f32 v[62:63], v[62:63], v[74:75]
    v_pk_add_f32 v[64:65], v[64:65], v[76:77]
    v_pk_add_f32 v[66:67], v[66:67], v[78:79]
    v_pk_add_f32 v[68:69], v[68:69], v[80:81]
    v_pk_add_f32 v[70:71], v[70:71], v[82:83]
    s_waitcnt vmcnt(0)
    v_pk_add_f32 v[60:61], v[60:61], v[84:85]
    v_pk_add_f32 v[62:63], v[62:63], v[86:87]
    v_pk_add_f32 v[64:65], v[64:65], v[88:89]
    v_pk_add_f32 v[66:67], v[66:67], v[90:91]
    v_pk_add_f32 v[68:69], v[68:69], v[92:93]
    v_pk_add_f32 v[70:71], v[70:71], v[94:95]
    v_cmp_lt_u32 vcc, 31, v1
    s_nop 1
    v_cndmask_b32 v60, v58, v60, vcc
    v_cndmask_b32 v61, v58, v61, vcc
    v_cndmask_b32 v62, v58, v62, vcc
    v_cndmask_b32 v63, v58, v63, vcc
    v_cmp_ge_i32 vcc, 0, v57
    s_nop 1
    v_cndmask_b32 v64, v58, v64, vcc
    v_cmp_ge_i32 vcc, -1, v57
    s_nop 1
    v_cndmask_b32 v65, v58, v65, vcc
    v_cmp_ge_i32 vcc, -2, v57
    s_nop 1
    v_cndmask_b32 v66, v58, v66, vcc
    v_cmp_ge_i32 vcc, -3, v57
    s_nop 1
    v_cndmask_b32 v67, v58, v67, vcc
    v_cmp_ge_i32 vcc, -16, v57
    s_nop 1
    v_cndmask_b32 v68, v58, v68, vcc
    v_cmp_ge_i32 vcc, -17, v57
    s_nop 1
    v_cndmask_b32 v69, v58, v69, vcc
    v_cmp_ge_i32 vcc, -18, v57
    s_nop 1
    v_cndmask_b32 v70, v58, v70, vcc
    v_cmp_ge_i32 vcc, -19, v57
    s_nop 1
    v_cndmask_b32 v71, v58, v71, vcc
    v_max_f32 v44, v60, v61
    v_max3_f32 v44, v44, v62, v63
    v_max3_f32 v44, v44, v64, v65
    v_max3_f32 v44, v44, v66, v67
    v_max3_f32 v44, v44, v68, v69
    v_max3_f32 v44, v44, v70, v71
    v_mov_b32 v45, v44
    s_nop 1
    v_permlane16_swap_b32 v44, v45
    v_max_f32 v44, v44, v45
    v_mov_b32 v45, v44
    s_nop 1
    v_permlane32_swap_b32 v44, v45
    v_max_f32 v44, v44, v45
    v_mul_f32 v44, s41, v44
    v_fma_f32 v60, v60, s41, -v44
    v_fma_f32 v61, v61, s41, -v44
    v_fma_f32 v62, v62, s41, -v44
    v_fma_f32 v63, v63, s41, -v44
    v_fma_f32 v64, v64, s41, -v44
    v_fma_f32 v65, v65, s41, -v44
    v_fma_f32 v66, v66, s41, -v44
    v_fma_f32 v67, v67, s41, -v44
    v_fma_f32 v68, v68, s41, -v44
    v_fma_f32 v69, v69, s41, -v44
    v_fma_f32 v70, v70, s41, -v44
    v_fma_f32 v71, v71, s41, -v44
    v_exp_f32 v60, v60
    v_exp_f32 v61, v61
    v_exp_f32 v62, v62
    v_exp_f32 v63, v63
    v_exp_f32 v64, v64
    v_exp_f32 v65, v65
    v_exp_f32 v66, v66
    v_exp_f32 v67, v67
    v_exp_f32 v68, v68
    v_exp_f32 v69, v69
    v_exp_f32 v70, v70
    v_exp_f32 v71, v71
    v_add_f32 v44, v60, v61
    v_add_f32 v44, v44, v62
    v_add_f32 v44, v44, v63
    v_add_f32 v44, v44, v64
    v_add_f32 v44, v44, v65
    v_add_f32 v44, v44, v66
    v_add_f32 v44, v44, v67
    v_add_f32 v44, v44, v68
    v_add_f32 v44, v44, v69
    v_add_f32 v44, v44, v70
    v_add_f32 v44, v44, v71
    v_mov_b32 v45, v44
    s_nop 1
    v_permlane16_swap_b32 v44, v45
    v_add_f32 v44, v44, v45
    v_mov_b32 v45, v44
    s_nop 1
    v_permlane32_swap_b32 v44, v45
    v_add_f32 v44, v44, v45
    v_rcp_f32 v44, v44
    s_nop 0
    v_mul_f32 v60, v60, v44
    v_mul_f32 v61, v61, v44
    v_mul_f32 v62, v62, v44
    v_mul_f32 v63, v63, v44
    v_mul_f32 v64, v64, v44
    v_mul_f32 v65, v65, v44
    v_mul_f32 v66, v66, v44
    v_mul_f32 v67, v67, v44
    v_mul_f32 v68, v68, v44
    v_mul_f32 v69, v69, v44
    v_mul_f32 v70, v70, v44
    v_mul_f32 v71, v71, v44
    v_cvt_pk_bf16_f32 v48, v64, v65
    v_cvt_pk_bf16_f32 v49, v68, v69
    v_cvt_pk_bf16_f32 v50, v66, v67
    v_cvt_pk_bf16_f32 v51, v70, v71
    v_cvt_pk_bf16_f32 v52, v60, v61
    v_cvt_pk_bf16_f32 v53, v62, v63
    buffer_store_dwordx4 v[48:51], v2, s[8:11], s5 offen offset:0 sc1
    s_mov_b32 exec_lo, 0
    buffer_store_dwordx2 v[52:53], v56, s[8:11], s6 offen offset:0 sc1
    s_mov_b64 exec, -1
    s_waitcnt vmcnt(0)
    v_mov_b32 v10, s21
    s_mov_b64 exec, 1
    buffer_store_dword v10, v9, s[8:11], s33 offen sc1
    s_mov_b64 exec, -1
    s_cmp_eq_u32 s21, 64
    s_cbranch_scc1 X_join
    s_bitcmp1_b32 s21, 0
    s_cbranch_scc1 Xs_loop
    s_lshr_b32 s29, s21, 1
    s_sub_u32 s29, s29, 2
    s_cbranch_scc1 Xs_loop
    s_cmp_lt_u32 s29, 2
    s_cbranch_scc1 Xsb_e
    s_cmp_lt_u32 s29, 10
    s_cbranch_scc0 Xsb_a
    s_mov_b32 exec_hi, 0x0fffffff
    s_add_u32 m0, s99, 0
    s_nop 0
    buffer_load_dwordx4 v0, s[84:87], s98 offen nt lds
    s_add_u32 m0, s99, 15360
    s_nop 0
    buffer_load_dwordx4 v0, s[88:91], s98 offen nt lds
    s_add_u32 s98, s98, 30720
    s_add_u32 s99, s99, 960
    s_add_u32 m0, s99, 0
    s_nop 0
    buffer_load_dwordx4 v0, s[84:87], s98 offen nt lds
    s_add_u32 m0, s99, 15360
    s_nop 0
    buffer_load_dwordx4 v0, s[88:91], s98 offen nt lds
    s_add_u32 s98, s98, 30720
    s_add_u32 s99, s99, 960
    s_mov_b64 exec, -1
Xsb_a:
    s_cmp_eq_u32 s29, 11
    s_cbranch_scc0 Xsb_b
    s_waitcnt vmcnt(0)
    v_lshrrev_b32 v12, 4, v1
    v_lshlrev_b32 v12, 3, v12
    v_bfe_u32 v13, v1, 2, 2
    v_add_u32 v12, v12, v13
    v_mul_u32_u24 v12, 96, v12
    v_and_b32 v13, 3, v1
    v_lshlrev_b32 v13, 3, v13
    v_add_u32 v12, v12, v13
    s_mul_i32 s4, s3, 30720
    s_add_u32 s4, s4, 40960
    v_add_u32 v12, s4, v12
    ds_read_b64_tr_b16 a[0:1], v12 offset:0
    ds_read_b64_tr_b16 a[2:3], v12 offset:384
    ds_read_b64_tr_b16 a[4:5], v12 offset:3072
    ds_read_b64_tr_b16 a[6:7], v12 offset:3456
    ds_read_b64_tr_b16 a[8:9], v12 offset:6144
    ds_read_b64_tr_b16 a[10:11], v12 offset:6528
    ds_read_b64_tr_b16 a[12:13], v12 offset:9216
    ds_read_b64_tr_b16 a[14:15], v12 offset:9600
    ds_read_b64_tr_b16 a[16:17], v12 offset:12288
    ds_read_b64_tr_b16 a[18:19], v12 offset:12672
    ds_read_b64_tr_b16 a[20:21], v12 offset:15360
    ds_read_b64_tr_b16 a[22:23], v12 offset:15744
    ds_read_b64_tr_b16 a[24:25], v12 offset:18432
    ds_read_b64_tr_b16 a[26:27], v12 offset:18816
    ds_read_b64_tr_b16 a[28:29], v12 offset:21504
    ds_read_b64_tr_b16 a[30:31], v12 offset:21888
    ds_read_b64_tr_b16 a[32:33], v12 offset:24576
    ds_read_b64_tr_b16 a[34:35], v12 offset:24960
    ds_read_b64_tr_b16 a[36:37], v12 offset:27648
    ds_read_b64_tr_b16 a[38:39], v12 offset:28032
    ds_read_b64_tr_b16 a[40:41], v12 offset:32
    ds_read_b64_tr_b16 a[42:43], v12 offset:416
    ds_read_b64_tr_b16 a[44:45], v12 offset:3104
    ds_read_b64_tr_b16 a[46:47], v12 offset:3488
    ds_read_b64_tr_b16 a[48:49], v12 offset:6176
    ds_read_b64_tr_b16 a[50:51], v12 offset:6560
    ds_read_b64_tr_b16 a[52:53], v12 offset:9248
    ds_read_b64_tr_b16 a[54:55], v12 offset:9632
    ds_read_b64_tr_b16 a[56:57], v12 offset:12320
    ds_read_b64_tr_b16 a[58:59], v12 offset:12704
    ds_read_b64_tr_b16 a[60:61], v12 offset:15392
    ds_read_b64_tr_b16 a[62:63], v12 offset:15776
    ds_read_b64_tr_b16 a[64:65], v12 offset:18464
    ds_read_b64_tr_b16 a[66:67], v12 offset:18848
    ds_read_b64_tr_b16 a[68:69], v12 offset:21536
    ds_read_b64_tr_b16 a[70:71], v12 offset:21920
    ds_read_b64_tr_b16 a[72:73], v12 offset:24608
    ds_read_b64_tr_b16 a[74:75], v12 offset:24992
    ds_read_b64_tr_b16 a[76:77], v12 offset:27680
    ds_read_b64_tr_b16 a[78:79], v12 offset:28064
    ds_read_b64_tr_b16 a[80:81], v12 offset:64
    ds_read_b64_tr_b16 a[82:83], v12 offset:448
    ds_read_b64_tr_b16 a[84:85], v12 offset:3136
    ds_read_b64_tr_b16 a[86:87], v12 offset:3520
    ds_read_b64_tr_b16 a[88:89], v12 offset:6208
    ds_read_b64_tr_b16 a[90:91], v12 offset:6592
    ds_read_b64_tr_b16 a[92:93], v12 offset:9280
    ds_read_b64_tr_b16 a[94:95], v12 offset:9664
    ds_read_b64_tr_b16 a[96:97], v12 offset:12352
    ds_read_b64_tr_b16 a[98:99], v12 offset:12736
    ds_read_b64_tr_b16 a[100:101], v12 offset:15424
    ds_read_b64_tr_b16 a[102:103], v12 offset:15808
    ds_read_b64_tr_b16 a[104:105], v12 offset:18496
    ds_read_b64_tr_b16 a[106:107], v12 offset:18880
    ds_read_b64_tr_b16 a[108:109], v12 offset:21568
    ds_read_b64_tr_b16 a[110:111], v12 offset:21952
    ds_read_b64_tr_b16 a[112:113], v12 offset:24640
    ds_read_b64_tr_b16 a[114:115], v12 offset:25024
    ds_read_b64_tr_b16 a[116:117], v12 offset:27712
    ds_read_b64_tr_b16 a[118:119], v12 offset:28096
    v_lshrrev_b32 v4, 2, v1
    v_mul_u32_u24 v4, 1280, v4
    v_and_b32 v5, 3, v1
    v_lshl_add_u32 v0, v5, 4, v4
    s_mul_i32 s4, s3, 491520
    s_lshl_b32 s5, s20, 6
    s_add_u32 s98, s4, s5
    s_mul_i32 s99, s3, 30720
    s_add_u32 s99, s99, 40960
    s_waitcnt lgkmcnt(0)
Xsb_b:
    s_sub_u32 s4, s29, 12
    s_cmp_lt_u32 s4, 8
    s_cbranch_scc0 Xsb_d
    s_cmp_ge_u32 s20, 20
    s_cbranch_scc1 Xsb_d
    s_mov_b32 m0, s99
    s_add_u32 s99, s99, 1024
    buffer_load_dwordx4 v0, s[92:95], s98 offen nt lds
    s_add_u32 s98, s98, 20480
    s_mov_b32 m0, s99
    s_add_u32 s99, s99, 1024
    buffer_load_dwordx4 v0, s[92:95], s98 offen nt lds
    s_add_u32 s98, s98, 20480
    s_mov_b32 m0, s99
    s_add_u32 s99, s99, 1024
    buffer_load_dwordx4 v0, s[92:95], s98 offen nt lds
    s_add_u32 s98, s98, 20480
Xsb_d:
    s_cmp_eq_u32 s29, 21
    s_cbranch_scc0 Xsb_c
    s_waitcnt vmcnt(0)
    v_lshrrev_b32 v12, 4, v1
    v_lshlrev_b32 v12, 3, v12
    v_bfe_u32 v13, v1, 2, 2
    v_add_u32 v12, v12, v13
    v_mul_u32_u24 v12, 64, v12
    v_and_b32 v13, 3, v1
    v_lshlrev_b32 v13, 3, v13
    v_add_u32 v12, v12, v13
    s_mul_i32 s4, s3, 30720
    s_add_u32 s4, s4, 40960
    v_add_u32 v12, s4, v12
    ds_read_b64_tr_b16 a[120:121], v12 offset:0
    ds_read_b64_tr_b16 a[122:123], v12 offset:256
    ds_read_b64_tr_b16 a[124:125], v12 offset:2048
    ds_read_b64_tr_b16 a[126:127], v12 offset:2304
    ds_read_b64_tr_b16 a[128:129], v12 offset:4096
    ds_read_b64_tr_b16 a[130:131], v12 offset:4352
    ds_read_b64_tr_b16 a[132:133], v12 offset:6144
    ds_read_b64_tr_b16 a[134:135], v12 offset:6400
    ds_read_b64_tr_b16 a[136:137], v12 offset:8192
    ds_read_b64_tr_b16 a[138:139], v12 offset:8448
    ds_read_b64_tr_b16 a[140:141], v12 offset:10240
    ds_read_b64_tr_b16 a[142:143], v12 offset:10496
    ds_read_b64_tr_b16 a[144:145], v12 offset:12288
    ds_read_b64_tr_b16 a[146:147], v12 offset:12544
    ds_read_b64_tr_b16 a[148:149], v12 offset:14336
    ds_read_b64_tr_b16 a[150:151], v12 offset:14592
    ds_read_b64_tr_b16 a[152:153], v12 offset:16384
    ds_read_b64_tr_b16 a[154:155], v12 offset:16640
    ds_read_b64_tr_b16 a[156:157], v12 offset:18432
    ds_read_b64_tr_b16 a[158:159], v12 offset:18688
    ds_read_b64_tr_b16 a[160:161], v12 offset:20480
    ds_read_b64_tr_b16 a[162:163], v12 offset:20736
    ds_read_b64_tr_b16 a[164:165], v12 offset:22528
    ds_read_b64_tr_b16 a[166:167], v12 offset:22784
    ds_read_b64_tr_b16 a[168:169], v12 offset:32
    ds_read_b64_tr_b16 a[170:171], v12 offset:288
    ds_read_b64_tr_b16 a[172:173], v12 offset:2080
    ds_read_b64_tr_b16 a[174:175], v12 offset:2336
    ds_read_b64_tr_b16 a[176:177], v12 offset:4128
    ds_read_b64_tr_b16 a[178:179], v12 offset:4384
    ds_read_b64_tr_b16 a[180:181], v12 offset:6176
    ds_read_b64_tr_b16 a[182:183], v12 offset:6432
    ds_read_b64_tr_b16 a[184:185], v12 offset:8224
    ds_read_b64_tr_b16 a[186:187], v12 offset:8480
    ds_read_b64_tr_b16 a[188:189], v12 offset:10272
    ds_read_b64_tr_b16 a[190:191], v12 offset:10528
    ds_read_b64_tr_b16 a[192:193], v12 offset:12320
    ds_read_b64_tr_b16 a[194:195], v12 offset:12576
    ds_read_b64_tr_b16 a[196:197], v12 offset:14368
    ds_read_b64_tr_b16 a[198:199], v12 offset:14624
    ds_read_b64_tr_b16 a[200:201], v12 offset:16416
    ds_read_b64_tr_b16 a[202:203], v12 offset:16672
    ds_read_b64_tr_b16 a[204:205], v12 offset:18464
    ds_read_b64_tr_b16 a[206:207], v12 offset:18720
    ds_read_b64_tr_b16 a[208:209], v12 offset:20512
    ds_read_b64_tr_b16 a[210:211], v12 offset:20768
    ds_read_b64_tr_b16 a[212:213], v12 offset:22560
    ds_read_b64_tr_b16 a[214:215], v12 offset:22816
    s_waitcnt lgkmcnt(0)
Xsb_c:
Xsb_e:
    s_branch Xs_loop
X3_go:
    s_load_dwordx2 s[24:25], s[0:1], 64
    s_mov_b32 s26, 1280
    s_mov_b32 s27, 0x20000
    s_waitcnt lgkmcnt(0)
    v_lshlrev_b32 v3, 2, v1
    v_lshlrev_b32 v11, 3, v1
    s_mov_b32 s4, 5120
    buffer_load_dwordx2 v[146:147], v11, s[8:11], s4 offen offset:0 sc1
    buffer_load_dwordx2 v[148:149], v11, s[8:11], s4 offen offset:512 sc1
    buffer_load_dwordx2 v[150:151], v11, s[8:11], s4 offen offset:1024 sc1
    buffer_load_dwordx2 v[152:153], v11, s[8:11], s4 offen offset:1536 sc1
    buffer_load_dwordx2 v[154:155], v11, s[8:11], s4 offen offset:2048 sc1
    s_mov_b32 s5, 7680
    s_mov_b32 s6, 10240
    s_mov_b32 s7, 12800
    buffer_load_dwordx2 v[100:101], v11, s[8:11], s5 offen offset:0 sc1
    buffer_load_dwordx2 v[110:111], v11, s[8:11], s6 offen offset:0 sc1
    buffer_load_dwordx2 v[120:121], v11, s[8:11], s7 offen offset:0 sc1
    buffer_load_dword v140, v3, s[24:27], 0 offen offset:0
    buffer_load_dwordx2 v[102:103], v11, s[8:11], s5 offen offset:512 sc1
    buffer_load_dwordx2 v[112:113], v11, s[8:11], s6 offen offset:512 sc1
    buffer_load_dwordx2 v[122:123], v11, s[8:11], s7 offen offset:512 sc1
    buffer_load_dword v141, v3, s[24:27], 0 offen offset:256
    buffer_load_dwordx2 v[104:105], v11, s[8:11], s5 offen offset:1024 sc1
    buffer_load_dwordx2 v[114:115], v11, s[8:11], s6 offen offset:1024 sc1
    buffer_load_dwordx2 v[124:125], v11, s[8:11], s7 offen offset:1024 sc1
    buffer_load_dword v142, v3, s[24:27], 0 offen offset:512
    buffer_load_dwordx2 v[106:107], v11, s[8:11], s5 offen offset:1536 sc1
    buffer_load_dwordx2 v[116:117], v11, s[8:11], s6 offen offset:1536 sc1
    buffer_load_dwordx2 v[126:127], v11, s[8:11], s7 offen offset:1536 sc1
    buffer_load_dword v143, v3, s[24:27], 0 offen offset:768
    buffer_load_dwordx2 v[108:109], v11, s[8:11], s5 offen offset:2048 sc1
    buffer_load_dwordx2 v[118:119], v11, s[8:11], s6 offen offset:2048 sc1
    buffer_load_dwordx2 v[128:129], v11, s[8:11], s7 offen offset:2048 sc1
    buffer_load_dword v144, v3, s[24:27], 0 offen offset:1024
    s_waitcnt vmcnt(0)
    v_add_f32 v110, 1.0, v110
    v_cvt_pk_bf16_f32 v110, v110, v110
    v_and_b32 v110, 0xffff0000, v110
    v_add_f32 v111, 1.0, v111
    v_cvt_pk_bf16_f32 v111, v111, v111
    v_and_b32 v111, 0xffff0000, v111
    v_add_f32 v112, 1.0, v112
    v_cvt_pk_bf16_f32 v112, v112, v112
    v_and_b32 v112, 0xffff0000, v112
    v_add_f32 v113, 1.0, v113
    v_cvt_pk_bf16_f32 v113, v113, v113
    v_and_b32 v113, 0xffff0000, v113
    v_add_f32 v114, 1.0, v114
    v_cvt_pk_bf16_f32 v114, v114, v114
    v_and_b32 v114, 0xffff0000, v114
    v_add_f32 v115, 1.0, v115
    v_cvt_pk_bf16_f32 v115, v115, v115
    v_and_b32 v115, 0xffff0000, v115
    v_add_f32 v116, 1.0, v116
    v_cvt_pk_bf16_f32 v116, v116, v116
    v_and_b32 v116, 0xffff0000, v116
    v_add_f32 v117, 1.0, v117
    v_cvt_pk_bf16_f32 v117, v117, v117
    v_and_b32 v117, 0xffff0000, v117
    v_add_f32 v118, 1.0, v118
    v_cvt_pk_bf16_f32 v118, v118, v118
    v_and_b32 v118, 0xffff0000, v118
    v_add_f32 v119, 1.0, v119
    v_cvt_pk_bf16_f32 v119, v119, v119
    v_and_b32 v119, 0xffff0000, v119
    v_lshlrev_b32 v130, 16, v140
    v_and_b32 v131, 0xffff0000, v140
    v_lshlrev_b32 v132, 16, v141
    v_and_b32 v133, 0xffff0000, v141
    v_lshlrev_b32 v134, 16, v142
    v_and_b32 v135, 0xffff0000, v142
    v_lshlrev_b32 v136, 16, v143
    v_and_b32 v137, 0xffff0000, v143
    v_lshlrev_b32 v138, 16, v144
    v_and_b32 v139, 0xffff0000, v144
    s_sub_u32 s21, s28, 2
    s_lshl_b32 s28, s28, 2
    s_add_u32 s28, s28, s3
    s_lshl_b32 s4, s21, 5
    s_add_u32 s4, s4, s96
    s_mul_i32 s4, s4, 1280
    v_mov_b32 v20, 0
    s_lshl_b32 s42, s96, 7
    s_add_u32 s42, s42, 61997056
    buffer_load_dword v224, v3, s[12:15], s4 offen offset:0
    buffer_load_dword v225, v3, s[12:15], s4 offen offset:256
    buffer_load_dword v226, v3, s[12:15], s4 offen offset:512
    buffer_load_dword v227, v3, s[12:15], s4 offen offset:768
    buffer_load_dword v228, v3, s[12:15], s4 offen offset:1024
X3_loop:
    s_cmp_lt_u32 s21, 57
    s_cselect_b32 s4, 5, 4
    s_add_u32 s35, s21, s4
    s_mov_b32 s41, s42
    s_mov_b32 s40, 1
    s_cmp_ge_u32 s21, 60
    s_cselect_b32 s35, -1, s35
    s_waitcnt vmcnt(21)
    v_cmp_gt_u32 vcc, s35, v20
    s_cbranch_vccz X3w_o
    s_waitcnt vmcnt(0)
    s_mov_b64 exec, 1
    buffer_store_dword v9, v3, s[8:11], s42 offen sc1
    s_mov_b64 exec, -1
    s_mov_b32 s40, 0
    s_cmp_ge_u32 s21, 60
    s_cbranch_scc1 X_join
    s_mov_b32 s31, 0
X3w_l:
    buffer_load_dword v18, v15, s[8:11], s22 offen sc1
    s_waitcnt vmcnt(0)
X3w_c:
    v_cmp_gt_u32 vcc, s35, v18
    s_cbranch_vccz X3w_o
    s_sleep 4
    s_add_u32 s31, s31, 1
    s_cmp_lt_u32 s31, s30
    s_cbranch_scc1 X3w_l
    s_mov_b32 s30, 1
X3w_o:
    v_lshrrev_b32 v16, 3, v1
    v_lshlrev_b32 v16, 7, v16
    v_and_b32 v17, 7, v1
    v_lshl_add_u32 v16, v17, 2, v16
    s_lshl_b32 s4, s3, 5
    v_add_u32 v16, s4, v16
    s_lshl_b32 s4, s21, 5
    s_add_u32 s4, s4, s96
    s_mul_i32 s24, s4, 1280
    s_add_u32 s25, s24, 59244544
    s_lshr_b32 s5, s4, 2
    s_lshl_b32 s5, s5, 7
    s_lshl_b32 s6, s3, 2
    s_add_u32 s5, s5, s6
    s_add_u32 s42, s5, 61865984
    s_mul_i32 s35, s21, 524288
    s_lshr_b32 s4, s96, 2
    s_mul_i32 s4, s4, 49152
    s_add_u32 s35, s35, s4
    s_add_u32 s35, s35, 23068672
    s_call_b64 s[100:101], T3_sub
    s_add_u32 s4, s24, 56623104
    buffer_store_dword v140, v3, s[8:11], s4 offen offset:0 sc1
    buffer_store_dword v141, v3, s[8:11], s4 offen offset:256 sc1
    buffer_store_dword v142, v3, s[8:11], s4 offen offset:512 sc1
    buffer_store_dword v143, v3, s[8:11], s4 offen offset:768 sc1
    buffer_store_dword v144, v3, s[8:11], s4 offen offset:1024 sc1
    s_add_u32 s21, s21, 2
    s_cmp_ge_u32 s21, 60
    s_cbranch_scc1 X3_loop
    s_lshr_b32 s29, s21, 1
    s_cmp_lt_u32 s29, 2
    s_cbranch_scc1 X3b_e
    s_cmp_lt_u32 s29, 10
    s_cbranch_scc0 X3b_a
    s_mov_b32 exec_hi, 0x0fffffff
    s_add_u32 m0, s99, 0
    s_nop 0
    buffer_load_dwordx4 v0, s[84:87], s98 offen nt lds
    s_add_u32 m0, s99, 15360
    s_nop 0
    buffer_load_dwordx4 v0, s[88:91], s98 offen nt lds
    s_add_u32 s98, s98, 30720
    s_add_u32 s99, s99, 960
    s_add_u32 m0, s99, 0
    s_nop 0
    buffer_load_dwordx4 v0, s[84:87], s98 offen nt lds
    s_add_u32 m0, s99, 15360
    s_nop 0
    buffer_load_dwordx4 v0, s[88:91], s98 offen nt lds
    s_add_u32 s98, s98, 30720
    s_add_u32 s99, s99, 960
    s_mov_b64 exec, -1
X3b_a:
    s_cmp_eq_u32 s29, 11
    s_cbranch_scc0 X3b_b
    s_waitcnt vmcnt(0)
    v_lshrrev_b32 v12, 4, v1
    v_lshlrev_b32 v12, 3, v12
    v_bfe_u32 v13, v1, 2, 2
    v_add_u32 v12, v12, v13
    v_mul_u32_u24 v12, 96, v12
    v_and_b32 v13, 3, v1
    v_lshlrev_b32 v13, 3, v13
    v_add_u32 v12, v12, v13
    s_mul_i32 s4, s3, 30720
    s_add_u32 s4, s4, 40960
    v_add_u32 v12, s4, v12
    ds_read_b64_tr_b16 a[0:1], v12 offset:0
    ds_read_b64_tr_b16 a[2:3], v12 offset:384
    ds_read_b64_tr_b16 a[4:5], v12 offset:3072
    ds_read_b64_tr_b16 a[6:7], v12 offset:3456
    ds_read_b64_tr_b16 a[8:9], v12 offset:6144
    ds_read_b64_tr_b16 a[10:11], v12 offset:6528
    ds_read_b64_tr_b16 a[12:13], v12 offset:9216
    ds_read_b64_tr_b16 a[14:15], v12 offset:9600
    ds_read_b64_tr_b16 a[16:17], v12 offset:12288
    ds_read_b64_tr_b16 a[18:19], v12 offset:12672
    ds_read_b64_tr_b16 a[20:21], v12 offset:15360
    ds_read_b64_tr_b16 a[22:23], v12 offset:15744
    ds_read_b64_tr_b16 a[24:25], v12 offset:18432
    ds_read_b64_tr_b16 a[26:27], v12 offset:18816
    ds_read_b64_tr_b16 a[28:29], v12 offset:21504
    ds_read_b64_tr_b16 a[30:31], v12 offset:21888
    ds_read_b64_tr_b16 a[32:33], v12 offset:24576
    ds_read_b64_tr_b16 a[34:35], v12 offset:24960
    ds_read_b64_tr_b16 a[36:37], v12 offset:27648
    ds_read_b64_tr_b16 a[38:39], v12 offset:28032
    ds_read_b64_tr_b16 a[40:41], v12 offset:32
    ds_read_b64_tr_b16 a[42:43], v12 offset:416
    ds_read_b64_tr_b16 a[44:45], v12 offset:3104
    ds_read_b64_tr_b16 a[46:47], v12 offset:3488
    ds_read_b64_tr_b16 a[48:49], v12 offset:6176
    ds_read_b64_tr_b16 a[50:51], v12 offset:6560
    ds_read_b64_tr_b16 a[52:53], v12 offset:9248
    ds_read_b64_tr_b16 a[54:55], v12 offset:9632
    ds_read_b64_tr_b16 a[56:57], v12 offset:12320
    ds_read_b64_tr_b16 a[58:59], v12 offset:12704
    ds_read_b64_tr_b16 a[60:61], v12 offset:15392
    ds_read_b64_tr_b16 a[62:63], v12 offset:15776
    ds_read_b64_tr_b16 a[64:65], v12 offset:18464
    ds_read_b64_tr_b16 a[66:67], v12 offset:18848
    ds_read_b64_tr_b16 a[68:69], v12 offset:21536
    ds_read_b64_tr_b16 a[70:71], v12 offset:21920
    ds_read_b64_tr_b16 a[72:73], v12 offset:24608
    ds_read_b64_tr_b16 a[74:75], v12 offset:24992
    ds_read_b64_tr_b16 a[76:77], v12 offset:27680
    ds_read_b64_tr_b16 a[78:79], v12 offset:28064
    ds_read_b64_tr_b16 a[80:81], v12 offset:64
    ds_read_b64_tr_b16 a[82:83], v12 offset:448
    ds_read_b64_tr_b16 a[84:85], v12 offset:3136
    ds_read_b64_tr_b16 a[86:87], v12 offset:3520
    ds_read_b64_tr_b16 a[88:89], v12 offset:6208
    ds_read_b64_tr_b16 a[90:91], v12 offset:6592
    ds_read_b64_tr_b16 a[92:93], v12 offset:9280
    ds_read_b64_tr_b16 a[94:95], v12 offset:9664
    ds_read_b64_tr_b16 a[96:97], v12 offset:12352
    ds_read_b64_tr_b16 a[98:99], v12 offset:12736
    ds_read_b64_tr_b16 a[100:101], v12 offset:15424
    ds_read_b64_tr_b16 a[102:103], v12 offset:15808
    ds_read_b64_tr_b16 a[104:105], v12 offset:18496
    ds_read_b64_tr_b16 a[106:107], v12 offset:18880
    ds_read_b64_tr_b16 a[108:109], v12 offset:21568
    ds_read_b64_tr_b16 a[110:111], v12 offset:21952
    ds_read_b64_tr_b16 a[112:113], v12 offset:24640
    ds_read_b64_tr_b16 a[114:115], v12 offset:25024
    ds_read_b64_tr_b16 a[116:117], v12 offset:27712
    ds_read_b64_tr_b16 a[118:119], v12 offset:28096
    v_lshrrev_b32 v4, 2, v1
    v_mul_u32_u24 v4, 1280, v4
    v_and_b32 v5, 3, v1
    v_lshl_add_u32 v0, v5, 4, v4
    s_mul_i32 s4, s3, 491520
    s_lshl_b32 s5, s20, 6
    s_add_u32 s98, s4, s5
    s_mul_i32 s99, s3, 30720
    s_add_u32 s99, s99, 40960
    s_waitcnt lgkmcnt(0)
X3b_b:
    s_sub_u32 s4, s29, 12
    s_cmp_lt_u32 s4, 8
    s_cbranch_scc0 X3b_d
    s_cmp_ge_u32 s20, 20
    s_cbranch_scc1 X3b_d
    s_mov_b32 m0, s99
    s_add_u32 s99, s99, 1024
    buffer_load_dwordx4 v0, s[92:95], s98 offen nt lds
    s_add_u32 s98, s98, 20480
    s_mov_b32 m0, s99
    s_add_u32 s99, s99, 1024
    buffer_load_dwordx4 v0, s[92:95], s98 offen nt lds
    s_add_u32 s98, s98, 20480
    s_mov_b32 m0, s99
    s_add_u32 s99, s99, 1024
    buffer_load_dwordx4 v0, s[92:95], s98 offen nt lds
    s_add_u32 s98, s98, 20480
X3b_d:
    s_cmp_eq_u32 s29, 21
    s_cbranch_scc0 X3b_c
    s_waitcnt vmcnt(0)
    v_lshrrev_b32 v12, 4, v1
    v_lshlrev_b32 v12, 3, v12
    v_bfe_u32 v13, v1, 2, 2
    v_add_u32 v12, v12, v13
    v_mul_u32_u24 v12, 64, v12
    v_and_b32 v13, 3, v1
    v_lshlrev_b32 v13, 3, v13
    v_add_u32 v12, v12, v13
    s_mul_i32 s4, s3, 30720
    s_add_u32 s4, s4, 40960
    v_add_u32 v12, s4, v12
    ds_read_b64_tr_b16 a[120:121], v12 offset:0
    ds_read_b64_tr_b16 a[122:123], v12 offset:256
    ds_read_b64_tr_b16 a[124:125], v12 offset:2048
    ds_read_b64_tr_b16 a[126:127], v12 offset:2304
    ds_read_b64_tr_b16 a[128:129], v12 offset:4096
    ds_read_b64_tr_b16 a[130:131], v12 offset:4352
    ds_read_b64_tr_b16 a[132:133], v12 offset:6144
    ds_read_b64_tr_b16 a[134:135], v12 offset:6400
    ds_read_b64_tr_b16 a[136:137], v12 offset:8192
    ds_read_b64_tr_b16 a[138:139], v12 offset:8448
    ds_read_b64_tr_b16 a[140:141], v12 offset:10240
    ds_read_b64_tr_b16 a[142:143], v12 offset:10496
    ds_read_b64_tr_b16 a[144:145], v12 offset:12288
    ds_read_b64_tr_b16 a[146:147], v12 offset:12544
    ds_read_b64_tr_b16 a[148:149], v12 offset:14336
    ds_read_b64_tr_b16 a[150:151], v12 offset:14592
    ds_read_b64_tr_b16 a[152:153], v12 offset:16384
    ds_read_b64_tr_b16 a[154:155], v12 offset:16640
    ds_read_b64_tr_b16 a[156:157], v12 offset:18432
    ds_read_b64_tr_b16 a[158:159], v12 offset:18688
    ds_read_b64_tr_b16 a[160:161], v12 offset:20480
    ds_read_b64_tr_b16 a[162:163], v12 offset:20736
    ds_read_b64_tr_b16 a[164:165], v12 offset:22528
    ds_read_b64_tr_b16 a[166:167], v12 offset:22784
    ds_read_b64_tr_b16 a[168:169], v12 offset:32
    ds_read_b64_tr_b16 a[170:171], v12 offset:288
    ds_read_b64_tr_b16 a[172:173], v12 offset:2080
    ds_read_b64_tr_b16 a[174:175], v12 offset:2336
    ds_read_b64_tr_b16 a[176:177], v12 offset:4128
    ds_read_b64_tr_b16 a[178:179], v12 offset:4384
    ds_read_b64_tr_b16 a[180:181], v12 offset:6176
    ds_read_b64_tr_b16 a[182:183], v12 offset:6432
    ds_read_b64_tr_b16 a[184:185], v12 offset:8224
    ds_read_b64_tr_b16 a[186:187], v12 offset:8480
    ds_read_b64_tr_b16 a[188:189], v12 offset:10272
    ds_read_b64_tr_b16 a[190:191], v12 offset:10528
    ds_read_b64_tr_b16 a[192:193], v12 offset:12320
    ds_read_b64_tr_b16 a[194:195], v12 offset:12576
    ds_read_b64_tr_b16 a[196:197], v12 offset:14368
    ds_read_b64_tr_b16 a[198:199], v12 offset:14624
    ds_read_b64_tr_b16 a[200:201], v12 offset:16416
    ds_read_b64_tr_b16 a[202:203], v12 offset:16672
    ds_read_b64_tr_b16 a[204:205], v12 offset:18464
    ds_read_b64_tr_b16 a[206:207], v12 offset:18720
    ds_read_b64_tr_b16 a[208:209], v12 offset:20512
    ds_read_b64_tr_b16 a[210:211], v12 offset:20768
    ds_read_b64_tr_b16 a[212:213], v12 offset:22560
    ds_read_b64_tr_b16 a[214:215], v12 offset:22816
    s_waitcnt lgkmcnt(0)
X3b_c:
X3b_e:
    s_cmp_lg_u32 s28, 8
    s_cbranch_scc1 X3_loop
    s_cmp_lt_u32 s29, 4
    s_cbranch_scc1 X3_loop
    s_call_b64 s[100:101], XG_sub
    s_branch X3_loop
X_join:
    s_add_u32 s26, s22, 156160
    v_and_b32 v4, 7, v1
    v_lshlrev_b32 v4, 5, v4
    v_lshrrev_b32 v5, 4, v1
    v_lshl_add_u32 v16, v5, 3, v4
    s_mul_i32 s4, s20, 768
    s_lshl_b32 s5, s3, 8
    s_add_u32 s4, s4, s5
    v_add_u32 v16, s4, v16
    v_lshlrev_b32 v18, 4, v5
    v_and_b32 v17, 16, v18
    v_add_u32 v17, v17, v4
    v_lshrrev_b32 v4, 5, v1
    v_lshl_add_u32 v17, v4, 8, v17
    s_mul_i32 s4, s3, 6144
    v_add_u32 v17, s4, v17
    v_add_u32 v32, 3072, v17
    s_mul_i32 s4, s3, 6144
    v_add_u32 v19, s4, v2
    s_lshl_b32 s4, s3, 11
    v_add_u32 v20, s4, v2
    s_lshl_b32 s4, s3, 10
    v_add_u32 v21, s4, v2
    s_lshl_b32 s22, s20, 6
    s_and_b32 s4, s3, 1
    s_lshl_b32 s4, s4, 5
    s_add_u32 s22, s22, s4
    s_min_u32 s22, s22, 1248
    s_lshl_b32 s4, s22, 1
    s_add_u32 s4, s4, 12800
    buffer_load_dwordx4 v[22:25], v18, s[8:11], s4 offen sc1
    v_and_b32 v27, 7, v1
    v_lshlrev_b32 v27, 2, v27
    s_cmp_lg_u32 s28, 8
    s_cbranch_scc1 XE_b
XE_m:
    s_call_b64 s[100:101], XG_sub
    s_cmp_lt_u32 s43, 1920
    s_cbranch_scc1 XE_m
    v_writelane_b32 v26, s44, 0
    v_writelane_b32 v26, s45, 1
    v_writelane_b32 v26, s46, 2
    v_writelane_b32 v26, s47, 3
    v_writelane_b32 v26, s38, 4
    v_writelane_b32 v26, s39, 5
    v_writelane_b32 v26, s48, 6
    v_writelane_b32 v26, s49, 7
    s_mov_b64 exec, 0xff
    buffer_store_dword v26, v27, s[8:11], s26 offen sc1
    s_mov_b64 exec, -1
XE_b:
    s_mov_b32 s31, 0
XL_l:
    buffer_load_dword v26, v27, s[8:11], s26 offen sc1
    s_waitcnt vmcnt(0)
XL_c:
    v_cmp_gt_u32 vcc, 1, v26
    s_cbranch_vccz XL_o
    s_sleep 1
    s_add_u32 s31, s31, 1
    s_cmp_lt_u32 s31, s30
    s_cbranch_scc1 XL_l
    s_mov_b32 s30, 1
XL_o:
    s_mov_b32 s43, 1920
    v_readlane_b32 s44, v26, 0
    v_readlane_b32 s45, v26, 1
    v_readlane_b32 s46, v26, 2
    v_readlane_b32 s47, v26, 3
    v_readlane_b32 s38, v26, 4
    v_readlane_b32 s39, v26, 5
    v_readlane_b32 s48, v26, 6
    v_readlane_b32 s49, v26, 7
    s_mov_b32 s97, 1
    s_mov_b32 s23, 61931520
    s_call_b64 s[100:101], XM_sub
    s_mov_b32 s27, 0
    s_call_b64 s[100:101], XG_sub
    s_call_b64 s[100:101], XG_sub
    s_cmp_eq_u32 s27, 0
    s_cbranch_scc1 XE_st
    s_mov_b32 s23, 61956096
    s_call_b64 s[100:101], XM_sub
XE_st:
    s_cmp_ge_u32 s20, 20
    s_cbranch_scc1 XE_e
    s_cmp_ge_u32 s3, 2
    s_cbranch_scc1 XE_e
    s_mov_b32 exec_lo, 0x00ff00ff
    s_mov_b32 exec_hi, 0x00ff00ff
    buffer_store_dwordx2 v[28:29], v27, s[16:19], 0 offen sc1
    s_mov_b64 exec, -1
XE_e:
    s_branch R_done
XM_sub:
    s_barrier
    s_mov_b32 exec_lo, 0x01010101
    s_mov_b32 exec_hi, 0x01010101
    v_mov_b32 v26, s44
    s_lshl_b64 exec, exec, 1
    v_mov_b32 v26, s45
    s_lshl_b64 exec, exec, 1
    v_mov_b32 v26, s46
    s_lshl_b64 exec, exec, 1
    v_mov_b32 v26, s47
    s_lshl_b64 exec, exec, 1
    v_mov_b32 v26, s38
    s_lshl_b64 exec, exec, 1
    v_mov_b32 v26, s39
    s_lshl_b64 exec, exec, 1
    v_mov_b32 v26, s48
    s_lshl_b64 exec, exec, 1
    v_mov_b32 v26, s49
    s_mov_b64 exec, -1
    v_and_b32 v27, 0x7ff, v26
    v_sub_u32 v27, 0x7ff, v27
    v_mul_u32_u24 v27, 1280, v27
    v_add_u32 v30, v27, v18
    s_mul_i32 s5, s3, 320
    s_add_u32 s5, s5, 59244544
    s_mov_b32 s31, 0
XH_l:
    buffer_load_dwordx4 v[96:99], v30, s[8:11], s5 offen offset:0 sc1
    buffer_load_dwordx4 v[100:103], v30, s[8:11], s5 offen offset:64 sc1
    buffer_load_dwordx4 v[104:107], v30, s[8:11], s5 offen offset:128 sc1
    buffer_load_dwordx4 v[108:111], v30, s[8:11], s5 offen offset:192 sc1
    buffer_load_dwordx4 v[112:115], v30, s[8:11], s5 offen offset:256 sc1
    s_waitcnt vmcnt(0)
    v_max3_u32 v31, v96, v97, v98
    v_max3_u32 v31, v31, v99, v100
    v_max3_u32 v31, v31, v101, v102
    v_max3_u32 v31, v31, v103, v104
    v_max3_u32 v31, v31, v105, v106
    v_max3_u32 v31, v31, v107, v108
    v_max3_u32 v31, v31, v109, v110
    v_max3_u32 v31, v31, v111, v112
    v_max3_u32 v31, v31, v113, v114
    v_max_u32 v31, v31, v115
    v_cmp_eq_u32 vcc, -1, v31
    s_cbranch_vccz XH_o
    s_sleep 1
    s_add_u32 s31, s31, 1
    s_cmp_lt_u32 s31, s30
    s_cbranch_scc1 XH_l
    s_mov_b32 s30, 1
XH_o:
    v_mfma_f32_16x16x32_bf16 v[116:119], a[0:3], v[96:99], 0
    v_mfma_f32_16x16x32_bf16 v[120:123], a[20:23], v[96:99], 0
    v_mfma_f32_16x16x32_bf16 v[124:127], a[40:43], v[96:99], 0
    v_mfma_f32_16x16x32_bf16 v[128:131], a[60:63], v[96:99], 0
    v_mfma_f32_16x16x32_bf16 v[132:135], a[80:83], v[96:99], 0
    v_mfma_f32_16x16x32_bf16 v[136:139], a[100:103], v[96:99], 0
    v_mfma_f32_16x16x32_bf16 v[116:119], a[4:7], v[100:103], v[116:119]
    v_mfma_f32_16x16x32_bf16 v[120:123], a[24:27], v[100:103], v[120:123]
    v_mfma_f32_16x16x32_bf16 v[124:127], a[44:47], v[100:103], v[124:127]
    v_mfma_f32_16x16x32_bf16 v[128:131], a[64:67], v[100:103], v[128:131]
    v_mfma_f32_16x16x32_bf16 v[132:135], a[84:87], v[100:103], v[132:135]
    v_mfma_f32_16x16x32_bf16 v[136:139], a[104:107], v[100:103], v[136:139]
    v_mfma_f32_16x16x32_bf16 v[116:119], a[8:11], v[104:107], v[116:119]
    v_mfma_f32_16x16x32_bf16 v[120:123], a[28:31], v[104:107], v[120:123]
    v_mfma_f32_16x16x32_bf16 v[124:127], a[48:51], v[104:107], v[124:127]
    v_mfma_f32_16x16x32_bf16 v[128:131], a[68:71], v[104:107], v[128:131]
    v_mfma_f32_16x16x32_bf16 v[132:135], a[88:91], v[104:107], v[132:135]
    v_mfma_f32_16x16x32_bf16 v[136:139], a[108:111], v[104:107], v[136:139]
    v_mfma_f32_16x16x32_bf16 v[116:119], a[12:15], v[108:111], v[116:119]
    v_mfma_f32_16x16x32_bf16 v[120:123], a[32:35], v[108:111], v[120:123]
    v_mfma_f32_16x16x32_bf16 v[124:127], a[52:55], v[108:111], v[124:127]
    v_mfma_f32_16x16x32_bf16 v[128:131], a[72:75], v[108:111], v[128:131]
    v_mfma_f32_16x16x32_bf16 v[132:135], a[92:95], v[108:111], v[132:135]
    v_mfma_f32_16x16x32_bf16 v[136:139], a[112:115], v[108:111], v[136:139]
    v_mfma_f32_16x16x32_bf16 v[116:119], a[16:19], v[112:115], v[116:119]
    v_mfma_f32_16x16x32_bf16 v[120:123], a[36:39], v[112:115], v[120:123]
    v_mfma_f32_16x16x32_bf16 v[124:127], a[56:59], v[112:115], v[124:127]
    v_mfma_f32_16x16x32_bf16 v[128:131], a[76:79], v[112:115], v[128:131]
    v_mfma_f32_16x16x32_bf16 v[132:135], a[96:99], v[112:115], v[132:135]
    v_mfma_f32_16x16x32_bf16 v[136:139], a[116:119], v[112:115], v[136:139]
    ds_write_b128 v19, v[116:119] offset:0
    ds_write_b128 v19, v[120:123] offset:1024
    ds_write_b128 v19, v[124:127] offset:2048
    ds_write_b128 v19, v[128:131] offset:3072
    ds_write_b128 v19, v[132:135] offset:4096
    s_nop 2
    ds_write_b128 v19, v[136:139] offset:5120
    v_lshrrev_b32 v30, 1, v18
    v_add3_u32 v27, v27, v30, s22
    s_waitcnt lgkmcnt(0)
    s_barrier
    s_cmp_eq_u32 s3, 3
    s_cbranch_scc1 XM_ng
    ds_read_b128 v[96:99], v20 offset:0
    ds_read_b128 v[100:103], v20 offset:1024
    ds_read_b128 v[104:107], v20 offset:6144
    ds_read_b128 v[108:111], v20 offset:7168
    ds_read_b128 v[112:115], v20 offset:12288
    ds_read_b128 v[116:119], v20 offset:13312
    ds_read_b128 v[120:123], v20 offset:18432
    ds_read_b128 v[124:127], v20 offset:19456
    s_waitcnt lgkmcnt(4)
    v_pk_add_f32 v[96:97], v[96:97], v[104:105]
    v_pk_add_f32 v[98:99], v[98:99], v[106:107]
    v_pk_add_f32 v[100:101], v[100:101], v[108:109]
    v_pk_add_f32 v[102:103], v[102:103], v[110:111]
    s_waitcnt lgkmcnt(2)
    v_pk_add_f32 v[96:97], v[96:97], v[112:113]
    v_pk_add_f32 v[98:99], v[98:99], v[114:115]
    v_pk_add_f32 v[100:101], v[100:101], v[116:117]
    v_pk_add_f32 v[102:103], v[102:103], v[118:119]
    s_waitcnt lgkmcnt(0)
    v_pk_add_f32 v[96:97], v[96:97], v[120:121]
    v_pk_add_f32 v[98:99], v[98:99], v[122:123]
    v_pk_add_f32 v[100:101], v[100:101], v[124:125]
    v_pk_add_f32 v[102:103], v[102:103], v[126:127]
    v_cvt_pk_bf16_f32 v100, v96, v100
    v_lshlrev_b32 v96, 16, v100
    v_and_b32 v100, 0xffff0000, v100
    v_mul_f32 v108, 0xbfb8aa3b, v96
    v_exp_f32 v108, v108
    s_nop 0
    v_add_f32 v108, 1.0, v108
    v_rcp_f32 v104, v108
    v_cvt_pk_bf16_f32 v101, v97, v101
    v_lshlrev_b32 v97, 16, v101
    v_and_b32 v101, 0xffff0000, v101
    v_mul_f32 v109, 0xbfb8aa3b, v97
    v_exp_f32 v109, v109
    s_nop 0
    v_add_f32 v109, 1.0, v109
    v_rcp_f32 v105, v109
    v_cvt_pk_bf16_f32 v102, v98, v102
    v_lshlrev_b32 v98, 16, v102
    v_and_b32 v102, 0xffff0000, v102
    v_mul_f32 v110, 0xbfb8aa3b, v98
    v_exp_f32 v110, v110
    s_nop 0
    v_add_f32 v110, 1.0, v110
    v_rcp_f32 v106, v110
    v_cvt_pk_bf16_f32 v103, v99, v103
    v_lshlrev_b32 v99, 16, v103
    v_and_b32 v103, 0xffff0000, v103
    v_mul_f32 v111, 0xbfb8aa3b, v99
    v_exp_f32 v111, v111
    s_nop 0
    v_add_f32 v111, 1.0, v111
    v_rcp_f32 v107, v111
    v_mul_f32 v96, v96, v104
    v_mul_f32 v97, v97, v105
    v_mul_f32 v98, v98, v106
    v_mul_f32 v99, v99, v107
    v_cvt_pk_bf16_f32 v97, v96, v97
    v_lshlrev_b32 v96, 16, v97
    v_and_b32 v97, 0xffff0000, v97
    v_cvt_pk_bf16_f32 v99, v98, v99
    v_lshlrev_b32 v98, 16, v99
    v_and_b32 v99, 0xffff0000, v99
    v_mul_f32 v96, v96, v100
    v_mul_f32 v97, v97, v101
    v_mul_f32 v98, v98, v102
    v_mul_f32 v99, v99, v103
    v_cvt_pk_bf16_f32 v96, v96, v97
    v_cvt_pk_bf16_f32 v97, v98, v99
    s_mov_b32 exec_lo, 0x00ff00ff
    s_mov_b32 exec_hi, 0x00ff00ff
    buffer_store_dwordx2 v[96:97], v16, s[8:11], s23 offen sc1
    s_mov_b64 exec, -1
XM_ng:
    s_cmp_ge_u32 s20, 20
    s_cbranch_scc1 XM_r
    s_mov_b32 s6, 59244544
    s_mov_b32 s7, 56623104
    buffer_load_dwordx2 v[144:145], v27, s[8:11], s6 offen sc1
    buffer_load_dwordx2 v[146:147], v27, s[8:11], s7 offen sc1
    s_waitcnt vmcnt(0)
    s_barrier
    buffer_load_dwordx4 v[96:99], v17, s[8:11], s23 offen offset:0 sc1
    buffer_load_dwordx4 v[100:103], v17, s[8:11], s23 offen offset:512 sc1
    buffer_load_dwordx4 v[104:107], v17, s[8:11], s23 offen offset:1024 sc1
    buffer_load_dwordx4 v[108:111], v17, s[8:11], s23 offen offset:1536 sc1
    buffer_load_dwordx4 v[112:115], v17, s[8:11], s23 offen offset:2048 sc1
    buffer_load_dwordx4 v[116:119], v17, s[8:11], s23 offen offset:2560 sc1
    buffer_load_dwordx4 v[120:123], v32, s[8:11], s23 offen offset:0 sc1
    buffer_load_dwordx4 v[124:127], v32, s[8:11], s23 offen offset:512 sc1
    buffer_load_dwordx4 v[128:131], v32, s[8:11], s23 offen offset:1024 sc1
    buffer_load_dwordx4 v[132:135], v32, s[8:11], s23 offen offset:1536 sc1
    buffer_load_dwordx4 v[136:139], v32, s[8:11], s23 offen offset:2048 sc1
    buffer_load_dwordx4 v[140:143], v32, s[8:11], s23 offen offset:2560 sc1
    v_and_b32 v30, 0xffff0000, v26
    v_ashrrev_i32 v31, 31, v30
    v_not_b32 v31, v31
    v_or_b32 v31, 0x80000000, v31
    v_xor_b32 v30, v30, v31
    v_and_b32 v30, 0xffff0000, v30
    v_mul_f32 v31, 0xbfb8aa3b, v30
    v_exp_f32 v31, v31
    s_nop 0
    v_add_f32 v31, 1.0, v31
    v_rcp_f32 v30, v31
    s_nop 0
    v_cvt_pk_bf16_f32 v30, v30, v30
    v_and_b32 v30, 0xffff0000, v30
    s_mov_b32 s31, 0
    s_waitcnt vmcnt(0)
    v_max3_u32 v31, v144, v145, v146
    v_max3_u32 v31, v31, v147, v96
    v_max3_u32 v31, v31, v97, v98
    v_max3_u32 v31, v31, v99, v100
    v_max3_u32 v31, v31, v101, v102
    v_max3_u32 v31, v31, v103, v104
    v_max3_u32 v31, v31, v105, v106
    v_max3_u32 v31, v31, v107, v108
    v_max3_u32 v31, v31, v109, v110
    v_max3_u32 v31, v31, v111, v112
    v_max3_u32 v31, v31, v113, v114
    v_max3_u32 v31, v31, v115, v116
    v_max3_u32 v31, v31, v117, v118
    v_max3_u32 v31, v31, v119, v120
    v_max3_u32 v31, v31, v121, v122
    v_max3_u32 v31, v31, v123, v124
    v_max3_u32 v31, v31, v125, v126
    v_max3_u32 v31, v31, v127, v128
    v_max3_u32 v31, v31, v129, v130
    v_max3_u32 v31, v31, v131, v132
    v_max3_u32 v31, v31, v133, v134
    v_max3_u32 v31, v31, v135, v136
    v_max3_u32 v31, v31, v137, v138
    v_max3_u32 v31, v31, v139, v140
    v_max3_u32 v31, v31, v141, v142
    v_max_u32 v31, v31, v143
    v_cmp_eq_u32 vcc, -1, v31
    s_cbranch_vccz XA_o
XA_l:
    s_mov_b32 s4, 0
    s_sleep 1
    v_max3_u32 v31, v144, v145, v146
    v_max_u32 v31, v31, v147
    v_cmp_eq_u32 vcc, -1, v31
    s_cbranch_vccz XA_k0
    buffer_load_dwordx2 v[144:145], v27, s[8:11], s6 offen sc1
    buffer_load_dwordx2 v[146:147], v27, s[8:11], s7 offen sc1
    s_mov_b32 s4, 1
XA_k0:
    v_max3_u32 v31, v96, v97, v98
    v_max3_u32 v31, v31, v99, v100
    v_max3_u32 v31, v31, v101, v102
    v_max3_u32 v31, v31, v103, v104
    v_max3_u32 v31, v31, v105, v106
    v_max_u32 v31, v31, v107
    v_cmp_eq_u32 vcc, -1, v31
    s_cbranch_vccz XA_k1
    buffer_load_dwordx4 v[96:99], v17, s[8:11], s23 offen offset:0 sc1
    buffer_load_dwordx4 v[100:103], v17, s[8:11], s23 offen offset:512 sc1
    buffer_load_dwordx4 v[104:107], v17, s[8:11], s23 offen offset:1024 sc1
    s_mov_b32 s4, 1
XA_k1:
    v_max3_u32 v31, v108, v109, v110
    v_max3_u32 v31, v31, v111, v112
    v_max3_u32 v31, v31, v113, v114
    v_max3_u32 v31, v31, v115, v116
    v_max3_u32 v31, v31, v117, v118
    v_max_u32 v31, v31, v119
    v_cmp_eq_u32 vcc, -1, v31
    s_cbranch_vccz XA_k2
    buffer_load_dwordx4 v[108:111], v17, s[8:11], s23 offen offset:1536 sc1
    buffer_load_dwordx4 v[112:115], v17, s[8:11], s23 offen offset:2048 sc1
    buffer_load_dwordx4 v[116:119], v17, s[8:11], s23 offen offset:2560 sc1
    s_mov_b32 s4, 1
XA_k2:
    v_max3_u32 v31, v120, v121, v122
    v_max3_u32 v31, v31, v123, v124
    v_max3_u32 v31, v31, v125, v126
    v_max3_u32 v31, v31, v127, v128
    v_max3_u32 v31, v31, v129, v130
    v_max_u32 v31, v31, v131
    v_cmp_eq_u32 vcc, -1, v31
    s_cbranch_vccz XA_k3
    buffer_load_dwordx4 v[120:123], v32, s[8:11], s23 offen offset:0 sc1
    buffer_load_dwordx4 v[124:127], v32, s[8:11], s23 offen offset:512 sc1
    buffer_load_dwordx4 v[128:131], v32, s[8:11], s23 offen offset:1024 sc1
    s_mov_b32 s4, 1
XA_k3:
    v_max3_u32 v31, v132, v133, v134
    v_max3_u32 v31, v31, v135, v136
    v_max3_u32 v31, v31, v137, v138
    v_max3_u32 v31, v31, v139, v140
    v_max3_u32 v31, v31, v141, v142
    v_max_u32 v31, v31, v143
    v_cmp_eq_u32 vcc, -1, v31
    s_cbranch_vccz XA_k4
    buffer_load_dwordx4 v[132:135], v32, s[8:11], s23 offen offset:1536 sc1
    buffer_load_dwordx4 v[136:139], v32, s[8:11], s23 offen offset:2048 sc1
    buffer_load_dwordx4 v[140:143], v32, s[8:11], s23 offen offset:2560 sc1
    s_mov_b32 s4, 1
XA_k4:
    s_cmp_eq_u32 s4, 0
    s_cbranch_scc1 XA_o
    s_waitcnt vmcnt(0)
    s_add_u32 s31, s31, 1
    s_cmp_lt_u32 s31, s30
    s_cbranch_scc1 XA_l
    s_mov_b32 s30, 1
XA_o:
    v_mfma_f32_16x16x32_bf16 v[148:151], a[120:123], v[96:99], 0
    v_mfma_f32_16x16x32_bf16 v[152:155], a[168:171], v[96:99], 0
    v_mfma_f32_16x16x32_bf16 v[148:151], a[124:127], v[100:103], v[148:151]
    v_mfma_f32_16x16x32_bf16 v[152:155], a[172:175], v[100:103], v[152:155]
    v_mfma_f32_16x16x32_bf16 v[148:151], a[128:131], v[104:107], v[148:151]
    v_mfma_f32_16x16x32_bf16 v[152:155], a[176:179], v[104:107], v[152:155]
    v_mfma_f32_16x16x32_bf16 v[148:151], a[132:135], v[108:111], v[148:151]
    v_mfma_f32_16x16x32_bf16 v[152:155], a[180:183], v[108:111], v[152:155]
    v_mfma_f32_16x16x32_bf16 v[148:151], a[136:139], v[112:115], v[148:151]
    v_mfma_f32_16x16x32_bf16 v[152:155], a[184:187], v[112:115], v[152:155]
    v_mfma_f32_16x16x32_bf16 v[148:151], a[140:143], v[116:119], v[148:151]
    v_mfma_f32_16x16x32_bf16 v[152:155], a[188:191], v[116:119], v[152:155]
    v_mfma_f32_16x16x32_bf16 v[148:151], a[144:147], v[120:123], v[148:151]
    v_mfma_f32_16x16x32_bf16 v[152:155], a[192:195], v[120:123], v[152:155]
    v_mfma_f32_16x16x32_bf16 v[148:151], a[148:151], v[124:127], v[148:151]
    v_mfma_f32_16x16x32_bf16 v[152:155], a[196:199], v[124:127], v[152:155]
    v_mfma_f32_16x16x32_bf16 v[148:151], a[152:155], v[128:131], v[148:151]
    v_mfma_f32_16x16x32_bf16 v[152:155], a[200:203], v[128:131], v[152:155]
    v_mfma_f32_16x16x32_bf16 v[148:151], a[156:159], v[132:135], v[148:151]
    v_mfma_f32_16x16x32_bf16 v[152:155], a[204:207], v[132:135], v[152:155]
    v_mfma_f32_16x16x32_bf16 v[148:151], a[160:163], v[136:139], v[148:151]
    v_mfma_f32_16x16x32_bf16 v[152:155], a[208:211], v[136:139], v[152:155]
    v_mfma_f32_16x16x32_bf16 v[148:151], a[164:167], v[140:143], v[148:151]
    v_mfma_f32_16x16x32_bf16 v[152:155], a[212:215], v[140:143], v[152:155]
    s_nop 3
    ds_write_b128 v20, v[148:151] offset:24576
    s_nop 2
    ds_write_b128 v20, v[152:155] offset:25600
    s_waitcnt lgkmcnt(0)
    s_barrier
    s_cmp_ge_u32 s3, 2
    s_cbranch_scc1 XM_r
    ds_read_b128 v[96:99], v21 offset:24576
    ds_read_b128 v[100:103], v21 offset:26624
    ds_read_b128 v[104:107], v21 offset:28672
    ds_read_b128 v[108:111], v21 offset:30720
    s_waitcnt lgkmcnt(0)
    v_pk_add_f32 v[96:97], v[96:97], v[100:101]
    v_pk_add_f32 v[98:99], v[98:99], v[102:103]
    v_pk_add_f32 v[96:97], v[96:97], v[104:105]
    v_pk_add_f32 v[98:99], v[98:99], v[106:107]
    v_pk_add_f32 v[96:97], v[96:97], v[108:109]
    v_pk_add_f32 v[98:99], v[98:99], v[110:111]
    v_cvt_pk_bf16_f32 v97, v96, v97
    v_lshlrev_b32 v96, 16, v97
    v_and_b32 v97, 0xffff0000, v97
    v_mul_f32 v96, v96, v30
    v_mul_f32 v97, v97, v30
    v_cvt_pk_bf16_f32 v97, v96, v97
    v_lshlrev_b32 v96, 16, v97
    v_and_b32 v97, 0xffff0000, v97
    v_lshlrev_b32 v104, 16, v144
    v_and_b32 v105, 0xffff0000, v144
    v_add_f32 v96, v96, v104
    v_add_f32 v97, v97, v105
    v_cvt_pk_bf16_f32 v97, v96, v97
    v_lshlrev_b32 v96, 16, v97
    v_and_b32 v97, 0xffff0000, v97
    v_mul_f32 v96, v96, v22
    v_mul_f32 v97, v97, v23
    v_cvt_pk_bf16_f32 v97, v96, v97
    v_lshlrev_b32 v96, 16, v97
    v_and_b32 v97, 0xffff0000, v97
    v_lshlrev_b32 v104, 16, v146
    v_and_b32 v105, 0xffff0000, v146
    v_add_f32 v96, v96, v104
    v_add_f32 v97, v97, v105
    v_cvt_pk_bf16_f32 v28, v96, v97
    v_cvt_pk_bf16_f32 v99, v98, v99
    v_lshlrev_b32 v98, 16, v99
    v_and_b32 v99, 0xffff0000, v99
    v_mul_f32 v98, v98, v30
    v_mul_f32 v99, v99, v30
    v_cvt_pk_bf16_f32 v99, v98, v99
    v_lshlrev_b32 v98, 16, v99
    v_and_b32 v99, 0xffff0000, v99
    v_lshlrev_b32 v104, 16, v145
    v_and_b32 v105, 0xffff0000, v145
    v_add_f32 v98, v98, v104
    v_add_f32 v99, v99, v105
    v_cvt_pk_bf16_f32 v99, v98, v99
    v_lshlrev_b32 v98, 16, v99
    v_and_b32 v99, 0xffff0000, v99
    v_mul_f32 v98, v98, v24
    v_mul_f32 v99, v99, v25
    v_cvt_pk_bf16_f32 v99, v98, v99
    v_lshlrev_b32 v98, 16, v99
    v_and_b32 v99, 0xffff0000, v99
    v_lshlrev_b32 v104, 16, v147
    v_and_b32 v105, 0xffff0000, v147
    v_add_f32 v98, v98, v104
    v_add_f32 v99, v99, v105
    v_cvt_pk_bf16_f32 v29, v98, v99
XM_r:
    s_setpc_b64 s[100:101]
XG_sub:
    s_lshl_b32 s5, s43, 5
    s_add_u32 s5, s5, 61865984
    v_lshrrev_b32 v93, 2, v1
    v_lshlrev_b32 v93, 7, v93
    v_and_b32 v94, 3, v1
    v_lshl_add_u32 v93, v94, 2, v93
    s_sub_u32 s4, 0x7ff, s43
    v_sub_u32 v94, s4, v1
    s_add_u32 s43, s43, 64
    s_mov_b32 s31, 0
XG_l:
    buffer_load_dword v92, v93, s[8:11], s5 offen sc1
    s_waitcnt vmcnt(0)
    v_max_u32 v95, v92, v92
    v_cmp_eq_u32 vcc, -1, v95
    s_cbranch_vccz XG_o
    s_sleep 1
    s_add_u32 s31, s31, 1
    s_cmp_lt_u32 s31, s30
    s_cbranch_scc1 XG_l
    s_mov_b32 s30, 1
XG_o:
    v_ashrrev_i32 v95, 31, v92
    v_or_b32 v95, 0x80000000, v95
    v_xor_b32 v92, v92, v95
    v_and_b32 v92, 0xffff0000, v92
    v_or_b32 v92, v92, v94
    s_mov_b64 s[6:7], -1
XG_i:
    v_cmp_lt_u32 vcc, s49, v92
    s_and_b64 s[6:7], s[6:7], vcc
    s_cbranch_scc0 XG_d
    s_mov_b32 s27, 1
    s_ff1_i32_b64 s4, s[6:7]
    v_readlane_b32 s5, v92, s4
    s_bitset0_b64 s[6:7], s4
    s_min_u32 s4, s5, s44
    s_max_u32 s44, s5, s44
    s_min_u32 s5, s4, s45
    s_max_u32 s45, s4, s45
    s_min_u32 s4, s5, s46
    s_max_u32 s46, s5, s46
    s_min_u32 s5, s4, s47
    s_max_u32 s47, s4, s47
    s_min_u32 s4, s5, s38
    s_max_u32 s38, s5, s38
    s_min_u32 s5, s4, s39
    s_max_u32 s39, s4, s39
    s_min_u32 s4, s5, s48
    s_max_u32 s48, s5, s48
    s_min_u32 s5, s4, s49
    s_max_u32 s49, s4, s49
    s_branch XG_i
XG_d:
    s_setpc_b64 s[100:101]
T3_sub:
    v_bfe_u32 v18, v1, 3, 2
    v_lshlrev_b32 v18, 5, v18
    v_xor_b32 v19, v2, v18
    v_xor_b32 v18, v16, v18
    s_lshr_b32 s4, s3, 1
    s_mul_i32 s5, s4, 20480
    s_lshl_b32 s4, s4, 13
    s_and_b32 s6, s3, 1
    s_lshl_b32 s6, s6, 10
    s_add_u32 s5, s5, s6
    s_add_u32 s6, s6, s4
    s_add_u32 s6, s6, s35
    s_barrier
    s_add_u32 m0, s5, 0
    s_add_u32 s4, s6, 0
    buffer_load_dwordx4 v19, s[8:11], s4 offen sc1 lds
    s_add_u32 m0, s5, 2048
    s_add_u32 s4, s6, 2048
    buffer_load_dwordx4 v19, s[8:11], s4 offen sc1 lds
    s_add_u32 m0, s5, 4096
    s_add_u32 s4, s6, 4096
    buffer_load_dwordx4 v19, s[8:11], s4 offen sc1 lds
    s_add_u32 m0, s5, 6144
    s_add_u32 s4, s6, 6144
    buffer_load_dwordx4 v19, s[8:11], s4 offen sc1 lds
    s_add_u32 m0, s5, 8192
    s_add_u32 s4, s6, 16384
    buffer_load_dwordx4 v19, s[8:11], s4 offen sc1 lds
    s_add_u32 m0, s5, 10240
    s_add_u32 s4, s6, 18432
    buffer_load_dwordx4 v19, s[8:11], s4 offen sc1 lds
    s_add_u32 m0, s5, 12288
    s_add_u32 s4, s6, 20480
    buffer_load_dwordx4 v19, s[8:11], s4 offen sc1 lds
    s_add_u32 m0, s5, 14336
    s_add_u32 s4, s6, 22528
    buffer_load_dwordx4 v19, s[8:11], s4 offen sc1 lds
    s_add_u32 m0, s5, 16384
    s_add_u32 s4, s6, 32768
    buffer_load_dwordx4 v19, s[8:11], s4 offen sc1 lds
    s_add_u32 m0, s5, 18432
    s_add_u32 s4, s6, 34816
    buffer_load_dwordx4 v19, s[8:11], s4 offen sc1 lds
    s_waitcnt vmcnt(0)
    v_mov_b32 v140, v224
    v_mov_b32 v141, v225
    v_mov_b32 v142, v226
    v_mov_b32 v143, v227
    v_mov_b32 v144, v228
    s_barrier
    ds_read2st64_b32 v[184:185], v18 offset0:0 offset1:4
    ds_read2st64_b32 v[186:187], v18 offset0:8 offset1:12
    ds_read2st64_b32 v[188:189], v18 offset0:16 offset1:20
    ds_read2st64_b32 v[190:191], v18 offset0:24 offset1:28
    ds_read2st64_b32 v[192:193], v18 offset0:32 offset1:36
    ds_read2st64_b32 v[194:195], v18 offset0:40 offset1:44
    ds_read2st64_b32 v[196:197], v18 offset0:48 offset1:52
    ds_read2st64_b32 v[198:199], v18 offset0:56 offset1:60
    ds_read2st64_b32 v[200:201], v18 offset0:64 offset1:68
    ds_read2st64_b32 v[202:203], v18 offset0:72 offset1:76
    ds_read2st64_b32 v[204:205], v18 offset0:80 offset1:84
    ds_read2st64_b32 v[206:207], v18 offset0:88 offset1:92
    ds_read2st64_b32 v[208:209], v18 offset0:96 offset1:100
    ds_read2st64_b32 v[210:211], v18 offset0:104 offset1:108
    ds_read2st64_b32 v[212:213], v18 offset0:112 offset1:116
    ds_read2st64_b32 v[214:215], v18 offset0:120 offset1:124
    ds_read2st64_b32 v[216:217], v18 offset0:128 offset1:132
    ds_read2st64_b32 v[218:219], v18 offset0:136 offset1:140
    ds_read2st64_b32 v[220:221], v18 offset0:144 offset1:148
    ds_read2st64_b32 v[222:223], v18 offset0:152 offset1:156
    s_mov_b64 s[6:7], -1
    v_mov_b32 v10, 0xffff0000
    buffer_load_dword v20, v15, s[8:11], s22 offen offset:0 sc1
    s_add_u32 s4, s24, 81920
    buffer_load_dword v224, v3, s[12:15], s4 offen offset:0
    buffer_load_dword v225, v3, s[12:15], s4 offen offset:256
    buffer_load_dword v226, v3, s[12:15], s4 offen offset:512
    buffer_load_dword v227, v3, s[12:15], s4 offen offset:768
    buffer_load_dword v228, v3, s[12:15], s4 offen offset:1024
    s_mov_b32 exec_lo, s40
    s_mov_b32 exec_hi, 0
    buffer_store_dword v9, v3, s[8:11], s41 offen offset:0 sc1
    s_mov_b64 exec, -1
T3p_o:
    s_waitcnt lgkmcnt(15)
    v_lshlrev_b32 v160, 16, v184
    v_and_b32 v161, 0xffff0000, v184
    v_lshlrev_b32 v162, 16, v185
    v_and_b32 v163, 0xffff0000, v185
    v_lshlrev_b32 v164, 16, v186
    v_and_b32 v165, 0xffff0000, v186
    v_lshlrev_b32 v166, 16, v187
    v_and_b32 v167, 0xffff0000, v187
    v_lshlrev_b32 v168, 16, v188
    v_and_b32 v169, 0xffff0000, v188
    v_lshlrev_b32 v6, 16, v189
    v_and_b32 v7, v10, v189
    v_pk_add_f32 v[160:161], v[160:161], v[6:7]
    v_lshlrev_b32 v8, 16, v190
    v_and_b32 v9, v10, v190
    v_pk_add_f32 v[162:163], v[162:163], v[8:9]
    v_lshlrev_b32 v6, 16, v191
    v_and_b32 v7, v10, v191
    v_pk_add_f32 v[164:165], v[164:165], v[6:7]
    v_lshlrev_b32 v8, 16, v192
    v_and_b32 v9, v10, v192
    v_pk_add_f32 v[166:167], v[166:167], v[8:9]
    v_lshlrev_b32 v6, 16, v193
    v_and_b32 v7, v10, v193
    v_pk_add_f32 v[168:169], v[168:169], v[6:7]
    s_waitcnt lgkmcnt(10)
    v_lshlrev_b32 v6, 16, v194
    v_and_b32 v7, v10, v194
    v_pk_add_f32 v[160:161], v[160:161], v[6:7]
    v_lshlrev_b32 v8, 16, v195
    v_and_b32 v9, v10, v195
    v_pk_add_f32 v[162:163], v[162:163], v[8:9]
    v_lshlrev_b32 v6, 16, v196
    v_and_b32 v7, v10, v196
    v_pk_add_f32 v[164:165], v[164:165], v[6:7]
    v_lshlrev_b32 v8, 16, v197
    v_and_b32 v9, v10, v197
    v_pk_add_f32 v[166:167], v[166:167], v[8:9]
    v_lshlrev_b32 v6, 16, v198
    v_and_b32 v7, v10, v198
    v_pk_add_f32 v[168:169], v[168:169], v[6:7]
    v_lshlrev_b32 v6, 16, v199
    v_and_b32 v7, v10, v199
    v_pk_add_f32 v[160:161], v[160:161], v[6:7]
    v_lshlrev_b32 v8, 16, v200
    v_and_b32 v9, v10, v200
    v_pk_add_f32 v[162:163], v[162:163], v[8:9]
    v_lshlrev_b32 v6, 16, v201
    v_and_b32 v7, v10, v201
    v_pk_add_f32 v[164:165], v[164:165], v[6:7]
    v_lshlrev_b32 v8, 16, v202
    v_and_b32 v9, v10, v202
    v_pk_add_f32 v[166:167], v[166:167], v[8:9]
    v_lshlrev_b32 v6, 16, v203
    v_and_b32 v7, v10, v203
    v_pk_add_f32 v[168:169], v[168:169], v[6:7]
    s_waitcnt lgkmcnt(5)
    v_lshlrev_b32 v6, 16, v204
    v_and_b32 v7, v10, v204
    v_pk_add_f32 v[160:161], v[160:161], v[6:7]
    v_lshlrev_b32 v8, 16, v205
    v_and_b32 v9, v10, v205
    v_pk_add_f32 v[162:163], v[162:163], v[8:9]
    v_lshlrev_b32 v6, 16, v206
    v_and_b32 v7, v10, v206
    v_pk_add_f32 v[164:165], v[164:165], v[6:7]
    v_lshlrev_b32 v8, 16, v207
    v_and_b32 v9, v10, v207
    v_pk_add_f32 v[166:167], v[166:167], v[8:9]
    v_lshlrev_b32 v6, 16, v208
    v_and_b32 v7, v10, v208
    v_pk_add_f32 v[168:169], v[168:169], v[6:7]
    v_lshlrev_b32 v6, 16, v209
    v_and_b32 v7, v10, v209
    v_pk_add_f32 v[160:161], v[160:161], v[6:7]
    v_lshlrev_b32 v8, 16, v210
    v_and_b32 v9, v10, v210
    v_pk_add_f32 v[162:163], v[162:163], v[8:9]
    v_lshlrev_b32 v6, 16, v211
    v_and_b32 v7, v10, v211
    v_pk_add_f32 v[164:165], v[164:165], v[6:7]
    v_lshlrev_b32 v8, 16, v212
    v_and_b32 v9, v10, v212
    v_pk_add_f32 v[166:167], v[166:167], v[8:9]
    v_lshlrev_b32 v6, 16, v213
    v_and_b32 v7, v10, v213
    v_pk_add_f32 v[168:169], v[168:169], v[6:7]
    s_waitcnt lgkmcnt(0)
    v_lshlrev_b32 v6, 16, v214
    v_and_b32 v7, v10, v214
    v_pk_add_f32 v[160:161], v[160:161], v[6:7]
    v_lshlrev_b32 v8, 16, v215
    v_and_b32 v9, v10, v215
    v_pk_add_f32 v[162:163], v[162:163], v[8:9]
    v_lshlrev_b32 v6, 16, v216
    v_and_b32 v7, v10, v216
    v_pk_add_f32 v[164:165], v[164:165], v[6:7]
    v_lshlrev_b32 v8, 16, v217
    v_and_b32 v9, v10, v217
    v_pk_add_f32 v[166:167], v[166:167], v[8:9]
    v_lshlrev_b32 v6, 16, v218
    v_and_b32 v7, v10, v218
    v_pk_add_f32 v[168:169], v[168:169], v[6:7]
    v_lshlrev_b32 v6, 16, v219
    v_and_b32 v7, v10, v219
    v_pk_add_f32 v[160:161], v[160:161], v[6:7]
    v_lshlrev_b32 v8, 16, v220
    v_and_b32 v9, v10, v220
    v_pk_add_f32 v[162:163], v[162:163], v[8:9]
    v_lshlrev_b32 v6, 16, v221
    v_and_b32 v7, v10, v221
    v_pk_add_f32 v[164:165], v[164:165], v[6:7]
    v_lshlrev_b32 v8, 16, v222
    v_and_b32 v9, v10, v222
    v_pk_add_f32 v[166:167], v[166:167], v[8:9]
    v_lshlrev_b32 v6, 16, v223
    v_and_b32 v7, v10, v223
    v_pk_add_f32 v[168:169], v[168:169], v[6:7]
    v_add_f32 v6, v160, v162
    v_add_f32 v7, v164, v166
    v_add_f32 v6, v6, v168
    v_cmp_u_f32 vcc, v6, v7
    s_and_b64 vcc, vcc, s[6:7]
    s_cbranch_vccnz T3p_s
    v_cvt_pk_bf16_f32 v161, v160, v161
    v_lshlrev_b32 v160, 16, v161
    v_and_b32 v161, 0xffff0000, v161
    v_mul_f32 v160, v160, v146
    v_mul_f32 v161, v161, v147
    v_cvt_pk_bf16_f32 v161, v160, v161
    v_lshlrev_b32 v160, 16, v161
    v_and_b32 v161, 0xffff0000, v161
    v_lshlrev_b32 v6, 16, v140
    v_and_b32 v7, 0xffff0000, v140
    v_add_f32 v160, v160, v6
    v_add_f32 v161, v161, v7
    v_cvt_pk_bf16_f32 v140, v160, v161
    v_cvt_pk_bf16_f32 v163, v162, v163
    v_lshlrev_b32 v162, 16, v163
    v_and_b32 v163, 0xffff0000, v163
    v_mul_f32 v162, v162, v148
    v_mul_f32 v163, v163, v149
    v_cvt_pk_bf16_f32 v163, v162, v163
    v_lshlrev_b32 v162, 16, v163
    v_and_b32 v163, 0xffff0000, v163
    v_lshlrev_b32 v6, 16, v141
    v_and_b32 v7, 0xffff0000, v141
    v_add_f32 v162, v162, v6
    v_add_f32 v163, v163, v7
    v_cvt_pk_bf16_f32 v141, v162, v163
    v_cvt_pk_bf16_f32 v165, v164, v165
    v_lshlrev_b32 v164, 16, v165
    v_and_b32 v165, 0xffff0000, v165
    v_mul_f32 v164, v164, v150
    v_mul_f32 v165, v165, v151
    v_cvt_pk_bf16_f32 v165, v164, v165
    v_lshlrev_b32 v164, 16, v165
    v_and_b32 v165, 0xffff0000, v165
    v_lshlrev_b32 v6, 16, v142
    v_and_b32 v7, 0xffff0000, v142
    v_add_f32 v164, v164, v6
    v_add_f32 v165, v165, v7
    v_cvt_pk_bf16_f32 v142, v164, v165
    v_cvt_pk_bf16_f32 v167, v166, v167
    v_lshlrev_b32 v166, 16, v167
    v_and_b32 v167, 0xffff0000, v167
    v_mul_f32 v166, v166, v152
    v_mul_f32 v167, v167, v153
    v_cvt_pk_bf16_f32 v167, v166, v167
    v_lshlrev_b32 v166, 16, v167
    v_and_b32 v167, 0xffff0000, v167
    v_lshlrev_b32 v6, 16, v143
    v_and_b32 v7, 0xffff0000, v143
    v_add_f32 v166, v166, v6
    v_add_f32 v167, v167, v7
    v_cvt_pk_bf16_f32 v143, v166, v167
    v_cvt_pk_bf16_f32 v169, v168, v169
    v_lshlrev_b32 v168, 16, v169
    v_and_b32 v169, 0xffff0000, v169
    v_mul_f32 v168, v168, v154
    v_mul_f32 v169, v169, v155
    v_cvt_pk_bf16_f32 v169, v168, v169
    v_lshlrev_b32 v168, 16, v169
    v_and_b32 v169, 0xffff0000, v169
    v_lshlrev_b32 v6, 16, v144
    v_and_b32 v7, 0xffff0000, v144
    v_add_f32 v168, v168, v6
    v_add_f32 v169, v169, v7
    v_cvt_pk_bf16_f32 v144, v168, v169
    v_lshlrev_b32 v160, 16, v140
    v_and_b32 v161, 0xffff0000, v140
    v_lshlrev_b32 v162, 16, v141
    v_and_b32 v163, 0xffff0000, v141
    v_lshlrev_b32 v164, 16, v142
    v_and_b32 v165, 0xffff0000, v142
    v_lshlrev_b32 v166, 16, v143
    v_and_b32 v167, 0xffff0000, v143
    v_lshlrev_b32 v168, 16, v144
    v_and_b32 v169, 0xffff0000, v144
    v_add_f32 v6, v160, v161
    v_add_f32 v6, v6, v162
    v_add_f32 v6, v6, v163
    v_add_f32 v6, v6, v164
    v_add_f32 v6, v6, v165
    v_add_f32 v6, v6, v166
    v_add_f32 v6, v6, v167
    v_add_f32 v6, v6, v168
    v_add_f32 v6, v6, v169
    s_nop 1
    v_add_f32 v6, v6, v6 row_ror:8 row_mask:0xf bank_mask:0xf
    s_nop 1
    v_add_f32 v6, v6, v6 row_ror:4 row_mask:0xf bank_mask:0xf
    s_nop 1
    v_add_f32 v6, v6, v6 row_ror:2 row_mask:0xf bank_mask:0xf
    s_nop 1
    v_add_f32 v6, v6, v6 row_ror:1 row_mask:0xf bank_mask:0xf
    v_mov_b32 v7, v6
    s_nop 1
    v_permlane16_swap_b32 v6, v7
    v_add_f32 v6, v6, v7
    v_mov_b32 v7, v6
    s_nop 1
    v_permlane32_swap_b32 v6, v7
    v_add_f32 v6, v6, v7
    v_mul_f32 v6, 0x3acccccd, v6
    v_sub_f32 v7, v160, v6
    v_mul_f32 v8, v7, v7
    v_sub_f32 v7, v161, v6
    v_fmac_f32 v8, v7, v7
    v_sub_f32 v7, v162, v6
    v_fmac_f32 v8, v7, v7
    v_sub_f32 v7, v163, v6
    v_fmac_f32 v8, v7, v7
    v_sub_f32 v7, v164, v6
    v_fmac_f32 v8, v7, v7
    v_sub_f32 v7, v165, v6
    v_fmac_f32 v8, v7, v7
    v_sub_f32 v7, v166, v6
    v_fmac_f32 v8, v7, v7
    v_sub_f32 v7, v167, v6
    v_fmac_f32 v8, v7, v7
    v_sub_f32 v7, v168, v6
    v_fmac_f32 v8, v7, v7
    v_sub_f32 v7, v169, v6
    v_fmac_f32 v8, v7, v7
    s_nop 1
    v_add_f32 v8, v8, v8 row_ror:8 row_mask:0xf bank_mask:0xf
    s_nop 1
    v_add_f32 v8, v8, v8 row_ror:4 row_mask:0xf bank_mask:0xf
    s_nop 1
    v_add_f32 v8, v8, v8 row_ror:2 row_mask:0xf bank_mask:0xf
    s_nop 1
    v_add_f32 v8, v8, v8 row_ror:1 row_mask:0xf bank_mask:0xf
    v_mov_b32 v7, v8
    s_nop 1
    v_permlane16_swap_b32 v8, v7
    v_add_f32 v8, v8, v7
    v_mov_b32 v7, v8
    s_nop 1
    v_permlane32_swap_b32 v8, v7
    v_add_f32 v8, v8, v7
    v_mul_f32 v8, 0x3acccccd, v8
    v_cvt_pk_bf16_f32 v8, v8, v8
    v_and_b32 v8, 0xffff0000, v8
    v_add_f32 v8, 0x3727c5ac, v8
    v_cvt_pk_bf16_f32 v8, v8, v8
    v_and_b32 v8, 0xffff0000, v8
    v_sqrt_f32 v8, v8
    s_nop 0
    v_cvt_pk_bf16_f32 v8, v8, v8
    v_and_b32 v8, 0xffff0000, v8
    v_rcp_f32 v8, v8
    v_cvt_pk_bf16_f32 v6, v6, v6
    v_and_b32 v6, 0xffff0000, v6
    v_sub_f32 v160, v160, v6
    v_sub_f32 v161, v161, v6
    v_cvt_pk_bf16_f32 v161, v160, v161
    v_lshlrev_b32 v160, 16, v161
    v_and_b32 v161, 0xffff0000, v161
    v_mul_f32 v160, v160, v8
    v_mul_f32 v161, v161, v8
    v_cvt_pk_bf16_f32 v161, v160, v161
    v_lshlrev_b32 v160, 16, v161
    v_and_b32 v161, 0xffff0000, v161
    v_sub_f32 v162, v162, v6
    v_sub_f32 v163, v163, v6
    v_cvt_pk_bf16_f32 v163, v162, v163
    v_lshlrev_b32 v162, 16, v163
    v_and_b32 v163, 0xffff0000, v163
    v_mul_f32 v162, v162, v8
    v_mul_f32 v163, v163, v8
    v_cvt_pk_bf16_f32 v163, v162, v163
    v_lshlrev_b32 v162, 16, v163
    v_and_b32 v163, 0xffff0000, v163
    v_sub_f32 v164, v164, v6
    v_sub_f32 v165, v165, v6
    v_cvt_pk_bf16_f32 v165, v164, v165
    v_lshlrev_b32 v164, 16, v165
    v_and_b32 v165, 0xffff0000, v165
    v_mul_f32 v164, v164, v8
    v_mul_f32 v165, v165, v8
    v_cvt_pk_bf16_f32 v165, v164, v165
    v_lshlrev_b32 v164, 16, v165
    v_and_b32 v165, 0xffff0000, v165
    v_sub_f32 v166, v166, v6
    v_sub_f32 v167, v167, v6
    v_cvt_pk_bf16_f32 v167, v166, v167
    v_lshlrev_b32 v166, 16, v167
    v_and_b32 v167, 0xffff0000, v167
    v_mul_f32 v166, v166, v8
    v_mul_f32 v167, v167, v8
    v_cvt_pk_bf16_f32 v167, v166, v167
    v_lshlrev_b32 v166, 16, v167
    v_and_b32 v167, 0xffff0000, v167
    v_sub_f32 v168, v168, v6
    v_sub_f32 v169, v169, v6
    v_cvt_pk_bf16_f32 v169, v168, v169
    v_lshlrev_b32 v168, 16, v169
    v_and_b32 v169, 0xffff0000, v169
    v_mul_f32 v168, v168, v8
    v_mul_f32 v169, v169, v8
    v_cvt_pk_bf16_f32 v169, v168, v169
    v_lshlrev_b32 v168, 16, v169
    v_and_b32 v169, 0xffff0000, v169
    v_mov_b32 v9, 0
    v_mul_f32 v160, v160, v110
    v_mul_f32 v161, v161, v111
    v_cvt_pk_bf16_f32 v161, v160, v161
    v_lshlrev_b32 v160, 16, v161
    v_and_b32 v161, 0xffff0000, v161
    v_add_f32 v160, v160, v100
    v_add_f32 v161, v161, v101
    v_cvt_pk_bf16_f32 v170, v160, v161
    buffer_store_dword v170, v3, s[8:11], s25 offen offset:0 sc1
    v_lshlrev_b32 v160, 16, v170
    v_and_b32 v161, 0xffff0000, v170
    v_fmac_f32 v9, v160, v130
    v_fmac_f32 v9, v161, v131
    v_mul_f32 v160, v160, v120
    v_mul_f32 v161, v161, v121
    v_cvt_pk_bf16_f32 v161, v160, v161
    v_lshlrev_b32 v160, 16, v161
    v_and_b32 v161, 0xffff0000, v161
    v_lshlrev_b32 v6, 16, v140
    v_and_b32 v7, 0xffff0000, v140
    v_add_f32 v160, v160, v6
    v_add_f32 v161, v161, v7
    v_cvt_pk_bf16_f32 v175, v160, v161
    buffer_store_dword v175, v3, s[16:19], s24 offen offset:0 sc1
    v_mul_f32 v162, v162, v112
    v_mul_f32 v163, v163, v113
    v_cvt_pk_bf16_f32 v163, v162, v163
    v_lshlrev_b32 v162, 16, v163
    v_and_b32 v163, 0xffff0000, v163
    v_add_f32 v162, v162, v102
    v_add_f32 v163, v163, v103
    v_cvt_pk_bf16_f32 v171, v162, v163
    buffer_store_dword v171, v3, s[8:11], s25 offen offset:256 sc1
    v_lshlrev_b32 v162, 16, v171
    v_and_b32 v163, 0xffff0000, v171
    v_fmac_f32 v9, v162, v132
    v_fmac_f32 v9, v163, v133
    v_mul_f32 v162, v162, v122
    v_mul_f32 v163, v163, v123
    v_cvt_pk_bf16_f32 v163, v162, v163
    v_lshlrev_b32 v162, 16, v163
    v_and_b32 v163, 0xffff0000, v163
    v_lshlrev_b32 v6, 16, v141
    v_and_b32 v7, 0xffff0000, v141
    v_add_f32 v162, v162, v6
    v_add_f32 v163, v163, v7
    v_cvt_pk_bf16_f32 v176, v162, v163
    buffer_store_dword v176, v3, s[16:19], s24 offen offset:256 sc1
    v_mul_f32 v164, v164, v114
    v_mul_f32 v165, v165, v115
    v_cvt_pk_bf16_f32 v165, v164, v165
    v_lshlrev_b32 v164, 16, v165
    v_and_b32 v165, 0xffff0000, v165
    v_add_f32 v164, v164, v104
    v_add_f32 v165, v165, v105
    v_cvt_pk_bf16_f32 v172, v164, v165
    buffer_store_dword v172, v3, s[8:11], s25 offen offset:512 sc1
    v_lshlrev_b32 v164, 16, v172
    v_and_b32 v165, 0xffff0000, v172
    v_fmac_f32 v9, v164, v134
    v_fmac_f32 v9, v165, v135
    v_mul_f32 v164, v164, v124
    v_mul_f32 v165, v165, v125
    v_cvt_pk_bf16_f32 v165, v164, v165
    v_lshlrev_b32 v164, 16, v165
    v_and_b32 v165, 0xffff0000, v165
    v_lshlrev_b32 v6, 16, v142
    v_and_b32 v7, 0xffff0000, v142
    v_add_f32 v164, v164, v6
    v_add_f32 v165, v165, v7
    v_cvt_pk_bf16_f32 v177, v164, v165
    buffer_store_dword v177, v3, s[16:19], s24 offen offset:512 sc1
    v_mul_f32 v166, v166, v116
    v_mul_f32 v167, v167, v117
    v_cvt_pk_bf16_f32 v167, v166, v167
    v_lshlrev_b32 v166, 16, v167
    v_and_b32 v167, 0xffff0000, v167
    v_add_f32 v166, v166, v106
    v_add_f32 v167, v167, v107
    v_cvt_pk_bf16_f32 v173, v166, v167
    buffer_store_dword v173, v3, s[8:11], s25 offen offset:768 sc1
    v_lshlrev_b32 v166, 16, v173
    v_and_b32 v167, 0xffff0000, v173
    v_fmac_f32 v9, v166, v136
    v_fmac_f32 v9, v167, v137
    v_mul_f32 v166, v166, v126
    v_mul_f32 v167, v167, v127
    v_cvt_pk_bf16_f32 v167, v166, v167
    v_lshlrev_b32 v166, 16, v167
    v_and_b32 v167, 0xffff0000, v167
    v_lshlrev_b32 v6, 16, v143
    v_and_b32 v7, 0xffff0000, v143
    v_add_f32 v166, v166, v6
    v_add_f32 v167, v167, v7
    v_cvt_pk_bf16_f32 v178, v166, v167
    buffer_store_dword v178, v3, s[16:19], s24 offen offset:768 sc1
    v_mul_f32 v168, v168, v118
    v_mul_f32 v169, v169, v119
    v_cvt_pk_bf16_f32 v169, v168, v169
    v_lshlrev_b32 v168, 16, v169
    v_and_b32 v169, 0xffff0000, v169
    v_add_f32 v168, v168, v108
    v_add_f32 v169, v169, v109
    v_cvt_pk_bf16_f32 v174, v168, v169
    buffer_store_dword v174, v3, s[8:11], s25 offen offset:1024 sc1
    v_lshlrev_b32 v168, 16, v174
    v_and_b32 v169, 0xffff0000, v174
    v_fmac_f32 v9, v168, v138
    v_fmac_f32 v9, v169, v139
    v_mul_f32 v168, v168, v128
    v_mul_f32 v169, v169, v129
    v_cvt_pk_bf16_f32 v169, v168, v169
    v_lshlrev_b32 v168, 16, v169
    v_and_b32 v169, 0xffff0000, v169
    v_lshlrev_b32 v6, 16, v144
    v_and_b32 v7, 0xffff0000, v144
    v_add_f32 v168, v168, v6
    v_add_f32 v169, v169, v7
    v_cvt_pk_bf16_f32 v179, v168, v169
    buffer_store_dword v179, v3, s[16:19], s24 offen offset:1024 sc1
    v_add_f32 v9, v9, v9 row_ror:8 row_mask:0xf bank_mask:0xf
    s_nop 1
    v_add_f32 v9, v9, v9 row_ror:4 row_mask:0xf bank_mask:0xf
    s_nop 1
    v_add_f32 v9, v9, v9 row_ror:2 row_mask:0xf bank_mask:0xf
    s_nop 1
    v_add_f32 v9, v9, v9 row_ror:1 row_mask:0xf bank_mask:0xf
    v_mov_b32 v6, v9
    s_nop 1
    v_permlane16_swap_b32 v9, v6
    v_add_f32 v9, v9, v6
    v_mov_b32 v6, v9
    s_nop 1
    v_permlane32_swap_b32 v9, v6
    v_add_f32 v9, v9, v6
    v_cvt_pk_bf16_f32 v9, v9, v9
    v_and_b32 v9, 0xffff0000, v9
    s_setpc_b64 s[100:101]
T3p_s:
    s_mov_b64 s[6:7], 0
    s_mov_b32 s31, 0
T3pq_l:
    s_add_u32 s4, s35, 0
    buffer_load_dword v184, v16, s[8:11], s4 offen offset:0 sc1
    s_add_u32 s4, s35, 1024
    buffer_load_dword v185, v16, s[8:11], s4 offen offset:0 sc1
    s_add_u32 s4, s35, 2048
    buffer_load_dword v186, v16, s[8:11], s4 offen offset:0 sc1
    s_add_u32 s4, s35, 3072
    buffer_load_dword v187, v16, s[8:11], s4 offen offset:0 sc1
    s_add_u32 s4, s35, 4096
    buffer_load_dword v188, v16, s[8:11], s4 offen offset:0 sc1
    s_add_u32 s4, s35, 5120
    buffer_load_dword v189, v16, s[8:11], s4 offen offset:0 sc1
    s_add_u32 s4, s35, 6144
    buffer_load_dword v190, v16, s[8:11], s4 offen offset:0 sc1
    s_add_u32 s4, s35, 7168
    buffer_load_dword v191, v16, s[8:11], s4 offen offset:0 sc1
    s_add_u32 s4, s35, 16384
    buffer_load_dword v192, v16, s[8:11], s4 offen offset:0 sc1
    s_add_u32 s4, s35, 17408
    buffer_load_dword v193, v16, s[8:11], s4 offen offset:0 sc1
    s_add_u32 s4, s35, 18432
    buffer_load_dword v194, v16, s[8:11], s4 offen offset:0 sc1
    s_add_u32 s4, s35, 19456
    buffer_load_dword v195, v16, s[8:11], s4 offen offset:0 sc1
    s_add_u32 s4, s35, 20480
    buffer_load_dword v196, v16, s[8:11], s4 offen offset:0 sc1
    s_add_u32 s4, s35, 21504
    buffer_load_dword v197, v16, s[8:11], s4 offen offset:0 sc1
    s_add_u32 s4, s35, 22528
    buffer_load_dword v198, v16, s[8:11], s4 offen offset:0 sc1
    s_add_u32 s4, s35, 23552
    buffer_load_dword v199, v16, s[8:11], s4 offen offset:0 sc1
    s_add_u32 s4, s35, 32768
    buffer_load_dword v200, v16, s[8:11], s4 offen offset:0 sc1
    s_add_u32 s4, s35, 33792
    buffer_load_dword v201, v16, s[8:11], s4 offen offset:0 sc1
    s_add_u32 s4, s35, 34816
    buffer_load_dword v202, v16, s[8:11], s4 offen offset:0 sc1
    s_add_u32 s4, s35, 35840
    buffer_load_dword v203, v16, s[8:11], s4 offen offset:0 sc1
    s_add_u32 s4, s35, 8192
    buffer_load_dword v204, v16, s[8:11], s4 offen offset:0 sc1
    s_add_u32 s4, s35, 9216
    buffer_load_dword v205, v16, s[8:11], s4 offen offset:0 sc1
    s_add_u32 s4, s35, 10240
    buffer_load_dword v206, v16, s[8:11], s4 offen offset:0 sc1
    s_add_u32 s4, s35, 11264
    buffer_load_dword v207, v16, s[8:11], s4 offen offset:0 sc1
    s_add_u32 s4, s35, 12288
    buffer_load_dword v208, v16, s[8:11], s4 offen offset:0 sc1
    s_add_u32 s4, s35, 13312
    buffer_load_dword v209, v16, s[8:11], s4 offen offset:0 sc1
    s_add_u32 s4, s35, 14336
    buffer_load_dword v210, v16, s[8:11], s4 offen offset:0 sc1
    s_add_u32 s4, s35, 15360
    buffer_load_dword v211, v16, s[8:11], s4 offen offset:0 sc1
    s_add_u32 s4, s35, 24576
    buffer_load_dword v212, v16, s[8:11], s4 offen offset:0 sc1
    s_add_u32 s4, s35, 25600
    buffer_load_dword v213, v16, s[8:11], s4 offen offset:0 sc1
    s_add_u32 s4, s35, 26624
    buffer_load_dword v214, v16, s[8:11], s4 offen offset:0 sc1
    s_add_u32 s4, s35, 27648
    buffer_load_dword v215, v16, s[8:11], s4 offen offset:0 sc1
    s_add_u32 s4, s35, 28672
    buffer_load_dword v216, v16, s[8:11], s4 offen offset:0 sc1
    s_add_u32 s4, s35, 29696
    buffer_load_dword v217, v16, s[8:11], s4 offen offset:0 sc1
    s_add_u32 s4, s35, 30720
    buffer_load_dword v218, v16, s[8:11], s4 offen offset:0 sc1
    s_add_u32 s4, s35, 31744
    buffer_load_dword v219, v16, s[8:11], s4 offen offset:0 sc1
    s_add_u32 s4, s35, 40960
    buffer_load_dword v220, v16, s[8:11], s4 offen offset:0 sc1
    s_add_u32 s4, s35, 41984
    buffer_load_dword v221, v16, s[8:11], s4 offen offset:0 sc1
    s_add_u32 s4, s35, 43008
    buffer_load_dword v222, v16, s[8:11], s4 offen offset:0 sc1
    s_add_u32 s4, s35, 44032
    buffer_load_dword v223, v16, s[8:11], s4 offen offset:0 sc1
    s_waitcnt vmcnt(0)
    v_max3_u32 v6, v184, v185, v186
    v_max3_u32 v6, v6, v187, v188
    v_max3_u32 v6, v6, v189, v190
    v_max3_u32 v6, v6, v191, v192
    v_max3_u32 v6, v6, v193, v194
    v_max3_u32 v6, v6, v195, v196
    v_max3_u32 v6, v6, v197, v198
    v_max3_u32 v6, v6, v199, v200
    v_max3_u32 v6, v6, v201, v202
    v_max3_u32 v6, v6, v203, v204
    v_max3_u32 v6, v6, v205, v206
    v_max3_u32 v6, v6, v207, v208
    v_max3_u32 v6, v6, v209, v210
    v_max3_u32 v6, v6, v211, v212
    v_max3_u32 v6, v6, v213, v214
    v_max3_u32 v6, v6, v215, v216
    v_max3_u32 v6, v6, v217, v218
    v_max3_u32 v6, v6, v219, v220
    v_max3_u32 v6, v6, v221, v222
    v_max_u32 v6, v6, v223
    v_cmp_eq_u32 vcc, -1, v6
    s_cbranch_vccz T3pq_o
    s_sleep 1
    s_add_u32 s31, s31, 1
    s_cmp_lt_u32 s31, s30
    s_cbranch_scc1 T3pq_l
    s_mov_b32 s30, 1
T3pq_o:
    s_branch T3p_o
XN_sub:
    ds_read2_b64 v[40:43], v12 offset0:0 offset1:4
    ds_read2_b64 v[44:47], v12 offset0:32 offset1:36
    ds_read2_b64 v[48:51], v12 offset0:64 offset1:68
    ds_read2_b64 v[52:55], v12 offset0:96 offset1:100
    ds_read2_b64 v[56:59], v12 offset0:128 offset1:132
    s_waitcnt lgkmcnt(4)
    v_lshlrev_b32 v60, 16, v40
    v_and_b32 v61, 0xffff0000, v40
    v_lshlrev_b32 v62, 16, v42
    v_and_b32 v63, 0xffff0000, v42
    v_lshlrev_b32 v64, 16, v41
    v_and_b32 v65, 0xffff0000, v41
    v_lshlrev_b32 v66, 16, v43
    v_and_b32 v67, 0xffff0000, v43
    s_waitcnt lgkmcnt(3)
    v_lshlrev_b32 v68, 16, v44
    v_and_b32 v69, 0xffff0000, v44
    v_lshlrev_b32 v70, 16, v46
    v_and_b32 v71, 0xffff0000, v46
    v_lshlrev_b32 v72, 16, v45
    v_and_b32 v73, 0xffff0000, v45
    v_lshlrev_b32 v74, 16, v47
    v_and_b32 v75, 0xffff0000, v47
    s_waitcnt lgkmcnt(2)
    v_lshlrev_b32 v76, 16, v48
    v_and_b32 v77, 0xffff0000, v48
    v_lshlrev_b32 v78, 16, v50
    v_and_b32 v79, 0xffff0000, v50
    v_lshlrev_b32 v80, 16, v49
    v_and_b32 v81, 0xffff0000, v49
    v_lshlrev_b32 v82, 16, v51
    v_and_b32 v83, 0xffff0000, v51
    s_waitcnt lgkmcnt(1)
    v_lshlrev_b32 v84, 16, v52
    v_and_b32 v85, 0xffff0000, v52
    v_lshlrev_b32 v86, 16, v54
    v_and_b32 v87, 0xffff0000, v54
    v_lshlrev_b32 v88, 16, v53
    v_and_b32 v89, 0xffff0000, v53
    v_lshlrev_b32 v90, 16, v55
    v_and_b32 v91, 0xffff0000, v55
    s_waitcnt lgkmcnt(0)
    v_lshlrev_b32 v92, 16, v56
    v_and_b32 v93, 0xffff0000, v56
    v_lshlrev_b32 v94, 16, v58
    v_and_b32 v95, 0xffff0000, v58
    v_lshlrev_b32 v96, 16, v57
    v_and_b32 v97, 0xffff0000, v57
    v_lshlrev_b32 v98, 16, v59
    v_and_b32 v99, 0xffff0000, v59
    v_pk_add_f32 v[16:17], v[60:61], v[68:69]
    v_pk_add_f32 v[18:19], v[62:63], v[70:71]
    v_pk_add_f32 v[20:21], v[64:65], v[72:73]
    v_pk_add_f32 v[22:23], v[66:67], v[74:75]
    v_pk_add_f32 v[16:17], v[16:17], v[76:77]
    v_pk_add_f32 v[18:19], v[18:19], v[78:79]
    v_pk_add_f32 v[20:21], v[20:21], v[80:81]
    v_pk_add_f32 v[22:23], v[22:23], v[82:83]
    v_pk_add_f32 v[16:17], v[16:17], v[84:85]
    v_pk_add_f32 v[18:19], v[18:19], v[86:87]
    v_pk_add_f32 v[20:21], v[20:21], v[88:89]
    v_pk_add_f32 v[22:23], v[22:23], v[90:91]
    v_pk_add_f32 v[16:17], v[16:17], v[92:93]
    v_pk_add_f32 v[18:19], v[18:19], v[94:95]
    v_pk_add_f32 v[20:21], v[20:21], v[96:97]
    v_pk_add_f32 v[22:23], v[22:23], v[98:99]
    v_pk_add_f32 v[16:17], v[16:17], v[18:19]
    v_pk_add_f32 v[20:21], v[20:21], v[22:23]
    v_pk_add_f32 v[16:17], v[16:17], v[20:21]
    v_add_f32 v16, v16, v17
    s_nop 1
    v_add_f32 v16, v16, v16 row_ror:4 row_mask:0xf bank_mask:0xf
    s_nop 1
    v_add_f32 v16, v16, v16 row_ror:8 row_mask:0xf bank_mask:0xf
    v_mov_b32 v17, v16
    s_nop 1
    v_permlane16_swap_b32 v16, v17
    v_add_f32 v16, v16, v17
    v_mov_b32 v17, v16
    s_nop 1
    v_permlane32_swap_b32 v16, v17
    v_add_f32 v16, v16, v17
    v_mul_f32 v6, 0xbacccccd, v16
    v_mov_b32 v7, v6
    v_pk_add_f32 v[40:41], v[60:61], v[6:7]
    v_pk_add_f32 v[42:43], v[62:63], v[6:7]
    v_pk_add_f32 v[44:45], v[64:65], v[6:7]
    v_pk_add_f32 v[46:47], v[66:67], v[6:7]
    v_pk_mul_f32 v[16:17], v[40:41], v[40:41]
    v_pk_mul_f32 v[18:19], v[42:43], v[42:43]
    v_pk_mul_f32 v[20:21], v[44:45], v[44:45]
    v_pk_mul_f32 v[22:23], v[46:47], v[46:47]
    v_pk_add_f32 v[48:49], v[68:69], v[6:7]
    v_pk_add_f32 v[50:51], v[70:71], v[6:7]
    v_pk_add_f32 v[52:53], v[72:73], v[6:7]
    v_pk_add_f32 v[54:55], v[74:75], v[6:7]
    v_pk_fma_f32 v[16:17], v[48:49], v[48:49], v[16:17]
    v_pk_fma_f32 v[18:19], v[50:51], v[50:51], v[18:19]
    v_pk_fma_f32 v[20:21], v[52:53], v[52:53], v[20:21]
    v_pk_fma_f32 v[22:23], v[54:55], v[54:55], v[22:23]
    v_pk_add_f32 v[40:41], v[76:77], v[6:7]
    v_pk_add_f32 v[42:43], v[78:79], v[6:7]
    v_pk_add_f32 v[44:45], v[80:81], v[6:7]
    v_pk_add_f32 v[46:47], v[82:83], v[6:7]
    v_pk_fma_f32 v[16:17], v[40:41], v[40:41], v[16:17]
    v_pk_fma_f32 v[18:19], v[42:43], v[42:43], v[18:19]
    v_pk_fma_f32 v[20:21], v[44:45], v[44:45], v[20:21]
    v_pk_fma_f32 v[22:23], v[46:47], v[46:47], v[22:23]
    v_pk_add_f32 v[48:49], v[84:85], v[6:7]
    v_pk_add_f32 v[50:51], v[86:87], v[6:7]
    v_pk_add_f32 v[52:53], v[88:89], v[6:7]
    v_pk_add_f32 v[54:55], v[90:91], v[6:7]
    v_pk_fma_f32 v[16:17], v[48:49], v[48:49], v[16:17]
    v_pk_fma_f32 v[18:19], v[50:51], v[50:51], v[18:19]
    v_pk_fma_f32 v[20:21], v[52:53], v[52:53], v[20:21]
    v_pk_fma_f32 v[22:23], v[54:55], v[54:55], v[22:23]
    v_pk_add_f32 v[40:41], v[92:93], v[6:7]
    v_pk_add_f32 v[42:43], v[94:95], v[6:7]
    v_pk_add_f32 v[44:45], v[96:97], v[6:7]
    v_pk_add_f32 v[46:47], v[98:99], v[6:7]
    v_pk_fma_f32 v[16:17], v[40:41], v[40:41], v[16:17]
    v_pk_fma_f32 v[18:19], v[42:43], v[42:43], v[18:19]
    v_pk_fma_f32 v[20:21], v[44:45], v[44:45], v[20:21]
    v_pk_fma_f32 v[22:23], v[46:47], v[46:47], v[22:23]
    v_cvt_pk_bf16_f32 v6, v6, v6
    v_and_b32 v6, 0xffff0000, v6
    v_mov_b32 v7, v6
    v_pk_add_f32 v[16:17], v[16:17], v[18:19]
    v_pk_add_f32 v[20:21], v[20:21], v[22:23]
    v_pk_add_f32 v[16:17], v[16:17], v[20:21]
    v_add_f32 v16, v16, v17
    s_nop 1
    v_add_f32 v16, v16, v16 row_ror:4 row_mask:0xf bank_mask:0xf
    s_nop 1
    v_add_f32 v16, v16, v16 row_ror:8 row_mask:0xf bank_mask:0xf
    v_mov_b32 v17, v16
    s_nop 1
    v_permlane16_swap_b32 v16, v17
    v_add_f32 v16, v16, v17
    v_mov_b32 v17, v16
    s_nop 1
    v_permlane32_swap_b32 v16, v17
    v_add_f32 v16, v16, v17
    v_mul_f32 v8, 0x3acccccd, v16
    v_pk_add_f32 v[60:61], v[60:61], v[6:7]
    v_pk_add_f32 v[62:63], v[62:63], v[6:7]
    v_cvt_pk_bf16_f32 v8, v8, v8
    v_pk_add_f32 v[64:65], v[64:65], v[6:7]
    v_pk_add_f32 v[66:67], v[66:67], v[6:7]
    v_and_b32 v8, 0xffff0000, v8
    v_pk_add_f32 v[68:69], v[68:69], v[6:7]
    v_pk_add_f32 v[70:71], v[70:71], v[6:7]
    v_add_f32 v8, 0x3727c5ac, v8
    v_pk_add_f32 v[72:73], v[72:73], v[6:7]
    v_pk_add_f32 v[74:75], v[74:75], v[6:7]
    v_cvt_pk_bf16_f32 v8, v8, v8
    v_pk_add_f32 v[76:77], v[76:77], v[6:7]
    v_pk_add_f32 v[78:79], v[78:79], v[6:7]
    v_and_b32 v8, 0xffff0000, v8
    v_pk_add_f32 v[80:81], v[80:81], v[6:7]
    v_pk_add_f32 v[82:83], v[82:83], v[6:7]
    v_sqrt_f32 v8, v8
    v_pk_add_f32 v[84:85], v[84:85], v[6:7]
    v_pk_add_f32 v[86:87], v[86:87], v[6:7]
    v_cvt_pk_bf16_f32 v8, v8, v8
    v_pk_add_f32 v[88:89], v[88:89], v[6:7]
    v_pk_add_f32 v[90:91], v[90:91], v[6:7]
    v_and_b32 v8, 0xffff0000, v8
    v_pk_add_f32 v[92:93], v[92:93], v[6:7]
    v_pk_add_f32 v[94:95], v[94:95], v[6:7]
    v_rcp_f32 v8, v8
    v_pk_add_f32 v[96:97], v[96:97], v[6:7]
    v_pk_add_f32 v[98:99], v[98:99], v[6:7]
    v_mov_b32 v9, v8
    v_cvt_pk_bf16_f32 v40, v60, v61
    v_cvt_pk_bf16_f32 v41, v62, v63
    v_cvt_pk_bf16_f32 v42, v64, v65
    v_cvt_pk_bf16_f32 v43, v66, v67
    v_cvt_pk_bf16_f32 v44, v68, v69
    v_cvt_pk_bf16_f32 v45, v70, v71
    v_cvt_pk_bf16_f32 v46, v72, v73
    v_cvt_pk_bf16_f32 v47, v74, v75
    v_cvt_pk_bf16_f32 v48, v76, v77
    v_cvt_pk_bf16_f32 v49, v78, v79
    v_cvt_pk_bf16_f32 v50, v80, v81
    v_cvt_pk_bf16_f32 v51, v82, v83
    v_cvt_pk_bf16_f32 v52, v84, v85
    v_cvt_pk_bf16_f32 v53, v86, v87
    v_cvt_pk_bf16_f32 v54, v88, v89
    v_cvt_pk_bf16_f32 v55, v90, v91
    v_cvt_pk_bf16_f32 v56, v92, v93
    v_cvt_pk_bf16_f32 v57, v94, v95
    v_cvt_pk_bf16_f32 v58, v96, v97
    v_cvt_pk_bf16_f32 v59, v98, v99
    v_lshlrev_b32 v60, 16, v40
    v_and_b32 v61, 0xffff0000, v40
    v_lshlrev_b32 v62, 16, v41
    v_and_b32 v63, 0xffff0000, v41
    v_lshlrev_b32 v64, 16, v42
    v_and_b32 v65, 0xffff0000, v42
    v_lshlrev_b32 v66, 16, v43
    v_and_b32 v67, 0xffff0000, v43
    v_lshlrev_b32 v68, 16, v44
    v_and_b32 v69, 0xffff0000, v44
    v_lshlrev_b32 v70, 16, v45
    v_and_b32 v71, 0xffff0000, v45
    v_lshlrev_b32 v72, 16, v46
    v_and_b32 v73, 0xffff0000, v46
    v_lshlrev_b32 v74, 16, v47
    v_and_b32 v75, 0xffff0000, v47
    v_lshlrev_b32 v76, 16, v48
    v_and_b32 v77, 0xffff0000, v48
    v_lshlrev_b32 v78, 16, v49
    v_and_b32 v79, 0xffff0000, v49
    v_lshlrev_b32 v80, 16, v50
    v_and_b32 v81, 0xffff0000, v50
    v_lshlrev_b32 v82, 16, v51
    v_and_b32 v83, 0xffff0000, v51
    v_lshlrev_b32 v84, 16, v52
    v_and_b32 v85, 0xffff0000, v52
    v_lshlrev_b32 v86, 16, v53
    v_and_b32 v87, 0xffff0000, v53
    v_lshlrev_b32 v88, 16, v54
    v_and_b32 v89, 0xffff0000, v54
    v_lshlrev_b32 v90, 16, v55
    v_and_b32 v91, 0xffff0000, v55
    v_lshlrev_b32 v92, 16, v56
    v_and_b32 v93, 0xffff0000, v56
    v_lshlrev_b32 v94, 16, v57
    v_and_b32 v95, 0xffff0000, v57
    v_lshlrev_b32 v96, 16, v58
    v_and_b32 v97, 0xffff0000, v58
    v_lshlrev_b32 v98, 16, v59
    v_and_b32 v99, 0xffff0000, v59
    v_pk_mul_f32 v[60:61], v[60:61], v[8:9]
    v_pk_mul_f32 v[62:63], v[62:63], v[8:9]
    v_pk_mul_f32 v[64:65], v[64:65], v[8:9]
    v_pk_mul_f32 v[66:67], v[66:67], v[8:9]
    v_pk_mul_f32 v[68:69], v[68:69], v[8:9]
    v_pk_mul_f32 v[70:71], v[70:71], v[8:9]
    v_pk_mul_f32 v[72:73], v[72:73], v[8:9]
    v_pk_mul_f32 v[74:75], v[74:75], v[8:9]
    v_pk_mul_f32 v[76:77], v[76:77], v[8:9]
    v_pk_mul_f32 v[78:79], v[78:79], v[8:9]
    v_pk_mul_f32 v[80:81], v[80:81], v[8:9]
    v_pk_mul_f32 v[82:83], v[82:83], v[8:9]
    v_pk_mul_f32 v[84:85], v[84:85], v[8:9]
    v_pk_mul_f32 v[86:87], v[86:87], v[8:9]
    v_pk_mul_f32 v[88:89], v[88:89], v[8:9]
    v_pk_mul_f32 v[90:91], v[90:91], v[8:9]
    v_pk_mul_f32 v[92:93], v[92:93], v[8:9]
    v_pk_mul_f32 v[94:95], v[94:95], v[8:9]
    v_pk_mul_f32 v[96:97], v[96:97], v[8:9]
    v_pk_mul_f32 v[98:99], v[98:99], v[8:9]
    s_setpc_b64 s[100:101]
XS_sub:
    v_pk_mul_f32 v[60:61], v[60:61], v[100:101]
    v_pk_mul_f32 v[62:63], v[62:63], v[102:103]
    v_pk_mul_f32 v[64:65], v[64:65], v[104:105]
    v_pk_mul_f32 v[66:67], v[66:67], v[106:107]
    v_pk_mul_f32 v[68:69], v[68:69], v[108:109]
    v_pk_mul_f32 v[70:71], v[70:71], v[110:111]
    v_pk_mul_f32 v[72:73], v[72:73], v[112:113]
    v_pk_mul_f32 v[74:75], v[74:75], v[114:115]
    v_pk_mul_f32 v[76:77], v[76:77], v[116:117]
    v_pk_mul_f32 v[78:79], v[78:79], v[118:119]
    v_pk_mul_f32 v[80:81], v[80:81], v[120:121]
    v_pk_mul_f32 v[82:83], v[82:83], v[122:123]
    v_pk_mul_f32 v[84:85], v[84:85], v[124:125]
    v_pk_mul_f32 v[86:87], v[86:87], v[126:127]
    v_pk_mul_f32 v[88:89], v[88:89], v[128:129]
    v_pk_mul_f32 v[90:91], v[90:91], v[130:131]
    v_pk_mul_f32 v[92:93], v[92:93], v[132:133]
    v_pk_mul_f32 v[94:95], v[94:95], v[134:135]
    v_pk_mul_f32 v[96:97], v[96:97], v[136:137]
    v_pk_mul_f32 v[98:99], v[98:99], v[138:139]
    v_cvt_pk_bf16_f32 v40, v60, v61
    v_cvt_pk_bf16_f32 v41, v62, v63
    v_cvt_pk_bf16_f32 v42, v64, v65
    v_cvt_pk_bf16_f32 v43, v66, v67
    v_cvt_pk_bf16_f32 v44, v68, v69
    v_cvt_pk_bf16_f32 v45, v70, v71
    v_cvt_pk_bf16_f32 v46, v72, v73
    v_cvt_pk_bf16_f32 v47, v74, v75
    v_cvt_pk_bf16_f32 v48, v76, v77
    v_cvt_pk_bf16_f32 v49, v78, v79
    v_cvt_pk_bf16_f32 v50, v80, v81
    v_cvt_pk_bf16_f32 v51, v82, v83
    v_cvt_pk_bf16_f32 v52, v84, v85
    v_cvt_pk_bf16_f32 v53, v86, v87
    v_cvt_pk_bf16_f32 v54, v88, v89
    v_cvt_pk_bf16_f32 v55, v90, v91
    v_cvt_pk_bf16_f32 v56, v92, v93
    v_cvt_pk_bf16_f32 v57, v94, v95
    v_cvt_pk_bf16_f32 v58, v96, v97
    v_cvt_pk_bf16_f32 v59, v98, v99
    v_lshlrev_b32 v60, 16, v40
    v_and_b32 v61, 0xffff0000, v40
    v_lshlrev_b32 v62, 16, v41
    v_and_b32 v63, 0xffff0000, v41
    v_lshlrev_b32 v64, 16, v42
    v_and_b32 v65, 0xffff0000, v42
    v_lshlrev_b32 v66, 16, v43
    v_and_b32 v67, 0xffff0000, v43
    v_lshlrev_b32 v68, 16, v44
    v_and_b32 v69, 0xffff0000, v44
    v_lshlrev_b32 v70, 16, v45
    v_and_b32 v71, 0xffff0000, v45
    v_lshlrev_b32 v72, 16, v46
    v_and_b32 v73, 0xffff0000, v46
    v_lshlrev_b32 v74, 16, v47
    v_and_b32 v75, 0xffff0000, v47
    v_lshlrev_b32 v76, 16, v48
    v_and_b32 v77, 0xffff0000, v48
    v_lshlrev_b32 v78, 16, v49
    v_and_b32 v79, 0xffff0000, v49
    v_lshlrev_b32 v80, 16, v50
    v_and_b32 v81, 0xffff0000, v50
    v_lshlrev_b32 v82, 16, v51
    v_and_b32 v83, 0xffff0000, v51
    v_lshlrev_b32 v84, 16, v52
    v_and_b32 v85, 0xffff0000, v52
    v_lshlrev_b32 v86, 16, v53
    v_and_b32 v87, 0xffff0000, v53
    v_lshlrev_b32 v88, 16, v54
    v_and_b32 v89, 0xffff0000, v54
    v_lshlrev_b32 v90, 16, v55
    v_and_b32 v91, 0xffff0000, v55
    v_lshlrev_b32 v92, 16, v56
    v_and_b32 v93, 0xffff0000, v56
    v_lshlrev_b32 v94, 16, v57
    v_and_b32 v95, 0xffff0000, v57
    v_lshlrev_b32 v96, 16, v58
    v_and_b32 v97, 0xffff0000, v58
    v_lshlrev_b32 v98, 16, v59
    v_and_b32 v99, 0xffff0000, v59
    v_pk_add_f32 v[60:61], v[60:61], v[140:141]
    v_pk_add_f32 v[62:63], v[62:63], v[142:143]
    v_pk_add_f32 v[64:65], v[64:65], v[144:145]
    v_pk_add_f32 v[66:67], v[66:67], v[146:147]
    v_pk_add_f32 v[68:69], v[68:69], v[148:149]
    v_pk_add_f32 v[70:71], v[70:71], v[150:151]
    v_pk_add_f32 v[72:73], v[72:73], v[152:153]
    v_pk_add_f32 v[74:75], v[74:75], v[154:155]
    v_pk_add_f32 v[76:77], v[76:77], v[156:157]
    v_pk_add_f32 v[78:79], v[78:79], v[158:159]
    v_pk_add_f32 v[80:81], v[80:81], v[160:161]
    v_pk_add_f32 v[82:83], v[82:83], v[162:163]
    v_pk_add_f32 v[84:85], v[84:85], v[164:165]
    v_pk_add_f32 v[86:87], v[86:87], v[166:167]
    v_pk_add_f32 v[88:89], v[88:89], v[168:169]
    v_pk_add_f32 v[90:91], v[90:91], v[170:171]
    v_pk_add_f32 v[92:93], v[92:93], v[172:173]
    v_pk_add_f32 v[94:95], v[94:95], v[174:175]
    v_pk_add_f32 v[96:97], v[96:97], v[176:177]
    v_pk_add_f32 v[98:99], v[98:99], v[178:179]
    v_cvt_pk_bf16_f32 v40, v60, v61
    v_cvt_pk_bf16_f32 v41, v62, v63
    v_cvt_pk_bf16_f32 v42, v64, v65
    v_cvt_pk_bf16_f32 v43, v66, v67
    v_cvt_pk_bf16_f32 v44, v68, v69
    v_cvt_pk_bf16_f32 v45, v70, v71
    v_cvt_pk_bf16_f32 v46, v72, v73
    v_cvt_pk_bf16_f32 v47, v74, v75
    v_cvt_pk_bf16_f32 v48, v76, v77
    v_cvt_pk_bf16_f32 v49, v78, v79
    v_cvt_pk_bf16_f32 v50, v80, v81
    v_cvt_pk_bf16_f32 v51, v82, v83
    v_cvt_pk_bf16_f32 v52, v84, v85
    v_cvt_pk_bf16_f32 v53, v86, v87
    v_cvt_pk_bf16_f32 v54, v88, v89
    v_cvt_pk_bf16_f32 v55, v90, v91
    v_cvt_pk_bf16_f32 v56, v92, v93
    v_cvt_pk_bf16_f32 v57, v94, v95
    v_cvt_pk_bf16_f32 v58, v96, v97
    v_cvt_pk_bf16_f32 v59, v98, v99
    s_mov_b64 exec, s[24:25]
    ds_write_b128 v12, v[40:43] offset:0
    ds_write_b128 v12, v[44:47] offset:4096
    ds_write_b128 v12, v[48:51] offset:8192
    ds_write_b128 v12, v[52:55] offset:12288
    ds_write_b128 v12, v[56:59] offset:16384
    s_waitcnt lgkmcnt(0)
    s_barrier
    s_cbranch_execz XS_r
    ds_read_b128 v[40:43], v11 offset:0
    ds_read_b128 v[44:47], v11 offset:1024
    ds_read_b128 v[48:51], v11 offset:2048
    ds_read_b128 v[52:55], v11 offset:3072
    ds_read_b128 v[56:59], v11 offset:4096
    s_add_u32 s4, s27, 4096
    s_waitcnt lgkmcnt(4)
    buffer_store_dwordx4 v[40:43], v2, s[8:11], s27 offen offset:0 sc1
    s_waitcnt lgkmcnt(3)
    buffer_store_dwordx4 v[44:47], v2, s[8:11], s27 offen offset:1024 sc1
    s_waitcnt lgkmcnt(2)
    buffer_store_dwordx4 v[48:51], v2, s[8:11], s27 offen offset:2048 sc1
    s_waitcnt lgkmcnt(1)
    buffer_store_dwordx4 v[52:55], v2, s[8:11], s27 offen offset:3072 sc1
    s_waitcnt lgkmcnt(0)
    buffer_store_dwordx4 v[56:59], v2, s[8:11], s4 offen offset:0 sc1
XS_r:
    s_mov_b64 exec, -1
    s_setpc_b64 s[100:101]
R_ovf:
    s_waitcnt vmcnt(0) lgkmcnt(0)
    s_barrier
    s_load_dwordx2 s[12:13], s[0:1], 120
    s_mov_b32 s14, 256
    s_mov_b32 s15, 0x20000
    s_waitcnt lgkmcnt(0)
    v_mov_b32 v4, 0
    s_cmp_lg_u32 s3, 0
    s_cbranch_scc1 RO_b
    s_getreg_b32 s22, hwreg(HW_REG_XCC_ID)
    s_and_b32 s22, s22, 7
    s_lshl_b32 s21, s22, 5
    v_mov_b32 v5, 1
    s_mov_b64 exec, 1
    buffer_atomic_add v5, v4, s[12:15], s21 offen offset:12 sc0 sc1
    s_mov_b64 exec, -1
    v_and_b32 v6, 7, v1
    v_lshlrev_b32 v6, 5, v6
    s_waitcnt vmcnt(0)
    v_readfirstlane_b32 s20, v5
    s_mov_b32 s31, 0
RO_l:
    buffer_load_dwordx4 v[8:11], v6, s[12:15], 0 offen sc1
    s_waitcnt vmcnt(0)
    v_bcnt_u32_b32 v7, v8, v11
    v_cmp_lt_u32 s[4:5], 32, v7
    s_and_b32 s23, s4, 0xff
    v_cmp_ne_u32 s[4:5], 32, v7
    s_cmp_eq_u32 s23, 0
    s_cselect_b32 s5, 0xff, 0
    s_and_b32 s4, s4, s5
    s_mov_b32 s5, 0
    s_mov_b32 s24, s20
    v_readlane_b32 s4, v7, 0
    s_add_u32 s5, s5, s4
    v_readlane_b32 s4, v11, 0
    s_cmp_gt_u32 s22, 0
    s_cselect_b32 s4, s4, 0
    s_add_u32 s24, s24, s4
    v_readlane_b32 s4, v7, 1
    s_add_u32 s5, s5, s4
    v_readlane_b32 s4, v11, 1
    s_cmp_gt_u32 s22, 1
    s_cselect_b32 s4, s4, 0
    s_add_u32 s24, s24, s4
    v_readlane_b32 s4, v7, 2
    s_add_u32 s5, s5, s4
    v_readlane_b32 s4, v11, 2
    s_cmp_gt_u32 s22, 2
    s_cselect_b32 s4, s4, 0
    s_add_u32 s24, s24, s4
    v_readlane_b32 s4, v7, 3
    s_add_u32 s5, s5, s4
    v_readlane_b32 s4, v11, 3
    s_cmp_gt_u32 s22, 3
    s_cselect_b32 s4, s4, 0
    s_add_u32 s24, s24, s4
    v_readlane_b32 s4, v7, 4
    s_add_u32 s5, s5, s4
    v_readlane_b32 s4, v11, 4
    s_cmp_gt_u32 s22, 4
    s_cselect_b32 s4, s4, 0
    s_add_u32 s24, s24, s4
    v_readlane_b32 s4, v7, 5
    s_add_u32 s5, s5, s4
    v_readlane_b32 s4, v11, 5
    s_cmp_gt_u32 s22, 5
    s_cselect_b32 s4, s4, 0
    s_add_u32 s24, s24, s4
    v_readlane_b32 s4, v7, 6
    s_add_u32 s5, s5, s4
    v_readlane_b32 s4, v11, 6
    s_cmp_gt_u32 s22, 6
    s_cselect_b32 s4, s4, 0
    s_add_u32 s24, s24, s4
    v_readlane_b32 s4, v7, 7
    s_add_u32 s5, s5, s4
    v_readlane_b32 s4, v11, 7
    s_cmp_gt_u32 s22, 7
    s_cselect_b32 s4, s4, 0
    s_add_u32 s24, s24, s4
    s_cmp_ge_u32 s5, 256
    s_cbranch_scc1 RO_o
    s_sleep 4
    s_add_u32 s31, s31, 1
    s_cmp_lt_u32 s31, 0x80000
    s_cbranch_scc1 RO_l
    s_mov_b32 s21, 256
    s_branch RO_w
RO_o:
    v_mov_b32 v7, v8
    s_cmp_eq_u32 s23, 0
    s_cselect_b32 s21, s21, 0
    s_cselect_b32 s20, s20, s24
RO_x:
    s_lshr_b32 s6, s21, 5
    s_nop 4
    v_readlane_b32 s4, v7, s6
    s_bcnt0_i32_b32 s5, s4
    s_cmp_lt_u32 s20, s5
    s_cbranch_scc1 RO_f
    s_sub_u32 s20, s20, s5
    s_add_u32 s21, s21, 32
    s_cmp_lt_u32 s21, 256
    s_cbranch_scc1 RO_x
    s_branch RO_w
RO_f:
    s_ff0_i32_b32 s5, s4
    s_bitset1_b32 s4, s5
    s_sub_u32 s20, s20, 1
    s_cbranch_scc0 RO_f
    s_add_u32 s21, s21, s5
RO_w:
    v_mov_b32 v5, s21
    ds_write_b32 v4, v5
    s_waitcnt lgkmcnt(0)
RO_b:
    s_barrier
    ds_read_b32 v5, v4
    s_waitcnt lgkmcnt(0)
    v_readfirstlane_b32 s20, v5
    s_barrier
    s_cmp_ge_u32 s20, 256
    s_cbranch_scc1 R_exit
    s_lshr_b32 s4, s20, 5
    s_and_b32 s20, s20, 31
    s_mov_b32 s33, 0
    s_branch R_disp
R_c8:
    v_mov_b32 v133, 163776
    s_cmp_lg_u32 s3, 0
    s_cbranch_scc1 R_c8b
    s_mov_b32 s31, 0
    s_sleep 8
R_c8l:
    v_mov_b32 v135, 0
    s_mov_b64 exec, 1
    buffer_atomic_or v135, v134, s[12:15], s5 offen sc0 sc1
    s_mov_b64 exec, -1
    s_waitcnt vmcnt(0)
    v_readfirstlane_b32 s6, v135
    s_lshr_b32 s6, s6, s7
    s_and_b32 s6, s6, 0xff
    s_bcnt1_i32_b32 s21, s6
    s_add_u32 s31, s31, 1
    s_cmp_ge_u32 s31, 40
    s_cselect_b32 s21, 8, s21
    s_cmp_lt_u32 s21, 7
    s_cbranch_scc1 R_c8l
    s_ff0_i32_b32 s6, s6
    s_add_u32 s6, s6, s7
    s_cmp_eq_u32 s21, 7
    s_cselect_b32 s20, s6, s20
    v_mov_b32 v135, s20
    ds_write_b32 v133, v135
    s_waitcnt lgkmcnt(0)
R_c8b:
    s_barrier
    ds_read_b32 v135, v133
    s_waitcnt lgkmcnt(0)
    v_readfirstlane_b32 s20, v135
    s_barrier
    s_branch R_clm
R_done:
    s_waitcnt vmcnt(0)
R_exit:
    s_endpgm
.section .rodata,"a"
.p2align 6
.amdhsa_kernel rec_kernel
  .amdhsa_next_free_vgpr 512
  .amdhsa_next_free_sgpr 102
  .amdhsa_accum_offset 256
  .amdhsa_group_segment_fixed_size 0
  .amdhsa_kernarg_size 136
  .amdhsa_user_sgpr_count 2
  .amdhsa_user_sgpr_kernarg_segment_ptr 1
  .amdhsa_system_sgpr_workgroup_id_x 1
.end_amdhsa_kernel
```
